```python
import torch

def _softmax(x, axis=-1):
    return torch.softmax(x, dim=axis)
def _gelu(x):
    return torch.nn.functional.gelu(x, approximate="tanh")
def _silu(x):
    return torch.nn.functional.silu(x)
def _sigmoid(x):
    return torch.sigmoid(x)
def _layernorm(x, axis=-1, eps=1e-5):
    m = x.mean(dim=axis, keepdim=True)
    v = x.var(dim=axis, keepdim=True, unbiased=False)
    return (x - m) / torch.sqrt(v + eps)
def _scatter_add(tgt, idx, src, axis=0):
    return tgt.clone().index_add_(axis, idx, src)
def _segment_sum(src, seg, n):
    out = torch.zeros((n,) + src.shape[1:], dtype=src.dtype)
    return out.index_add_(0, seg, src)
def _pad(x, pw):
    flat = tuple(v for pair in reversed(pw) for v in pair)
    return torch.nn.functional.pad(x, flat)

kernel_name = 'interleave_layers__gqa_block_cached__glu_gated_geglu__decode'

def setup_inputs():

    _w = (lambda a: (lambda t: t.to(torch.bfloat16) if t.is_floating_point() else t)(torch.as_tensor(a)))
    def _A_setup():
        B, Sq, D = 1, 1, 576
        Hq, Hkv, Sk, Dh = 32, 16, 65536, 128
        assert Hq % Hkv == 0, (Hq, Hkv)
        return {
            "x": _w((lambda *s: torch.randn(*s, dtype=torch.bfloat16) * 0.05)(B, Sq, D)),
            "k_cache": _w((lambda *s: torch.randn(*s, dtype=torch.bfloat16) * 0.8)(B, Hkv, Sk, Dh)),
            "v_cache": _w((lambda *s: torch.randn(*s, dtype=torch.bfloat16) * 1.6)(B, Hkv, Sk, Dh)),
            "wq": _w((lambda *s: torch.randn(*s, dtype=torch.bfloat16) * 0.8)(D, Hq * Dh) * (D ** -0.5)),
            "wo": _w((lambda *s: torch.randn(*s, dtype=torch.bfloat16) * 1.6)(Hq * Dh, D) * ((Hq * Dh) ** -0.5)),
        }
    _A_in = _A_setup()

    def _B_setup():
        B, S, Dm, Df = 1, 1, 576, 4608
        return {
            "x": _w((lambda *s: torch.randn(*s, dtype=torch.bfloat16) * 0.05)(B, S, Dm)),
            "w_gate": _w((lambda *s: torch.randn(*s, dtype=torch.bfloat16) * 0.4)(Dm, Df) * (Dm ** -0.5)),
            "w_up": _w((lambda *s: torch.randn(*s, dtype=torch.bfloat16) * 0.4)(Dm, Df) * (Dm ** -0.5)),
            "w_down": _w((lambda *s: torch.randn(*s, dtype=torch.bfloat16) * 0.4)(Df, Dm) * (Df ** -0.5)),
        }
    _B_in = _B_setup()

    return {
        "A_x": _A_in["x"],
        "A_k_cache": _A_in["k_cache"],
        "A_v_cache": _A_in["v_cache"],
        "A_wq": _A_in["wq"],
        "A_wo": _A_in["wo"],
        "B_x": _B_in["x"],
        "B_w_gate": _B_in["w_gate"],
        "B_w_up": _B_in["w_up"],
        "B_w_down": _B_in["w_down"],
    }

def reference(A_x, A_k_cache, A_v_cache, A_wq, A_wo, B_x, B_w_gate, B_w_up, B_w_down):
    def _A_ref(x, k_cache, v_cache, wq, wo):
        B, Sq, D = x.shape
        Hq, Dh = 32, 128
        Hkv = k_cache.shape[1]
        rep = Hq // Hkv
        q = (lambda x, *d: x.permute(*d))((x @ wq).reshape(B, Sq, Hq, Dh), 0, 2, 1, 3)
        k = (lambda x, n, axis: torch.repeat_interleave(x, n, dim=axis))(k_cache, rep, axis=1)
        v = (lambda x, n, axis: torch.repeat_interleave(x, n, dim=axis))(v_cache, rep, axis=1)
        scores = torch.einsum("bhqd,bhkd->bhqk", q, k) * (Dh ** -0.5)
        p = _softmax(scores, axis=-1)
        o = torch.einsum("bhqk,bhkd->bhqd", p, v)
        return (lambda x, *d: x.permute(*d))(o, 0, 2, 1, 3).reshape(B, Sq, Hq * Dh) @ wo

    def _B_ref(x, w_gate, w_up, w_down):
        g = torch.einsum("bsd,df->bsf", x, w_gate)
        u = torch.einsum("bsd,df->bsf", x, w_up)
        h = _gelu(g) * u
        return torch.einsum("bsf,fd->bsd", h, w_down)

    x = A_x
    x = x + _A_ref(_layernorm(x, axis=-1), A_k_cache, A_v_cache, A_wq, A_wo)
    x = x + _B_ref(_layernorm(x, axis=-1), B_w_gate, B_w_up, B_w_down)
    x = x + _A_ref(_layernorm(x, axis=-1), A_k_cache, A_v_cache, A_wq, A_wo)
    x = x + _B_ref(_layernorm(x, axis=-1), B_w_gate, B_w_up, B_w_down)
    return x
```

```asm
; @launch grid=(256,1,1) block=(256,1,1) lds=163840
.amdgcn_target "amdgcn-amd-amdhsa--gfx950"
.text
.globl interleave_layers__gqa_block_cached__glu_gated_geglu__decode_kernel
.p2align 8
.type interleave_layers__gqa_block_cached__glu_gated_geglu__decode_kernel,@function
interleave_layers__gqa_block_cached__glu_gated_geglu__decode_kernel:
    s_cmp_ge_u32 s2, 256
    s_cbranch_scc1 L_quit
    s_load_dwordx2 s[4:5], s[0:1], 8
    s_load_dwordx2 s[8:9], s[0:1], 16
    s_load_dwordx2 s[12:13], s[0:1], 24
    s_load_dwordx2 s[16:17], s[0:1], 32
    s_load_dwordx2 s[20:21], s[0:1], 48
    s_load_dwordx2 s[24:25], s[0:1], 56
    s_load_dwordx2 s[28:29], s[0:1], 64
    s_load_dwordx2 s[32:33], s[0:1], 88
    s_load_dwordx2 s[36:37], s[0:1], 80
    s_load_dwordx2 s[40:41], s[0:1], 0
    s_load_dwordx2 s[44:45], s[0:1], 72
    s_load_dwordx2 s[48:49], s[0:1], 88
    s_mov_b32 s6, 268435456
    s_mov_b32 s7, 0x00020000
    s_mov_b32 s10, 268435456
    s_mov_b32 s11, 0x00020000
    s_mov_b32 s14, 4718592
    s_mov_b32 s15, 0x00020000
    s_mov_b32 s18, 4718592
    s_mov_b32 s19, 0x00020000
    s_mov_b32 s22, 5308416
    s_mov_b32 s23, 0x00020000
    s_mov_b32 s26, 5308416
    s_mov_b32 s27, 0x00020000
    s_mov_b32 s30, 5308416
    s_mov_b32 s31, 0x00020000
    s_mov_b32 s34, 8388608
    s_mov_b32 s35, 0x00020000
    s_mov_b32 s38, 256
    s_mov_b32 s39, 0x00020000
    s_mov_b32 s42, 1152
    s_mov_b32 s43, 0x00020000
    s_mov_b32 s46, 1152
    s_mov_b32 s47, 0x00020000
    s_mov_b32 s50, 8388608
    s_mov_b32 s51, 0x00020000
    s_mov_b32 s84, 0
    s_mov_b32 s83, 0
    s_mov_b32 s82, 0
    s_mov_b32 s85, 4096
    v_lshrrev_b32 v1, 6, v0
    v_and_b32 v0, 63, v0
    v_readfirstlane_b32 s3, v1
    s_lshr_b32 s57, s2, 4
    s_add_u32 s58, s2, s57
    s_and_b32 s58, s58, 7
    s_and_b32 s60, s2, 8
    s_or_b32 s58, s58, s60
    s_and_b32 s88, s2, 7
    s_lshr_b32 s91, s2, 3
    s_lshl_b32 s87, s57, 4
    s_add_u32 s87, s87, s58
    s_lshl_b32 s60, s57, 24
    s_lshl_b32 s61, s58, 2
    s_add_u32 s61, s61, s3
    s_mul_i32 s62, s61, 65536
    s_sub_u32 s54, s61, 52
    s_mul_i32 s54, s54, 81920
    s_add_u32 s54, s54, 3407872
    s_cmp_lt_u32 s58, 13
    s_cselect_b32 s61, s62, s54
    s_add_u32 s52, s60, s61
    s_add_u32 s61, s2, 1
    s_and_b32 s61, s61, 7
    s_and_b32 s90, s2, 8
    s_or_b32 s90, s90, s61
    s_add_u32 s61, s2, 1
    s_and_b32 s61, s61, 7
    s_and_b32 s62, s2, 8
    s_or_b32 s61, s61, s62
    s_mul_i32 s62, s3, 256
    s_add_u32 s61, s61, s62
    s_lshl_b32 s61, s61, 12
    s_add_u32 s52, s60, s61
    s_sub_u32 s61, s58, 13
    s_lshl_b32 s61, s61, 2
    s_add_u32 s61, s61, s3
    s_mul_i32 s61, s61, 16384
    s_add_u32 s89, s60, s61
    s_add_u32 s89, s89, 4194304
    s_mul_i32 s61, s3, 3096576
    s_add_u32 s53, s60, s61
    s_add_u32 s53, s53, 4390912
    s_mul_i32 s59, s3, 36864
    s_mov_b32 s55, 0x1e0293ee
    s_mov_b32 s56, 0x41000000
    s_mov_b32 s81, 0
    s_lshr_b32 s62, s57, 3
    s_add_u32 s60, s62, 16
    s_cmp_lt_u32 s58, 8
    s_cselect_b32 s63, s57, s60
    s_mul_i32 s61, s88, 18
    s_add_u32 s63, s63, s61
    s_cmp_lt_u32 s58, 9
    s_cbranch_scc1 RL_1
    s_mov_b32 s81, 1
    s_sub_u32 s63, s58, 9
    s_cmp_lt_u32 s58, 13
    s_cbranch_scc1 RL_1
    s_mov_b32 s81, 2
    s_sub_u32 s63, s58, 13
    s_lshl_b32 s63, s63, 1
    s_add_u32 s63, s63, s62
RL_1:
    s_mov_b32 s66, 0x00ff00ff
    s_mov_b32 s67, 0x00ff00ff
    s_mov_b32 s68, 0x00ff00ff
    s_mov_b32 s69, 0xff00ff00
    s_mov_b32 s70, 0x0f0f0f0f
    s_mov_b32 s71, 0x0f0f0f0f
    s_mov_b32 s72, 0xf0f0f0f0
    s_mov_b32 s73, 0xf0f0f0f0
    s_mov_b32 s74, 0x55555555
    s_mov_b32 s75, 0x55555555
    v_lshrrev_b32 v1, 4, v0
    v_and_b32 v2, 15, v0
    v_xor_b32 v38, v1, v2
    v_xor_b32 v36, 0, v38
    v_lshlrev_b32 v36, 4, v36
    v_lshl_add_u32 v4, v1, 8, v36
    v_lshl_add_u32 v9, v2, 8, v36
    v_add_u32 v9, s59, v9
    v_xor_b32 v36, 4, v38
    v_lshlrev_b32 v36, 4, v36
    v_lshl_add_u32 v5, v1, 8, v36
    v_lshl_add_u32 v10, v2, 8, v36
    v_add_u32 v10, s59, v10
    v_xor_b32 v36, 8, v38
    v_lshlrev_b32 v36, 4, v36
    v_lshl_add_u32 v6, v1, 8, v36
    v_lshl_add_u32 v11, v2, 8, v36
    v_add_u32 v11, s59, v11
    v_xor_b32 v36, 12, v38
    v_lshlrev_b32 v36, 4, v36
    v_lshl_add_u32 v7, v1, 8, v36
    v_lshl_add_u32 v12, v2, 8, v36
    v_add_u32 v12, s59, v12
    v_lshlrev_b32 v8, 10, v1
    v_lshl_add_u32 v8, v2, 4, v8
    v_and_b32 v38, 1, v0
    v_cmp_eq_u32 vcc, 1, v38
    v_mov_b32 v36, 0x0000ffff
    v_mov_b32 v37, 0xffff0000
    v_cndmask_b32 v36, v36, v37, vcc
    v_bfe_u32 v38, v0, 1, 2
    v_cmp_eq_u32 vcc, 0, v38
    s_nop 1
    v_cndmask_b32 v13, 0, v36, vcc
    v_cmp_eq_u32 vcc, 1, v38
    s_nop 1
    v_cndmask_b32 v14, 0, v36, vcc
    v_cmp_eq_u32 vcc, 2, v38
    s_nop 1
    v_cndmask_b32 v15, 0, v36, vcc
    v_cmp_eq_u32 vcc, 3, v38
    s_nop 1
    v_cndmask_b32 v16, 0, v36, vcc
    s_waitcnt lgkmcnt(0)
    s_cmp_eq_u32 s81, 1
    s_cbranch_scc0 NQ_2
    s_cmp_eq_u32 s3, 0
    s_cbranch_scc0 X0_4
    v_lshlrev_b32 v2, 4, v0
    v_mov_b32 v68, 0
    v_mov_b32 v69, 0
    v_mov_b32 v70, 0
    v_mov_b32 v71, 0
    buffer_load_dwordx4 v[64:67], v2, s[40:43], 0 offen
    s_mov_b64 exec, 0xff
    buffer_load_dwordx4 v[68:71], v2, s[40:43], 0 offen offset:1024
    s_mov_b64 exec, -1
X0_4:
    v_lshrrev_b32 v1, 4, v0
    v_lshlrev_b32 v1, 1, v1
    v_bfe_u32 v2, v0, 3, 1
    v_add_u32 v1, v1, v2
    v_mul_u32_u24 v1, 8192, v1
    v_and_b32 v2, 7, v0
    v_lshl_add_u32 v1, v2, 4, v1
    s_mul_i32 s60, s3, 1179648
    s_lshl_b32 s61, s57, 9
    s_lshl_b32 s62, s63, 7
    s_add_u32 s61, s61, s62
    s_add_u32 s60, s60, s61
    s_add_u32 s61, s60, 0
    buffer_load_dwordx4 a[160:163], v1, s[12:15], s61 offen nt
    s_add_u32 s61, s60, 65536
    buffer_load_dwordx4 a[164:167], v1, s[12:15], s61 offen nt
    s_add_u32 s61, s60, 131072
    buffer_load_dwordx4 a[168:171], v1, s[12:15], s61 offen nt
    s_add_u32 s61, s60, 196608
    buffer_load_dwordx4 a[172:175], v1, s[12:15], s61 offen nt
    s_add_u32 s61, s60, 262144
    buffer_load_dwordx4 a[176:179], v1, s[12:15], s61 offen nt
    s_add_u32 s61, s60, 327680
    buffer_load_dwordx4 a[180:183], v1, s[12:15], s61 offen nt
    s_add_u32 s61, s60, 393216
    buffer_load_dwordx4 a[184:187], v1, s[12:15], s61 offen nt
    s_add_u32 s61, s60, 458752
    buffer_load_dwordx4 a[188:191], v1, s[12:15], s61 offen nt
    s_add_u32 s61, s60, 524288
    buffer_load_dwordx4 a[192:195], v1, s[12:15], s61 offen nt
    s_add_u32 s61, s60, 589824
    buffer_load_dwordx4 a[196:199], v1, s[12:15], s61 offen nt
    s_add_u32 s61, s60, 655360
    buffer_load_dwordx4 a[200:203], v1, s[12:15], s61 offen nt
    s_add_u32 s61, s60, 720896
    buffer_load_dwordx4 a[204:207], v1, s[12:15], s61 offen nt
    s_add_u32 s61, s60, 786432
    buffer_load_dwordx4 a[208:211], v1, s[12:15], s61 offen nt
    s_add_u32 s61, s60, 851968
    buffer_load_dwordx4 a[212:215], v1, s[12:15], s61 offen nt
    s_add_u32 s61, s60, 917504
    buffer_load_dwordx4 a[216:219], v1, s[12:15], s61 offen nt
    s_add_u32 s61, s60, 983040
    buffer_load_dwordx4 a[220:223], v1, s[12:15], s61 offen nt
    s_add_u32 s61, s60, 1048576
    buffer_load_dwordx4 a[224:227], v1, s[12:15], s61 offen nt
    s_add_u32 s61, s60, 1114112
    buffer_load_dwordx4 a[228:231], v1, s[12:15], s61 offen nt
NQ_2:
    v_mov_b32 v24, -1
    v_mov_b32 v25, -1
    v_mov_b32 v26, -1
    v_mov_b32 v27, -1
    v_lshlrev_b32 v36, 4, v0
    s_mul_i32 s60, s2, 10752
    s_lshl_b32 s61, s3, 10
    s_add_u32 s60, s60, s61
    buffer_store_dwordx4 v[24:27], v36, s[32:35], s60 offen sc1
    s_add_u32 s60, s60, 4096
    buffer_store_dwordx4 v[24:27], v36, s[32:35], s60 offen sc1
    s_cmp_lt_u32 s3, 3
    s_cbranch_scc0 CLR_5
    s_add_u32 s60, s60, 4096
    s_cmp_eq_u32 s3, 2
    s_cbranch_scc0 CLRH_6
    s_mov_b64 exec, 0xffffffff
CLRH_6:
    buffer_store_dwordx4 v[24:27], v36, s[32:35], s60 offen sc1
    s_mov_b64 exec, -1
CLR_5:
    s_cmp_eq_u32 s3, 3
    s_cbranch_scc0 CZ_7
    s_cmp_lt_u32 s2, 128
    s_cbranch_scc0 CZ_7
    s_lshl_b32 s60, s2, 8
    s_add_u32 s60, s60, 3211264
    v_mov_b32 v37, 0
    s_mov_b64 exec, 1
    buffer_store_dword v37, v37, s[32:35], s60 offen sc1
    s_mov_b64 exec, -1
CZ_7:
    v_mov_b32 v44, 0
    v_mov_b32 v45, 0
    s_mul_i32 s60, s3, 288
    v_lshlrev_b32 v37, 3, v0
    s_mov_b32 exec_lo, -1
    s_mov_b32 exec_hi, 0xf
    s_cmp_eq_u32 s81, 2
    s_cbranch_scc0 XS_8
    s_mul_i32 s60, s3, 6
    s_add_u32 s60, s60, s63
    s_lshl_b32 s60, s60, 6
    s_mov_b64 exec, -1
    v_and_b32 v37, 7, v0
    v_lshlrev_b32 v37, 3, v37
XS_8:
    buffer_load_dwordx2 v[44:45], v37, s[40:43], s60 offen
    s_mov_b64 exec, -1
    s_cmp_eq_u32 s3, 0
    s_cbranch_scc0 XC_9
    s_getreg_b32 s60, hwreg(HW_REG_XCC_ID, 0, 4)
    s_lshl_b32 s60, 1, s60
    v_mov_b32 v37, s60
    s_lshl_b32 s60, s88, 2
    v_mov_b32 v36, s60
    s_mov_b64 exec, 1
    buffer_atomic_or v37, v36, s[36:39], 0 offen offset:96
    s_mov_b64 exec, -1
XC_9:
    s_cmp_eq_u32 s81, 1
    s_cbranch_scc0 ST_3
    s_cmp_eq_u32 s3, 0
    s_cbranch_scc0 LN0_10
    s_waitcnt vmcnt(0)
    v_lshlrev_b32 v48, 16, v64
    v_and_b32 v49, 0xffff0000, v64
    v_lshlrev_b32 v50, 16, v65
    v_and_b32 v51, 0xffff0000, v65
    v_lshlrev_b32 v52, 16, v66
    v_and_b32 v53, 0xffff0000, v66
    v_lshlrev_b32 v54, 16, v67
    v_and_b32 v55, 0xffff0000, v67
    v_lshlrev_b32 v56, 16, v68
    v_and_b32 v57, 0xffff0000, v68
    v_lshlrev_b32 v58, 16, v69
    v_and_b32 v59, 0xffff0000, v69
    v_lshlrev_b32 v60, 16, v70
    v_and_b32 v61, 0xffff0000, v70
    v_lshlrev_b32 v62, 16, v71
    v_and_b32 v63, 0xffff0000, v71
    v_add_f32 v38, v48, v49
    v_add_f32 v39, v50, v51
    v_mul_f32 v40, v48, v48
    v_mul_f32 v41, v49, v49
    v_add_f32 v38, v38, v52
    v_add_f32 v39, v39, v53
    v_add_f32 v38, v38, v54
    v_add_f32 v39, v39, v55
    v_add_f32 v38, v38, v56
    v_add_f32 v39, v39, v57
    v_add_f32 v38, v38, v58
    v_add_f32 v39, v39, v59
    v_add_f32 v38, v38, v60
    v_add_f32 v39, v39, v61
    v_add_f32 v38, v38, v62
    v_add_f32 v39, v39, v63
    v_fma_f32 v40, v50, v50, v40
    v_fma_f32 v41, v51, v51, v41
    v_fma_f32 v40, v52, v52, v40
    v_fma_f32 v41, v53, v53, v41
    v_fma_f32 v40, v54, v54, v40
    v_fma_f32 v41, v55, v55, v41
    v_fma_f32 v40, v56, v56, v40
    v_fma_f32 v41, v57, v57, v41
    v_fma_f32 v40, v58, v58, v40
    v_fma_f32 v41, v59, v59, v41
    v_fma_f32 v40, v60, v60, v40
    v_fma_f32 v41, v61, v61, v41
    v_fma_f32 v40, v62, v62, v40
    v_fma_f32 v41, v63, v63, v41
    v_add_f32 v38, v38, v39
    v_add_f32 v40, v40, v41
    s_nop 0
    v_add_f32_dpp v38, v38, v38 row_ror:8 row_mask:0xf bank_mask:0xf
    v_add_f32_dpp v40, v40, v40 row_ror:8 row_mask:0xf bank_mask:0xf
    s_nop 0
    v_add_f32_dpp v38, v38, v38 row_ror:4 row_mask:0xf bank_mask:0xf
    v_add_f32_dpp v40, v40, v40 row_ror:4 row_mask:0xf bank_mask:0xf
    s_nop 0
    v_add_f32_dpp v38, v38, v38 row_ror:2 row_mask:0xf bank_mask:0xf
    v_add_f32_dpp v40, v40, v40 row_ror:2 row_mask:0xf bank_mask:0xf
    s_nop 0
    v_add_f32_dpp v38, v38, v38 row_ror:1 row_mask:0xf bank_mask:0xf
    v_add_f32_dpp v40, v40, v40 row_ror:1 row_mask:0xf bank_mask:0xf
    v_mov_b32 v39, v38
    v_mov_b32 v41, v40
    s_nop 0
    v_permlane16_swap_b32 v38, v39
    v_permlane16_swap_b32 v40, v41
    v_add_f32 v38, v38, v39
    v_add_f32 v40, v40, v41
    v_mov_b32 v39, v38
    v_mov_b32 v41, v40
    s_nop 0
    v_permlane32_swap_b32 v38, v39
    v_permlane32_swap_b32 v40, v41
    v_add_f32 v38, v38, v39
    v_add_f32 v40, v40, v41
    v_mul_f32 v38, 0x3ae38e39, v38
    v_mul_f32 v40, 0x3ae38e39, v40
    v_fma_f32 v40, -v38, v38, v40
    v_max_f32 v40, 0, v40
    v_cvt_pk_bf16_f32 v39, v38, v40
    v_lshlrev_b32 v38, 16, v39
    v_and_b32 v40, 0xffff0000, v39
    v_add_f32 v40, 0x3727c5ac, v40
    v_cvt_pk_bf16_f32 v40, v40, v40
    v_and_b32 v40, 0xffff0000, v40
    v_sqrt_f32 v40, v40
    s_nop 0
    v_cvt_pk_bf16_f32 v40, v40, v40
    v_and_b32 v40, 0xffff0000, v40
    v_rcp_f32 v40, v40
    v_lshlrev_b32 v42, 5, v0
    v_add_u32 v42, 153600, v42
    v_sub_f32 v48, v48, v38
    v_sub_f32 v49, v49, v38
    v_sub_f32 v50, v50, v38
    v_sub_f32 v51, v51, v38
    v_sub_f32 v52, v52, v38
    v_sub_f32 v53, v53, v38
    v_sub_f32 v54, v54, v38
    v_sub_f32 v55, v55, v38
    v_sub_f32 v56, v56, v38
    v_sub_f32 v57, v57, v38
    v_sub_f32 v58, v58, v38
    v_sub_f32 v59, v59, v38
    v_sub_f32 v60, v60, v38
    v_sub_f32 v61, v61, v38
    v_sub_f32 v62, v62, v38
    v_sub_f32 v63, v63, v38
    v_mul_f32 v48, v48, v40
    v_mul_f32 v49, v49, v40
    v_mul_f32 v50, v50, v40
    v_mul_f32 v51, v51, v40
    v_mul_f32 v52, v52, v40
    v_mul_f32 v53, v53, v40
    v_mul_f32 v54, v54, v40
    v_mul_f32 v55, v55, v40
    v_mul_f32 v56, v56, v40
    v_mul_f32 v57, v57, v40
    v_mul_f32 v58, v58, v40
    v_mul_f32 v59, v59, v40
    v_mul_f32 v60, v60, v40
    v_mul_f32 v61, v61, v40
    v_mul_f32 v62, v62, v40
    v_mul_f32 v63, v63, v40
    v_cvt_pk_bf16_f32 v48, v48, v48
    v_cvt_pk_bf16_f32 v49, v49, v49
    v_cvt_pk_bf16_f32 v50, v50, v50
    v_cvt_pk_bf16_f32 v51, v51, v51
    v_cvt_pk_bf16_f32 v52, v52, v52
    v_cvt_pk_bf16_f32 v53, v53, v53
    v_cvt_pk_bf16_f32 v54, v54, v54
    v_cvt_pk_bf16_f32 v55, v55, v55
    v_cvt_pk_bf16_f32 v56, v56, v56
    v_cvt_pk_bf16_f32 v57, v57, v57
    v_cvt_pk_bf16_f32 v58, v58, v58
    v_cvt_pk_bf16_f32 v59, v59, v59
    v_cvt_pk_bf16_f32 v60, v60, v60
    v_cvt_pk_bf16_f32 v61, v61, v61
    v_cvt_pk_bf16_f32 v62, v62, v62
    v_cvt_pk_bf16_f32 v63, v63, v63
    ds_write_b32 v42, v48 offset:0
    ds_write_b32 v42, v49 offset:4
    ds_write_b32 v42, v50 offset:8
    ds_write_b32 v42, v51 offset:12
    ds_write_b32 v42, v52 offset:16
    ds_write_b32 v42, v53 offset:20
    ds_write_b32 v42, v54 offset:24
    ds_write_b32 v42, v55 offset:28
    s_mov_b64 exec, 0xff
    ds_write_b32 v42, v56 offset:2048
    ds_write_b32 v42, v57 offset:2052
    ds_write_b32 v42, v58 offset:2056
    ds_write_b32 v42, v59 offset:2060
    ds_write_b32 v42, v60 offset:2064
    ds_write_b32 v42, v61 offset:2068
    ds_write_b32 v42, v62 offset:2072
    ds_write_b32 v42, v63 offset:2076
    s_mov_b64 exec, -1
    s_nop 7
    s_nop 1
LN0_10:
    v_lshrrev_b32 v38, 4, v0
    v_lshlrev_b32 v38, 1, v38
    v_bfe_u32 v39, v0, 3, 1
    v_add_u32 v38, v38, v39
    s_mul_i32 s60, s3, 144
    v_add_u32 v38, s60, v38
    v_lshlrev_b32 v38, 2, v38
    v_add_u32 v38, 153600, v38
    v_lshrrev_b32 v40, 5, v0
    v_lshlrev_b32 v40, 8, v40
    v_bfe_u32 v39, v0, 4, 1
    v_lshl_add_u32 v40, v39, 7, v40
    v_and_b32 v39, 7, v0
    v_lshl_add_u32 v40, v39, 2, v40
    s_lshl_b32 s60, s3, 9
    s_add_u32 s60, s60, 156160
    v_add_u32 v40, s60, v40
    s_waitcnt vmcnt(0)
    s_waitcnt lgkmcnt(0)
    s_barrier
    ds_read2_b32 v[48:49], v38 offset0:0 offset1:8
    ds_read2_b32 v[50:51], v38 offset0:16 offset1:24
    ds_read2_b32 v[52:53], v38 offset0:32 offset1:40
    ds_read2_b32 v[54:55], v38 offset0:48 offset1:56
    ds_read2_b32 v[56:57], v38 offset0:64 offset1:72
    ds_read2_b32 v[58:59], v38 offset0:80 offset1:88
    ds_read2_b32 v[60:61], v38 offset0:96 offset1:104
    ds_read2_b32 v[62:63], v38 offset0:112 offset1:120
    ds_read2_b32 v[64:65], v38 offset0:128 offset1:136
    s_waitcnt lgkmcnt(8)
    v_and_b32 v24, v48, v13
    v_and_b32 v25, v48, v14
    v_and_b32 v26, v48, v15
    v_and_b32 v27, v48, v16
    s_nop 1
    v_mfma_f32_16x16x32_bf16 v[20:23], a[160:163], v[24:27], 0
    v_and_b32 v28, v49, v13
    v_and_b32 v29, v49, v14
    v_and_b32 v30, v49, v15
    v_and_b32 v31, v49, v16
    s_nop 1
    v_mfma_f32_16x16x32_bf16 v[32:35], a[164:167], v[28:31], 0
    s_waitcnt lgkmcnt(7)
    v_and_b32 v24, v50, v13
    v_and_b32 v25, v50, v14
    v_and_b32 v26, v50, v15
    v_and_b32 v27, v50, v16
    s_nop 1
    v_mfma_f32_16x16x32_bf16 v[20:23], a[168:171], v[24:27], v[20:23]
    v_and_b32 v28, v51, v13
    v_and_b32 v29, v51, v14
    v_and_b32 v30, v51, v15
    v_and_b32 v31, v51, v16
    s_nop 1
    v_mfma_f32_16x16x32_bf16 v[32:35], a[172:175], v[28:31], v[32:35]
    s_waitcnt lgkmcnt(6)
    v_and_b32 v24, v52, v13
    v_and_b32 v25, v52, v14
    v_and_b32 v26, v52, v15
    v_and_b32 v27, v52, v16
    s_nop 1
    v_mfma_f32_16x16x32_bf16 v[20:23], a[176:179], v[24:27], v[20:23]
    v_and_b32 v28, v53, v13
    v_and_b32 v29, v53, v14
    v_and_b32 v30, v53, v15
    v_and_b32 v31, v53, v16
    s_nop 1
    v_mfma_f32_16x16x32_bf16 v[32:35], a[180:183], v[28:31], v[32:35]
    s_waitcnt lgkmcnt(5)
    v_and_b32 v24, v54, v13
    v_and_b32 v25, v54, v14
    v_and_b32 v26, v54, v15
    v_and_b32 v27, v54, v16
    s_nop 1
    v_mfma_f32_16x16x32_bf16 v[20:23], a[184:187], v[24:27], v[20:23]
    v_and_b32 v28, v55, v13
    v_and_b32 v29, v55, v14
    v_and_b32 v30, v55, v15
    v_and_b32 v31, v55, v16
    s_nop 1
    v_mfma_f32_16x16x32_bf16 v[32:35], a[188:191], v[28:31], v[32:35]
    s_waitcnt lgkmcnt(4)
    v_and_b32 v24, v56, v13
    v_and_b32 v25, v56, v14
    v_and_b32 v26, v56, v15
    v_and_b32 v27, v56, v16
    s_nop 1
    v_mfma_f32_16x16x32_bf16 v[20:23], a[192:195], v[24:27], v[20:23]
    v_and_b32 v28, v57, v13
    v_and_b32 v29, v57, v14
    v_and_b32 v30, v57, v15
    v_and_b32 v31, v57, v16
    s_nop 1
    v_mfma_f32_16x16x32_bf16 v[32:35], a[196:199], v[28:31], v[32:35]
    s_waitcnt lgkmcnt(3)
    v_and_b32 v24, v58, v13
    v_and_b32 v25, v58, v14
    v_and_b32 v26, v58, v15
    v_and_b32 v27, v58, v16
    s_nop 1
    v_mfma_f32_16x16x32_bf16 v[20:23], a[200:203], v[24:27], v[20:23]
    v_and_b32 v28, v59, v13
    v_and_b32 v29, v59, v14
    v_and_b32 v30, v59, v15
    v_and_b32 v31, v59, v16
    s_nop 1
    v_mfma_f32_16x16x32_bf16 v[32:35], a[204:207], v[28:31], v[32:35]
    s_waitcnt lgkmcnt(2)
    v_and_b32 v24, v60, v13
    v_and_b32 v25, v60, v14
    v_and_b32 v26, v60, v15
    v_and_b32 v27, v60, v16
    s_nop 1
    v_mfma_f32_16x16x32_bf16 v[20:23], a[208:211], v[24:27], v[20:23]
    v_and_b32 v28, v61, v13
    v_and_b32 v29, v61, v14
    v_and_b32 v30, v61, v15
    v_and_b32 v31, v61, v16
    s_nop 1
    v_mfma_f32_16x16x32_bf16 v[32:35], a[212:215], v[28:31], v[32:35]
    s_waitcnt lgkmcnt(1)
    v_and_b32 v24, v62, v13
    v_and_b32 v25, v62, v14
    v_and_b32 v26, v62, v15
    v_and_b32 v27, v62, v16
    s_nop 1
    v_mfma_f32_16x16x32_bf16 v[20:23], a[216:219], v[24:27], v[20:23]
    v_and_b32 v28, v63, v13
    v_and_b32 v29, v63, v14
    v_and_b32 v30, v63, v15
    v_and_b32 v31, v63, v16
    s_nop 1
    v_mfma_f32_16x16x32_bf16 v[32:35], a[220:223], v[28:31], v[32:35]
    s_waitcnt lgkmcnt(0)
    v_and_b32 v24, v64, v13
    v_and_b32 v25, v64, v14
    v_and_b32 v26, v64, v15
    v_and_b32 v27, v64, v16
    s_nop 1
    v_mfma_f32_16x16x32_bf16 v[20:23], a[224:227], v[24:27], v[20:23]
    v_and_b32 v28, v65, v13
    v_and_b32 v29, v65, v14
    v_and_b32 v30, v65, v15
    v_and_b32 v31, v65, v16
    s_nop 1
    v_mfma_f32_16x16x32_bf16 v[32:35], a[228:231], v[28:31], v[32:35]
    s_nop 7
    v_add_f32 v20, v20, v32
    v_add_f32 v21, v21, v33
    v_add_f32 v22, v22, v34
    v_add_f32 v23, v23, v35
    s_mov_b64 exec, s[68:69]
    ds_write_b32 v40, v20 offset:0
    ds_write_b32 v40, v21 offset:32
    ds_write_b32 v40, v22 offset:64
    ds_write_b32 v40, v23 offset:96
    s_mov_b64 exec, -1
    s_waitcnt lgkmcnt(0)
    s_barrier
    s_cmp_eq_u32 s3, 0
    s_cbranch_scc0 QS_11
    v_lshlrev_b32 v38, 2, v0
    v_add_u32 v38, 156160, v38
    ds_read2st64_b32 v[48:49], v38 offset0:0 offset1:1
    ds_read2st64_b32 v[50:51], v38 offset0:2 offset1:3
    ds_read2st64_b32 v[52:53], v38 offset0:4 offset1:5
    ds_read2st64_b32 v[54:55], v38 offset0:6 offset1:7
    s_waitcnt lgkmcnt(0)
    v_add_f32 v48, v48, v49
    v_add_f32 v50, v50, v51
    v_add_f32 v52, v52, v53
    v_add_f32 v54, v54, v55
    v_add_f32 v48, v48, v50
    v_add_f32 v52, v52, v54
    v_add_f32 v36, v48, v52
    v_mul_f32 v36, 0x5f800000, v36
    s_nop 1
    v_mov_b32_dpp v37, v36 quad_perm:[1,0,3,2] row_mask:0xf bank_mask:0xf
    v_cvt_pk_bf16_f32 v36, v36, v37
    v_lshlrev_b32 v38, 1, v0
    s_lshl_b32 s60, s57, 9
    s_lshl_b32 s61, s63, 7
    s_add_u32 s60, s60, s61
    s_add_u32 s60, s60, 3145728
    s_mov_b64 exec, s[74:75]
    buffer_store_dword v36, v38, s[32:35], s60 offen sc1
    s_mov_b64 exec, -1
    s_waitcnt vmcnt(0)
    s_lshl_b32 s60, s57, 2
    v_mov_b32 v38, s60
    v_mov_b32 v36, 1
    s_mov_b64 exec, 1
    buffer_atomic_add v36, v38, s[36:39], 0 offen
    s_mov_b64 exec, -1
    s_nop 7
    s_nop 1
QS_11:
ST_3:
    s_nop 7
    s_nop 1
    s_mov_b32 s78, 0x70007000
    s_mov_b32 s79, 0x7fff7fff
    s_mov_b32 s80, 0x80008000
    s_mov_b32 s98, 0x31803180
    s_mov_b32 s99, 0
    s_mov_b32 s78, 0x78007800
    s_mov_b32 s98, 0x38803880
    s_mov_b32 s94, 0x39003900
    s_mov_b32 s100, 0x00f000f0
    s_mov_b32 s101, 0x07000700
    s_mov_b32 s96, 0
    s_mov_b32 s97, 0
    s_mov_b32 s6, 268435456
    s_mov_b32 s10, 268435456
    s_mov_b32 s50, 8388608
    s_add_u32 s54, s52, 0
    s_add_u32 m0, s59, 32768
    s_nop 0
    buffer_load_dwordx4 v4, s[4:7], s54 offen offset:0 nt lds
    buffer_load_dwordx4 v5, s[4:7], s54 offen offset:1024 nt lds
    buffer_load_dwordx4 v6, s[4:7], s54 offen offset:2048 nt lds
    buffer_load_dwordx4 v7, s[4:7], s54 offen offset:3072 nt lds
    buffer_load_dwordx4 a[232:235], v8, s[8:11], s54 offen offset:0 nt
    buffer_load_dwordx4 a[236:239], v8, s[8:11], s54 offen offset:256 nt
    buffer_load_dwordx4 a[240:243], v8, s[8:11], s54 offen offset:512 nt
    buffer_load_dwordx4 a[244:247], v8, s[8:11], s54 offen offset:768 nt
    s_add_u32 s54, s52, 65536
    s_add_u32 m0, s59, 0
    s_nop 0
    buffer_load_dwordx4 v4, s[4:7], s54 offen offset:0 nt lds
    buffer_load_dwordx4 v5, s[4:7], s54 offen offset:1024 nt lds
    buffer_load_dwordx4 v6, s[4:7], s54 offen offset:2048 nt lds
    buffer_load_dwordx4 v7, s[4:7], s54 offen offset:3072 nt lds
    buffer_load_dwordx4 a[0:3], v8, s[8:11], s54 offen offset:0 nt
    buffer_load_dwordx4 a[4:7], v8, s[8:11], s54 offen offset:256 nt
    buffer_load_dwordx4 a[8:11], v8, s[8:11], s54 offen offset:512 nt
    buffer_load_dwordx4 a[12:15], v8, s[8:11], s54 offen offset:768 nt
    s_add_u32 s54, s52, 131072
    s_add_u32 m0, s59, 4096
    s_nop 0
    buffer_load_dwordx4 v4, s[4:7], s54 offen offset:0 nt lds
    buffer_load_dwordx4 v5, s[4:7], s54 offen offset:1024 nt lds
    buffer_load_dwordx4 v6, s[4:7], s54 offen offset:2048 nt lds
    buffer_load_dwordx4 v7, s[4:7], s54 offen offset:3072 nt lds
    buffer_load_dwordx4 a[16:19], v8, s[8:11], s54 offen offset:0 nt
    buffer_load_dwordx4 a[20:23], v8, s[8:11], s54 offen offset:256 nt
    buffer_load_dwordx4 a[24:27], v8, s[8:11], s54 offen offset:512 nt
    buffer_load_dwordx4 a[28:31], v8, s[8:11], s54 offen offset:768 nt
    s_waitcnt vmcnt(20)
    ds_read_b128 v[48:51], v9 offset:32768
    ds_read_b128 v[52:55], v10 offset:32768
    ds_read_b128 v[56:59], v11 offset:32768
    ds_read_b128 v[60:63], v12 offset:32768
    s_waitcnt vmcnt(16)
    v_accvgpr_read_b32 v64, a232
    v_accvgpr_read_b32 v65, a233
    v_accvgpr_read_b32 v66, a234
    v_accvgpr_read_b32 v67, a235
    v_accvgpr_read_b32 v68, a236
    v_accvgpr_read_b32 v69, a237
    v_accvgpr_read_b32 v70, a238
    v_accvgpr_read_b32 v71, a239
    v_accvgpr_read_b32 v72, a240
    v_accvgpr_read_b32 v73, a241
    v_accvgpr_read_b32 v74, a242
    v_accvgpr_read_b32 v75, a243
    v_accvgpr_read_b32 v76, a244
    v_accvgpr_read_b32 v77, a245
    v_accvgpr_read_b32 v78, a246
    v_accvgpr_read_b32 v79, a247
    s_waitcnt lgkmcnt(0)
    s_add_u32 s54, s52, 196608
    s_add_u32 m0, s59, 32768
    s_nop 0
    buffer_load_dwordx4 v4, s[4:7], s54 offen offset:0 nt lds
    buffer_load_dwordx4 v5, s[4:7], s54 offen offset:1024 nt lds
    buffer_load_dwordx4 v6, s[4:7], s54 offen offset:2048 nt lds
    buffer_load_dwordx4 v7, s[4:7], s54 offen offset:3072 nt lds
    buffer_load_dwordx4 a[232:235], v8, s[8:11], s54 offen offset:0 nt
    buffer_load_dwordx4 a[236:239], v8, s[8:11], s54 offen offset:256 nt
    buffer_load_dwordx4 a[240:243], v8, s[8:11], s54 offen offset:512 nt
    buffer_load_dwordx4 a[244:247], v8, s[8:11], s54 offen offset:768 nt
    v_and_b32 v25, 0x7fff7fff, v64
    v_pk_sub_u16 v25, v25, 1 op_sel_hi:[1,0]
    v_and_b32 v37, 0x7fff7fff, v65
    v_pk_sub_u16 v37, v37, 1 op_sel_hi:[1,0]
    v_pk_min_u16 v25, v25, v37
    v_and_b32 v36, 0x7fff7fff, v66
    v_pk_sub_u16 v36, v36, 1 op_sel_hi:[1,0]
    v_pk_min_u16 v25, v25, v36
    v_and_b32 v37, 0x7fff7fff, v67
    v_pk_sub_u16 v37, v37, 1 op_sel_hi:[1,0]
    v_pk_min_u16 v25, v25, v37
    v_and_b32 v36, 0x7fff7fff, v68
    v_pk_sub_u16 v36, v36, 1 op_sel_hi:[1,0]
    v_pk_min_u16 v25, v25, v36
    v_and_b32 v37, 0x7fff7fff, v69
    v_pk_sub_u16 v37, v37, 1 op_sel_hi:[1,0]
    v_pk_min_u16 v25, v25, v37
    v_and_b32 v36, 0x7fff7fff, v70
    v_pk_sub_u16 v36, v36, 1 op_sel_hi:[1,0]
    v_pk_min_u16 v25, v25, v36
    v_and_b32 v37, 0x7fff7fff, v71
    v_pk_sub_u16 v37, v37, 1 op_sel_hi:[1,0]
    v_pk_min_u16 v25, v25, v37
    v_and_b32 v36, 0x7fff7fff, v72
    v_pk_sub_u16 v36, v36, 1 op_sel_hi:[1,0]
    v_pk_min_u16 v25, v25, v36
    v_and_b32 v37, 0x7fff7fff, v73
    v_pk_sub_u16 v37, v37, 1 op_sel_hi:[1,0]
    v_pk_min_u16 v25, v25, v37
    v_and_b32 v36, 0x7fff7fff, v74
    v_pk_sub_u16 v36, v36, 1 op_sel_hi:[1,0]
    v_pk_min_u16 v25, v25, v36
    v_and_b32 v37, 0x7fff7fff, v75
    v_pk_sub_u16 v37, v37, 1 op_sel_hi:[1,0]
    v_pk_min_u16 v25, v25, v37
    v_and_b32 v36, 0x7fff7fff, v76
    v_pk_sub_u16 v36, v36, 1 op_sel_hi:[1,0]
    v_pk_min_u16 v25, v25, v36
    v_and_b32 v37, 0x7fff7fff, v77
    v_pk_sub_u16 v37, v37, 1 op_sel_hi:[1,0]
    v_pk_min_u16 v25, v25, v37
    v_and_b32 v36, 0x7fff7fff, v78
    v_pk_sub_u16 v36, v36, 1 op_sel_hi:[1,0]
    v_pk_min_u16 v25, v25, v36
    v_and_b32 v37, 0x7fff7fff, v79
    v_pk_sub_u16 v37, v37, 1 op_sel_hi:[1,0]
    v_pk_min_u16 v25, v25, v37
    v_mov_b32 v36, 0x397f397f
    v_pk_sub_u16 v36, v36, v25 clamp
    v_cmp_ne_u32 vcc, 0, v36
    s_or_b32 s62, 32, 0
    s_getpc_b64 s[92:93]
    s_cbranch_vccnz REC_V
    v_and_b32 v26, 0x7fff7fff, v64
    v_pk_sub_u16 v26, v26, s94 clamp
    v_bfi_b32 v64, s79, v26, v64
    v_and_b32 v27, 0x7fff7fff, v65
    v_pk_sub_u16 v27, v27, s94 clamp
    v_bfi_b32 v65, s79, v27, v65
    v_and_b32 v26, 0x7fff7fff, v66
    v_pk_sub_u16 v26, v26, s94 clamp
    v_bfi_b32 v66, s79, v26, v66
    v_and_b32 v27, 0x7fff7fff, v67
    v_pk_sub_u16 v27, v27, s94 clamp
    v_bfi_b32 v67, s79, v27, v67
    v_and_b32 v26, 0x7fff7fff, v68
    v_pk_sub_u16 v26, v26, s94 clamp
    v_bfi_b32 v68, s79, v26, v68
    v_and_b32 v27, 0x7fff7fff, v69
    v_pk_sub_u16 v27, v27, s94 clamp
    v_bfi_b32 v69, s79, v27, v69
    v_and_b32 v26, 0x7fff7fff, v70
    v_pk_sub_u16 v26, v26, s94 clamp
    v_bfi_b32 v70, s79, v26, v70
    v_and_b32 v27, 0x7fff7fff, v71
    v_pk_sub_u16 v27, v27, s94 clamp
    v_bfi_b32 v71, s79, v27, v71
    v_and_b32 v26, 0x7fff7fff, v72
    v_pk_sub_u16 v26, v26, s94 clamp
    v_bfi_b32 v72, s79, v26, v72
    v_and_b32 v27, 0x7fff7fff, v73
    v_pk_sub_u16 v27, v27, s94 clamp
    v_bfi_b32 v73, s79, v27, v73
    v_and_b32 v26, 0x7fff7fff, v74
    v_pk_sub_u16 v26, v26, s94 clamp
    v_bfi_b32 v74, s79, v26, v74
    v_and_b32 v27, 0x7fff7fff, v75
    v_pk_sub_u16 v27, v27, s94 clamp
    v_bfi_b32 v75, s79, v27, v75
    v_and_b32 v26, 0x7fff7fff, v76
    v_pk_sub_u16 v26, v26, s94 clamp
    v_bfi_b32 v76, s79, v26, v76
    v_and_b32 v27, 0x7fff7fff, v77
    v_pk_sub_u16 v27, v27, s94 clamp
    v_bfi_b32 v77, s79, v27, v77
    v_and_b32 v26, 0x7fff7fff, v78
    v_pk_sub_u16 v26, v26, s94 clamp
    v_bfi_b32 v78, s79, v26, v78
    v_and_b32 v27, 0x7fff7fff, v79
    v_pk_sub_u16 v27, v27, s94 clamp
    v_bfi_b32 v79, s79, v27, v79
    v_or_b32 v24, v64, v65
    v_or3_b32 v24, v24, v66, v67
    v_or3_b32 v24, v24, v68, v69
    v_or3_b32 v24, v24, v70, v71
    v_or3_b32 v24, v24, v72, v73
    v_or3_b32 v24, v24, v74, v75
    v_or3_b32 v24, v24, v76, v77
    v_or3_b32 v24, v24, v78, v79
    v_lshlrev_b32 v36, 11, v76
    v_and_or_b32 v80, v36, s78, v64
    v_lshlrev_b32 v37, 11, v77
    v_and_or_b32 v81, v37, s78, v65
    v_lshlrev_b32 v36, 11, v78
    v_and_or_b32 v82, v36, s78, v66
    v_lshlrev_b32 v37, 11, v79
    v_and_or_b32 v83, v37, s78, v67
    v_lshlrev_b32 v36, 7, v76
    v_and_or_b32 v84, v36, s78, v68
    v_lshlrev_b32 v37, 7, v77
    v_and_or_b32 v85, v37, s78, v69
    v_lshlrev_b32 v36, 7, v78
    v_and_or_b32 v86, v36, s78, v70
    v_lshlrev_b32 v37, 7, v79
    v_and_or_b32 v87, v37, s78, v71
    v_lshlrev_b32 v36, 3, v76
    v_and_or_b32 v72, v36, s78, v72
    v_lshrrev_b32 v37, 1, v76
    v_and_or_b32 v88, v37, s78, v72
    v_lshlrev_b32 v36, 3, v77
    v_and_or_b32 v73, v36, s78, v73
    v_lshrrev_b32 v37, 1, v77
    v_and_or_b32 v89, v37, s78, v73
    v_lshlrev_b32 v36, 3, v78
    v_and_or_b32 v74, v36, s78, v74
    v_lshrrev_b32 v37, 1, v78
    v_and_or_b32 v90, v37, s78, v74
    v_lshlrev_b32 v36, 3, v79
    v_and_or_b32 v75, v36, s78, v75
    v_lshrrev_b32 v37, 1, v79
    v_and_or_b32 v91, v37, s78, v75
    v_and_b32 v25, 0x7fff7fff, v48
    v_pk_sub_u16 v25, v25, 1 op_sel_hi:[1,0]
    v_and_b32 v37, 0x7fff7fff, v49
    v_pk_sub_u16 v37, v37, 1 op_sel_hi:[1,0]
    v_pk_min_u16 v25, v25, v37
    v_and_b32 v36, 0x7fff7fff, v50
    v_pk_sub_u16 v36, v36, 1 op_sel_hi:[1,0]
    v_pk_min_u16 v25, v25, v36
    v_and_b32 v37, 0x7fff7fff, v51
    v_pk_sub_u16 v37, v37, 1 op_sel_hi:[1,0]
    v_pk_min_u16 v25, v25, v37
    v_and_b32 v36, 0x7fff7fff, v52
    v_pk_sub_u16 v36, v36, 1 op_sel_hi:[1,0]
    v_pk_min_u16 v25, v25, v36
    v_and_b32 v37, 0x7fff7fff, v53
    v_pk_sub_u16 v37, v37, 1 op_sel_hi:[1,0]
    v_pk_min_u16 v25, v25, v37
    v_and_b32 v36, 0x7fff7fff, v54
    v_pk_sub_u16 v36, v36, 1 op_sel_hi:[1,0]
    v_pk_min_u16 v25, v25, v36
    v_and_b32 v37, 0x7fff7fff, v55
    v_pk_sub_u16 v37, v37, 1 op_sel_hi:[1,0]
    v_pk_min_u16 v25, v25, v37
    v_and_b32 v36, 0x7fff7fff, v56
    v_pk_sub_u16 v36, v36, 1 op_sel_hi:[1,0]
    v_pk_min_u16 v25, v25, v36
    v_and_b32 v37, 0x7fff7fff, v57
    v_pk_sub_u16 v37, v37, 1 op_sel_hi:[1,0]
    v_pk_min_u16 v25, v25, v37
    v_and_b32 v36, 0x7fff7fff, v58
    v_pk_sub_u16 v36, v36, 1 op_sel_hi:[1,0]
    v_pk_min_u16 v25, v25, v36
    v_and_b32 v37, 0x7fff7fff, v59
    v_pk_sub_u16 v37, v37, 1 op_sel_hi:[1,0]
    v_pk_min_u16 v25, v25, v37
    v_and_b32 v36, 0x7fff7fff, v60
    v_pk_sub_u16 v36, v36, 1 op_sel_hi:[1,0]
    v_pk_min_u16 v25, v25, v36
    v_and_b32 v37, 0x7fff7fff, v61
    v_pk_sub_u16 v37, v37, 1 op_sel_hi:[1,0]
    v_pk_min_u16 v25, v25, v37
    v_and_b32 v36, 0x7fff7fff, v62
    v_pk_sub_u16 v36, v36, 1 op_sel_hi:[1,0]
    v_pk_min_u16 v25, v25, v36
    v_and_b32 v37, 0x7fff7fff, v63
    v_pk_sub_u16 v37, v37, 1 op_sel_hi:[1,0]
    v_pk_min_u16 v25, v25, v37
    v_mov_b32 v36, 0x38ff38ff
    v_pk_sub_u16 v36, v36, v25 clamp
    v_cmp_ne_u32 vcc, 0, v36
    s_or_b32 s62, 0, 0
    s_getpc_b64 s[92:93]
    s_cbranch_vccnz REC_K
    v_and_b32 v26, 0x7fff7fff, v48
    v_pk_sub_u16 v26, v26, s98 clamp
    v_bfi_b32 v48, s79, v26, v48
    v_and_b32 v27, 0x7fff7fff, v49
    v_pk_sub_u16 v27, v27, s98 clamp
    v_bfi_b32 v49, s79, v27, v49
    v_and_b32 v26, 0x7fff7fff, v50
    v_pk_sub_u16 v26, v26, s98 clamp
    v_bfi_b32 v50, s79, v26, v50
    v_and_b32 v27, 0x7fff7fff, v51
    v_pk_sub_u16 v27, v27, s98 clamp
    v_bfi_b32 v51, s79, v27, v51
    v_and_b32 v26, 0x7fff7fff, v52
    v_pk_sub_u16 v26, v26, s98 clamp
    v_bfi_b32 v52, s79, v26, v52
    v_and_b32 v27, 0x7fff7fff, v53
    v_pk_sub_u16 v27, v27, s98 clamp
    v_bfi_b32 v53, s79, v27, v53
    v_and_b32 v26, 0x7fff7fff, v54
    v_pk_sub_u16 v26, v26, s98 clamp
    v_bfi_b32 v54, s79, v26, v54
    v_and_b32 v27, 0x7fff7fff, v55
    v_pk_sub_u16 v27, v27, s98 clamp
    v_bfi_b32 v55, s79, v27, v55
    v_and_b32 v26, 0x7fff7fff, v56
    v_pk_sub_u16 v26, v26, s98 clamp
    v_bfi_b32 v56, s79, v26, v56
    v_and_b32 v27, 0x7fff7fff, v57
    v_pk_sub_u16 v27, v27, s98 clamp
    v_bfi_b32 v57, s79, v27, v57
    v_and_b32 v26, 0x7fff7fff, v58
    v_pk_sub_u16 v26, v26, s98 clamp
    v_bfi_b32 v58, s79, v26, v58
    v_and_b32 v27, 0x7fff7fff, v59
    v_pk_sub_u16 v27, v27, s98 clamp
    v_bfi_b32 v59, s79, v27, v59
    v_and_b32 v26, 0x7fff7fff, v60
    v_pk_sub_u16 v26, v26, s98 clamp
    v_bfi_b32 v60, s79, v26, v60
    v_and_b32 v27, 0x7fff7fff, v61
    v_pk_sub_u16 v27, v27, s98 clamp
    v_bfi_b32 v61, s79, v27, v61
    v_and_b32 v26, 0x7fff7fff, v62
    v_pk_sub_u16 v26, v26, s98 clamp
    v_bfi_b32 v62, s79, v26, v62
    v_and_b32 v27, 0x7fff7fff, v63
    v_pk_sub_u16 v27, v27, s98 clamp
    v_bfi_b32 v63, s79, v27, v63
    v_or3_b32 v24, v24, v48, v49
    v_or3_b32 v24, v24, v50, v51
    v_or3_b32 v24, v24, v52, v53
    v_or3_b32 v24, v24, v54, v55
    v_or3_b32 v24, v24, v56, v57
    v_or3_b32 v24, v24, v58, v59
    v_or3_b32 v24, v24, v60, v61
    v_or3_b32 v24, v24, v62, v63
    v_lshlrev_b32 v36, 11, v60
    v_and_or_b32 v48, v36, s78, v48
    v_accvgpr_write_b32 a48, v48
    v_lshlrev_b32 v37, 11, v61
    v_and_or_b32 v49, v37, s78, v49
    v_accvgpr_write_b32 a49, v49
    v_lshlrev_b32 v36, 11, v62
    v_and_or_b32 v50, v36, s78, v50
    v_accvgpr_write_b32 a50, v50
    v_lshlrev_b32 v37, 11, v63
    v_and_or_b32 v51, v37, s78, v51
    v_accvgpr_write_b32 a51, v51
    v_lshlrev_b32 v36, 7, v60
    v_and_or_b32 v52, v36, s78, v52
    v_accvgpr_write_b32 a52, v52
    v_lshlrev_b32 v37, 7, v61
    v_and_or_b32 v53, v37, s78, v53
    v_accvgpr_write_b32 a53, v53
    v_lshlrev_b32 v36, 7, v62
    v_and_or_b32 v54, v36, s78, v54
    v_accvgpr_write_b32 a54, v54
    v_lshlrev_b32 v37, 7, v63
    v_and_or_b32 v55, v37, s78, v55
    v_accvgpr_write_b32 a55, v55
    v_lshlrev_b32 v36, 3, v60
    v_and_or_b32 v56, v36, s78, v56
    v_lshrrev_b32 v37, 1, v60
    v_and_or_b32 v56, v37, s78, v56
    v_accvgpr_write_b32 a56, v56
    v_lshlrev_b32 v36, 3, v61
    v_and_or_b32 v57, v36, s78, v57
    v_lshrrev_b32 v37, 1, v61
    v_and_or_b32 v57, v37, s78, v57
    v_accvgpr_write_b32 a57, v57
    v_lshlrev_b32 v36, 3, v62
    v_and_or_b32 v58, v36, s78, v58
    v_lshrrev_b32 v37, 1, v62
    v_and_or_b32 v58, v37, s78, v58
    v_accvgpr_write_b32 a58, v58
    v_lshlrev_b32 v36, 3, v63
    v_and_or_b32 v59, v36, s78, v59
    v_lshrrev_b32 v37, 1, v63
    v_and_or_b32 v59, v37, s78, v59
    v_accvgpr_write_b32 a59, v59
    v_and_b32 v24, s78, v24
    v_cmp_ne_u32 vcc, 0, v24
    s_cmp_lg_u64 vcc, 0
    s_cselect_b32 s60, 1, 0
    s_or_b32 s99, s99, s60
    s_waitcnt vmcnt(20)
    ds_read_b128 v[48:51], v9 offset:0
    ds_read_b128 v[52:55], v10 offset:0
    ds_read_b128 v[56:59], v11 offset:0
    ds_read_b128 v[60:63], v12 offset:0
    s_waitcnt vmcnt(16)
    v_accvgpr_read_b32 v64, a0
    v_accvgpr_read_b32 v65, a1
    v_accvgpr_read_b32 v66, a2
    v_accvgpr_read_b32 v67, a3
    v_accvgpr_read_b32 v68, a4
    v_accvgpr_read_b32 v69, a5
    v_accvgpr_read_b32 v70, a6
    v_accvgpr_read_b32 v71, a7
    v_accvgpr_read_b32 v72, a8
    v_accvgpr_read_b32 v73, a9
    v_accvgpr_read_b32 v74, a10
    v_accvgpr_read_b32 v75, a11
    v_accvgpr_read_b32 v76, a12
    v_accvgpr_read_b32 v77, a13
    v_accvgpr_read_b32 v78, a14
    v_accvgpr_read_b32 v79, a15
    s_waitcnt lgkmcnt(0)
    s_add_u32 s54, s52, 262144
    s_add_u32 m0, s59, 0
    s_nop 0
    buffer_load_dwordx4 v4, s[4:7], s54 offen offset:0 nt lds
    buffer_load_dwordx4 v5, s[4:7], s54 offen offset:1024 nt lds
    buffer_load_dwordx4 v6, s[4:7], s54 offen offset:2048 nt lds
    buffer_load_dwordx4 v7, s[4:7], s54 offen offset:3072 nt lds
    buffer_load_dwordx4 a[0:3], v8, s[8:11], s54 offen offset:0 nt
    buffer_load_dwordx4 a[4:7], v8, s[8:11], s54 offen offset:256 nt
    buffer_load_dwordx4 a[8:11], v8, s[8:11], s54 offen offset:512 nt
    buffer_load_dwordx4 a[12:15], v8, s[8:11], s54 offen offset:768 nt
    v_and_b32 v25, 0x7fff7fff, v64
    v_pk_sub_u16 v25, v25, 1 op_sel_hi:[1,0]
    v_and_b32 v37, 0x7fff7fff, v65
    v_pk_sub_u16 v37, v37, 1 op_sel_hi:[1,0]
    v_pk_min_u16 v25, v25, v37
    v_and_b32 v36, 0x7fff7fff, v66
    v_pk_sub_u16 v36, v36, 1 op_sel_hi:[1,0]
    v_pk_min_u16 v25, v25, v36
    v_and_b32 v37, 0x7fff7fff, v67
    v_pk_sub_u16 v37, v37, 1 op_sel_hi:[1,0]
    v_pk_min_u16 v25, v25, v37
    v_and_b32 v36, 0x7fff7fff, v68
    v_pk_sub_u16 v36, v36, 1 op_sel_hi:[1,0]
    v_pk_min_u16 v25, v25, v36
    v_and_b32 v37, 0x7fff7fff, v69
    v_pk_sub_u16 v37, v37, 1 op_sel_hi:[1,0]
    v_pk_min_u16 v25, v25, v37
    v_and_b32 v36, 0x7fff7fff, v70
    v_pk_sub_u16 v36, v36, 1 op_sel_hi:[1,0]
    v_pk_min_u16 v25, v25, v36
    v_and_b32 v37, 0x7fff7fff, v71
    v_pk_sub_u16 v37, v37, 1 op_sel_hi:[1,0]
    v_pk_min_u16 v25, v25, v37
    v_and_b32 v36, 0x7fff7fff, v72
    v_pk_sub_u16 v36, v36, 1 op_sel_hi:[1,0]
    v_pk_min_u16 v25, v25, v36
    v_and_b32 v37, 0x7fff7fff, v73
    v_pk_sub_u16 v37, v37, 1 op_sel_hi:[1,0]
    v_pk_min_u16 v25, v25, v37
    v_and_b32 v36, 0x7fff7fff, v74
    v_pk_sub_u16 v36, v36, 1 op_sel_hi:[1,0]
    v_pk_min_u16 v25, v25, v36
    v_and_b32 v37, 0x7fff7fff, v75
    v_pk_sub_u16 v37, v37, 1 op_sel_hi:[1,0]
    v_pk_min_u16 v25, v25, v37
    v_and_b32 v36, 0x7fff7fff, v76
    v_pk_sub_u16 v36, v36, 1 op_sel_hi:[1,0]
    v_pk_min_u16 v25, v25, v36
    v_and_b32 v37, 0x7fff7fff, v77
    v_pk_sub_u16 v37, v37, 1 op_sel_hi:[1,0]
    v_pk_min_u16 v25, v25, v37
    v_and_b32 v36, 0x7fff7fff, v78
    v_pk_sub_u16 v36, v36, 1 op_sel_hi:[1,0]
    v_pk_min_u16 v25, v25, v36
    v_and_b32 v37, 0x7fff7fff, v79
    v_pk_sub_u16 v37, v37, 1 op_sel_hi:[1,0]
    v_pk_min_u16 v25, v25, v37
    v_mov_b32 v36, 0x397f397f
    v_pk_sub_u16 v36, v36, v25 clamp
    v_cmp_ne_u32 vcc, 0, v36
    s_or_b32 s62, 33, 0
    s_getpc_b64 s[92:93]
    s_cbranch_vccnz REC_V
    v_and_b32 v26, 0x7fff7fff, v64
    v_pk_sub_u16 v26, v26, s94 clamp
    v_bfi_b32 v64, s79, v26, v64
    v_and_b32 v27, 0x7fff7fff, v65
    v_pk_sub_u16 v27, v27, s94 clamp
    v_bfi_b32 v65, s79, v27, v65
    v_and_b32 v26, 0x7fff7fff, v66
    v_pk_sub_u16 v26, v26, s94 clamp
    v_bfi_b32 v66, s79, v26, v66
    v_and_b32 v27, 0x7fff7fff, v67
    v_pk_sub_u16 v27, v27, s94 clamp
    v_bfi_b32 v67, s79, v27, v67
    v_and_b32 v26, 0x7fff7fff, v68
    v_pk_sub_u16 v26, v26, s94 clamp
    v_bfi_b32 v68, s79, v26, v68
    v_and_b32 v27, 0x7fff7fff, v69
    v_pk_sub_u16 v27, v27, s94 clamp
    v_bfi_b32 v69, s79, v27, v69
    v_and_b32 v26, 0x7fff7fff, v70
    v_pk_sub_u16 v26, v26, s94 clamp
    v_bfi_b32 v70, s79, v26, v70
    v_and_b32 v27, 0x7fff7fff, v71
    v_pk_sub_u16 v27, v27, s94 clamp
    v_bfi_b32 v71, s79, v27, v71
    v_and_b32 v26, 0x7fff7fff, v72
    v_pk_sub_u16 v26, v26, s94 clamp
    v_bfi_b32 v72, s79, v26, v72
    v_and_b32 v27, 0x7fff7fff, v73
    v_pk_sub_u16 v27, v27, s94 clamp
    v_bfi_b32 v73, s79, v27, v73
    v_and_b32 v26, 0x7fff7fff, v74
    v_pk_sub_u16 v26, v26, s94 clamp
    v_bfi_b32 v74, s79, v26, v74
    v_and_b32 v27, 0x7fff7fff, v75
    v_pk_sub_u16 v27, v27, s94 clamp
    v_bfi_b32 v75, s79, v27, v75
    v_and_b32 v26, 0x7fff7fff, v76
    v_pk_sub_u16 v26, v26, s94 clamp
    v_bfi_b32 v76, s79, v26, v76
    v_and_b32 v27, 0x7fff7fff, v77
    v_pk_sub_u16 v27, v27, s94 clamp
    v_bfi_b32 v77, s79, v27, v77
    v_and_b32 v26, 0x7fff7fff, v78
    v_pk_sub_u16 v26, v26, s94 clamp
    v_bfi_b32 v78, s79, v26, v78
    v_and_b32 v27, 0x7fff7fff, v79
    v_pk_sub_u16 v27, v27, s94 clamp
    v_bfi_b32 v79, s79, v27, v79
    v_or_b32 v24, v64, v65
    v_or3_b32 v24, v24, v66, v67
    v_or3_b32 v24, v24, v68, v69
    v_or3_b32 v24, v24, v70, v71
    v_or3_b32 v24, v24, v72, v73
    v_or3_b32 v24, v24, v74, v75
    v_or3_b32 v24, v24, v76, v77
    v_or3_b32 v24, v24, v78, v79
    v_lshlrev_b32 v36, 11, v76
    v_and_or_b32 v92, v36, s78, v64
    v_lshlrev_b32 v37, 11, v77
    v_and_or_b32 v93, v37, s78, v65
    v_lshlrev_b32 v36, 11, v78
    v_and_or_b32 v94, v36, s78, v66
    v_lshlrev_b32 v37, 11, v79
    v_and_or_b32 v95, v37, s78, v67
    v_lshlrev_b32 v36, 7, v76
    v_and_or_b32 v96, v36, s78, v68
    v_lshlrev_b32 v37, 7, v77
    v_and_or_b32 v97, v37, s78, v69
    v_lshlrev_b32 v36, 7, v78
    v_and_or_b32 v98, v36, s78, v70
    v_lshlrev_b32 v37, 7, v79
    v_and_or_b32 v99, v37, s78, v71
    v_lshlrev_b32 v36, 3, v76
    v_and_or_b32 v72, v36, s78, v72
    v_lshrrev_b32 v37, 1, v76
    v_and_or_b32 v100, v37, s78, v72
    v_lshlrev_b32 v36, 3, v77
    v_and_or_b32 v73, v36, s78, v73
    v_lshrrev_b32 v37, 1, v77
    v_and_or_b32 v101, v37, s78, v73
    v_lshlrev_b32 v36, 3, v78
    v_and_or_b32 v74, v36, s78, v74
    v_lshrrev_b32 v37, 1, v78
    v_and_or_b32 v102, v37, s78, v74
    v_lshlrev_b32 v36, 3, v79
    v_and_or_b32 v75, v36, s78, v75
    v_lshrrev_b32 v37, 1, v79
    v_and_or_b32 v103, v37, s78, v75
    v_and_b32 v25, 0x7fff7fff, v48
    v_pk_sub_u16 v25, v25, 1 op_sel_hi:[1,0]
    v_and_b32 v37, 0x7fff7fff, v49
    v_pk_sub_u16 v37, v37, 1 op_sel_hi:[1,0]
    v_pk_min_u16 v25, v25, v37
    v_and_b32 v36, 0x7fff7fff, v50
    v_pk_sub_u16 v36, v36, 1 op_sel_hi:[1,0]
    v_pk_min_u16 v25, v25, v36
    v_and_b32 v37, 0x7fff7fff, v51
    v_pk_sub_u16 v37, v37, 1 op_sel_hi:[1,0]
    v_pk_min_u16 v25, v25, v37
    v_and_b32 v36, 0x7fff7fff, v52
    v_pk_sub_u16 v36, v36, 1 op_sel_hi:[1,0]
    v_pk_min_u16 v25, v25, v36
    v_and_b32 v37, 0x7fff7fff, v53
    v_pk_sub_u16 v37, v37, 1 op_sel_hi:[1,0]
    v_pk_min_u16 v25, v25, v37
    v_and_b32 v36, 0x7fff7fff, v54
    v_pk_sub_u16 v36, v36, 1 op_sel_hi:[1,0]
    v_pk_min_u16 v25, v25, v36
    v_and_b32 v37, 0x7fff7fff, v55
    v_pk_sub_u16 v37, v37, 1 op_sel_hi:[1,0]
    v_pk_min_u16 v25, v25, v37
    v_and_b32 v36, 0x7fff7fff, v56
    v_pk_sub_u16 v36, v36, 1 op_sel_hi:[1,0]
    v_pk_min_u16 v25, v25, v36
    v_and_b32 v37, 0x7fff7fff, v57
    v_pk_sub_u16 v37, v37, 1 op_sel_hi:[1,0]
    v_pk_min_u16 v25, v25, v37
    v_and_b32 v36, 0x7fff7fff, v58
    v_pk_sub_u16 v36, v36, 1 op_sel_hi:[1,0]
    v_pk_min_u16 v25, v25, v36
    v_and_b32 v37, 0x7fff7fff, v59
    v_pk_sub_u16 v37, v37, 1 op_sel_hi:[1,0]
    v_pk_min_u16 v25, v25, v37
    v_and_b32 v36, 0x7fff7fff, v60
    v_pk_sub_u16 v36, v36, 1 op_sel_hi:[1,0]
    v_pk_min_u16 v25, v25, v36
    v_and_b32 v37, 0x7fff7fff, v61
    v_pk_sub_u16 v37, v37, 1 op_sel_hi:[1,0]
    v_pk_min_u16 v25, v25, v37
    v_and_b32 v36, 0x7fff7fff, v62
    v_pk_sub_u16 v36, v36, 1 op_sel_hi:[1,0]
    v_pk_min_u16 v25, v25, v36
    v_and_b32 v37, 0x7fff7fff, v63
    v_pk_sub_u16 v37, v37, 1 op_sel_hi:[1,0]
    v_pk_min_u16 v25, v25, v37
    v_mov_b32 v36, 0x38ff38ff
    v_pk_sub_u16 v36, v36, v25 clamp
    v_cmp_ne_u32 vcc, 0, v36
    s_or_b32 s62, 1, 0
    s_getpc_b64 s[92:93]
    s_cbranch_vccnz REC_K
    v_and_b32 v26, 0x7fff7fff, v48
    v_pk_sub_u16 v26, v26, s98 clamp
    v_bfi_b32 v48, s79, v26, v48
    v_and_b32 v27, 0x7fff7fff, v49
    v_pk_sub_u16 v27, v27, s98 clamp
    v_bfi_b32 v49, s79, v27, v49
    v_and_b32 v26, 0x7fff7fff, v50
    v_pk_sub_u16 v26, v26, s98 clamp
    v_bfi_b32 v50, s79, v26, v50
    v_and_b32 v27, 0x7fff7fff, v51
    v_pk_sub_u16 v27, v27, s98 clamp
    v_bfi_b32 v51, s79, v27, v51
    v_and_b32 v26, 0x7fff7fff, v52
    v_pk_sub_u16 v26, v26, s98 clamp
    v_bfi_b32 v52, s79, v26, v52
    v_and_b32 v27, 0x7fff7fff, v53
    v_pk_sub_u16 v27, v27, s98 clamp
    v_bfi_b32 v53, s79, v27, v53
    v_and_b32 v26, 0x7fff7fff, v54
    v_pk_sub_u16 v26, v26, s98 clamp
    v_bfi_b32 v54, s79, v26, v54
    v_and_b32 v27, 0x7fff7fff, v55
    v_pk_sub_u16 v27, v27, s98 clamp
    v_bfi_b32 v55, s79, v27, v55
    v_and_b32 v26, 0x7fff7fff, v56
    v_pk_sub_u16 v26, v26, s98 clamp
    v_bfi_b32 v56, s79, v26, v56
    v_and_b32 v27, 0x7fff7fff, v57
    v_pk_sub_u16 v27, v27, s98 clamp
    v_bfi_b32 v57, s79, v27, v57
    v_and_b32 v26, 0x7fff7fff, v58
    v_pk_sub_u16 v26, v26, s98 clamp
    v_bfi_b32 v58, s79, v26, v58
    v_and_b32 v27, 0x7fff7fff, v59
    v_pk_sub_u16 v27, v27, s98 clamp
    v_bfi_b32 v59, s79, v27, v59
    v_and_b32 v26, 0x7fff7fff, v60
    v_pk_sub_u16 v26, v26, s98 clamp
    v_bfi_b32 v60, s79, v26, v60
    v_and_b32 v27, 0x7fff7fff, v61
    v_pk_sub_u16 v27, v27, s98 clamp
    v_bfi_b32 v61, s79, v27, v61
    v_and_b32 v26, 0x7fff7fff, v62
    v_pk_sub_u16 v26, v26, s98 clamp
    v_bfi_b32 v62, s79, v26, v62
    v_and_b32 v27, 0x7fff7fff, v63
    v_pk_sub_u16 v27, v27, s98 clamp
    v_bfi_b32 v63, s79, v27, v63
    v_or3_b32 v24, v24, v48, v49
    v_or3_b32 v24, v24, v50, v51
    v_or3_b32 v24, v24, v52, v53
    v_or3_b32 v24, v24, v54, v55
    v_or3_b32 v24, v24, v56, v57
    v_or3_b32 v24, v24, v58, v59
    v_or3_b32 v24, v24, v60, v61
    v_or3_b32 v24, v24, v62, v63
    v_lshlrev_b32 v36, 11, v60
    v_and_or_b32 v48, v36, s78, v48
    v_accvgpr_write_b32 a60, v48
    v_lshlrev_b32 v37, 11, v61
    v_and_or_b32 v49, v37, s78, v49
    v_accvgpr_write_b32 a61, v49
    v_lshlrev_b32 v36, 11, v62
    v_and_or_b32 v50, v36, s78, v50
    v_accvgpr_write_b32 a62, v50
    v_lshlrev_b32 v37, 11, v63
    v_and_or_b32 v51, v37, s78, v51
    v_accvgpr_write_b32 a63, v51
    v_lshlrev_b32 v36, 7, v60
    v_and_or_b32 v52, v36, s78, v52
    v_accvgpr_write_b32 a64, v52
    v_lshlrev_b32 v37, 7, v61
    v_and_or_b32 v53, v37, s78, v53
    v_accvgpr_write_b32 a65, v53
    v_lshlrev_b32 v36, 7, v62
    v_and_or_b32 v54, v36, s78, v54
    v_accvgpr_write_b32 a66, v54
    v_lshlrev_b32 v37, 7, v63
    v_and_or_b32 v55, v37, s78, v55
    v_accvgpr_write_b32 a67, v55
    v_lshlrev_b32 v36, 3, v60
    v_and_or_b32 v56, v36, s78, v56
    v_lshrrev_b32 v37, 1, v60
    v_and_or_b32 v56, v37, s78, v56
    v_accvgpr_write_b32 a68, v56
    v_lshlrev_b32 v36, 3, v61
    v_and_or_b32 v57, v36, s78, v57
    v_lshrrev_b32 v37, 1, v61
    v_and_or_b32 v57, v37, s78, v57
    v_accvgpr_write_b32 a69, v57
    v_lshlrev_b32 v36, 3, v62
    v_and_or_b32 v58, v36, s78, v58
    v_lshrrev_b32 v37, 1, v62
    v_and_or_b32 v58, v37, s78, v58
    v_accvgpr_write_b32 a70, v58
    v_lshlrev_b32 v36, 3, v63
    v_and_or_b32 v59, v36, s78, v59
    v_lshrrev_b32 v37, 1, v63
    v_and_or_b32 v59, v37, s78, v59
    v_accvgpr_write_b32 a71, v59
    v_and_b32 v24, s78, v24
    v_cmp_ne_u32 vcc, 0, v24
    s_cmp_lg_u64 vcc, 0
    s_cselect_b32 s60, 2, 0
    s_or_b32 s99, s99, s60
    s_waitcnt vmcnt(20)
    ds_read_b128 v[48:51], v9 offset:4096
    ds_read_b128 v[52:55], v10 offset:4096
    ds_read_b128 v[56:59], v11 offset:4096
    ds_read_b128 v[60:63], v12 offset:4096
    s_waitcnt vmcnt(16)
    v_accvgpr_read_b32 v64, a16
    v_accvgpr_read_b32 v65, a17
    v_accvgpr_read_b32 v66, a18
    v_accvgpr_read_b32 v67, a19
    v_accvgpr_read_b32 v68, a20
    v_accvgpr_read_b32 v69, a21
    v_accvgpr_read_b32 v70, a22
    v_accvgpr_read_b32 v71, a23
    v_accvgpr_read_b32 v72, a24
    v_accvgpr_read_b32 v73, a25
    v_accvgpr_read_b32 v74, a26
    v_accvgpr_read_b32 v75, a27
    v_accvgpr_read_b32 v76, a28
    v_accvgpr_read_b32 v77, a29
    v_accvgpr_read_b32 v78, a30
    v_accvgpr_read_b32 v79, a31
    s_waitcnt lgkmcnt(0)
    s_add_u32 s54, s52, 327680
    s_add_u32 m0, s59, 4096
    s_nop 0
    buffer_load_dwordx4 v4, s[4:7], s54 offen offset:0 nt lds
    buffer_load_dwordx4 v5, s[4:7], s54 offen offset:1024 nt lds
    buffer_load_dwordx4 v6, s[4:7], s54 offen offset:2048 nt lds
    buffer_load_dwordx4 v7, s[4:7], s54 offen offset:3072 nt lds
    buffer_load_dwordx4 a[16:19], v8, s[8:11], s54 offen offset:0 nt
    buffer_load_dwordx4 a[20:23], v8, s[8:11], s54 offen offset:256 nt
    buffer_load_dwordx4 a[24:27], v8, s[8:11], s54 offen offset:512 nt
    buffer_load_dwordx4 a[28:31], v8, s[8:11], s54 offen offset:768 nt
    v_and_b32 v25, 0x7fff7fff, v64
    v_pk_sub_u16 v25, v25, 1 op_sel_hi:[1,0]
    v_and_b32 v37, 0x7fff7fff, v65
    v_pk_sub_u16 v37, v37, 1 op_sel_hi:[1,0]
    v_pk_min_u16 v25, v25, v37
    v_and_b32 v36, 0x7fff7fff, v66
    v_pk_sub_u16 v36, v36, 1 op_sel_hi:[1,0]
    v_pk_min_u16 v25, v25, v36
    v_and_b32 v37, 0x7fff7fff, v67
    v_pk_sub_u16 v37, v37, 1 op_sel_hi:[1,0]
    v_pk_min_u16 v25, v25, v37
    v_and_b32 v36, 0x7fff7fff, v68
    v_pk_sub_u16 v36, v36, 1 op_sel_hi:[1,0]
    v_pk_min_u16 v25, v25, v36
    v_and_b32 v37, 0x7fff7fff, v69
    v_pk_sub_u16 v37, v37, 1 op_sel_hi:[1,0]
    v_pk_min_u16 v25, v25, v37
    v_and_b32 v36, 0x7fff7fff, v70
    v_pk_sub_u16 v36, v36, 1 op_sel_hi:[1,0]
    v_pk_min_u16 v25, v25, v36
    v_and_b32 v37, 0x7fff7fff, v71
    v_pk_sub_u16 v37, v37, 1 op_sel_hi:[1,0]
    v_pk_min_u16 v25, v25, v37
    v_and_b32 v36, 0x7fff7fff, v72
    v_pk_sub_u16 v36, v36, 1 op_sel_hi:[1,0]
    v_pk_min_u16 v25, v25, v36
    v_and_b32 v37, 0x7fff7fff, v73
    v_pk_sub_u16 v37, v37, 1 op_sel_hi:[1,0]
    v_pk_min_u16 v25, v25, v37
    v_and_b32 v36, 0x7fff7fff, v74
    v_pk_sub_u16 v36, v36, 1 op_sel_hi:[1,0]
    v_pk_min_u16 v25, v25, v36
    v_and_b32 v37, 0x7fff7fff, v75
    v_pk_sub_u16 v37, v37, 1 op_sel_hi:[1,0]
    v_pk_min_u16 v25, v25, v37
    v_and_b32 v36, 0x7fff7fff, v76
    v_pk_sub_u16 v36, v36, 1 op_sel_hi:[1,0]
    v_pk_min_u16 v25, v25, v36
    v_and_b32 v37, 0x7fff7fff, v77
    v_pk_sub_u16 v37, v37, 1 op_sel_hi:[1,0]
    v_pk_min_u16 v25, v25, v37
    v_and_b32 v36, 0x7fff7fff, v78
    v_pk_sub_u16 v36, v36, 1 op_sel_hi:[1,0]
    v_pk_min_u16 v25, v25, v36
    v_and_b32 v37, 0x7fff7fff, v79
    v_pk_sub_u16 v37, v37, 1 op_sel_hi:[1,0]
    v_pk_min_u16 v25, v25, v37
    v_mov_b32 v36, 0x397f397f
    v_pk_sub_u16 v36, v36, v25 clamp
    v_cmp_ne_u32 vcc, 0, v36
    s_or_b32 s62, 34, 0
    s_getpc_b64 s[92:93]
    s_cbranch_vccnz REC_V
    v_and_b32 v26, 0x7fff7fff, v64
    v_pk_sub_u16 v26, v26, s94 clamp
    v_bfi_b32 v64, s79, v26, v64
    v_and_b32 v27, 0x7fff7fff, v65
    v_pk_sub_u16 v27, v27, s94 clamp
    v_bfi_b32 v65, s79, v27, v65
    v_and_b32 v26, 0x7fff7fff, v66
    v_pk_sub_u16 v26, v26, s94 clamp
    v_bfi_b32 v66, s79, v26, v66
    v_and_b32 v27, 0x7fff7fff, v67
    v_pk_sub_u16 v27, v27, s94 clamp
    v_bfi_b32 v67, s79, v27, v67
    v_and_b32 v26, 0x7fff7fff, v68
    v_pk_sub_u16 v26, v26, s94 clamp
    v_bfi_b32 v68, s79, v26, v68
    v_and_b32 v27, 0x7fff7fff, v69
    v_pk_sub_u16 v27, v27, s94 clamp
    v_bfi_b32 v69, s79, v27, v69
    v_and_b32 v26, 0x7fff7fff, v70
    v_pk_sub_u16 v26, v26, s94 clamp
    v_bfi_b32 v70, s79, v26, v70
    v_and_b32 v27, 0x7fff7fff, v71
    v_pk_sub_u16 v27, v27, s94 clamp
    v_bfi_b32 v71, s79, v27, v71
    v_and_b32 v26, 0x7fff7fff, v72
    v_pk_sub_u16 v26, v26, s94 clamp
    v_bfi_b32 v72, s79, v26, v72
    v_and_b32 v27, 0x7fff7fff, v73
    v_pk_sub_u16 v27, v27, s94 clamp
    v_bfi_b32 v73, s79, v27, v73
    v_and_b32 v26, 0x7fff7fff, v74
    v_pk_sub_u16 v26, v26, s94 clamp
    v_bfi_b32 v74, s79, v26, v74
    v_and_b32 v27, 0x7fff7fff, v75
    v_pk_sub_u16 v27, v27, s94 clamp
    v_bfi_b32 v75, s79, v27, v75
    v_and_b32 v26, 0x7fff7fff, v76
    v_pk_sub_u16 v26, v26, s94 clamp
    v_bfi_b32 v76, s79, v26, v76
    v_and_b32 v27, 0x7fff7fff, v77
    v_pk_sub_u16 v27, v27, s94 clamp
    v_bfi_b32 v77, s79, v27, v77
    v_and_b32 v26, 0x7fff7fff, v78
    v_pk_sub_u16 v26, v26, s94 clamp
    v_bfi_b32 v78, s79, v26, v78
    v_and_b32 v27, 0x7fff7fff, v79
    v_pk_sub_u16 v27, v27, s94 clamp
    v_bfi_b32 v79, s79, v27, v79
    v_or_b32 v24, v64, v65
    v_or3_b32 v24, v24, v66, v67
    v_or3_b32 v24, v24, v68, v69
    v_or3_b32 v24, v24, v70, v71
    v_or3_b32 v24, v24, v72, v73
    v_or3_b32 v24, v24, v74, v75
    v_or3_b32 v24, v24, v76, v77
    v_or3_b32 v24, v24, v78, v79
    v_lshlrev_b32 v36, 11, v76
    v_and_or_b32 v104, v36, s78, v64
    v_lshlrev_b32 v37, 11, v77
    v_and_or_b32 v105, v37, s78, v65
    v_lshlrev_b32 v36, 11, v78
    v_and_or_b32 v106, v36, s78, v66
    v_lshlrev_b32 v37, 11, v79
    v_and_or_b32 v107, v37, s78, v67
    v_lshlrev_b32 v36, 7, v76
    v_and_or_b32 v108, v36, s78, v68
    v_lshlrev_b32 v37, 7, v77
    v_and_or_b32 v109, v37, s78, v69
    v_lshlrev_b32 v36, 7, v78
    v_and_or_b32 v110, v36, s78, v70
    v_lshlrev_b32 v37, 7, v79
    v_and_or_b32 v111, v37, s78, v71
    v_lshlrev_b32 v36, 3, v76
    v_and_or_b32 v72, v36, s78, v72
    v_lshrrev_b32 v37, 1, v76
    v_and_or_b32 v112, v37, s78, v72
    v_lshlrev_b32 v36, 3, v77
    v_and_or_b32 v73, v36, s78, v73
    v_lshrrev_b32 v37, 1, v77
    v_and_or_b32 v113, v37, s78, v73
    v_lshlrev_b32 v36, 3, v78
    v_and_or_b32 v74, v36, s78, v74
    v_lshrrev_b32 v37, 1, v78
    v_and_or_b32 v114, v37, s78, v74
    v_lshlrev_b32 v36, 3, v79
    v_and_or_b32 v75, v36, s78, v75
    v_lshrrev_b32 v37, 1, v79
    v_and_or_b32 v115, v37, s78, v75
    v_and_b32 v25, 0x7fff7fff, v48
    v_pk_sub_u16 v25, v25, 1 op_sel_hi:[1,0]
    v_and_b32 v37, 0x7fff7fff, v49
    v_pk_sub_u16 v37, v37, 1 op_sel_hi:[1,0]
    v_pk_min_u16 v25, v25, v37
    v_and_b32 v36, 0x7fff7fff, v50
    v_pk_sub_u16 v36, v36, 1 op_sel_hi:[1,0]
    v_pk_min_u16 v25, v25, v36
    v_and_b32 v37, 0x7fff7fff, v51
    v_pk_sub_u16 v37, v37, 1 op_sel_hi:[1,0]
    v_pk_min_u16 v25, v25, v37
    v_and_b32 v36, 0x7fff7fff, v52
    v_pk_sub_u16 v36, v36, 1 op_sel_hi:[1,0]
    v_pk_min_u16 v25, v25, v36
    v_and_b32 v37, 0x7fff7fff, v53
    v_pk_sub_u16 v37, v37, 1 op_sel_hi:[1,0]
    v_pk_min_u16 v25, v25, v37
    v_and_b32 v36, 0x7fff7fff, v54
    v_pk_sub_u16 v36, v36, 1 op_sel_hi:[1,0]
    v_pk_min_u16 v25, v25, v36
    v_and_b32 v37, 0x7fff7fff, v55
    v_pk_sub_u16 v37, v37, 1 op_sel_hi:[1,0]
    v_pk_min_u16 v25, v25, v37
    v_and_b32 v36, 0x7fff7fff, v56
    v_pk_sub_u16 v36, v36, 1 op_sel_hi:[1,0]
    v_pk_min_u16 v25, v25, v36
    v_and_b32 v37, 0x7fff7fff, v57
    v_pk_sub_u16 v37, v37, 1 op_sel_hi:[1,0]
    v_pk_min_u16 v25, v25, v37
    v_and_b32 v36, 0x7fff7fff, v58
    v_pk_sub_u16 v36, v36, 1 op_sel_hi:[1,0]
    v_pk_min_u16 v25, v25, v36
    v_and_b32 v37, 0x7fff7fff, v59
    v_pk_sub_u16 v37, v37, 1 op_sel_hi:[1,0]
    v_pk_min_u16 v25, v25, v37
    v_and_b32 v36, 0x7fff7fff, v60
    v_pk_sub_u16 v36, v36, 1 op_sel_hi:[1,0]
    v_pk_min_u16 v25, v25, v36
    v_and_b32 v37, 0x7fff7fff, v61
    v_pk_sub_u16 v37, v37, 1 op_sel_hi:[1,0]
    v_pk_min_u16 v25, v25, v37
    v_and_b32 v36, 0x7fff7fff, v62
    v_pk_sub_u16 v36, v36, 1 op_sel_hi:[1,0]
    v_pk_min_u16 v25, v25, v36
    v_and_b32 v37, 0x7fff7fff, v63
    v_pk_sub_u16 v37, v37, 1 op_sel_hi:[1,0]
    v_pk_min_u16 v25, v25, v37
    v_mov_b32 v36, 0x38ff38ff
    v_pk_sub_u16 v36, v36, v25 clamp
    v_cmp_ne_u32 vcc, 0, v36
    s_or_b32 s62, 2, 0
    s_getpc_b64 s[92:93]
    s_cbranch_vccnz REC_K
    v_and_b32 v26, 0x7fff7fff, v48
    v_pk_sub_u16 v26, v26, s98 clamp
    v_bfi_b32 v48, s79, v26, v48
    v_and_b32 v27, 0x7fff7fff, v49
    v_pk_sub_u16 v27, v27, s98 clamp
    v_bfi_b32 v49, s79, v27, v49
    v_and_b32 v26, 0x7fff7fff, v50
    v_pk_sub_u16 v26, v26, s98 clamp
    v_bfi_b32 v50, s79, v26, v50
    v_and_b32 v27, 0x7fff7fff, v51
    v_pk_sub_u16 v27, v27, s98 clamp
    v_bfi_b32 v51, s79, v27, v51
    v_and_b32 v26, 0x7fff7fff, v52
    v_pk_sub_u16 v26, v26, s98 clamp
    v_bfi_b32 v52, s79, v26, v52
    v_and_b32 v27, 0x7fff7fff, v53
    v_pk_sub_u16 v27, v27, s98 clamp
    v_bfi_b32 v53, s79, v27, v53
    v_and_b32 v26, 0x7fff7fff, v54
    v_pk_sub_u16 v26, v26, s98 clamp
    v_bfi_b32 v54, s79, v26, v54
    v_and_b32 v27, 0x7fff7fff, v55
    v_pk_sub_u16 v27, v27, s98 clamp
    v_bfi_b32 v55, s79, v27, v55
    v_and_b32 v26, 0x7fff7fff, v56
    v_pk_sub_u16 v26, v26, s98 clamp
    v_bfi_b32 v56, s79, v26, v56
    v_and_b32 v27, 0x7fff7fff, v57
    v_pk_sub_u16 v27, v27, s98 clamp
    v_bfi_b32 v57, s79, v27, v57
    v_and_b32 v26, 0x7fff7fff, v58
    v_pk_sub_u16 v26, v26, s98 clamp
    v_bfi_b32 v58, s79, v26, v58
    v_and_b32 v27, 0x7fff7fff, v59
    v_pk_sub_u16 v27, v27, s98 clamp
    v_bfi_b32 v59, s79, v27, v59
    v_and_b32 v26, 0x7fff7fff, v60
    v_pk_sub_u16 v26, v26, s98 clamp
    v_bfi_b32 v60, s79, v26, v60
    v_and_b32 v27, 0x7fff7fff, v61
    v_pk_sub_u16 v27, v27, s98 clamp
    v_bfi_b32 v61, s79, v27, v61
    v_and_b32 v26, 0x7fff7fff, v62
    v_pk_sub_u16 v26, v26, s98 clamp
    v_bfi_b32 v62, s79, v26, v62
    v_and_b32 v27, 0x7fff7fff, v63
    v_pk_sub_u16 v27, v27, s98 clamp
    v_bfi_b32 v63, s79, v27, v63
    v_or3_b32 v24, v24, v48, v49
    v_or3_b32 v24, v24, v50, v51
    v_or3_b32 v24, v24, v52, v53
    v_or3_b32 v24, v24, v54, v55
    v_or3_b32 v24, v24, v56, v57
    v_or3_b32 v24, v24, v58, v59
    v_or3_b32 v24, v24, v60, v61
    v_or3_b32 v24, v24, v62, v63
    v_lshlrev_b32 v36, 11, v60
    v_and_or_b32 v48, v36, s78, v48
    v_accvgpr_write_b32 a72, v48
    v_lshlrev_b32 v37, 11, v61
    v_and_or_b32 v49, v37, s78, v49
    v_accvgpr_write_b32 a73, v49
    v_lshlrev_b32 v36, 11, v62
    v_and_or_b32 v50, v36, s78, v50
    v_accvgpr_write_b32 a74, v50
    v_lshlrev_b32 v37, 11, v63
    v_and_or_b32 v51, v37, s78, v51
    v_accvgpr_write_b32 a75, v51
    v_lshlrev_b32 v36, 7, v60
    v_and_or_b32 v52, v36, s78, v52
    v_accvgpr_write_b32 a76, v52
    v_lshlrev_b32 v37, 7, v61
    v_and_or_b32 v53, v37, s78, v53
    v_accvgpr_write_b32 a77, v53
    v_lshlrev_b32 v36, 7, v62
    v_and_or_b32 v54, v36, s78, v54
    v_accvgpr_write_b32 a78, v54
    v_lshlrev_b32 v37, 7, v63
    v_and_or_b32 v55, v37, s78, v55
    v_accvgpr_write_b32 a79, v55
    v_lshlrev_b32 v36, 3, v60
    v_and_or_b32 v56, v36, s78, v56
    v_lshrrev_b32 v37, 1, v60
    v_and_or_b32 v56, v37, s78, v56
    v_accvgpr_write_b32 a80, v56
    v_lshlrev_b32 v36, 3, v61
    v_and_or_b32 v57, v36, s78, v57
    v_lshrrev_b32 v37, 1, v61
    v_and_or_b32 v57, v37, s78, v57
    v_accvgpr_write_b32 a81, v57
    v_lshlrev_b32 v36, 3, v62
    v_and_or_b32 v58, v36, s78, v58
    v_lshrrev_b32 v37, 1, v62
    v_and_or_b32 v58, v37, s78, v58
    v_accvgpr_write_b32 a82, v58
    v_lshlrev_b32 v36, 3, v63
    v_and_or_b32 v59, v36, s78, v59
    v_lshrrev_b32 v37, 1, v63
    v_and_or_b32 v59, v37, s78, v59
    v_accvgpr_write_b32 a83, v59
    v_and_b32 v24, s78, v24
    v_cmp_ne_u32 vcc, 0, v24
    s_cmp_lg_u64 vcc, 0
    s_cselect_b32 s60, 4, 0
    s_or_b32 s99, s99, s60
    s_waitcnt vmcnt(20)
    ds_read_b128 v[48:51], v9 offset:32768
    ds_read_b128 v[52:55], v10 offset:32768
    ds_read_b128 v[56:59], v11 offset:32768
    ds_read_b128 v[60:63], v12 offset:32768
    s_waitcnt vmcnt(16)
    v_accvgpr_read_b32 v64, a232
    v_accvgpr_read_b32 v65, a233
    v_accvgpr_read_b32 v66, a234
    v_accvgpr_read_b32 v67, a235
    v_accvgpr_read_b32 v68, a236
    v_accvgpr_read_b32 v69, a237
    v_accvgpr_read_b32 v70, a238
    v_accvgpr_read_b32 v71, a239
    v_accvgpr_read_b32 v72, a240
    v_accvgpr_read_b32 v73, a241
    v_accvgpr_read_b32 v74, a242
    v_accvgpr_read_b32 v75, a243
    v_accvgpr_read_b32 v76, a244
    v_accvgpr_read_b32 v77, a245
    v_accvgpr_read_b32 v78, a246
    v_accvgpr_read_b32 v79, a247
    s_waitcnt lgkmcnt(0)
    s_add_u32 s54, s52, 393216
    s_add_u32 m0, s59, 32768
    s_nop 0
    buffer_load_dwordx4 v4, s[4:7], s54 offen offset:0 nt lds
    buffer_load_dwordx4 v5, s[4:7], s54 offen offset:1024 nt lds
    buffer_load_dwordx4 v6, s[4:7], s54 offen offset:2048 nt lds
    buffer_load_dwordx4 v7, s[4:7], s54 offen offset:3072 nt lds
    buffer_load_dwordx4 a[232:235], v8, s[8:11], s54 offen offset:0 nt
    buffer_load_dwordx4 a[236:239], v8, s[8:11], s54 offen offset:256 nt
    buffer_load_dwordx4 a[240:243], v8, s[8:11], s54 offen offset:512 nt
    buffer_load_dwordx4 a[244:247], v8, s[8:11], s54 offen offset:768 nt
    v_and_b32 v25, 0x7fff7fff, v64
    v_pk_sub_u16 v25, v25, 1 op_sel_hi:[1,0]
    v_and_b32 v37, 0x7fff7fff, v65
    v_pk_sub_u16 v37, v37, 1 op_sel_hi:[1,0]
    v_pk_min_u16 v25, v25, v37
    v_and_b32 v36, 0x7fff7fff, v66
    v_pk_sub_u16 v36, v36, 1 op_sel_hi:[1,0]
    v_pk_min_u16 v25, v25, v36
    v_and_b32 v37, 0x7fff7fff, v67
    v_pk_sub_u16 v37, v37, 1 op_sel_hi:[1,0]
    v_pk_min_u16 v25, v25, v37
    v_and_b32 v36, 0x7fff7fff, v68
    v_pk_sub_u16 v36, v36, 1 op_sel_hi:[1,0]
    v_pk_min_u16 v25, v25, v36
    v_and_b32 v37, 0x7fff7fff, v69
    v_pk_sub_u16 v37, v37, 1 op_sel_hi:[1,0]
    v_pk_min_u16 v25, v25, v37
    v_and_b32 v36, 0x7fff7fff, v70
    v_pk_sub_u16 v36, v36, 1 op_sel_hi:[1,0]
    v_pk_min_u16 v25, v25, v36
    v_and_b32 v37, 0x7fff7fff, v71
    v_pk_sub_u16 v37, v37, 1 op_sel_hi:[1,0]
    v_pk_min_u16 v25, v25, v37
    v_and_b32 v36, 0x7fff7fff, v72
    v_pk_sub_u16 v36, v36, 1 op_sel_hi:[1,0]
    v_pk_min_u16 v25, v25, v36
    v_and_b32 v37, 0x7fff7fff, v73
    v_pk_sub_u16 v37, v37, 1 op_sel_hi:[1,0]
    v_pk_min_u16 v25, v25, v37
    v_and_b32 v36, 0x7fff7fff, v74
    v_pk_sub_u16 v36, v36, 1 op_sel_hi:[1,0]
    v_pk_min_u16 v25, v25, v36
    v_and_b32 v37, 0x7fff7fff, v75
    v_pk_sub_u16 v37, v37, 1 op_sel_hi:[1,0]
    v_pk_min_u16 v25, v25, v37
    v_and_b32 v36, 0x7fff7fff, v76
    v_pk_sub_u16 v36, v36, 1 op_sel_hi:[1,0]
    v_pk_min_u16 v25, v25, v36
    v_and_b32 v37, 0x7fff7fff, v77
    v_pk_sub_u16 v37, v37, 1 op_sel_hi:[1,0]
    v_pk_min_u16 v25, v25, v37
    v_and_b32 v36, 0x7fff7fff, v78
    v_pk_sub_u16 v36, v36, 1 op_sel_hi:[1,0]
    v_pk_min_u16 v25, v25, v36
    v_and_b32 v37, 0x7fff7fff, v79
    v_pk_sub_u16 v37, v37, 1 op_sel_hi:[1,0]
    v_pk_min_u16 v25, v25, v37
    v_mov_b32 v36, 0x397f397f
    v_pk_sub_u16 v36, v36, v25 clamp
    v_cmp_ne_u32 vcc, 0, v36
    s_or_b32 s62, 35, 0
    s_getpc_b64 s[92:93]
    s_cbranch_vccnz REC_V
    v_and_b32 v26, 0x7fff7fff, v64
    v_pk_sub_u16 v26, v26, s94 clamp
    v_bfi_b32 v64, s79, v26, v64
    v_and_b32 v27, 0x7fff7fff, v65
    v_pk_sub_u16 v27, v27, s94 clamp
    v_bfi_b32 v65, s79, v27, v65
    v_and_b32 v26, 0x7fff7fff, v66
    v_pk_sub_u16 v26, v26, s94 clamp
    v_bfi_b32 v66, s79, v26, v66
    v_and_b32 v27, 0x7fff7fff, v67
    v_pk_sub_u16 v27, v27, s94 clamp
    v_bfi_b32 v67, s79, v27, v67
    v_and_b32 v26, 0x7fff7fff, v68
    v_pk_sub_u16 v26, v26, s94 clamp
    v_bfi_b32 v68, s79, v26, v68
    v_and_b32 v27, 0x7fff7fff, v69
    v_pk_sub_u16 v27, v27, s94 clamp
    v_bfi_b32 v69, s79, v27, v69
    v_and_b32 v26, 0x7fff7fff, v70
    v_pk_sub_u16 v26, v26, s94 clamp
    v_bfi_b32 v70, s79, v26, v70
    v_and_b32 v27, 0x7fff7fff, v71
    v_pk_sub_u16 v27, v27, s94 clamp
    v_bfi_b32 v71, s79, v27, v71
    v_and_b32 v26, 0x7fff7fff, v72
    v_pk_sub_u16 v26, v26, s94 clamp
    v_bfi_b32 v72, s79, v26, v72
    v_and_b32 v27, 0x7fff7fff, v73
    v_pk_sub_u16 v27, v27, s94 clamp
    v_bfi_b32 v73, s79, v27, v73
    v_and_b32 v26, 0x7fff7fff, v74
    v_pk_sub_u16 v26, v26, s94 clamp
    v_bfi_b32 v74, s79, v26, v74
    v_and_b32 v27, 0x7fff7fff, v75
    v_pk_sub_u16 v27, v27, s94 clamp
    v_bfi_b32 v75, s79, v27, v75
    v_and_b32 v26, 0x7fff7fff, v76
    v_pk_sub_u16 v26, v26, s94 clamp
    v_bfi_b32 v76, s79, v26, v76
    v_and_b32 v27, 0x7fff7fff, v77
    v_pk_sub_u16 v27, v27, s94 clamp
    v_bfi_b32 v77, s79, v27, v77
    v_and_b32 v26, 0x7fff7fff, v78
    v_pk_sub_u16 v26, v26, s94 clamp
    v_bfi_b32 v78, s79, v26, v78
    v_and_b32 v27, 0x7fff7fff, v79
    v_pk_sub_u16 v27, v27, s94 clamp
    v_bfi_b32 v79, s79, v27, v79
    v_or_b32 v24, v64, v65
    v_or3_b32 v24, v24, v66, v67
    v_or3_b32 v24, v24, v68, v69
    v_or3_b32 v24, v24, v70, v71
    v_or3_b32 v24, v24, v72, v73
    v_or3_b32 v24, v24, v74, v75
    v_or3_b32 v24, v24, v76, v77
    v_or3_b32 v24, v24, v78, v79
    v_lshlrev_b32 v36, 11, v76
    v_and_or_b32 v116, v36, s78, v64
    v_lshlrev_b32 v37, 11, v77
    v_and_or_b32 v117, v37, s78, v65
    v_lshlrev_b32 v36, 11, v78
    v_and_or_b32 v118, v36, s78, v66
    v_lshlrev_b32 v37, 11, v79
    v_and_or_b32 v119, v37, s78, v67
    v_lshlrev_b32 v36, 7, v76
    v_and_or_b32 v120, v36, s78, v68
    v_lshlrev_b32 v37, 7, v77
    v_and_or_b32 v121, v37, s78, v69
    v_lshlrev_b32 v36, 7, v78
    v_and_or_b32 v122, v36, s78, v70
    v_lshlrev_b32 v37, 7, v79
    v_and_or_b32 v123, v37, s78, v71
    v_lshlrev_b32 v36, 3, v76
    v_and_or_b32 v72, v36, s78, v72
    v_lshrrev_b32 v37, 1, v76
    v_and_or_b32 v124, v37, s78, v72
    v_lshlrev_b32 v36, 3, v77
    v_and_or_b32 v73, v36, s78, v73
    v_lshrrev_b32 v37, 1, v77
    v_and_or_b32 v125, v37, s78, v73
    v_lshlrev_b32 v36, 3, v78
    v_and_or_b32 v74, v36, s78, v74
    v_lshrrev_b32 v37, 1, v78
    v_and_or_b32 v126, v37, s78, v74
    v_lshlrev_b32 v36, 3, v79
    v_and_or_b32 v75, v36, s78, v75
    v_lshrrev_b32 v37, 1, v79
    v_and_or_b32 v127, v37, s78, v75
    v_and_b32 v25, 0x7fff7fff, v48
    v_pk_sub_u16 v25, v25, 1 op_sel_hi:[1,0]
    v_and_b32 v37, 0x7fff7fff, v49
    v_pk_sub_u16 v37, v37, 1 op_sel_hi:[1,0]
    v_pk_min_u16 v25, v25, v37
    v_and_b32 v36, 0x7fff7fff, v50
    v_pk_sub_u16 v36, v36, 1 op_sel_hi:[1,0]
    v_pk_min_u16 v25, v25, v36
    v_and_b32 v37, 0x7fff7fff, v51
    v_pk_sub_u16 v37, v37, 1 op_sel_hi:[1,0]
    v_pk_min_u16 v25, v25, v37
    v_and_b32 v36, 0x7fff7fff, v52
    v_pk_sub_u16 v36, v36, 1 op_sel_hi:[1,0]
    v_pk_min_u16 v25, v25, v36
    v_and_b32 v37, 0x7fff7fff, v53
    v_pk_sub_u16 v37, v37, 1 op_sel_hi:[1,0]
    v_pk_min_u16 v25, v25, v37
    v_and_b32 v36, 0x7fff7fff, v54
    v_pk_sub_u16 v36, v36, 1 op_sel_hi:[1,0]
    v_pk_min_u16 v25, v25, v36
    v_and_b32 v37, 0x7fff7fff, v55
    v_pk_sub_u16 v37, v37, 1 op_sel_hi:[1,0]
    v_pk_min_u16 v25, v25, v37
    v_and_b32 v36, 0x7fff7fff, v56
    v_pk_sub_u16 v36, v36, 1 op_sel_hi:[1,0]
    v_pk_min_u16 v25, v25, v36
    v_and_b32 v37, 0x7fff7fff, v57
    v_pk_sub_u16 v37, v37, 1 op_sel_hi:[1,0]
    v_pk_min_u16 v25, v25, v37
    v_and_b32 v36, 0x7fff7fff, v58
    v_pk_sub_u16 v36, v36, 1 op_sel_hi:[1,0]
    v_pk_min_u16 v25, v25, v36
    v_and_b32 v37, 0x7fff7fff, v59
    v_pk_sub_u16 v37, v37, 1 op_sel_hi:[1,0]
    v_pk_min_u16 v25, v25, v37
    v_and_b32 v36, 0x7fff7fff, v60
    v_pk_sub_u16 v36, v36, 1 op_sel_hi:[1,0]
    v_pk_min_u16 v25, v25, v36
    v_and_b32 v37, 0x7fff7fff, v61
    v_pk_sub_u16 v37, v37, 1 op_sel_hi:[1,0]
    v_pk_min_u16 v25, v25, v37
    v_and_b32 v36, 0x7fff7fff, v62
    v_pk_sub_u16 v36, v36, 1 op_sel_hi:[1,0]
    v_pk_min_u16 v25, v25, v36
    v_and_b32 v37, 0x7fff7fff, v63
    v_pk_sub_u16 v37, v37, 1 op_sel_hi:[1,0]
    v_pk_min_u16 v25, v25, v37
    v_mov_b32 v36, 0x38ff38ff
    v_pk_sub_u16 v36, v36, v25 clamp
    v_cmp_ne_u32 vcc, 0, v36
    s_or_b32 s62, 3, 0
    s_getpc_b64 s[92:93]
    s_cbranch_vccnz REC_K
    v_and_b32 v26, 0x7fff7fff, v48
    v_pk_sub_u16 v26, v26, s98 clamp
    v_bfi_b32 v48, s79, v26, v48
    v_and_b32 v27, 0x7fff7fff, v49
    v_pk_sub_u16 v27, v27, s98 clamp
    v_bfi_b32 v49, s79, v27, v49
    v_and_b32 v26, 0x7fff7fff, v50
    v_pk_sub_u16 v26, v26, s98 clamp
    v_bfi_b32 v50, s79, v26, v50
    v_and_b32 v27, 0x7fff7fff, v51
    v_pk_sub_u16 v27, v27, s98 clamp
    v_bfi_b32 v51, s79, v27, v51
    v_and_b32 v26, 0x7fff7fff, v52
    v_pk_sub_u16 v26, v26, s98 clamp
    v_bfi_b32 v52, s79, v26, v52
    v_and_b32 v27, 0x7fff7fff, v53
    v_pk_sub_u16 v27, v27, s98 clamp
    v_bfi_b32 v53, s79, v27, v53
    v_and_b32 v26, 0x7fff7fff, v54
    v_pk_sub_u16 v26, v26, s98 clamp
    v_bfi_b32 v54, s79, v26, v54
    v_and_b32 v27, 0x7fff7fff, v55
    v_pk_sub_u16 v27, v27, s98 clamp
    v_bfi_b32 v55, s79, v27, v55
    v_and_b32 v26, 0x7fff7fff, v56
    v_pk_sub_u16 v26, v26, s98 clamp
    v_bfi_b32 v56, s79, v26, v56
    v_and_b32 v27, 0x7fff7fff, v57
    v_pk_sub_u16 v27, v27, s98 clamp
    v_bfi_b32 v57, s79, v27, v57
    v_and_b32 v26, 0x7fff7fff, v58
    v_pk_sub_u16 v26, v26, s98 clamp
    v_bfi_b32 v58, s79, v26, v58
    v_and_b32 v27, 0x7fff7fff, v59
    v_pk_sub_u16 v27, v27, s98 clamp
    v_bfi_b32 v59, s79, v27, v59
    v_and_b32 v26, 0x7fff7fff, v60
    v_pk_sub_u16 v26, v26, s98 clamp
    v_bfi_b32 v60, s79, v26, v60
    v_and_b32 v27, 0x7fff7fff, v61
    v_pk_sub_u16 v27, v27, s98 clamp
    v_bfi_b32 v61, s79, v27, v61
    v_and_b32 v26, 0x7fff7fff, v62
    v_pk_sub_u16 v26, v26, s98 clamp
    v_bfi_b32 v62, s79, v26, v62
    v_and_b32 v27, 0x7fff7fff, v63
    v_pk_sub_u16 v27, v27, s98 clamp
    v_bfi_b32 v63, s79, v27, v63
    v_or3_b32 v24, v24, v48, v49
    v_or3_b32 v24, v24, v50, v51
    v_or3_b32 v24, v24, v52, v53
    v_or3_b32 v24, v24, v54, v55
    v_or3_b32 v24, v24, v56, v57
    v_or3_b32 v24, v24, v58, v59
    v_or3_b32 v24, v24, v60, v61
    v_or3_b32 v24, v24, v62, v63
    v_lshlrev_b32 v36, 11, v60
    v_and_or_b32 v48, v36, s78, v48
    v_accvgpr_write_b32 a84, v48
    v_lshlrev_b32 v37, 11, v61
    v_and_or_b32 v49, v37, s78, v49
    v_accvgpr_write_b32 a85, v49
    v_lshlrev_b32 v36, 11, v62
    v_and_or_b32 v50, v36, s78, v50
    v_accvgpr_write_b32 a86, v50
    v_lshlrev_b32 v37, 11, v63
    v_and_or_b32 v51, v37, s78, v51
    v_accvgpr_write_b32 a87, v51
    v_lshlrev_b32 v36, 7, v60
    v_and_or_b32 v52, v36, s78, v52
    v_accvgpr_write_b32 a88, v52
    v_lshlrev_b32 v37, 7, v61
    v_and_or_b32 v53, v37, s78, v53
    v_accvgpr_write_b32 a89, v53
    v_lshlrev_b32 v36, 7, v62
    v_and_or_b32 v54, v36, s78, v54
    v_accvgpr_write_b32 a90, v54
    v_lshlrev_b32 v37, 7, v63
    v_and_or_b32 v55, v37, s78, v55
    v_accvgpr_write_b32 a91, v55
    v_lshlrev_b32 v36, 3, v60
    v_and_or_b32 v56, v36, s78, v56
    v_lshrrev_b32 v37, 1, v60
    v_and_or_b32 v56, v37, s78, v56
    v_accvgpr_write_b32 a92, v56
    v_lshlrev_b32 v36, 3, v61
    v_and_or_b32 v57, v36, s78, v57
    v_lshrrev_b32 v37, 1, v61
    v_and_or_b32 v57, v37, s78, v57
    v_accvgpr_write_b32 a93, v57
    v_lshlrev_b32 v36, 3, v62
    v_and_or_b32 v58, v36, s78, v58
    v_lshrrev_b32 v37, 1, v62
    v_and_or_b32 v58, v37, s78, v58
    v_accvgpr_write_b32 a94, v58
    v_lshlrev_b32 v36, 3, v63
    v_and_or_b32 v59, v36, s78, v59
    v_lshrrev_b32 v37, 1, v63
    v_and_or_b32 v59, v37, s78, v59
    v_accvgpr_write_b32 a95, v59
    v_and_b32 v24, s78, v24
    v_cmp_ne_u32 vcc, 0, v24
    s_cmp_lg_u64 vcc, 0
    s_cselect_b32 s60, 8, 0
    s_or_b32 s99, s99, s60
    s_barrier
    s_cmp_eq_u32 s3, 0
    s_cbranch_scc0 CS_12
    v_mov_b32 v36, 64
    v_mov_b32 v37, 1
    s_mov_b64 exec, 1
    buffer_atomic_add v37, v36, s[36:39], 0 offen
    s_mov_b64 exec, -1
CS_12:
    v_and_b32 v47, 0xffff0000, v45
    v_lshlrev_b32 v46, 16, v45
    v_and_b32 v45, 0xffff0000, v44
    v_lshlrev_b32 v44, 16, v44
    s_waitcnt vmcnt(20)
    ds_read_b128 v[48:51], v9 offset:0
    ds_read_b128 v[52:55], v10 offset:0
    ds_read_b128 v[56:59], v11 offset:0
    ds_read_b128 v[60:63], v12 offset:0
    s_waitcnt vmcnt(16)
    v_accvgpr_read_b32 v64, a0
    v_accvgpr_read_b32 v65, a1
    v_accvgpr_read_b32 v66, a2
    v_accvgpr_read_b32 v67, a3
    v_accvgpr_read_b32 v68, a4
    v_accvgpr_read_b32 v69, a5
    v_accvgpr_read_b32 v70, a6
    v_accvgpr_read_b32 v71, a7
    v_accvgpr_read_b32 v72, a8
    v_accvgpr_read_b32 v73, a9
    v_accvgpr_read_b32 v74, a10
    v_accvgpr_read_b32 v75, a11
    v_accvgpr_read_b32 v76, a12
    v_accvgpr_read_b32 v77, a13
    v_accvgpr_read_b32 v78, a14
    v_accvgpr_read_b32 v79, a15
    s_waitcnt lgkmcnt(0)
    s_add_u32 s54, s52, 458752
    s_add_u32 m0, s59, 0
    s_nop 0
    buffer_load_dwordx4 v4, s[4:7], s54 offen offset:0 nt lds
    buffer_load_dwordx4 v5, s[4:7], s54 offen offset:1024 nt lds
    buffer_load_dwordx4 v6, s[4:7], s54 offen offset:2048 nt lds
    buffer_load_dwordx4 v7, s[4:7], s54 offen offset:3072 nt lds
    buffer_load_dwordx4 a[0:3], v8, s[8:11], s54 offen offset:0 nt
    buffer_load_dwordx4 a[4:7], v8, s[8:11], s54 offen offset:256 nt
    buffer_load_dwordx4 a[8:11], v8, s[8:11], s54 offen offset:512 nt
    buffer_load_dwordx4 a[12:15], v8, s[8:11], s54 offen offset:768 nt
    v_and_b32 v25, 0x7fff7fff, v64
    v_pk_sub_u16 v25, v25, 1 op_sel_hi:[1,0]
    v_and_b32 v37, 0x7fff7fff, v65
    v_pk_sub_u16 v37, v37, 1 op_sel_hi:[1,0]
    v_pk_min_u16 v25, v25, v37
    v_and_b32 v36, 0x7fff7fff, v66
    v_pk_sub_u16 v36, v36, 1 op_sel_hi:[1,0]
    v_pk_min_u16 v25, v25, v36
    v_and_b32 v37, 0x7fff7fff, v67
    v_pk_sub_u16 v37, v37, 1 op_sel_hi:[1,0]
    v_pk_min_u16 v25, v25, v37
    v_and_b32 v36, 0x7fff7fff, v68
    v_pk_sub_u16 v36, v36, 1 op_sel_hi:[1,0]
    v_pk_min_u16 v25, v25, v36
    v_and_b32 v37, 0x7fff7fff, v69
    v_pk_sub_u16 v37, v37, 1 op_sel_hi:[1,0]
    v_pk_min_u16 v25, v25, v37
    v_and_b32 v36, 0x7fff7fff, v70
    v_pk_sub_u16 v36, v36, 1 op_sel_hi:[1,0]
    v_pk_min_u16 v25, v25, v36
    v_and_b32 v37, 0x7fff7fff, v71
    v_pk_sub_u16 v37, v37, 1 op_sel_hi:[1,0]
    v_pk_min_u16 v25, v25, v37
    v_and_b32 v36, 0x7fff7fff, v72
    v_pk_sub_u16 v36, v36, 1 op_sel_hi:[1,0]
    v_pk_min_u16 v25, v25, v36
    v_and_b32 v37, 0x7fff7fff, v73
    v_pk_sub_u16 v37, v37, 1 op_sel_hi:[1,0]
    v_pk_min_u16 v25, v25, v37
    v_and_b32 v36, 0x7fff7fff, v74
    v_pk_sub_u16 v36, v36, 1 op_sel_hi:[1,0]
    v_pk_min_u16 v25, v25, v36
    v_and_b32 v37, 0x7fff7fff, v75
    v_pk_sub_u16 v37, v37, 1 op_sel_hi:[1,0]
    v_pk_min_u16 v25, v25, v37
    v_and_b32 v36, 0x7fff7fff, v76
    v_pk_sub_u16 v36, v36, 1 op_sel_hi:[1,0]
    v_pk_min_u16 v25, v25, v36
    v_and_b32 v37, 0x7fff7fff, v77
    v_pk_sub_u16 v37, v37, 1 op_sel_hi:[1,0]
    v_pk_min_u16 v25, v25, v37
    v_and_b32 v36, 0x7fff7fff, v78
    v_pk_sub_u16 v36, v36, 1 op_sel_hi:[1,0]
    v_pk_min_u16 v25, v25, v36
    v_and_b32 v37, 0x7fff7fff, v79
    v_pk_sub_u16 v37, v37, 1 op_sel_hi:[1,0]
    v_pk_min_u16 v25, v25, v37
    v_mov_b32 v36, 0x397f397f
    v_pk_sub_u16 v36, v36, v25 clamp
    v_cmp_ne_u32 vcc, 0, v36
    s_or_b32 s62, 36, 0
    s_getpc_b64 s[92:93]
    s_cbranch_vccnz REC_V
    v_and_b32 v26, 0x7fff7fff, v64
    v_pk_sub_u16 v26, v26, s94 clamp
    v_bfi_b32 v64, s79, v26, v64
    v_and_b32 v27, 0x7fff7fff, v65
    v_pk_sub_u16 v27, v27, s94 clamp
    v_bfi_b32 v65, s79, v27, v65
    v_and_b32 v26, 0x7fff7fff, v66
    v_pk_sub_u16 v26, v26, s94 clamp
    v_bfi_b32 v66, s79, v26, v66
    v_and_b32 v27, 0x7fff7fff, v67
    v_pk_sub_u16 v27, v27, s94 clamp
    v_bfi_b32 v67, s79, v27, v67
    v_and_b32 v26, 0x7fff7fff, v68
    v_pk_sub_u16 v26, v26, s94 clamp
    v_bfi_b32 v68, s79, v26, v68
    v_and_b32 v27, 0x7fff7fff, v69
    v_pk_sub_u16 v27, v27, s94 clamp
    v_bfi_b32 v69, s79, v27, v69
    v_and_b32 v26, 0x7fff7fff, v70
    v_pk_sub_u16 v26, v26, s94 clamp
    v_bfi_b32 v70, s79, v26, v70
    v_and_b32 v27, 0x7fff7fff, v71
    v_pk_sub_u16 v27, v27, s94 clamp
    v_bfi_b32 v71, s79, v27, v71
    v_and_b32 v26, 0x7fff7fff, v72
    v_pk_sub_u16 v26, v26, s94 clamp
    v_bfi_b32 v72, s79, v26, v72
    v_and_b32 v27, 0x7fff7fff, v73
    v_pk_sub_u16 v27, v27, s94 clamp
    v_bfi_b32 v73, s79, v27, v73
    v_and_b32 v26, 0x7fff7fff, v74
    v_pk_sub_u16 v26, v26, s94 clamp
    v_bfi_b32 v74, s79, v26, v74
    v_and_b32 v27, 0x7fff7fff, v75
    v_pk_sub_u16 v27, v27, s94 clamp
    v_bfi_b32 v75, s79, v27, v75
    v_and_b32 v26, 0x7fff7fff, v76
    v_pk_sub_u16 v26, v26, s94 clamp
    v_bfi_b32 v76, s79, v26, v76
    v_and_b32 v27, 0x7fff7fff, v77
    v_pk_sub_u16 v27, v27, s94 clamp
    v_bfi_b32 v77, s79, v27, v77
    v_and_b32 v26, 0x7fff7fff, v78
    v_pk_sub_u16 v26, v26, s94 clamp
    v_bfi_b32 v78, s79, v26, v78
    v_and_b32 v27, 0x7fff7fff, v79
    v_pk_sub_u16 v27, v27, s94 clamp
    v_bfi_b32 v79, s79, v27, v79
    v_or_b32 v24, v64, v65
    v_or3_b32 v24, v24, v66, v67
    v_or3_b32 v24, v24, v68, v69
    v_or3_b32 v24, v24, v70, v71
    v_or3_b32 v24, v24, v72, v73
    v_or3_b32 v24, v24, v74, v75
    v_or3_b32 v24, v24, v76, v77
    v_or3_b32 v24, v24, v78, v79
    v_lshlrev_b32 v36, 11, v76
    v_and_or_b32 v128, v36, s78, v64
    v_lshlrev_b32 v37, 11, v77
    v_and_or_b32 v129, v37, s78, v65
    v_lshlrev_b32 v36, 11, v78
    v_and_or_b32 v130, v36, s78, v66
    v_lshlrev_b32 v37, 11, v79
    v_and_or_b32 v131, v37, s78, v67
    v_lshlrev_b32 v36, 7, v76
    v_and_or_b32 v132, v36, s78, v68
    v_lshlrev_b32 v37, 7, v77
    v_and_or_b32 v133, v37, s78, v69
    v_lshlrev_b32 v36, 7, v78
    v_and_or_b32 v134, v36, s78, v70
    v_lshlrev_b32 v37, 7, v79
    v_and_or_b32 v135, v37, s78, v71
    v_lshlrev_b32 v36, 3, v76
    v_and_or_b32 v72, v36, s78, v72
    v_lshrrev_b32 v37, 1, v76
    v_and_or_b32 v136, v37, s78, v72
    v_lshlrev_b32 v36, 3, v77
    v_and_or_b32 v73, v36, s78, v73
    v_lshrrev_b32 v37, 1, v77
    v_and_or_b32 v137, v37, s78, v73
    v_lshlrev_b32 v36, 3, v78
    v_and_or_b32 v74, v36, s78, v74
    v_lshrrev_b32 v37, 1, v78
    v_and_or_b32 v138, v37, s78, v74
    v_lshlrev_b32 v36, 3, v79
    v_and_or_b32 v75, v36, s78, v75
    v_lshrrev_b32 v37, 1, v79
    v_and_or_b32 v139, v37, s78, v75
    v_and_b32 v25, 0x7fff7fff, v48
    v_pk_sub_u16 v25, v25, 1 op_sel_hi:[1,0]
    v_and_b32 v37, 0x7fff7fff, v49
    v_pk_sub_u16 v37, v37, 1 op_sel_hi:[1,0]
    v_pk_min_u16 v25, v25, v37
    v_and_b32 v36, 0x7fff7fff, v50
    v_pk_sub_u16 v36, v36, 1 op_sel_hi:[1,0]
    v_pk_min_u16 v25, v25, v36
    v_and_b32 v37, 0x7fff7fff, v51
    v_pk_sub_u16 v37, v37, 1 op_sel_hi:[1,0]
    v_pk_min_u16 v25, v25, v37
    v_and_b32 v36, 0x7fff7fff, v52
    v_pk_sub_u16 v36, v36, 1 op_sel_hi:[1,0]
    v_pk_min_u16 v25, v25, v36
    v_and_b32 v37, 0x7fff7fff, v53
    v_pk_sub_u16 v37, v37, 1 op_sel_hi:[1,0]
    v_pk_min_u16 v25, v25, v37
    v_and_b32 v36, 0x7fff7fff, v54
    v_pk_sub_u16 v36, v36, 1 op_sel_hi:[1,0]
    v_pk_min_u16 v25, v25, v36
    v_and_b32 v37, 0x7fff7fff, v55
    v_pk_sub_u16 v37, v37, 1 op_sel_hi:[1,0]
    v_pk_min_u16 v25, v25, v37
    v_and_b32 v36, 0x7fff7fff, v56
    v_pk_sub_u16 v36, v36, 1 op_sel_hi:[1,0]
    v_pk_min_u16 v25, v25, v36
    v_and_b32 v37, 0x7fff7fff, v57
    v_pk_sub_u16 v37, v37, 1 op_sel_hi:[1,0]
    v_pk_min_u16 v25, v25, v37
    v_and_b32 v36, 0x7fff7fff, v58
    v_pk_sub_u16 v36, v36, 1 op_sel_hi:[1,0]
    v_pk_min_u16 v25, v25, v36
    v_and_b32 v37, 0x7fff7fff, v59
    v_pk_sub_u16 v37, v37, 1 op_sel_hi:[1,0]
    v_pk_min_u16 v25, v25, v37
    v_and_b32 v36, 0x7fff7fff, v60
    v_pk_sub_u16 v36, v36, 1 op_sel_hi:[1,0]
    v_pk_min_u16 v25, v25, v36
    v_and_b32 v37, 0x7fff7fff, v61
    v_pk_sub_u16 v37, v37, 1 op_sel_hi:[1,0]
    v_pk_min_u16 v25, v25, v37
    v_and_b32 v36, 0x7fff7fff, v62
    v_pk_sub_u16 v36, v36, 1 op_sel_hi:[1,0]
    v_pk_min_u16 v25, v25, v36
    v_and_b32 v37, 0x7fff7fff, v63
    v_pk_sub_u16 v37, v37, 1 op_sel_hi:[1,0]
    v_pk_min_u16 v25, v25, v37
    v_mov_b32 v36, 0x38ff38ff
    v_pk_sub_u16 v36, v36, v25 clamp
    v_cmp_ne_u32 vcc, 0, v36
    s_or_b32 s62, 4, 0
    s_getpc_b64 s[92:93]
    s_cbranch_vccnz REC_K
    v_and_b32 v26, 0x7fff7fff, v48
    v_pk_sub_u16 v26, v26, s98 clamp
    v_bfi_b32 v48, s79, v26, v48
    v_and_b32 v27, 0x7fff7fff, v49
    v_pk_sub_u16 v27, v27, s98 clamp
    v_bfi_b32 v49, s79, v27, v49
    v_and_b32 v26, 0x7fff7fff, v50
    v_pk_sub_u16 v26, v26, s98 clamp
    v_bfi_b32 v50, s79, v26, v50
    v_and_b32 v27, 0x7fff7fff, v51
    v_pk_sub_u16 v27, v27, s98 clamp
    v_bfi_b32 v51, s79, v27, v51
    v_and_b32 v26, 0x7fff7fff, v52
    v_pk_sub_u16 v26, v26, s98 clamp
    v_bfi_b32 v52, s79, v26, v52
    v_and_b32 v27, 0x7fff7fff, v53
    v_pk_sub_u16 v27, v27, s98 clamp
    v_bfi_b32 v53, s79, v27, v53
    v_and_b32 v26, 0x7fff7fff, v54
    v_pk_sub_u16 v26, v26, s98 clamp
    v_bfi_b32 v54, s79, v26, v54
    v_and_b32 v27, 0x7fff7fff, v55
    v_pk_sub_u16 v27, v27, s98 clamp
    v_bfi_b32 v55, s79, v27, v55
    v_and_b32 v26, 0x7fff7fff, v56
    v_pk_sub_u16 v26, v26, s98 clamp
    v_bfi_b32 v56, s79, v26, v56
    v_and_b32 v27, 0x7fff7fff, v57
    v_pk_sub_u16 v27, v27, s98 clamp
    v_bfi_b32 v57, s79, v27, v57
    v_and_b32 v26, 0x7fff7fff, v58
    v_pk_sub_u16 v26, v26, s98 clamp
    v_bfi_b32 v58, s79, v26, v58
    v_and_b32 v27, 0x7fff7fff, v59
    v_pk_sub_u16 v27, v27, s98 clamp
    v_bfi_b32 v59, s79, v27, v59
    v_and_b32 v26, 0x7fff7fff, v60
    v_pk_sub_u16 v26, v26, s98 clamp
    v_bfi_b32 v60, s79, v26, v60
    v_and_b32 v27, 0x7fff7fff, v61
    v_pk_sub_u16 v27, v27, s98 clamp
    v_bfi_b32 v61, s79, v27, v61
    v_and_b32 v26, 0x7fff7fff, v62
    v_pk_sub_u16 v26, v26, s98 clamp
    v_bfi_b32 v62, s79, v26, v62
    v_and_b32 v27, 0x7fff7fff, v63
    v_pk_sub_u16 v27, v27, s98 clamp
    v_bfi_b32 v63, s79, v27, v63
    v_or3_b32 v24, v24, v48, v49
    v_or3_b32 v24, v24, v50, v51
    v_or3_b32 v24, v24, v52, v53
    v_or3_b32 v24, v24, v54, v55
    v_or3_b32 v24, v24, v56, v57
    v_or3_b32 v24, v24, v58, v59
    v_or3_b32 v24, v24, v60, v61
    v_or3_b32 v24, v24, v62, v63
    v_lshlrev_b32 v36, 11, v60
    v_and_or_b32 v48, v36, s78, v48
    v_accvgpr_write_b32 a96, v48
    v_lshlrev_b32 v37, 11, v61
    v_and_or_b32 v49, v37, s78, v49
    v_accvgpr_write_b32 a97, v49
    v_lshlrev_b32 v36, 11, v62
    v_and_or_b32 v50, v36, s78, v50
    v_accvgpr_write_b32 a98, v50
    v_lshlrev_b32 v37, 11, v63
    v_and_or_b32 v51, v37, s78, v51
    v_accvgpr_write_b32 a99, v51
    v_lshlrev_b32 v36, 7, v60
    v_and_or_b32 v52, v36, s78, v52
    v_accvgpr_write_b32 a100, v52
    v_lshlrev_b32 v37, 7, v61
    v_and_or_b32 v53, v37, s78, v53
    v_accvgpr_write_b32 a101, v53
    v_lshlrev_b32 v36, 7, v62
    v_and_or_b32 v54, v36, s78, v54
    v_accvgpr_write_b32 a102, v54
    v_lshlrev_b32 v37, 7, v63
    v_and_or_b32 v55, v37, s78, v55
    v_accvgpr_write_b32 a103, v55
    v_lshlrev_b32 v36, 3, v60
    v_and_or_b32 v56, v36, s78, v56
    v_lshrrev_b32 v37, 1, v60
    v_and_or_b32 v56, v37, s78, v56
    v_accvgpr_write_b32 a104, v56
    v_lshlrev_b32 v36, 3, v61
    v_and_or_b32 v57, v36, s78, v57
    v_lshrrev_b32 v37, 1, v61
    v_and_or_b32 v57, v37, s78, v57
    v_accvgpr_write_b32 a105, v57
    v_lshlrev_b32 v36, 3, v62
    v_and_or_b32 v58, v36, s78, v58
    v_lshrrev_b32 v37, 1, v62
    v_and_or_b32 v58, v37, s78, v58
    v_accvgpr_write_b32 a106, v58
    v_lshlrev_b32 v36, 3, v63
    v_and_or_b32 v59, v36, s78, v59
    v_lshrrev_b32 v37, 1, v63
    v_and_or_b32 v59, v37, s78, v59
    v_accvgpr_write_b32 a107, v59
    v_and_b32 v24, s78, v24
    v_cmp_ne_u32 vcc, 0, v24
    s_cmp_lg_u64 vcc, 0
    s_cselect_b32 s60, 16, 0
    s_or_b32 s99, s99, s60
    s_waitcnt vmcnt(20)
    ds_read_b128 v[48:51], v9 offset:4096
    ds_read_b128 v[52:55], v10 offset:4096
    ds_read_b128 v[56:59], v11 offset:4096
    ds_read_b128 v[60:63], v12 offset:4096
    s_waitcnt vmcnt(16)
    v_accvgpr_read_b32 v64, a16
    v_accvgpr_read_b32 v65, a17
    v_accvgpr_read_b32 v66, a18
    v_accvgpr_read_b32 v67, a19
    v_accvgpr_read_b32 v68, a20
    v_accvgpr_read_b32 v69, a21
    v_accvgpr_read_b32 v70, a22
    v_accvgpr_read_b32 v71, a23
    v_accvgpr_read_b32 v72, a24
    v_accvgpr_read_b32 v73, a25
    v_accvgpr_read_b32 v74, a26
    v_accvgpr_read_b32 v75, a27
    v_accvgpr_read_b32 v76, a28
    v_accvgpr_read_b32 v77, a29
    v_accvgpr_read_b32 v78, a30
    v_accvgpr_read_b32 v79, a31
    s_waitcnt lgkmcnt(0)
    s_add_u32 s54, s52, 524288
    s_add_u32 m0, s59, 4096
    s_nop 0
    buffer_load_dwordx4 v4, s[4:7], s54 offen offset:0 nt lds
    buffer_load_dwordx4 v5, s[4:7], s54 offen offset:1024 nt lds
    buffer_load_dwordx4 v6, s[4:7], s54 offen offset:2048 nt lds
    buffer_load_dwordx4 v7, s[4:7], s54 offen offset:3072 nt lds
    buffer_load_dwordx4 a[16:19], v8, s[8:11], s54 offen offset:0 nt
    buffer_load_dwordx4 a[20:23], v8, s[8:11], s54 offen offset:256 nt
    buffer_load_dwordx4 a[24:27], v8, s[8:11], s54 offen offset:512 nt
    buffer_load_dwordx4 a[28:31], v8, s[8:11], s54 offen offset:768 nt
    v_and_b32 v25, 0x7fff7fff, v64
    v_pk_sub_u16 v25, v25, 1 op_sel_hi:[1,0]
    v_and_b32 v37, 0x7fff7fff, v65
    v_pk_sub_u16 v37, v37, 1 op_sel_hi:[1,0]
    v_pk_min_u16 v25, v25, v37
    v_and_b32 v36, 0x7fff7fff, v66
    v_pk_sub_u16 v36, v36, 1 op_sel_hi:[1,0]
    v_pk_min_u16 v25, v25, v36
    v_and_b32 v37, 0x7fff7fff, v67
    v_pk_sub_u16 v37, v37, 1 op_sel_hi:[1,0]
    v_pk_min_u16 v25, v25, v37
    v_and_b32 v36, 0x7fff7fff, v68
    v_pk_sub_u16 v36, v36, 1 op_sel_hi:[1,0]
    v_pk_min_u16 v25, v25, v36
    v_and_b32 v37, 0x7fff7fff, v69
    v_pk_sub_u16 v37, v37, 1 op_sel_hi:[1,0]
    v_pk_min_u16 v25, v25, v37
    v_and_b32 v36, 0x7fff7fff, v70
    v_pk_sub_u16 v36, v36, 1 op_sel_hi:[1,0]
    v_pk_min_u16 v25, v25, v36
    v_and_b32 v37, 0x7fff7fff, v71
    v_pk_sub_u16 v37, v37, 1 op_sel_hi:[1,0]
    v_pk_min_u16 v25, v25, v37
    v_and_b32 v36, 0x7fff7fff, v72
    v_pk_sub_u16 v36, v36, 1 op_sel_hi:[1,0]
    v_pk_min_u16 v25, v25, v36
    v_and_b32 v37, 0x7fff7fff, v73
    v_pk_sub_u16 v37, v37, 1 op_sel_hi:[1,0]
    v_pk_min_u16 v25, v25, v37
    v_and_b32 v36, 0x7fff7fff, v74
    v_pk_sub_u16 v36, v36, 1 op_sel_hi:[1,0]
    v_pk_min_u16 v25, v25, v36
    v_and_b32 v37, 0x7fff7fff, v75
    v_pk_sub_u16 v37, v37, 1 op_sel_hi:[1,0]
    v_pk_min_u16 v25, v25, v37
    v_and_b32 v36, 0x7fff7fff, v76
    v_pk_sub_u16 v36, v36, 1 op_sel_hi:[1,0]
    v_pk_min_u16 v25, v25, v36
    v_and_b32 v37, 0x7fff7fff, v77
    v_pk_sub_u16 v37, v37, 1 op_sel_hi:[1,0]
    v_pk_min_u16 v25, v25, v37
    v_and_b32 v36, 0x7fff7fff, v78
    v_pk_sub_u16 v36, v36, 1 op_sel_hi:[1,0]
    v_pk_min_u16 v25, v25, v36
    v_and_b32 v37, 0x7fff7fff, v79
    v_pk_sub_u16 v37, v37, 1 op_sel_hi:[1,0]
    v_pk_min_u16 v25, v25, v37
    v_mov_b32 v36, 0x397f397f
    v_pk_sub_u16 v36, v36, v25 clamp
    v_cmp_ne_u32 vcc, 0, v36
    s_or_b32 s62, 37, 0
    s_getpc_b64 s[92:93]
    s_cbranch_vccnz REC_V
    v_and_b32 v26, 0x7fff7fff, v64
    v_pk_sub_u16 v26, v26, s94 clamp
    v_bfi_b32 v64, s79, v26, v64
    v_and_b32 v27, 0x7fff7fff, v65
    v_pk_sub_u16 v27, v27, s94 clamp
    v_bfi_b32 v65, s79, v27, v65
    v_and_b32 v26, 0x7fff7fff, v66
    v_pk_sub_u16 v26, v26, s94 clamp
    v_bfi_b32 v66, s79, v26, v66
    v_and_b32 v27, 0x7fff7fff, v67
    v_pk_sub_u16 v27, v27, s94 clamp
    v_bfi_b32 v67, s79, v27, v67
    v_and_b32 v26, 0x7fff7fff, v68
    v_pk_sub_u16 v26, v26, s94 clamp
    v_bfi_b32 v68, s79, v26, v68
    v_and_b32 v27, 0x7fff7fff, v69
    v_pk_sub_u16 v27, v27, s94 clamp
    v_bfi_b32 v69, s79, v27, v69
    v_and_b32 v26, 0x7fff7fff, v70
    v_pk_sub_u16 v26, v26, s94 clamp
    v_bfi_b32 v70, s79, v26, v70
    v_and_b32 v27, 0x7fff7fff, v71
    v_pk_sub_u16 v27, v27, s94 clamp
    v_bfi_b32 v71, s79, v27, v71
    v_and_b32 v26, 0x7fff7fff, v72
    v_pk_sub_u16 v26, v26, s94 clamp
    v_bfi_b32 v72, s79, v26, v72
    v_and_b32 v27, 0x7fff7fff, v73
    v_pk_sub_u16 v27, v27, s94 clamp
    v_bfi_b32 v73, s79, v27, v73
    v_and_b32 v26, 0x7fff7fff, v74
    v_pk_sub_u16 v26, v26, s94 clamp
    v_bfi_b32 v74, s79, v26, v74
    v_and_b32 v27, 0x7fff7fff, v75
    v_pk_sub_u16 v27, v27, s94 clamp
    v_bfi_b32 v75, s79, v27, v75
    v_and_b32 v26, 0x7fff7fff, v76
    v_pk_sub_u16 v26, v26, s94 clamp
    v_bfi_b32 v76, s79, v26, v76
    v_and_b32 v27, 0x7fff7fff, v77
    v_pk_sub_u16 v27, v27, s94 clamp
    v_bfi_b32 v77, s79, v27, v77
    v_and_b32 v26, 0x7fff7fff, v78
    v_pk_sub_u16 v26, v26, s94 clamp
    v_bfi_b32 v78, s79, v26, v78
    v_and_b32 v27, 0x7fff7fff, v79
    v_pk_sub_u16 v27, v27, s94 clamp
    v_bfi_b32 v79, s79, v27, v79
    v_or_b32 v24, v64, v65
    v_or3_b32 v24, v24, v66, v67
    v_or3_b32 v24, v24, v68, v69
    v_or3_b32 v24, v24, v70, v71
    v_or3_b32 v24, v24, v72, v73
    v_or3_b32 v24, v24, v74, v75
    v_or3_b32 v24, v24, v76, v77
    v_or3_b32 v24, v24, v78, v79
    v_lshlrev_b32 v36, 11, v76
    v_and_or_b32 v140, v36, s78, v64
    v_lshlrev_b32 v37, 11, v77
    v_and_or_b32 v141, v37, s78, v65
    v_lshlrev_b32 v36, 11, v78
    v_and_or_b32 v142, v36, s78, v66
    v_lshlrev_b32 v37, 11, v79
    v_and_or_b32 v143, v37, s78, v67
    v_lshlrev_b32 v36, 7, v76
    v_and_or_b32 v144, v36, s78, v68
    v_lshlrev_b32 v37, 7, v77
    v_and_or_b32 v145, v37, s78, v69
    v_lshlrev_b32 v36, 7, v78
    v_and_or_b32 v146, v36, s78, v70
    v_lshlrev_b32 v37, 7, v79
    v_and_or_b32 v147, v37, s78, v71
    v_lshlrev_b32 v36, 3, v76
    v_and_or_b32 v72, v36, s78, v72
    v_lshrrev_b32 v37, 1, v76
    v_and_or_b32 v148, v37, s78, v72
    v_lshlrev_b32 v36, 3, v77
    v_and_or_b32 v73, v36, s78, v73
    v_lshrrev_b32 v37, 1, v77
    v_and_or_b32 v149, v37, s78, v73
    v_lshlrev_b32 v36, 3, v78
    v_and_or_b32 v74, v36, s78, v74
    v_lshrrev_b32 v37, 1, v78
    v_and_or_b32 v150, v37, s78, v74
    v_lshlrev_b32 v36, 3, v79
    v_and_or_b32 v75, v36, s78, v75
    v_lshrrev_b32 v37, 1, v79
    v_and_or_b32 v151, v37, s78, v75
    v_and_b32 v25, 0x7fff7fff, v48
    v_pk_sub_u16 v25, v25, 1 op_sel_hi:[1,0]
    v_and_b32 v37, 0x7fff7fff, v49
    v_pk_sub_u16 v37, v37, 1 op_sel_hi:[1,0]
    v_pk_min_u16 v25, v25, v37
    v_and_b32 v36, 0x7fff7fff, v50
    v_pk_sub_u16 v36, v36, 1 op_sel_hi:[1,0]
    v_pk_min_u16 v25, v25, v36
    v_and_b32 v37, 0x7fff7fff, v51
    v_pk_sub_u16 v37, v37, 1 op_sel_hi:[1,0]
    v_pk_min_u16 v25, v25, v37
    v_and_b32 v36, 0x7fff7fff, v52
    v_pk_sub_u16 v36, v36, 1 op_sel_hi:[1,0]
    v_pk_min_u16 v25, v25, v36
    v_and_b32 v37, 0x7fff7fff, v53
    v_pk_sub_u16 v37, v37, 1 op_sel_hi:[1,0]
    v_pk_min_u16 v25, v25, v37
    v_and_b32 v36, 0x7fff7fff, v54
    v_pk_sub_u16 v36, v36, 1 op_sel_hi:[1,0]
    v_pk_min_u16 v25, v25, v36
    v_and_b32 v37, 0x7fff7fff, v55
    v_pk_sub_u16 v37, v37, 1 op_sel_hi:[1,0]
    v_pk_min_u16 v25, v25, v37
    v_and_b32 v36, 0x7fff7fff, v56
    v_pk_sub_u16 v36, v36, 1 op_sel_hi:[1,0]
    v_pk_min_u16 v25, v25, v36
    v_and_b32 v37, 0x7fff7fff, v57
    v_pk_sub_u16 v37, v37, 1 op_sel_hi:[1,0]
    v_pk_min_u16 v25, v25, v37
    v_and_b32 v36, 0x7fff7fff, v58
    v_pk_sub_u16 v36, v36, 1 op_sel_hi:[1,0]
    v_pk_min_u16 v25, v25, v36
    v_and_b32 v37, 0x7fff7fff, v59
    v_pk_sub_u16 v37, v37, 1 op_sel_hi:[1,0]
    v_pk_min_u16 v25, v25, v37
    v_and_b32 v36, 0x7fff7fff, v60
    v_pk_sub_u16 v36, v36, 1 op_sel_hi:[1,0]
    v_pk_min_u16 v25, v25, v36
    v_and_b32 v37, 0x7fff7fff, v61
    v_pk_sub_u16 v37, v37, 1 op_sel_hi:[1,0]
    v_pk_min_u16 v25, v25, v37
    v_and_b32 v36, 0x7fff7fff, v62
    v_pk_sub_u16 v36, v36, 1 op_sel_hi:[1,0]
    v_pk_min_u16 v25, v25, v36
    v_and_b32 v37, 0x7fff7fff, v63
    v_pk_sub_u16 v37, v37, 1 op_sel_hi:[1,0]
    v_pk_min_u16 v25, v25, v37
    v_mov_b32 v36, 0x38ff38ff
    v_pk_sub_u16 v36, v36, v25 clamp
    v_cmp_ne_u32 vcc, 0, v36
    s_or_b32 s62, 5, 0
    s_getpc_b64 s[92:93]
    s_cbranch_vccnz REC_K
    v_and_b32 v26, 0x7fff7fff, v48
    v_pk_sub_u16 v26, v26, s98 clamp
    v_bfi_b32 v48, s79, v26, v48
    v_and_b32 v27, 0x7fff7fff, v49
    v_pk_sub_u16 v27, v27, s98 clamp
    v_bfi_b32 v49, s79, v27, v49
    v_and_b32 v26, 0x7fff7fff, v50
    v_pk_sub_u16 v26, v26, s98 clamp
    v_bfi_b32 v50, s79, v26, v50
    v_and_b32 v27, 0x7fff7fff, v51
    v_pk_sub_u16 v27, v27, s98 clamp
    v_bfi_b32 v51, s79, v27, v51
    v_and_b32 v26, 0x7fff7fff, v52
    v_pk_sub_u16 v26, v26, s98 clamp
    v_bfi_b32 v52, s79, v26, v52
    v_and_b32 v27, 0x7fff7fff, v53
    v_pk_sub_u16 v27, v27, s98 clamp
    v_bfi_b32 v53, s79, v27, v53
    v_and_b32 v26, 0x7fff7fff, v54
    v_pk_sub_u16 v26, v26, s98 clamp
    v_bfi_b32 v54, s79, v26, v54
    v_and_b32 v27, 0x7fff7fff, v55
    v_pk_sub_u16 v27, v27, s98 clamp
    v_bfi_b32 v55, s79, v27, v55
    v_and_b32 v26, 0x7fff7fff, v56
    v_pk_sub_u16 v26, v26, s98 clamp
    v_bfi_b32 v56, s79, v26, v56
    v_and_b32 v27, 0x7fff7fff, v57
    v_pk_sub_u16 v27, v27, s98 clamp
    v_bfi_b32 v57, s79, v27, v57
    v_and_b32 v26, 0x7fff7fff, v58
    v_pk_sub_u16 v26, v26, s98 clamp
    v_bfi_b32 v58, s79, v26, v58
    v_and_b32 v27, 0x7fff7fff, v59
    v_pk_sub_u16 v27, v27, s98 clamp
    v_bfi_b32 v59, s79, v27, v59
    v_and_b32 v26, 0x7fff7fff, v60
    v_pk_sub_u16 v26, v26, s98 clamp
    v_bfi_b32 v60, s79, v26, v60
    v_and_b32 v27, 0x7fff7fff, v61
    v_pk_sub_u16 v27, v27, s98 clamp
    v_bfi_b32 v61, s79, v27, v61
    v_and_b32 v26, 0x7fff7fff, v62
    v_pk_sub_u16 v26, v26, s98 clamp
    v_bfi_b32 v62, s79, v26, v62
    v_and_b32 v27, 0x7fff7fff, v63
    v_pk_sub_u16 v27, v27, s98 clamp
    v_bfi_b32 v63, s79, v27, v63
    v_or3_b32 v24, v24, v48, v49
    v_or3_b32 v24, v24, v50, v51
    v_or3_b32 v24, v24, v52, v53
    v_or3_b32 v24, v24, v54, v55
    v_or3_b32 v24, v24, v56, v57
    v_or3_b32 v24, v24, v58, v59
    v_or3_b32 v24, v24, v60, v61
    v_or3_b32 v24, v24, v62, v63
    v_lshlrev_b32 v36, 11, v60
    v_and_or_b32 v48, v36, s78, v48
    v_accvgpr_write_b32 a108, v48
    v_lshlrev_b32 v37, 11, v61
    v_and_or_b32 v49, v37, s78, v49
    v_accvgpr_write_b32 a109, v49
    v_lshlrev_b32 v36, 11, v62
    v_and_or_b32 v50, v36, s78, v50
    v_accvgpr_write_b32 a110, v50
    v_lshlrev_b32 v37, 11, v63
    v_and_or_b32 v51, v37, s78, v51
    v_accvgpr_write_b32 a111, v51
    v_lshlrev_b32 v36, 7, v60
    v_and_or_b32 v52, v36, s78, v52
    v_accvgpr_write_b32 a112, v52
    v_lshlrev_b32 v37, 7, v61
    v_and_or_b32 v53, v37, s78, v53
    v_accvgpr_write_b32 a113, v53
    v_lshlrev_b32 v36, 7, v62
    v_and_or_b32 v54, v36, s78, v54
    v_accvgpr_write_b32 a114, v54
    v_lshlrev_b32 v37, 7, v63
    v_and_or_b32 v55, v37, s78, v55
    v_accvgpr_write_b32 a115, v55
    v_lshlrev_b32 v36, 3, v60
    v_and_or_b32 v56, v36, s78, v56
    v_lshrrev_b32 v37, 1, v60
    v_and_or_b32 v56, v37, s78, v56
    v_accvgpr_write_b32 a116, v56
    v_lshlrev_b32 v36, 3, v61
    v_and_or_b32 v57, v36, s78, v57
    v_lshrrev_b32 v37, 1, v61
    v_and_or_b32 v57, v37, s78, v57
    v_accvgpr_write_b32 a117, v57
    v_lshlrev_b32 v36, 3, v62
    v_and_or_b32 v58, v36, s78, v58
    v_lshrrev_b32 v37, 1, v62
    v_and_or_b32 v58, v37, s78, v58
    v_accvgpr_write_b32 a118, v58
    v_lshlrev_b32 v36, 3, v63
    v_and_or_b32 v59, v36, s78, v59
    v_lshrrev_b32 v37, 1, v63
    v_and_or_b32 v59, v37, s78, v59
    v_accvgpr_write_b32 a119, v59
    v_and_b32 v24, s78, v24
    v_cmp_ne_u32 vcc, 0, v24
    s_cmp_lg_u64 vcc, 0
    s_cselect_b32 s60, 32, 0
    s_or_b32 s99, s99, s60
    s_waitcnt vmcnt(20)
    ds_read_b128 v[48:51], v9 offset:32768
    ds_read_b128 v[52:55], v10 offset:32768
    ds_read_b128 v[56:59], v11 offset:32768
    ds_read_b128 v[60:63], v12 offset:32768
    s_waitcnt vmcnt(16)
    v_accvgpr_read_b32 v64, a232
    v_accvgpr_read_b32 v65, a233
    v_accvgpr_read_b32 v66, a234
    v_accvgpr_read_b32 v67, a235
    v_accvgpr_read_b32 v68, a236
    v_accvgpr_read_b32 v69, a237
    v_accvgpr_read_b32 v70, a238
    v_accvgpr_read_b32 v71, a239
    v_accvgpr_read_b32 v72, a240
    v_accvgpr_read_b32 v73, a241
    v_accvgpr_read_b32 v74, a242
    v_accvgpr_read_b32 v75, a243
    v_accvgpr_read_b32 v76, a244
    v_accvgpr_read_b32 v77, a245
    v_accvgpr_read_b32 v78, a246
    v_accvgpr_read_b32 v79, a247
    s_waitcnt lgkmcnt(0)
    s_add_u32 s54, s52, 589824
    s_add_u32 m0, s59, 32768
    s_nop 0
    buffer_load_dwordx4 v4, s[4:7], s54 offen offset:0 nt lds
    buffer_load_dwordx4 v5, s[4:7], s54 offen offset:1024 nt lds
    buffer_load_dwordx4 v6, s[4:7], s54 offen offset:2048 nt lds
    buffer_load_dwordx4 v7, s[4:7], s54 offen offset:3072 nt lds
    buffer_load_dwordx4 a[232:235], v8, s[8:11], s54 offen offset:0 nt
    buffer_load_dwordx4 a[236:239], v8, s[8:11], s54 offen offset:256 nt
    buffer_load_dwordx4 a[240:243], v8, s[8:11], s54 offen offset:512 nt
    buffer_load_dwordx4 a[244:247], v8, s[8:11], s54 offen offset:768 nt
    v_and_b32 v25, 0x7fff7fff, v64
    v_pk_sub_u16 v25, v25, 1 op_sel_hi:[1,0]
    v_and_b32 v37, 0x7fff7fff, v65
    v_pk_sub_u16 v37, v37, 1 op_sel_hi:[1,0]
    v_pk_min_u16 v25, v25, v37
    v_and_b32 v36, 0x7fff7fff, v66
    v_pk_sub_u16 v36, v36, 1 op_sel_hi:[1,0]
    v_pk_min_u16 v25, v25, v36
    v_and_b32 v37, 0x7fff7fff, v67
    v_pk_sub_u16 v37, v37, 1 op_sel_hi:[1,0]
    v_pk_min_u16 v25, v25, v37
    v_and_b32 v36, 0x7fff7fff, v68
    v_pk_sub_u16 v36, v36, 1 op_sel_hi:[1,0]
    v_pk_min_u16 v25, v25, v36
    v_and_b32 v37, 0x7fff7fff, v69
    v_pk_sub_u16 v37, v37, 1 op_sel_hi:[1,0]
    v_pk_min_u16 v25, v25, v37
    v_and_b32 v36, 0x7fff7fff, v70
    v_pk_sub_u16 v36, v36, 1 op_sel_hi:[1,0]
    v_pk_min_u16 v25, v25, v36
    v_and_b32 v37, 0x7fff7fff, v71
    v_pk_sub_u16 v37, v37, 1 op_sel_hi:[1,0]
    v_pk_min_u16 v25, v25, v37
    v_and_b32 v36, 0x7fff7fff, v72
    v_pk_sub_u16 v36, v36, 1 op_sel_hi:[1,0]
    v_pk_min_u16 v25, v25, v36
    v_and_b32 v37, 0x7fff7fff, v73
    v_pk_sub_u16 v37, v37, 1 op_sel_hi:[1,0]
    v_pk_min_u16 v25, v25, v37
    v_and_b32 v36, 0x7fff7fff, v74
    v_pk_sub_u16 v36, v36, 1 op_sel_hi:[1,0]
    v_pk_min_u16 v25, v25, v36
    v_and_b32 v37, 0x7fff7fff, v75
    v_pk_sub_u16 v37, v37, 1 op_sel_hi:[1,0]
    v_pk_min_u16 v25, v25, v37
    v_and_b32 v36, 0x7fff7fff, v76
    v_pk_sub_u16 v36, v36, 1 op_sel_hi:[1,0]
    v_pk_min_u16 v25, v25, v36
    v_and_b32 v37, 0x7fff7fff, v77
    v_pk_sub_u16 v37, v37, 1 op_sel_hi:[1,0]
    v_pk_min_u16 v25, v25, v37
    v_and_b32 v36, 0x7fff7fff, v78
    v_pk_sub_u16 v36, v36, 1 op_sel_hi:[1,0]
    v_pk_min_u16 v25, v25, v36
    v_and_b32 v37, 0x7fff7fff, v79
    v_pk_sub_u16 v37, v37, 1 op_sel_hi:[1,0]
    v_pk_min_u16 v25, v25, v37
    v_mov_b32 v36, 0x397f397f
    v_pk_sub_u16 v36, v36, v25 clamp
    v_cmp_ne_u32 vcc, 0, v36
    s_or_b32 s62, 38, 0
    s_getpc_b64 s[92:93]
    s_cbranch_vccnz REC_V
    v_and_b32 v26, 0x7fff7fff, v64
    v_pk_sub_u16 v26, v26, s94 clamp
    v_bfi_b32 v64, s79, v26, v64
    v_and_b32 v27, 0x7fff7fff, v65
    v_pk_sub_u16 v27, v27, s94 clamp
    v_bfi_b32 v65, s79, v27, v65
    v_and_b32 v26, 0x7fff7fff, v66
    v_pk_sub_u16 v26, v26, s94 clamp
    v_bfi_b32 v66, s79, v26, v66
    v_and_b32 v27, 0x7fff7fff, v67
    v_pk_sub_u16 v27, v27, s94 clamp
    v_bfi_b32 v67, s79, v27, v67
    v_and_b32 v26, 0x7fff7fff, v68
    v_pk_sub_u16 v26, v26, s94 clamp
    v_bfi_b32 v68, s79, v26, v68
    v_and_b32 v27, 0x7fff7fff, v69
    v_pk_sub_u16 v27, v27, s94 clamp
    v_bfi_b32 v69, s79, v27, v69
    v_and_b32 v26, 0x7fff7fff, v70
    v_pk_sub_u16 v26, v26, s94 clamp
    v_bfi_b32 v70, s79, v26, v70
    v_and_b32 v27, 0x7fff7fff, v71
    v_pk_sub_u16 v27, v27, s94 clamp
    v_bfi_b32 v71, s79, v27, v71
    v_and_b32 v26, 0x7fff7fff, v72
    v_pk_sub_u16 v26, v26, s94 clamp
    v_bfi_b32 v72, s79, v26, v72
    v_and_b32 v27, 0x7fff7fff, v73
    v_pk_sub_u16 v27, v27, s94 clamp
    v_bfi_b32 v73, s79, v27, v73
    v_and_b32 v26, 0x7fff7fff, v74
    v_pk_sub_u16 v26, v26, s94 clamp
    v_bfi_b32 v74, s79, v26, v74
    v_and_b32 v27, 0x7fff7fff, v75
    v_pk_sub_u16 v27, v27, s94 clamp
    v_bfi_b32 v75, s79, v27, v75
    v_and_b32 v26, 0x7fff7fff, v76
    v_pk_sub_u16 v26, v26, s94 clamp
    v_bfi_b32 v76, s79, v26, v76
    v_and_b32 v27, 0x7fff7fff, v77
    v_pk_sub_u16 v27, v27, s94 clamp
    v_bfi_b32 v77, s79, v27, v77
    v_and_b32 v26, 0x7fff7fff, v78
    v_pk_sub_u16 v26, v26, s94 clamp
    v_bfi_b32 v78, s79, v26, v78
    v_and_b32 v27, 0x7fff7fff, v79
    v_pk_sub_u16 v27, v27, s94 clamp
    v_bfi_b32 v79, s79, v27, v79
    v_or_b32 v24, v64, v65
    v_or3_b32 v24, v24, v66, v67
    v_or3_b32 v24, v24, v68, v69
    v_or3_b32 v24, v24, v70, v71
    v_or3_b32 v24, v24, v72, v73
    v_or3_b32 v24, v24, v74, v75
    v_or3_b32 v24, v24, v76, v77
    v_or3_b32 v24, v24, v78, v79
    v_lshlrev_b32 v36, 11, v76
    v_and_or_b32 v152, v36, s78, v64
    v_lshlrev_b32 v37, 11, v77
    v_and_or_b32 v153, v37, s78, v65
    v_lshlrev_b32 v36, 11, v78
    v_and_or_b32 v154, v36, s78, v66
    v_lshlrev_b32 v37, 11, v79
    v_and_or_b32 v155, v37, s78, v67
    v_lshlrev_b32 v36, 7, v76
    v_and_or_b32 v156, v36, s78, v68
    v_lshlrev_b32 v37, 7, v77
    v_and_or_b32 v157, v37, s78, v69
    v_lshlrev_b32 v36, 7, v78
    v_and_or_b32 v158, v36, s78, v70
    v_lshlrev_b32 v37, 7, v79
    v_and_or_b32 v159, v37, s78, v71
    v_lshlrev_b32 v36, 3, v76
    v_and_or_b32 v72, v36, s78, v72
    v_lshrrev_b32 v37, 1, v76
    v_and_or_b32 v160, v37, s78, v72
    v_lshlrev_b32 v36, 3, v77
    v_and_or_b32 v73, v36, s78, v73
    v_lshrrev_b32 v37, 1, v77
    v_and_or_b32 v161, v37, s78, v73
    v_lshlrev_b32 v36, 3, v78
    v_and_or_b32 v74, v36, s78, v74
    v_lshrrev_b32 v37, 1, v78
    v_and_or_b32 v162, v37, s78, v74
    v_lshlrev_b32 v36, 3, v79
    v_and_or_b32 v75, v36, s78, v75
    v_lshrrev_b32 v37, 1, v79
    v_and_or_b32 v163, v37, s78, v75
    v_and_b32 v25, 0x7fff7fff, v48
    v_pk_sub_u16 v25, v25, 1 op_sel_hi:[1,0]
    v_and_b32 v37, 0x7fff7fff, v49
    v_pk_sub_u16 v37, v37, 1 op_sel_hi:[1,0]
    v_pk_min_u16 v25, v25, v37
    v_and_b32 v36, 0x7fff7fff, v50
    v_pk_sub_u16 v36, v36, 1 op_sel_hi:[1,0]
    v_pk_min_u16 v25, v25, v36
    v_and_b32 v37, 0x7fff7fff, v51
    v_pk_sub_u16 v37, v37, 1 op_sel_hi:[1,0]
    v_pk_min_u16 v25, v25, v37
    v_and_b32 v36, 0x7fff7fff, v52
    v_pk_sub_u16 v36, v36, 1 op_sel_hi:[1,0]
    v_pk_min_u16 v25, v25, v36
    v_and_b32 v37, 0x7fff7fff, v53
    v_pk_sub_u16 v37, v37, 1 op_sel_hi:[1,0]
    v_pk_min_u16 v25, v25, v37
    v_and_b32 v36, 0x7fff7fff, v54
    v_pk_sub_u16 v36, v36, 1 op_sel_hi:[1,0]
    v_pk_min_u16 v25, v25, v36
    v_and_b32 v37, 0x7fff7fff, v55
    v_pk_sub_u16 v37, v37, 1 op_sel_hi:[1,0]
    v_pk_min_u16 v25, v25, v37
    v_and_b32 v36, 0x7fff7fff, v56
    v_pk_sub_u16 v36, v36, 1 op_sel_hi:[1,0]
    v_pk_min_u16 v25, v25, v36
    v_and_b32 v37, 0x7fff7fff, v57
    v_pk_sub_u16 v37, v37, 1 op_sel_hi:[1,0]
    v_pk_min_u16 v25, v25, v37
    v_and_b32 v36, 0x7fff7fff, v58
    v_pk_sub_u16 v36, v36, 1 op_sel_hi:[1,0]
    v_pk_min_u16 v25, v25, v36
    v_and_b32 v37, 0x7fff7fff, v59
    v_pk_sub_u16 v37, v37, 1 op_sel_hi:[1,0]
    v_pk_min_u16 v25, v25, v37
    v_and_b32 v36, 0x7fff7fff, v60
    v_pk_sub_u16 v36, v36, 1 op_sel_hi:[1,0]
    v_pk_min_u16 v25, v25, v36
    v_and_b32 v37, 0x7fff7fff, v61
    v_pk_sub_u16 v37, v37, 1 op_sel_hi:[1,0]
    v_pk_min_u16 v25, v25, v37
    v_and_b32 v36, 0x7fff7fff, v62
    v_pk_sub_u16 v36, v36, 1 op_sel_hi:[1,0]
    v_pk_min_u16 v25, v25, v36
    v_and_b32 v37, 0x7fff7fff, v63
    v_pk_sub_u16 v37, v37, 1 op_sel_hi:[1,0]
    v_pk_min_u16 v25, v25, v37
    v_mov_b32 v36, 0x38ff38ff
    v_pk_sub_u16 v36, v36, v25 clamp
    v_cmp_ne_u32 vcc, 0, v36
    s_or_b32 s62, 6, 0
    s_getpc_b64 s[92:93]
    s_cbranch_vccnz REC_K
    v_and_b32 v26, 0x7fff7fff, v48
    v_pk_sub_u16 v26, v26, s98 clamp
    v_bfi_b32 v48, s79, v26, v48
    v_and_b32 v27, 0x7fff7fff, v49
    v_pk_sub_u16 v27, v27, s98 clamp
    v_bfi_b32 v49, s79, v27, v49
    v_and_b32 v26, 0x7fff7fff, v50
    v_pk_sub_u16 v26, v26, s98 clamp
    v_bfi_b32 v50, s79, v26, v50
    v_and_b32 v27, 0x7fff7fff, v51
    v_pk_sub_u16 v27, v27, s98 clamp
    v_bfi_b32 v51, s79, v27, v51
    v_and_b32 v26, 0x7fff7fff, v52
    v_pk_sub_u16 v26, v26, s98 clamp
    v_bfi_b32 v52, s79, v26, v52
    v_and_b32 v27, 0x7fff7fff, v53
    v_pk_sub_u16 v27, v27, s98 clamp
    v_bfi_b32 v53, s79, v27, v53
    v_and_b32 v26, 0x7fff7fff, v54
    v_pk_sub_u16 v26, v26, s98 clamp
    v_bfi_b32 v54, s79, v26, v54
    v_and_b32 v27, 0x7fff7fff, v55
    v_pk_sub_u16 v27, v27, s98 clamp
    v_bfi_b32 v55, s79, v27, v55
    v_and_b32 v26, 0x7fff7fff, v56
    v_pk_sub_u16 v26, v26, s98 clamp
    v_bfi_b32 v56, s79, v26, v56
    v_and_b32 v27, 0x7fff7fff, v57
    v_pk_sub_u16 v27, v27, s98 clamp
    v_bfi_b32 v57, s79, v27, v57
    v_and_b32 v26, 0x7fff7fff, v58
    v_pk_sub_u16 v26, v26, s98 clamp
    v_bfi_b32 v58, s79, v26, v58
    v_and_b32 v27, 0x7fff7fff, v59
    v_pk_sub_u16 v27, v27, s98 clamp
    v_bfi_b32 v59, s79, v27, v59
    v_and_b32 v26, 0x7fff7fff, v60
    v_pk_sub_u16 v26, v26, s98 clamp
    v_bfi_b32 v60, s79, v26, v60
    v_and_b32 v27, 0x7fff7fff, v61
    v_pk_sub_u16 v27, v27, s98 clamp
    v_bfi_b32 v61, s79, v27, v61
    v_and_b32 v26, 0x7fff7fff, v62
    v_pk_sub_u16 v26, v26, s98 clamp
    v_bfi_b32 v62, s79, v26, v62
    v_and_b32 v27, 0x7fff7fff, v63
    v_pk_sub_u16 v27, v27, s98 clamp
    v_bfi_b32 v63, s79, v27, v63
    v_or3_b32 v24, v24, v48, v49
    v_or3_b32 v24, v24, v50, v51
    v_or3_b32 v24, v24, v52, v53
    v_or3_b32 v24, v24, v54, v55
    v_or3_b32 v24, v24, v56, v57
    v_or3_b32 v24, v24, v58, v59
    v_or3_b32 v24, v24, v60, v61
    v_or3_b32 v24, v24, v62, v63
    v_lshlrev_b32 v36, 11, v60
    v_and_or_b32 v48, v36, s78, v48
    v_accvgpr_write_b32 a120, v48
    v_lshlrev_b32 v37, 11, v61
    v_and_or_b32 v49, v37, s78, v49
    v_accvgpr_write_b32 a121, v49
    v_lshlrev_b32 v36, 11, v62
    v_and_or_b32 v50, v36, s78, v50
    v_accvgpr_write_b32 a122, v50
    v_lshlrev_b32 v37, 11, v63
    v_and_or_b32 v51, v37, s78, v51
    v_accvgpr_write_b32 a123, v51
    v_lshlrev_b32 v36, 7, v60
    v_and_or_b32 v52, v36, s78, v52
    v_accvgpr_write_b32 a124, v52
    v_lshlrev_b32 v37, 7, v61
    v_and_or_b32 v53, v37, s78, v53
    v_accvgpr_write_b32 a125, v53
    v_lshlrev_b32 v36, 7, v62
    v_and_or_b32 v54, v36, s78, v54
    v_accvgpr_write_b32 a126, v54
    v_lshlrev_b32 v37, 7, v63
    v_and_or_b32 v55, v37, s78, v55
    v_accvgpr_write_b32 a127, v55
    v_lshlrev_b32 v36, 3, v60
    v_and_or_b32 v56, v36, s78, v56
    v_lshrrev_b32 v37, 1, v60
    v_and_or_b32 v56, v37, s78, v56
    v_accvgpr_write_b32 a128, v56
    v_lshlrev_b32 v36, 3, v61
    v_and_or_b32 v57, v36, s78, v57
    v_lshrrev_b32 v37, 1, v61
    v_and_or_b32 v57, v37, s78, v57
    v_accvgpr_write_b32 a129, v57
    v_lshlrev_b32 v36, 3, v62
    v_and_or_b32 v58, v36, s78, v58
    v_lshrrev_b32 v37, 1, v62
    v_and_or_b32 v58, v37, s78, v58
    v_accvgpr_write_b32 a130, v58
    v_lshlrev_b32 v36, 3, v63
    v_and_or_b32 v59, v36, s78, v59
    v_lshrrev_b32 v37, 1, v63
    v_and_or_b32 v59, v37, s78, v59
    v_accvgpr_write_b32 a131, v59
    v_and_b32 v24, s78, v24
    v_cmp_ne_u32 vcc, 0, v24
    s_cmp_lg_u64 vcc, 0
    s_cselect_b32 s60, 64, 0
    s_or_b32 s99, s99, s60
    s_waitcnt vmcnt(20)
    ds_read_b128 v[48:51], v9 offset:0
    ds_read_b128 v[52:55], v10 offset:0
    ds_read_b128 v[56:59], v11 offset:0
    ds_read_b128 v[60:63], v12 offset:0
    s_waitcnt vmcnt(16)
    v_accvgpr_read_b32 v64, a0
    v_accvgpr_read_b32 v65, a1
    v_accvgpr_read_b32 v66, a2
    v_accvgpr_read_b32 v67, a3
    v_accvgpr_read_b32 v68, a4
    v_accvgpr_read_b32 v69, a5
    v_accvgpr_read_b32 v70, a6
    v_accvgpr_read_b32 v71, a7
    v_accvgpr_read_b32 v72, a8
    v_accvgpr_read_b32 v73, a9
    v_accvgpr_read_b32 v74, a10
    v_accvgpr_read_b32 v75, a11
    v_accvgpr_read_b32 v76, a12
    v_accvgpr_read_b32 v77, a13
    v_accvgpr_read_b32 v78, a14
    v_accvgpr_read_b32 v79, a15
    s_waitcnt lgkmcnt(0)
    s_add_u32 s54, s52, 655360
    s_add_u32 m0, s59, 0
    s_nop 0
    buffer_load_dwordx4 v4, s[4:7], s54 offen offset:0 nt lds
    buffer_load_dwordx4 v5, s[4:7], s54 offen offset:1024 nt lds
    buffer_load_dwordx4 v6, s[4:7], s54 offen offset:2048 nt lds
    buffer_load_dwordx4 v7, s[4:7], s54 offen offset:3072 nt lds
    buffer_load_dwordx4 a[0:3], v8, s[8:11], s54 offen offset:0 nt
    buffer_load_dwordx4 a[4:7], v8, s[8:11], s54 offen offset:256 nt
    buffer_load_dwordx4 a[8:11], v8, s[8:11], s54 offen offset:512 nt
    buffer_load_dwordx4 a[12:15], v8, s[8:11], s54 offen offset:768 nt
    v_and_b32 v25, 0x7fff7fff, v64
    v_pk_sub_u16 v25, v25, 1 op_sel_hi:[1,0]
    v_and_b32 v37, 0x7fff7fff, v65
    v_pk_sub_u16 v37, v37, 1 op_sel_hi:[1,0]
    v_pk_min_u16 v25, v25, v37
    v_and_b32 v36, 0x7fff7fff, v66
    v_pk_sub_u16 v36, v36, 1 op_sel_hi:[1,0]
    v_pk_min_u16 v25, v25, v36
    v_and_b32 v37, 0x7fff7fff, v67
    v_pk_sub_u16 v37, v37, 1 op_sel_hi:[1,0]
    v_pk_min_u16 v25, v25, v37
    v_and_b32 v36, 0x7fff7fff, v68
    v_pk_sub_u16 v36, v36, 1 op_sel_hi:[1,0]
    v_pk_min_u16 v25, v25, v36
    v_and_b32 v37, 0x7fff7fff, v69
    v_pk_sub_u16 v37, v37, 1 op_sel_hi:[1,0]
    v_pk_min_u16 v25, v25, v37
    v_and_b32 v36, 0x7fff7fff, v70
    v_pk_sub_u16 v36, v36, 1 op_sel_hi:[1,0]
    v_pk_min_u16 v25, v25, v36
    v_and_b32 v37, 0x7fff7fff, v71
    v_pk_sub_u16 v37, v37, 1 op_sel_hi:[1,0]
    v_pk_min_u16 v25, v25, v37
    v_and_b32 v36, 0x7fff7fff, v72
    v_pk_sub_u16 v36, v36, 1 op_sel_hi:[1,0]
    v_pk_min_u16 v25, v25, v36
    v_and_b32 v37, 0x7fff7fff, v73
    v_pk_sub_u16 v37, v37, 1 op_sel_hi:[1,0]
    v_pk_min_u16 v25, v25, v37
    v_and_b32 v36, 0x7fff7fff, v74
    v_pk_sub_u16 v36, v36, 1 op_sel_hi:[1,0]
    v_pk_min_u16 v25, v25, v36
    v_and_b32 v37, 0x7fff7fff, v75
    v_pk_sub_u16 v37, v37, 1 op_sel_hi:[1,0]
    v_pk_min_u16 v25, v25, v37
    v_and_b32 v36, 0x7fff7fff, v76
    v_pk_sub_u16 v36, v36, 1 op_sel_hi:[1,0]
    v_pk_min_u16 v25, v25, v36
    v_and_b32 v37, 0x7fff7fff, v77
    v_pk_sub_u16 v37, v37, 1 op_sel_hi:[1,0]
    v_pk_min_u16 v25, v25, v37
    v_and_b32 v36, 0x7fff7fff, v78
    v_pk_sub_u16 v36, v36, 1 op_sel_hi:[1,0]
    v_pk_min_u16 v25, v25, v36
    v_and_b32 v37, 0x7fff7fff, v79
    v_pk_sub_u16 v37, v37, 1 op_sel_hi:[1,0]
    v_pk_min_u16 v25, v25, v37
    v_mov_b32 v36, 0x397f397f
    v_pk_sub_u16 v36, v36, v25 clamp
    v_cmp_ne_u32 vcc, 0, v36
    s_or_b32 s62, 39, 0
    s_getpc_b64 s[92:93]
    s_cbranch_vccnz REC_V
    v_and_b32 v26, 0x7fff7fff, v64
    v_pk_sub_u16 v26, v26, s94 clamp
    v_bfi_b32 v64, s79, v26, v64
    v_and_b32 v27, 0x7fff7fff, v65
    v_pk_sub_u16 v27, v27, s94 clamp
    v_bfi_b32 v65, s79, v27, v65
    v_and_b32 v26, 0x7fff7fff, v66
    v_pk_sub_u16 v26, v26, s94 clamp
    v_bfi_b32 v66, s79, v26, v66
    v_and_b32 v27, 0x7fff7fff, v67
    v_pk_sub_u16 v27, v27, s94 clamp
    v_bfi_b32 v67, s79, v27, v67
    v_and_b32 v26, 0x7fff7fff, v68
    v_pk_sub_u16 v26, v26, s94 clamp
    v_bfi_b32 v68, s79, v26, v68
    v_and_b32 v27, 0x7fff7fff, v69
    v_pk_sub_u16 v27, v27, s94 clamp
    v_bfi_b32 v69, s79, v27, v69
    v_and_b32 v26, 0x7fff7fff, v70
    v_pk_sub_u16 v26, v26, s94 clamp
    v_bfi_b32 v70, s79, v26, v70
    v_and_b32 v27, 0x7fff7fff, v71
    v_pk_sub_u16 v27, v27, s94 clamp
    v_bfi_b32 v71, s79, v27, v71
    v_and_b32 v26, 0x7fff7fff, v72
    v_pk_sub_u16 v26, v26, s94 clamp
    v_bfi_b32 v72, s79, v26, v72
    v_and_b32 v27, 0x7fff7fff, v73
    v_pk_sub_u16 v27, v27, s94 clamp
    v_bfi_b32 v73, s79, v27, v73
    v_and_b32 v26, 0x7fff7fff, v74
    v_pk_sub_u16 v26, v26, s94 clamp
    v_bfi_b32 v74, s79, v26, v74
    v_and_b32 v27, 0x7fff7fff, v75
    v_pk_sub_u16 v27, v27, s94 clamp
    v_bfi_b32 v75, s79, v27, v75
    v_and_b32 v26, 0x7fff7fff, v76
    v_pk_sub_u16 v26, v26, s94 clamp
    v_bfi_b32 v76, s79, v26, v76
    v_and_b32 v27, 0x7fff7fff, v77
    v_pk_sub_u16 v27, v27, s94 clamp
    v_bfi_b32 v77, s79, v27, v77
    v_and_b32 v26, 0x7fff7fff, v78
    v_pk_sub_u16 v26, v26, s94 clamp
    v_bfi_b32 v78, s79, v26, v78
    v_and_b32 v27, 0x7fff7fff, v79
    v_pk_sub_u16 v27, v27, s94 clamp
    v_bfi_b32 v79, s79, v27, v79
    v_or_b32 v24, v64, v65
    v_or3_b32 v24, v24, v66, v67
    v_or3_b32 v24, v24, v68, v69
    v_or3_b32 v24, v24, v70, v71
    v_or3_b32 v24, v24, v72, v73
    v_or3_b32 v24, v24, v74, v75
    v_or3_b32 v24, v24, v76, v77
    v_or3_b32 v24, v24, v78, v79
    v_lshlrev_b32 v36, 11, v76
    v_and_or_b32 v164, v36, s78, v64
    v_lshlrev_b32 v37, 11, v77
    v_and_or_b32 v165, v37, s78, v65
    v_lshlrev_b32 v36, 11, v78
    v_and_or_b32 v166, v36, s78, v66
    v_lshlrev_b32 v37, 11, v79
    v_and_or_b32 v167, v37, s78, v67
    v_lshlrev_b32 v36, 7, v76
    v_and_or_b32 v168, v36, s78, v68
    v_lshlrev_b32 v37, 7, v77
    v_and_or_b32 v169, v37, s78, v69
    v_lshlrev_b32 v36, 7, v78
    v_and_or_b32 v170, v36, s78, v70
    v_lshlrev_b32 v37, 7, v79
    v_and_or_b32 v171, v37, s78, v71
    v_lshlrev_b32 v36, 3, v76
    v_and_or_b32 v72, v36, s78, v72
    v_lshrrev_b32 v37, 1, v76
    v_and_or_b32 v172, v37, s78, v72
    v_lshlrev_b32 v36, 3, v77
    v_and_or_b32 v73, v36, s78, v73
    v_lshrrev_b32 v37, 1, v77
    v_and_or_b32 v173, v37, s78, v73
    v_lshlrev_b32 v36, 3, v78
    v_and_or_b32 v74, v36, s78, v74
    v_lshrrev_b32 v37, 1, v78
    v_and_or_b32 v174, v37, s78, v74
    v_lshlrev_b32 v36, 3, v79
    v_and_or_b32 v75, v36, s78, v75
    v_lshrrev_b32 v37, 1, v79
    v_and_or_b32 v175, v37, s78, v75
    v_and_b32 v25, 0x7fff7fff, v48
    v_pk_sub_u16 v25, v25, 1 op_sel_hi:[1,0]
    v_and_b32 v37, 0x7fff7fff, v49
    v_pk_sub_u16 v37, v37, 1 op_sel_hi:[1,0]
    v_pk_min_u16 v25, v25, v37
    v_and_b32 v36, 0x7fff7fff, v50
    v_pk_sub_u16 v36, v36, 1 op_sel_hi:[1,0]
    v_pk_min_u16 v25, v25, v36
    v_and_b32 v37, 0x7fff7fff, v51
    v_pk_sub_u16 v37, v37, 1 op_sel_hi:[1,0]
    v_pk_min_u16 v25, v25, v37
    v_and_b32 v36, 0x7fff7fff, v52
    v_pk_sub_u16 v36, v36, 1 op_sel_hi:[1,0]
    v_pk_min_u16 v25, v25, v36
    v_and_b32 v37, 0x7fff7fff, v53
    v_pk_sub_u16 v37, v37, 1 op_sel_hi:[1,0]
    v_pk_min_u16 v25, v25, v37
    v_and_b32 v36, 0x7fff7fff, v54
    v_pk_sub_u16 v36, v36, 1 op_sel_hi:[1,0]
    v_pk_min_u16 v25, v25, v36
    v_and_b32 v37, 0x7fff7fff, v55
    v_pk_sub_u16 v37, v37, 1 op_sel_hi:[1,0]
    v_pk_min_u16 v25, v25, v37
    v_and_b32 v36, 0x7fff7fff, v56
    v_pk_sub_u16 v36, v36, 1 op_sel_hi:[1,0]
    v_pk_min_u16 v25, v25, v36
    v_and_b32 v37, 0x7fff7fff, v57
    v_pk_sub_u16 v37, v37, 1 op_sel_hi:[1,0]
    v_pk_min_u16 v25, v25, v37
    v_and_b32 v36, 0x7fff7fff, v58
    v_pk_sub_u16 v36, v36, 1 op_sel_hi:[1,0]
    v_pk_min_u16 v25, v25, v36
    v_and_b32 v37, 0x7fff7fff, v59
    v_pk_sub_u16 v37, v37, 1 op_sel_hi:[1,0]
    v_pk_min_u16 v25, v25, v37
    v_and_b32 v36, 0x7fff7fff, v60
    v_pk_sub_u16 v36, v36, 1 op_sel_hi:[1,0]
    v_pk_min_u16 v25, v25, v36
    v_and_b32 v37, 0x7fff7fff, v61
    v_pk_sub_u16 v37, v37, 1 op_sel_hi:[1,0]
    v_pk_min_u16 v25, v25, v37
    v_and_b32 v36, 0x7fff7fff, v62
    v_pk_sub_u16 v36, v36, 1 op_sel_hi:[1,0]
    v_pk_min_u16 v25, v25, v36
    v_and_b32 v37, 0x7fff7fff, v63
    v_pk_sub_u16 v37, v37, 1 op_sel_hi:[1,0]
    v_pk_min_u16 v25, v25, v37
    v_mov_b32 v36, 0x38ff38ff
    v_pk_sub_u16 v36, v36, v25 clamp
    v_cmp_ne_u32 vcc, 0, v36
    s_or_b32 s62, 7, 0
    s_getpc_b64 s[92:93]
    s_cbranch_vccnz REC_K
    v_and_b32 v26, 0x7fff7fff, v48
    v_pk_sub_u16 v26, v26, s98 clamp
    v_bfi_b32 v48, s79, v26, v48
    v_and_b32 v27, 0x7fff7fff, v49
    v_pk_sub_u16 v27, v27, s98 clamp
    v_bfi_b32 v49, s79, v27, v49
    v_and_b32 v26, 0x7fff7fff, v50
    v_pk_sub_u16 v26, v26, s98 clamp
    v_bfi_b32 v50, s79, v26, v50
    v_and_b32 v27, 0x7fff7fff, v51
    v_pk_sub_u16 v27, v27, s98 clamp
    v_bfi_b32 v51, s79, v27, v51
    v_and_b32 v26, 0x7fff7fff, v52
    v_pk_sub_u16 v26, v26, s98 clamp
    v_bfi_b32 v52, s79, v26, v52
    v_and_b32 v27, 0x7fff7fff, v53
    v_pk_sub_u16 v27, v27, s98 clamp
    v_bfi_b32 v53, s79, v27, v53
    v_and_b32 v26, 0x7fff7fff, v54
    v_pk_sub_u16 v26, v26, s98 clamp
    v_bfi_b32 v54, s79, v26, v54
    v_and_b32 v27, 0x7fff7fff, v55
    v_pk_sub_u16 v27, v27, s98 clamp
    v_bfi_b32 v55, s79, v27, v55
    v_and_b32 v26, 0x7fff7fff, v56
    v_pk_sub_u16 v26, v26, s98 clamp
    v_bfi_b32 v56, s79, v26, v56
    v_and_b32 v27, 0x7fff7fff, v57
    v_pk_sub_u16 v27, v27, s98 clamp
    v_bfi_b32 v57, s79, v27, v57
    v_and_b32 v26, 0x7fff7fff, v58
    v_pk_sub_u16 v26, v26, s98 clamp
    v_bfi_b32 v58, s79, v26, v58
    v_and_b32 v27, 0x7fff7fff, v59
    v_pk_sub_u16 v27, v27, s98 clamp
    v_bfi_b32 v59, s79, v27, v59
    v_and_b32 v26, 0x7fff7fff, v60
    v_pk_sub_u16 v26, v26, s98 clamp
    v_bfi_b32 v60, s79, v26, v60
    v_and_b32 v27, 0x7fff7fff, v61
    v_pk_sub_u16 v27, v27, s98 clamp
    v_bfi_b32 v61, s79, v27, v61
    v_and_b32 v26, 0x7fff7fff, v62
    v_pk_sub_u16 v26, v26, s98 clamp
    v_bfi_b32 v62, s79, v26, v62
    v_and_b32 v27, 0x7fff7fff, v63
    v_pk_sub_u16 v27, v27, s98 clamp
    v_bfi_b32 v63, s79, v27, v63
    v_or3_b32 v24, v24, v48, v49
    v_or3_b32 v24, v24, v50, v51
    v_or3_b32 v24, v24, v52, v53
    v_or3_b32 v24, v24, v54, v55
    v_or3_b32 v24, v24, v56, v57
    v_or3_b32 v24, v24, v58, v59
    v_or3_b32 v24, v24, v60, v61
    v_or3_b32 v24, v24, v62, v63
    v_lshlrev_b32 v36, 11, v60
    v_and_or_b32 v48, v36, s78, v48
    v_accvgpr_write_b32 a132, v48
    v_lshlrev_b32 v37, 11, v61
    v_and_or_b32 v49, v37, s78, v49
    v_accvgpr_write_b32 a133, v49
    v_lshlrev_b32 v36, 11, v62
    v_and_or_b32 v50, v36, s78, v50
    v_accvgpr_write_b32 a134, v50
    v_lshlrev_b32 v37, 11, v63
    v_and_or_b32 v51, v37, s78, v51
    v_accvgpr_write_b32 a135, v51
    v_lshlrev_b32 v36, 7, v60
    v_and_or_b32 v52, v36, s78, v52
    v_accvgpr_write_b32 a136, v52
    v_lshlrev_b32 v37, 7, v61
    v_and_or_b32 v53, v37, s78, v53
    v_accvgpr_write_b32 a137, v53
    v_lshlrev_b32 v36, 7, v62
    v_and_or_b32 v54, v36, s78, v54
    v_accvgpr_write_b32 a138, v54
    v_lshlrev_b32 v37, 7, v63
    v_and_or_b32 v55, v37, s78, v55
    v_accvgpr_write_b32 a139, v55
    v_lshlrev_b32 v36, 3, v60
    v_and_or_b32 v56, v36, s78, v56
    v_lshrrev_b32 v37, 1, v60
    v_and_or_b32 v56, v37, s78, v56
    v_accvgpr_write_b32 a140, v56
    v_lshlrev_b32 v36, 3, v61
    v_and_or_b32 v57, v36, s78, v57
    v_lshrrev_b32 v37, 1, v61
    v_and_or_b32 v57, v37, s78, v57
    v_accvgpr_write_b32 a141, v57
    v_lshlrev_b32 v36, 3, v62
    v_and_or_b32 v58, v36, s78, v58
    v_lshrrev_b32 v37, 1, v62
    v_and_or_b32 v58, v37, s78, v58
    v_accvgpr_write_b32 a142, v58
    v_lshlrev_b32 v36, 3, v63
    v_and_or_b32 v59, v36, s78, v59
    v_lshrrev_b32 v37, 1, v63
    v_and_or_b32 v59, v37, s78, v59
    v_accvgpr_write_b32 a143, v59
    v_and_b32 v24, s78, v24
    v_cmp_ne_u32 vcc, 0, v24
    s_cmp_lg_u64 vcc, 0
    s_cselect_b32 s60, 128, 0
    s_or_b32 s99, s99, s60
    s_waitcnt vmcnt(20)
    ds_read_b128 v[48:51], v9 offset:4096
    ds_read_b128 v[52:55], v10 offset:4096
    ds_read_b128 v[56:59], v11 offset:4096
    ds_read_b128 v[60:63], v12 offset:4096
    s_waitcnt vmcnt(16)
    v_accvgpr_read_b32 v64, a16
    v_accvgpr_read_b32 v65, a17
    v_accvgpr_read_b32 v66, a18
    v_accvgpr_read_b32 v67, a19
    v_accvgpr_read_b32 v68, a20
    v_accvgpr_read_b32 v69, a21
    v_accvgpr_read_b32 v70, a22
    v_accvgpr_read_b32 v71, a23
    v_accvgpr_read_b32 v72, a24
    v_accvgpr_read_b32 v73, a25
    v_accvgpr_read_b32 v74, a26
    v_accvgpr_read_b32 v75, a27
    v_accvgpr_read_b32 v76, a28
    v_accvgpr_read_b32 v77, a29
    v_accvgpr_read_b32 v78, a30
    v_accvgpr_read_b32 v79, a31
    s_waitcnt lgkmcnt(0)
    s_add_u32 s54, s52, 720896
    s_add_u32 m0, s59, 4096
    s_nop 0
    buffer_load_dwordx4 v4, s[4:7], s54 offen offset:0 nt lds
    buffer_load_dwordx4 v5, s[4:7], s54 offen offset:1024 nt lds
    buffer_load_dwordx4 v6, s[4:7], s54 offen offset:2048 nt lds
    buffer_load_dwordx4 v7, s[4:7], s54 offen offset:3072 nt lds
    buffer_load_dwordx4 a[16:19], v8, s[8:11], s54 offen offset:0 nt
    buffer_load_dwordx4 a[20:23], v8, s[8:11], s54 offen offset:256 nt
    buffer_load_dwordx4 a[24:27], v8, s[8:11], s54 offen offset:512 nt
    buffer_load_dwordx4 a[28:31], v8, s[8:11], s54 offen offset:768 nt
    v_and_b32 v25, 0x7fff7fff, v64
    v_pk_sub_u16 v25, v25, 1 op_sel_hi:[1,0]
    v_and_b32 v37, 0x7fff7fff, v65
    v_pk_sub_u16 v37, v37, 1 op_sel_hi:[1,0]
    v_pk_min_u16 v25, v25, v37
    v_and_b32 v36, 0x7fff7fff, v66
    v_pk_sub_u16 v36, v36, 1 op_sel_hi:[1,0]
    v_pk_min_u16 v25, v25, v36
    v_and_b32 v37, 0x7fff7fff, v67
    v_pk_sub_u16 v37, v37, 1 op_sel_hi:[1,0]
    v_pk_min_u16 v25, v25, v37
    v_and_b32 v36, 0x7fff7fff, v68
    v_pk_sub_u16 v36, v36, 1 op_sel_hi:[1,0]
    v_pk_min_u16 v25, v25, v36
    v_and_b32 v37, 0x7fff7fff, v69
    v_pk_sub_u16 v37, v37, 1 op_sel_hi:[1,0]
    v_pk_min_u16 v25, v25, v37
    v_and_b32 v36, 0x7fff7fff, v70
    v_pk_sub_u16 v36, v36, 1 op_sel_hi:[1,0]
    v_pk_min_u16 v25, v25, v36
    v_and_b32 v37, 0x7fff7fff, v71
    v_pk_sub_u16 v37, v37, 1 op_sel_hi:[1,0]
    v_pk_min_u16 v25, v25, v37
    v_and_b32 v36, 0x7fff7fff, v72
    v_pk_sub_u16 v36, v36, 1 op_sel_hi:[1,0]
    v_pk_min_u16 v25, v25, v36
    v_and_b32 v37, 0x7fff7fff, v73
    v_pk_sub_u16 v37, v37, 1 op_sel_hi:[1,0]
    v_pk_min_u16 v25, v25, v37
    v_and_b32 v36, 0x7fff7fff, v74
    v_pk_sub_u16 v36, v36, 1 op_sel_hi:[1,0]
    v_pk_min_u16 v25, v25, v36
    v_and_b32 v37, 0x7fff7fff, v75
    v_pk_sub_u16 v37, v37, 1 op_sel_hi:[1,0]
    v_pk_min_u16 v25, v25, v37
    v_and_b32 v36, 0x7fff7fff, v76
    v_pk_sub_u16 v36, v36, 1 op_sel_hi:[1,0]
    v_pk_min_u16 v25, v25, v36
    v_and_b32 v37, 0x7fff7fff, v77
    v_pk_sub_u16 v37, v37, 1 op_sel_hi:[1,0]
    v_pk_min_u16 v25, v25, v37
    v_and_b32 v36, 0x7fff7fff, v78
    v_pk_sub_u16 v36, v36, 1 op_sel_hi:[1,0]
    v_pk_min_u16 v25, v25, v36
    v_and_b32 v37, 0x7fff7fff, v79
    v_pk_sub_u16 v37, v37, 1 op_sel_hi:[1,0]
    v_pk_min_u16 v25, v25, v37
    v_mov_b32 v36, 0x397f397f
    v_pk_sub_u16 v36, v36, v25 clamp
    v_cmp_ne_u32 vcc, 0, v36
    s_or_b32 s62, 40, 0
    s_getpc_b64 s[92:93]
    s_cbranch_vccnz REC_V
    v_and_b32 v26, 0x7fff7fff, v64
    v_pk_sub_u16 v26, v26, s94 clamp
    v_bfi_b32 v64, s79, v26, v64
    v_and_b32 v27, 0x7fff7fff, v65
    v_pk_sub_u16 v27, v27, s94 clamp
    v_bfi_b32 v65, s79, v27, v65
    v_and_b32 v26, 0x7fff7fff, v66
    v_pk_sub_u16 v26, v26, s94 clamp
    v_bfi_b32 v66, s79, v26, v66
    v_and_b32 v27, 0x7fff7fff, v67
    v_pk_sub_u16 v27, v27, s94 clamp
    v_bfi_b32 v67, s79, v27, v67
    v_and_b32 v26, 0x7fff7fff, v68
    v_pk_sub_u16 v26, v26, s94 clamp
    v_bfi_b32 v68, s79, v26, v68
    v_and_b32 v27, 0x7fff7fff, v69
    v_pk_sub_u16 v27, v27, s94 clamp
    v_bfi_b32 v69, s79, v27, v69
    v_and_b32 v26, 0x7fff7fff, v70
    v_pk_sub_u16 v26, v26, s94 clamp
    v_bfi_b32 v70, s79, v26, v70
    v_and_b32 v27, 0x7fff7fff, v71
    v_pk_sub_u16 v27, v27, s94 clamp
    v_bfi_b32 v71, s79, v27, v71
    v_and_b32 v26, 0x7fff7fff, v72
    v_pk_sub_u16 v26, v26, s94 clamp
    v_bfi_b32 v72, s79, v26, v72
    v_and_b32 v27, 0x7fff7fff, v73
    v_pk_sub_u16 v27, v27, s94 clamp
    v_bfi_b32 v73, s79, v27, v73
    v_and_b32 v26, 0x7fff7fff, v74
    v_pk_sub_u16 v26, v26, s94 clamp
    v_bfi_b32 v74, s79, v26, v74
    v_and_b32 v27, 0x7fff7fff, v75
    v_pk_sub_u16 v27, v27, s94 clamp
    v_bfi_b32 v75, s79, v27, v75
    v_and_b32 v26, 0x7fff7fff, v76
    v_pk_sub_u16 v26, v26, s94 clamp
    v_bfi_b32 v76, s79, v26, v76
    v_and_b32 v27, 0x7fff7fff, v77
    v_pk_sub_u16 v27, v27, s94 clamp
    v_bfi_b32 v77, s79, v27, v77
    v_and_b32 v26, 0x7fff7fff, v78
    v_pk_sub_u16 v26, v26, s94 clamp
    v_bfi_b32 v78, s79, v26, v78
    v_and_b32 v27, 0x7fff7fff, v79
    v_pk_sub_u16 v27, v27, s94 clamp
    v_bfi_b32 v79, s79, v27, v79
    v_or_b32 v24, v64, v65
    v_or3_b32 v24, v24, v66, v67
    v_or3_b32 v24, v24, v68, v69
    v_or3_b32 v24, v24, v70, v71
    v_or3_b32 v24, v24, v72, v73
    v_or3_b32 v24, v24, v74, v75
    v_or3_b32 v24, v24, v76, v77
    v_or3_b32 v24, v24, v78, v79
    v_lshlrev_b32 v36, 11, v76
    v_and_or_b32 v176, v36, s78, v64
    v_lshlrev_b32 v37, 11, v77
    v_and_or_b32 v177, v37, s78, v65
    v_lshlrev_b32 v36, 11, v78
    v_and_or_b32 v178, v36, s78, v66
    v_lshlrev_b32 v37, 11, v79
    v_and_or_b32 v179, v37, s78, v67
    v_lshlrev_b32 v36, 7, v76
    v_and_or_b32 v180, v36, s78, v68
    v_lshlrev_b32 v37, 7, v77
    v_and_or_b32 v181, v37, s78, v69
    v_lshlrev_b32 v36, 7, v78
    v_and_or_b32 v182, v36, s78, v70
    v_lshlrev_b32 v37, 7, v79
    v_and_or_b32 v183, v37, s78, v71
    v_lshlrev_b32 v36, 3, v76
    v_and_or_b32 v72, v36, s78, v72
    v_lshrrev_b32 v37, 1, v76
    v_and_or_b32 v184, v37, s78, v72
    v_lshlrev_b32 v36, 3, v77
    v_and_or_b32 v73, v36, s78, v73
    v_lshrrev_b32 v37, 1, v77
    v_and_or_b32 v185, v37, s78, v73
    v_lshlrev_b32 v36, 3, v78
    v_and_or_b32 v74, v36, s78, v74
    v_lshrrev_b32 v37, 1, v78
    v_and_or_b32 v186, v37, s78, v74
    v_lshlrev_b32 v36, 3, v79
    v_and_or_b32 v75, v36, s78, v75
    v_lshrrev_b32 v37, 1, v79
    v_and_or_b32 v187, v37, s78, v75
    v_and_b32 v25, 0x7fff7fff, v48
    v_pk_sub_u16 v25, v25, 1 op_sel_hi:[1,0]
    v_and_b32 v37, 0x7fff7fff, v49
    v_pk_sub_u16 v37, v37, 1 op_sel_hi:[1,0]
    v_pk_min_u16 v25, v25, v37
    v_and_b32 v36, 0x7fff7fff, v50
    v_pk_sub_u16 v36, v36, 1 op_sel_hi:[1,0]
    v_pk_min_u16 v25, v25, v36
    v_and_b32 v37, 0x7fff7fff, v51
    v_pk_sub_u16 v37, v37, 1 op_sel_hi:[1,0]
    v_pk_min_u16 v25, v25, v37
    v_and_b32 v36, 0x7fff7fff, v52
    v_pk_sub_u16 v36, v36, 1 op_sel_hi:[1,0]
    v_pk_min_u16 v25, v25, v36
    v_and_b32 v37, 0x7fff7fff, v53
    v_pk_sub_u16 v37, v37, 1 op_sel_hi:[1,0]
    v_pk_min_u16 v25, v25, v37
    v_and_b32 v36, 0x7fff7fff, v54
    v_pk_sub_u16 v36, v36, 1 op_sel_hi:[1,0]
    v_pk_min_u16 v25, v25, v36
    v_and_b32 v37, 0x7fff7fff, v55
    v_pk_sub_u16 v37, v37, 1 op_sel_hi:[1,0]
    v_pk_min_u16 v25, v25, v37
    v_and_b32 v36, 0x7fff7fff, v56
    v_pk_sub_u16 v36, v36, 1 op_sel_hi:[1,0]
    v_pk_min_u16 v25, v25, v36
    v_and_b32 v37, 0x7fff7fff, v57
    v_pk_sub_u16 v37, v37, 1 op_sel_hi:[1,0]
    v_pk_min_u16 v25, v25, v37
    v_and_b32 v36, 0x7fff7fff, v58
    v_pk_sub_u16 v36, v36, 1 op_sel_hi:[1,0]
    v_pk_min_u16 v25, v25, v36
    v_and_b32 v37, 0x7fff7fff, v59
    v_pk_sub_u16 v37, v37, 1 op_sel_hi:[1,0]
    v_pk_min_u16 v25, v25, v37
    v_and_b32 v36, 0x7fff7fff, v60
    v_pk_sub_u16 v36, v36, 1 op_sel_hi:[1,0]
    v_pk_min_u16 v25, v25, v36
    v_and_b32 v37, 0x7fff7fff, v61
    v_pk_sub_u16 v37, v37, 1 op_sel_hi:[1,0]
    v_pk_min_u16 v25, v25, v37
    v_and_b32 v36, 0x7fff7fff, v62
    v_pk_sub_u16 v36, v36, 1 op_sel_hi:[1,0]
    v_pk_min_u16 v25, v25, v36
    v_and_b32 v37, 0x7fff7fff, v63
    v_pk_sub_u16 v37, v37, 1 op_sel_hi:[1,0]
    v_pk_min_u16 v25, v25, v37
    v_mov_b32 v36, 0x38ff38ff
    v_pk_sub_u16 v36, v36, v25 clamp
    v_cmp_ne_u32 vcc, 0, v36
    s_or_b32 s62, 8, 0
    s_getpc_b64 s[92:93]
    s_cbranch_vccnz REC_K
    v_and_b32 v26, 0x7fff7fff, v48
    v_pk_sub_u16 v26, v26, s98 clamp
    v_bfi_b32 v48, s79, v26, v48
    v_and_b32 v27, 0x7fff7fff, v49
    v_pk_sub_u16 v27, v27, s98 clamp
    v_bfi_b32 v49, s79, v27, v49
    v_and_b32 v26, 0x7fff7fff, v50
    v_pk_sub_u16 v26, v26, s98 clamp
    v_bfi_b32 v50, s79, v26, v50
    v_and_b32 v27, 0x7fff7fff, v51
    v_pk_sub_u16 v27, v27, s98 clamp
    v_bfi_b32 v51, s79, v27, v51
    v_and_b32 v26, 0x7fff7fff, v52
    v_pk_sub_u16 v26, v26, s98 clamp
    v_bfi_b32 v52, s79, v26, v52
    v_and_b32 v27, 0x7fff7fff, v53
    v_pk_sub_u16 v27, v27, s98 clamp
    v_bfi_b32 v53, s79, v27, v53
    v_and_b32 v26, 0x7fff7fff, v54
    v_pk_sub_u16 v26, v26, s98 clamp
    v_bfi_b32 v54, s79, v26, v54
    v_and_b32 v27, 0x7fff7fff, v55
    v_pk_sub_u16 v27, v27, s98 clamp
    v_bfi_b32 v55, s79, v27, v55
    v_and_b32 v26, 0x7fff7fff, v56
    v_pk_sub_u16 v26, v26, s98 clamp
    v_bfi_b32 v56, s79, v26, v56
    v_and_b32 v27, 0x7fff7fff, v57
    v_pk_sub_u16 v27, v27, s98 clamp
    v_bfi_b32 v57, s79, v27, v57
    v_and_b32 v26, 0x7fff7fff, v58
    v_pk_sub_u16 v26, v26, s98 clamp
    v_bfi_b32 v58, s79, v26, v58
    v_and_b32 v27, 0x7fff7fff, v59
    v_pk_sub_u16 v27, v27, s98 clamp
    v_bfi_b32 v59, s79, v27, v59
    v_and_b32 v26, 0x7fff7fff, v60
    v_pk_sub_u16 v26, v26, s98 clamp
    v_bfi_b32 v60, s79, v26, v60
    v_and_b32 v27, 0x7fff7fff, v61
    v_pk_sub_u16 v27, v27, s98 clamp
    v_bfi_b32 v61, s79, v27, v61
    v_and_b32 v26, 0x7fff7fff, v62
    v_pk_sub_u16 v26, v26, s98 clamp
    v_bfi_b32 v62, s79, v26, v62
    v_and_b32 v27, 0x7fff7fff, v63
    v_pk_sub_u16 v27, v27, s98 clamp
    v_bfi_b32 v63, s79, v27, v63
    v_or3_b32 v24, v24, v48, v49
    v_or3_b32 v24, v24, v50, v51
    v_or3_b32 v24, v24, v52, v53
    v_or3_b32 v24, v24, v54, v55
    v_or3_b32 v24, v24, v56, v57
    v_or3_b32 v24, v24, v58, v59
    v_or3_b32 v24, v24, v60, v61
    v_or3_b32 v24, v24, v62, v63
    v_lshlrev_b32 v36, 11, v60
    v_and_or_b32 v48, v36, s78, v48
    v_accvgpr_write_b32 a144, v48
    v_lshlrev_b32 v37, 11, v61
    v_and_or_b32 v49, v37, s78, v49
    v_accvgpr_write_b32 a145, v49
    v_lshlrev_b32 v36, 11, v62
    v_and_or_b32 v50, v36, s78, v50
    v_accvgpr_write_b32 a146, v50
    v_lshlrev_b32 v37, 11, v63
    v_and_or_b32 v51, v37, s78, v51
    v_accvgpr_write_b32 a147, v51
    v_lshlrev_b32 v36, 7, v60
    v_and_or_b32 v52, v36, s78, v52
    v_accvgpr_write_b32 a148, v52
    v_lshlrev_b32 v37, 7, v61
    v_and_or_b32 v53, v37, s78, v53
    v_accvgpr_write_b32 a149, v53
    v_lshlrev_b32 v36, 7, v62
    v_and_or_b32 v54, v36, s78, v54
    v_accvgpr_write_b32 a150, v54
    v_lshlrev_b32 v37, 7, v63
    v_and_or_b32 v55, v37, s78, v55
    v_accvgpr_write_b32 a151, v55
    v_lshlrev_b32 v36, 3, v60
    v_and_or_b32 v56, v36, s78, v56
    v_lshrrev_b32 v37, 1, v60
    v_and_or_b32 v56, v37, s78, v56
    v_accvgpr_write_b32 a152, v56
    v_lshlrev_b32 v36, 3, v61
    v_and_or_b32 v57, v36, s78, v57
    v_lshrrev_b32 v37, 1, v61
    v_and_or_b32 v57, v37, s78, v57
    v_accvgpr_write_b32 a153, v57
    v_lshlrev_b32 v36, 3, v62
    v_and_or_b32 v58, v36, s78, v58
    v_lshrrev_b32 v37, 1, v62
    v_and_or_b32 v58, v37, s78, v58
    v_accvgpr_write_b32 a154, v58
    v_lshlrev_b32 v36, 3, v63
    v_and_or_b32 v59, v36, s78, v59
    v_lshrrev_b32 v37, 1, v63
    v_and_or_b32 v59, v37, s78, v59
    v_accvgpr_write_b32 a155, v59
    v_and_b32 v24, s78, v24
    v_cmp_ne_u32 vcc, 0, v24
    s_cmp_lg_u64 vcc, 0
    s_cselect_b32 s60, 256, 0
    s_or_b32 s99, s99, s60
    s_waitcnt vmcnt(20)
    ds_read_b128 v[48:51], v9 offset:32768
    ds_read_b128 v[52:55], v10 offset:32768
    ds_read_b128 v[56:59], v11 offset:32768
    ds_read_b128 v[60:63], v12 offset:32768
    s_waitcnt vmcnt(16)
    v_accvgpr_read_b32 v64, a232
    v_accvgpr_read_b32 v65, a233
    v_accvgpr_read_b32 v66, a234
    v_accvgpr_read_b32 v67, a235
    v_accvgpr_read_b32 v68, a236
    v_accvgpr_read_b32 v69, a237
    v_accvgpr_read_b32 v70, a238
    v_accvgpr_read_b32 v71, a239
    v_accvgpr_read_b32 v72, a240
    v_accvgpr_read_b32 v73, a241
    v_accvgpr_read_b32 v74, a242
    v_accvgpr_read_b32 v75, a243
    v_accvgpr_read_b32 v76, a244
    v_accvgpr_read_b32 v77, a245
    v_accvgpr_read_b32 v78, a246
    v_accvgpr_read_b32 v79, a247
    s_waitcnt lgkmcnt(0)
    s_add_u32 s54, s52, 786432
    s_add_u32 m0, s59, 32768
    s_nop 0
    buffer_load_dwordx4 v4, s[4:7], s54 offen offset:0 nt lds
    buffer_load_dwordx4 v5, s[4:7], s54 offen offset:1024 nt lds
    buffer_load_dwordx4 v6, s[4:7], s54 offen offset:2048 nt lds
    buffer_load_dwordx4 v7, s[4:7], s54 offen offset:3072 nt lds
    buffer_load_dwordx4 a[232:235], v8, s[8:11], s54 offen offset:0 nt
    buffer_load_dwordx4 a[236:239], v8, s[8:11], s54 offen offset:256 nt
    buffer_load_dwordx4 a[240:243], v8, s[8:11], s54 offen offset:512 nt
    buffer_load_dwordx4 a[244:247], v8, s[8:11], s54 offen offset:768 nt
    v_and_b32 v25, 0x7fff7fff, v64
    v_pk_sub_u16 v25, v25, 1 op_sel_hi:[1,0]
    v_and_b32 v37, 0x7fff7fff, v65
    v_pk_sub_u16 v37, v37, 1 op_sel_hi:[1,0]
    v_pk_min_u16 v25, v25, v37
    v_and_b32 v36, 0x7fff7fff, v66
    v_pk_sub_u16 v36, v36, 1 op_sel_hi:[1,0]
    v_pk_min_u16 v25, v25, v36
    v_and_b32 v37, 0x7fff7fff, v67
    v_pk_sub_u16 v37, v37, 1 op_sel_hi:[1,0]
    v_pk_min_u16 v25, v25, v37
    v_and_b32 v36, 0x7fff7fff, v68
    v_pk_sub_u16 v36, v36, 1 op_sel_hi:[1,0]
    v_pk_min_u16 v25, v25, v36
    v_and_b32 v37, 0x7fff7fff, v69
    v_pk_sub_u16 v37, v37, 1 op_sel_hi:[1,0]
    v_pk_min_u16 v25, v25, v37
    v_and_b32 v36, 0x7fff7fff, v70
    v_pk_sub_u16 v36, v36, 1 op_sel_hi:[1,0]
    v_pk_min_u16 v25, v25, v36
    v_and_b32 v37, 0x7fff7fff, v71
    v_pk_sub_u16 v37, v37, 1 op_sel_hi:[1,0]
    v_pk_min_u16 v25, v25, v37
    v_and_b32 v36, 0x7fff7fff, v72
    v_pk_sub_u16 v36, v36, 1 op_sel_hi:[1,0]
    v_pk_min_u16 v25, v25, v36
    v_and_b32 v37, 0x7fff7fff, v73
    v_pk_sub_u16 v37, v37, 1 op_sel_hi:[1,0]
    v_pk_min_u16 v25, v25, v37
    v_and_b32 v36, 0x7fff7fff, v74
    v_pk_sub_u16 v36, v36, 1 op_sel_hi:[1,0]
    v_pk_min_u16 v25, v25, v36
    v_and_b32 v37, 0x7fff7fff, v75
    v_pk_sub_u16 v37, v37, 1 op_sel_hi:[1,0]
    v_pk_min_u16 v25, v25, v37
    v_and_b32 v36, 0x7fff7fff, v76
    v_pk_sub_u16 v36, v36, 1 op_sel_hi:[1,0]
    v_pk_min_u16 v25, v25, v36
    v_and_b32 v37, 0x7fff7fff, v77
    v_pk_sub_u16 v37, v37, 1 op_sel_hi:[1,0]
    v_pk_min_u16 v25, v25, v37
    v_and_b32 v36, 0x7fff7fff, v78
    v_pk_sub_u16 v36, v36, 1 op_sel_hi:[1,0]
    v_pk_min_u16 v25, v25, v36
    v_and_b32 v37, 0x7fff7fff, v79
    v_pk_sub_u16 v37, v37, 1 op_sel_hi:[1,0]
    v_pk_min_u16 v25, v25, v37
    v_mov_b32 v36, 0x397f397f
    v_pk_sub_u16 v36, v36, v25 clamp
    v_cmp_ne_u32 vcc, 0, v36
    s_or_b32 s62, 41, 0
    s_getpc_b64 s[92:93]
    s_cbranch_vccnz REC_V
    v_and_b32 v26, 0x7fff7fff, v64
    v_pk_sub_u16 v26, v26, s94 clamp
    v_bfi_b32 v64, s79, v26, v64
    v_and_b32 v27, 0x7fff7fff, v65
    v_pk_sub_u16 v27, v27, s94 clamp
    v_bfi_b32 v65, s79, v27, v65
    v_and_b32 v26, 0x7fff7fff, v66
    v_pk_sub_u16 v26, v26, s94 clamp
    v_bfi_b32 v66, s79, v26, v66
    v_and_b32 v27, 0x7fff7fff, v67
    v_pk_sub_u16 v27, v27, s94 clamp
    v_bfi_b32 v67, s79, v27, v67
    v_and_b32 v26, 0x7fff7fff, v68
    v_pk_sub_u16 v26, v26, s94 clamp
    v_bfi_b32 v68, s79, v26, v68
    v_and_b32 v27, 0x7fff7fff, v69
    v_pk_sub_u16 v27, v27, s94 clamp
    v_bfi_b32 v69, s79, v27, v69
    v_and_b32 v26, 0x7fff7fff, v70
    v_pk_sub_u16 v26, v26, s94 clamp
    v_bfi_b32 v70, s79, v26, v70
    v_and_b32 v27, 0x7fff7fff, v71
    v_pk_sub_u16 v27, v27, s94 clamp
    v_bfi_b32 v71, s79, v27, v71
    v_and_b32 v26, 0x7fff7fff, v72
    v_pk_sub_u16 v26, v26, s94 clamp
    v_bfi_b32 v72, s79, v26, v72
    v_and_b32 v27, 0x7fff7fff, v73
    v_pk_sub_u16 v27, v27, s94 clamp
    v_bfi_b32 v73, s79, v27, v73
    v_and_b32 v26, 0x7fff7fff, v74
    v_pk_sub_u16 v26, v26, s94 clamp
    v_bfi_b32 v74, s79, v26, v74
    v_and_b32 v27, 0x7fff7fff, v75
    v_pk_sub_u16 v27, v27, s94 clamp
    v_bfi_b32 v75, s79, v27, v75
    v_and_b32 v26, 0x7fff7fff, v76
    v_pk_sub_u16 v26, v26, s94 clamp
    v_bfi_b32 v76, s79, v26, v76
    v_and_b32 v27, 0x7fff7fff, v77
    v_pk_sub_u16 v27, v27, s94 clamp
    v_bfi_b32 v77, s79, v27, v77
    v_and_b32 v26, 0x7fff7fff, v78
    v_pk_sub_u16 v26, v26, s94 clamp
    v_bfi_b32 v78, s79, v26, v78
    v_and_b32 v27, 0x7fff7fff, v79
    v_pk_sub_u16 v27, v27, s94 clamp
    v_bfi_b32 v79, s79, v27, v79
    v_or_b32 v24, v64, v65
    v_or3_b32 v24, v24, v66, v67
    v_or3_b32 v24, v24, v68, v69
    v_or3_b32 v24, v24, v70, v71
    v_or3_b32 v24, v24, v72, v73
    v_or3_b32 v24, v24, v74, v75
    v_or3_b32 v24, v24, v76, v77
    v_or3_b32 v24, v24, v78, v79
    v_lshlrev_b32 v36, 11, v76
    v_and_or_b32 v188, v36, s78, v64
    v_lshlrev_b32 v37, 11, v77
    v_and_or_b32 v189, v37, s78, v65
    v_lshlrev_b32 v36, 11, v78
    v_and_or_b32 v190, v36, s78, v66
    v_lshlrev_b32 v37, 11, v79
    v_and_or_b32 v191, v37, s78, v67
    v_lshlrev_b32 v36, 7, v76
    v_and_or_b32 v192, v36, s78, v68
    v_lshlrev_b32 v37, 7, v77
    v_and_or_b32 v193, v37, s78, v69
    v_lshlrev_b32 v36, 7, v78
    v_and_or_b32 v194, v36, s78, v70
    v_lshlrev_b32 v37, 7, v79
    v_and_or_b32 v195, v37, s78, v71
    v_lshlrev_b32 v36, 3, v76
    v_and_or_b32 v72, v36, s78, v72
    v_lshrrev_b32 v37, 1, v76
    v_and_or_b32 v196, v37, s78, v72
    v_lshlrev_b32 v36, 3, v77
    v_and_or_b32 v73, v36, s78, v73
    v_lshrrev_b32 v37, 1, v77
    v_and_or_b32 v197, v37, s78, v73
    v_lshlrev_b32 v36, 3, v78
    v_and_or_b32 v74, v36, s78, v74
    v_lshrrev_b32 v37, 1, v78
    v_and_or_b32 v198, v37, s78, v74
    v_lshlrev_b32 v36, 3, v79
    v_and_or_b32 v75, v36, s78, v75
    v_lshrrev_b32 v37, 1, v79
    v_and_or_b32 v199, v37, s78, v75
    v_and_b32 v25, 0x7fff7fff, v48
    v_pk_sub_u16 v25, v25, 1 op_sel_hi:[1,0]
    v_and_b32 v37, 0x7fff7fff, v49
    v_pk_sub_u16 v37, v37, 1 op_sel_hi:[1,0]
    v_pk_min_u16 v25, v25, v37
    v_and_b32 v36, 0x7fff7fff, v50
    v_pk_sub_u16 v36, v36, 1 op_sel_hi:[1,0]
    v_pk_min_u16 v25, v25, v36
    v_and_b32 v37, 0x7fff7fff, v51
    v_pk_sub_u16 v37, v37, 1 op_sel_hi:[1,0]
    v_pk_min_u16 v25, v25, v37
    v_and_b32 v36, 0x7fff7fff, v52
    v_pk_sub_u16 v36, v36, 1 op_sel_hi:[1,0]
    v_pk_min_u16 v25, v25, v36
    v_and_b32 v37, 0x7fff7fff, v53
    v_pk_sub_u16 v37, v37, 1 op_sel_hi:[1,0]
    v_pk_min_u16 v25, v25, v37
    v_and_b32 v36, 0x7fff7fff, v54
    v_pk_sub_u16 v36, v36, 1 op_sel_hi:[1,0]
    v_pk_min_u16 v25, v25, v36
    v_and_b32 v37, 0x7fff7fff, v55
    v_pk_sub_u16 v37, v37, 1 op_sel_hi:[1,0]
    v_pk_min_u16 v25, v25, v37
    v_and_b32 v36, 0x7fff7fff, v56
    v_pk_sub_u16 v36, v36, 1 op_sel_hi:[1,0]
    v_pk_min_u16 v25, v25, v36
    v_and_b32 v37, 0x7fff7fff, v57
    v_pk_sub_u16 v37, v37, 1 op_sel_hi:[1,0]
    v_pk_min_u16 v25, v25, v37
    v_and_b32 v36, 0x7fff7fff, v58
    v_pk_sub_u16 v36, v36, 1 op_sel_hi:[1,0]
    v_pk_min_u16 v25, v25, v36
    v_and_b32 v37, 0x7fff7fff, v59
    v_pk_sub_u16 v37, v37, 1 op_sel_hi:[1,0]
    v_pk_min_u16 v25, v25, v37
    v_and_b32 v36, 0x7fff7fff, v60
    v_pk_sub_u16 v36, v36, 1 op_sel_hi:[1,0]
    v_pk_min_u16 v25, v25, v36
    v_and_b32 v37, 0x7fff7fff, v61
    v_pk_sub_u16 v37, v37, 1 op_sel_hi:[1,0]
    v_pk_min_u16 v25, v25, v37
    v_and_b32 v36, 0x7fff7fff, v62
    v_pk_sub_u16 v36, v36, 1 op_sel_hi:[1,0]
    v_pk_min_u16 v25, v25, v36
    v_and_b32 v37, 0x7fff7fff, v63
    v_pk_sub_u16 v37, v37, 1 op_sel_hi:[1,0]
    v_pk_min_u16 v25, v25, v37
    v_mov_b32 v36, 0x38ff38ff
    v_pk_sub_u16 v36, v36, v25 clamp
    v_cmp_ne_u32 vcc, 0, v36
    s_or_b32 s62, 9, 0
    s_getpc_b64 s[92:93]
    s_cbranch_vccnz REC_K
    v_and_b32 v26, 0x7fff7fff, v48
    v_pk_sub_u16 v26, v26, s98 clamp
    v_bfi_b32 v48, s79, v26, v48
    v_and_b32 v27, 0x7fff7fff, v49
    v_pk_sub_u16 v27, v27, s98 clamp
    v_bfi_b32 v49, s79, v27, v49
    v_and_b32 v26, 0x7fff7fff, v50
    v_pk_sub_u16 v26, v26, s98 clamp
    v_bfi_b32 v50, s79, v26, v50
    v_and_b32 v27, 0x7fff7fff, v51
    v_pk_sub_u16 v27, v27, s98 clamp
    v_bfi_b32 v51, s79, v27, v51
    v_and_b32 v26, 0x7fff7fff, v52
    v_pk_sub_u16 v26, v26, s98 clamp
    v_bfi_b32 v52, s79, v26, v52
    v_and_b32 v27, 0x7fff7fff, v53
    v_pk_sub_u16 v27, v27, s98 clamp
    v_bfi_b32 v53, s79, v27, v53
    v_and_b32 v26, 0x7fff7fff, v54
    v_pk_sub_u16 v26, v26, s98 clamp
    v_bfi_b32 v54, s79, v26, v54
    v_and_b32 v27, 0x7fff7fff, v55
    v_pk_sub_u16 v27, v27, s98 clamp
    v_bfi_b32 v55, s79, v27, v55
    v_and_b32 v26, 0x7fff7fff, v56
    v_pk_sub_u16 v26, v26, s98 clamp
    v_bfi_b32 v56, s79, v26, v56
    v_and_b32 v27, 0x7fff7fff, v57
    v_pk_sub_u16 v27, v27, s98 clamp
    v_bfi_b32 v57, s79, v27, v57
    v_and_b32 v26, 0x7fff7fff, v58
    v_pk_sub_u16 v26, v26, s98 clamp
    v_bfi_b32 v58, s79, v26, v58
    v_and_b32 v27, 0x7fff7fff, v59
    v_pk_sub_u16 v27, v27, s98 clamp
    v_bfi_b32 v59, s79, v27, v59
    v_and_b32 v26, 0x7fff7fff, v60
    v_pk_sub_u16 v26, v26, s98 clamp
    v_bfi_b32 v60, s79, v26, v60
    v_and_b32 v27, 0x7fff7fff, v61
    v_pk_sub_u16 v27, v27, s98 clamp
    v_bfi_b32 v61, s79, v27, v61
    v_and_b32 v26, 0x7fff7fff, v62
    v_pk_sub_u16 v26, v26, s98 clamp
    v_bfi_b32 v62, s79, v26, v62
    v_and_b32 v27, 0x7fff7fff, v63
    v_pk_sub_u16 v27, v27, s98 clamp
    v_bfi_b32 v63, s79, v27, v63
    v_or3_b32 v24, v24, v48, v49
    v_or3_b32 v24, v24, v50, v51
    v_or3_b32 v24, v24, v52, v53
    v_or3_b32 v24, v24, v54, v55
    v_or3_b32 v24, v24, v56, v57
    v_or3_b32 v24, v24, v58, v59
    v_or3_b32 v24, v24, v60, v61
    v_or3_b32 v24, v24, v62, v63
    v_lshlrev_b32 v36, 11, v60
    v_and_or_b32 v48, v36, s78, v48
    v_accvgpr_write_b32 a156, v48
    v_lshlrev_b32 v37, 11, v61
    v_and_or_b32 v49, v37, s78, v49
    v_accvgpr_write_b32 a157, v49
    v_lshlrev_b32 v36, 11, v62
    v_and_or_b32 v50, v36, s78, v50
    v_accvgpr_write_b32 a158, v50
    v_lshlrev_b32 v37, 11, v63
    v_and_or_b32 v51, v37, s78, v51
    v_accvgpr_write_b32 a159, v51
    v_lshlrev_b32 v36, 7, v60
    v_and_or_b32 v52, v36, s78, v52
    v_accvgpr_write_b32 a248, v52
    v_lshlrev_b32 v37, 7, v61
    v_and_or_b32 v53, v37, s78, v53
    v_accvgpr_write_b32 a249, v53
    v_lshlrev_b32 v36, 7, v62
    v_and_or_b32 v54, v36, s78, v54
    v_accvgpr_write_b32 a250, v54
    v_lshlrev_b32 v37, 7, v63
    v_and_or_b32 v55, v37, s78, v55
    v_accvgpr_write_b32 a251, v55
    v_lshlrev_b32 v36, 3, v60
    v_and_or_b32 v56, v36, s78, v56
    v_lshrrev_b32 v37, 1, v60
    v_and_or_b32 v56, v37, s78, v56
    v_accvgpr_write_b32 a252, v56
    v_lshlrev_b32 v36, 3, v61
    v_and_or_b32 v57, v36, s78, v57
    v_lshrrev_b32 v37, 1, v61
    v_and_or_b32 v57, v37, s78, v57
    v_accvgpr_write_b32 a253, v57
    v_lshlrev_b32 v36, 3, v62
    v_and_or_b32 v58, v36, s78, v58
    v_lshrrev_b32 v37, 1, v62
    v_and_or_b32 v58, v37, s78, v58
    v_accvgpr_write_b32 a254, v58
    v_lshlrev_b32 v36, 3, v63
    v_and_or_b32 v59, v36, s78, v59
    v_lshrrev_b32 v37, 1, v63
    v_and_or_b32 v59, v37, s78, v59
    v_accvgpr_write_b32 a255, v59
    v_and_b32 v24, s78, v24
    v_cmp_ne_u32 vcc, 0, v24
    s_cmp_lg_u64 vcc, 0
    s_cselect_b32 s60, 512, 0
    s_or_b32 s99, s99, s60
    s_waitcnt vmcnt(20)
    ds_read_b128 v[48:51], v9 offset:0
    ds_read_b128 v[52:55], v10 offset:0
    ds_read_b128 v[56:59], v11 offset:0
    ds_read_b128 v[60:63], v12 offset:0
    s_waitcnt vmcnt(16)
    v_accvgpr_read_b32 v64, a0
    v_accvgpr_read_b32 v65, a1
    v_accvgpr_read_b32 v66, a2
    v_accvgpr_read_b32 v67, a3
    v_accvgpr_read_b32 v68, a4
    v_accvgpr_read_b32 v69, a5
    v_accvgpr_read_b32 v70, a6
    v_accvgpr_read_b32 v71, a7
    v_accvgpr_read_b32 v72, a8
    v_accvgpr_read_b32 v73, a9
    v_accvgpr_read_b32 v74, a10
    v_accvgpr_read_b32 v75, a11
    v_accvgpr_read_b32 v76, a12
    v_accvgpr_read_b32 v77, a13
    v_accvgpr_read_b32 v78, a14
    v_accvgpr_read_b32 v79, a15
    s_waitcnt lgkmcnt(0)
    s_add_u32 s54, s52, 851968
    s_add_u32 m0, s59, 0
    s_nop 0
    buffer_load_dwordx4 v4, s[4:7], s54 offen offset:0 nt lds
    buffer_load_dwordx4 v5, s[4:7], s54 offen offset:1024 nt lds
    buffer_load_dwordx4 v6, s[4:7], s54 offen offset:2048 nt lds
    buffer_load_dwordx4 v7, s[4:7], s54 offen offset:3072 nt lds
    buffer_load_dwordx4 a[0:3], v8, s[8:11], s54 offen offset:0 nt
    buffer_load_dwordx4 a[4:7], v8, s[8:11], s54 offen offset:256 nt
    buffer_load_dwordx4 a[8:11], v8, s[8:11], s54 offen offset:512 nt
    buffer_load_dwordx4 a[12:15], v8, s[8:11], s54 offen offset:768 nt
    v_and_b32 v25, 0x7fff7fff, v64
    v_pk_sub_u16 v25, v25, 1 op_sel_hi:[1,0]
    v_and_b32 v37, 0x7fff7fff, v65
    v_pk_sub_u16 v37, v37, 1 op_sel_hi:[1,0]
    v_pk_min_u16 v25, v25, v37
    v_and_b32 v36, 0x7fff7fff, v66
    v_pk_sub_u16 v36, v36, 1 op_sel_hi:[1,0]
    v_pk_min_u16 v25, v25, v36
    v_and_b32 v37, 0x7fff7fff, v67
    v_pk_sub_u16 v37, v37, 1 op_sel_hi:[1,0]
    v_pk_min_u16 v25, v25, v37
    v_and_b32 v36, 0x7fff7fff, v68
    v_pk_sub_u16 v36, v36, 1 op_sel_hi:[1,0]
    v_pk_min_u16 v25, v25, v36
    v_and_b32 v37, 0x7fff7fff, v69
    v_pk_sub_u16 v37, v37, 1 op_sel_hi:[1,0]
    v_pk_min_u16 v25, v25, v37
    v_and_b32 v36, 0x7fff7fff, v70
    v_pk_sub_u16 v36, v36, 1 op_sel_hi:[1,0]
    v_pk_min_u16 v25, v25, v36
    v_and_b32 v37, 0x7fff7fff, v71
    v_pk_sub_u16 v37, v37, 1 op_sel_hi:[1,0]
    v_pk_min_u16 v25, v25, v37
    v_and_b32 v36, 0x7fff7fff, v72
    v_pk_sub_u16 v36, v36, 1 op_sel_hi:[1,0]
    v_pk_min_u16 v25, v25, v36
    v_and_b32 v37, 0x7fff7fff, v73
    v_pk_sub_u16 v37, v37, 1 op_sel_hi:[1,0]
    v_pk_min_u16 v25, v25, v37
    v_and_b32 v36, 0x7fff7fff, v74
    v_pk_sub_u16 v36, v36, 1 op_sel_hi:[1,0]
    v_pk_min_u16 v25, v25, v36
    v_and_b32 v37, 0x7fff7fff, v75
    v_pk_sub_u16 v37, v37, 1 op_sel_hi:[1,0]
    v_pk_min_u16 v25, v25, v37
    v_and_b32 v36, 0x7fff7fff, v76
    v_pk_sub_u16 v36, v36, 1 op_sel_hi:[1,0]
    v_pk_min_u16 v25, v25, v36
    v_and_b32 v37, 0x7fff7fff, v77
    v_pk_sub_u16 v37, v37, 1 op_sel_hi:[1,0]
    v_pk_min_u16 v25, v25, v37
    v_and_b32 v36, 0x7fff7fff, v78
    v_pk_sub_u16 v36, v36, 1 op_sel_hi:[1,0]
    v_pk_min_u16 v25, v25, v36
    v_and_b32 v37, 0x7fff7fff, v79
    v_pk_sub_u16 v37, v37, 1 op_sel_hi:[1,0]
    v_pk_min_u16 v25, v25, v37
    v_mov_b32 v36, 0x397f397f
    v_pk_sub_u16 v36, v36, v25 clamp
    v_cmp_ne_u32 vcc, 0, v36
    s_or_b32 s62, 42, 0
    s_getpc_b64 s[92:93]
    s_cbranch_vccnz REC_V
    v_and_b32 v26, 0x7fff7fff, v64
    v_pk_sub_u16 v26, v26, s94 clamp
    v_bfi_b32 v64, s79, v26, v64
    v_and_b32 v27, 0x7fff7fff, v65
    v_pk_sub_u16 v27, v27, s94 clamp
    v_bfi_b32 v65, s79, v27, v65
    v_and_b32 v26, 0x7fff7fff, v66
    v_pk_sub_u16 v26, v26, s94 clamp
    v_bfi_b32 v66, s79, v26, v66
    v_and_b32 v27, 0x7fff7fff, v67
    v_pk_sub_u16 v27, v27, s94 clamp
    v_bfi_b32 v67, s79, v27, v67
    v_and_b32 v26, 0x7fff7fff, v68
    v_pk_sub_u16 v26, v26, s94 clamp
    v_bfi_b32 v68, s79, v26, v68
    v_and_b32 v27, 0x7fff7fff, v69
    v_pk_sub_u16 v27, v27, s94 clamp
    v_bfi_b32 v69, s79, v27, v69
    v_and_b32 v26, 0x7fff7fff, v70
    v_pk_sub_u16 v26, v26, s94 clamp
    v_bfi_b32 v70, s79, v26, v70
    v_and_b32 v27, 0x7fff7fff, v71
    v_pk_sub_u16 v27, v27, s94 clamp
    v_bfi_b32 v71, s79, v27, v71
    v_and_b32 v26, 0x7fff7fff, v72
    v_pk_sub_u16 v26, v26, s94 clamp
    v_bfi_b32 v72, s79, v26, v72
    v_and_b32 v27, 0x7fff7fff, v73
    v_pk_sub_u16 v27, v27, s94 clamp
    v_bfi_b32 v73, s79, v27, v73
    v_and_b32 v26, 0x7fff7fff, v74
    v_pk_sub_u16 v26, v26, s94 clamp
    v_bfi_b32 v74, s79, v26, v74
    v_and_b32 v27, 0x7fff7fff, v75
    v_pk_sub_u16 v27, v27, s94 clamp
    v_bfi_b32 v75, s79, v27, v75
    v_and_b32 v26, 0x7fff7fff, v76
    v_pk_sub_u16 v26, v26, s94 clamp
    v_bfi_b32 v76, s79, v26, v76
    v_and_b32 v27, 0x7fff7fff, v77
    v_pk_sub_u16 v27, v27, s94 clamp
    v_bfi_b32 v77, s79, v27, v77
    v_and_b32 v26, 0x7fff7fff, v78
    v_pk_sub_u16 v26, v26, s94 clamp
    v_bfi_b32 v78, s79, v26, v78
    v_and_b32 v27, 0x7fff7fff, v79
    v_pk_sub_u16 v27, v27, s94 clamp
    v_bfi_b32 v79, s79, v27, v79
    v_or_b32 v24, v64, v65
    v_or3_b32 v24, v24, v66, v67
    v_or3_b32 v24, v24, v68, v69
    v_or3_b32 v24, v24, v70, v71
    v_or3_b32 v24, v24, v72, v73
    v_or3_b32 v24, v24, v74, v75
    v_or3_b32 v24, v24, v76, v77
    v_or3_b32 v24, v24, v78, v79
    v_lshlrev_b32 v36, 11, v76
    v_and_or_b32 v200, v36, s78, v64
    v_lshlrev_b32 v37, 11, v77
    v_and_or_b32 v201, v37, s78, v65
    v_lshlrev_b32 v36, 11, v78
    v_and_or_b32 v202, v36, s78, v66
    v_lshlrev_b32 v37, 11, v79
    v_and_or_b32 v203, v37, s78, v67
    v_lshlrev_b32 v36, 7, v76
    v_and_or_b32 v204, v36, s78, v68
    v_lshlrev_b32 v37, 7, v77
    v_and_or_b32 v205, v37, s78, v69
    v_lshlrev_b32 v36, 7, v78
    v_and_or_b32 v206, v36, s78, v70
    v_lshlrev_b32 v37, 7, v79
    v_and_or_b32 v207, v37, s78, v71
    v_lshlrev_b32 v36, 3, v76
    v_and_or_b32 v72, v36, s78, v72
    v_lshrrev_b32 v37, 1, v76
    v_and_or_b32 v208, v37, s78, v72
    v_lshlrev_b32 v36, 3, v77
    v_and_or_b32 v73, v36, s78, v73
    v_lshrrev_b32 v37, 1, v77
    v_and_or_b32 v209, v37, s78, v73
    v_lshlrev_b32 v36, 3, v78
    v_and_or_b32 v74, v36, s78, v74
    v_lshrrev_b32 v37, 1, v78
    v_and_or_b32 v210, v37, s78, v74
    v_lshlrev_b32 v36, 3, v79
    v_and_or_b32 v75, v36, s78, v75
    v_lshrrev_b32 v37, 1, v79
    v_and_or_b32 v211, v37, s78, v75
    v_and_b32 v25, 0x7fff7fff, v48
    v_pk_sub_u16 v25, v25, 1 op_sel_hi:[1,0]
    v_and_b32 v37, 0x7fff7fff, v49
    v_pk_sub_u16 v37, v37, 1 op_sel_hi:[1,0]
    v_pk_min_u16 v25, v25, v37
    v_and_b32 v36, 0x7fff7fff, v50
    v_pk_sub_u16 v36, v36, 1 op_sel_hi:[1,0]
    v_pk_min_u16 v25, v25, v36
    v_and_b32 v37, 0x7fff7fff, v51
    v_pk_sub_u16 v37, v37, 1 op_sel_hi:[1,0]
    v_pk_min_u16 v25, v25, v37
    v_and_b32 v36, 0x7fff7fff, v52
    v_pk_sub_u16 v36, v36, 1 op_sel_hi:[1,0]
    v_pk_min_u16 v25, v25, v36
    v_and_b32 v37, 0x7fff7fff, v53
    v_pk_sub_u16 v37, v37, 1 op_sel_hi:[1,0]
    v_pk_min_u16 v25, v25, v37
    v_and_b32 v36, 0x7fff7fff, v54
    v_pk_sub_u16 v36, v36, 1 op_sel_hi:[1,0]
    v_pk_min_u16 v25, v25, v36
    v_and_b32 v37, 0x7fff7fff, v55
    v_pk_sub_u16 v37, v37, 1 op_sel_hi:[1,0]
    v_pk_min_u16 v25, v25, v37
    v_and_b32 v36, 0x7fff7fff, v56
    v_pk_sub_u16 v36, v36, 1 op_sel_hi:[1,0]
    v_pk_min_u16 v25, v25, v36
    v_and_b32 v37, 0x7fff7fff, v57
    v_pk_sub_u16 v37, v37, 1 op_sel_hi:[1,0]
    v_pk_min_u16 v25, v25, v37
    v_and_b32 v36, 0x7fff7fff, v58
    v_pk_sub_u16 v36, v36, 1 op_sel_hi:[1,0]
    v_pk_min_u16 v25, v25, v36
    v_and_b32 v37, 0x7fff7fff, v59
    v_pk_sub_u16 v37, v37, 1 op_sel_hi:[1,0]
    v_pk_min_u16 v25, v25, v37
    v_and_b32 v36, 0x7fff7fff, v60
    v_pk_sub_u16 v36, v36, 1 op_sel_hi:[1,0]
    v_pk_min_u16 v25, v25, v36
    v_and_b32 v37, 0x7fff7fff, v61
    v_pk_sub_u16 v37, v37, 1 op_sel_hi:[1,0]
    v_pk_min_u16 v25, v25, v37
    v_and_b32 v36, 0x7fff7fff, v62
    v_pk_sub_u16 v36, v36, 1 op_sel_hi:[1,0]
    v_pk_min_u16 v25, v25, v36
    v_and_b32 v37, 0x7fff7fff, v63
    v_pk_sub_u16 v37, v37, 1 op_sel_hi:[1,0]
    v_pk_min_u16 v25, v25, v37
    v_mov_b32 v36, 0x38ff38ff
    v_pk_sub_u16 v36, v36, v25 clamp
    v_cmp_ne_u32 vcc, 0, v36
    s_or_b32 s62, 10, 0
    s_getpc_b64 s[92:93]
    s_cbranch_vccnz REC_K
    v_and_b32 v26, 0x7fff7fff, v48
    v_pk_sub_u16 v26, v26, s98 clamp
    v_bfi_b32 v48, s79, v26, v48
    v_and_b32 v27, 0x7fff7fff, v49
    v_pk_sub_u16 v27, v27, s98 clamp
    v_bfi_b32 v49, s79, v27, v49
    v_and_b32 v26, 0x7fff7fff, v50
    v_pk_sub_u16 v26, v26, s98 clamp
    v_bfi_b32 v50, s79, v26, v50
    v_and_b32 v27, 0x7fff7fff, v51
    v_pk_sub_u16 v27, v27, s98 clamp
    v_bfi_b32 v51, s79, v27, v51
    v_and_b32 v26, 0x7fff7fff, v52
    v_pk_sub_u16 v26, v26, s98 clamp
    v_bfi_b32 v52, s79, v26, v52
    v_and_b32 v27, 0x7fff7fff, v53
    v_pk_sub_u16 v27, v27, s98 clamp
    v_bfi_b32 v53, s79, v27, v53
    v_and_b32 v26, 0x7fff7fff, v54
    v_pk_sub_u16 v26, v26, s98 clamp
    v_bfi_b32 v54, s79, v26, v54
    v_and_b32 v27, 0x7fff7fff, v55
    v_pk_sub_u16 v27, v27, s98 clamp
    v_bfi_b32 v55, s79, v27, v55
    v_and_b32 v26, 0x7fff7fff, v56
    v_pk_sub_u16 v26, v26, s98 clamp
    v_bfi_b32 v56, s79, v26, v56
    v_and_b32 v27, 0x7fff7fff, v57
    v_pk_sub_u16 v27, v27, s98 clamp
    v_bfi_b32 v57, s79, v27, v57
    v_and_b32 v26, 0x7fff7fff, v58
    v_pk_sub_u16 v26, v26, s98 clamp
    v_bfi_b32 v58, s79, v26, v58
    v_and_b32 v27, 0x7fff7fff, v59
    v_pk_sub_u16 v27, v27, s98 clamp
    v_bfi_b32 v59, s79, v27, v59
    v_and_b32 v26, 0x7fff7fff, v60
    v_pk_sub_u16 v26, v26, s98 clamp
    v_bfi_b32 v60, s79, v26, v60
    v_and_b32 v27, 0x7fff7fff, v61
    v_pk_sub_u16 v27, v27, s98 clamp
    v_bfi_b32 v61, s79, v27, v61
    v_and_b32 v26, 0x7fff7fff, v62
    v_pk_sub_u16 v26, v26, s98 clamp
    v_bfi_b32 v62, s79, v26, v62
    v_and_b32 v27, 0x7fff7fff, v63
    v_pk_sub_u16 v27, v27, s98 clamp
    v_bfi_b32 v63, s79, v27, v63
    v_or3_b32 v24, v24, v48, v49
    v_or3_b32 v24, v24, v50, v51
    v_or3_b32 v24, v24, v52, v53
    v_or3_b32 v24, v24, v54, v55
    v_or3_b32 v24, v24, v56, v57
    v_or3_b32 v24, v24, v58, v59
    v_or3_b32 v24, v24, v60, v61
    v_or3_b32 v24, v24, v62, v63
    v_lshlrev_b32 v36, 11, v60
    v_and_or_b32 v48, v36, s78, v48
    v_lshlrev_b32 v37, 11, v61
    v_and_or_b32 v49, v37, s78, v49
    v_lshlrev_b32 v36, 11, v62
    v_and_or_b32 v50, v36, s78, v50
    v_lshlrev_b32 v37, 11, v63
    v_and_or_b32 v51, v37, s78, v51
    v_lshlrev_b32 v36, 7, v60
    v_and_or_b32 v52, v36, s78, v52
    v_lshlrev_b32 v37, 7, v61
    v_and_or_b32 v53, v37, s78, v53
    v_lshlrev_b32 v36, 7, v62
    v_and_or_b32 v54, v36, s78, v54
    v_lshlrev_b32 v37, 7, v63
    v_and_or_b32 v55, v37, s78, v55
    v_lshlrev_b32 v36, 3, v60
    v_and_or_b32 v56, v36, s78, v56
    v_lshrrev_b32 v37, 1, v60
    v_and_or_b32 v56, v37, s78, v56
    v_lshlrev_b32 v36, 3, v61
    v_and_or_b32 v57, v36, s78, v57
    v_lshrrev_b32 v37, 1, v61
    v_and_or_b32 v57, v37, s78, v57
    v_lshlrev_b32 v36, 3, v62
    v_and_or_b32 v58, v36, s78, v58
    v_lshrrev_b32 v37, 1, v62
    v_and_or_b32 v58, v37, s78, v58
    v_lshlrev_b32 v36, 3, v63
    v_and_or_b32 v59, v36, s78, v59
    v_lshrrev_b32 v37, 1, v63
    v_and_or_b32 v59, v37, s78, v59
    v_lshlrev_b32 v36, 4, v0
    v_add_u32 v36, s59, v36
    ds_write_b128 v36, v[48:51] offset:8704
    ds_write_b128 v36, v[52:55] offset:9728
    ds_write_b128 v36, v[56:59] offset:10752
    v_and_b32 v24, s78, v24
    v_cmp_ne_u32 vcc, 0, v24
    s_cmp_lg_u64 vcc, 0
    s_cselect_b32 s60, 1024, 0
    s_or_b32 s99, s99, s60
    s_waitcnt vmcnt(20)
    ds_read_b128 v[48:51], v9 offset:4096
    ds_read_b128 v[52:55], v10 offset:4096
    ds_read_b128 v[56:59], v11 offset:4096
    ds_read_b128 v[60:63], v12 offset:4096
    s_waitcnt vmcnt(16)
    v_accvgpr_read_b32 v64, a16
    v_accvgpr_read_b32 v65, a17
    v_accvgpr_read_b32 v66, a18
    v_accvgpr_read_b32 v67, a19
    v_accvgpr_read_b32 v68, a20
    v_accvgpr_read_b32 v69, a21
    v_accvgpr_read_b32 v70, a22
    v_accvgpr_read_b32 v71, a23
    v_accvgpr_read_b32 v72, a24
    v_accvgpr_read_b32 v73, a25
    v_accvgpr_read_b32 v74, a26
    v_accvgpr_read_b32 v75, a27
    v_accvgpr_read_b32 v76, a28
    v_accvgpr_read_b32 v77, a29
    v_accvgpr_read_b32 v78, a30
    v_accvgpr_read_b32 v79, a31
    s_waitcnt lgkmcnt(0)
    s_add_u32 s54, s52, 917504
    s_add_u32 m0, s59, 4096
    s_nop 0
    buffer_load_dwordx4 v4, s[4:7], s54 offen offset:0 nt lds
    buffer_load_dwordx4 v5, s[4:7], s54 offen offset:1024 nt lds
    buffer_load_dwordx4 v6, s[4:7], s54 offen offset:2048 nt lds
    buffer_load_dwordx4 v7, s[4:7], s54 offen offset:3072 nt lds
    buffer_load_dwordx4 a[16:19], v8, s[8:11], s54 offen offset:0 nt
    buffer_load_dwordx4 a[20:23], v8, s[8:11], s54 offen offset:256 nt
    buffer_load_dwordx4 a[24:27], v8, s[8:11], s54 offen offset:512 nt
    buffer_load_dwordx4 a[28:31], v8, s[8:11], s54 offen offset:768 nt
    v_and_b32 v25, 0x7fff7fff, v64
    v_pk_sub_u16 v25, v25, 1 op_sel_hi:[1,0]
    v_and_b32 v37, 0x7fff7fff, v65
    v_pk_sub_u16 v37, v37, 1 op_sel_hi:[1,0]
    v_pk_min_u16 v25, v25, v37
    v_and_b32 v36, 0x7fff7fff, v66
    v_pk_sub_u16 v36, v36, 1 op_sel_hi:[1,0]
    v_pk_min_u16 v25, v25, v36
    v_and_b32 v37, 0x7fff7fff, v67
    v_pk_sub_u16 v37, v37, 1 op_sel_hi:[1,0]
    v_pk_min_u16 v25, v25, v37
    v_and_b32 v36, 0x7fff7fff, v68
    v_pk_sub_u16 v36, v36, 1 op_sel_hi:[1,0]
    v_pk_min_u16 v25, v25, v36
    v_and_b32 v37, 0x7fff7fff, v69
    v_pk_sub_u16 v37, v37, 1 op_sel_hi:[1,0]
    v_pk_min_u16 v25, v25, v37
    v_and_b32 v36, 0x7fff7fff, v70
    v_pk_sub_u16 v36, v36, 1 op_sel_hi:[1,0]
    v_pk_min_u16 v25, v25, v36
    v_and_b32 v37, 0x7fff7fff, v71
    v_pk_sub_u16 v37, v37, 1 op_sel_hi:[1,0]
    v_pk_min_u16 v25, v25, v37
    v_and_b32 v36, 0x7fff7fff, v72
    v_pk_sub_u16 v36, v36, 1 op_sel_hi:[1,0]
    v_pk_min_u16 v25, v25, v36
    v_and_b32 v37, 0x7fff7fff, v73
    v_pk_sub_u16 v37, v37, 1 op_sel_hi:[1,0]
    v_pk_min_u16 v25, v25, v37
    v_and_b32 v36, 0x7fff7fff, v74
    v_pk_sub_u16 v36, v36, 1 op_sel_hi:[1,0]
    v_pk_min_u16 v25, v25, v36
    v_and_b32 v37, 0x7fff7fff, v75
    v_pk_sub_u16 v37, v37, 1 op_sel_hi:[1,0]
    v_pk_min_u16 v25, v25, v37
    v_and_b32 v36, 0x7fff7fff, v76
    v_pk_sub_u16 v36, v36, 1 op_sel_hi:[1,0]
    v_pk_min_u16 v25, v25, v36
    v_and_b32 v37, 0x7fff7fff, v77
    v_pk_sub_u16 v37, v37, 1 op_sel_hi:[1,0]
    v_pk_min_u16 v25, v25, v37
    v_and_b32 v36, 0x7fff7fff, v78
    v_pk_sub_u16 v36, v36, 1 op_sel_hi:[1,0]
    v_pk_min_u16 v25, v25, v36
    v_and_b32 v37, 0x7fff7fff, v79
    v_pk_sub_u16 v37, v37, 1 op_sel_hi:[1,0]
    v_pk_min_u16 v25, v25, v37
    v_mov_b32 v36, 0x397f397f
    v_pk_sub_u16 v36, v36, v25 clamp
    v_cmp_ne_u32 vcc, 0, v36
    s_or_b32 s62, 43, 0
    s_getpc_b64 s[92:93]
    s_cbranch_vccnz REC_V
    v_and_b32 v26, 0x7fff7fff, v64
    v_pk_sub_u16 v26, v26, s94 clamp
    v_bfi_b32 v64, s79, v26, v64
    v_and_b32 v27, 0x7fff7fff, v65
    v_pk_sub_u16 v27, v27, s94 clamp
    v_bfi_b32 v65, s79, v27, v65
    v_and_b32 v26, 0x7fff7fff, v66
    v_pk_sub_u16 v26, v26, s94 clamp
    v_bfi_b32 v66, s79, v26, v66
    v_and_b32 v27, 0x7fff7fff, v67
    v_pk_sub_u16 v27, v27, s94 clamp
    v_bfi_b32 v67, s79, v27, v67
    v_and_b32 v26, 0x7fff7fff, v68
    v_pk_sub_u16 v26, v26, s94 clamp
    v_bfi_b32 v68, s79, v26, v68
    v_and_b32 v27, 0x7fff7fff, v69
    v_pk_sub_u16 v27, v27, s94 clamp
    v_bfi_b32 v69, s79, v27, v69
    v_and_b32 v26, 0x7fff7fff, v70
    v_pk_sub_u16 v26, v26, s94 clamp
    v_bfi_b32 v70, s79, v26, v70
    v_and_b32 v27, 0x7fff7fff, v71
    v_pk_sub_u16 v27, v27, s94 clamp
    v_bfi_b32 v71, s79, v27, v71
    v_and_b32 v26, 0x7fff7fff, v72
    v_pk_sub_u16 v26, v26, s94 clamp
    v_bfi_b32 v72, s79, v26, v72
    v_and_b32 v27, 0x7fff7fff, v73
    v_pk_sub_u16 v27, v27, s94 clamp
    v_bfi_b32 v73, s79, v27, v73
    v_and_b32 v26, 0x7fff7fff, v74
    v_pk_sub_u16 v26, v26, s94 clamp
    v_bfi_b32 v74, s79, v26, v74
    v_and_b32 v27, 0x7fff7fff, v75
    v_pk_sub_u16 v27, v27, s94 clamp
    v_bfi_b32 v75, s79, v27, v75
    v_and_b32 v26, 0x7fff7fff, v76
    v_pk_sub_u16 v26, v26, s94 clamp
    v_bfi_b32 v76, s79, v26, v76
    v_and_b32 v27, 0x7fff7fff, v77
    v_pk_sub_u16 v27, v27, s94 clamp
    v_bfi_b32 v77, s79, v27, v77
    v_and_b32 v26, 0x7fff7fff, v78
    v_pk_sub_u16 v26, v26, s94 clamp
    v_bfi_b32 v78, s79, v26, v78
    v_and_b32 v27, 0x7fff7fff, v79
    v_pk_sub_u16 v27, v27, s94 clamp
    v_bfi_b32 v79, s79, v27, v79
    v_or_b32 v24, v64, v65
    v_or3_b32 v24, v24, v66, v67
    v_or3_b32 v24, v24, v68, v69
    v_or3_b32 v24, v24, v70, v71
    v_or3_b32 v24, v24, v72, v73
    v_or3_b32 v24, v24, v74, v75
    v_or3_b32 v24, v24, v76, v77
    v_or3_b32 v24, v24, v78, v79
    v_lshlrev_b32 v36, 11, v76
    v_and_or_b32 v212, v36, s78, v64
    v_lshlrev_b32 v37, 11, v77
    v_and_or_b32 v213, v37, s78, v65
    v_lshlrev_b32 v36, 11, v78
    v_and_or_b32 v214, v36, s78, v66
    v_lshlrev_b32 v37, 11, v79
    v_and_or_b32 v215, v37, s78, v67
    v_lshlrev_b32 v36, 7, v76
    v_and_or_b32 v216, v36, s78, v68
    v_lshlrev_b32 v37, 7, v77
    v_and_or_b32 v217, v37, s78, v69
    v_lshlrev_b32 v36, 7, v78
    v_and_or_b32 v218, v36, s78, v70
    v_lshlrev_b32 v37, 7, v79
    v_and_or_b32 v219, v37, s78, v71
    v_lshlrev_b32 v36, 3, v76
    v_and_or_b32 v72, v36, s78, v72
    v_lshrrev_b32 v37, 1, v76
    v_and_or_b32 v220, v37, s78, v72
    v_lshlrev_b32 v36, 3, v77
    v_and_or_b32 v73, v36, s78, v73
    v_lshrrev_b32 v37, 1, v77
    v_and_or_b32 v221, v37, s78, v73
    v_lshlrev_b32 v36, 3, v78
    v_and_or_b32 v74, v36, s78, v74
    v_lshrrev_b32 v37, 1, v78
    v_and_or_b32 v222, v37, s78, v74
    v_lshlrev_b32 v36, 3, v79
    v_and_or_b32 v75, v36, s78, v75
    v_lshrrev_b32 v37, 1, v79
    v_and_or_b32 v223, v37, s78, v75
    v_and_b32 v25, 0x7fff7fff, v48
    v_pk_sub_u16 v25, v25, 1 op_sel_hi:[1,0]
    v_and_b32 v37, 0x7fff7fff, v49
    v_pk_sub_u16 v37, v37, 1 op_sel_hi:[1,0]
    v_pk_min_u16 v25, v25, v37
    v_and_b32 v36, 0x7fff7fff, v50
    v_pk_sub_u16 v36, v36, 1 op_sel_hi:[1,0]
    v_pk_min_u16 v25, v25, v36
    v_and_b32 v37, 0x7fff7fff, v51
    v_pk_sub_u16 v37, v37, 1 op_sel_hi:[1,0]
    v_pk_min_u16 v25, v25, v37
    v_and_b32 v36, 0x7fff7fff, v52
    v_pk_sub_u16 v36, v36, 1 op_sel_hi:[1,0]
    v_pk_min_u16 v25, v25, v36
    v_and_b32 v37, 0x7fff7fff, v53
    v_pk_sub_u16 v37, v37, 1 op_sel_hi:[1,0]
    v_pk_min_u16 v25, v25, v37
    v_and_b32 v36, 0x7fff7fff, v54
    v_pk_sub_u16 v36, v36, 1 op_sel_hi:[1,0]
    v_pk_min_u16 v25, v25, v36
    v_and_b32 v37, 0x7fff7fff, v55
    v_pk_sub_u16 v37, v37, 1 op_sel_hi:[1,0]
    v_pk_min_u16 v25, v25, v37
    v_and_b32 v36, 0x7fff7fff, v56
    v_pk_sub_u16 v36, v36, 1 op_sel_hi:[1,0]
    v_pk_min_u16 v25, v25, v36
    v_and_b32 v37, 0x7fff7fff, v57
    v_pk_sub_u16 v37, v37, 1 op_sel_hi:[1,0]
    v_pk_min_u16 v25, v25, v37
    v_and_b32 v36, 0x7fff7fff, v58
    v_pk_sub_u16 v36, v36, 1 op_sel_hi:[1,0]
    v_pk_min_u16 v25, v25, v36
    v_and_b32 v37, 0x7fff7fff, v59
    v_pk_sub_u16 v37, v37, 1 op_sel_hi:[1,0]
    v_pk_min_u16 v25, v25, v37
    v_and_b32 v36, 0x7fff7fff, v60
    v_pk_sub_u16 v36, v36, 1 op_sel_hi:[1,0]
    v_pk_min_u16 v25, v25, v36
    v_and_b32 v37, 0x7fff7fff, v61
    v_pk_sub_u16 v37, v37, 1 op_sel_hi:[1,0]
    v_pk_min_u16 v25, v25, v37
    v_and_b32 v36, 0x7fff7fff, v62
    v_pk_sub_u16 v36, v36, 1 op_sel_hi:[1,0]
    v_pk_min_u16 v25, v25, v36
    v_and_b32 v37, 0x7fff7fff, v63
    v_pk_sub_u16 v37, v37, 1 op_sel_hi:[1,0]
    v_pk_min_u16 v25, v25, v37
    v_mov_b32 v36, 0x38ff38ff
    v_pk_sub_u16 v36, v36, v25 clamp
    v_cmp_ne_u32 vcc, 0, v36
    s_or_b32 s62, 11, 0
    s_getpc_b64 s[92:93]
    s_cbranch_vccnz REC_K
    v_and_b32 v26, 0x7fff7fff, v48
    v_pk_sub_u16 v26, v26, s98 clamp
    v_bfi_b32 v48, s79, v26, v48
    v_and_b32 v27, 0x7fff7fff, v49
    v_pk_sub_u16 v27, v27, s98 clamp
    v_bfi_b32 v49, s79, v27, v49
    v_and_b32 v26, 0x7fff7fff, v50
    v_pk_sub_u16 v26, v26, s98 clamp
    v_bfi_b32 v50, s79, v26, v50
    v_and_b32 v27, 0x7fff7fff, v51
    v_pk_sub_u16 v27, v27, s98 clamp
    v_bfi_b32 v51, s79, v27, v51
    v_and_b32 v26, 0x7fff7fff, v52
    v_pk_sub_u16 v26, v26, s98 clamp
    v_bfi_b32 v52, s79, v26, v52
    v_and_b32 v27, 0x7fff7fff, v53
    v_pk_sub_u16 v27, v27, s98 clamp
    v_bfi_b32 v53, s79, v27, v53
    v_and_b32 v26, 0x7fff7fff, v54
    v_pk_sub_u16 v26, v26, s98 clamp
    v_bfi_b32 v54, s79, v26, v54
    v_and_b32 v27, 0x7fff7fff, v55
    v_pk_sub_u16 v27, v27, s98 clamp
    v_bfi_b32 v55, s79, v27, v55
    v_and_b32 v26, 0x7fff7fff, v56
    v_pk_sub_u16 v26, v26, s98 clamp
    v_bfi_b32 v56, s79, v26, v56
    v_and_b32 v27, 0x7fff7fff, v57
    v_pk_sub_u16 v27, v27, s98 clamp
    v_bfi_b32 v57, s79, v27, v57
    v_and_b32 v26, 0x7fff7fff, v58
    v_pk_sub_u16 v26, v26, s98 clamp
    v_bfi_b32 v58, s79, v26, v58
    v_and_b32 v27, 0x7fff7fff, v59
    v_pk_sub_u16 v27, v27, s98 clamp
    v_bfi_b32 v59, s79, v27, v59
    v_and_b32 v26, 0x7fff7fff, v60
    v_pk_sub_u16 v26, v26, s98 clamp
    v_bfi_b32 v60, s79, v26, v60
    v_and_b32 v27, 0x7fff7fff, v61
    v_pk_sub_u16 v27, v27, s98 clamp
    v_bfi_b32 v61, s79, v27, v61
    v_and_b32 v26, 0x7fff7fff, v62
    v_pk_sub_u16 v26, v26, s98 clamp
    v_bfi_b32 v62, s79, v26, v62
    v_and_b32 v27, 0x7fff7fff, v63
    v_pk_sub_u16 v27, v27, s98 clamp
    v_bfi_b32 v63, s79, v27, v63
    v_or3_b32 v24, v24, v48, v49
    v_or3_b32 v24, v24, v50, v51
    v_or3_b32 v24, v24, v52, v53
    v_or3_b32 v24, v24, v54, v55
    v_or3_b32 v24, v24, v56, v57
    v_or3_b32 v24, v24, v58, v59
    v_or3_b32 v24, v24, v60, v61
    v_or3_b32 v24, v24, v62, v63
    v_lshlrev_b32 v36, 11, v60
    v_and_or_b32 v48, v36, s78, v48
    v_lshlrev_b32 v37, 11, v61
    v_and_or_b32 v49, v37, s78, v49
    v_lshlrev_b32 v36, 11, v62
    v_and_or_b32 v50, v36, s78, v50
    v_lshlrev_b32 v37, 11, v63
    v_and_or_b32 v51, v37, s78, v51
    v_lshlrev_b32 v36, 7, v60
    v_and_or_b32 v52, v36, s78, v52
    v_lshlrev_b32 v37, 7, v61
    v_and_or_b32 v53, v37, s78, v53
    v_lshlrev_b32 v36, 7, v62
    v_and_or_b32 v54, v36, s78, v54
    v_lshlrev_b32 v37, 7, v63
    v_and_or_b32 v55, v37, s78, v55
    v_lshlrev_b32 v36, 3, v60
    v_and_or_b32 v56, v36, s78, v56
    v_lshrrev_b32 v37, 1, v60
    v_and_or_b32 v56, v37, s78, v56
    v_lshlrev_b32 v36, 3, v61
    v_and_or_b32 v57, v36, s78, v57
    v_lshrrev_b32 v37, 1, v61
    v_and_or_b32 v57, v37, s78, v57
    v_lshlrev_b32 v36, 3, v62
    v_and_or_b32 v58, v36, s78, v58
    v_lshrrev_b32 v37, 1, v62
    v_and_or_b32 v58, v37, s78, v58
    v_lshlrev_b32 v36, 3, v63
    v_and_or_b32 v59, v36, s78, v59
    v_lshrrev_b32 v37, 1, v63
    v_and_or_b32 v59, v37, s78, v59
    v_lshlrev_b32 v36, 4, v0
    v_add_u32 v36, s59, v36
    ds_write_b128 v36, v[48:51] offset:11776
    ds_write_b128 v36, v[52:55] offset:12800
    ds_write_b128 v36, v[56:59] offset:13824
    v_and_b32 v24, s78, v24
    v_cmp_ne_u32 vcc, 0, v24
    s_cmp_lg_u64 vcc, 0
    s_cselect_b32 s60, 2048, 0
    s_or_b32 s99, s99, s60
    s_waitcnt vmcnt(20)
    ds_read_b128 v[48:51], v9 offset:32768
    ds_read_b128 v[52:55], v10 offset:32768
    ds_read_b128 v[56:59], v11 offset:32768
    ds_read_b128 v[60:63], v12 offset:32768
    s_waitcnt vmcnt(16)
    v_accvgpr_read_b32 v64, a232
    v_accvgpr_read_b32 v65, a233
    v_accvgpr_read_b32 v66, a234
    v_accvgpr_read_b32 v67, a235
    v_accvgpr_read_b32 v68, a236
    v_accvgpr_read_b32 v69, a237
    v_accvgpr_read_b32 v70, a238
    v_accvgpr_read_b32 v71, a239
    v_accvgpr_read_b32 v72, a240
    v_accvgpr_read_b32 v73, a241
    v_accvgpr_read_b32 v74, a242
    v_accvgpr_read_b32 v75, a243
    v_accvgpr_read_b32 v76, a244
    v_accvgpr_read_b32 v77, a245
    v_accvgpr_read_b32 v78, a246
    v_accvgpr_read_b32 v79, a247
    s_waitcnt lgkmcnt(0)
    s_add_u32 s54, s52, 983040
    s_add_u32 m0, s59, 32768
    s_nop 0
    buffer_load_dwordx4 v4, s[4:7], s54 offen offset:0 nt lds
    buffer_load_dwordx4 v5, s[4:7], s54 offen offset:1024 nt lds
    buffer_load_dwordx4 v6, s[4:7], s54 offen offset:2048 nt lds
    buffer_load_dwordx4 v7, s[4:7], s54 offen offset:3072 nt lds
    buffer_load_dwordx4 a[232:235], v8, s[8:11], s54 offen offset:0 nt
    buffer_load_dwordx4 a[236:239], v8, s[8:11], s54 offen offset:256 nt
    buffer_load_dwordx4 a[240:243], v8, s[8:11], s54 offen offset:512 nt
    buffer_load_dwordx4 a[244:247], v8, s[8:11], s54 offen offset:768 nt
    v_and_b32 v25, 0x7fff7fff, v64
    v_pk_sub_u16 v25, v25, 1 op_sel_hi:[1,0]
    v_and_b32 v37, 0x7fff7fff, v65
    v_pk_sub_u16 v37, v37, 1 op_sel_hi:[1,0]
    v_pk_min_u16 v25, v25, v37
    v_and_b32 v36, 0x7fff7fff, v66
    v_pk_sub_u16 v36, v36, 1 op_sel_hi:[1,0]
    v_pk_min_u16 v25, v25, v36
    v_and_b32 v37, 0x7fff7fff, v67
    v_pk_sub_u16 v37, v37, 1 op_sel_hi:[1,0]
    v_pk_min_u16 v25, v25, v37
    v_and_b32 v36, 0x7fff7fff, v68
    v_pk_sub_u16 v36, v36, 1 op_sel_hi:[1,0]
    v_pk_min_u16 v25, v25, v36
    v_and_b32 v37, 0x7fff7fff, v69
    v_pk_sub_u16 v37, v37, 1 op_sel_hi:[1,0]
    v_pk_min_u16 v25, v25, v37
    v_and_b32 v36, 0x7fff7fff, v70
    v_pk_sub_u16 v36, v36, 1 op_sel_hi:[1,0]
    v_pk_min_u16 v25, v25, v36
    v_and_b32 v37, 0x7fff7fff, v71
    v_pk_sub_u16 v37, v37, 1 op_sel_hi:[1,0]
    v_pk_min_u16 v25, v25, v37
    v_and_b32 v36, 0x7fff7fff, v72
    v_pk_sub_u16 v36, v36, 1 op_sel_hi:[1,0]
    v_pk_min_u16 v25, v25, v36
    v_and_b32 v37, 0x7fff7fff, v73
    v_pk_sub_u16 v37, v37, 1 op_sel_hi:[1,0]
    v_pk_min_u16 v25, v25, v37
    v_and_b32 v36, 0x7fff7fff, v74
    v_pk_sub_u16 v36, v36, 1 op_sel_hi:[1,0]
    v_pk_min_u16 v25, v25, v36
    v_and_b32 v37, 0x7fff7fff, v75
    v_pk_sub_u16 v37, v37, 1 op_sel_hi:[1,0]
    v_pk_min_u16 v25, v25, v37
    v_and_b32 v36, 0x7fff7fff, v76
    v_pk_sub_u16 v36, v36, 1 op_sel_hi:[1,0]
    v_pk_min_u16 v25, v25, v36
    v_and_b32 v37, 0x7fff7fff, v77
    v_pk_sub_u16 v37, v37, 1 op_sel_hi:[1,0]
    v_pk_min_u16 v25, v25, v37
    v_and_b32 v36, 0x7fff7fff, v78
    v_pk_sub_u16 v36, v36, 1 op_sel_hi:[1,0]
    v_pk_min_u16 v25, v25, v36
    v_and_b32 v37, 0x7fff7fff, v79
    v_pk_sub_u16 v37, v37, 1 op_sel_hi:[1,0]
    v_pk_min_u16 v25, v25, v37
    v_mov_b32 v36, 0x397f397f
    v_pk_sub_u16 v36, v36, v25 clamp
    v_cmp_ne_u32 vcc, 0, v36
    s_or_b32 s62, 44, 0
    s_getpc_b64 s[92:93]
    s_cbranch_vccnz REC_V
    v_and_b32 v26, 0x7fff7fff, v64
    v_pk_sub_u16 v26, v26, s94 clamp
    v_bfi_b32 v64, s79, v26, v64
    v_and_b32 v27, 0x7fff7fff, v65
    v_pk_sub_u16 v27, v27, s94 clamp
    v_bfi_b32 v65, s79, v27, v65
    v_and_b32 v26, 0x7fff7fff, v66
    v_pk_sub_u16 v26, v26, s94 clamp
    v_bfi_b32 v66, s79, v26, v66
    v_and_b32 v27, 0x7fff7fff, v67
    v_pk_sub_u16 v27, v27, s94 clamp
    v_bfi_b32 v67, s79, v27, v67
    v_and_b32 v26, 0x7fff7fff, v68
    v_pk_sub_u16 v26, v26, s94 clamp
    v_bfi_b32 v68, s79, v26, v68
    v_and_b32 v27, 0x7fff7fff, v69
    v_pk_sub_u16 v27, v27, s94 clamp
    v_bfi_b32 v69, s79, v27, v69
    v_and_b32 v26, 0x7fff7fff, v70
    v_pk_sub_u16 v26, v26, s94 clamp
    v_bfi_b32 v70, s79, v26, v70
    v_and_b32 v27, 0x7fff7fff, v71
    v_pk_sub_u16 v27, v27, s94 clamp
    v_bfi_b32 v71, s79, v27, v71
    v_and_b32 v26, 0x7fff7fff, v72
    v_pk_sub_u16 v26, v26, s94 clamp
    v_bfi_b32 v72, s79, v26, v72
    v_and_b32 v27, 0x7fff7fff, v73
    v_pk_sub_u16 v27, v27, s94 clamp
    v_bfi_b32 v73, s79, v27, v73
    v_and_b32 v26, 0x7fff7fff, v74
    v_pk_sub_u16 v26, v26, s94 clamp
    v_bfi_b32 v74, s79, v26, v74
    v_and_b32 v27, 0x7fff7fff, v75
    v_pk_sub_u16 v27, v27, s94 clamp
    v_bfi_b32 v75, s79, v27, v75
    v_and_b32 v26, 0x7fff7fff, v76
    v_pk_sub_u16 v26, v26, s94 clamp
    v_bfi_b32 v76, s79, v26, v76
    v_and_b32 v27, 0x7fff7fff, v77
    v_pk_sub_u16 v27, v27, s94 clamp
    v_bfi_b32 v77, s79, v27, v77
    v_and_b32 v26, 0x7fff7fff, v78
    v_pk_sub_u16 v26, v26, s94 clamp
    v_bfi_b32 v78, s79, v26, v78
    v_and_b32 v27, 0x7fff7fff, v79
    v_pk_sub_u16 v27, v27, s94 clamp
    v_bfi_b32 v79, s79, v27, v79
    v_or_b32 v24, v64, v65
    v_or3_b32 v24, v24, v66, v67
    v_or3_b32 v24, v24, v68, v69
    v_or3_b32 v24, v24, v70, v71
    v_or3_b32 v24, v24, v72, v73
    v_or3_b32 v24, v24, v74, v75
    v_or3_b32 v24, v24, v76, v77
    v_or3_b32 v24, v24, v78, v79
    v_lshlrev_b32 v36, 11, v76
    v_and_or_b32 v224, v36, s78, v64
    v_lshlrev_b32 v37, 11, v77
    v_and_or_b32 v225, v37, s78, v65
    v_lshlrev_b32 v36, 11, v78
    v_and_or_b32 v226, v36, s78, v66
    v_lshlrev_b32 v37, 11, v79
    v_and_or_b32 v227, v37, s78, v67
    v_lshlrev_b32 v36, 7, v76
    v_and_or_b32 v228, v36, s78, v68
    v_lshlrev_b32 v37, 7, v77
    v_and_or_b32 v229, v37, s78, v69
    v_lshlrev_b32 v36, 7, v78
    v_and_or_b32 v230, v36, s78, v70
    v_lshlrev_b32 v37, 7, v79
    v_and_or_b32 v231, v37, s78, v71
    v_lshlrev_b32 v36, 3, v76
    v_and_or_b32 v72, v36, s78, v72
    v_lshrrev_b32 v37, 1, v76
    v_and_or_b32 v232, v37, s78, v72
    v_lshlrev_b32 v36, 3, v77
    v_and_or_b32 v73, v36, s78, v73
    v_lshrrev_b32 v37, 1, v77
    v_and_or_b32 v233, v37, s78, v73
    v_lshlrev_b32 v36, 3, v78
    v_and_or_b32 v74, v36, s78, v74
    v_lshrrev_b32 v37, 1, v78
    v_and_or_b32 v234, v37, s78, v74
    v_lshlrev_b32 v36, 3, v79
    v_and_or_b32 v75, v36, s78, v75
    v_lshrrev_b32 v37, 1, v79
    v_and_or_b32 v235, v37, s78, v75
    v_and_b32 v25, 0x7fff7fff, v48
    v_pk_sub_u16 v25, v25, 1 op_sel_hi:[1,0]
    v_and_b32 v37, 0x7fff7fff, v49
    v_pk_sub_u16 v37, v37, 1 op_sel_hi:[1,0]
    v_pk_min_u16 v25, v25, v37
    v_and_b32 v36, 0x7fff7fff, v50
    v_pk_sub_u16 v36, v36, 1 op_sel_hi:[1,0]
    v_pk_min_u16 v25, v25, v36
    v_and_b32 v37, 0x7fff7fff, v51
    v_pk_sub_u16 v37, v37, 1 op_sel_hi:[1,0]
    v_pk_min_u16 v25, v25, v37
    v_and_b32 v36, 0x7fff7fff, v52
    v_pk_sub_u16 v36, v36, 1 op_sel_hi:[1,0]
    v_pk_min_u16 v25, v25, v36
    v_and_b32 v37, 0x7fff7fff, v53
    v_pk_sub_u16 v37, v37, 1 op_sel_hi:[1,0]
    v_pk_min_u16 v25, v25, v37
    v_and_b32 v36, 0x7fff7fff, v54
    v_pk_sub_u16 v36, v36, 1 op_sel_hi:[1,0]
    v_pk_min_u16 v25, v25, v36
    v_and_b32 v37, 0x7fff7fff, v55
    v_pk_sub_u16 v37, v37, 1 op_sel_hi:[1,0]
    v_pk_min_u16 v25, v25, v37
    v_and_b32 v36, 0x7fff7fff, v56
    v_pk_sub_u16 v36, v36, 1 op_sel_hi:[1,0]
    v_pk_min_u16 v25, v25, v36
    v_and_b32 v37, 0x7fff7fff, v57
    v_pk_sub_u16 v37, v37, 1 op_sel_hi:[1,0]
    v_pk_min_u16 v25, v25, v37
    v_and_b32 v36, 0x7fff7fff, v58
    v_pk_sub_u16 v36, v36, 1 op_sel_hi:[1,0]
    v_pk_min_u16 v25, v25, v36
    v_and_b32 v37, 0x7fff7fff, v59
    v_pk_sub_u16 v37, v37, 1 op_sel_hi:[1,0]
    v_pk_min_u16 v25, v25, v37
    v_and_b32 v36, 0x7fff7fff, v60
    v_pk_sub_u16 v36, v36, 1 op_sel_hi:[1,0]
    v_pk_min_u16 v25, v25, v36
    v_and_b32 v37, 0x7fff7fff, v61
    v_pk_sub_u16 v37, v37, 1 op_sel_hi:[1,0]
    v_pk_min_u16 v25, v25, v37
    v_and_b32 v36, 0x7fff7fff, v62
    v_pk_sub_u16 v36, v36, 1 op_sel_hi:[1,0]
    v_pk_min_u16 v25, v25, v36
    v_and_b32 v37, 0x7fff7fff, v63
    v_pk_sub_u16 v37, v37, 1 op_sel_hi:[1,0]
    v_pk_min_u16 v25, v25, v37
    v_mov_b32 v36, 0x38ff38ff
    v_pk_sub_u16 v36, v36, v25 clamp
    v_cmp_ne_u32 vcc, 0, v36
    s_or_b32 s62, 12, 0
    s_getpc_b64 s[92:93]
    s_cbranch_vccnz REC_K
    v_and_b32 v26, 0x7fff7fff, v48
    v_pk_sub_u16 v26, v26, s98 clamp
    v_bfi_b32 v48, s79, v26, v48
    v_and_b32 v27, 0x7fff7fff, v49
    v_pk_sub_u16 v27, v27, s98 clamp
    v_bfi_b32 v49, s79, v27, v49
    v_and_b32 v26, 0x7fff7fff, v50
    v_pk_sub_u16 v26, v26, s98 clamp
    v_bfi_b32 v50, s79, v26, v50
    v_and_b32 v27, 0x7fff7fff, v51
    v_pk_sub_u16 v27, v27, s98 clamp
    v_bfi_b32 v51, s79, v27, v51
    v_and_b32 v26, 0x7fff7fff, v52
    v_pk_sub_u16 v26, v26, s98 clamp
    v_bfi_b32 v52, s79, v26, v52
    v_and_b32 v27, 0x7fff7fff, v53
    v_pk_sub_u16 v27, v27, s98 clamp
    v_bfi_b32 v53, s79, v27, v53
    v_and_b32 v26, 0x7fff7fff, v54
    v_pk_sub_u16 v26, v26, s98 clamp
    v_bfi_b32 v54, s79, v26, v54
    v_and_b32 v27, 0x7fff7fff, v55
    v_pk_sub_u16 v27, v27, s98 clamp
    v_bfi_b32 v55, s79, v27, v55
    v_and_b32 v26, 0x7fff7fff, v56
    v_pk_sub_u16 v26, v26, s98 clamp
    v_bfi_b32 v56, s79, v26, v56
    v_and_b32 v27, 0x7fff7fff, v57
    v_pk_sub_u16 v27, v27, s98 clamp
    v_bfi_b32 v57, s79, v27, v57
    v_and_b32 v26, 0x7fff7fff, v58
    v_pk_sub_u16 v26, v26, s98 clamp
    v_bfi_b32 v58, s79, v26, v58
    v_and_b32 v27, 0x7fff7fff, v59
    v_pk_sub_u16 v27, v27, s98 clamp
    v_bfi_b32 v59, s79, v27, v59
    v_and_b32 v26, 0x7fff7fff, v60
    v_pk_sub_u16 v26, v26, s98 clamp
    v_bfi_b32 v60, s79, v26, v60
    v_and_b32 v27, 0x7fff7fff, v61
    v_pk_sub_u16 v27, v27, s98 clamp
    v_bfi_b32 v61, s79, v27, v61
    v_and_b32 v26, 0x7fff7fff, v62
    v_pk_sub_u16 v26, v26, s98 clamp
    v_bfi_b32 v62, s79, v26, v62
    v_and_b32 v27, 0x7fff7fff, v63
    v_pk_sub_u16 v27, v27, s98 clamp
    v_bfi_b32 v63, s79, v27, v63
    v_or3_b32 v24, v24, v48, v49
    v_or3_b32 v24, v24, v50, v51
    v_or3_b32 v24, v24, v52, v53
    v_or3_b32 v24, v24, v54, v55
    v_or3_b32 v24, v24, v56, v57
    v_or3_b32 v24, v24, v58, v59
    v_or3_b32 v24, v24, v60, v61
    v_or3_b32 v24, v24, v62, v63
    v_lshlrev_b32 v36, 11, v60
    v_and_or_b32 v48, v36, s78, v48
    v_lshlrev_b32 v37, 11, v61
    v_and_or_b32 v49, v37, s78, v49
    v_lshlrev_b32 v36, 11, v62
    v_and_or_b32 v50, v36, s78, v50
    v_lshlrev_b32 v37, 11, v63
    v_and_or_b32 v51, v37, s78, v51
    v_lshlrev_b32 v36, 7, v60
    v_and_or_b32 v52, v36, s78, v52
    v_lshlrev_b32 v37, 7, v61
    v_and_or_b32 v53, v37, s78, v53
    v_lshlrev_b32 v36, 7, v62
    v_and_or_b32 v54, v36, s78, v54
    v_lshlrev_b32 v37, 7, v63
    v_and_or_b32 v55, v37, s78, v55
    v_lshlrev_b32 v36, 3, v60
    v_and_or_b32 v56, v36, s78, v56
    v_lshrrev_b32 v37, 1, v60
    v_and_or_b32 v56, v37, s78, v56
    v_lshlrev_b32 v36, 3, v61
    v_and_or_b32 v57, v36, s78, v57
    v_lshrrev_b32 v37, 1, v61
    v_and_or_b32 v57, v37, s78, v57
    v_lshlrev_b32 v36, 3, v62
    v_and_or_b32 v58, v36, s78, v58
    v_lshrrev_b32 v37, 1, v62
    v_and_or_b32 v58, v37, s78, v58
    v_lshlrev_b32 v36, 3, v63
    v_and_or_b32 v59, v36, s78, v59
    v_lshrrev_b32 v37, 1, v63
    v_and_or_b32 v59, v37, s78, v59
    v_lshlrev_b32 v36, 4, v0
    v_add_u32 v36, s59, v36
    ds_write_b128 v36, v[48:51] offset:14848
    ds_write_b128 v36, v[52:55] offset:15872
    ds_write_b128 v36, v[56:59] offset:16896
    v_and_b32 v24, s78, v24
    v_cmp_ne_u32 vcc, 0, v24
    s_cmp_lg_u64 vcc, 0
    s_cselect_b32 s60, 4096, 0
    s_or_b32 s99, s99, s60
    s_lshl_b32 s60, s57, 2
    v_mov_b32 v28, s60
    s_cmp_eq_u32 s81, 0
    s_cbranch_scc1 RP_15
    s_cmp_eq_u32 s81, 1
    s_cbranch_scc1 RP_16
    s_nop 7
    s_nop 1
RP_14:
    s_nop 7
    s_nop 1
    s_waitcnt vmcnt(20)
    ds_read_b128 v[48:51], v9 offset:0
    ds_read_b128 v[52:55], v10 offset:0
    ds_read_b128 v[56:59], v11 offset:0
    ds_read_b128 v[60:63], v12 offset:0
    s_waitcnt vmcnt(16)
    v_accvgpr_read_b32 v64, a0
    v_accvgpr_read_b32 v65, a1
    v_accvgpr_read_b32 v66, a2
    v_accvgpr_read_b32 v67, a3
    v_accvgpr_read_b32 v68, a4
    v_accvgpr_read_b32 v69, a5
    v_accvgpr_read_b32 v70, a6
    v_accvgpr_read_b32 v71, a7
    v_accvgpr_read_b32 v72, a8
    v_accvgpr_read_b32 v73, a9
    v_accvgpr_read_b32 v74, a10
    v_accvgpr_read_b32 v75, a11
    v_accvgpr_read_b32 v76, a12
    v_accvgpr_read_b32 v77, a13
    v_accvgpr_read_b32 v78, a14
    v_accvgpr_read_b32 v79, a15
    s_waitcnt lgkmcnt(0)
    s_add_u32 s54, s89, 0
    s_add_u32 m0, s59, 0
    s_nop 0
    buffer_load_dwordx4 v4, s[4:7], s54 offen offset:0 nt lds
    buffer_load_dwordx4 v5, s[4:7], s54 offen offset:1024 nt lds
    buffer_load_dwordx4 v6, s[4:7], s54 offen offset:2048 nt lds
    buffer_load_dwordx4 v7, s[4:7], s54 offen offset:3072 nt lds
    buffer_load_dwordx4 a[0:3], v8, s[8:11], s54 offen offset:0 nt
    buffer_load_dwordx4 a[4:7], v8, s[8:11], s54 offen offset:256 nt
    buffer_load_dwordx4 a[8:11], v8, s[8:11], s54 offen offset:512 nt
    buffer_load_dwordx4 a[12:15], v8, s[8:11], s54 offen offset:768 nt
    v_and_b32 v25, 0x7fff7fff, v64
    v_pk_sub_u16 v25, v25, 1 op_sel_hi:[1,0]
    v_and_b32 v37, 0x7fff7fff, v65
    v_pk_sub_u16 v37, v37, 1 op_sel_hi:[1,0]
    v_pk_min_u16 v25, v25, v37
    v_and_b32 v36, 0x7fff7fff, v66
    v_pk_sub_u16 v36, v36, 1 op_sel_hi:[1,0]
    v_pk_min_u16 v25, v25, v36
    v_and_b32 v37, 0x7fff7fff, v67
    v_pk_sub_u16 v37, v37, 1 op_sel_hi:[1,0]
    v_pk_min_u16 v25, v25, v37
    v_and_b32 v36, 0x7fff7fff, v68
    v_pk_sub_u16 v36, v36, 1 op_sel_hi:[1,0]
    v_pk_min_u16 v25, v25, v36
    v_and_b32 v37, 0x7fff7fff, v69
    v_pk_sub_u16 v37, v37, 1 op_sel_hi:[1,0]
    v_pk_min_u16 v25, v25, v37
    v_and_b32 v36, 0x7fff7fff, v70
    v_pk_sub_u16 v36, v36, 1 op_sel_hi:[1,0]
    v_pk_min_u16 v25, v25, v36
    v_and_b32 v37, 0x7fff7fff, v71
    v_pk_sub_u16 v37, v37, 1 op_sel_hi:[1,0]
    v_pk_min_u16 v25, v25, v37
    v_and_b32 v36, 0x7fff7fff, v72
    v_pk_sub_u16 v36, v36, 1 op_sel_hi:[1,0]
    v_pk_min_u16 v25, v25, v36
    v_and_b32 v37, 0x7fff7fff, v73
    v_pk_sub_u16 v37, v37, 1 op_sel_hi:[1,0]
    v_pk_min_u16 v25, v25, v37
    v_and_b32 v36, 0x7fff7fff, v74
    v_pk_sub_u16 v36, v36, 1 op_sel_hi:[1,0]
    v_pk_min_u16 v25, v25, v36
    v_and_b32 v37, 0x7fff7fff, v75
    v_pk_sub_u16 v37, v37, 1 op_sel_hi:[1,0]
    v_pk_min_u16 v25, v25, v37
    v_and_b32 v36, 0x7fff7fff, v76
    v_pk_sub_u16 v36, v36, 1 op_sel_hi:[1,0]
    v_pk_min_u16 v25, v25, v36
    v_and_b32 v37, 0x7fff7fff, v77
    v_pk_sub_u16 v37, v37, 1 op_sel_hi:[1,0]
    v_pk_min_u16 v25, v25, v37
    v_and_b32 v36, 0x7fff7fff, v78
    v_pk_sub_u16 v36, v36, 1 op_sel_hi:[1,0]
    v_pk_min_u16 v25, v25, v36
    v_and_b32 v37, 0x7fff7fff, v79
    v_pk_sub_u16 v37, v37, 1 op_sel_hi:[1,0]
    v_pk_min_u16 v25, v25, v37
    v_mov_b32 v36, 0x397f397f
    v_pk_sub_u16 v36, v36, v25 clamp
    v_cmp_ne_u32 vcc, 0, v36
    s_or_b32 s62, 45, 0
    s_getpc_b64 s[92:93]
    s_cbranch_vccnz REC_V
    v_and_b32 v26, 0x7fff7fff, v64
    v_pk_sub_u16 v26, v26, s94 clamp
    v_bfi_b32 v64, s79, v26, v64
    v_and_b32 v27, 0x7fff7fff, v65
    v_pk_sub_u16 v27, v27, s94 clamp
    v_bfi_b32 v65, s79, v27, v65
    v_and_b32 v26, 0x7fff7fff, v66
    v_pk_sub_u16 v26, v26, s94 clamp
    v_bfi_b32 v66, s79, v26, v66
    v_and_b32 v27, 0x7fff7fff, v67
    v_pk_sub_u16 v27, v27, s94 clamp
    v_bfi_b32 v67, s79, v27, v67
    v_and_b32 v26, 0x7fff7fff, v68
    v_pk_sub_u16 v26, v26, s94 clamp
    v_bfi_b32 v68, s79, v26, v68
    v_and_b32 v27, 0x7fff7fff, v69
    v_pk_sub_u16 v27, v27, s94 clamp
    v_bfi_b32 v69, s79, v27, v69
    v_and_b32 v26, 0x7fff7fff, v70
    v_pk_sub_u16 v26, v26, s94 clamp
    v_bfi_b32 v70, s79, v26, v70
    v_and_b32 v27, 0x7fff7fff, v71
    v_pk_sub_u16 v27, v27, s94 clamp
    v_bfi_b32 v71, s79, v27, v71
    v_and_b32 v26, 0x7fff7fff, v72
    v_pk_sub_u16 v26, v26, s94 clamp
    v_bfi_b32 v72, s79, v26, v72
    v_and_b32 v27, 0x7fff7fff, v73
    v_pk_sub_u16 v27, v27, s94 clamp
    v_bfi_b32 v73, s79, v27, v73
    v_and_b32 v26, 0x7fff7fff, v74
    v_pk_sub_u16 v26, v26, s94 clamp
    v_bfi_b32 v74, s79, v26, v74
    v_and_b32 v27, 0x7fff7fff, v75
    v_pk_sub_u16 v27, v27, s94 clamp
    v_bfi_b32 v75, s79, v27, v75
    v_and_b32 v26, 0x7fff7fff, v76
    v_pk_sub_u16 v26, v26, s94 clamp
    v_bfi_b32 v76, s79, v26, v76
    v_and_b32 v27, 0x7fff7fff, v77
    v_pk_sub_u16 v27, v27, s94 clamp
    v_bfi_b32 v77, s79, v27, v77
    v_and_b32 v26, 0x7fff7fff, v78
    v_pk_sub_u16 v26, v26, s94 clamp
    v_bfi_b32 v78, s79, v26, v78
    v_and_b32 v27, 0x7fff7fff, v79
    v_pk_sub_u16 v27, v27, s94 clamp
    v_bfi_b32 v79, s79, v27, v79
    v_or_b32 v24, v64, v65
    v_or3_b32 v24, v24, v66, v67
    v_or3_b32 v24, v24, v68, v69
    v_or3_b32 v24, v24, v70, v71
    v_or3_b32 v24, v24, v72, v73
    v_or3_b32 v24, v24, v74, v75
    v_or3_b32 v24, v24, v76, v77
    v_or3_b32 v24, v24, v78, v79
    v_lshlrev_b32 v36, 11, v76
    v_and_or_b32 v236, v36, s78, v64
    v_lshlrev_b32 v37, 11, v77
    v_and_or_b32 v237, v37, s78, v65
    v_lshlrev_b32 v36, 11, v78
    v_and_or_b32 v238, v36, s78, v66
    v_lshlrev_b32 v37, 11, v79
    v_and_or_b32 v239, v37, s78, v67
    v_lshlrev_b32 v36, 7, v76
    v_and_or_b32 v240, v36, s78, v68
    v_lshlrev_b32 v37, 7, v77
    v_and_or_b32 v241, v37, s78, v69
    v_lshlrev_b32 v36, 7, v78
    v_and_or_b32 v242, v36, s78, v70
    v_lshlrev_b32 v37, 7, v79
    v_and_or_b32 v243, v37, s78, v71
    v_lshlrev_b32 v36, 3, v76
    v_and_or_b32 v72, v36, s78, v72
    v_lshrrev_b32 v37, 1, v76
    v_and_or_b32 v244, v37, s78, v72
    v_lshlrev_b32 v36, 3, v77
    v_and_or_b32 v73, v36, s78, v73
    v_lshrrev_b32 v37, 1, v77
    v_and_or_b32 v245, v37, s78, v73
    v_lshlrev_b32 v36, 3, v78
    v_and_or_b32 v74, v36, s78, v74
    v_lshrrev_b32 v37, 1, v78
    v_and_or_b32 v246, v37, s78, v74
    v_lshlrev_b32 v36, 3, v79
    v_and_or_b32 v75, v36, s78, v75
    v_lshrrev_b32 v37, 1, v79
    v_and_or_b32 v247, v37, s78, v75
    v_and_b32 v25, 0x7fff7fff, v48
    v_pk_sub_u16 v25, v25, 1 op_sel_hi:[1,0]
    v_and_b32 v37, 0x7fff7fff, v49
    v_pk_sub_u16 v37, v37, 1 op_sel_hi:[1,0]
    v_pk_min_u16 v25, v25, v37
    v_and_b32 v36, 0x7fff7fff, v50
    v_pk_sub_u16 v36, v36, 1 op_sel_hi:[1,0]
    v_pk_min_u16 v25, v25, v36
    v_and_b32 v37, 0x7fff7fff, v51
    v_pk_sub_u16 v37, v37, 1 op_sel_hi:[1,0]
    v_pk_min_u16 v25, v25, v37
    v_and_b32 v36, 0x7fff7fff, v52
    v_pk_sub_u16 v36, v36, 1 op_sel_hi:[1,0]
    v_pk_min_u16 v25, v25, v36
    v_and_b32 v37, 0x7fff7fff, v53
    v_pk_sub_u16 v37, v37, 1 op_sel_hi:[1,0]
    v_pk_min_u16 v25, v25, v37
    v_and_b32 v36, 0x7fff7fff, v54
    v_pk_sub_u16 v36, v36, 1 op_sel_hi:[1,0]
    v_pk_min_u16 v25, v25, v36
    v_and_b32 v37, 0x7fff7fff, v55
    v_pk_sub_u16 v37, v37, 1 op_sel_hi:[1,0]
    v_pk_min_u16 v25, v25, v37
    v_and_b32 v36, 0x7fff7fff, v56
    v_pk_sub_u16 v36, v36, 1 op_sel_hi:[1,0]
    v_pk_min_u16 v25, v25, v36
    v_and_b32 v37, 0x7fff7fff, v57
    v_pk_sub_u16 v37, v37, 1 op_sel_hi:[1,0]
    v_pk_min_u16 v25, v25, v37
    v_and_b32 v36, 0x7fff7fff, v58
    v_pk_sub_u16 v36, v36, 1 op_sel_hi:[1,0]
    v_pk_min_u16 v25, v25, v36
    v_and_b32 v37, 0x7fff7fff, v59
    v_pk_sub_u16 v37, v37, 1 op_sel_hi:[1,0]
    v_pk_min_u16 v25, v25, v37
    v_and_b32 v36, 0x7fff7fff, v60
    v_pk_sub_u16 v36, v36, 1 op_sel_hi:[1,0]
    v_pk_min_u16 v25, v25, v36
    v_and_b32 v37, 0x7fff7fff, v61
    v_pk_sub_u16 v37, v37, 1 op_sel_hi:[1,0]
    v_pk_min_u16 v25, v25, v37
    v_and_b32 v36, 0x7fff7fff, v62
    v_pk_sub_u16 v36, v36, 1 op_sel_hi:[1,0]
    v_pk_min_u16 v25, v25, v36
    v_and_b32 v37, 0x7fff7fff, v63
    v_pk_sub_u16 v37, v37, 1 op_sel_hi:[1,0]
    v_pk_min_u16 v25, v25, v37
    v_mov_b32 v36, 0x38ff38ff
    v_pk_sub_u16 v36, v36, v25 clamp
    v_cmp_ne_u32 vcc, 0, v36
    s_or_b32 s62, 13, 0
    s_getpc_b64 s[92:93]
    s_cbranch_vccnz REC_K
    v_and_b32 v26, 0x7fff7fff, v48
    v_pk_sub_u16 v26, v26, s98 clamp
    v_bfi_b32 v48, s79, v26, v48
    v_and_b32 v27, 0x7fff7fff, v49
    v_pk_sub_u16 v27, v27, s98 clamp
    v_bfi_b32 v49, s79, v27, v49
    v_and_b32 v26, 0x7fff7fff, v50
    v_pk_sub_u16 v26, v26, s98 clamp
    v_bfi_b32 v50, s79, v26, v50
    v_and_b32 v27, 0x7fff7fff, v51
    v_pk_sub_u16 v27, v27, s98 clamp
    v_bfi_b32 v51, s79, v27, v51
    v_and_b32 v26, 0x7fff7fff, v52
    v_pk_sub_u16 v26, v26, s98 clamp
    v_bfi_b32 v52, s79, v26, v52
    v_and_b32 v27, 0x7fff7fff, v53
    v_pk_sub_u16 v27, v27, s98 clamp
    v_bfi_b32 v53, s79, v27, v53
    v_and_b32 v26, 0x7fff7fff, v54
    v_pk_sub_u16 v26, v26, s98 clamp
    v_bfi_b32 v54, s79, v26, v54
    v_and_b32 v27, 0x7fff7fff, v55
    v_pk_sub_u16 v27, v27, s98 clamp
    v_bfi_b32 v55, s79, v27, v55
    v_and_b32 v26, 0x7fff7fff, v56
    v_pk_sub_u16 v26, v26, s98 clamp
    v_bfi_b32 v56, s79, v26, v56
    v_and_b32 v27, 0x7fff7fff, v57
    v_pk_sub_u16 v27, v27, s98 clamp
    v_bfi_b32 v57, s79, v27, v57
    v_and_b32 v26, 0x7fff7fff, v58
    v_pk_sub_u16 v26, v26, s98 clamp
    v_bfi_b32 v58, s79, v26, v58
    v_and_b32 v27, 0x7fff7fff, v59
    v_pk_sub_u16 v27, v27, s98 clamp
    v_bfi_b32 v59, s79, v27, v59
    v_and_b32 v26, 0x7fff7fff, v60
    v_pk_sub_u16 v26, v26, s98 clamp
    v_bfi_b32 v60, s79, v26, v60
    v_and_b32 v27, 0x7fff7fff, v61
    v_pk_sub_u16 v27, v27, s98 clamp
    v_bfi_b32 v61, s79, v27, v61
    v_and_b32 v26, 0x7fff7fff, v62
    v_pk_sub_u16 v26, v26, s98 clamp
    v_bfi_b32 v62, s79, v26, v62
    v_and_b32 v27, 0x7fff7fff, v63
    v_pk_sub_u16 v27, v27, s98 clamp
    v_bfi_b32 v63, s79, v27, v63
    v_or3_b32 v24, v24, v48, v49
    v_or3_b32 v24, v24, v50, v51
    v_or3_b32 v24, v24, v52, v53
    v_or3_b32 v24, v24, v54, v55
    v_or3_b32 v24, v24, v56, v57
    v_or3_b32 v24, v24, v58, v59
    v_or3_b32 v24, v24, v60, v61
    v_or3_b32 v24, v24, v62, v63
    v_lshlrev_b32 v36, 11, v60
    v_and_or_b32 v48, v36, s78, v48
    v_lshlrev_b32 v37, 11, v61
    v_and_or_b32 v49, v37, s78, v49
    v_lshlrev_b32 v36, 11, v62
    v_and_or_b32 v50, v36, s78, v50
    v_lshlrev_b32 v37, 11, v63
    v_and_or_b32 v51, v37, s78, v51
    v_lshlrev_b32 v36, 7, v60
    v_and_or_b32 v52, v36, s78, v52
    v_lshlrev_b32 v37, 7, v61
    v_and_or_b32 v53, v37, s78, v53
    v_lshlrev_b32 v36, 7, v62
    v_and_or_b32 v54, v36, s78, v54
    v_lshlrev_b32 v37, 7, v63
    v_and_or_b32 v55, v37, s78, v55
    v_lshlrev_b32 v36, 3, v60
    v_and_or_b32 v56, v36, s78, v56
    v_lshrrev_b32 v37, 1, v60
    v_and_or_b32 v56, v37, s78, v56
    v_lshlrev_b32 v36, 3, v61
    v_and_or_b32 v57, v36, s78, v57
    v_lshrrev_b32 v37, 1, v61
    v_and_or_b32 v57, v37, s78, v57
    v_lshlrev_b32 v36, 3, v62
    v_and_or_b32 v58, v36, s78, v58
    v_lshrrev_b32 v37, 1, v62
    v_and_or_b32 v58, v37, s78, v58
    v_lshlrev_b32 v36, 3, v63
    v_and_or_b32 v59, v36, s78, v59
    v_lshrrev_b32 v37, 1, v63
    v_and_or_b32 v59, v37, s78, v59
    v_lshlrev_b32 v36, 4, v0
    v_add_u32 v36, s59, v36
    ds_write_b128 v36, v[48:51] offset:17920
    ds_write_b128 v36, v[52:55] offset:18944
    ds_write_b128 v36, v[56:59] offset:19968
    v_and_b32 v24, s78, v24
    v_cmp_ne_u32 vcc, 0, v24
    s_cmp_lg_u64 vcc, 0
    s_cselect_b32 s60, 8192, 0
    s_or_b32 s99, s99, s60
    s_waitcnt vmcnt(20)
    ds_read_b128 v[48:51], v9 offset:4096
    ds_read_b128 v[52:55], v10 offset:4096
    ds_read_b128 v[56:59], v11 offset:4096
    ds_read_b128 v[60:63], v12 offset:4096
    s_waitcnt vmcnt(16)
    v_accvgpr_read_b32 v64, a16
    v_accvgpr_read_b32 v65, a17
    v_accvgpr_read_b32 v66, a18
    v_accvgpr_read_b32 v67, a19
    v_accvgpr_read_b32 v68, a20
    v_accvgpr_read_b32 v69, a21
    v_accvgpr_read_b32 v70, a22
    v_accvgpr_read_b32 v71, a23
    v_accvgpr_read_b32 v72, a24
    v_accvgpr_read_b32 v73, a25
    v_accvgpr_read_b32 v74, a26
    v_accvgpr_read_b32 v75, a27
    v_accvgpr_read_b32 v76, a28
    v_accvgpr_read_b32 v77, a29
    v_accvgpr_read_b32 v78, a30
    v_accvgpr_read_b32 v79, a31
    s_waitcnt lgkmcnt(0)
    s_add_u32 s54, s89, 4096
    s_add_u32 m0, s59, 4096
    s_nop 0
    buffer_load_dwordx4 v4, s[4:7], s54 offen offset:0 nt lds
    buffer_load_dwordx4 v5, s[4:7], s54 offen offset:1024 nt lds
    buffer_load_dwordx4 v6, s[4:7], s54 offen offset:2048 nt lds
    buffer_load_dwordx4 v7, s[4:7], s54 offen offset:3072 nt lds
    buffer_load_dwordx4 a[16:19], v8, s[8:11], s54 offen offset:0 nt
    buffer_load_dwordx4 a[20:23], v8, s[8:11], s54 offen offset:256 nt
    buffer_load_dwordx4 a[24:27], v8, s[8:11], s54 offen offset:512 nt
    buffer_load_dwordx4 a[28:31], v8, s[8:11], s54 offen offset:768 nt
    v_and_b32 v25, 0x7fff7fff, v64
    v_pk_sub_u16 v25, v25, 1 op_sel_hi:[1,0]
    v_and_b32 v37, 0x7fff7fff, v65
    v_pk_sub_u16 v37, v37, 1 op_sel_hi:[1,0]
    v_pk_min_u16 v25, v25, v37
    v_and_b32 v36, 0x7fff7fff, v66
    v_pk_sub_u16 v36, v36, 1 op_sel_hi:[1,0]
    v_pk_min_u16 v25, v25, v36
    v_and_b32 v37, 0x7fff7fff, v67
    v_pk_sub_u16 v37, v37, 1 op_sel_hi:[1,0]
    v_pk_min_u16 v25, v25, v37
    v_and_b32 v36, 0x7fff7fff, v68
    v_pk_sub_u16 v36, v36, 1 op_sel_hi:[1,0]
    v_pk_min_u16 v25, v25, v36
    v_and_b32 v37, 0x7fff7fff, v69
    v_pk_sub_u16 v37, v37, 1 op_sel_hi:[1,0]
    v_pk_min_u16 v25, v25, v37
    v_and_b32 v36, 0x7fff7fff, v70
    v_pk_sub_u16 v36, v36, 1 op_sel_hi:[1,0]
    v_pk_min_u16 v25, v25, v36
    v_and_b32 v37, 0x7fff7fff, v71
    v_pk_sub_u16 v37, v37, 1 op_sel_hi:[1,0]
    v_pk_min_u16 v25, v25, v37
    v_and_b32 v36, 0x7fff7fff, v72
    v_pk_sub_u16 v36, v36, 1 op_sel_hi:[1,0]
    v_pk_min_u16 v25, v25, v36
    v_and_b32 v37, 0x7fff7fff, v73
    v_pk_sub_u16 v37, v37, 1 op_sel_hi:[1,0]
    v_pk_min_u16 v25, v25, v37
    v_and_b32 v36, 0x7fff7fff, v74
    v_pk_sub_u16 v36, v36, 1 op_sel_hi:[1,0]
    v_pk_min_u16 v25, v25, v36
    v_and_b32 v37, 0x7fff7fff, v75
    v_pk_sub_u16 v37, v37, 1 op_sel_hi:[1,0]
    v_pk_min_u16 v25, v25, v37
    v_and_b32 v36, 0x7fff7fff, v76
    v_pk_sub_u16 v36, v36, 1 op_sel_hi:[1,0]
    v_pk_min_u16 v25, v25, v36
    v_and_b32 v37, 0x7fff7fff, v77
    v_pk_sub_u16 v37, v37, 1 op_sel_hi:[1,0]
    v_pk_min_u16 v25, v25, v37
    v_and_b32 v36, 0x7fff7fff, v78
    v_pk_sub_u16 v36, v36, 1 op_sel_hi:[1,0]
    v_pk_min_u16 v25, v25, v36
    v_and_b32 v37, 0x7fff7fff, v79
    v_pk_sub_u16 v37, v37, 1 op_sel_hi:[1,0]
    v_pk_min_u16 v25, v25, v37
    v_mov_b32 v36, 0x397f397f
    v_pk_sub_u16 v36, v36, v25 clamp
    v_cmp_ne_u32 vcc, 0, v36
    s_or_b32 s62, 46, 0
    s_getpc_b64 s[92:93]
    s_cbranch_vccnz REC_V
    v_and_b32 v26, 0x7fff7fff, v64
    v_pk_sub_u16 v26, v26, s94 clamp
    v_bfi_b32 v64, s79, v26, v64
    v_and_b32 v27, 0x7fff7fff, v65
    v_pk_sub_u16 v27, v27, s94 clamp
    v_bfi_b32 v65, s79, v27, v65
    v_and_b32 v26, 0x7fff7fff, v66
    v_pk_sub_u16 v26, v26, s94 clamp
    v_bfi_b32 v66, s79, v26, v66
    v_and_b32 v27, 0x7fff7fff, v67
    v_pk_sub_u16 v27, v27, s94 clamp
    v_bfi_b32 v67, s79, v27, v67
    v_and_b32 v26, 0x7fff7fff, v68
    v_pk_sub_u16 v26, v26, s94 clamp
    v_bfi_b32 v68, s79, v26, v68
    v_and_b32 v27, 0x7fff7fff, v69
    v_pk_sub_u16 v27, v27, s94 clamp
    v_bfi_b32 v69, s79, v27, v69
    v_and_b32 v26, 0x7fff7fff, v70
    v_pk_sub_u16 v26, v26, s94 clamp
    v_bfi_b32 v70, s79, v26, v70
    v_and_b32 v27, 0x7fff7fff, v71
    v_pk_sub_u16 v27, v27, s94 clamp
    v_bfi_b32 v71, s79, v27, v71
    v_and_b32 v26, 0x7fff7fff, v72
    v_pk_sub_u16 v26, v26, s94 clamp
    v_bfi_b32 v72, s79, v26, v72
    v_and_b32 v27, 0x7fff7fff, v73
    v_pk_sub_u16 v27, v27, s94 clamp
    v_bfi_b32 v73, s79, v27, v73
    v_and_b32 v26, 0x7fff7fff, v74
    v_pk_sub_u16 v26, v26, s94 clamp
    v_bfi_b32 v74, s79, v26, v74
    v_and_b32 v27, 0x7fff7fff, v75
    v_pk_sub_u16 v27, v27, s94 clamp
    v_bfi_b32 v75, s79, v27, v75
    v_and_b32 v26, 0x7fff7fff, v76
    v_pk_sub_u16 v26, v26, s94 clamp
    v_bfi_b32 v76, s79, v26, v76
    v_and_b32 v27, 0x7fff7fff, v77
    v_pk_sub_u16 v27, v27, s94 clamp
    v_bfi_b32 v77, s79, v27, v77
    v_and_b32 v26, 0x7fff7fff, v78
    v_pk_sub_u16 v26, v26, s94 clamp
    v_bfi_b32 v78, s79, v26, v78
    v_and_b32 v27, 0x7fff7fff, v79
    v_pk_sub_u16 v27, v27, s94 clamp
    v_bfi_b32 v79, s79, v27, v79
    v_or_b32 v24, v64, v65
    v_or3_b32 v24, v24, v66, v67
    v_or3_b32 v24, v24, v68, v69
    v_or3_b32 v24, v24, v70, v71
    v_or3_b32 v24, v24, v72, v73
    v_or3_b32 v24, v24, v74, v75
    v_or3_b32 v24, v24, v76, v77
    v_or3_b32 v24, v24, v78, v79
    v_lshlrev_b32 v36, 11, v76
    v_and_or_b32 v248, v36, s78, v64
    v_lshlrev_b32 v37, 11, v77
    v_and_or_b32 v249, v37, s78, v65
    v_lshlrev_b32 v36, 11, v78
    v_and_or_b32 v250, v36, s78, v66
    v_lshlrev_b32 v37, 11, v79
    v_and_or_b32 v251, v37, s78, v67
    v_lshlrev_b32 v36, 7, v76
    v_and_or_b32 v252, v36, s78, v68
    v_lshlrev_b32 v37, 7, v77
    v_and_or_b32 v253, v37, s78, v69
    v_lshlrev_b32 v36, 7, v78
    v_and_or_b32 v254, v36, s78, v70
    v_lshlrev_b32 v37, 7, v79
    v_and_or_b32 v255, v37, s78, v71
    v_lshlrev_b32 v36, 3, v76
    v_and_or_b32 v72, v36, s78, v72
    v_lshrrev_b32 v37, 1, v76
    v_and_or_b32 v72, v37, s78, v72
    v_accvgpr_write_b32 a32, v72
    v_lshlrev_b32 v36, 3, v77
    v_and_or_b32 v73, v36, s78, v73
    v_lshrrev_b32 v37, 1, v77
    v_and_or_b32 v73, v37, s78, v73
    v_accvgpr_write_b32 a33, v73
    v_lshlrev_b32 v36, 3, v78
    v_and_or_b32 v74, v36, s78, v74
    v_lshrrev_b32 v37, 1, v78
    v_and_or_b32 v74, v37, s78, v74
    v_accvgpr_write_b32 a34, v74
    v_lshlrev_b32 v36, 3, v79
    v_and_or_b32 v75, v36, s78, v75
    v_lshrrev_b32 v37, 1, v79
    v_and_or_b32 v75, v37, s78, v75
    v_accvgpr_write_b32 a35, v75
    v_and_b32 v25, 0x7fff7fff, v48
    v_pk_sub_u16 v25, v25, 1 op_sel_hi:[1,0]
    v_and_b32 v37, 0x7fff7fff, v49
    v_pk_sub_u16 v37, v37, 1 op_sel_hi:[1,0]
    v_pk_min_u16 v25, v25, v37
    v_and_b32 v36, 0x7fff7fff, v50
    v_pk_sub_u16 v36, v36, 1 op_sel_hi:[1,0]
    v_pk_min_u16 v25, v25, v36
    v_and_b32 v37, 0x7fff7fff, v51
    v_pk_sub_u16 v37, v37, 1 op_sel_hi:[1,0]
    v_pk_min_u16 v25, v25, v37
    v_and_b32 v36, 0x7fff7fff, v52
    v_pk_sub_u16 v36, v36, 1 op_sel_hi:[1,0]
    v_pk_min_u16 v25, v25, v36
    v_and_b32 v37, 0x7fff7fff, v53
    v_pk_sub_u16 v37, v37, 1 op_sel_hi:[1,0]
    v_pk_min_u16 v25, v25, v37
    v_and_b32 v36, 0x7fff7fff, v54
    v_pk_sub_u16 v36, v36, 1 op_sel_hi:[1,0]
    v_pk_min_u16 v25, v25, v36
    v_and_b32 v37, 0x7fff7fff, v55
    v_pk_sub_u16 v37, v37, 1 op_sel_hi:[1,0]
    v_pk_min_u16 v25, v25, v37
    v_and_b32 v36, 0x7fff7fff, v56
    v_pk_sub_u16 v36, v36, 1 op_sel_hi:[1,0]
    v_pk_min_u16 v25, v25, v36
    v_and_b32 v37, 0x7fff7fff, v57
    v_pk_sub_u16 v37, v37, 1 op_sel_hi:[1,0]
    v_pk_min_u16 v25, v25, v37
    v_and_b32 v36, 0x7fff7fff, v58
    v_pk_sub_u16 v36, v36, 1 op_sel_hi:[1,0]
    v_pk_min_u16 v25, v25, v36
    v_and_b32 v37, 0x7fff7fff, v59
    v_pk_sub_u16 v37, v37, 1 op_sel_hi:[1,0]
    v_pk_min_u16 v25, v25, v37
    v_and_b32 v36, 0x7fff7fff, v60
    v_pk_sub_u16 v36, v36, 1 op_sel_hi:[1,0]
    v_pk_min_u16 v25, v25, v36
    v_and_b32 v37, 0x7fff7fff, v61
    v_pk_sub_u16 v37, v37, 1 op_sel_hi:[1,0]
    v_pk_min_u16 v25, v25, v37
    v_and_b32 v36, 0x7fff7fff, v62
    v_pk_sub_u16 v36, v36, 1 op_sel_hi:[1,0]
    v_pk_min_u16 v25, v25, v36
    v_and_b32 v37, 0x7fff7fff, v63
    v_pk_sub_u16 v37, v37, 1 op_sel_hi:[1,0]
    v_pk_min_u16 v25, v25, v37
    v_mov_b32 v36, 0x38ff38ff
    v_pk_sub_u16 v36, v36, v25 clamp
    v_cmp_ne_u32 vcc, 0, v36
    s_or_b32 s62, 14, 0
    s_getpc_b64 s[92:93]
    s_cbranch_vccnz REC_K
    v_and_b32 v26, 0x7fff7fff, v48
    v_pk_sub_u16 v26, v26, s98 clamp
    v_bfi_b32 v48, s79, v26, v48
    v_and_b32 v27, 0x7fff7fff, v49
    v_pk_sub_u16 v27, v27, s98 clamp
    v_bfi_b32 v49, s79, v27, v49
    v_and_b32 v26, 0x7fff7fff, v50
    v_pk_sub_u16 v26, v26, s98 clamp
    v_bfi_b32 v50, s79, v26, v50
    v_and_b32 v27, 0x7fff7fff, v51
    v_pk_sub_u16 v27, v27, s98 clamp
    v_bfi_b32 v51, s79, v27, v51
    v_and_b32 v26, 0x7fff7fff, v52
    v_pk_sub_u16 v26, v26, s98 clamp
    v_bfi_b32 v52, s79, v26, v52
    v_and_b32 v27, 0x7fff7fff, v53
    v_pk_sub_u16 v27, v27, s98 clamp
    v_bfi_b32 v53, s79, v27, v53
    v_and_b32 v26, 0x7fff7fff, v54
    v_pk_sub_u16 v26, v26, s98 clamp
    v_bfi_b32 v54, s79, v26, v54
    v_and_b32 v27, 0x7fff7fff, v55
    v_pk_sub_u16 v27, v27, s98 clamp
    v_bfi_b32 v55, s79, v27, v55
    v_and_b32 v26, 0x7fff7fff, v56
    v_pk_sub_u16 v26, v26, s98 clamp
    v_bfi_b32 v56, s79, v26, v56
    v_and_b32 v27, 0x7fff7fff, v57
    v_pk_sub_u16 v27, v27, s98 clamp
    v_bfi_b32 v57, s79, v27, v57
    v_and_b32 v26, 0x7fff7fff, v58
    v_pk_sub_u16 v26, v26, s98 clamp
    v_bfi_b32 v58, s79, v26, v58
    v_and_b32 v27, 0x7fff7fff, v59
    v_pk_sub_u16 v27, v27, s98 clamp
    v_bfi_b32 v59, s79, v27, v59
    v_and_b32 v26, 0x7fff7fff, v60
    v_pk_sub_u16 v26, v26, s98 clamp
    v_bfi_b32 v60, s79, v26, v60
    v_and_b32 v27, 0x7fff7fff, v61
    v_pk_sub_u16 v27, v27, s98 clamp
    v_bfi_b32 v61, s79, v27, v61
    v_and_b32 v26, 0x7fff7fff, v62
    v_pk_sub_u16 v26, v26, s98 clamp
    v_bfi_b32 v62, s79, v26, v62
    v_and_b32 v27, 0x7fff7fff, v63
    v_pk_sub_u16 v27, v27, s98 clamp
    v_bfi_b32 v63, s79, v27, v63
    v_or3_b32 v24, v24, v48, v49
    v_or3_b32 v24, v24, v50, v51
    v_or3_b32 v24, v24, v52, v53
    v_or3_b32 v24, v24, v54, v55
    v_or3_b32 v24, v24, v56, v57
    v_or3_b32 v24, v24, v58, v59
    v_or3_b32 v24, v24, v60, v61
    v_or3_b32 v24, v24, v62, v63
    v_lshlrev_b32 v36, 11, v60
    v_and_or_b32 v48, v36, s78, v48
    v_lshlrev_b32 v37, 11, v61
    v_and_or_b32 v49, v37, s78, v49
    v_lshlrev_b32 v36, 11, v62
    v_and_or_b32 v50, v36, s78, v50
    v_lshlrev_b32 v37, 11, v63
    v_and_or_b32 v51, v37, s78, v51
    v_lshlrev_b32 v36, 7, v60
    v_and_or_b32 v52, v36, s78, v52
    v_lshlrev_b32 v37, 7, v61
    v_and_or_b32 v53, v37, s78, v53
    v_lshlrev_b32 v36, 7, v62
    v_and_or_b32 v54, v36, s78, v54
    v_lshlrev_b32 v37, 7, v63
    v_and_or_b32 v55, v37, s78, v55
    v_lshlrev_b32 v36, 3, v60
    v_and_or_b32 v56, v36, s78, v56
    v_lshrrev_b32 v37, 1, v60
    v_and_or_b32 v56, v37, s78, v56
    v_lshlrev_b32 v36, 3, v61
    v_and_or_b32 v57, v36, s78, v57
    v_lshrrev_b32 v37, 1, v61
    v_and_or_b32 v57, v37, s78, v57
    v_lshlrev_b32 v36, 3, v62
    v_and_or_b32 v58, v36, s78, v58
    v_lshrrev_b32 v37, 1, v62
    v_and_or_b32 v58, v37, s78, v58
    v_lshlrev_b32 v36, 3, v63
    v_and_or_b32 v59, v36, s78, v59
    v_lshrrev_b32 v37, 1, v63
    v_and_or_b32 v59, v37, s78, v59
    v_lshlrev_b32 v36, 4, v0
    v_add_u32 v36, s59, v36
    ds_write_b128 v36, v[48:51] offset:20992
    ds_write_b128 v36, v[52:55] offset:22016
    ds_write_b128 v36, v[56:59] offset:23040
    v_and_b32 v24, s78, v24
    v_cmp_ne_u32 vcc, 0, v24
    s_cmp_lg_u64 vcc, 0
    s_cselect_b32 s60, 16384, 0
    s_or_b32 s99, s99, s60
    s_waitcnt vmcnt(20)
    ds_read_b128 v[48:51], v9 offset:32768
    ds_read_b128 v[52:55], v10 offset:32768
    ds_read_b128 v[56:59], v11 offset:32768
    ds_read_b128 v[60:63], v12 offset:32768
    s_waitcnt vmcnt(16)
    v_accvgpr_read_b32 v64, a232
    v_accvgpr_read_b32 v65, a233
    v_accvgpr_read_b32 v66, a234
    v_accvgpr_read_b32 v67, a235
    v_accvgpr_read_b32 v68, a236
    v_accvgpr_read_b32 v69, a237
    v_accvgpr_read_b32 v70, a238
    v_accvgpr_read_b32 v71, a239
    v_accvgpr_read_b32 v72, a240
    v_accvgpr_read_b32 v73, a241
    v_accvgpr_read_b32 v74, a242
    v_accvgpr_read_b32 v75, a243
    v_accvgpr_read_b32 v76, a244
    v_accvgpr_read_b32 v77, a245
    v_accvgpr_read_b32 v78, a246
    v_accvgpr_read_b32 v79, a247
    s_waitcnt lgkmcnt(0)
    s_add_u32 s54, s89, 8192
    s_add_u32 m0, s59, 32768
    s_nop 0
    buffer_load_dwordx4 v4, s[4:7], s54 offen offset:0 nt lds
    buffer_load_dwordx4 v5, s[4:7], s54 offen offset:1024 nt lds
    buffer_load_dwordx4 v6, s[4:7], s54 offen offset:2048 nt lds
    buffer_load_dwordx4 v7, s[4:7], s54 offen offset:3072 nt lds
    buffer_load_dwordx4 a[232:235], v8, s[8:11], s54 offen offset:0 nt
    buffer_load_dwordx4 a[236:239], v8, s[8:11], s54 offen offset:256 nt
    buffer_load_dwordx4 a[240:243], v8, s[8:11], s54 offen offset:512 nt
    buffer_load_dwordx4 a[244:247], v8, s[8:11], s54 offen offset:768 nt
    v_and_b32 v25, 0x7fff7fff, v64
    v_pk_sub_u16 v25, v25, 1 op_sel_hi:[1,0]
    v_and_b32 v37, 0x7fff7fff, v65
    v_pk_sub_u16 v37, v37, 1 op_sel_hi:[1,0]
    v_pk_min_u16 v25, v25, v37
    v_and_b32 v36, 0x7fff7fff, v66
    v_pk_sub_u16 v36, v36, 1 op_sel_hi:[1,0]
    v_pk_min_u16 v25, v25, v36
    v_and_b32 v37, 0x7fff7fff, v67
    v_pk_sub_u16 v37, v37, 1 op_sel_hi:[1,0]
    v_pk_min_u16 v25, v25, v37
    v_and_b32 v36, 0x7fff7fff, v68
    v_pk_sub_u16 v36, v36, 1 op_sel_hi:[1,0]
    v_pk_min_u16 v25, v25, v36
    v_and_b32 v37, 0x7fff7fff, v69
    v_pk_sub_u16 v37, v37, 1 op_sel_hi:[1,0]
    v_pk_min_u16 v25, v25, v37
    v_and_b32 v36, 0x7fff7fff, v70
    v_pk_sub_u16 v36, v36, 1 op_sel_hi:[1,0]
    v_pk_min_u16 v25, v25, v36
    v_and_b32 v37, 0x7fff7fff, v71
    v_pk_sub_u16 v37, v37, 1 op_sel_hi:[1,0]
    v_pk_min_u16 v25, v25, v37
    v_and_b32 v36, 0x7fff7fff, v72
    v_pk_sub_u16 v36, v36, 1 op_sel_hi:[1,0]
    v_pk_min_u16 v25, v25, v36
    v_and_b32 v37, 0x7fff7fff, v73
    v_pk_sub_u16 v37, v37, 1 op_sel_hi:[1,0]
    v_pk_min_u16 v25, v25, v37
    v_and_b32 v36, 0x7fff7fff, v74
    v_pk_sub_u16 v36, v36, 1 op_sel_hi:[1,0]
    v_pk_min_u16 v25, v25, v36
    v_and_b32 v37, 0x7fff7fff, v75
    v_pk_sub_u16 v37, v37, 1 op_sel_hi:[1,0]
    v_pk_min_u16 v25, v25, v37
    v_and_b32 v36, 0x7fff7fff, v76
    v_pk_sub_u16 v36, v36, 1 op_sel_hi:[1,0]
    v_pk_min_u16 v25, v25, v36
    v_and_b32 v37, 0x7fff7fff, v77
    v_pk_sub_u16 v37, v37, 1 op_sel_hi:[1,0]
    v_pk_min_u16 v25, v25, v37
    v_and_b32 v36, 0x7fff7fff, v78
    v_pk_sub_u16 v36, v36, 1 op_sel_hi:[1,0]
    v_pk_min_u16 v25, v25, v36
    v_and_b32 v37, 0x7fff7fff, v79
    v_pk_sub_u16 v37, v37, 1 op_sel_hi:[1,0]
    v_pk_min_u16 v25, v25, v37
    v_mov_b32 v36, 0x397f397f
    v_pk_sub_u16 v36, v36, v25 clamp
    v_cmp_ne_u32 vcc, 0, v36
    s_or_b32 s62, 47, 0
    s_getpc_b64 s[92:93]
    s_cbranch_vccnz REC_V
    v_and_b32 v26, 0x7fff7fff, v64
    v_pk_sub_u16 v26, v26, s94 clamp
    v_bfi_b32 v64, s79, v26, v64
    v_and_b32 v27, 0x7fff7fff, v65
    v_pk_sub_u16 v27, v27, s94 clamp
    v_bfi_b32 v65, s79, v27, v65
    v_and_b32 v26, 0x7fff7fff, v66
    v_pk_sub_u16 v26, v26, s94 clamp
    v_bfi_b32 v66, s79, v26, v66
    v_and_b32 v27, 0x7fff7fff, v67
    v_pk_sub_u16 v27, v27, s94 clamp
    v_bfi_b32 v67, s79, v27, v67
    v_and_b32 v26, 0x7fff7fff, v68
    v_pk_sub_u16 v26, v26, s94 clamp
    v_bfi_b32 v68, s79, v26, v68
    v_and_b32 v27, 0x7fff7fff, v69
    v_pk_sub_u16 v27, v27, s94 clamp
    v_bfi_b32 v69, s79, v27, v69
    v_and_b32 v26, 0x7fff7fff, v70
    v_pk_sub_u16 v26, v26, s94 clamp
    v_bfi_b32 v70, s79, v26, v70
    v_and_b32 v27, 0x7fff7fff, v71
    v_pk_sub_u16 v27, v27, s94 clamp
    v_bfi_b32 v71, s79, v27, v71
    v_and_b32 v26, 0x7fff7fff, v72
    v_pk_sub_u16 v26, v26, s94 clamp
    v_bfi_b32 v72, s79, v26, v72
    v_and_b32 v27, 0x7fff7fff, v73
    v_pk_sub_u16 v27, v27, s94 clamp
    v_bfi_b32 v73, s79, v27, v73
    v_and_b32 v26, 0x7fff7fff, v74
    v_pk_sub_u16 v26, v26, s94 clamp
    v_bfi_b32 v74, s79, v26, v74
    v_and_b32 v27, 0x7fff7fff, v75
    v_pk_sub_u16 v27, v27, s94 clamp
    v_bfi_b32 v75, s79, v27, v75
    v_and_b32 v26, 0x7fff7fff, v76
    v_pk_sub_u16 v26, v26, s94 clamp
    v_bfi_b32 v76, s79, v26, v76
    v_and_b32 v27, 0x7fff7fff, v77
    v_pk_sub_u16 v27, v27, s94 clamp
    v_bfi_b32 v77, s79, v27, v77
    v_and_b32 v26, 0x7fff7fff, v78
    v_pk_sub_u16 v26, v26, s94 clamp
    v_bfi_b32 v78, s79, v26, v78
    v_and_b32 v27, 0x7fff7fff, v79
    v_pk_sub_u16 v27, v27, s94 clamp
    v_bfi_b32 v79, s79, v27, v79
    v_or_b32 v24, v64, v65
    v_or3_b32 v24, v24, v66, v67
    v_or3_b32 v24, v24, v68, v69
    v_or3_b32 v24, v24, v70, v71
    v_or3_b32 v24, v24, v72, v73
    v_or3_b32 v24, v24, v74, v75
    v_or3_b32 v24, v24, v76, v77
    v_or3_b32 v24, v24, v78, v79
    v_lshlrev_b32 v36, 11, v76
    v_and_or_b32 v64, v36, s78, v64
    v_accvgpr_write_b32 a36, v64
    v_lshlrev_b32 v37, 11, v77
    v_and_or_b32 v65, v37, s78, v65
    v_accvgpr_write_b32 a37, v65
    v_lshlrev_b32 v36, 11, v78
    v_and_or_b32 v66, v36, s78, v66
    v_accvgpr_write_b32 a38, v66
    v_lshlrev_b32 v37, 11, v79
    v_and_or_b32 v67, v37, s78, v67
    v_accvgpr_write_b32 a39, v67
    v_lshlrev_b32 v36, 7, v76
    v_and_or_b32 v68, v36, s78, v68
    v_accvgpr_write_b32 a40, v68
    v_lshlrev_b32 v37, 7, v77
    v_and_or_b32 v69, v37, s78, v69
    v_accvgpr_write_b32 a41, v69
    v_lshlrev_b32 v36, 7, v78
    v_and_or_b32 v70, v36, s78, v70
    v_accvgpr_write_b32 a42, v70
    v_lshlrev_b32 v37, 7, v79
    v_and_or_b32 v71, v37, s78, v71
    v_accvgpr_write_b32 a43, v71
    v_lshlrev_b32 v36, 3, v76
    v_and_or_b32 v72, v36, s78, v72
    v_lshrrev_b32 v37, 1, v76
    v_and_or_b32 v72, v37, s78, v72
    v_accvgpr_write_b32 a44, v72
    v_lshlrev_b32 v36, 3, v77
    v_and_or_b32 v73, v36, s78, v73
    v_lshrrev_b32 v37, 1, v77
    v_and_or_b32 v73, v37, s78, v73
    v_accvgpr_write_b32 a45, v73
    v_lshlrev_b32 v36, 3, v78
    v_and_or_b32 v74, v36, s78, v74
    v_lshrrev_b32 v37, 1, v78
    v_and_or_b32 v74, v37, s78, v74
    v_accvgpr_write_b32 a46, v74
    v_lshlrev_b32 v36, 3, v79
    v_and_or_b32 v75, v36, s78, v75
    v_lshrrev_b32 v37, 1, v79
    v_and_or_b32 v75, v37, s78, v75
    v_accvgpr_write_b32 a47, v75
    v_and_b32 v25, 0x7fff7fff, v48
    v_pk_sub_u16 v25, v25, 1 op_sel_hi:[1,0]
    v_and_b32 v37, 0x7fff7fff, v49
    v_pk_sub_u16 v37, v37, 1 op_sel_hi:[1,0]
    v_pk_min_u16 v25, v25, v37
    v_and_b32 v36, 0x7fff7fff, v50
    v_pk_sub_u16 v36, v36, 1 op_sel_hi:[1,0]
    v_pk_min_u16 v25, v25, v36
    v_and_b32 v37, 0x7fff7fff, v51
    v_pk_sub_u16 v37, v37, 1 op_sel_hi:[1,0]
    v_pk_min_u16 v25, v25, v37
    v_and_b32 v36, 0x7fff7fff, v52
    v_pk_sub_u16 v36, v36, 1 op_sel_hi:[1,0]
    v_pk_min_u16 v25, v25, v36
    v_and_b32 v37, 0x7fff7fff, v53
    v_pk_sub_u16 v37, v37, 1 op_sel_hi:[1,0]
    v_pk_min_u16 v25, v25, v37
    v_and_b32 v36, 0x7fff7fff, v54
    v_pk_sub_u16 v36, v36, 1 op_sel_hi:[1,0]
    v_pk_min_u16 v25, v25, v36
    v_and_b32 v37, 0x7fff7fff, v55
    v_pk_sub_u16 v37, v37, 1 op_sel_hi:[1,0]
    v_pk_min_u16 v25, v25, v37
    v_and_b32 v36, 0x7fff7fff, v56
    v_pk_sub_u16 v36, v36, 1 op_sel_hi:[1,0]
    v_pk_min_u16 v25, v25, v36
    v_and_b32 v37, 0x7fff7fff, v57
    v_pk_sub_u16 v37, v37, 1 op_sel_hi:[1,0]
    v_pk_min_u16 v25, v25, v37
    v_and_b32 v36, 0x7fff7fff, v58
    v_pk_sub_u16 v36, v36, 1 op_sel_hi:[1,0]
    v_pk_min_u16 v25, v25, v36
    v_and_b32 v37, 0x7fff7fff, v59
    v_pk_sub_u16 v37, v37, 1 op_sel_hi:[1,0]
    v_pk_min_u16 v25, v25, v37
    v_and_b32 v36, 0x7fff7fff, v60
    v_pk_sub_u16 v36, v36, 1 op_sel_hi:[1,0]
    v_pk_min_u16 v25, v25, v36
    v_and_b32 v37, 0x7fff7fff, v61
    v_pk_sub_u16 v37, v37, 1 op_sel_hi:[1,0]
    v_pk_min_u16 v25, v25, v37
    v_and_b32 v36, 0x7fff7fff, v62
    v_pk_sub_u16 v36, v36, 1 op_sel_hi:[1,0]
    v_pk_min_u16 v25, v25, v36
    v_and_b32 v37, 0x7fff7fff, v63
    v_pk_sub_u16 v37, v37, 1 op_sel_hi:[1,0]
    v_pk_min_u16 v25, v25, v37
    v_mov_b32 v36, 0x38ff38ff
    v_pk_sub_u16 v36, v36, v25 clamp
    v_cmp_ne_u32 vcc, 0, v36
    s_or_b32 s62, 15, 0
    s_getpc_b64 s[92:93]
    s_cbranch_vccnz REC_K
    v_and_b32 v26, 0x7fff7fff, v48
    v_pk_sub_u16 v26, v26, s98 clamp
    v_bfi_b32 v48, s79, v26, v48
    v_and_b32 v27, 0x7fff7fff, v49
    v_pk_sub_u16 v27, v27, s98 clamp
    v_bfi_b32 v49, s79, v27, v49
    v_and_b32 v26, 0x7fff7fff, v50
    v_pk_sub_u16 v26, v26, s98 clamp
    v_bfi_b32 v50, s79, v26, v50
    v_and_b32 v27, 0x7fff7fff, v51
    v_pk_sub_u16 v27, v27, s98 clamp
    v_bfi_b32 v51, s79, v27, v51
    v_and_b32 v26, 0x7fff7fff, v52
    v_pk_sub_u16 v26, v26, s98 clamp
    v_bfi_b32 v52, s79, v26, v52
    v_and_b32 v27, 0x7fff7fff, v53
    v_pk_sub_u16 v27, v27, s98 clamp
    v_bfi_b32 v53, s79, v27, v53
    v_and_b32 v26, 0x7fff7fff, v54
    v_pk_sub_u16 v26, v26, s98 clamp
    v_bfi_b32 v54, s79, v26, v54
    v_and_b32 v27, 0x7fff7fff, v55
    v_pk_sub_u16 v27, v27, s98 clamp
    v_bfi_b32 v55, s79, v27, v55
    v_and_b32 v26, 0x7fff7fff, v56
    v_pk_sub_u16 v26, v26, s98 clamp
    v_bfi_b32 v56, s79, v26, v56
    v_and_b32 v27, 0x7fff7fff, v57
    v_pk_sub_u16 v27, v27, s98 clamp
    v_bfi_b32 v57, s79, v27, v57
    v_and_b32 v26, 0x7fff7fff, v58
    v_pk_sub_u16 v26, v26, s98 clamp
    v_bfi_b32 v58, s79, v26, v58
    v_and_b32 v27, 0x7fff7fff, v59
    v_pk_sub_u16 v27, v27, s98 clamp
    v_bfi_b32 v59, s79, v27, v59
    v_and_b32 v26, 0x7fff7fff, v60
    v_pk_sub_u16 v26, v26, s98 clamp
    v_bfi_b32 v60, s79, v26, v60
    v_and_b32 v27, 0x7fff7fff, v61
    v_pk_sub_u16 v27, v27, s98 clamp
    v_bfi_b32 v61, s79, v27, v61
    v_and_b32 v26, 0x7fff7fff, v62
    v_pk_sub_u16 v26, v26, s98 clamp
    v_bfi_b32 v62, s79, v26, v62
    v_and_b32 v27, 0x7fff7fff, v63
    v_pk_sub_u16 v27, v27, s98 clamp
    v_bfi_b32 v63, s79, v27, v63
    v_or3_b32 v24, v24, v48, v49
    v_or3_b32 v24, v24, v50, v51
    v_or3_b32 v24, v24, v52, v53
    v_or3_b32 v24, v24, v54, v55
    v_or3_b32 v24, v24, v56, v57
    v_or3_b32 v24, v24, v58, v59
    v_or3_b32 v24, v24, v60, v61
    v_or3_b32 v24, v24, v62, v63
    v_lshlrev_b32 v36, 11, v60
    v_and_or_b32 v48, v36, s78, v48
    v_lshlrev_b32 v37, 11, v61
    v_and_or_b32 v49, v37, s78, v49
    v_lshlrev_b32 v36, 11, v62
    v_and_or_b32 v50, v36, s78, v50
    v_lshlrev_b32 v37, 11, v63
    v_and_or_b32 v51, v37, s78, v51
    v_lshlrev_b32 v36, 7, v60
    v_and_or_b32 v52, v36, s78, v52
    v_lshlrev_b32 v37, 7, v61
    v_and_or_b32 v53, v37, s78, v53
    v_lshlrev_b32 v36, 7, v62
    v_and_or_b32 v54, v36, s78, v54
    v_lshlrev_b32 v37, 7, v63
    v_and_or_b32 v55, v37, s78, v55
    v_lshlrev_b32 v36, 3, v60
    v_and_or_b32 v56, v36, s78, v56
    v_lshrrev_b32 v37, 1, v60
    v_and_or_b32 v56, v37, s78, v56
    v_lshlrev_b32 v36, 3, v61
    v_and_or_b32 v57, v36, s78, v57
    v_lshrrev_b32 v37, 1, v61
    v_and_or_b32 v57, v37, s78, v57
    v_lshlrev_b32 v36, 3, v62
    v_and_or_b32 v58, v36, s78, v58
    v_lshrrev_b32 v37, 1, v62
    v_and_or_b32 v58, v37, s78, v58
    v_lshlrev_b32 v36, 3, v63
    v_and_or_b32 v59, v36, s78, v59
    v_lshrrev_b32 v37, 1, v63
    v_and_or_b32 v59, v37, s78, v59
    v_lshlrev_b32 v36, 4, v0
    v_add_u32 v36, s59, v36
    ds_write_b128 v36, v[48:51] offset:24064
    ds_write_b128 v36, v[52:55] offset:25088
    ds_write_b128 v36, v[56:59] offset:26112
    v_and_b32 v24, s78, v24
    v_cmp_ne_u32 vcc, 0, v24
    s_cmp_lg_u64 vcc, 0
    s_cselect_b32 s60, 32768, 0
    s_or_b32 s99, s99, s60
    s_waitcnt vmcnt(20)
    ds_read_b128 v[48:51], v9 offset:0
    ds_read_b128 v[52:55], v10 offset:0
    ds_read_b128 v[56:59], v11 offset:0
    ds_read_b128 v[60:63], v12 offset:0
    s_waitcnt vmcnt(16)
    v_accvgpr_read_b32 v64, a0
    v_accvgpr_read_b32 v65, a1
    v_accvgpr_read_b32 v66, a2
    v_accvgpr_read_b32 v67, a3
    v_accvgpr_read_b32 v68, a4
    v_accvgpr_read_b32 v69, a5
    v_accvgpr_read_b32 v70, a6
    v_accvgpr_read_b32 v71, a7
    v_accvgpr_read_b32 v72, a8
    v_accvgpr_read_b32 v73, a9
    v_accvgpr_read_b32 v74, a10
    v_accvgpr_read_b32 v75, a11
    v_accvgpr_read_b32 v76, a12
    v_accvgpr_read_b32 v77, a13
    v_accvgpr_read_b32 v78, a14
    v_accvgpr_read_b32 v79, a15
    s_waitcnt lgkmcnt(0)
    s_add_u32 s54, s89, 12288
    s_add_u32 m0, s59, 0
    s_nop 0
    buffer_load_dwordx4 v4, s[4:7], s54 offen offset:0 nt lds
    buffer_load_dwordx4 v5, s[4:7], s54 offen offset:1024 nt lds
    buffer_load_dwordx4 v6, s[4:7], s54 offen offset:2048 nt lds
    buffer_load_dwordx4 v7, s[4:7], s54 offen offset:3072 nt lds
    buffer_load_dwordx4 a[0:3], v8, s[8:11], s54 offen offset:0 nt
    buffer_load_dwordx4 a[4:7], v8, s[8:11], s54 offen offset:256 nt
    buffer_load_dwordx4 a[8:11], v8, s[8:11], s54 offen offset:512 nt
    buffer_load_dwordx4 a[12:15], v8, s[8:11], s54 offen offset:768 nt
    v_and_b32 v25, 0x7fff7fff, v64
    v_pk_sub_u16 v25, v25, 1 op_sel_hi:[1,0]
    v_and_b32 v37, 0x7fff7fff, v65
    v_pk_sub_u16 v37, v37, 1 op_sel_hi:[1,0]
    v_pk_min_u16 v25, v25, v37
    v_and_b32 v36, 0x7fff7fff, v66
    v_pk_sub_u16 v36, v36, 1 op_sel_hi:[1,0]
    v_pk_min_u16 v25, v25, v36
    v_and_b32 v37, 0x7fff7fff, v67
    v_pk_sub_u16 v37, v37, 1 op_sel_hi:[1,0]
    v_pk_min_u16 v25, v25, v37
    v_and_b32 v36, 0x7fff7fff, v68
    v_pk_sub_u16 v36, v36, 1 op_sel_hi:[1,0]
    v_pk_min_u16 v25, v25, v36
    v_and_b32 v37, 0x7fff7fff, v69
    v_pk_sub_u16 v37, v37, 1 op_sel_hi:[1,0]
    v_pk_min_u16 v25, v25, v37
    v_and_b32 v36, 0x7fff7fff, v70
    v_pk_sub_u16 v36, v36, 1 op_sel_hi:[1,0]
    v_pk_min_u16 v25, v25, v36
    v_and_b32 v37, 0x7fff7fff, v71
    v_pk_sub_u16 v37, v37, 1 op_sel_hi:[1,0]
    v_pk_min_u16 v25, v25, v37
    v_and_b32 v36, 0x7fff7fff, v72
    v_pk_sub_u16 v36, v36, 1 op_sel_hi:[1,0]
    v_pk_min_u16 v25, v25, v36
    v_and_b32 v37, 0x7fff7fff, v73
    v_pk_sub_u16 v37, v37, 1 op_sel_hi:[1,0]
    v_pk_min_u16 v25, v25, v37
    v_and_b32 v36, 0x7fff7fff, v74
    v_pk_sub_u16 v36, v36, 1 op_sel_hi:[1,0]
    v_pk_min_u16 v25, v25, v36
    v_and_b32 v37, 0x7fff7fff, v75
    v_pk_sub_u16 v37, v37, 1 op_sel_hi:[1,0]
    v_pk_min_u16 v25, v25, v37
    v_and_b32 v36, 0x7fff7fff, v76
    v_pk_sub_u16 v36, v36, 1 op_sel_hi:[1,0]
    v_pk_min_u16 v25, v25, v36
    v_and_b32 v37, 0x7fff7fff, v77
    v_pk_sub_u16 v37, v37, 1 op_sel_hi:[1,0]
    v_pk_min_u16 v25, v25, v37
    v_and_b32 v36, 0x7fff7fff, v78
    v_pk_sub_u16 v36, v36, 1 op_sel_hi:[1,0]
    v_pk_min_u16 v25, v25, v36
    v_and_b32 v37, 0x7fff7fff, v79
    v_pk_sub_u16 v37, v37, 1 op_sel_hi:[1,0]
    v_pk_min_u16 v25, v25, v37
    v_mov_b32 v36, 0x397f397f
    v_pk_sub_u16 v36, v36, v25 clamp
    v_cmp_ne_u32 vcc, 0, v36
    s_or_b32 s62, 48, 0
    s_getpc_b64 s[92:93]
    s_cbranch_vccnz REC_V
    v_and_b32 v26, 0x7fff7fff, v64
    v_pk_sub_u16 v26, v26, s94 clamp
    v_bfi_b32 v64, s79, v26, v64
    v_and_b32 v27, 0x7fff7fff, v65
    v_pk_sub_u16 v27, v27, s94 clamp
    v_bfi_b32 v65, s79, v27, v65
    v_and_b32 v26, 0x7fff7fff, v66
    v_pk_sub_u16 v26, v26, s94 clamp
    v_bfi_b32 v66, s79, v26, v66
    v_and_b32 v27, 0x7fff7fff, v67
    v_pk_sub_u16 v27, v27, s94 clamp
    v_bfi_b32 v67, s79, v27, v67
    v_and_b32 v26, 0x7fff7fff, v68
    v_pk_sub_u16 v26, v26, s94 clamp
    v_bfi_b32 v68, s79, v26, v68
    v_and_b32 v27, 0x7fff7fff, v69
    v_pk_sub_u16 v27, v27, s94 clamp
    v_bfi_b32 v69, s79, v27, v69
    v_and_b32 v26, 0x7fff7fff, v70
    v_pk_sub_u16 v26, v26, s94 clamp
    v_bfi_b32 v70, s79, v26, v70
    v_and_b32 v27, 0x7fff7fff, v71
    v_pk_sub_u16 v27, v27, s94 clamp
    v_bfi_b32 v71, s79, v27, v71
    v_and_b32 v26, 0x7fff7fff, v72
    v_pk_sub_u16 v26, v26, s94 clamp
    v_bfi_b32 v72, s79, v26, v72
    v_and_b32 v27, 0x7fff7fff, v73
    v_pk_sub_u16 v27, v27, s94 clamp
    v_bfi_b32 v73, s79, v27, v73
    v_and_b32 v26, 0x7fff7fff, v74
    v_pk_sub_u16 v26, v26, s94 clamp
    v_bfi_b32 v74, s79, v26, v74
    v_and_b32 v27, 0x7fff7fff, v75
    v_pk_sub_u16 v27, v27, s94 clamp
    v_bfi_b32 v75, s79, v27, v75
    v_and_b32 v26, 0x7fff7fff, v76
    v_pk_sub_u16 v26, v26, s94 clamp
    v_bfi_b32 v76, s79, v26, v76
    v_and_b32 v27, 0x7fff7fff, v77
    v_pk_sub_u16 v27, v27, s94 clamp
    v_bfi_b32 v77, s79, v27, v77
    v_and_b32 v26, 0x7fff7fff, v78
    v_pk_sub_u16 v26, v26, s94 clamp
    v_bfi_b32 v78, s79, v26, v78
    v_and_b32 v27, 0x7fff7fff, v79
    v_pk_sub_u16 v27, v27, s94 clamp
    v_bfi_b32 v79, s79, v27, v79
    v_or_b32 v24, v64, v65
    v_or3_b32 v24, v24, v66, v67
    v_or3_b32 v24, v24, v68, v69
    v_or3_b32 v24, v24, v70, v71
    v_or3_b32 v24, v24, v72, v73
    v_or3_b32 v24, v24, v74, v75
    v_or3_b32 v24, v24, v76, v77
    v_or3_b32 v24, v24, v78, v79
    v_lshlrev_b32 v36, 11, v76
    v_and_or_b32 v64, v36, s78, v64
    v_accvgpr_write_b32 a184, v64
    v_lshlrev_b32 v37, 11, v77
    v_and_or_b32 v65, v37, s78, v65
    v_accvgpr_write_b32 a185, v65
    v_lshlrev_b32 v36, 11, v78
    v_and_or_b32 v66, v36, s78, v66
    v_accvgpr_write_b32 a186, v66
    v_lshlrev_b32 v37, 11, v79
    v_and_or_b32 v67, v37, s78, v67
    v_accvgpr_write_b32 a187, v67
    v_lshlrev_b32 v36, 7, v76
    v_and_or_b32 v68, v36, s78, v68
    v_accvgpr_write_b32 a188, v68
    v_lshlrev_b32 v37, 7, v77
    v_and_or_b32 v69, v37, s78, v69
    v_accvgpr_write_b32 a189, v69
    v_lshlrev_b32 v36, 7, v78
    v_and_or_b32 v70, v36, s78, v70
    v_accvgpr_write_b32 a190, v70
    v_lshlrev_b32 v37, 7, v79
    v_and_or_b32 v71, v37, s78, v71
    v_accvgpr_write_b32 a191, v71
    v_lshlrev_b32 v36, 3, v76
    v_and_or_b32 v72, v36, s78, v72
    v_lshrrev_b32 v37, 1, v76
    v_and_or_b32 v72, v37, s78, v72
    v_accvgpr_write_b32 a192, v72
    v_lshlrev_b32 v36, 3, v77
    v_and_or_b32 v73, v36, s78, v73
    v_lshrrev_b32 v37, 1, v77
    v_and_or_b32 v73, v37, s78, v73
    v_accvgpr_write_b32 a193, v73
    v_lshlrev_b32 v36, 3, v78
    v_and_or_b32 v74, v36, s78, v74
    v_lshrrev_b32 v37, 1, v78
    v_and_or_b32 v74, v37, s78, v74
    v_accvgpr_write_b32 a194, v74
    v_lshlrev_b32 v36, 3, v79
    v_and_or_b32 v75, v36, s78, v75
    v_lshrrev_b32 v37, 1, v79
    v_and_or_b32 v75, v37, s78, v75
    v_accvgpr_write_b32 a195, v75
    v_and_b32 v25, 0x7fff7fff, v48
    v_pk_sub_u16 v25, v25, 1 op_sel_hi:[1,0]
    v_and_b32 v37, 0x7fff7fff, v49
    v_pk_sub_u16 v37, v37, 1 op_sel_hi:[1,0]
    v_pk_min_u16 v25, v25, v37
    v_and_b32 v36, 0x7fff7fff, v50
    v_pk_sub_u16 v36, v36, 1 op_sel_hi:[1,0]
    v_pk_min_u16 v25, v25, v36
    v_and_b32 v37, 0x7fff7fff, v51
    v_pk_sub_u16 v37, v37, 1 op_sel_hi:[1,0]
    v_pk_min_u16 v25, v25, v37
    v_and_b32 v36, 0x7fff7fff, v52
    v_pk_sub_u16 v36, v36, 1 op_sel_hi:[1,0]
    v_pk_min_u16 v25, v25, v36
    v_and_b32 v37, 0x7fff7fff, v53
    v_pk_sub_u16 v37, v37, 1 op_sel_hi:[1,0]
    v_pk_min_u16 v25, v25, v37
    v_and_b32 v36, 0x7fff7fff, v54
    v_pk_sub_u16 v36, v36, 1 op_sel_hi:[1,0]
    v_pk_min_u16 v25, v25, v36
    v_and_b32 v37, 0x7fff7fff, v55
    v_pk_sub_u16 v37, v37, 1 op_sel_hi:[1,0]
    v_pk_min_u16 v25, v25, v37
    v_and_b32 v36, 0x7fff7fff, v56
    v_pk_sub_u16 v36, v36, 1 op_sel_hi:[1,0]
    v_pk_min_u16 v25, v25, v36
    v_and_b32 v37, 0x7fff7fff, v57
    v_pk_sub_u16 v37, v37, 1 op_sel_hi:[1,0]
    v_pk_min_u16 v25, v25, v37
    v_and_b32 v36, 0x7fff7fff, v58
    v_pk_sub_u16 v36, v36, 1 op_sel_hi:[1,0]
    v_pk_min_u16 v25, v25, v36
    v_and_b32 v37, 0x7fff7fff, v59
    v_pk_sub_u16 v37, v37, 1 op_sel_hi:[1,0]
    v_pk_min_u16 v25, v25, v37
    v_and_b32 v36, 0x7fff7fff, v60
    v_pk_sub_u16 v36, v36, 1 op_sel_hi:[1,0]
    v_pk_min_u16 v25, v25, v36
    v_and_b32 v37, 0x7fff7fff, v61
    v_pk_sub_u16 v37, v37, 1 op_sel_hi:[1,0]
    v_pk_min_u16 v25, v25, v37
    v_and_b32 v36, 0x7fff7fff, v62
    v_pk_sub_u16 v36, v36, 1 op_sel_hi:[1,0]
    v_pk_min_u16 v25, v25, v36
    v_and_b32 v37, 0x7fff7fff, v63
    v_pk_sub_u16 v37, v37, 1 op_sel_hi:[1,0]
    v_pk_min_u16 v25, v25, v37
    v_mov_b32 v36, 0x38ff38ff
    v_pk_sub_u16 v36, v36, v25 clamp
    v_cmp_ne_u32 vcc, 0, v36
    s_or_b32 s62, 16, 0
    s_getpc_b64 s[92:93]
    s_cbranch_vccnz REC_K
    v_and_b32 v26, 0x7fff7fff, v48
    v_pk_sub_u16 v26, v26, s98 clamp
    v_bfi_b32 v48, s79, v26, v48
    v_and_b32 v27, 0x7fff7fff, v49
    v_pk_sub_u16 v27, v27, s98 clamp
    v_bfi_b32 v49, s79, v27, v49
    v_and_b32 v26, 0x7fff7fff, v50
    v_pk_sub_u16 v26, v26, s98 clamp
    v_bfi_b32 v50, s79, v26, v50
    v_and_b32 v27, 0x7fff7fff, v51
    v_pk_sub_u16 v27, v27, s98 clamp
    v_bfi_b32 v51, s79, v27, v51
    v_and_b32 v26, 0x7fff7fff, v52
    v_pk_sub_u16 v26, v26, s98 clamp
    v_bfi_b32 v52, s79, v26, v52
    v_and_b32 v27, 0x7fff7fff, v53
    v_pk_sub_u16 v27, v27, s98 clamp
    v_bfi_b32 v53, s79, v27, v53
    v_and_b32 v26, 0x7fff7fff, v54
    v_pk_sub_u16 v26, v26, s98 clamp
    v_bfi_b32 v54, s79, v26, v54
    v_and_b32 v27, 0x7fff7fff, v55
    v_pk_sub_u16 v27, v27, s98 clamp
    v_bfi_b32 v55, s79, v27, v55
    v_and_b32 v26, 0x7fff7fff, v56
    v_pk_sub_u16 v26, v26, s98 clamp
    v_bfi_b32 v56, s79, v26, v56
    v_and_b32 v27, 0x7fff7fff, v57
    v_pk_sub_u16 v27, v27, s98 clamp
    v_bfi_b32 v57, s79, v27, v57
    v_and_b32 v26, 0x7fff7fff, v58
    v_pk_sub_u16 v26, v26, s98 clamp
    v_bfi_b32 v58, s79, v26, v58
    v_and_b32 v27, 0x7fff7fff, v59
    v_pk_sub_u16 v27, v27, s98 clamp
    v_bfi_b32 v59, s79, v27, v59
    v_and_b32 v26, 0x7fff7fff, v60
    v_pk_sub_u16 v26, v26, s98 clamp
    v_bfi_b32 v60, s79, v26, v60
    v_and_b32 v27, 0x7fff7fff, v61
    v_pk_sub_u16 v27, v27, s98 clamp
    v_bfi_b32 v61, s79, v27, v61
    v_and_b32 v26, 0x7fff7fff, v62
    v_pk_sub_u16 v26, v26, s98 clamp
    v_bfi_b32 v62, s79, v26, v62
    v_and_b32 v27, 0x7fff7fff, v63
    v_pk_sub_u16 v27, v27, s98 clamp
    v_bfi_b32 v63, s79, v27, v63
    v_or3_b32 v24, v24, v48, v49
    v_or3_b32 v24, v24, v50, v51
    v_or3_b32 v24, v24, v52, v53
    v_or3_b32 v24, v24, v54, v55
    v_or3_b32 v24, v24, v56, v57
    v_or3_b32 v24, v24, v58, v59
    v_or3_b32 v24, v24, v60, v61
    v_or3_b32 v24, v24, v62, v63
    v_lshlrev_b32 v36, 11, v60
    v_and_or_b32 v48, v36, s78, v48
    v_lshlrev_b32 v37, 11, v61
    v_and_or_b32 v49, v37, s78, v49
    v_lshlrev_b32 v36, 11, v62
    v_and_or_b32 v50, v36, s78, v50
    v_lshlrev_b32 v37, 11, v63
    v_and_or_b32 v51, v37, s78, v51
    v_lshlrev_b32 v36, 7, v60
    v_and_or_b32 v52, v36, s78, v52
    v_lshlrev_b32 v37, 7, v61
    v_and_or_b32 v53, v37, s78, v53
    v_lshlrev_b32 v36, 7, v62
    v_and_or_b32 v54, v36, s78, v54
    v_lshlrev_b32 v37, 7, v63
    v_and_or_b32 v55, v37, s78, v55
    v_lshlrev_b32 v36, 3, v60
    v_and_or_b32 v56, v36, s78, v56
    v_lshrrev_b32 v37, 1, v60
    v_and_or_b32 v56, v37, s78, v56
    v_lshlrev_b32 v36, 3, v61
    v_and_or_b32 v57, v36, s78, v57
    v_lshrrev_b32 v37, 1, v61
    v_and_or_b32 v57, v37, s78, v57
    v_lshlrev_b32 v36, 3, v62
    v_and_or_b32 v58, v36, s78, v58
    v_lshrrev_b32 v37, 1, v62
    v_and_or_b32 v58, v37, s78, v58
    v_lshlrev_b32 v36, 3, v63
    v_and_or_b32 v59, v36, s78, v59
    v_lshrrev_b32 v37, 1, v63
    v_and_or_b32 v59, v37, s78, v59
    v_lshlrev_b32 v36, 4, v0
    v_add_u32 v36, s59, v36
    ds_write_b128 v36, v[48:51] offset:27136
    ds_write_b128 v36, v[52:55] offset:28160
    ds_write_b128 v36, v[56:59] offset:29184
    v_and_b32 v24, s78, v24
    v_cmp_ne_u32 vcc, 0, v24
    s_cmp_lg_u64 vcc, 0
    s_cselect_b32 s60, 65536, 0
    s_or_b32 s99, s99, s60
    s_waitcnt vmcnt(20)
    ds_read_b128 v[48:51], v9 offset:4096
    ds_read_b128 v[52:55], v10 offset:4096
    ds_read_b128 v[56:59], v11 offset:4096
    ds_read_b128 v[60:63], v12 offset:4096
    s_waitcnt vmcnt(16)
    v_accvgpr_read_b32 v64, a16
    v_accvgpr_read_b32 v65, a17
    v_accvgpr_read_b32 v66, a18
    v_accvgpr_read_b32 v67, a19
    v_accvgpr_read_b32 v68, a20
    v_accvgpr_read_b32 v69, a21
    v_accvgpr_read_b32 v70, a22
    v_accvgpr_read_b32 v71, a23
    v_accvgpr_read_b32 v72, a24
    v_accvgpr_read_b32 v73, a25
    v_accvgpr_read_b32 v74, a26
    v_accvgpr_read_b32 v75, a27
    v_accvgpr_read_b32 v76, a28
    v_accvgpr_read_b32 v77, a29
    v_accvgpr_read_b32 v78, a30
    v_accvgpr_read_b32 v79, a31
    s_waitcnt lgkmcnt(0)
    s_add_u32 s54, s89, 16384
    s_add_u32 m0, s59, 4096
    s_nop 0
    buffer_load_dwordx4 v4, s[4:7], s54 offen offset:0 nt lds
    buffer_load_dwordx4 v5, s[4:7], s54 offen offset:1024 nt lds
    buffer_load_dwordx4 v6, s[4:7], s54 offen offset:2048 nt lds
    buffer_load_dwordx4 v7, s[4:7], s54 offen offset:3072 nt lds
    buffer_load_dwordx4 a[16:19], v8, s[8:11], s54 offen offset:0 nt
    buffer_load_dwordx4 a[20:23], v8, s[8:11], s54 offen offset:256 nt
    buffer_load_dwordx4 a[24:27], v8, s[8:11], s54 offen offset:512 nt
    buffer_load_dwordx4 a[28:31], v8, s[8:11], s54 offen offset:768 nt
    v_and_b32 v25, 0x7fff7fff, v64
    v_pk_sub_u16 v25, v25, 1 op_sel_hi:[1,0]
    v_and_b32 v37, 0x7fff7fff, v65
    v_pk_sub_u16 v37, v37, 1 op_sel_hi:[1,0]
    v_pk_min_u16 v25, v25, v37
    v_and_b32 v36, 0x7fff7fff, v66
    v_pk_sub_u16 v36, v36, 1 op_sel_hi:[1,0]
    v_pk_min_u16 v25, v25, v36
    v_and_b32 v37, 0x7fff7fff, v67
    v_pk_sub_u16 v37, v37, 1 op_sel_hi:[1,0]
    v_pk_min_u16 v25, v25, v37
    v_and_b32 v36, 0x7fff7fff, v68
    v_pk_sub_u16 v36, v36, 1 op_sel_hi:[1,0]
    v_pk_min_u16 v25, v25, v36
    v_and_b32 v37, 0x7fff7fff, v69
    v_pk_sub_u16 v37, v37, 1 op_sel_hi:[1,0]
    v_pk_min_u16 v25, v25, v37
    v_and_b32 v36, 0x7fff7fff, v70
    v_pk_sub_u16 v36, v36, 1 op_sel_hi:[1,0]
    v_pk_min_u16 v25, v25, v36
    v_and_b32 v37, 0x7fff7fff, v71
    v_pk_sub_u16 v37, v37, 1 op_sel_hi:[1,0]
    v_pk_min_u16 v25, v25, v37
    v_and_b32 v36, 0x7fff7fff, v72
    v_pk_sub_u16 v36, v36, 1 op_sel_hi:[1,0]
    v_pk_min_u16 v25, v25, v36
    v_and_b32 v37, 0x7fff7fff, v73
    v_pk_sub_u16 v37, v37, 1 op_sel_hi:[1,0]
    v_pk_min_u16 v25, v25, v37
    v_and_b32 v36, 0x7fff7fff, v74
    v_pk_sub_u16 v36, v36, 1 op_sel_hi:[1,0]
    v_pk_min_u16 v25, v25, v36
    v_and_b32 v37, 0x7fff7fff, v75
    v_pk_sub_u16 v37, v37, 1 op_sel_hi:[1,0]
    v_pk_min_u16 v25, v25, v37
    v_and_b32 v36, 0x7fff7fff, v76
    v_pk_sub_u16 v36, v36, 1 op_sel_hi:[1,0]
    v_pk_min_u16 v25, v25, v36
    v_and_b32 v37, 0x7fff7fff, v77
    v_pk_sub_u16 v37, v37, 1 op_sel_hi:[1,0]
    v_pk_min_u16 v25, v25, v37
    v_and_b32 v36, 0x7fff7fff, v78
    v_pk_sub_u16 v36, v36, 1 op_sel_hi:[1,0]
    v_pk_min_u16 v25, v25, v36
    v_and_b32 v37, 0x7fff7fff, v79
    v_pk_sub_u16 v37, v37, 1 op_sel_hi:[1,0]
    v_pk_min_u16 v25, v25, v37
    v_mov_b32 v36, 0x397f397f
    v_pk_sub_u16 v36, v36, v25 clamp
    v_cmp_ne_u32 vcc, 0, v36
    s_or_b32 s62, 49, 0
    s_getpc_b64 s[92:93]
    s_cbranch_vccnz REC_V
    v_and_b32 v26, 0x7fff7fff, v64
    v_pk_sub_u16 v26, v26, s94 clamp
    v_bfi_b32 v64, s79, v26, v64
    v_and_b32 v27, 0x7fff7fff, v65
    v_pk_sub_u16 v27, v27, s94 clamp
    v_bfi_b32 v65, s79, v27, v65
    v_and_b32 v26, 0x7fff7fff, v66
    v_pk_sub_u16 v26, v26, s94 clamp
    v_bfi_b32 v66, s79, v26, v66
    v_and_b32 v27, 0x7fff7fff, v67
    v_pk_sub_u16 v27, v27, s94 clamp
    v_bfi_b32 v67, s79, v27, v67
    v_and_b32 v26, 0x7fff7fff, v68
    v_pk_sub_u16 v26, v26, s94 clamp
    v_bfi_b32 v68, s79, v26, v68
    v_and_b32 v27, 0x7fff7fff, v69
    v_pk_sub_u16 v27, v27, s94 clamp
    v_bfi_b32 v69, s79, v27, v69
    v_and_b32 v26, 0x7fff7fff, v70
    v_pk_sub_u16 v26, v26, s94 clamp
    v_bfi_b32 v70, s79, v26, v70
    v_and_b32 v27, 0x7fff7fff, v71
    v_pk_sub_u16 v27, v27, s94 clamp
    v_bfi_b32 v71, s79, v27, v71
    v_and_b32 v26, 0x7fff7fff, v72
    v_pk_sub_u16 v26, v26, s94 clamp
    v_bfi_b32 v72, s79, v26, v72
    v_and_b32 v27, 0x7fff7fff, v73
    v_pk_sub_u16 v27, v27, s94 clamp
    v_bfi_b32 v73, s79, v27, v73
    v_and_b32 v26, 0x7fff7fff, v74
    v_pk_sub_u16 v26, v26, s94 clamp
    v_bfi_b32 v74, s79, v26, v74
    v_and_b32 v27, 0x7fff7fff, v75
    v_pk_sub_u16 v27, v27, s94 clamp
    v_bfi_b32 v75, s79, v27, v75
    v_and_b32 v26, 0x7fff7fff, v76
    v_pk_sub_u16 v26, v26, s94 clamp
    v_bfi_b32 v76, s79, v26, v76
    v_and_b32 v27, 0x7fff7fff, v77
    v_pk_sub_u16 v27, v27, s94 clamp
    v_bfi_b32 v77, s79, v27, v77
    v_and_b32 v26, 0x7fff7fff, v78
    v_pk_sub_u16 v26, v26, s94 clamp
    v_bfi_b32 v78, s79, v26, v78
    v_and_b32 v27, 0x7fff7fff, v79
    v_pk_sub_u16 v27, v27, s94 clamp
    v_bfi_b32 v79, s79, v27, v79
    v_or_b32 v24, v64, v65
    v_or3_b32 v24, v24, v66, v67
    v_or3_b32 v24, v24, v68, v69
    v_or3_b32 v24, v24, v70, v71
    v_or3_b32 v24, v24, v72, v73
    v_or3_b32 v24, v24, v74, v75
    v_or3_b32 v24, v24, v76, v77
    v_or3_b32 v24, v24, v78, v79
    v_lshlrev_b32 v36, 11, v76
    v_and_or_b32 v64, v36, s78, v64
    v_accvgpr_write_b32 a196, v64
    v_lshlrev_b32 v37, 11, v77
    v_and_or_b32 v65, v37, s78, v65
    v_accvgpr_write_b32 a197, v65
    v_lshlrev_b32 v36, 11, v78
    v_and_or_b32 v66, v36, s78, v66
    v_accvgpr_write_b32 a198, v66
    v_lshlrev_b32 v37, 11, v79
    v_and_or_b32 v67, v37, s78, v67
    v_accvgpr_write_b32 a199, v67
    v_lshlrev_b32 v36, 7, v76
    v_and_or_b32 v68, v36, s78, v68
    v_accvgpr_write_b32 a200, v68
    v_lshlrev_b32 v37, 7, v77
    v_and_or_b32 v69, v37, s78, v69
    v_accvgpr_write_b32 a201, v69
    v_lshlrev_b32 v36, 7, v78
    v_and_or_b32 v70, v36, s78, v70
    v_accvgpr_write_b32 a202, v70
    v_lshlrev_b32 v37, 7, v79
    v_and_or_b32 v71, v37, s78, v71
    v_accvgpr_write_b32 a203, v71
    v_lshlrev_b32 v36, 3, v76
    v_and_or_b32 v72, v36, s78, v72
    v_lshrrev_b32 v37, 1, v76
    v_and_or_b32 v72, v37, s78, v72
    v_accvgpr_write_b32 a204, v72
    v_lshlrev_b32 v36, 3, v77
    v_and_or_b32 v73, v36, s78, v73
    v_lshrrev_b32 v37, 1, v77
    v_and_or_b32 v73, v37, s78, v73
    v_accvgpr_write_b32 a205, v73
    v_lshlrev_b32 v36, 3, v78
    v_and_or_b32 v74, v36, s78, v74
    v_lshrrev_b32 v37, 1, v78
    v_and_or_b32 v74, v37, s78, v74
    v_accvgpr_write_b32 a206, v74
    v_lshlrev_b32 v36, 3, v79
    v_and_or_b32 v75, v36, s78, v75
    v_lshrrev_b32 v37, 1, v79
    v_and_or_b32 v75, v37, s78, v75
    v_accvgpr_write_b32 a207, v75
    v_and_b32 v25, 0x7fff7fff, v48
    v_pk_sub_u16 v25, v25, 1 op_sel_hi:[1,0]
    v_and_b32 v37, 0x7fff7fff, v49
    v_pk_sub_u16 v37, v37, 1 op_sel_hi:[1,0]
    v_pk_min_u16 v25, v25, v37
    v_and_b32 v36, 0x7fff7fff, v50
    v_pk_sub_u16 v36, v36, 1 op_sel_hi:[1,0]
    v_pk_min_u16 v25, v25, v36
    v_and_b32 v37, 0x7fff7fff, v51
    v_pk_sub_u16 v37, v37, 1 op_sel_hi:[1,0]
    v_pk_min_u16 v25, v25, v37
    v_and_b32 v36, 0x7fff7fff, v52
    v_pk_sub_u16 v36, v36, 1 op_sel_hi:[1,0]
    v_pk_min_u16 v25, v25, v36
    v_and_b32 v37, 0x7fff7fff, v53
    v_pk_sub_u16 v37, v37, 1 op_sel_hi:[1,0]
    v_pk_min_u16 v25, v25, v37
    v_and_b32 v36, 0x7fff7fff, v54
    v_pk_sub_u16 v36, v36, 1 op_sel_hi:[1,0]
    v_pk_min_u16 v25, v25, v36
    v_and_b32 v37, 0x7fff7fff, v55
    v_pk_sub_u16 v37, v37, 1 op_sel_hi:[1,0]
    v_pk_min_u16 v25, v25, v37
    v_and_b32 v36, 0x7fff7fff, v56
    v_pk_sub_u16 v36, v36, 1 op_sel_hi:[1,0]
    v_pk_min_u16 v25, v25, v36
    v_and_b32 v37, 0x7fff7fff, v57
    v_pk_sub_u16 v37, v37, 1 op_sel_hi:[1,0]
    v_pk_min_u16 v25, v25, v37
    v_and_b32 v36, 0x7fff7fff, v58
    v_pk_sub_u16 v36, v36, 1 op_sel_hi:[1,0]
    v_pk_min_u16 v25, v25, v36
    v_and_b32 v37, 0x7fff7fff, v59
    v_pk_sub_u16 v37, v37, 1 op_sel_hi:[1,0]
    v_pk_min_u16 v25, v25, v37
    v_and_b32 v36, 0x7fff7fff, v60
    v_pk_sub_u16 v36, v36, 1 op_sel_hi:[1,0]
    v_pk_min_u16 v25, v25, v36
    v_and_b32 v37, 0x7fff7fff, v61
    v_pk_sub_u16 v37, v37, 1 op_sel_hi:[1,0]
    v_pk_min_u16 v25, v25, v37
    v_and_b32 v36, 0x7fff7fff, v62
    v_pk_sub_u16 v36, v36, 1 op_sel_hi:[1,0]
    v_pk_min_u16 v25, v25, v36
    v_and_b32 v37, 0x7fff7fff, v63
    v_pk_sub_u16 v37, v37, 1 op_sel_hi:[1,0]
    v_pk_min_u16 v25, v25, v37
    v_mov_b32 v36, 0x38ff38ff
    v_pk_sub_u16 v36, v36, v25 clamp
    v_cmp_ne_u32 vcc, 0, v36
    s_or_b32 s62, 17, 0
    s_getpc_b64 s[92:93]
    s_cbranch_vccnz REC_K
    v_and_b32 v26, 0x7fff7fff, v48
    v_pk_sub_u16 v26, v26, s98 clamp
    v_bfi_b32 v48, s79, v26, v48
    v_and_b32 v27, 0x7fff7fff, v49
    v_pk_sub_u16 v27, v27, s98 clamp
    v_bfi_b32 v49, s79, v27, v49
    v_and_b32 v26, 0x7fff7fff, v50
    v_pk_sub_u16 v26, v26, s98 clamp
    v_bfi_b32 v50, s79, v26, v50
    v_and_b32 v27, 0x7fff7fff, v51
    v_pk_sub_u16 v27, v27, s98 clamp
    v_bfi_b32 v51, s79, v27, v51
    v_and_b32 v26, 0x7fff7fff, v52
    v_pk_sub_u16 v26, v26, s98 clamp
    v_bfi_b32 v52, s79, v26, v52
    v_and_b32 v27, 0x7fff7fff, v53
    v_pk_sub_u16 v27, v27, s98 clamp
    v_bfi_b32 v53, s79, v27, v53
    v_and_b32 v26, 0x7fff7fff, v54
    v_pk_sub_u16 v26, v26, s98 clamp
    v_bfi_b32 v54, s79, v26, v54
    v_and_b32 v27, 0x7fff7fff, v55
    v_pk_sub_u16 v27, v27, s98 clamp
    v_bfi_b32 v55, s79, v27, v55
    v_and_b32 v26, 0x7fff7fff, v56
    v_pk_sub_u16 v26, v26, s98 clamp
    v_bfi_b32 v56, s79, v26, v56
    v_and_b32 v27, 0x7fff7fff, v57
    v_pk_sub_u16 v27, v27, s98 clamp
    v_bfi_b32 v57, s79, v27, v57
    v_and_b32 v26, 0x7fff7fff, v58
    v_pk_sub_u16 v26, v26, s98 clamp
    v_bfi_b32 v58, s79, v26, v58
    v_and_b32 v27, 0x7fff7fff, v59
    v_pk_sub_u16 v27, v27, s98 clamp
    v_bfi_b32 v59, s79, v27, v59
    v_and_b32 v26, 0x7fff7fff, v60
    v_pk_sub_u16 v26, v26, s98 clamp
    v_bfi_b32 v60, s79, v26, v60
    v_and_b32 v27, 0x7fff7fff, v61
    v_pk_sub_u16 v27, v27, s98 clamp
    v_bfi_b32 v61, s79, v27, v61
    v_and_b32 v26, 0x7fff7fff, v62
    v_pk_sub_u16 v26, v26, s98 clamp
    v_bfi_b32 v62, s79, v26, v62
    v_and_b32 v27, 0x7fff7fff, v63
    v_pk_sub_u16 v27, v27, s98 clamp
    v_bfi_b32 v63, s79, v27, v63
    v_or3_b32 v24, v24, v48, v49
    v_or3_b32 v24, v24, v50, v51
    v_or3_b32 v24, v24, v52, v53
    v_or3_b32 v24, v24, v54, v55
    v_or3_b32 v24, v24, v56, v57
    v_or3_b32 v24, v24, v58, v59
    v_or3_b32 v24, v24, v60, v61
    v_or3_b32 v24, v24, v62, v63
    v_lshlrev_b32 v36, 11, v60
    v_and_or_b32 v48, v36, s78, v48
    v_accvgpr_write_b32 a160, v48
    v_lshlrev_b32 v37, 11, v61
    v_and_or_b32 v49, v37, s78, v49
    v_accvgpr_write_b32 a161, v49
    v_lshlrev_b32 v36, 11, v62
    v_and_or_b32 v50, v36, s78, v50
    v_accvgpr_write_b32 a162, v50
    v_lshlrev_b32 v37, 11, v63
    v_and_or_b32 v51, v37, s78, v51
    v_accvgpr_write_b32 a163, v51
    v_lshlrev_b32 v36, 7, v60
    v_and_or_b32 v52, v36, s78, v52
    v_accvgpr_write_b32 a164, v52
    v_lshlrev_b32 v37, 7, v61
    v_and_or_b32 v53, v37, s78, v53
    v_accvgpr_write_b32 a165, v53
    v_lshlrev_b32 v36, 7, v62
    v_and_or_b32 v54, v36, s78, v54
    v_accvgpr_write_b32 a166, v54
    v_lshlrev_b32 v37, 7, v63
    v_and_or_b32 v55, v37, s78, v55
    v_accvgpr_write_b32 a167, v55
    v_lshlrev_b32 v36, 3, v60
    v_and_or_b32 v56, v36, s78, v56
    v_lshrrev_b32 v37, 1, v60
    v_and_or_b32 v56, v37, s78, v56
    v_accvgpr_write_b32 a168, v56
    v_lshlrev_b32 v36, 3, v61
    v_and_or_b32 v57, v36, s78, v57
    v_lshrrev_b32 v37, 1, v61
    v_and_or_b32 v57, v37, s78, v57
    v_accvgpr_write_b32 a169, v57
    v_lshlrev_b32 v36, 3, v62
    v_and_or_b32 v58, v36, s78, v58
    v_lshrrev_b32 v37, 1, v62
    v_and_or_b32 v58, v37, s78, v58
    v_accvgpr_write_b32 a170, v58
    v_lshlrev_b32 v36, 3, v63
    v_and_or_b32 v59, v36, s78, v59
    v_lshrrev_b32 v37, 1, v63
    v_and_or_b32 v59, v37, s78, v59
    v_accvgpr_write_b32 a171, v59
    v_and_b32 v24, s78, v24
    v_cmp_ne_u32 vcc, 0, v24
    s_cmp_lg_u64 vcc, 0
    s_cselect_b32 s60, 131072, 0
    s_or_b32 s99, s99, s60
    s_waitcnt vmcnt(20)
    ds_read_b128 v[48:51], v9 offset:32768
    ds_read_b128 v[52:55], v10 offset:32768
    ds_read_b128 v[56:59], v11 offset:32768
    ds_read_b128 v[60:63], v12 offset:32768
    s_waitcnt vmcnt(16)
    v_accvgpr_read_b32 v64, a232
    v_accvgpr_read_b32 v65, a233
    v_accvgpr_read_b32 v66, a234
    v_accvgpr_read_b32 v67, a235
    v_accvgpr_read_b32 v68, a236
    v_accvgpr_read_b32 v69, a237
    v_accvgpr_read_b32 v70, a238
    v_accvgpr_read_b32 v71, a239
    v_accvgpr_read_b32 v72, a240
    v_accvgpr_read_b32 v73, a241
    v_accvgpr_read_b32 v74, a242
    v_accvgpr_read_b32 v75, a243
    v_accvgpr_read_b32 v76, a244
    v_accvgpr_read_b32 v77, a245
    v_accvgpr_read_b32 v78, a246
    v_accvgpr_read_b32 v79, a247
    s_waitcnt lgkmcnt(0)
    v_and_b32 v25, 0x7fff7fff, v64
    v_pk_sub_u16 v25, v25, 1 op_sel_hi:[1,0]
    v_and_b32 v37, 0x7fff7fff, v65
    v_pk_sub_u16 v37, v37, 1 op_sel_hi:[1,0]
    v_pk_min_u16 v25, v25, v37
    v_and_b32 v36, 0x7fff7fff, v66
    v_pk_sub_u16 v36, v36, 1 op_sel_hi:[1,0]
    v_pk_min_u16 v25, v25, v36
    v_and_b32 v37, 0x7fff7fff, v67
    v_pk_sub_u16 v37, v37, 1 op_sel_hi:[1,0]
    v_pk_min_u16 v25, v25, v37
    v_and_b32 v36, 0x7fff7fff, v68
    v_pk_sub_u16 v36, v36, 1 op_sel_hi:[1,0]
    v_pk_min_u16 v25, v25, v36
    v_and_b32 v37, 0x7fff7fff, v69
    v_pk_sub_u16 v37, v37, 1 op_sel_hi:[1,0]
    v_pk_min_u16 v25, v25, v37
    v_and_b32 v36, 0x7fff7fff, v70
    v_pk_sub_u16 v36, v36, 1 op_sel_hi:[1,0]
    v_pk_min_u16 v25, v25, v36
    v_and_b32 v37, 0x7fff7fff, v71
    v_pk_sub_u16 v37, v37, 1 op_sel_hi:[1,0]
    v_pk_min_u16 v25, v25, v37
    v_and_b32 v36, 0x7fff7fff, v72
    v_pk_sub_u16 v36, v36, 1 op_sel_hi:[1,0]
    v_pk_min_u16 v25, v25, v36
    v_and_b32 v37, 0x7fff7fff, v73
    v_pk_sub_u16 v37, v37, 1 op_sel_hi:[1,0]
    v_pk_min_u16 v25, v25, v37
    v_and_b32 v36, 0x7fff7fff, v74
    v_pk_sub_u16 v36, v36, 1 op_sel_hi:[1,0]
    v_pk_min_u16 v25, v25, v36
    v_and_b32 v37, 0x7fff7fff, v75
    v_pk_sub_u16 v37, v37, 1 op_sel_hi:[1,0]
    v_pk_min_u16 v25, v25, v37
    v_and_b32 v36, 0x7fff7fff, v76
    v_pk_sub_u16 v36, v36, 1 op_sel_hi:[1,0]
    v_pk_min_u16 v25, v25, v36
    v_and_b32 v37, 0x7fff7fff, v77
    v_pk_sub_u16 v37, v37, 1 op_sel_hi:[1,0]
    v_pk_min_u16 v25, v25, v37
    v_and_b32 v36, 0x7fff7fff, v78
    v_pk_sub_u16 v36, v36, 1 op_sel_hi:[1,0]
    v_pk_min_u16 v25, v25, v36
    v_and_b32 v37, 0x7fff7fff, v79
    v_pk_sub_u16 v37, v37, 1 op_sel_hi:[1,0]
    v_pk_min_u16 v25, v25, v37
    v_mov_b32 v36, 0x397f397f
    v_pk_sub_u16 v36, v36, v25 clamp
    v_cmp_ne_u32 vcc, 0, v36
    s_or_b32 s62, 50, 0
    s_getpc_b64 s[92:93]
    s_cbranch_vccnz REC_V
    v_and_b32 v26, 0x7fff7fff, v64
    v_pk_sub_u16 v26, v26, s94 clamp
    v_bfi_b32 v64, s79, v26, v64
    v_and_b32 v27, 0x7fff7fff, v65
    v_pk_sub_u16 v27, v27, s94 clamp
    v_bfi_b32 v65, s79, v27, v65
    v_and_b32 v26, 0x7fff7fff, v66
    v_pk_sub_u16 v26, v26, s94 clamp
    v_bfi_b32 v66, s79, v26, v66
    v_and_b32 v27, 0x7fff7fff, v67
    v_pk_sub_u16 v27, v27, s94 clamp
    v_bfi_b32 v67, s79, v27, v67
    v_and_b32 v26, 0x7fff7fff, v68
    v_pk_sub_u16 v26, v26, s94 clamp
    v_bfi_b32 v68, s79, v26, v68
    v_and_b32 v27, 0x7fff7fff, v69
    v_pk_sub_u16 v27, v27, s94 clamp
    v_bfi_b32 v69, s79, v27, v69
    v_and_b32 v26, 0x7fff7fff, v70
    v_pk_sub_u16 v26, v26, s94 clamp
    v_bfi_b32 v70, s79, v26, v70
    v_and_b32 v27, 0x7fff7fff, v71
    v_pk_sub_u16 v27, v27, s94 clamp
    v_bfi_b32 v71, s79, v27, v71
    v_and_b32 v26, 0x7fff7fff, v72
    v_pk_sub_u16 v26, v26, s94 clamp
    v_bfi_b32 v72, s79, v26, v72
    v_and_b32 v27, 0x7fff7fff, v73
    v_pk_sub_u16 v27, v27, s94 clamp
    v_bfi_b32 v73, s79, v27, v73
    v_and_b32 v26, 0x7fff7fff, v74
    v_pk_sub_u16 v26, v26, s94 clamp
    v_bfi_b32 v74, s79, v26, v74
    v_and_b32 v27, 0x7fff7fff, v75
    v_pk_sub_u16 v27, v27, s94 clamp
    v_bfi_b32 v75, s79, v27, v75
    v_and_b32 v26, 0x7fff7fff, v76
    v_pk_sub_u16 v26, v26, s94 clamp
    v_bfi_b32 v76, s79, v26, v76
    v_and_b32 v27, 0x7fff7fff, v77
    v_pk_sub_u16 v27, v27, s94 clamp
    v_bfi_b32 v77, s79, v27, v77
    v_and_b32 v26, 0x7fff7fff, v78
    v_pk_sub_u16 v26, v26, s94 clamp
    v_bfi_b32 v78, s79, v26, v78
    v_and_b32 v27, 0x7fff7fff, v79
    v_pk_sub_u16 v27, v27, s94 clamp
    v_bfi_b32 v79, s79, v27, v79
    v_or_b32 v24, v64, v65
    v_or3_b32 v24, v24, v66, v67
    v_or3_b32 v24, v24, v68, v69
    v_or3_b32 v24, v24, v70, v71
    v_or3_b32 v24, v24, v72, v73
    v_or3_b32 v24, v24, v74, v75
    v_or3_b32 v24, v24, v76, v77
    v_or3_b32 v24, v24, v78, v79
    v_lshlrev_b32 v36, 11, v76
    v_and_or_b32 v64, v36, s78, v64
    v_accvgpr_write_b32 a208, v64
    v_lshlrev_b32 v37, 11, v77
    v_and_or_b32 v65, v37, s78, v65
    v_accvgpr_write_b32 a209, v65
    v_lshlrev_b32 v36, 11, v78
    v_and_or_b32 v66, v36, s78, v66
    v_accvgpr_write_b32 a210, v66
    v_lshlrev_b32 v37, 11, v79
    v_and_or_b32 v67, v37, s78, v67
    v_accvgpr_write_b32 a211, v67
    v_lshlrev_b32 v36, 7, v76
    v_and_or_b32 v68, v36, s78, v68
    v_accvgpr_write_b32 a212, v68
    v_lshlrev_b32 v37, 7, v77
    v_and_or_b32 v69, v37, s78, v69
    v_accvgpr_write_b32 a213, v69
    v_lshlrev_b32 v36, 7, v78
    v_and_or_b32 v70, v36, s78, v70
    v_accvgpr_write_b32 a214, v70
    v_lshlrev_b32 v37, 7, v79
    v_and_or_b32 v71, v37, s78, v71
    v_accvgpr_write_b32 a215, v71
    v_lshlrev_b32 v36, 3, v76
    v_and_or_b32 v72, v36, s78, v72
    v_lshrrev_b32 v37, 1, v76
    v_and_or_b32 v72, v37, s78, v72
    v_accvgpr_write_b32 a216, v72
    v_lshlrev_b32 v36, 3, v77
    v_and_or_b32 v73, v36, s78, v73
    v_lshrrev_b32 v37, 1, v77
    v_and_or_b32 v73, v37, s78, v73
    v_accvgpr_write_b32 a217, v73
    v_lshlrev_b32 v36, 3, v78
    v_and_or_b32 v74, v36, s78, v74
    v_lshrrev_b32 v37, 1, v78
    v_and_or_b32 v74, v37, s78, v74
    v_accvgpr_write_b32 a218, v74
    v_lshlrev_b32 v36, 3, v79
    v_and_or_b32 v75, v36, s78, v75
    v_lshrrev_b32 v37, 1, v79
    v_and_or_b32 v75, v37, s78, v75
    v_accvgpr_write_b32 a219, v75
    v_and_b32 v25, 0x7fff7fff, v48
    v_pk_sub_u16 v25, v25, 1 op_sel_hi:[1,0]
    v_and_b32 v37, 0x7fff7fff, v49
    v_pk_sub_u16 v37, v37, 1 op_sel_hi:[1,0]
    v_pk_min_u16 v25, v25, v37
    v_and_b32 v36, 0x7fff7fff, v50
    v_pk_sub_u16 v36, v36, 1 op_sel_hi:[1,0]
    v_pk_min_u16 v25, v25, v36
    v_and_b32 v37, 0x7fff7fff, v51
    v_pk_sub_u16 v37, v37, 1 op_sel_hi:[1,0]
    v_pk_min_u16 v25, v25, v37
    v_and_b32 v36, 0x7fff7fff, v52
    v_pk_sub_u16 v36, v36, 1 op_sel_hi:[1,0]
    v_pk_min_u16 v25, v25, v36
    v_and_b32 v37, 0x7fff7fff, v53
    v_pk_sub_u16 v37, v37, 1 op_sel_hi:[1,0]
    v_pk_min_u16 v25, v25, v37
    v_and_b32 v36, 0x7fff7fff, v54
    v_pk_sub_u16 v36, v36, 1 op_sel_hi:[1,0]
    v_pk_min_u16 v25, v25, v36
    v_and_b32 v37, 0x7fff7fff, v55
    v_pk_sub_u16 v37, v37, 1 op_sel_hi:[1,0]
    v_pk_min_u16 v25, v25, v37
    v_and_b32 v36, 0x7fff7fff, v56
    v_pk_sub_u16 v36, v36, 1 op_sel_hi:[1,0]
    v_pk_min_u16 v25, v25, v36
    v_and_b32 v37, 0x7fff7fff, v57
    v_pk_sub_u16 v37, v37, 1 op_sel_hi:[1,0]
    v_pk_min_u16 v25, v25, v37
    v_and_b32 v36, 0x7fff7fff, v58
    v_pk_sub_u16 v36, v36, 1 op_sel_hi:[1,0]
    v_pk_min_u16 v25, v25, v36
    v_and_b32 v37, 0x7fff7fff, v59
    v_pk_sub_u16 v37, v37, 1 op_sel_hi:[1,0]
    v_pk_min_u16 v25, v25, v37
    v_and_b32 v36, 0x7fff7fff, v60
    v_pk_sub_u16 v36, v36, 1 op_sel_hi:[1,0]
    v_pk_min_u16 v25, v25, v36
    v_and_b32 v37, 0x7fff7fff, v61
    v_pk_sub_u16 v37, v37, 1 op_sel_hi:[1,0]
    v_pk_min_u16 v25, v25, v37
    v_and_b32 v36, 0x7fff7fff, v62
    v_pk_sub_u16 v36, v36, 1 op_sel_hi:[1,0]
    v_pk_min_u16 v25, v25, v36
    v_and_b32 v37, 0x7fff7fff, v63
    v_pk_sub_u16 v37, v37, 1 op_sel_hi:[1,0]
    v_pk_min_u16 v25, v25, v37
    v_mov_b32 v36, 0x38ff38ff
    v_pk_sub_u16 v36, v36, v25 clamp
    v_cmp_ne_u32 vcc, 0, v36
    s_or_b32 s62, 18, 0
    s_getpc_b64 s[92:93]
    s_cbranch_vccnz REC_K
    v_and_b32 v26, 0x7fff7fff, v48
    v_pk_sub_u16 v26, v26, s98 clamp
    v_bfi_b32 v48, s79, v26, v48
    v_and_b32 v27, 0x7fff7fff, v49
    v_pk_sub_u16 v27, v27, s98 clamp
    v_bfi_b32 v49, s79, v27, v49
    v_and_b32 v26, 0x7fff7fff, v50
    v_pk_sub_u16 v26, v26, s98 clamp
    v_bfi_b32 v50, s79, v26, v50
    v_and_b32 v27, 0x7fff7fff, v51
    v_pk_sub_u16 v27, v27, s98 clamp
    v_bfi_b32 v51, s79, v27, v51
    v_and_b32 v26, 0x7fff7fff, v52
    v_pk_sub_u16 v26, v26, s98 clamp
    v_bfi_b32 v52, s79, v26, v52
    v_and_b32 v27, 0x7fff7fff, v53
    v_pk_sub_u16 v27, v27, s98 clamp
    v_bfi_b32 v53, s79, v27, v53
    v_and_b32 v26, 0x7fff7fff, v54
    v_pk_sub_u16 v26, v26, s98 clamp
    v_bfi_b32 v54, s79, v26, v54
    v_and_b32 v27, 0x7fff7fff, v55
    v_pk_sub_u16 v27, v27, s98 clamp
    v_bfi_b32 v55, s79, v27, v55
    v_and_b32 v26, 0x7fff7fff, v56
    v_pk_sub_u16 v26, v26, s98 clamp
    v_bfi_b32 v56, s79, v26, v56
    v_and_b32 v27, 0x7fff7fff, v57
    v_pk_sub_u16 v27, v27, s98 clamp
    v_bfi_b32 v57, s79, v27, v57
    v_and_b32 v26, 0x7fff7fff, v58
    v_pk_sub_u16 v26, v26, s98 clamp
    v_bfi_b32 v58, s79, v26, v58
    v_and_b32 v27, 0x7fff7fff, v59
    v_pk_sub_u16 v27, v27, s98 clamp
    v_bfi_b32 v59, s79, v27, v59
    v_and_b32 v26, 0x7fff7fff, v60
    v_pk_sub_u16 v26, v26, s98 clamp
    v_bfi_b32 v60, s79, v26, v60
    v_and_b32 v27, 0x7fff7fff, v61
    v_pk_sub_u16 v27, v27, s98 clamp
    v_bfi_b32 v61, s79, v27, v61
    v_and_b32 v26, 0x7fff7fff, v62
    v_pk_sub_u16 v26, v26, s98 clamp
    v_bfi_b32 v62, s79, v26, v62
    v_and_b32 v27, 0x7fff7fff, v63
    v_pk_sub_u16 v27, v27, s98 clamp
    v_bfi_b32 v63, s79, v27, v63
    v_or3_b32 v24, v24, v48, v49
    v_or3_b32 v24, v24, v50, v51
    v_or3_b32 v24, v24, v52, v53
    v_or3_b32 v24, v24, v54, v55
    v_or3_b32 v24, v24, v56, v57
    v_or3_b32 v24, v24, v58, v59
    v_or3_b32 v24, v24, v60, v61
    v_or3_b32 v24, v24, v62, v63
    v_lshlrev_b32 v36, 11, v60
    v_and_or_b32 v48, v36, s78, v48
    v_lshlrev_b32 v37, 11, v61
    v_and_or_b32 v49, v37, s78, v49
    v_lshlrev_b32 v36, 11, v62
    v_and_or_b32 v50, v36, s78, v50
    v_lshlrev_b32 v37, 11, v63
    v_and_or_b32 v51, v37, s78, v51
    v_lshlrev_b32 v36, 7, v60
    v_and_or_b32 v52, v36, s78, v52
    v_lshlrev_b32 v37, 7, v61
    v_and_or_b32 v53, v37, s78, v53
    v_lshlrev_b32 v36, 7, v62
    v_and_or_b32 v54, v36, s78, v54
    v_lshlrev_b32 v37, 7, v63
    v_and_or_b32 v55, v37, s78, v55
    v_lshlrev_b32 v36, 3, v60
    v_and_or_b32 v56, v36, s78, v56
    v_lshrrev_b32 v37, 1, v60
    v_and_or_b32 v56, v37, s78, v56
    v_lshlrev_b32 v36, 3, v61
    v_and_or_b32 v57, v36, s78, v57
    v_lshrrev_b32 v37, 1, v61
    v_and_or_b32 v57, v37, s78, v57
    v_lshlrev_b32 v36, 3, v62
    v_and_or_b32 v58, v36, s78, v58
    v_lshrrev_b32 v37, 1, v62
    v_and_or_b32 v58, v37, s78, v58
    v_lshlrev_b32 v36, 3, v63
    v_and_or_b32 v59, v36, s78, v59
    v_lshrrev_b32 v37, 1, v63
    v_and_or_b32 v59, v37, s78, v59
    v_lshlrev_b32 v36, 4, v0
    v_add_u32 v36, s59, v36
    ds_write_b128 v36, v[48:51] offset:30208
    ds_write_b128 v36, v[52:55] offset:31232
    ds_write_b128 v36, v[56:59] offset:32256
    v_and_b32 v24, s78, v24
    v_cmp_ne_u32 vcc, 0, v24
    s_cmp_lg_u64 vcc, 0
    s_cselect_b32 s60, 262144, 0
    s_or_b32 s99, s99, s60
    s_waitcnt vmcnt(12)
    ds_read_b128 v[48:51], v9 offset:0
    ds_read_b128 v[52:55], v10 offset:0
    ds_read_b128 v[56:59], v11 offset:0
    ds_read_b128 v[60:63], v12 offset:0
    s_waitcnt vmcnt(8)
    v_accvgpr_read_b32 v64, a0
    v_accvgpr_read_b32 v65, a1
    v_accvgpr_read_b32 v66, a2
    v_accvgpr_read_b32 v67, a3
    v_accvgpr_read_b32 v68, a4
    v_accvgpr_read_b32 v69, a5
    v_accvgpr_read_b32 v70, a6
    v_accvgpr_read_b32 v71, a7
    v_accvgpr_read_b32 v72, a8
    v_accvgpr_read_b32 v73, a9
    v_accvgpr_read_b32 v74, a10
    v_accvgpr_read_b32 v75, a11
    v_accvgpr_read_b32 v76, a12
    v_accvgpr_read_b32 v77, a13
    v_accvgpr_read_b32 v78, a14
    v_accvgpr_read_b32 v79, a15
    s_waitcnt lgkmcnt(0)
    s_add_u32 s76, s90, 0
    s_mul_i32 s54, s76, s85
    s_add_u32 s54, s54, s53
    s_add_u32 m0, s59, 0
    s_nop 0
    buffer_load_dwordx4 v4, s[4:7], s54 offen offset:0 nt lds
    buffer_load_dwordx4 v5, s[4:7], s54 offen offset:1024 nt lds
    buffer_load_dwordx4 v6, s[4:7], s54 offen offset:2048 nt lds
    buffer_load_dwordx4 v7, s[4:7], s54 offen offset:3072 nt lds
    buffer_load_dwordx4 a[0:3], v8, s[8:11], s54 offen offset:0 nt
    buffer_load_dwordx4 a[4:7], v8, s[8:11], s54 offen offset:256 nt
    buffer_load_dwordx4 a[8:11], v8, s[8:11], s54 offen offset:512 nt
    buffer_load_dwordx4 a[12:15], v8, s[8:11], s54 offen offset:768 nt
    buffer_load_dword v29, v28, s[36:39], 0 offen sc1
    v_and_b32 v25, 0x7fff7fff, v64
    v_pk_sub_u16 v25, v25, 1 op_sel_hi:[1,0]
    v_and_b32 v37, 0x7fff7fff, v65
    v_pk_sub_u16 v37, v37, 1 op_sel_hi:[1,0]
    v_pk_min_u16 v25, v25, v37
    v_and_b32 v36, 0x7fff7fff, v66
    v_pk_sub_u16 v36, v36, 1 op_sel_hi:[1,0]
    v_pk_min_u16 v25, v25, v36
    v_and_b32 v37, 0x7fff7fff, v67
    v_pk_sub_u16 v37, v37, 1 op_sel_hi:[1,0]
    v_pk_min_u16 v25, v25, v37
    v_and_b32 v36, 0x7fff7fff, v68
    v_pk_sub_u16 v36, v36, 1 op_sel_hi:[1,0]
    v_pk_min_u16 v25, v25, v36
    v_and_b32 v37, 0x7fff7fff, v69
    v_pk_sub_u16 v37, v37, 1 op_sel_hi:[1,0]
    v_pk_min_u16 v25, v25, v37
    v_and_b32 v36, 0x7fff7fff, v70
    v_pk_sub_u16 v36, v36, 1 op_sel_hi:[1,0]
    v_pk_min_u16 v25, v25, v36
    v_and_b32 v37, 0x7fff7fff, v71
    v_pk_sub_u16 v37, v37, 1 op_sel_hi:[1,0]
    v_pk_min_u16 v25, v25, v37
    v_and_b32 v36, 0x7fff7fff, v72
    v_pk_sub_u16 v36, v36, 1 op_sel_hi:[1,0]
    v_pk_min_u16 v25, v25, v36
    v_and_b32 v37, 0x7fff7fff, v73
    v_pk_sub_u16 v37, v37, 1 op_sel_hi:[1,0]
    v_pk_min_u16 v25, v25, v37
    v_and_b32 v36, 0x7fff7fff, v74
    v_pk_sub_u16 v36, v36, 1 op_sel_hi:[1,0]
    v_pk_min_u16 v25, v25, v36
    v_and_b32 v37, 0x7fff7fff, v75
    v_pk_sub_u16 v37, v37, 1 op_sel_hi:[1,0]
    v_pk_min_u16 v25, v25, v37
    v_and_b32 v36, 0x7fff7fff, v76
    v_pk_sub_u16 v36, v36, 1 op_sel_hi:[1,0]
    v_pk_min_u16 v25, v25, v36
    v_and_b32 v37, 0x7fff7fff, v77
    v_pk_sub_u16 v37, v37, 1 op_sel_hi:[1,0]
    v_pk_min_u16 v25, v25, v37
    v_and_b32 v36, 0x7fff7fff, v78
    v_pk_sub_u16 v36, v36, 1 op_sel_hi:[1,0]
    v_pk_min_u16 v25, v25, v36
    v_and_b32 v37, 0x7fff7fff, v79
    v_pk_sub_u16 v37, v37, 1 op_sel_hi:[1,0]
    v_pk_min_u16 v25, v25, v37
    v_mov_b32 v36, 0x397f397f
    v_pk_sub_u16 v36, v36, v25 clamp
    v_cmp_ne_u32 vcc, 0, v36
    s_or_b32 s62, 51, 0
    s_getpc_b64 s[92:93]
    s_cbranch_vccnz REC_V
    v_and_b32 v26, 0x7fff7fff, v64
    v_pk_sub_u16 v26, v26, s94 clamp
    v_bfi_b32 v64, s79, v26, v64
    v_and_b32 v27, 0x7fff7fff, v65
    v_pk_sub_u16 v27, v27, s94 clamp
    v_bfi_b32 v65, s79, v27, v65
    v_and_b32 v26, 0x7fff7fff, v66
    v_pk_sub_u16 v26, v26, s94 clamp
    v_bfi_b32 v66, s79, v26, v66
    v_and_b32 v27, 0x7fff7fff, v67
    v_pk_sub_u16 v27, v27, s94 clamp
    v_bfi_b32 v67, s79, v27, v67
    v_and_b32 v26, 0x7fff7fff, v68
    v_pk_sub_u16 v26, v26, s94 clamp
    v_bfi_b32 v68, s79, v26, v68
    v_and_b32 v27, 0x7fff7fff, v69
    v_pk_sub_u16 v27, v27, s94 clamp
    v_bfi_b32 v69, s79, v27, v69
    v_and_b32 v26, 0x7fff7fff, v70
    v_pk_sub_u16 v26, v26, s94 clamp
    v_bfi_b32 v70, s79, v26, v70
    v_and_b32 v27, 0x7fff7fff, v71
    v_pk_sub_u16 v27, v27, s94 clamp
    v_bfi_b32 v71, s79, v27, v71
    v_and_b32 v26, 0x7fff7fff, v72
    v_pk_sub_u16 v26, v26, s94 clamp
    v_bfi_b32 v72, s79, v26, v72
    v_and_b32 v27, 0x7fff7fff, v73
    v_pk_sub_u16 v27, v27, s94 clamp
    v_bfi_b32 v73, s79, v27, v73
    v_and_b32 v26, 0x7fff7fff, v74
    v_pk_sub_u16 v26, v26, s94 clamp
    v_bfi_b32 v74, s79, v26, v74
    v_and_b32 v27, 0x7fff7fff, v75
    v_pk_sub_u16 v27, v27, s94 clamp
    v_bfi_b32 v75, s79, v27, v75
    v_and_b32 v26, 0x7fff7fff, v76
    v_pk_sub_u16 v26, v26, s94 clamp
    v_bfi_b32 v76, s79, v26, v76
    v_and_b32 v27, 0x7fff7fff, v77
    v_pk_sub_u16 v27, v27, s94 clamp
    v_bfi_b32 v77, s79, v27, v77
    v_and_b32 v26, 0x7fff7fff, v78
    v_pk_sub_u16 v26, v26, s94 clamp
    v_bfi_b32 v78, s79, v26, v78
    v_and_b32 v27, 0x7fff7fff, v79
    v_pk_sub_u16 v27, v27, s94 clamp
    v_bfi_b32 v79, s79, v27, v79
    v_or_b32 v24, v64, v65
    v_or3_b32 v24, v24, v66, v67
    v_or3_b32 v24, v24, v68, v69
    v_or3_b32 v24, v24, v70, v71
    v_or3_b32 v24, v24, v72, v73
    v_or3_b32 v24, v24, v74, v75
    v_or3_b32 v24, v24, v76, v77
    v_or3_b32 v24, v24, v78, v79
    v_lshlrev_b32 v36, 11, v76
    v_and_or_b32 v64, v36, s78, v64
    v_accvgpr_write_b32 a220, v64
    v_lshlrev_b32 v37, 11, v77
    v_and_or_b32 v65, v37, s78, v65
    v_accvgpr_write_b32 a221, v65
    v_lshlrev_b32 v36, 11, v78
    v_and_or_b32 v66, v36, s78, v66
    v_accvgpr_write_b32 a222, v66
    v_lshlrev_b32 v37, 11, v79
    v_and_or_b32 v67, v37, s78, v67
    v_accvgpr_write_b32 a223, v67
    v_lshlrev_b32 v36, 7, v76
    v_and_or_b32 v68, v36, s78, v68
    v_accvgpr_write_b32 a224, v68
    v_lshlrev_b32 v37, 7, v77
    v_and_or_b32 v69, v37, s78, v69
    v_accvgpr_write_b32 a225, v69
    v_lshlrev_b32 v36, 7, v78
    v_and_or_b32 v70, v36, s78, v70
    v_accvgpr_write_b32 a226, v70
    v_lshlrev_b32 v37, 7, v79
    v_and_or_b32 v71, v37, s78, v71
    v_accvgpr_write_b32 a227, v71
    v_lshlrev_b32 v36, 3, v76
    v_and_or_b32 v72, v36, s78, v72
    v_lshrrev_b32 v37, 1, v76
    v_and_or_b32 v72, v37, s78, v72
    v_accvgpr_write_b32 a228, v72
    v_lshlrev_b32 v36, 3, v77
    v_and_or_b32 v73, v36, s78, v73
    v_lshrrev_b32 v37, 1, v77
    v_and_or_b32 v73, v37, s78, v73
    v_accvgpr_write_b32 a229, v73
    v_lshlrev_b32 v36, 3, v78
    v_and_or_b32 v74, v36, s78, v74
    v_lshrrev_b32 v37, 1, v78
    v_and_or_b32 v74, v37, s78, v74
    v_accvgpr_write_b32 a230, v74
    v_lshlrev_b32 v36, 3, v79
    v_and_or_b32 v75, v36, s78, v75
    v_lshrrev_b32 v37, 1, v79
    v_and_or_b32 v75, v37, s78, v75
    v_accvgpr_write_b32 a231, v75
    v_and_b32 v25, 0x7fff7fff, v48
    v_pk_sub_u16 v25, v25, 1 op_sel_hi:[1,0]
    v_and_b32 v37, 0x7fff7fff, v49
    v_pk_sub_u16 v37, v37, 1 op_sel_hi:[1,0]
    v_pk_min_u16 v25, v25, v37
    v_and_b32 v36, 0x7fff7fff, v50
    v_pk_sub_u16 v36, v36, 1 op_sel_hi:[1,0]
    v_pk_min_u16 v25, v25, v36
    v_and_b32 v37, 0x7fff7fff, v51
    v_pk_sub_u16 v37, v37, 1 op_sel_hi:[1,0]
    v_pk_min_u16 v25, v25, v37
    v_and_b32 v36, 0x7fff7fff, v52
    v_pk_sub_u16 v36, v36, 1 op_sel_hi:[1,0]
    v_pk_min_u16 v25, v25, v36
    v_and_b32 v37, 0x7fff7fff, v53
    v_pk_sub_u16 v37, v37, 1 op_sel_hi:[1,0]
    v_pk_min_u16 v25, v25, v37
    v_and_b32 v36, 0x7fff7fff, v54
    v_pk_sub_u16 v36, v36, 1 op_sel_hi:[1,0]
    v_pk_min_u16 v25, v25, v36
    v_and_b32 v37, 0x7fff7fff, v55
    v_pk_sub_u16 v37, v37, 1 op_sel_hi:[1,0]
    v_pk_min_u16 v25, v25, v37
    v_and_b32 v36, 0x7fff7fff, v56
    v_pk_sub_u16 v36, v36, 1 op_sel_hi:[1,0]
    v_pk_min_u16 v25, v25, v36
    v_and_b32 v37, 0x7fff7fff, v57
    v_pk_sub_u16 v37, v37, 1 op_sel_hi:[1,0]
    v_pk_min_u16 v25, v25, v37
    v_and_b32 v36, 0x7fff7fff, v58
    v_pk_sub_u16 v36, v36, 1 op_sel_hi:[1,0]
    v_pk_min_u16 v25, v25, v36
    v_and_b32 v37, 0x7fff7fff, v59
    v_pk_sub_u16 v37, v37, 1 op_sel_hi:[1,0]
    v_pk_min_u16 v25, v25, v37
    v_and_b32 v36, 0x7fff7fff, v60
    v_pk_sub_u16 v36, v36, 1 op_sel_hi:[1,0]
    v_pk_min_u16 v25, v25, v36
    v_and_b32 v37, 0x7fff7fff, v61
    v_pk_sub_u16 v37, v37, 1 op_sel_hi:[1,0]
    v_pk_min_u16 v25, v25, v37
    v_and_b32 v36, 0x7fff7fff, v62
    v_pk_sub_u16 v36, v36, 1 op_sel_hi:[1,0]
    v_pk_min_u16 v25, v25, v36
    v_and_b32 v37, 0x7fff7fff, v63
    v_pk_sub_u16 v37, v37, 1 op_sel_hi:[1,0]
    v_pk_min_u16 v25, v25, v37
    v_mov_b32 v36, 0x38ff38ff
    v_pk_sub_u16 v36, v36, v25 clamp
    v_cmp_ne_u32 vcc, 0, v36
    s_or_b32 s62, 19, 0
    s_getpc_b64 s[92:93]
    s_cbranch_vccnz REC_K
    v_and_b32 v26, 0x7fff7fff, v48
    v_pk_sub_u16 v26, v26, s98 clamp
    v_bfi_b32 v48, s79, v26, v48
    v_and_b32 v27, 0x7fff7fff, v49
    v_pk_sub_u16 v27, v27, s98 clamp
    v_bfi_b32 v49, s79, v27, v49
    v_and_b32 v26, 0x7fff7fff, v50
    v_pk_sub_u16 v26, v26, s98 clamp
    v_bfi_b32 v50, s79, v26, v50
    v_and_b32 v27, 0x7fff7fff, v51
    v_pk_sub_u16 v27, v27, s98 clamp
    v_bfi_b32 v51, s79, v27, v51
    v_and_b32 v26, 0x7fff7fff, v52
    v_pk_sub_u16 v26, v26, s98 clamp
    v_bfi_b32 v52, s79, v26, v52
    v_and_b32 v27, 0x7fff7fff, v53
    v_pk_sub_u16 v27, v27, s98 clamp
    v_bfi_b32 v53, s79, v27, v53
    v_and_b32 v26, 0x7fff7fff, v54
    v_pk_sub_u16 v26, v26, s98 clamp
    v_bfi_b32 v54, s79, v26, v54
    v_and_b32 v27, 0x7fff7fff, v55
    v_pk_sub_u16 v27, v27, s98 clamp
    v_bfi_b32 v55, s79, v27, v55
    v_and_b32 v26, 0x7fff7fff, v56
    v_pk_sub_u16 v26, v26, s98 clamp
    v_bfi_b32 v56, s79, v26, v56
    v_and_b32 v27, 0x7fff7fff, v57
    v_pk_sub_u16 v27, v27, s98 clamp
    v_bfi_b32 v57, s79, v27, v57
    v_and_b32 v26, 0x7fff7fff, v58
    v_pk_sub_u16 v26, v26, s98 clamp
    v_bfi_b32 v58, s79, v26, v58
    v_and_b32 v27, 0x7fff7fff, v59
    v_pk_sub_u16 v27, v27, s98 clamp
    v_bfi_b32 v59, s79, v27, v59
    v_and_b32 v26, 0x7fff7fff, v60
    v_pk_sub_u16 v26, v26, s98 clamp
    v_bfi_b32 v60, s79, v26, v60
    v_and_b32 v27, 0x7fff7fff, v61
    v_pk_sub_u16 v27, v27, s98 clamp
    v_bfi_b32 v61, s79, v27, v61
    v_and_b32 v26, 0x7fff7fff, v62
    v_pk_sub_u16 v26, v26, s98 clamp
    v_bfi_b32 v62, s79, v26, v62
    v_and_b32 v27, 0x7fff7fff, v63
    v_pk_sub_u16 v27, v27, s98 clamp
    v_bfi_b32 v63, s79, v27, v63
    v_or3_b32 v24, v24, v48, v49
    v_or3_b32 v24, v24, v50, v51
    v_or3_b32 v24, v24, v52, v53
    v_or3_b32 v24, v24, v54, v55
    v_or3_b32 v24, v24, v56, v57
    v_or3_b32 v24, v24, v58, v59
    v_or3_b32 v24, v24, v60, v61
    v_or3_b32 v24, v24, v62, v63
    v_lshlrev_b32 v36, 11, v60
    v_and_or_b32 v48, v36, s78, v48
    v_lshlrev_b32 v37, 11, v61
    v_and_or_b32 v49, v37, s78, v49
    v_lshlrev_b32 v36, 11, v62
    v_and_or_b32 v50, v36, s78, v50
    v_lshlrev_b32 v37, 11, v63
    v_and_or_b32 v51, v37, s78, v51
    v_lshlrev_b32 v36, 7, v60
    v_and_or_b32 v52, v36, s78, v52
    v_lshlrev_b32 v37, 7, v61
    v_and_or_b32 v53, v37, s78, v53
    v_lshlrev_b32 v36, 7, v62
    v_and_or_b32 v54, v36, s78, v54
    v_lshlrev_b32 v37, 7, v63
    v_and_or_b32 v55, v37, s78, v55
    v_lshlrev_b32 v36, 3, v60
    v_and_or_b32 v56, v36, s78, v56
    v_lshrrev_b32 v37, 1, v60
    v_and_or_b32 v56, v37, s78, v56
    v_lshlrev_b32 v36, 3, v61
    v_and_or_b32 v57, v36, s78, v57
    v_lshrrev_b32 v37, 1, v61
    v_and_or_b32 v57, v37, s78, v57
    v_lshlrev_b32 v36, 3, v62
    v_and_or_b32 v58, v36, s78, v58
    v_lshrrev_b32 v37, 1, v62
    v_and_or_b32 v58, v37, s78, v58
    v_lshlrev_b32 v36, 3, v63
    v_and_or_b32 v59, v36, s78, v59
    v_lshrrev_b32 v37, 1, v63
    v_and_or_b32 v59, v37, s78, v59
    v_lshlrev_b32 v36, 4, v0
    v_add_u32 v36, s59, v36
    ds_write_b128 v36, v[48:51] offset:33280
    ds_write_b128 v36, v[52:55] offset:34304
    ds_write_b128 v36, v[56:59] offset:35328
    v_and_b32 v24, s78, v24
    v_cmp_ne_u32 vcc, 0, v24
    s_cmp_lg_u64 vcc, 0
    s_cselect_b32 s60, 524288, 0
    s_or_b32 s99, s99, s60
    s_waitcnt vmcnt(13)
    ds_read_b128 v[48:51], v9 offset:4096
    ds_read_b128 v[52:55], v10 offset:4096
    ds_read_b128 v[56:59], v11 offset:4096
    ds_read_b128 v[60:63], v12 offset:4096
    s_waitcnt vmcnt(9)
    v_accvgpr_read_b32 v64, a16
    v_accvgpr_read_b32 v65, a17
    v_accvgpr_read_b32 v66, a18
    v_accvgpr_read_b32 v67, a19
    v_accvgpr_read_b32 v68, a20
    v_accvgpr_read_b32 v69, a21
    v_accvgpr_read_b32 v70, a22
    v_accvgpr_read_b32 v71, a23
    v_accvgpr_read_b32 v72, a24
    v_accvgpr_read_b32 v73, a25
    v_accvgpr_read_b32 v74, a26
    v_accvgpr_read_b32 v75, a27
    v_accvgpr_read_b32 v76, a28
    v_accvgpr_read_b32 v77, a29
    v_accvgpr_read_b32 v78, a30
    v_accvgpr_read_b32 v79, a31
    s_waitcnt lgkmcnt(0)
    s_add_u32 s77, s90, 16
    s_mul_i32 s54, s77, s85
    s_add_u32 s54, s54, s53
    s_add_u32 m0, s59, 4096
    s_nop 0
    buffer_load_dwordx4 v4, s[4:7], s54 offen offset:0 nt lds
    buffer_load_dwordx4 v5, s[4:7], s54 offen offset:1024 nt lds
    buffer_load_dwordx4 v6, s[4:7], s54 offen offset:2048 nt lds
    buffer_load_dwordx4 v7, s[4:7], s54 offen offset:3072 nt lds
    buffer_load_dwordx4 a[16:19], v8, s[8:11], s54 offen offset:0 nt
    buffer_load_dwordx4 a[20:23], v8, s[8:11], s54 offen offset:256 nt
    buffer_load_dwordx4 a[24:27], v8, s[8:11], s54 offen offset:512 nt
    buffer_load_dwordx4 a[28:31], v8, s[8:11], s54 offen offset:768 nt
    v_and_b32 v25, 0x7fff7fff, v64
    v_pk_sub_u16 v25, v25, 1 op_sel_hi:[1,0]
    v_and_b32 v37, 0x7fff7fff, v65
    v_pk_sub_u16 v37, v37, 1 op_sel_hi:[1,0]
    v_pk_min_u16 v25, v25, v37
    v_and_b32 v36, 0x7fff7fff, v66
    v_pk_sub_u16 v36, v36, 1 op_sel_hi:[1,0]
    v_pk_min_u16 v25, v25, v36
    v_and_b32 v37, 0x7fff7fff, v67
    v_pk_sub_u16 v37, v37, 1 op_sel_hi:[1,0]
    v_pk_min_u16 v25, v25, v37
    v_and_b32 v36, 0x7fff7fff, v68
    v_pk_sub_u16 v36, v36, 1 op_sel_hi:[1,0]
    v_pk_min_u16 v25, v25, v36
    v_and_b32 v37, 0x7fff7fff, v69
    v_pk_sub_u16 v37, v37, 1 op_sel_hi:[1,0]
    v_pk_min_u16 v25, v25, v37
    v_and_b32 v36, 0x7fff7fff, v70
    v_pk_sub_u16 v36, v36, 1 op_sel_hi:[1,0]
    v_pk_min_u16 v25, v25, v36
    v_and_b32 v37, 0x7fff7fff, v71
    v_pk_sub_u16 v37, v37, 1 op_sel_hi:[1,0]
    v_pk_min_u16 v25, v25, v37
    v_and_b32 v36, 0x7fff7fff, v72
    v_pk_sub_u16 v36, v36, 1 op_sel_hi:[1,0]
    v_pk_min_u16 v25, v25, v36
    v_and_b32 v37, 0x7fff7fff, v73
    v_pk_sub_u16 v37, v37, 1 op_sel_hi:[1,0]
    v_pk_min_u16 v25, v25, v37
    v_and_b32 v36, 0x7fff7fff, v74
    v_pk_sub_u16 v36, v36, 1 op_sel_hi:[1,0]
    v_pk_min_u16 v25, v25, v36
    v_and_b32 v37, 0x7fff7fff, v75
    v_pk_sub_u16 v37, v37, 1 op_sel_hi:[1,0]
    v_pk_min_u16 v25, v25, v37
    v_and_b32 v36, 0x7fff7fff, v76
    v_pk_sub_u16 v36, v36, 1 op_sel_hi:[1,0]
    v_pk_min_u16 v25, v25, v36
    v_and_b32 v37, 0x7fff7fff, v77
    v_pk_sub_u16 v37, v37, 1 op_sel_hi:[1,0]
    v_pk_min_u16 v25, v25, v37
    v_and_b32 v36, 0x7fff7fff, v78
    v_pk_sub_u16 v36, v36, 1 op_sel_hi:[1,0]
    v_pk_min_u16 v25, v25, v36
    v_and_b32 v37, 0x7fff7fff, v79
    v_pk_sub_u16 v37, v37, 1 op_sel_hi:[1,0]
    v_pk_min_u16 v25, v25, v37
    v_mov_b32 v36, 0x397f397f
    v_pk_sub_u16 v36, v36, v25 clamp
    v_cmp_ne_u32 vcc, 0, v36
    s_or_b32 s62, 52, 0
    s_getpc_b64 s[92:93]
    s_cbranch_vccnz REC_V
    v_and_b32 v26, 0x7fff7fff, v64
    v_pk_sub_u16 v26, v26, s94 clamp
    v_bfi_b32 v64, s79, v26, v64
    v_and_b32 v27, 0x7fff7fff, v65
    v_pk_sub_u16 v27, v27, s94 clamp
    v_bfi_b32 v65, s79, v27, v65
    v_and_b32 v26, 0x7fff7fff, v66
    v_pk_sub_u16 v26, v26, s94 clamp
    v_bfi_b32 v66, s79, v26, v66
    v_and_b32 v27, 0x7fff7fff, v67
    v_pk_sub_u16 v27, v27, s94 clamp
    v_bfi_b32 v67, s79, v27, v67
    v_and_b32 v26, 0x7fff7fff, v68
    v_pk_sub_u16 v26, v26, s94 clamp
    v_bfi_b32 v68, s79, v26, v68
    v_and_b32 v27, 0x7fff7fff, v69
    v_pk_sub_u16 v27, v27, s94 clamp
    v_bfi_b32 v69, s79, v27, v69
    v_and_b32 v26, 0x7fff7fff, v70
    v_pk_sub_u16 v26, v26, s94 clamp
    v_bfi_b32 v70, s79, v26, v70
    v_and_b32 v27, 0x7fff7fff, v71
    v_pk_sub_u16 v27, v27, s94 clamp
    v_bfi_b32 v71, s79, v27, v71
    v_and_b32 v26, 0x7fff7fff, v72
    v_pk_sub_u16 v26, v26, s94 clamp
    v_bfi_b32 v72, s79, v26, v72
    v_and_b32 v27, 0x7fff7fff, v73
    v_pk_sub_u16 v27, v27, s94 clamp
    v_bfi_b32 v73, s79, v27, v73
    v_and_b32 v26, 0x7fff7fff, v74
    v_pk_sub_u16 v26, v26, s94 clamp
    v_bfi_b32 v74, s79, v26, v74
    v_and_b32 v27, 0x7fff7fff, v75
    v_pk_sub_u16 v27, v27, s94 clamp
    v_bfi_b32 v75, s79, v27, v75
    v_and_b32 v26, 0x7fff7fff, v76
    v_pk_sub_u16 v26, v26, s94 clamp
    v_bfi_b32 v76, s79, v26, v76
    v_and_b32 v27, 0x7fff7fff, v77
    v_pk_sub_u16 v27, v27, s94 clamp
    v_bfi_b32 v77, s79, v27, v77
    v_and_b32 v26, 0x7fff7fff, v78
    v_pk_sub_u16 v26, v26, s94 clamp
    v_bfi_b32 v78, s79, v26, v78
    v_and_b32 v27, 0x7fff7fff, v79
    v_pk_sub_u16 v27, v27, s94 clamp
    v_bfi_b32 v79, s79, v27, v79
    v_or_b32 v24, v64, v65
    v_or3_b32 v24, v24, v66, v67
    v_or3_b32 v24, v24, v68, v69
    v_or3_b32 v24, v24, v70, v71
    v_or3_b32 v24, v24, v72, v73
    v_or3_b32 v24, v24, v74, v75
    v_or3_b32 v24, v24, v76, v77
    v_or3_b32 v24, v24, v78, v79
    v_lshlrev_b32 v36, 11, v76
    v_and_or_b32 v64, v36, s78, v64
    v_accvgpr_write_b32 a232, v64
    v_lshlrev_b32 v37, 11, v77
    v_and_or_b32 v65, v37, s78, v65
    v_accvgpr_write_b32 a233, v65
    v_lshlrev_b32 v36, 11, v78
    v_and_or_b32 v66, v36, s78, v66
    v_accvgpr_write_b32 a234, v66
    v_lshlrev_b32 v37, 11, v79
    v_and_or_b32 v67, v37, s78, v67
    v_accvgpr_write_b32 a235, v67
    v_lshlrev_b32 v36, 7, v76
    v_and_or_b32 v68, v36, s78, v68
    v_accvgpr_write_b32 a236, v68
    v_lshlrev_b32 v37, 7, v77
    v_and_or_b32 v69, v37, s78, v69
    v_accvgpr_write_b32 a237, v69
    v_lshlrev_b32 v36, 7, v78
    v_and_or_b32 v70, v36, s78, v70
    v_accvgpr_write_b32 a238, v70
    v_lshlrev_b32 v37, 7, v79
    v_and_or_b32 v71, v37, s78, v71
    v_accvgpr_write_b32 a239, v71
    v_lshlrev_b32 v36, 3, v76
    v_and_or_b32 v72, v36, s78, v72
    v_lshrrev_b32 v37, 1, v76
    v_and_or_b32 v72, v37, s78, v72
    v_accvgpr_write_b32 a240, v72
    v_lshlrev_b32 v36, 3, v77
    v_and_or_b32 v73, v36, s78, v73
    v_lshrrev_b32 v37, 1, v77
    v_and_or_b32 v73, v37, s78, v73
    v_accvgpr_write_b32 a241, v73
    v_lshlrev_b32 v36, 3, v78
    v_and_or_b32 v74, v36, s78, v74
    v_lshrrev_b32 v37, 1, v78
    v_and_or_b32 v74, v37, s78, v74
    v_accvgpr_write_b32 a242, v74
    v_lshlrev_b32 v36, 3, v79
    v_and_or_b32 v75, v36, s78, v75
    v_lshrrev_b32 v37, 1, v79
    v_and_or_b32 v75, v37, s78, v75
    v_accvgpr_write_b32 a243, v75
    v_and_b32 v25, 0x7fff7fff, v48
    v_pk_sub_u16 v25, v25, 1 op_sel_hi:[1,0]
    v_and_b32 v37, 0x7fff7fff, v49
    v_pk_sub_u16 v37, v37, 1 op_sel_hi:[1,0]
    v_pk_min_u16 v25, v25, v37
    v_and_b32 v36, 0x7fff7fff, v50
    v_pk_sub_u16 v36, v36, 1 op_sel_hi:[1,0]
    v_pk_min_u16 v25, v25, v36
    v_and_b32 v37, 0x7fff7fff, v51
    v_pk_sub_u16 v37, v37, 1 op_sel_hi:[1,0]
    v_pk_min_u16 v25, v25, v37
    v_and_b32 v36, 0x7fff7fff, v52
    v_pk_sub_u16 v36, v36, 1 op_sel_hi:[1,0]
    v_pk_min_u16 v25, v25, v36
    v_and_b32 v37, 0x7fff7fff, v53
    v_pk_sub_u16 v37, v37, 1 op_sel_hi:[1,0]
    v_pk_min_u16 v25, v25, v37
    v_and_b32 v36, 0x7fff7fff, v54
    v_pk_sub_u16 v36, v36, 1 op_sel_hi:[1,0]
    v_pk_min_u16 v25, v25, v36
    v_and_b32 v37, 0x7fff7fff, v55
    v_pk_sub_u16 v37, v37, 1 op_sel_hi:[1,0]
    v_pk_min_u16 v25, v25, v37
    v_and_b32 v36, 0x7fff7fff, v56
    v_pk_sub_u16 v36, v36, 1 op_sel_hi:[1,0]
    v_pk_min_u16 v25, v25, v36
    v_and_b32 v37, 0x7fff7fff, v57
    v_pk_sub_u16 v37, v37, 1 op_sel_hi:[1,0]
    v_pk_min_u16 v25, v25, v37
    v_and_b32 v36, 0x7fff7fff, v58
    v_pk_sub_u16 v36, v36, 1 op_sel_hi:[1,0]
    v_pk_min_u16 v25, v25, v36
    v_and_b32 v37, 0x7fff7fff, v59
    v_pk_sub_u16 v37, v37, 1 op_sel_hi:[1,0]
    v_pk_min_u16 v25, v25, v37
    v_and_b32 v36, 0x7fff7fff, v60
    v_pk_sub_u16 v36, v36, 1 op_sel_hi:[1,0]
    v_pk_min_u16 v25, v25, v36
    v_and_b32 v37, 0x7fff7fff, v61
    v_pk_sub_u16 v37, v37, 1 op_sel_hi:[1,0]
    v_pk_min_u16 v25, v25, v37
    v_and_b32 v36, 0x7fff7fff, v62
    v_pk_sub_u16 v36, v36, 1 op_sel_hi:[1,0]
    v_pk_min_u16 v25, v25, v36
    v_and_b32 v37, 0x7fff7fff, v63
    v_pk_sub_u16 v37, v37, 1 op_sel_hi:[1,0]
    v_pk_min_u16 v25, v25, v37
    v_mov_b32 v36, 0x38ff38ff
    v_pk_sub_u16 v36, v36, v25 clamp
    v_cmp_ne_u32 vcc, 0, v36
    s_or_b32 s62, 20, 0
    s_getpc_b64 s[92:93]
    s_cbranch_vccnz REC_K
    v_and_b32 v26, 0x7fff7fff, v48
    v_pk_sub_u16 v26, v26, s98 clamp
    v_bfi_b32 v48, s79, v26, v48
    v_and_b32 v27, 0x7fff7fff, v49
    v_pk_sub_u16 v27, v27, s98 clamp
    v_bfi_b32 v49, s79, v27, v49
    v_and_b32 v26, 0x7fff7fff, v50
    v_pk_sub_u16 v26, v26, s98 clamp
    v_bfi_b32 v50, s79, v26, v50
    v_and_b32 v27, 0x7fff7fff, v51
    v_pk_sub_u16 v27, v27, s98 clamp
    v_bfi_b32 v51, s79, v27, v51
    v_and_b32 v26, 0x7fff7fff, v52
    v_pk_sub_u16 v26, v26, s98 clamp
    v_bfi_b32 v52, s79, v26, v52
    v_and_b32 v27, 0x7fff7fff, v53
    v_pk_sub_u16 v27, v27, s98 clamp
    v_bfi_b32 v53, s79, v27, v53
    v_and_b32 v26, 0x7fff7fff, v54
    v_pk_sub_u16 v26, v26, s98 clamp
    v_bfi_b32 v54, s79, v26, v54
    v_and_b32 v27, 0x7fff7fff, v55
    v_pk_sub_u16 v27, v27, s98 clamp
    v_bfi_b32 v55, s79, v27, v55
    v_and_b32 v26, 0x7fff7fff, v56
    v_pk_sub_u16 v26, v26, s98 clamp
    v_bfi_b32 v56, s79, v26, v56
    v_and_b32 v27, 0x7fff7fff, v57
    v_pk_sub_u16 v27, v27, s98 clamp
    v_bfi_b32 v57, s79, v27, v57
    v_and_b32 v26, 0x7fff7fff, v58
    v_pk_sub_u16 v26, v26, s98 clamp
    v_bfi_b32 v58, s79, v26, v58
    v_and_b32 v27, 0x7fff7fff, v59
    v_pk_sub_u16 v27, v27, s98 clamp
    v_bfi_b32 v59, s79, v27, v59
    v_and_b32 v26, 0x7fff7fff, v60
    v_pk_sub_u16 v26, v26, s98 clamp
    v_bfi_b32 v60, s79, v26, v60
    v_and_b32 v27, 0x7fff7fff, v61
    v_pk_sub_u16 v27, v27, s98 clamp
    v_bfi_b32 v61, s79, v27, v61
    v_and_b32 v26, 0x7fff7fff, v62
    v_pk_sub_u16 v26, v26, s98 clamp
    v_bfi_b32 v62, s79, v26, v62
    v_and_b32 v27, 0x7fff7fff, v63
    v_pk_sub_u16 v27, v27, s98 clamp
    v_bfi_b32 v63, s79, v27, v63
    v_or3_b32 v24, v24, v48, v49
    v_or3_b32 v24, v24, v50, v51
    v_or3_b32 v24, v24, v52, v53
    v_or3_b32 v24, v24, v54, v55
    v_or3_b32 v24, v24, v56, v57
    v_or3_b32 v24, v24, v58, v59
    v_or3_b32 v24, v24, v60, v61
    v_or3_b32 v24, v24, v62, v63
    v_lshlrev_b32 v36, 11, v60
    v_and_or_b32 v48, v36, s78, v48
    v_accvgpr_write_b32 a172, v48
    v_lshlrev_b32 v37, 11, v61
    v_and_or_b32 v49, v37, s78, v49
    v_accvgpr_write_b32 a173, v49
    v_lshlrev_b32 v36, 11, v62
    v_and_or_b32 v50, v36, s78, v50
    v_accvgpr_write_b32 a174, v50
    v_lshlrev_b32 v37, 11, v63
    v_and_or_b32 v51, v37, s78, v51
    v_accvgpr_write_b32 a175, v51
    v_lshlrev_b32 v36, 7, v60
    v_and_or_b32 v52, v36, s78, v52
    v_accvgpr_write_b32 a176, v52
    v_lshlrev_b32 v37, 7, v61
    v_and_or_b32 v53, v37, s78, v53
    v_accvgpr_write_b32 a177, v53
    v_lshlrev_b32 v36, 7, v62
    v_and_or_b32 v54, v36, s78, v54
    v_accvgpr_write_b32 a178, v54
    v_lshlrev_b32 v37, 7, v63
    v_and_or_b32 v55, v37, s78, v55
    v_accvgpr_write_b32 a179, v55
    v_lshlrev_b32 v36, 3, v60
    v_and_or_b32 v56, v36, s78, v56
    v_lshrrev_b32 v37, 1, v60
    v_and_or_b32 v56, v37, s78, v56
    v_accvgpr_write_b32 a180, v56
    v_lshlrev_b32 v36, 3, v61
    v_and_or_b32 v57, v36, s78, v57
    v_lshrrev_b32 v37, 1, v61
    v_and_or_b32 v57, v37, s78, v57
    v_accvgpr_write_b32 a181, v57
    v_lshlrev_b32 v36, 3, v62
    v_and_or_b32 v58, v36, s78, v58
    v_lshrrev_b32 v37, 1, v62
    v_and_or_b32 v58, v37, s78, v58
    v_accvgpr_write_b32 a182, v58
    v_lshlrev_b32 v36, 3, v63
    v_and_or_b32 v59, v36, s78, v59
    v_lshrrev_b32 v37, 1, v63
    v_and_or_b32 v59, v37, s78, v59
    v_accvgpr_write_b32 a183, v59
    v_and_b32 v24, s78, v24
    v_cmp_ne_u32 vcc, 0, v24
    s_cmp_lg_u64 vcc, 0
    s_cselect_b32 s60, 1048576, 0
    s_or_b32 s99, s99, s60
    s_waitcnt vmcnt(8)
    s_mov_b32 s64, 200000
QF_17:
    v_cmp_ne_u32 vcc, 4, v29
    s_cbranch_vccz QD_18
    buffer_load_dword v29, v28, s[36:39], 0 offen sc1
    s_waitcnt vmcnt(0)
    s_sub_u32 s64, s64, 1
    s_cmp_lg_u32 s64, 0
    s_cbranch_scc1 QF_17
QD_18:
    v_bfe_u32 v38, v0, 3, 1
    v_lshlrev_b32 v38, 8, v38
    v_lshrrev_b32 v39, 4, v0
    v_lshl_add_u32 v38, v39, 4, v38
    s_lshl_b32 s60, s57, 9
    s_add_u32 s60, s60, 3145728
    buffer_load_dwordx4 v[64:67], v38, s[32:35], s60 offen offset:0 sc1
    buffer_load_dwordx4 v[68:71], v38, s[32:35], s60 offen offset:64 sc1
    buffer_load_dwordx4 v[72:75], v38, s[32:35], s60 offen offset:128 sc1
    buffer_load_dwordx4 v[76:79], v38, s[32:35], s60 offen offset:192 sc1
    s_waitcnt vmcnt(0)
    s_nop 7
    s_nop 1
    s_branch RJ_13
RP_15:
    s_nop 7
    s_nop 1
    s_waitcnt vmcnt(20)
    ds_read_b128 v[48:51], v9 offset:0
    ds_read_b128 v[52:55], v10 offset:0
    ds_read_b128 v[56:59], v11 offset:0
    ds_read_b128 v[60:63], v12 offset:0
    s_waitcnt vmcnt(16)
    v_accvgpr_read_b32 v64, a0
    v_accvgpr_read_b32 v65, a1
    v_accvgpr_read_b32 v66, a2
    v_accvgpr_read_b32 v67, a3
    v_accvgpr_read_b32 v68, a4
    v_accvgpr_read_b32 v69, a5
    v_accvgpr_read_b32 v70, a6
    v_accvgpr_read_b32 v71, a7
    v_accvgpr_read_b32 v72, a8
    v_accvgpr_read_b32 v73, a9
    v_accvgpr_read_b32 v74, a10
    v_accvgpr_read_b32 v75, a11
    v_accvgpr_read_b32 v76, a12
    v_accvgpr_read_b32 v77, a13
    v_accvgpr_read_b32 v78, a14
    v_accvgpr_read_b32 v79, a15
    s_waitcnt lgkmcnt(0)
    v_lshrrev_b32 v1, 4, v0
    v_lshlrev_b32 v1, 1, v1
    v_bfe_u32 v2, v0, 3, 1
    v_add_u32 v1, v1, v2
    v_mul_u32_u24 v1, 9216, v1
    v_and_b32 v2, 3, v0
    v_lshl_add_u32 v1, v2, 4, v1
    s_mul_i32 s60, s3, 1327104
    s_lshl_b32 s61, s63, 6
    s_add_u32 s60, s60, s61
    s_mov_b64 exec, s[70:71]
    s_add_u32 s61, s60, 0
    buffer_load_dwordx4 a[160:163], v1, s[20:23], s61 offen
    s_add_u32 s61, s60, 73728
    buffer_load_dwordx4 a[164:167], v1, s[20:23], s61 offen
    s_add_u32 s61, s60, 147456
    buffer_load_dwordx4 a[168:171], v1, s[20:23], s61 offen
    s_add_u32 s61, s60, 221184
    buffer_load_dwordx4 a[172:175], v1, s[20:23], s61 offen
    s_add_u32 s61, s60, 294912
    buffer_load_dwordx4 a[176:179], v1, s[20:23], s61 offen
    s_add_u32 s61, s60, 368640
    buffer_load_dwordx4 a[180:183], v1, s[20:23], s61 offen
    s_add_u32 s61, s60, 442368
    buffer_load_dwordx4 a[184:187], v1, s[20:23], s61 offen
    s_add_u32 s61, s60, 516096
    buffer_load_dwordx4 a[188:191], v1, s[20:23], s61 offen
    s_add_u32 s61, s60, 589824
    buffer_load_dwordx4 a[192:195], v1, s[20:23], s61 offen
    s_mov_b64 exec, s[72:73]
    s_add_u32 s61, s60, 0
    buffer_load_dwordx4 a[160:163], v1, s[24:27], s61 offen
    s_add_u32 s61, s60, 73728
    buffer_load_dwordx4 a[164:167], v1, s[24:27], s61 offen
    s_add_u32 s61, s60, 147456
    buffer_load_dwordx4 a[168:171], v1, s[24:27], s61 offen
    s_add_u32 s61, s60, 221184
    buffer_load_dwordx4 a[172:175], v1, s[24:27], s61 offen
    s_add_u32 s61, s60, 294912
    buffer_load_dwordx4 a[176:179], v1, s[24:27], s61 offen
    s_add_u32 s61, s60, 368640
    buffer_load_dwordx4 a[180:183], v1, s[24:27], s61 offen
    s_add_u32 s61, s60, 442368
    buffer_load_dwordx4 a[184:187], v1, s[24:27], s61 offen
    s_add_u32 s61, s60, 516096
    buffer_load_dwordx4 a[188:191], v1, s[24:27], s61 offen
    s_add_u32 s61, s60, 589824
    buffer_load_dwordx4 a[192:195], v1, s[24:27], s61 offen
    s_mov_b64 exec, -1
    v_and_b32 v25, 0x7fff7fff, v64
    v_pk_sub_u16 v25, v25, 1 op_sel_hi:[1,0]
    v_and_b32 v37, 0x7fff7fff, v65
    v_pk_sub_u16 v37, v37, 1 op_sel_hi:[1,0]
    v_pk_min_u16 v25, v25, v37
    v_and_b32 v36, 0x7fff7fff, v66
    v_pk_sub_u16 v36, v36, 1 op_sel_hi:[1,0]
    v_pk_min_u16 v25, v25, v36
    v_and_b32 v37, 0x7fff7fff, v67
    v_pk_sub_u16 v37, v37, 1 op_sel_hi:[1,0]
    v_pk_min_u16 v25, v25, v37
    v_and_b32 v36, 0x7fff7fff, v68
    v_pk_sub_u16 v36, v36, 1 op_sel_hi:[1,0]
    v_pk_min_u16 v25, v25, v36
    v_and_b32 v37, 0x7fff7fff, v69
    v_pk_sub_u16 v37, v37, 1 op_sel_hi:[1,0]
    v_pk_min_u16 v25, v25, v37
    v_and_b32 v36, 0x7fff7fff, v70
    v_pk_sub_u16 v36, v36, 1 op_sel_hi:[1,0]
    v_pk_min_u16 v25, v25, v36
    v_and_b32 v37, 0x7fff7fff, v71
    v_pk_sub_u16 v37, v37, 1 op_sel_hi:[1,0]
    v_pk_min_u16 v25, v25, v37
    v_and_b32 v36, 0x7fff7fff, v72
    v_pk_sub_u16 v36, v36, 1 op_sel_hi:[1,0]
    v_pk_min_u16 v25, v25, v36
    v_and_b32 v37, 0x7fff7fff, v73
    v_pk_sub_u16 v37, v37, 1 op_sel_hi:[1,0]
    v_pk_min_u16 v25, v25, v37
    v_and_b32 v36, 0x7fff7fff, v74
    v_pk_sub_u16 v36, v36, 1 op_sel_hi:[1,0]
    v_pk_min_u16 v25, v25, v36
    v_and_b32 v37, 0x7fff7fff, v75
    v_pk_sub_u16 v37, v37, 1 op_sel_hi:[1,0]
    v_pk_min_u16 v25, v25, v37
    v_and_b32 v36, 0x7fff7fff, v76
    v_pk_sub_u16 v36, v36, 1 op_sel_hi:[1,0]
    v_pk_min_u16 v25, v25, v36
    v_and_b32 v37, 0x7fff7fff, v77
    v_pk_sub_u16 v37, v37, 1 op_sel_hi:[1,0]
    v_pk_min_u16 v25, v25, v37
    v_and_b32 v36, 0x7fff7fff, v78
    v_pk_sub_u16 v36, v36, 1 op_sel_hi:[1,0]
    v_pk_min_u16 v25, v25, v36
    v_and_b32 v37, 0x7fff7fff, v79
    v_pk_sub_u16 v37, v37, 1 op_sel_hi:[1,0]
    v_pk_min_u16 v25, v25, v37
    v_mov_b32 v36, 0x397f397f
    v_pk_sub_u16 v36, v36, v25 clamp
    v_cmp_ne_u32 vcc, 0, v36
    s_or_b32 s62, 45, 0
    s_getpc_b64 s[92:93]
    s_cbranch_vccnz REC_V
    v_and_b32 v26, 0x7fff7fff, v64
    v_pk_sub_u16 v26, v26, s94 clamp
    v_bfi_b32 v64, s79, v26, v64
    v_and_b32 v27, 0x7fff7fff, v65
    v_pk_sub_u16 v27, v27, s94 clamp
    v_bfi_b32 v65, s79, v27, v65
    v_and_b32 v26, 0x7fff7fff, v66
    v_pk_sub_u16 v26, v26, s94 clamp
    v_bfi_b32 v66, s79, v26, v66
    v_and_b32 v27, 0x7fff7fff, v67
    v_pk_sub_u16 v27, v27, s94 clamp
    v_bfi_b32 v67, s79, v27, v67
    v_and_b32 v26, 0x7fff7fff, v68
    v_pk_sub_u16 v26, v26, s94 clamp
    v_bfi_b32 v68, s79, v26, v68
    v_and_b32 v27, 0x7fff7fff, v69
    v_pk_sub_u16 v27, v27, s94 clamp
    v_bfi_b32 v69, s79, v27, v69
    v_and_b32 v26, 0x7fff7fff, v70
    v_pk_sub_u16 v26, v26, s94 clamp
    v_bfi_b32 v70, s79, v26, v70
    v_and_b32 v27, 0x7fff7fff, v71
    v_pk_sub_u16 v27, v27, s94 clamp
    v_bfi_b32 v71, s79, v27, v71
    v_and_b32 v26, 0x7fff7fff, v72
    v_pk_sub_u16 v26, v26, s94 clamp
    v_bfi_b32 v72, s79, v26, v72
    v_and_b32 v27, 0x7fff7fff, v73
    v_pk_sub_u16 v27, v27, s94 clamp
    v_bfi_b32 v73, s79, v27, v73
    v_and_b32 v26, 0x7fff7fff, v74
    v_pk_sub_u16 v26, v26, s94 clamp
    v_bfi_b32 v74, s79, v26, v74
    v_and_b32 v27, 0x7fff7fff, v75
    v_pk_sub_u16 v27, v27, s94 clamp
    v_bfi_b32 v75, s79, v27, v75
    v_and_b32 v26, 0x7fff7fff, v76
    v_pk_sub_u16 v26, v26, s94 clamp
    v_bfi_b32 v76, s79, v26, v76
    v_and_b32 v27, 0x7fff7fff, v77
    v_pk_sub_u16 v27, v27, s94 clamp
    v_bfi_b32 v77, s79, v27, v77
    v_and_b32 v26, 0x7fff7fff, v78
    v_pk_sub_u16 v26, v26, s94 clamp
    v_bfi_b32 v78, s79, v26, v78
    v_and_b32 v27, 0x7fff7fff, v79
    v_pk_sub_u16 v27, v27, s94 clamp
    v_bfi_b32 v79, s79, v27, v79
    v_or_b32 v24, v64, v65
    v_or3_b32 v24, v24, v66, v67
    v_or3_b32 v24, v24, v68, v69
    v_or3_b32 v24, v24, v70, v71
    v_or3_b32 v24, v24, v72, v73
    v_or3_b32 v24, v24, v74, v75
    v_or3_b32 v24, v24, v76, v77
    v_or3_b32 v24, v24, v78, v79
    v_lshlrev_b32 v36, 11, v76
    v_and_or_b32 v236, v36, s78, v64
    v_lshlrev_b32 v37, 11, v77
    v_and_or_b32 v237, v37, s78, v65
    v_lshlrev_b32 v36, 11, v78
    v_and_or_b32 v238, v36, s78, v66
    v_lshlrev_b32 v37, 11, v79
    v_and_or_b32 v239, v37, s78, v67
    v_lshlrev_b32 v36, 7, v76
    v_and_or_b32 v240, v36, s78, v68
    v_lshlrev_b32 v37, 7, v77
    v_and_or_b32 v241, v37, s78, v69
    v_lshlrev_b32 v36, 7, v78
    v_and_or_b32 v242, v36, s78, v70
    v_lshlrev_b32 v37, 7, v79
    v_and_or_b32 v243, v37, s78, v71
    v_lshlrev_b32 v36, 3, v76
    v_and_or_b32 v72, v36, s78, v72
    v_lshrrev_b32 v37, 1, v76
    v_and_or_b32 v244, v37, s78, v72
    v_lshlrev_b32 v36, 3, v77
    v_and_or_b32 v73, v36, s78, v73
    v_lshrrev_b32 v37, 1, v77
    v_and_or_b32 v245, v37, s78, v73
    v_lshlrev_b32 v36, 3, v78
    v_and_or_b32 v74, v36, s78, v74
    v_lshrrev_b32 v37, 1, v78
    v_and_or_b32 v246, v37, s78, v74
    v_lshlrev_b32 v36, 3, v79
    v_and_or_b32 v75, v36, s78, v75
    v_lshrrev_b32 v37, 1, v79
    v_and_or_b32 v247, v37, s78, v75
    v_and_b32 v25, 0x7fff7fff, v48
    v_pk_sub_u16 v25, v25, 1 op_sel_hi:[1,0]
    v_and_b32 v37, 0x7fff7fff, v49
    v_pk_sub_u16 v37, v37, 1 op_sel_hi:[1,0]
    v_pk_min_u16 v25, v25, v37
    v_and_b32 v36, 0x7fff7fff, v50
    v_pk_sub_u16 v36, v36, 1 op_sel_hi:[1,0]
    v_pk_min_u16 v25, v25, v36
    v_and_b32 v37, 0x7fff7fff, v51
    v_pk_sub_u16 v37, v37, 1 op_sel_hi:[1,0]
    v_pk_min_u16 v25, v25, v37
    v_and_b32 v36, 0x7fff7fff, v52
    v_pk_sub_u16 v36, v36, 1 op_sel_hi:[1,0]
    v_pk_min_u16 v25, v25, v36
    v_and_b32 v37, 0x7fff7fff, v53
    v_pk_sub_u16 v37, v37, 1 op_sel_hi:[1,0]
    v_pk_min_u16 v25, v25, v37
    v_and_b32 v36, 0x7fff7fff, v54
    v_pk_sub_u16 v36, v36, 1 op_sel_hi:[1,0]
    v_pk_min_u16 v25, v25, v36
    v_and_b32 v37, 0x7fff7fff, v55
    v_pk_sub_u16 v37, v37, 1 op_sel_hi:[1,0]
    v_pk_min_u16 v25, v25, v37
    v_and_b32 v36, 0x7fff7fff, v56
    v_pk_sub_u16 v36, v36, 1 op_sel_hi:[1,0]
    v_pk_min_u16 v25, v25, v36
    v_and_b32 v37, 0x7fff7fff, v57
    v_pk_sub_u16 v37, v37, 1 op_sel_hi:[1,0]
    v_pk_min_u16 v25, v25, v37
    v_and_b32 v36, 0x7fff7fff, v58
    v_pk_sub_u16 v36, v36, 1 op_sel_hi:[1,0]
    v_pk_min_u16 v25, v25, v36
    v_and_b32 v37, 0x7fff7fff, v59
    v_pk_sub_u16 v37, v37, 1 op_sel_hi:[1,0]
    v_pk_min_u16 v25, v25, v37
    v_and_b32 v36, 0x7fff7fff, v60
    v_pk_sub_u16 v36, v36, 1 op_sel_hi:[1,0]
    v_pk_min_u16 v25, v25, v36
    v_and_b32 v37, 0x7fff7fff, v61
    v_pk_sub_u16 v37, v37, 1 op_sel_hi:[1,0]
    v_pk_min_u16 v25, v25, v37
    v_and_b32 v36, 0x7fff7fff, v62
    v_pk_sub_u16 v36, v36, 1 op_sel_hi:[1,0]
    v_pk_min_u16 v25, v25, v36
    v_and_b32 v37, 0x7fff7fff, v63
    v_pk_sub_u16 v37, v37, 1 op_sel_hi:[1,0]
    v_pk_min_u16 v25, v25, v37
    v_mov_b32 v36, 0x38ff38ff
    v_pk_sub_u16 v36, v36, v25 clamp
    v_cmp_ne_u32 vcc, 0, v36
    s_or_b32 s62, 13, 0
    s_getpc_b64 s[92:93]
    s_cbranch_vccnz REC_K
    v_and_b32 v26, 0x7fff7fff, v48
    v_pk_sub_u16 v26, v26, s98 clamp
    v_bfi_b32 v48, s79, v26, v48
    v_and_b32 v27, 0x7fff7fff, v49
    v_pk_sub_u16 v27, v27, s98 clamp
    v_bfi_b32 v49, s79, v27, v49
    v_and_b32 v26, 0x7fff7fff, v50
    v_pk_sub_u16 v26, v26, s98 clamp
    v_bfi_b32 v50, s79, v26, v50
    v_and_b32 v27, 0x7fff7fff, v51
    v_pk_sub_u16 v27, v27, s98 clamp
    v_bfi_b32 v51, s79, v27, v51
    v_and_b32 v26, 0x7fff7fff, v52
    v_pk_sub_u16 v26, v26, s98 clamp
    v_bfi_b32 v52, s79, v26, v52
    v_and_b32 v27, 0x7fff7fff, v53
    v_pk_sub_u16 v27, v27, s98 clamp
    v_bfi_b32 v53, s79, v27, v53
    v_and_b32 v26, 0x7fff7fff, v54
    v_pk_sub_u16 v26, v26, s98 clamp
    v_bfi_b32 v54, s79, v26, v54
    v_and_b32 v27, 0x7fff7fff, v55
    v_pk_sub_u16 v27, v27, s98 clamp
    v_bfi_b32 v55, s79, v27, v55
    v_and_b32 v26, 0x7fff7fff, v56
    v_pk_sub_u16 v26, v26, s98 clamp
    v_bfi_b32 v56, s79, v26, v56
    v_and_b32 v27, 0x7fff7fff, v57
    v_pk_sub_u16 v27, v27, s98 clamp
    v_bfi_b32 v57, s79, v27, v57
    v_and_b32 v26, 0x7fff7fff, v58
    v_pk_sub_u16 v26, v26, s98 clamp
    v_bfi_b32 v58, s79, v26, v58
    v_and_b32 v27, 0x7fff7fff, v59
    v_pk_sub_u16 v27, v27, s98 clamp
    v_bfi_b32 v59, s79, v27, v59
    v_and_b32 v26, 0x7fff7fff, v60
    v_pk_sub_u16 v26, v26, s98 clamp
    v_bfi_b32 v60, s79, v26, v60
    v_and_b32 v27, 0x7fff7fff, v61
    v_pk_sub_u16 v27, v27, s98 clamp
    v_bfi_b32 v61, s79, v27, v61
    v_and_b32 v26, 0x7fff7fff, v62
    v_pk_sub_u16 v26, v26, s98 clamp
    v_bfi_b32 v62, s79, v26, v62
    v_and_b32 v27, 0x7fff7fff, v63
    v_pk_sub_u16 v27, v27, s98 clamp
    v_bfi_b32 v63, s79, v27, v63
    v_or3_b32 v24, v24, v48, v49
    v_or3_b32 v24, v24, v50, v51
    v_or3_b32 v24, v24, v52, v53
    v_or3_b32 v24, v24, v54, v55
    v_or3_b32 v24, v24, v56, v57
    v_or3_b32 v24, v24, v58, v59
    v_or3_b32 v24, v24, v60, v61
    v_or3_b32 v24, v24, v62, v63
    v_lshlrev_b32 v36, 11, v60
    v_and_or_b32 v48, v36, s78, v48
    v_lshlrev_b32 v37, 11, v61
    v_and_or_b32 v49, v37, s78, v49
    v_lshlrev_b32 v36, 11, v62
    v_and_or_b32 v50, v36, s78, v50
    v_lshlrev_b32 v37, 11, v63
    v_and_or_b32 v51, v37, s78, v51
    v_lshlrev_b32 v36, 7, v60
    v_and_or_b32 v52, v36, s78, v52
    v_lshlrev_b32 v37, 7, v61
    v_and_or_b32 v53, v37, s78, v53
    v_lshlrev_b32 v36, 7, v62
    v_and_or_b32 v54, v36, s78, v54
    v_lshlrev_b32 v37, 7, v63
    v_and_or_b32 v55, v37, s78, v55
    v_lshlrev_b32 v36, 3, v60
    v_and_or_b32 v56, v36, s78, v56
    v_lshrrev_b32 v37, 1, v60
    v_and_or_b32 v56, v37, s78, v56
    v_lshlrev_b32 v36, 3, v61
    v_and_or_b32 v57, v36, s78, v57
    v_lshrrev_b32 v37, 1, v61
    v_and_or_b32 v57, v37, s78, v57
    v_lshlrev_b32 v36, 3, v62
    v_and_or_b32 v58, v36, s78, v58
    v_lshrrev_b32 v37, 1, v62
    v_and_or_b32 v58, v37, s78, v58
    v_lshlrev_b32 v36, 3, v63
    v_and_or_b32 v59, v36, s78, v59
    v_lshrrev_b32 v37, 1, v63
    v_and_or_b32 v59, v37, s78, v59
    v_lshlrev_b32 v36, 4, v0
    v_add_u32 v36, s59, v36
    ds_write_b128 v36, v[48:51] offset:17920
    ds_write_b128 v36, v[52:55] offset:18944
    ds_write_b128 v36, v[56:59] offset:19968
    v_and_b32 v24, s78, v24
    v_cmp_ne_u32 vcc, 0, v24
    s_cmp_lg_u64 vcc, 0
    s_cselect_b32 s60, 8192, 0
    s_or_b32 s99, s99, s60
    s_waitcnt vmcnt(30)
    ds_read_b128 v[48:51], v9 offset:4096
    ds_read_b128 v[52:55], v10 offset:4096
    ds_read_b128 v[56:59], v11 offset:4096
    ds_read_b128 v[60:63], v12 offset:4096
    s_waitcnt vmcnt(26)
    v_accvgpr_read_b32 v64, a16
    v_accvgpr_read_b32 v65, a17
    v_accvgpr_read_b32 v66, a18
    v_accvgpr_read_b32 v67, a19
    v_accvgpr_read_b32 v68, a20
    v_accvgpr_read_b32 v69, a21
    v_accvgpr_read_b32 v70, a22
    v_accvgpr_read_b32 v71, a23
    v_accvgpr_read_b32 v72, a24
    v_accvgpr_read_b32 v73, a25
    v_accvgpr_read_b32 v74, a26
    v_accvgpr_read_b32 v75, a27
    v_accvgpr_read_b32 v76, a28
    v_accvgpr_read_b32 v77, a29
    v_accvgpr_read_b32 v78, a30
    v_accvgpr_read_b32 v79, a31
    s_waitcnt lgkmcnt(0)
    v_lshrrev_b32 v1, 4, v0
    v_lshlrev_b32 v1, 1, v1
    v_bfe_u32 v2, v0, 3, 1
    v_add_u32 v1, v1, v2
    v_mul_u32_u24 v1, 9216, v1
    v_and_b32 v2, 3, v0
    v_lshl_add_u32 v1, v2, 4, v1
    s_mul_i32 s60, s3, 1327104
    s_lshl_b32 s61, s63, 6
    s_add_u32 s60, s60, s61
    s_mov_b64 exec, s[70:71]
    s_add_u32 s61, s60, 663552
    buffer_load_dwordx4 a[196:199], v1, s[20:23], s61 offen
    s_add_u32 s61, s60, 737280
    buffer_load_dwordx4 a[200:203], v1, s[20:23], s61 offen
    s_add_u32 s61, s60, 811008
    buffer_load_dwordx4 a[204:207], v1, s[20:23], s61 offen
    s_add_u32 s61, s60, 884736
    buffer_load_dwordx4 a[208:211], v1, s[20:23], s61 offen
    s_add_u32 s61, s60, 958464
    buffer_load_dwordx4 a[212:215], v1, s[20:23], s61 offen
    s_add_u32 s61, s60, 1032192
    buffer_load_dwordx4 a[216:219], v1, s[20:23], s61 offen
    s_add_u32 s61, s60, 1105920
    buffer_load_dwordx4 a[220:223], v1, s[20:23], s61 offen
    s_add_u32 s61, s60, 1179648
    buffer_load_dwordx4 a[224:227], v1, s[20:23], s61 offen
    s_add_u32 s61, s60, 1253376
    buffer_load_dwordx4 a[228:231], v1, s[20:23], s61 offen
    s_mov_b64 exec, s[72:73]
    s_add_u32 s61, s60, 663552
    buffer_load_dwordx4 a[196:199], v1, s[24:27], s61 offen
    s_add_u32 s61, s60, 737280
    buffer_load_dwordx4 a[200:203], v1, s[24:27], s61 offen
    s_add_u32 s61, s60, 811008
    buffer_load_dwordx4 a[204:207], v1, s[24:27], s61 offen
    s_add_u32 s61, s60, 884736
    buffer_load_dwordx4 a[208:211], v1, s[24:27], s61 offen
    s_add_u32 s61, s60, 958464
    buffer_load_dwordx4 a[212:215], v1, s[24:27], s61 offen
    s_add_u32 s61, s60, 1032192
    buffer_load_dwordx4 a[216:219], v1, s[24:27], s61 offen
    s_add_u32 s61, s60, 1105920
    buffer_load_dwordx4 a[220:223], v1, s[24:27], s61 offen
    s_add_u32 s61, s60, 1179648
    buffer_load_dwordx4 a[224:227], v1, s[24:27], s61 offen
    s_add_u32 s61, s60, 1253376
    buffer_load_dwordx4 a[228:231], v1, s[24:27], s61 offen
    s_mov_b64 exec, -1
    v_and_b32 v25, 0x7fff7fff, v64
    v_pk_sub_u16 v25, v25, 1 op_sel_hi:[1,0]
    v_and_b32 v37, 0x7fff7fff, v65
    v_pk_sub_u16 v37, v37, 1 op_sel_hi:[1,0]
    v_pk_min_u16 v25, v25, v37
    v_and_b32 v36, 0x7fff7fff, v66
    v_pk_sub_u16 v36, v36, 1 op_sel_hi:[1,0]
    v_pk_min_u16 v25, v25, v36
    v_and_b32 v37, 0x7fff7fff, v67
    v_pk_sub_u16 v37, v37, 1 op_sel_hi:[1,0]
    v_pk_min_u16 v25, v25, v37
    v_and_b32 v36, 0x7fff7fff, v68
    v_pk_sub_u16 v36, v36, 1 op_sel_hi:[1,0]
    v_pk_min_u16 v25, v25, v36
    v_and_b32 v37, 0x7fff7fff, v69
    v_pk_sub_u16 v37, v37, 1 op_sel_hi:[1,0]
    v_pk_min_u16 v25, v25, v37
    v_and_b32 v36, 0x7fff7fff, v70
    v_pk_sub_u16 v36, v36, 1 op_sel_hi:[1,0]
    v_pk_min_u16 v25, v25, v36
    v_and_b32 v37, 0x7fff7fff, v71
    v_pk_sub_u16 v37, v37, 1 op_sel_hi:[1,0]
    v_pk_min_u16 v25, v25, v37
    v_and_b32 v36, 0x7fff7fff, v72
    v_pk_sub_u16 v36, v36, 1 op_sel_hi:[1,0]
    v_pk_min_u16 v25, v25, v36
    v_and_b32 v37, 0x7fff7fff, v73
    v_pk_sub_u16 v37, v37, 1 op_sel_hi:[1,0]
    v_pk_min_u16 v25, v25, v37
    v_and_b32 v36, 0x7fff7fff, v74
    v_pk_sub_u16 v36, v36, 1 op_sel_hi:[1,0]
    v_pk_min_u16 v25, v25, v36
    v_and_b32 v37, 0x7fff7fff, v75
    v_pk_sub_u16 v37, v37, 1 op_sel_hi:[1,0]
    v_pk_min_u16 v25, v25, v37
    v_and_b32 v36, 0x7fff7fff, v76
    v_pk_sub_u16 v36, v36, 1 op_sel_hi:[1,0]
    v_pk_min_u16 v25, v25, v36
    v_and_b32 v37, 0x7fff7fff, v77
    v_pk_sub_u16 v37, v37, 1 op_sel_hi:[1,0]
    v_pk_min_u16 v25, v25, v37
    v_and_b32 v36, 0x7fff7fff, v78
    v_pk_sub_u16 v36, v36, 1 op_sel_hi:[1,0]
    v_pk_min_u16 v25, v25, v36
    v_and_b32 v37, 0x7fff7fff, v79
    v_pk_sub_u16 v37, v37, 1 op_sel_hi:[1,0]
    v_pk_min_u16 v25, v25, v37
    v_mov_b32 v36, 0x397f397f
    v_pk_sub_u16 v36, v36, v25 clamp
    v_cmp_ne_u32 vcc, 0, v36
    s_or_b32 s62, 46, 0
    s_getpc_b64 s[92:93]
    s_cbranch_vccnz REC_V
    v_and_b32 v26, 0x7fff7fff, v64
    v_pk_sub_u16 v26, v26, s94 clamp
    v_bfi_b32 v64, s79, v26, v64
    v_and_b32 v27, 0x7fff7fff, v65
    v_pk_sub_u16 v27, v27, s94 clamp
    v_bfi_b32 v65, s79, v27, v65
    v_and_b32 v26, 0x7fff7fff, v66
    v_pk_sub_u16 v26, v26, s94 clamp
    v_bfi_b32 v66, s79, v26, v66
    v_and_b32 v27, 0x7fff7fff, v67
    v_pk_sub_u16 v27, v27, s94 clamp
    v_bfi_b32 v67, s79, v27, v67
    v_and_b32 v26, 0x7fff7fff, v68
    v_pk_sub_u16 v26, v26, s94 clamp
    v_bfi_b32 v68, s79, v26, v68
    v_and_b32 v27, 0x7fff7fff, v69
    v_pk_sub_u16 v27, v27, s94 clamp
    v_bfi_b32 v69, s79, v27, v69
    v_and_b32 v26, 0x7fff7fff, v70
    v_pk_sub_u16 v26, v26, s94 clamp
    v_bfi_b32 v70, s79, v26, v70
    v_and_b32 v27, 0x7fff7fff, v71
    v_pk_sub_u16 v27, v27, s94 clamp
    v_bfi_b32 v71, s79, v27, v71
    v_and_b32 v26, 0x7fff7fff, v72
    v_pk_sub_u16 v26, v26, s94 clamp
    v_bfi_b32 v72, s79, v26, v72
    v_and_b32 v27, 0x7fff7fff, v73
    v_pk_sub_u16 v27, v27, s94 clamp
    v_bfi_b32 v73, s79, v27, v73
    v_and_b32 v26, 0x7fff7fff, v74
    v_pk_sub_u16 v26, v26, s94 clamp
    v_bfi_b32 v74, s79, v26, v74
    v_and_b32 v27, 0x7fff7fff, v75
    v_pk_sub_u16 v27, v27, s94 clamp
    v_bfi_b32 v75, s79, v27, v75
    v_and_b32 v26, 0x7fff7fff, v76
    v_pk_sub_u16 v26, v26, s94 clamp
    v_bfi_b32 v76, s79, v26, v76
    v_and_b32 v27, 0x7fff7fff, v77
    v_pk_sub_u16 v27, v27, s94 clamp
    v_bfi_b32 v77, s79, v27, v77
    v_and_b32 v26, 0x7fff7fff, v78
    v_pk_sub_u16 v26, v26, s94 clamp
    v_bfi_b32 v78, s79, v26, v78
    v_and_b32 v27, 0x7fff7fff, v79
    v_pk_sub_u16 v27, v27, s94 clamp
    v_bfi_b32 v79, s79, v27, v79
    v_or_b32 v24, v64, v65
    v_or3_b32 v24, v24, v66, v67
    v_or3_b32 v24, v24, v68, v69
    v_or3_b32 v24, v24, v70, v71
    v_or3_b32 v24, v24, v72, v73
    v_or3_b32 v24, v24, v74, v75
    v_or3_b32 v24, v24, v76, v77
    v_or3_b32 v24, v24, v78, v79
    v_lshlrev_b32 v36, 11, v76
    v_and_or_b32 v248, v36, s78, v64
    v_lshlrev_b32 v37, 11, v77
    v_and_or_b32 v249, v37, s78, v65
    v_lshlrev_b32 v36, 11, v78
    v_and_or_b32 v250, v36, s78, v66
    v_lshlrev_b32 v37, 11, v79
    v_and_or_b32 v251, v37, s78, v67
    v_lshlrev_b32 v36, 7, v76
    v_and_or_b32 v252, v36, s78, v68
    v_lshlrev_b32 v37, 7, v77
    v_and_or_b32 v253, v37, s78, v69
    v_lshlrev_b32 v36, 7, v78
    v_and_or_b32 v254, v36, s78, v70
    v_lshlrev_b32 v37, 7, v79
    v_and_or_b32 v255, v37, s78, v71
    v_lshlrev_b32 v36, 3, v76
    v_and_or_b32 v72, v36, s78, v72
    v_lshrrev_b32 v37, 1, v76
    v_and_or_b32 v72, v37, s78, v72
    v_accvgpr_write_b32 a32, v72
    v_lshlrev_b32 v36, 3, v77
    v_and_or_b32 v73, v36, s78, v73
    v_lshrrev_b32 v37, 1, v77
    v_and_or_b32 v73, v37, s78, v73
    v_accvgpr_write_b32 a33, v73
    v_lshlrev_b32 v36, 3, v78
    v_and_or_b32 v74, v36, s78, v74
    v_lshrrev_b32 v37, 1, v78
    v_and_or_b32 v74, v37, s78, v74
    v_accvgpr_write_b32 a34, v74
    v_lshlrev_b32 v36, 3, v79
    v_and_or_b32 v75, v36, s78, v75
    v_lshrrev_b32 v37, 1, v79
    v_and_or_b32 v75, v37, s78, v75
    v_accvgpr_write_b32 a35, v75
    v_and_b32 v25, 0x7fff7fff, v48
    v_pk_sub_u16 v25, v25, 1 op_sel_hi:[1,0]
    v_and_b32 v37, 0x7fff7fff, v49
    v_pk_sub_u16 v37, v37, 1 op_sel_hi:[1,0]
    v_pk_min_u16 v25, v25, v37
    v_and_b32 v36, 0x7fff7fff, v50
    v_pk_sub_u16 v36, v36, 1 op_sel_hi:[1,0]
    v_pk_min_u16 v25, v25, v36
    v_and_b32 v37, 0x7fff7fff, v51
    v_pk_sub_u16 v37, v37, 1 op_sel_hi:[1,0]
    v_pk_min_u16 v25, v25, v37
    v_and_b32 v36, 0x7fff7fff, v52
    v_pk_sub_u16 v36, v36, 1 op_sel_hi:[1,0]
    v_pk_min_u16 v25, v25, v36
    v_and_b32 v37, 0x7fff7fff, v53
    v_pk_sub_u16 v37, v37, 1 op_sel_hi:[1,0]
    v_pk_min_u16 v25, v25, v37
    v_and_b32 v36, 0x7fff7fff, v54
    v_pk_sub_u16 v36, v36, 1 op_sel_hi:[1,0]
    v_pk_min_u16 v25, v25, v36
    v_and_b32 v37, 0x7fff7fff, v55
    v_pk_sub_u16 v37, v37, 1 op_sel_hi:[1,0]
    v_pk_min_u16 v25, v25, v37
    v_and_b32 v36, 0x7fff7fff, v56
    v_pk_sub_u16 v36, v36, 1 op_sel_hi:[1,0]
    v_pk_min_u16 v25, v25, v36
    v_and_b32 v37, 0x7fff7fff, v57
    v_pk_sub_u16 v37, v37, 1 op_sel_hi:[1,0]
    v_pk_min_u16 v25, v25, v37
    v_and_b32 v36, 0x7fff7fff, v58
    v_pk_sub_u16 v36, v36, 1 op_sel_hi:[1,0]
    v_pk_min_u16 v25, v25, v36
    v_and_b32 v37, 0x7fff7fff, v59
    v_pk_sub_u16 v37, v37, 1 op_sel_hi:[1,0]
    v_pk_min_u16 v25, v25, v37
    v_and_b32 v36, 0x7fff7fff, v60
    v_pk_sub_u16 v36, v36, 1 op_sel_hi:[1,0]
    v_pk_min_u16 v25, v25, v36
    v_and_b32 v37, 0x7fff7fff, v61
    v_pk_sub_u16 v37, v37, 1 op_sel_hi:[1,0]
    v_pk_min_u16 v25, v25, v37
    v_and_b32 v36, 0x7fff7fff, v62
    v_pk_sub_u16 v36, v36, 1 op_sel_hi:[1,0]
    v_pk_min_u16 v25, v25, v36
    v_and_b32 v37, 0x7fff7fff, v63
    v_pk_sub_u16 v37, v37, 1 op_sel_hi:[1,0]
    v_pk_min_u16 v25, v25, v37
    v_mov_b32 v36, 0x38ff38ff
    v_pk_sub_u16 v36, v36, v25 clamp
    v_cmp_ne_u32 vcc, 0, v36
    s_or_b32 s62, 14, 0
    s_getpc_b64 s[92:93]
    s_cbranch_vccnz REC_K
    v_and_b32 v26, 0x7fff7fff, v48
    v_pk_sub_u16 v26, v26, s98 clamp
    v_bfi_b32 v48, s79, v26, v48
    v_and_b32 v27, 0x7fff7fff, v49
    v_pk_sub_u16 v27, v27, s98 clamp
    v_bfi_b32 v49, s79, v27, v49
    v_and_b32 v26, 0x7fff7fff, v50
    v_pk_sub_u16 v26, v26, s98 clamp
    v_bfi_b32 v50, s79, v26, v50
    v_and_b32 v27, 0x7fff7fff, v51
    v_pk_sub_u16 v27, v27, s98 clamp
    v_bfi_b32 v51, s79, v27, v51
    v_and_b32 v26, 0x7fff7fff, v52
    v_pk_sub_u16 v26, v26, s98 clamp
    v_bfi_b32 v52, s79, v26, v52
    v_and_b32 v27, 0x7fff7fff, v53
    v_pk_sub_u16 v27, v27, s98 clamp
    v_bfi_b32 v53, s79, v27, v53
    v_and_b32 v26, 0x7fff7fff, v54
    v_pk_sub_u16 v26, v26, s98 clamp
    v_bfi_b32 v54, s79, v26, v54
    v_and_b32 v27, 0x7fff7fff, v55
    v_pk_sub_u16 v27, v27, s98 clamp
    v_bfi_b32 v55, s79, v27, v55
    v_and_b32 v26, 0x7fff7fff, v56
    v_pk_sub_u16 v26, v26, s98 clamp
    v_bfi_b32 v56, s79, v26, v56
    v_and_b32 v27, 0x7fff7fff, v57
    v_pk_sub_u16 v27, v27, s98 clamp
    v_bfi_b32 v57, s79, v27, v57
    v_and_b32 v26, 0x7fff7fff, v58
    v_pk_sub_u16 v26, v26, s98 clamp
    v_bfi_b32 v58, s79, v26, v58
    v_and_b32 v27, 0x7fff7fff, v59
    v_pk_sub_u16 v27, v27, s98 clamp
    v_bfi_b32 v59, s79, v27, v59
    v_and_b32 v26, 0x7fff7fff, v60
    v_pk_sub_u16 v26, v26, s98 clamp
    v_bfi_b32 v60, s79, v26, v60
    v_and_b32 v27, 0x7fff7fff, v61
    v_pk_sub_u16 v27, v27, s98 clamp
    v_bfi_b32 v61, s79, v27, v61
    v_and_b32 v26, 0x7fff7fff, v62
    v_pk_sub_u16 v26, v26, s98 clamp
    v_bfi_b32 v62, s79, v26, v62
    v_and_b32 v27, 0x7fff7fff, v63
    v_pk_sub_u16 v27, v27, s98 clamp
    v_bfi_b32 v63, s79, v27, v63
    v_or3_b32 v24, v24, v48, v49
    v_or3_b32 v24, v24, v50, v51
    v_or3_b32 v24, v24, v52, v53
    v_or3_b32 v24, v24, v54, v55
    v_or3_b32 v24, v24, v56, v57
    v_or3_b32 v24, v24, v58, v59
    v_or3_b32 v24, v24, v60, v61
    v_or3_b32 v24, v24, v62, v63
    v_lshlrev_b32 v36, 11, v60
    v_and_or_b32 v48, v36, s78, v48
    v_lshlrev_b32 v37, 11, v61
    v_and_or_b32 v49, v37, s78, v49
    v_lshlrev_b32 v36, 11, v62
    v_and_or_b32 v50, v36, s78, v50
    v_lshlrev_b32 v37, 11, v63
    v_and_or_b32 v51, v37, s78, v51
    v_lshlrev_b32 v36, 7, v60
    v_and_or_b32 v52, v36, s78, v52
    v_lshlrev_b32 v37, 7, v61
    v_and_or_b32 v53, v37, s78, v53
    v_lshlrev_b32 v36, 7, v62
    v_and_or_b32 v54, v36, s78, v54
    v_lshlrev_b32 v37, 7, v63
    v_and_or_b32 v55, v37, s78, v55
    v_lshlrev_b32 v36, 3, v60
    v_and_or_b32 v56, v36, s78, v56
    v_lshrrev_b32 v37, 1, v60
    v_and_or_b32 v56, v37, s78, v56
    v_lshlrev_b32 v36, 3, v61
    v_and_or_b32 v57, v36, s78, v57
    v_lshrrev_b32 v37, 1, v61
    v_and_or_b32 v57, v37, s78, v57
    v_lshlrev_b32 v36, 3, v62
    v_and_or_b32 v58, v36, s78, v58
    v_lshrrev_b32 v37, 1, v62
    v_and_or_b32 v58, v37, s78, v58
    v_lshlrev_b32 v36, 3, v63
    v_and_or_b32 v59, v36, s78, v59
    v_lshrrev_b32 v37, 1, v63
    v_and_or_b32 v59, v37, s78, v59
    v_lshlrev_b32 v36, 4, v0
    v_add_u32 v36, s59, v36
    ds_write_b128 v36, v[48:51] offset:20992
    ds_write_b128 v36, v[52:55] offset:22016
    ds_write_b128 v36, v[56:59] offset:23040
    v_and_b32 v24, s78, v24
    v_cmp_ne_u32 vcc, 0, v24
    s_cmp_lg_u64 vcc, 0
    s_cselect_b32 s60, 16384, 0
    s_or_b32 s99, s99, s60
    s_waitcnt vmcnt(40)
    ds_read_b128 v[48:51], v9 offset:32768
    ds_read_b128 v[52:55], v10 offset:32768
    ds_read_b128 v[56:59], v11 offset:32768
    ds_read_b128 v[60:63], v12 offset:32768
    s_waitcnt vmcnt(36)
    v_accvgpr_read_b32 v64, a232
    v_accvgpr_read_b32 v65, a233
    v_accvgpr_read_b32 v66, a234
    v_accvgpr_read_b32 v67, a235
    v_accvgpr_read_b32 v68, a236
    v_accvgpr_read_b32 v69, a237
    v_accvgpr_read_b32 v70, a238
    v_accvgpr_read_b32 v71, a239
    v_accvgpr_read_b32 v72, a240
    v_accvgpr_read_b32 v73, a241
    v_accvgpr_read_b32 v74, a242
    v_accvgpr_read_b32 v75, a243
    v_accvgpr_read_b32 v76, a244
    v_accvgpr_read_b32 v77, a245
    v_accvgpr_read_b32 v78, a246
    v_accvgpr_read_b32 v79, a247
    s_waitcnt lgkmcnt(0)
    v_lshrrev_b32 v1, 4, v0
    v_mul_u32_u24 v1, 9216, v1
    v_and_b32 v2, 15, v0
    v_lshl_add_u32 v1, v2, 4, v1
    s_mul_i32 s60, s63, 36864
    s_lshl_b32 s61, s3, 8
    s_add_u32 s61, s61, s60
    s_add_u32 s62, s61, 0
    s_add_u32 m0, s59, 28672
    s_nop 0
    buffer_load_dwordx4 v1, s[28:31], s62 offen nt lds
    s_add_u32 s62, s61, 1152
    s_add_u32 m0, s59, 29696
    s_nop 0
    buffer_load_dwordx4 v1, s[28:31], s62 offen nt lds
    s_add_u32 s62, s61, 2304
    s_add_u32 m0, s59, 30720
    s_nop 0
    buffer_load_dwordx4 v1, s[28:31], s62 offen nt lds
    s_add_u32 s62, s61, 3456
    s_add_u32 m0, s59, 31744
    s_nop 0
    buffer_load_dwordx4 v1, s[28:31], s62 offen nt lds
    s_add_u32 s62, s61, 4608
    s_add_u32 m0, s59, 32768
    s_nop 0
    buffer_load_dwordx4 v1, s[28:31], s62 offen nt lds
    s_add_u32 s62, s61, 5760
    s_add_u32 m0, s59, 33792
    s_nop 0
    buffer_load_dwordx4 v1, s[28:31], s62 offen nt lds
    s_add_u32 s62, s61, 6912
    s_add_u32 m0, s59, 34816
    s_nop 0
    buffer_load_dwordx4 v1, s[28:31], s62 offen nt lds
    s_add_u32 s62, s61, 8064
    s_add_u32 m0, s59, 35840
    s_nop 0
    buffer_load_dwordx4 v1, s[28:31], s62 offen nt lds
    v_lshrrev_b32 v1, 4, v0
    v_lshlrev_b32 v1, 3, v1
    v_bfe_u32 v2, v0, 3, 1
    v_add_u32 v1, v1, v2
    v_mul_u32_u24 v1, 1152, v1
    v_and_b32 v2, 7, v0
    v_lshl_add_u32 v1, v2, 4, v1
    s_cmp_eq_u32 s3, 3
    s_cbranch_scc0 WD5_19
    s_add_u32 s62, s60, 1024
    buffer_load_dwordx4 a[232:235], v1, s[28:31], s62 offen nt
    s_add_u32 s62, s60, 3328
    buffer_load_dwordx4 a[236:239], v1, s[28:31], s62 offen nt
    s_add_u32 s62, s60, 5632
    buffer_load_dwordx4 a[240:243], v1, s[28:31], s62 offen nt
    s_add_u32 s62, s60, 7936
    buffer_load_dwordx4 a[244:247], v1, s[28:31], s62 offen nt
WD5_19:
    buffer_load_dword v29, v28, s[36:39], 0 offen sc1
    v_and_b32 v25, 0x7fff7fff, v64
    v_pk_sub_u16 v25, v25, 1 op_sel_hi:[1,0]
    v_and_b32 v37, 0x7fff7fff, v65
    v_pk_sub_u16 v37, v37, 1 op_sel_hi:[1,0]
    v_pk_min_u16 v25, v25, v37
    v_and_b32 v36, 0x7fff7fff, v66
    v_pk_sub_u16 v36, v36, 1 op_sel_hi:[1,0]
    v_pk_min_u16 v25, v25, v36
    v_and_b32 v37, 0x7fff7fff, v67
    v_pk_sub_u16 v37, v37, 1 op_sel_hi:[1,0]
    v_pk_min_u16 v25, v25, v37
    v_and_b32 v36, 0x7fff7fff, v68
    v_pk_sub_u16 v36, v36, 1 op_sel_hi:[1,0]
    v_pk_min_u16 v25, v25, v36
    v_and_b32 v37, 0x7fff7fff, v69
    v_pk_sub_u16 v37, v37, 1 op_sel_hi:[1,0]
    v_pk_min_u16 v25, v25, v37
    v_and_b32 v36, 0x7fff7fff, v70
    v_pk_sub_u16 v36, v36, 1 op_sel_hi:[1,0]
    v_pk_min_u16 v25, v25, v36
    v_and_b32 v37, 0x7fff7fff, v71
    v_pk_sub_u16 v37, v37, 1 op_sel_hi:[1,0]
    v_pk_min_u16 v25, v25, v37
    v_and_b32 v36, 0x7fff7fff, v72
    v_pk_sub_u16 v36, v36, 1 op_sel_hi:[1,0]
    v_pk_min_u16 v25, v25, v36
    v_and_b32 v37, 0x7fff7fff, v73
    v_pk_sub_u16 v37, v37, 1 op_sel_hi:[1,0]
    v_pk_min_u16 v25, v25, v37
    v_and_b32 v36, 0x7fff7fff, v74
    v_pk_sub_u16 v36, v36, 1 op_sel_hi:[1,0]
    v_pk_min_u16 v25, v25, v36
    v_and_b32 v37, 0x7fff7fff, v75
    v_pk_sub_u16 v37, v37, 1 op_sel_hi:[1,0]
    v_pk_min_u16 v25, v25, v37
    v_and_b32 v36, 0x7fff7fff, v76
    v_pk_sub_u16 v36, v36, 1 op_sel_hi:[1,0]
    v_pk_min_u16 v25, v25, v36
    v_and_b32 v37, 0x7fff7fff, v77
    v_pk_sub_u16 v37, v37, 1 op_sel_hi:[1,0]
    v_pk_min_u16 v25, v25, v37
    v_and_b32 v36, 0x7fff7fff, v78
    v_pk_sub_u16 v36, v36, 1 op_sel_hi:[1,0]
    v_pk_min_u16 v25, v25, v36
    v_and_b32 v37, 0x7fff7fff, v79
    v_pk_sub_u16 v37, v37, 1 op_sel_hi:[1,0]
    v_pk_min_u16 v25, v25, v37
    v_mov_b32 v36, 0x397f397f
    v_pk_sub_u16 v36, v36, v25 clamp
    v_cmp_ne_u32 vcc, 0, v36
    s_or_b32 s62, 47, 0
    s_getpc_b64 s[92:93]
    s_cbranch_vccnz REC_V
    v_and_b32 v26, 0x7fff7fff, v64
    v_pk_sub_u16 v26, v26, s94 clamp
    v_bfi_b32 v64, s79, v26, v64
    v_and_b32 v27, 0x7fff7fff, v65
    v_pk_sub_u16 v27, v27, s94 clamp
    v_bfi_b32 v65, s79, v27, v65
    v_and_b32 v26, 0x7fff7fff, v66
    v_pk_sub_u16 v26, v26, s94 clamp
    v_bfi_b32 v66, s79, v26, v66
    v_and_b32 v27, 0x7fff7fff, v67
    v_pk_sub_u16 v27, v27, s94 clamp
    v_bfi_b32 v67, s79, v27, v67
    v_and_b32 v26, 0x7fff7fff, v68
    v_pk_sub_u16 v26, v26, s94 clamp
    v_bfi_b32 v68, s79, v26, v68
    v_and_b32 v27, 0x7fff7fff, v69
    v_pk_sub_u16 v27, v27, s94 clamp
    v_bfi_b32 v69, s79, v27, v69
    v_and_b32 v26, 0x7fff7fff, v70
    v_pk_sub_u16 v26, v26, s94 clamp
    v_bfi_b32 v70, s79, v26, v70
    v_and_b32 v27, 0x7fff7fff, v71
    v_pk_sub_u16 v27, v27, s94 clamp
    v_bfi_b32 v71, s79, v27, v71
    v_and_b32 v26, 0x7fff7fff, v72
    v_pk_sub_u16 v26, v26, s94 clamp
    v_bfi_b32 v72, s79, v26, v72
    v_and_b32 v27, 0x7fff7fff, v73
    v_pk_sub_u16 v27, v27, s94 clamp
    v_bfi_b32 v73, s79, v27, v73
    v_and_b32 v26, 0x7fff7fff, v74
    v_pk_sub_u16 v26, v26, s94 clamp
    v_bfi_b32 v74, s79, v26, v74
    v_and_b32 v27, 0x7fff7fff, v75
    v_pk_sub_u16 v27, v27, s94 clamp
    v_bfi_b32 v75, s79, v27, v75
    v_and_b32 v26, 0x7fff7fff, v76
    v_pk_sub_u16 v26, v26, s94 clamp
    v_bfi_b32 v76, s79, v26, v76
    v_and_b32 v27, 0x7fff7fff, v77
    v_pk_sub_u16 v27, v27, s94 clamp
    v_bfi_b32 v77, s79, v27, v77
    v_and_b32 v26, 0x7fff7fff, v78
    v_pk_sub_u16 v26, v26, s94 clamp
    v_bfi_b32 v78, s79, v26, v78
    v_and_b32 v27, 0x7fff7fff, v79
    v_pk_sub_u16 v27, v27, s94 clamp
    v_bfi_b32 v79, s79, v27, v79
    v_or_b32 v24, v64, v65
    v_or3_b32 v24, v24, v66, v67
    v_or3_b32 v24, v24, v68, v69
    v_or3_b32 v24, v24, v70, v71
    v_or3_b32 v24, v24, v72, v73
    v_or3_b32 v24, v24, v74, v75
    v_or3_b32 v24, v24, v76, v77
    v_or3_b32 v24, v24, v78, v79
    v_lshlrev_b32 v36, 11, v76
    v_and_or_b32 v64, v36, s78, v64
    v_accvgpr_write_b32 a36, v64
    v_lshlrev_b32 v37, 11, v77
    v_and_or_b32 v65, v37, s78, v65
    v_accvgpr_write_b32 a37, v65
    v_lshlrev_b32 v36, 11, v78
    v_and_or_b32 v66, v36, s78, v66
    v_accvgpr_write_b32 a38, v66
    v_lshlrev_b32 v37, 11, v79
    v_and_or_b32 v67, v37, s78, v67
    v_accvgpr_write_b32 a39, v67
    v_lshlrev_b32 v36, 7, v76
    v_and_or_b32 v68, v36, s78, v68
    v_accvgpr_write_b32 a40, v68
    v_lshlrev_b32 v37, 7, v77
    v_and_or_b32 v69, v37, s78, v69
    v_accvgpr_write_b32 a41, v69
    v_lshlrev_b32 v36, 7, v78
    v_and_or_b32 v70, v36, s78, v70
    v_accvgpr_write_b32 a42, v70
    v_lshlrev_b32 v37, 7, v79
    v_and_or_b32 v71, v37, s78, v71
    v_accvgpr_write_b32 a43, v71
    v_lshlrev_b32 v36, 3, v76
    v_and_or_b32 v72, v36, s78, v72
    v_lshrrev_b32 v37, 1, v76
    v_and_or_b32 v72, v37, s78, v72
    v_accvgpr_write_b32 a44, v72
    v_lshlrev_b32 v36, 3, v77
    v_and_or_b32 v73, v36, s78, v73
    v_lshrrev_b32 v37, 1, v77
    v_and_or_b32 v73, v37, s78, v73
    v_accvgpr_write_b32 a45, v73
    v_lshlrev_b32 v36, 3, v78
    v_and_or_b32 v74, v36, s78, v74
    v_lshrrev_b32 v37, 1, v78
    v_and_or_b32 v74, v37, s78, v74
    v_accvgpr_write_b32 a46, v74
    v_lshlrev_b32 v36, 3, v79
    v_and_or_b32 v75, v36, s78, v75
    v_lshrrev_b32 v37, 1, v79
    v_and_or_b32 v75, v37, s78, v75
    v_accvgpr_write_b32 a47, v75
    v_and_b32 v25, 0x7fff7fff, v48
    v_pk_sub_u16 v25, v25, 1 op_sel_hi:[1,0]
    v_and_b32 v37, 0x7fff7fff, v49
    v_pk_sub_u16 v37, v37, 1 op_sel_hi:[1,0]
    v_pk_min_u16 v25, v25, v37
    v_and_b32 v36, 0x7fff7fff, v50
    v_pk_sub_u16 v36, v36, 1 op_sel_hi:[1,0]
    v_pk_min_u16 v25, v25, v36
    v_and_b32 v37, 0x7fff7fff, v51
    v_pk_sub_u16 v37, v37, 1 op_sel_hi:[1,0]
    v_pk_min_u16 v25, v25, v37
    v_and_b32 v36, 0x7fff7fff, v52
    v_pk_sub_u16 v36, v36, 1 op_sel_hi:[1,0]
    v_pk_min_u16 v25, v25, v36
    v_and_b32 v37, 0x7fff7fff, v53
    v_pk_sub_u16 v37, v37, 1 op_sel_hi:[1,0]
    v_pk_min_u16 v25, v25, v37
    v_and_b32 v36, 0x7fff7fff, v54
    v_pk_sub_u16 v36, v36, 1 op_sel_hi:[1,0]
    v_pk_min_u16 v25, v25, v36
    v_and_b32 v37, 0x7fff7fff, v55
    v_pk_sub_u16 v37, v37, 1 op_sel_hi:[1,0]
    v_pk_min_u16 v25, v25, v37
    v_and_b32 v36, 0x7fff7fff, v56
    v_pk_sub_u16 v36, v36, 1 op_sel_hi:[1,0]
    v_pk_min_u16 v25, v25, v36
    v_and_b32 v37, 0x7fff7fff, v57
    v_pk_sub_u16 v37, v37, 1 op_sel_hi:[1,0]
    v_pk_min_u16 v25, v25, v37
    v_and_b32 v36, 0x7fff7fff, v58
    v_pk_sub_u16 v36, v36, 1 op_sel_hi:[1,0]
    v_pk_min_u16 v25, v25, v36
    v_and_b32 v37, 0x7fff7fff, v59
    v_pk_sub_u16 v37, v37, 1 op_sel_hi:[1,0]
    v_pk_min_u16 v25, v25, v37
    v_and_b32 v36, 0x7fff7fff, v60
    v_pk_sub_u16 v36, v36, 1 op_sel_hi:[1,0]
    v_pk_min_u16 v25, v25, v36
    v_and_b32 v37, 0x7fff7fff, v61
    v_pk_sub_u16 v37, v37, 1 op_sel_hi:[1,0]
    v_pk_min_u16 v25, v25, v37
    v_and_b32 v36, 0x7fff7fff, v62
    v_pk_sub_u16 v36, v36, 1 op_sel_hi:[1,0]
    v_pk_min_u16 v25, v25, v36
    v_and_b32 v37, 0x7fff7fff, v63
    v_pk_sub_u16 v37, v37, 1 op_sel_hi:[1,0]
    v_pk_min_u16 v25, v25, v37
    v_mov_b32 v36, 0x38ff38ff
    v_pk_sub_u16 v36, v36, v25 clamp
    v_cmp_ne_u32 vcc, 0, v36
    s_or_b32 s62, 15, 0
    s_getpc_b64 s[92:93]
    s_cbranch_vccnz REC_K
    v_and_b32 v26, 0x7fff7fff, v48
    v_pk_sub_u16 v26, v26, s98 clamp
    v_bfi_b32 v48, s79, v26, v48
    v_and_b32 v27, 0x7fff7fff, v49
    v_pk_sub_u16 v27, v27, s98 clamp
    v_bfi_b32 v49, s79, v27, v49
    v_and_b32 v26, 0x7fff7fff, v50
    v_pk_sub_u16 v26, v26, s98 clamp
    v_bfi_b32 v50, s79, v26, v50
    v_and_b32 v27, 0x7fff7fff, v51
    v_pk_sub_u16 v27, v27, s98 clamp
    v_bfi_b32 v51, s79, v27, v51
    v_and_b32 v26, 0x7fff7fff, v52
    v_pk_sub_u16 v26, v26, s98 clamp
    v_bfi_b32 v52, s79, v26, v52
    v_and_b32 v27, 0x7fff7fff, v53
    v_pk_sub_u16 v27, v27, s98 clamp
    v_bfi_b32 v53, s79, v27, v53
    v_and_b32 v26, 0x7fff7fff, v54
    v_pk_sub_u16 v26, v26, s98 clamp
    v_bfi_b32 v54, s79, v26, v54
    v_and_b32 v27, 0x7fff7fff, v55
    v_pk_sub_u16 v27, v27, s98 clamp
    v_bfi_b32 v55, s79, v27, v55
    v_and_b32 v26, 0x7fff7fff, v56
    v_pk_sub_u16 v26, v26, s98 clamp
    v_bfi_b32 v56, s79, v26, v56
    v_and_b32 v27, 0x7fff7fff, v57
    v_pk_sub_u16 v27, v27, s98 clamp
    v_bfi_b32 v57, s79, v27, v57
    v_and_b32 v26, 0x7fff7fff, v58
    v_pk_sub_u16 v26, v26, s98 clamp
    v_bfi_b32 v58, s79, v26, v58
    v_and_b32 v27, 0x7fff7fff, v59
    v_pk_sub_u16 v27, v27, s98 clamp
    v_bfi_b32 v59, s79, v27, v59
    v_and_b32 v26, 0x7fff7fff, v60
    v_pk_sub_u16 v26, v26, s98 clamp
    v_bfi_b32 v60, s79, v26, v60
    v_and_b32 v27, 0x7fff7fff, v61
    v_pk_sub_u16 v27, v27, s98 clamp
    v_bfi_b32 v61, s79, v27, v61
    v_and_b32 v26, 0x7fff7fff, v62
    v_pk_sub_u16 v26, v26, s98 clamp
    v_bfi_b32 v62, s79, v26, v62
    v_and_b32 v27, 0x7fff7fff, v63
    v_pk_sub_u16 v27, v27, s98 clamp
    v_bfi_b32 v63, s79, v27, v63
    v_or3_b32 v24, v24, v48, v49
    v_or3_b32 v24, v24, v50, v51
    v_or3_b32 v24, v24, v52, v53
    v_or3_b32 v24, v24, v54, v55
    v_or3_b32 v24, v24, v56, v57
    v_or3_b32 v24, v24, v58, v59
    v_or3_b32 v24, v24, v60, v61
    v_or3_b32 v24, v24, v62, v63
    v_lshlrev_b32 v36, 11, v60
    v_and_or_b32 v48, v36, s78, v48
    v_lshlrev_b32 v37, 11, v61
    v_and_or_b32 v49, v37, s78, v49
    v_lshlrev_b32 v36, 11, v62
    v_and_or_b32 v50, v36, s78, v50
    v_lshlrev_b32 v37, 11, v63
    v_and_or_b32 v51, v37, s78, v51
    v_lshlrev_b32 v36, 7, v60
    v_and_or_b32 v52, v36, s78, v52
    v_lshlrev_b32 v37, 7, v61
    v_and_or_b32 v53, v37, s78, v53
    v_lshlrev_b32 v36, 7, v62
    v_and_or_b32 v54, v36, s78, v54
    v_lshlrev_b32 v37, 7, v63
    v_and_or_b32 v55, v37, s78, v55
    v_lshlrev_b32 v36, 3, v60
    v_and_or_b32 v56, v36, s78, v56
    v_lshrrev_b32 v37, 1, v60
    v_and_or_b32 v56, v37, s78, v56
    v_lshlrev_b32 v36, 3, v61
    v_and_or_b32 v57, v36, s78, v57
    v_lshrrev_b32 v37, 1, v61
    v_and_or_b32 v57, v37, s78, v57
    v_lshlrev_b32 v36, 3, v62
    v_and_or_b32 v58, v36, s78, v58
    v_lshrrev_b32 v37, 1, v62
    v_and_or_b32 v58, v37, s78, v58
    v_lshlrev_b32 v36, 3, v63
    v_and_or_b32 v59, v36, s78, v59
    v_lshrrev_b32 v37, 1, v63
    v_and_or_b32 v59, v37, s78, v59
    v_lshlrev_b32 v36, 4, v0
    v_add_u32 v36, s59, v36
    ds_write_b128 v36, v[48:51] offset:24064
    ds_write_b128 v36, v[52:55] offset:25088
    ds_write_b128 v36, v[56:59] offset:26112
    v_and_b32 v24, s78, v24
    v_cmp_ne_u32 vcc, 0, v24
    s_cmp_lg_u64 vcc, 0
    s_cselect_b32 s60, 32768, 0
    s_or_b32 s99, s99, s60
    s_waitcnt vmcnt(27)
    s_add_u32 s76, s90, 0
    s_mul_i32 s54, s76, s85
    s_add_u32 s54, s54, s53
    s_add_u32 m0, s59, 0
    s_nop 0
    buffer_load_dwordx4 v4, s[4:7], s54 offen offset:0 nt lds
    buffer_load_dwordx4 v5, s[4:7], s54 offen offset:1024 nt lds
    buffer_load_dwordx4 v6, s[4:7], s54 offen offset:2048 nt lds
    buffer_load_dwordx4 v7, s[4:7], s54 offen offset:3072 nt lds
    buffer_load_dwordx4 a[0:3], v8, s[8:11], s54 offen offset:0 nt
    buffer_load_dwordx4 a[4:7], v8, s[8:11], s54 offen offset:256 nt
    buffer_load_dwordx4 a[8:11], v8, s[8:11], s54 offen offset:512 nt
    buffer_load_dwordx4 a[12:15], v8, s[8:11], s54 offen offset:768 nt
    s_waitcnt vmcnt(8)
    s_mov_b32 s64, 200000
QF_20:
    v_cmp_ne_u32 vcc, 4, v29
    s_cbranch_vccz QD_21
    buffer_load_dword v29, v28, s[36:39], 0 offen sc1
    s_waitcnt vmcnt(0)
    s_sub_u32 s64, s64, 1
    s_cmp_lg_u32 s64, 0
    s_cbranch_scc1 QF_20
QD_21:
    v_bfe_u32 v38, v0, 3, 1
    v_lshlrev_b32 v38, 8, v38
    v_lshrrev_b32 v39, 4, v0
    v_lshl_add_u32 v38, v39, 4, v38
    s_lshl_b32 s60, s57, 9
    s_add_u32 s60, s60, 3145728
    buffer_load_dwordx4 v[64:67], v38, s[32:35], s60 offen offset:0 sc1
    buffer_load_dwordx4 v[68:71], v38, s[32:35], s60 offen offset:64 sc1
    buffer_load_dwordx4 v[72:75], v38, s[32:35], s60 offen offset:128 sc1
    buffer_load_dwordx4 v[76:79], v38, s[32:35], s60 offen offset:192 sc1
    s_add_u32 s77, s90, 16
    s_mul_i32 s54, s77, s85
    s_add_u32 s54, s54, s53
    s_add_u32 m0, s59, 4096
    s_nop 0
    buffer_load_dwordx4 v4, s[4:7], s54 offen offset:0 nt lds
    buffer_load_dwordx4 v5, s[4:7], s54 offen offset:1024 nt lds
    buffer_load_dwordx4 v6, s[4:7], s54 offen offset:2048 nt lds
    buffer_load_dwordx4 v7, s[4:7], s54 offen offset:3072 nt lds
    buffer_load_dwordx4 a[16:19], v8, s[8:11], s54 offen offset:0 nt
    buffer_load_dwordx4 a[20:23], v8, s[8:11], s54 offen offset:256 nt
    buffer_load_dwordx4 a[24:27], v8, s[8:11], s54 offen offset:512 nt
    buffer_load_dwordx4 a[28:31], v8, s[8:11], s54 offen offset:768 nt
    s_waitcnt vmcnt(8)
    s_nop 7
    s_nop 1
    s_branch RJ_13
RP_16:
    s_nop 7
    s_nop 1
    s_waitcnt vmcnt(20)
    ds_read_b128 v[48:51], v9 offset:0
    ds_read_b128 v[52:55], v10 offset:0
    ds_read_b128 v[56:59], v11 offset:0
    ds_read_b128 v[60:63], v12 offset:0
    s_waitcnt vmcnt(16)
    v_accvgpr_read_b32 v64, a0
    v_accvgpr_read_b32 v65, a1
    v_accvgpr_read_b32 v66, a2
    v_accvgpr_read_b32 v67, a3
    v_accvgpr_read_b32 v68, a4
    v_accvgpr_read_b32 v69, a5
    v_accvgpr_read_b32 v70, a6
    v_accvgpr_read_b32 v71, a7
    v_accvgpr_read_b32 v72, a8
    v_accvgpr_read_b32 v73, a9
    v_accvgpr_read_b32 v74, a10
    v_accvgpr_read_b32 v75, a11
    v_accvgpr_read_b32 v76, a12
    v_accvgpr_read_b32 v77, a13
    v_accvgpr_read_b32 v78, a14
    v_accvgpr_read_b32 v79, a15
    s_waitcnt lgkmcnt(0)
    s_add_u32 s76, s90, 0
    s_mul_i32 s54, s76, s85
    s_add_u32 s54, s54, s53
    s_add_u32 m0, s59, 0
    s_nop 0
    buffer_load_dwordx4 v4, s[4:7], s54 offen offset:0 nt lds
    buffer_load_dwordx4 v5, s[4:7], s54 offen offset:1024 nt lds
    buffer_load_dwordx4 v6, s[4:7], s54 offen offset:2048 nt lds
    buffer_load_dwordx4 v7, s[4:7], s54 offen offset:3072 nt lds
    buffer_load_dwordx4 a[0:3], v8, s[8:11], s54 offen offset:0 nt
    buffer_load_dwordx4 a[4:7], v8, s[8:11], s54 offen offset:256 nt
    buffer_load_dwordx4 a[8:11], v8, s[8:11], s54 offen offset:512 nt
    buffer_load_dwordx4 a[12:15], v8, s[8:11], s54 offen offset:768 nt
    v_and_b32 v25, 0x7fff7fff, v64
    v_pk_sub_u16 v25, v25, 1 op_sel_hi:[1,0]
    v_and_b32 v37, 0x7fff7fff, v65
    v_pk_sub_u16 v37, v37, 1 op_sel_hi:[1,0]
    v_pk_min_u16 v25, v25, v37
    v_and_b32 v36, 0x7fff7fff, v66
    v_pk_sub_u16 v36, v36, 1 op_sel_hi:[1,0]
    v_pk_min_u16 v25, v25, v36
    v_and_b32 v37, 0x7fff7fff, v67
    v_pk_sub_u16 v37, v37, 1 op_sel_hi:[1,0]
    v_pk_min_u16 v25, v25, v37
    v_and_b32 v36, 0x7fff7fff, v68
    v_pk_sub_u16 v36, v36, 1 op_sel_hi:[1,0]
    v_pk_min_u16 v25, v25, v36
    v_and_b32 v37, 0x7fff7fff, v69
    v_pk_sub_u16 v37, v37, 1 op_sel_hi:[1,0]
    v_pk_min_u16 v25, v25, v37
    v_and_b32 v36, 0x7fff7fff, v70
    v_pk_sub_u16 v36, v36, 1 op_sel_hi:[1,0]
    v_pk_min_u16 v25, v25, v36
    v_and_b32 v37, 0x7fff7fff, v71
    v_pk_sub_u16 v37, v37, 1 op_sel_hi:[1,0]
    v_pk_min_u16 v25, v25, v37
    v_and_b32 v36, 0x7fff7fff, v72
    v_pk_sub_u16 v36, v36, 1 op_sel_hi:[1,0]
    v_pk_min_u16 v25, v25, v36
    v_and_b32 v37, 0x7fff7fff, v73
    v_pk_sub_u16 v37, v37, 1 op_sel_hi:[1,0]
    v_pk_min_u16 v25, v25, v37
    v_and_b32 v36, 0x7fff7fff, v74
    v_pk_sub_u16 v36, v36, 1 op_sel_hi:[1,0]
    v_pk_min_u16 v25, v25, v36
    v_and_b32 v37, 0x7fff7fff, v75
    v_pk_sub_u16 v37, v37, 1 op_sel_hi:[1,0]
    v_pk_min_u16 v25, v25, v37
    v_and_b32 v36, 0x7fff7fff, v76
    v_pk_sub_u16 v36, v36, 1 op_sel_hi:[1,0]
    v_pk_min_u16 v25, v25, v36
    v_and_b32 v37, 0x7fff7fff, v77
    v_pk_sub_u16 v37, v37, 1 op_sel_hi:[1,0]
    v_pk_min_u16 v25, v25, v37
    v_and_b32 v36, 0x7fff7fff, v78
    v_pk_sub_u16 v36, v36, 1 op_sel_hi:[1,0]
    v_pk_min_u16 v25, v25, v36
    v_and_b32 v37, 0x7fff7fff, v79
    v_pk_sub_u16 v37, v37, 1 op_sel_hi:[1,0]
    v_pk_min_u16 v25, v25, v37
    v_mov_b32 v36, 0x397f397f
    v_pk_sub_u16 v36, v36, v25 clamp
    v_cmp_ne_u32 vcc, 0, v36
    s_or_b32 s62, 45, 0
    s_getpc_b64 s[92:93]
    s_cbranch_vccnz REC_V
    v_and_b32 v26, 0x7fff7fff, v64
    v_pk_sub_u16 v26, v26, s94 clamp
    v_bfi_b32 v64, s79, v26, v64
    v_and_b32 v27, 0x7fff7fff, v65
    v_pk_sub_u16 v27, v27, s94 clamp
    v_bfi_b32 v65, s79, v27, v65
    v_and_b32 v26, 0x7fff7fff, v66
    v_pk_sub_u16 v26, v26, s94 clamp
    v_bfi_b32 v66, s79, v26, v66
    v_and_b32 v27, 0x7fff7fff, v67
    v_pk_sub_u16 v27, v27, s94 clamp
    v_bfi_b32 v67, s79, v27, v67
    v_and_b32 v26, 0x7fff7fff, v68
    v_pk_sub_u16 v26, v26, s94 clamp
    v_bfi_b32 v68, s79, v26, v68
    v_and_b32 v27, 0x7fff7fff, v69
    v_pk_sub_u16 v27, v27, s94 clamp
    v_bfi_b32 v69, s79, v27, v69
    v_and_b32 v26, 0x7fff7fff, v70
    v_pk_sub_u16 v26, v26, s94 clamp
    v_bfi_b32 v70, s79, v26, v70
    v_and_b32 v27, 0x7fff7fff, v71
    v_pk_sub_u16 v27, v27, s94 clamp
    v_bfi_b32 v71, s79, v27, v71
    v_and_b32 v26, 0x7fff7fff, v72
    v_pk_sub_u16 v26, v26, s94 clamp
    v_bfi_b32 v72, s79, v26, v72
    v_and_b32 v27, 0x7fff7fff, v73
    v_pk_sub_u16 v27, v27, s94 clamp
    v_bfi_b32 v73, s79, v27, v73
    v_and_b32 v26, 0x7fff7fff, v74
    v_pk_sub_u16 v26, v26, s94 clamp
    v_bfi_b32 v74, s79, v26, v74
    v_and_b32 v27, 0x7fff7fff, v75
    v_pk_sub_u16 v27, v27, s94 clamp
    v_bfi_b32 v75, s79, v27, v75
    v_and_b32 v26, 0x7fff7fff, v76
    v_pk_sub_u16 v26, v26, s94 clamp
    v_bfi_b32 v76, s79, v26, v76
    v_and_b32 v27, 0x7fff7fff, v77
    v_pk_sub_u16 v27, v27, s94 clamp
    v_bfi_b32 v77, s79, v27, v77
    v_and_b32 v26, 0x7fff7fff, v78
    v_pk_sub_u16 v26, v26, s94 clamp
    v_bfi_b32 v78, s79, v26, v78
    v_and_b32 v27, 0x7fff7fff, v79
    v_pk_sub_u16 v27, v27, s94 clamp
    v_bfi_b32 v79, s79, v27, v79
    v_or_b32 v24, v64, v65
    v_or3_b32 v24, v24, v66, v67
    v_or3_b32 v24, v24, v68, v69
    v_or3_b32 v24, v24, v70, v71
    v_or3_b32 v24, v24, v72, v73
    v_or3_b32 v24, v24, v74, v75
    v_or3_b32 v24, v24, v76, v77
    v_or3_b32 v24, v24, v78, v79
    v_lshlrev_b32 v36, 11, v76
    v_and_or_b32 v236, v36, s78, v64
    v_lshlrev_b32 v37, 11, v77
    v_and_or_b32 v237, v37, s78, v65
    v_lshlrev_b32 v36, 11, v78
    v_and_or_b32 v238, v36, s78, v66
    v_lshlrev_b32 v37, 11, v79
    v_and_or_b32 v239, v37, s78, v67
    v_lshlrev_b32 v36, 7, v76
    v_and_or_b32 v240, v36, s78, v68
    v_lshlrev_b32 v37, 7, v77
    v_and_or_b32 v241, v37, s78, v69
    v_lshlrev_b32 v36, 7, v78
    v_and_or_b32 v242, v36, s78, v70
    v_lshlrev_b32 v37, 7, v79
    v_and_or_b32 v243, v37, s78, v71
    v_lshlrev_b32 v36, 3, v76
    v_and_or_b32 v72, v36, s78, v72
    v_lshrrev_b32 v37, 1, v76
    v_and_or_b32 v244, v37, s78, v72
    v_lshlrev_b32 v36, 3, v77
    v_and_or_b32 v73, v36, s78, v73
    v_lshrrev_b32 v37, 1, v77
    v_and_or_b32 v245, v37, s78, v73
    v_lshlrev_b32 v36, 3, v78
    v_and_or_b32 v74, v36, s78, v74
    v_lshrrev_b32 v37, 1, v78
    v_and_or_b32 v246, v37, s78, v74
    v_lshlrev_b32 v36, 3, v79
    v_and_or_b32 v75, v36, s78, v75
    v_lshrrev_b32 v37, 1, v79
    v_and_or_b32 v247, v37, s78, v75
    v_and_b32 v25, 0x7fff7fff, v48
    v_pk_sub_u16 v25, v25, 1 op_sel_hi:[1,0]
    v_and_b32 v37, 0x7fff7fff, v49
    v_pk_sub_u16 v37, v37, 1 op_sel_hi:[1,0]
    v_pk_min_u16 v25, v25, v37
    v_and_b32 v36, 0x7fff7fff, v50
    v_pk_sub_u16 v36, v36, 1 op_sel_hi:[1,0]
    v_pk_min_u16 v25, v25, v36
    v_and_b32 v37, 0x7fff7fff, v51
    v_pk_sub_u16 v37, v37, 1 op_sel_hi:[1,0]
    v_pk_min_u16 v25, v25, v37
    v_and_b32 v36, 0x7fff7fff, v52
    v_pk_sub_u16 v36, v36, 1 op_sel_hi:[1,0]
    v_pk_min_u16 v25, v25, v36
    v_and_b32 v37, 0x7fff7fff, v53
    v_pk_sub_u16 v37, v37, 1 op_sel_hi:[1,0]
    v_pk_min_u16 v25, v25, v37
    v_and_b32 v36, 0x7fff7fff, v54
    v_pk_sub_u16 v36, v36, 1 op_sel_hi:[1,0]
    v_pk_min_u16 v25, v25, v36
    v_and_b32 v37, 0x7fff7fff, v55
    v_pk_sub_u16 v37, v37, 1 op_sel_hi:[1,0]
    v_pk_min_u16 v25, v25, v37
    v_and_b32 v36, 0x7fff7fff, v56
    v_pk_sub_u16 v36, v36, 1 op_sel_hi:[1,0]
    v_pk_min_u16 v25, v25, v36
    v_and_b32 v37, 0x7fff7fff, v57
    v_pk_sub_u16 v37, v37, 1 op_sel_hi:[1,0]
    v_pk_min_u16 v25, v25, v37
    v_and_b32 v36, 0x7fff7fff, v58
    v_pk_sub_u16 v36, v36, 1 op_sel_hi:[1,0]
    v_pk_min_u16 v25, v25, v36
    v_and_b32 v37, 0x7fff7fff, v59
    v_pk_sub_u16 v37, v37, 1 op_sel_hi:[1,0]
    v_pk_min_u16 v25, v25, v37
    v_and_b32 v36, 0x7fff7fff, v60
    v_pk_sub_u16 v36, v36, 1 op_sel_hi:[1,0]
    v_pk_min_u16 v25, v25, v36
    v_and_b32 v37, 0x7fff7fff, v61
    v_pk_sub_u16 v37, v37, 1 op_sel_hi:[1,0]
    v_pk_min_u16 v25, v25, v37
    v_and_b32 v36, 0x7fff7fff, v62
    v_pk_sub_u16 v36, v36, 1 op_sel_hi:[1,0]
    v_pk_min_u16 v25, v25, v36
    v_and_b32 v37, 0x7fff7fff, v63
    v_pk_sub_u16 v37, v37, 1 op_sel_hi:[1,0]
    v_pk_min_u16 v25, v25, v37
    v_mov_b32 v36, 0x38ff38ff
    v_pk_sub_u16 v36, v36, v25 clamp
    v_cmp_ne_u32 vcc, 0, v36
    s_or_b32 s62, 13, 0
    s_getpc_b64 s[92:93]
    s_cbranch_vccnz REC_K
    v_and_b32 v26, 0x7fff7fff, v48
    v_pk_sub_u16 v26, v26, s98 clamp
    v_bfi_b32 v48, s79, v26, v48
    v_and_b32 v27, 0x7fff7fff, v49
    v_pk_sub_u16 v27, v27, s98 clamp
    v_bfi_b32 v49, s79, v27, v49
    v_and_b32 v26, 0x7fff7fff, v50
    v_pk_sub_u16 v26, v26, s98 clamp
    v_bfi_b32 v50, s79, v26, v50
    v_and_b32 v27, 0x7fff7fff, v51
    v_pk_sub_u16 v27, v27, s98 clamp
    v_bfi_b32 v51, s79, v27, v51
    v_and_b32 v26, 0x7fff7fff, v52
    v_pk_sub_u16 v26, v26, s98 clamp
    v_bfi_b32 v52, s79, v26, v52
    v_and_b32 v27, 0x7fff7fff, v53
    v_pk_sub_u16 v27, v27, s98 clamp
    v_bfi_b32 v53, s79, v27, v53
    v_and_b32 v26, 0x7fff7fff, v54
    v_pk_sub_u16 v26, v26, s98 clamp
    v_bfi_b32 v54, s79, v26, v54
    v_and_b32 v27, 0x7fff7fff, v55
    v_pk_sub_u16 v27, v27, s98 clamp
    v_bfi_b32 v55, s79, v27, v55
    v_and_b32 v26, 0x7fff7fff, v56
    v_pk_sub_u16 v26, v26, s98 clamp
    v_bfi_b32 v56, s79, v26, v56
    v_and_b32 v27, 0x7fff7fff, v57
    v_pk_sub_u16 v27, v27, s98 clamp
    v_bfi_b32 v57, s79, v27, v57
    v_and_b32 v26, 0x7fff7fff, v58
    v_pk_sub_u16 v26, v26, s98 clamp
    v_bfi_b32 v58, s79, v26, v58
    v_and_b32 v27, 0x7fff7fff, v59
    v_pk_sub_u16 v27, v27, s98 clamp
    v_bfi_b32 v59, s79, v27, v59
    v_and_b32 v26, 0x7fff7fff, v60
    v_pk_sub_u16 v26, v26, s98 clamp
    v_bfi_b32 v60, s79, v26, v60
    v_and_b32 v27, 0x7fff7fff, v61
    v_pk_sub_u16 v27, v27, s98 clamp
    v_bfi_b32 v61, s79, v27, v61
    v_and_b32 v26, 0x7fff7fff, v62
    v_pk_sub_u16 v26, v26, s98 clamp
    v_bfi_b32 v62, s79, v26, v62
    v_and_b32 v27, 0x7fff7fff, v63
    v_pk_sub_u16 v27, v27, s98 clamp
    v_bfi_b32 v63, s79, v27, v63
    v_or3_b32 v24, v24, v48, v49
    v_or3_b32 v24, v24, v50, v51
    v_or3_b32 v24, v24, v52, v53
    v_or3_b32 v24, v24, v54, v55
    v_or3_b32 v24, v24, v56, v57
    v_or3_b32 v24, v24, v58, v59
    v_or3_b32 v24, v24, v60, v61
    v_or3_b32 v24, v24, v62, v63
    v_lshlrev_b32 v36, 11, v60
    v_and_or_b32 v48, v36, s78, v48
    v_lshlrev_b32 v37, 11, v61
    v_and_or_b32 v49, v37, s78, v49
    v_lshlrev_b32 v36, 11, v62
    v_and_or_b32 v50, v36, s78, v50
    v_lshlrev_b32 v37, 11, v63
    v_and_or_b32 v51, v37, s78, v51
    v_lshlrev_b32 v36, 7, v60
    v_and_or_b32 v52, v36, s78, v52
    v_lshlrev_b32 v37, 7, v61
    v_and_or_b32 v53, v37, s78, v53
    v_lshlrev_b32 v36, 7, v62
    v_and_or_b32 v54, v36, s78, v54
    v_lshlrev_b32 v37, 7, v63
    v_and_or_b32 v55, v37, s78, v55
    v_lshlrev_b32 v36, 3, v60
    v_and_or_b32 v56, v36, s78, v56
    v_lshrrev_b32 v37, 1, v60
    v_and_or_b32 v56, v37, s78, v56
    v_lshlrev_b32 v36, 3, v61
    v_and_or_b32 v57, v36, s78, v57
    v_lshrrev_b32 v37, 1, v61
    v_and_or_b32 v57, v37, s78, v57
    v_lshlrev_b32 v36, 3, v62
    v_and_or_b32 v58, v36, s78, v58
    v_lshrrev_b32 v37, 1, v62
    v_and_or_b32 v58, v37, s78, v58
    v_lshlrev_b32 v36, 3, v63
    v_and_or_b32 v59, v36, s78, v59
    v_lshrrev_b32 v37, 1, v63
    v_and_or_b32 v59, v37, s78, v59
    v_lshlrev_b32 v36, 4, v0
    v_add_u32 v36, s59, v36
    ds_write_b128 v36, v[48:51] offset:17920
    ds_write_b128 v36, v[52:55] offset:18944
    ds_write_b128 v36, v[56:59] offset:19968
    v_and_b32 v24, s78, v24
    v_cmp_ne_u32 vcc, 0, v24
    s_cmp_lg_u64 vcc, 0
    s_cselect_b32 s60, 8192, 0
    s_or_b32 s99, s99, s60
    s_waitcnt vmcnt(20)
    ds_read_b128 v[48:51], v9 offset:4096
    ds_read_b128 v[52:55], v10 offset:4096
    ds_read_b128 v[56:59], v11 offset:4096
    ds_read_b128 v[60:63], v12 offset:4096
    s_waitcnt vmcnt(16)
    v_accvgpr_read_b32 v64, a16
    v_accvgpr_read_b32 v65, a17
    v_accvgpr_read_b32 v66, a18
    v_accvgpr_read_b32 v67, a19
    v_accvgpr_read_b32 v68, a20
    v_accvgpr_read_b32 v69, a21
    v_accvgpr_read_b32 v70, a22
    v_accvgpr_read_b32 v71, a23
    v_accvgpr_read_b32 v72, a24
    v_accvgpr_read_b32 v73, a25
    v_accvgpr_read_b32 v74, a26
    v_accvgpr_read_b32 v75, a27
    v_accvgpr_read_b32 v76, a28
    v_accvgpr_read_b32 v77, a29
    v_accvgpr_read_b32 v78, a30
    v_accvgpr_read_b32 v79, a31
    s_waitcnt lgkmcnt(0)
    s_add_u32 s77, s90, 16
    s_mul_i32 s54, s77, s85
    s_add_u32 s54, s54, s53
    s_add_u32 m0, s59, 4096
    s_nop 0
    buffer_load_dwordx4 v4, s[4:7], s54 offen offset:0 nt lds
    buffer_load_dwordx4 v5, s[4:7], s54 offen offset:1024 nt lds
    buffer_load_dwordx4 v6, s[4:7], s54 offen offset:2048 nt lds
    buffer_load_dwordx4 v7, s[4:7], s54 offen offset:3072 nt lds
    buffer_load_dwordx4 a[16:19], v8, s[8:11], s54 offen offset:0 nt
    buffer_load_dwordx4 a[20:23], v8, s[8:11], s54 offen offset:256 nt
    buffer_load_dwordx4 a[24:27], v8, s[8:11], s54 offen offset:512 nt
    buffer_load_dwordx4 a[28:31], v8, s[8:11], s54 offen offset:768 nt
    buffer_load_dword v29, v28, s[36:39], 0 offen sc1
    v_and_b32 v25, 0x7fff7fff, v64
    v_pk_sub_u16 v25, v25, 1 op_sel_hi:[1,0]
    v_and_b32 v37, 0x7fff7fff, v65
    v_pk_sub_u16 v37, v37, 1 op_sel_hi:[1,0]
    v_pk_min_u16 v25, v25, v37
    v_and_b32 v36, 0x7fff7fff, v66
    v_pk_sub_u16 v36, v36, 1 op_sel_hi:[1,0]
    v_pk_min_u16 v25, v25, v36
    v_and_b32 v37, 0x7fff7fff, v67
    v_pk_sub_u16 v37, v37, 1 op_sel_hi:[1,0]
    v_pk_min_u16 v25, v25, v37
    v_and_b32 v36, 0x7fff7fff, v68
    v_pk_sub_u16 v36, v36, 1 op_sel_hi:[1,0]
    v_pk_min_u16 v25, v25, v36
    v_and_b32 v37, 0x7fff7fff, v69
    v_pk_sub_u16 v37, v37, 1 op_sel_hi:[1,0]
    v_pk_min_u16 v25, v25, v37
    v_and_b32 v36, 0x7fff7fff, v70
    v_pk_sub_u16 v36, v36, 1 op_sel_hi:[1,0]
    v_pk_min_u16 v25, v25, v36
    v_and_b32 v37, 0x7fff7fff, v71
    v_pk_sub_u16 v37, v37, 1 op_sel_hi:[1,0]
    v_pk_min_u16 v25, v25, v37
    v_and_b32 v36, 0x7fff7fff, v72
    v_pk_sub_u16 v36, v36, 1 op_sel_hi:[1,0]
    v_pk_min_u16 v25, v25, v36
    v_and_b32 v37, 0x7fff7fff, v73
    v_pk_sub_u16 v37, v37, 1 op_sel_hi:[1,0]
    v_pk_min_u16 v25, v25, v37
    v_and_b32 v36, 0x7fff7fff, v74
    v_pk_sub_u16 v36, v36, 1 op_sel_hi:[1,0]
    v_pk_min_u16 v25, v25, v36
    v_and_b32 v37, 0x7fff7fff, v75
    v_pk_sub_u16 v37, v37, 1 op_sel_hi:[1,0]
    v_pk_min_u16 v25, v25, v37
    v_and_b32 v36, 0x7fff7fff, v76
    v_pk_sub_u16 v36, v36, 1 op_sel_hi:[1,0]
    v_pk_min_u16 v25, v25, v36
    v_and_b32 v37, 0x7fff7fff, v77
    v_pk_sub_u16 v37, v37, 1 op_sel_hi:[1,0]
    v_pk_min_u16 v25, v25, v37
    v_and_b32 v36, 0x7fff7fff, v78
    v_pk_sub_u16 v36, v36, 1 op_sel_hi:[1,0]
    v_pk_min_u16 v25, v25, v36
    v_and_b32 v37, 0x7fff7fff, v79
    v_pk_sub_u16 v37, v37, 1 op_sel_hi:[1,0]
    v_pk_min_u16 v25, v25, v37
    v_mov_b32 v36, 0x397f397f
    v_pk_sub_u16 v36, v36, v25 clamp
    v_cmp_ne_u32 vcc, 0, v36
    s_or_b32 s62, 46, 0
    s_getpc_b64 s[92:93]
    s_cbranch_vccnz REC_V
    v_and_b32 v26, 0x7fff7fff, v64
    v_pk_sub_u16 v26, v26, s94 clamp
    v_bfi_b32 v64, s79, v26, v64
    v_and_b32 v27, 0x7fff7fff, v65
    v_pk_sub_u16 v27, v27, s94 clamp
    v_bfi_b32 v65, s79, v27, v65
    v_and_b32 v26, 0x7fff7fff, v66
    v_pk_sub_u16 v26, v26, s94 clamp
    v_bfi_b32 v66, s79, v26, v66
    v_and_b32 v27, 0x7fff7fff, v67
    v_pk_sub_u16 v27, v27, s94 clamp
    v_bfi_b32 v67, s79, v27, v67
    v_and_b32 v26, 0x7fff7fff, v68
    v_pk_sub_u16 v26, v26, s94 clamp
    v_bfi_b32 v68, s79, v26, v68
    v_and_b32 v27, 0x7fff7fff, v69
    v_pk_sub_u16 v27, v27, s94 clamp
    v_bfi_b32 v69, s79, v27, v69
    v_and_b32 v26, 0x7fff7fff, v70
    v_pk_sub_u16 v26, v26, s94 clamp
    v_bfi_b32 v70, s79, v26, v70
    v_and_b32 v27, 0x7fff7fff, v71
    v_pk_sub_u16 v27, v27, s94 clamp
    v_bfi_b32 v71, s79, v27, v71
    v_and_b32 v26, 0x7fff7fff, v72
    v_pk_sub_u16 v26, v26, s94 clamp
    v_bfi_b32 v72, s79, v26, v72
    v_and_b32 v27, 0x7fff7fff, v73
    v_pk_sub_u16 v27, v27, s94 clamp
    v_bfi_b32 v73, s79, v27, v73
    v_and_b32 v26, 0x7fff7fff, v74
    v_pk_sub_u16 v26, v26, s94 clamp
    v_bfi_b32 v74, s79, v26, v74
    v_and_b32 v27, 0x7fff7fff, v75
    v_pk_sub_u16 v27, v27, s94 clamp
    v_bfi_b32 v75, s79, v27, v75
    v_and_b32 v26, 0x7fff7fff, v76
    v_pk_sub_u16 v26, v26, s94 clamp
    v_bfi_b32 v76, s79, v26, v76
    v_and_b32 v27, 0x7fff7fff, v77
    v_pk_sub_u16 v27, v27, s94 clamp
    v_bfi_b32 v77, s79, v27, v77
    v_and_b32 v26, 0x7fff7fff, v78
    v_pk_sub_u16 v26, v26, s94 clamp
    v_bfi_b32 v78, s79, v26, v78
    v_and_b32 v27, 0x7fff7fff, v79
    v_pk_sub_u16 v27, v27, s94 clamp
    v_bfi_b32 v79, s79, v27, v79
    v_or_b32 v24, v64, v65
    v_or3_b32 v24, v24, v66, v67
    v_or3_b32 v24, v24, v68, v69
    v_or3_b32 v24, v24, v70, v71
    v_or3_b32 v24, v24, v72, v73
    v_or3_b32 v24, v24, v74, v75
    v_or3_b32 v24, v24, v76, v77
    v_or3_b32 v24, v24, v78, v79
    v_lshlrev_b32 v36, 11, v76
    v_and_or_b32 v248, v36, s78, v64
    v_lshlrev_b32 v37, 11, v77
    v_and_or_b32 v249, v37, s78, v65
    v_lshlrev_b32 v36, 11, v78
    v_and_or_b32 v250, v36, s78, v66
    v_lshlrev_b32 v37, 11, v79
    v_and_or_b32 v251, v37, s78, v67
    v_lshlrev_b32 v36, 7, v76
    v_and_or_b32 v252, v36, s78, v68
    v_lshlrev_b32 v37, 7, v77
    v_and_or_b32 v253, v37, s78, v69
    v_lshlrev_b32 v36, 7, v78
    v_and_or_b32 v254, v36, s78, v70
    v_lshlrev_b32 v37, 7, v79
    v_and_or_b32 v255, v37, s78, v71
    v_lshlrev_b32 v36, 3, v76
    v_and_or_b32 v72, v36, s78, v72
    v_lshrrev_b32 v37, 1, v76
    v_and_or_b32 v72, v37, s78, v72
    v_accvgpr_write_b32 a32, v72
    v_lshlrev_b32 v36, 3, v77
    v_and_or_b32 v73, v36, s78, v73
    v_lshrrev_b32 v37, 1, v77
    v_and_or_b32 v73, v37, s78, v73
    v_accvgpr_write_b32 a33, v73
    v_lshlrev_b32 v36, 3, v78
    v_and_or_b32 v74, v36, s78, v74
    v_lshrrev_b32 v37, 1, v78
    v_and_or_b32 v74, v37, s78, v74
    v_accvgpr_write_b32 a34, v74
    v_lshlrev_b32 v36, 3, v79
    v_and_or_b32 v75, v36, s78, v75
    v_lshrrev_b32 v37, 1, v79
    v_and_or_b32 v75, v37, s78, v75
    v_accvgpr_write_b32 a35, v75
    v_and_b32 v25, 0x7fff7fff, v48
    v_pk_sub_u16 v25, v25, 1 op_sel_hi:[1,0]
    v_and_b32 v37, 0x7fff7fff, v49
    v_pk_sub_u16 v37, v37, 1 op_sel_hi:[1,0]
    v_pk_min_u16 v25, v25, v37
    v_and_b32 v36, 0x7fff7fff, v50
    v_pk_sub_u16 v36, v36, 1 op_sel_hi:[1,0]
    v_pk_min_u16 v25, v25, v36
    v_and_b32 v37, 0x7fff7fff, v51
    v_pk_sub_u16 v37, v37, 1 op_sel_hi:[1,0]
    v_pk_min_u16 v25, v25, v37
    v_and_b32 v36, 0x7fff7fff, v52
    v_pk_sub_u16 v36, v36, 1 op_sel_hi:[1,0]
    v_pk_min_u16 v25, v25, v36
    v_and_b32 v37, 0x7fff7fff, v53
    v_pk_sub_u16 v37, v37, 1 op_sel_hi:[1,0]
    v_pk_min_u16 v25, v25, v37
    v_and_b32 v36, 0x7fff7fff, v54
    v_pk_sub_u16 v36, v36, 1 op_sel_hi:[1,0]
    v_pk_min_u16 v25, v25, v36
    v_and_b32 v37, 0x7fff7fff, v55
    v_pk_sub_u16 v37, v37, 1 op_sel_hi:[1,0]
    v_pk_min_u16 v25, v25, v37
    v_and_b32 v36, 0x7fff7fff, v56
    v_pk_sub_u16 v36, v36, 1 op_sel_hi:[1,0]
    v_pk_min_u16 v25, v25, v36
    v_and_b32 v37, 0x7fff7fff, v57
    v_pk_sub_u16 v37, v37, 1 op_sel_hi:[1,0]
    v_pk_min_u16 v25, v25, v37
    v_and_b32 v36, 0x7fff7fff, v58
    v_pk_sub_u16 v36, v36, 1 op_sel_hi:[1,0]
    v_pk_min_u16 v25, v25, v36
    v_and_b32 v37, 0x7fff7fff, v59
    v_pk_sub_u16 v37, v37, 1 op_sel_hi:[1,0]
    v_pk_min_u16 v25, v25, v37
    v_and_b32 v36, 0x7fff7fff, v60
    v_pk_sub_u16 v36, v36, 1 op_sel_hi:[1,0]
    v_pk_min_u16 v25, v25, v36
    v_and_b32 v37, 0x7fff7fff, v61
    v_pk_sub_u16 v37, v37, 1 op_sel_hi:[1,0]
    v_pk_min_u16 v25, v25, v37
    v_and_b32 v36, 0x7fff7fff, v62
    v_pk_sub_u16 v36, v36, 1 op_sel_hi:[1,0]
    v_pk_min_u16 v25, v25, v36
    v_and_b32 v37, 0x7fff7fff, v63
    v_pk_sub_u16 v37, v37, 1 op_sel_hi:[1,0]
    v_pk_min_u16 v25, v25, v37
    v_mov_b32 v36, 0x38ff38ff
    v_pk_sub_u16 v36, v36, v25 clamp
    v_cmp_ne_u32 vcc, 0, v36
    s_or_b32 s62, 14, 0
    s_getpc_b64 s[92:93]
    s_cbranch_vccnz REC_K
    v_and_b32 v26, 0x7fff7fff, v48
    v_pk_sub_u16 v26, v26, s98 clamp
    v_bfi_b32 v48, s79, v26, v48
    v_and_b32 v27, 0x7fff7fff, v49
    v_pk_sub_u16 v27, v27, s98 clamp
    v_bfi_b32 v49, s79, v27, v49
    v_and_b32 v26, 0x7fff7fff, v50
    v_pk_sub_u16 v26, v26, s98 clamp
    v_bfi_b32 v50, s79, v26, v50
    v_and_b32 v27, 0x7fff7fff, v51
    v_pk_sub_u16 v27, v27, s98 clamp
    v_bfi_b32 v51, s79, v27, v51
    v_and_b32 v26, 0x7fff7fff, v52
    v_pk_sub_u16 v26, v26, s98 clamp
    v_bfi_b32 v52, s79, v26, v52
    v_and_b32 v27, 0x7fff7fff, v53
    v_pk_sub_u16 v27, v27, s98 clamp
    v_bfi_b32 v53, s79, v27, v53
    v_and_b32 v26, 0x7fff7fff, v54
    v_pk_sub_u16 v26, v26, s98 clamp
    v_bfi_b32 v54, s79, v26, v54
    v_and_b32 v27, 0x7fff7fff, v55
    v_pk_sub_u16 v27, v27, s98 clamp
    v_bfi_b32 v55, s79, v27, v55
    v_and_b32 v26, 0x7fff7fff, v56
    v_pk_sub_u16 v26, v26, s98 clamp
    v_bfi_b32 v56, s79, v26, v56
    v_and_b32 v27, 0x7fff7fff, v57
    v_pk_sub_u16 v27, v27, s98 clamp
    v_bfi_b32 v57, s79, v27, v57
    v_and_b32 v26, 0x7fff7fff, v58
    v_pk_sub_u16 v26, v26, s98 clamp
    v_bfi_b32 v58, s79, v26, v58
    v_and_b32 v27, 0x7fff7fff, v59
    v_pk_sub_u16 v27, v27, s98 clamp
    v_bfi_b32 v59, s79, v27, v59
    v_and_b32 v26, 0x7fff7fff, v60
    v_pk_sub_u16 v26, v26, s98 clamp
    v_bfi_b32 v60, s79, v26, v60
    v_and_b32 v27, 0x7fff7fff, v61
    v_pk_sub_u16 v27, v27, s98 clamp
    v_bfi_b32 v61, s79, v27, v61
    v_and_b32 v26, 0x7fff7fff, v62
    v_pk_sub_u16 v26, v26, s98 clamp
    v_bfi_b32 v62, s79, v26, v62
    v_and_b32 v27, 0x7fff7fff, v63
    v_pk_sub_u16 v27, v27, s98 clamp
    v_bfi_b32 v63, s79, v27, v63
    v_or3_b32 v24, v24, v48, v49
    v_or3_b32 v24, v24, v50, v51
    v_or3_b32 v24, v24, v52, v53
    v_or3_b32 v24, v24, v54, v55
    v_or3_b32 v24, v24, v56, v57
    v_or3_b32 v24, v24, v58, v59
    v_or3_b32 v24, v24, v60, v61
    v_or3_b32 v24, v24, v62, v63
    v_lshlrev_b32 v36, 11, v60
    v_and_or_b32 v48, v36, s78, v48
    v_lshlrev_b32 v37, 11, v61
    v_and_or_b32 v49, v37, s78, v49
    v_lshlrev_b32 v36, 11, v62
    v_and_or_b32 v50, v36, s78, v50
    v_lshlrev_b32 v37, 11, v63
    v_and_or_b32 v51, v37, s78, v51
    v_lshlrev_b32 v36, 7, v60
    v_and_or_b32 v52, v36, s78, v52
    v_lshlrev_b32 v37, 7, v61
    v_and_or_b32 v53, v37, s78, v53
    v_lshlrev_b32 v36, 7, v62
    v_and_or_b32 v54, v36, s78, v54
    v_lshlrev_b32 v37, 7, v63
    v_and_or_b32 v55, v37, s78, v55
    v_lshlrev_b32 v36, 3, v60
    v_and_or_b32 v56, v36, s78, v56
    v_lshrrev_b32 v37, 1, v60
    v_and_or_b32 v56, v37, s78, v56
    v_lshlrev_b32 v36, 3, v61
    v_and_or_b32 v57, v36, s78, v57
    v_lshrrev_b32 v37, 1, v61
    v_and_or_b32 v57, v37, s78, v57
    v_lshlrev_b32 v36, 3, v62
    v_and_or_b32 v58, v36, s78, v58
    v_lshrrev_b32 v37, 1, v62
    v_and_or_b32 v58, v37, s78, v58
    v_lshlrev_b32 v36, 3, v63
    v_and_or_b32 v59, v36, s78, v59
    v_lshrrev_b32 v37, 1, v63
    v_and_or_b32 v59, v37, s78, v59
    v_lshlrev_b32 v36, 4, v0
    v_add_u32 v36, s59, v36
    ds_write_b128 v36, v[48:51] offset:20992
    ds_write_b128 v36, v[52:55] offset:22016
    ds_write_b128 v36, v[56:59] offset:23040
    v_and_b32 v24, s78, v24
    v_cmp_ne_u32 vcc, 0, v24
    s_cmp_lg_u64 vcc, 0
    s_cselect_b32 s60, 16384, 0
    s_or_b32 s99, s99, s60
    s_waitcnt vmcnt(21)
    ds_read_b128 v[48:51], v9 offset:32768
    ds_read_b128 v[52:55], v10 offset:32768
    ds_read_b128 v[56:59], v11 offset:32768
    ds_read_b128 v[60:63], v12 offset:32768
    s_waitcnt vmcnt(17)
    v_accvgpr_read_b32 v64, a232
    v_accvgpr_read_b32 v65, a233
    v_accvgpr_read_b32 v66, a234
    v_accvgpr_read_b32 v67, a235
    v_accvgpr_read_b32 v68, a236
    v_accvgpr_read_b32 v69, a237
    v_accvgpr_read_b32 v70, a238
    v_accvgpr_read_b32 v71, a239
    v_accvgpr_read_b32 v72, a240
    v_accvgpr_read_b32 v73, a241
    v_accvgpr_read_b32 v74, a242
    v_accvgpr_read_b32 v75, a243
    v_accvgpr_read_b32 v76, a244
    v_accvgpr_read_b32 v77, a245
    v_accvgpr_read_b32 v78, a246
    v_accvgpr_read_b32 v79, a247
    s_waitcnt lgkmcnt(0)
    v_and_b32 v25, 0x7fff7fff, v64
    v_pk_sub_u16 v25, v25, 1 op_sel_hi:[1,0]
    v_and_b32 v37, 0x7fff7fff, v65
    v_pk_sub_u16 v37, v37, 1 op_sel_hi:[1,0]
    v_pk_min_u16 v25, v25, v37
    v_and_b32 v36, 0x7fff7fff, v66
    v_pk_sub_u16 v36, v36, 1 op_sel_hi:[1,0]
    v_pk_min_u16 v25, v25, v36
    v_and_b32 v37, 0x7fff7fff, v67
    v_pk_sub_u16 v37, v37, 1 op_sel_hi:[1,0]
    v_pk_min_u16 v25, v25, v37
    v_and_b32 v36, 0x7fff7fff, v68
    v_pk_sub_u16 v36, v36, 1 op_sel_hi:[1,0]
    v_pk_min_u16 v25, v25, v36
    v_and_b32 v37, 0x7fff7fff, v69
    v_pk_sub_u16 v37, v37, 1 op_sel_hi:[1,0]
    v_pk_min_u16 v25, v25, v37
    v_and_b32 v36, 0x7fff7fff, v70
    v_pk_sub_u16 v36, v36, 1 op_sel_hi:[1,0]
    v_pk_min_u16 v25, v25, v36
    v_and_b32 v37, 0x7fff7fff, v71
    v_pk_sub_u16 v37, v37, 1 op_sel_hi:[1,0]
    v_pk_min_u16 v25, v25, v37
    v_and_b32 v36, 0x7fff7fff, v72
    v_pk_sub_u16 v36, v36, 1 op_sel_hi:[1,0]
    v_pk_min_u16 v25, v25, v36
    v_and_b32 v37, 0x7fff7fff, v73
    v_pk_sub_u16 v37, v37, 1 op_sel_hi:[1,0]
    v_pk_min_u16 v25, v25, v37
    v_and_b32 v36, 0x7fff7fff, v74
    v_pk_sub_u16 v36, v36, 1 op_sel_hi:[1,0]
    v_pk_min_u16 v25, v25, v36
    v_and_b32 v37, 0x7fff7fff, v75
    v_pk_sub_u16 v37, v37, 1 op_sel_hi:[1,0]
    v_pk_min_u16 v25, v25, v37
    v_and_b32 v36, 0x7fff7fff, v76
    v_pk_sub_u16 v36, v36, 1 op_sel_hi:[1,0]
    v_pk_min_u16 v25, v25, v36
    v_and_b32 v37, 0x7fff7fff, v77
    v_pk_sub_u16 v37, v37, 1 op_sel_hi:[1,0]
    v_pk_min_u16 v25, v25, v37
    v_and_b32 v36, 0x7fff7fff, v78
    v_pk_sub_u16 v36, v36, 1 op_sel_hi:[1,0]
    v_pk_min_u16 v25, v25, v36
    v_and_b32 v37, 0x7fff7fff, v79
    v_pk_sub_u16 v37, v37, 1 op_sel_hi:[1,0]
    v_pk_min_u16 v25, v25, v37
    v_mov_b32 v36, 0x397f397f
    v_pk_sub_u16 v36, v36, v25 clamp
    v_cmp_ne_u32 vcc, 0, v36
    s_or_b32 s62, 47, 0
    s_getpc_b64 s[92:93]
    s_cbranch_vccnz REC_V
    v_and_b32 v26, 0x7fff7fff, v64
    v_pk_sub_u16 v26, v26, s94 clamp
    v_bfi_b32 v64, s79, v26, v64
    v_and_b32 v27, 0x7fff7fff, v65
    v_pk_sub_u16 v27, v27, s94 clamp
    v_bfi_b32 v65, s79, v27, v65
    v_and_b32 v26, 0x7fff7fff, v66
    v_pk_sub_u16 v26, v26, s94 clamp
    v_bfi_b32 v66, s79, v26, v66
    v_and_b32 v27, 0x7fff7fff, v67
    v_pk_sub_u16 v27, v27, s94 clamp
    v_bfi_b32 v67, s79, v27, v67
    v_and_b32 v26, 0x7fff7fff, v68
    v_pk_sub_u16 v26, v26, s94 clamp
    v_bfi_b32 v68, s79, v26, v68
    v_and_b32 v27, 0x7fff7fff, v69
    v_pk_sub_u16 v27, v27, s94 clamp
    v_bfi_b32 v69, s79, v27, v69
    v_and_b32 v26, 0x7fff7fff, v70
    v_pk_sub_u16 v26, v26, s94 clamp
    v_bfi_b32 v70, s79, v26, v70
    v_and_b32 v27, 0x7fff7fff, v71
    v_pk_sub_u16 v27, v27, s94 clamp
    v_bfi_b32 v71, s79, v27, v71
    v_and_b32 v26, 0x7fff7fff, v72
    v_pk_sub_u16 v26, v26, s94 clamp
    v_bfi_b32 v72, s79, v26, v72
    v_and_b32 v27, 0x7fff7fff, v73
    v_pk_sub_u16 v27, v27, s94 clamp
    v_bfi_b32 v73, s79, v27, v73
    v_and_b32 v26, 0x7fff7fff, v74
    v_pk_sub_u16 v26, v26, s94 clamp
    v_bfi_b32 v74, s79, v26, v74
    v_and_b32 v27, 0x7fff7fff, v75
    v_pk_sub_u16 v27, v27, s94 clamp
    v_bfi_b32 v75, s79, v27, v75
    v_and_b32 v26, 0x7fff7fff, v76
    v_pk_sub_u16 v26, v26, s94 clamp
    v_bfi_b32 v76, s79, v26, v76
    v_and_b32 v27, 0x7fff7fff, v77
    v_pk_sub_u16 v27, v27, s94 clamp
    v_bfi_b32 v77, s79, v27, v77
    v_and_b32 v26, 0x7fff7fff, v78
    v_pk_sub_u16 v26, v26, s94 clamp
    v_bfi_b32 v78, s79, v26, v78
    v_and_b32 v27, 0x7fff7fff, v79
    v_pk_sub_u16 v27, v27, s94 clamp
    v_bfi_b32 v79, s79, v27, v79
    v_or_b32 v24, v64, v65
    v_or3_b32 v24, v24, v66, v67
    v_or3_b32 v24, v24, v68, v69
    v_or3_b32 v24, v24, v70, v71
    v_or3_b32 v24, v24, v72, v73
    v_or3_b32 v24, v24, v74, v75
    v_or3_b32 v24, v24, v76, v77
    v_or3_b32 v24, v24, v78, v79
    v_lshlrev_b32 v36, 11, v76
    v_and_or_b32 v64, v36, s78, v64
    v_accvgpr_write_b32 a36, v64
    v_lshlrev_b32 v37, 11, v77
    v_and_or_b32 v65, v37, s78, v65
    v_accvgpr_write_b32 a37, v65
    v_lshlrev_b32 v36, 11, v78
    v_and_or_b32 v66, v36, s78, v66
    v_accvgpr_write_b32 a38, v66
    v_lshlrev_b32 v37, 11, v79
    v_and_or_b32 v67, v37, s78, v67
    v_accvgpr_write_b32 a39, v67
    v_lshlrev_b32 v36, 7, v76
    v_and_or_b32 v68, v36, s78, v68
    v_accvgpr_write_b32 a40, v68
    v_lshlrev_b32 v37, 7, v77
    v_and_or_b32 v69, v37, s78, v69
    v_accvgpr_write_b32 a41, v69
    v_lshlrev_b32 v36, 7, v78
    v_and_or_b32 v70, v36, s78, v70
    v_accvgpr_write_b32 a42, v70
    v_lshlrev_b32 v37, 7, v79
    v_and_or_b32 v71, v37, s78, v71
    v_accvgpr_write_b32 a43, v71
    v_lshlrev_b32 v36, 3, v76
    v_and_or_b32 v72, v36, s78, v72
    v_lshrrev_b32 v37, 1, v76
    v_and_or_b32 v72, v37, s78, v72
    v_accvgpr_write_b32 a44, v72
    v_lshlrev_b32 v36, 3, v77
    v_and_or_b32 v73, v36, s78, v73
    v_lshrrev_b32 v37, 1, v77
    v_and_or_b32 v73, v37, s78, v73
    v_accvgpr_write_b32 a45, v73
    v_lshlrev_b32 v36, 3, v78
    v_and_or_b32 v74, v36, s78, v74
    v_lshrrev_b32 v37, 1, v78
    v_and_or_b32 v74, v37, s78, v74
    v_accvgpr_write_b32 a46, v74
    v_lshlrev_b32 v36, 3, v79
    v_and_or_b32 v75, v36, s78, v75
    v_lshrrev_b32 v37, 1, v79
    v_and_or_b32 v75, v37, s78, v75
    v_accvgpr_write_b32 a47, v75
    v_and_b32 v25, 0x7fff7fff, v48
    v_pk_sub_u16 v25, v25, 1 op_sel_hi:[1,0]
    v_and_b32 v37, 0x7fff7fff, v49
    v_pk_sub_u16 v37, v37, 1 op_sel_hi:[1,0]
    v_pk_min_u16 v25, v25, v37
    v_and_b32 v36, 0x7fff7fff, v50
    v_pk_sub_u16 v36, v36, 1 op_sel_hi:[1,0]
    v_pk_min_u16 v25, v25, v36
    v_and_b32 v37, 0x7fff7fff, v51
    v_pk_sub_u16 v37, v37, 1 op_sel_hi:[1,0]
    v_pk_min_u16 v25, v25, v37
    v_and_b32 v36, 0x7fff7fff, v52
    v_pk_sub_u16 v36, v36, 1 op_sel_hi:[1,0]
    v_pk_min_u16 v25, v25, v36
    v_and_b32 v37, 0x7fff7fff, v53
    v_pk_sub_u16 v37, v37, 1 op_sel_hi:[1,0]
    v_pk_min_u16 v25, v25, v37
    v_and_b32 v36, 0x7fff7fff, v54
    v_pk_sub_u16 v36, v36, 1 op_sel_hi:[1,0]
    v_pk_min_u16 v25, v25, v36
    v_and_b32 v37, 0x7fff7fff, v55
    v_pk_sub_u16 v37, v37, 1 op_sel_hi:[1,0]
    v_pk_min_u16 v25, v25, v37
    v_and_b32 v36, 0x7fff7fff, v56
    v_pk_sub_u16 v36, v36, 1 op_sel_hi:[1,0]
    v_pk_min_u16 v25, v25, v36
    v_and_b32 v37, 0x7fff7fff, v57
    v_pk_sub_u16 v37, v37, 1 op_sel_hi:[1,0]
    v_pk_min_u16 v25, v25, v37
    v_and_b32 v36, 0x7fff7fff, v58
    v_pk_sub_u16 v36, v36, 1 op_sel_hi:[1,0]
    v_pk_min_u16 v25, v25, v36
    v_and_b32 v37, 0x7fff7fff, v59
    v_pk_sub_u16 v37, v37, 1 op_sel_hi:[1,0]
    v_pk_min_u16 v25, v25, v37
    v_and_b32 v36, 0x7fff7fff, v60
    v_pk_sub_u16 v36, v36, 1 op_sel_hi:[1,0]
    v_pk_min_u16 v25, v25, v36
    v_and_b32 v37, 0x7fff7fff, v61
    v_pk_sub_u16 v37, v37, 1 op_sel_hi:[1,0]
    v_pk_min_u16 v25, v25, v37
    v_and_b32 v36, 0x7fff7fff, v62
    v_pk_sub_u16 v36, v36, 1 op_sel_hi:[1,0]
    v_pk_min_u16 v25, v25, v36
    v_and_b32 v37, 0x7fff7fff, v63
    v_pk_sub_u16 v37, v37, 1 op_sel_hi:[1,0]
    v_pk_min_u16 v25, v25, v37
    v_mov_b32 v36, 0x38ff38ff
    v_pk_sub_u16 v36, v36, v25 clamp
    v_cmp_ne_u32 vcc, 0, v36
    s_or_b32 s62, 15, 0
    s_getpc_b64 s[92:93]
    s_cbranch_vccnz REC_K
    v_and_b32 v26, 0x7fff7fff, v48
    v_pk_sub_u16 v26, v26, s98 clamp
    v_bfi_b32 v48, s79, v26, v48
    v_and_b32 v27, 0x7fff7fff, v49
    v_pk_sub_u16 v27, v27, s98 clamp
    v_bfi_b32 v49, s79, v27, v49
    v_and_b32 v26, 0x7fff7fff, v50
    v_pk_sub_u16 v26, v26, s98 clamp
    v_bfi_b32 v50, s79, v26, v50
    v_and_b32 v27, 0x7fff7fff, v51
    v_pk_sub_u16 v27, v27, s98 clamp
    v_bfi_b32 v51, s79, v27, v51
    v_and_b32 v26, 0x7fff7fff, v52
    v_pk_sub_u16 v26, v26, s98 clamp
    v_bfi_b32 v52, s79, v26, v52
    v_and_b32 v27, 0x7fff7fff, v53
    v_pk_sub_u16 v27, v27, s98 clamp
    v_bfi_b32 v53, s79, v27, v53
    v_and_b32 v26, 0x7fff7fff, v54
    v_pk_sub_u16 v26, v26, s98 clamp
    v_bfi_b32 v54, s79, v26, v54
    v_and_b32 v27, 0x7fff7fff, v55
    v_pk_sub_u16 v27, v27, s98 clamp
    v_bfi_b32 v55, s79, v27, v55
    v_and_b32 v26, 0x7fff7fff, v56
    v_pk_sub_u16 v26, v26, s98 clamp
    v_bfi_b32 v56, s79, v26, v56
    v_and_b32 v27, 0x7fff7fff, v57
    v_pk_sub_u16 v27, v27, s98 clamp
    v_bfi_b32 v57, s79, v27, v57
    v_and_b32 v26, 0x7fff7fff, v58
    v_pk_sub_u16 v26, v26, s98 clamp
    v_bfi_b32 v58, s79, v26, v58
    v_and_b32 v27, 0x7fff7fff, v59
    v_pk_sub_u16 v27, v27, s98 clamp
    v_bfi_b32 v59, s79, v27, v59
    v_and_b32 v26, 0x7fff7fff, v60
    v_pk_sub_u16 v26, v26, s98 clamp
    v_bfi_b32 v60, s79, v26, v60
    v_and_b32 v27, 0x7fff7fff, v61
    v_pk_sub_u16 v27, v27, s98 clamp
    v_bfi_b32 v61, s79, v27, v61
    v_and_b32 v26, 0x7fff7fff, v62
    v_pk_sub_u16 v26, v26, s98 clamp
    v_bfi_b32 v62, s79, v26, v62
    v_and_b32 v27, 0x7fff7fff, v63
    v_pk_sub_u16 v27, v27, s98 clamp
    v_bfi_b32 v63, s79, v27, v63
    v_or3_b32 v24, v24, v48, v49
    v_or3_b32 v24, v24, v50, v51
    v_or3_b32 v24, v24, v52, v53
    v_or3_b32 v24, v24, v54, v55
    v_or3_b32 v24, v24, v56, v57
    v_or3_b32 v24, v24, v58, v59
    v_or3_b32 v24, v24, v60, v61
    v_or3_b32 v24, v24, v62, v63
    v_lshlrev_b32 v36, 11, v60
    v_and_or_b32 v48, v36, s78, v48
    v_lshlrev_b32 v37, 11, v61
    v_and_or_b32 v49, v37, s78, v49
    v_lshlrev_b32 v36, 11, v62
    v_and_or_b32 v50, v36, s78, v50
    v_lshlrev_b32 v37, 11, v63
    v_and_or_b32 v51, v37, s78, v51
    v_lshlrev_b32 v36, 7, v60
    v_and_or_b32 v52, v36, s78, v52
    v_lshlrev_b32 v37, 7, v61
    v_and_or_b32 v53, v37, s78, v53
    v_lshlrev_b32 v36, 7, v62
    v_and_or_b32 v54, v36, s78, v54
    v_lshlrev_b32 v37, 7, v63
    v_and_or_b32 v55, v37, s78, v55
    v_lshlrev_b32 v36, 3, v60
    v_and_or_b32 v56, v36, s78, v56
    v_lshrrev_b32 v37, 1, v60
    v_and_or_b32 v56, v37, s78, v56
    v_lshlrev_b32 v36, 3, v61
    v_and_or_b32 v57, v36, s78, v57
    v_lshrrev_b32 v37, 1, v61
    v_and_or_b32 v57, v37, s78, v57
    v_lshlrev_b32 v36, 3, v62
    v_and_or_b32 v58, v36, s78, v58
    v_lshrrev_b32 v37, 1, v62
    v_and_or_b32 v58, v37, s78, v58
    v_lshlrev_b32 v36, 3, v63
    v_and_or_b32 v59, v36, s78, v59
    v_lshrrev_b32 v37, 1, v63
    v_and_or_b32 v59, v37, s78, v59
    v_lshlrev_b32 v36, 4, v0
    v_add_u32 v36, s59, v36
    ds_write_b128 v36, v[48:51] offset:24064
    ds_write_b128 v36, v[52:55] offset:25088
    ds_write_b128 v36, v[56:59] offset:26112
    v_and_b32 v24, s78, v24
    v_cmp_ne_u32 vcc, 0, v24
    s_cmp_lg_u64 vcc, 0
    s_cselect_b32 s60, 32768, 0
    s_or_b32 s99, s99, s60
    s_waitcnt vmcnt(0)
    s_mov_b32 s64, 200000
QF_22:
    v_cmp_ne_u32 vcc, 4, v29
    s_cbranch_vccz QD_23
    buffer_load_dword v29, v28, s[36:39], 0 offen sc1
    s_waitcnt vmcnt(0)
    s_sub_u32 s64, s64, 1
    s_cmp_lg_u32 s64, 0
    s_cbranch_scc1 QF_22
QD_23:
    v_bfe_u32 v38, v0, 3, 1
    v_lshlrev_b32 v38, 8, v38
    v_lshrrev_b32 v39, 4, v0
    v_lshl_add_u32 v38, v39, 4, v38
    s_lshl_b32 s60, s57, 9
    s_add_u32 s60, s60, 3145728
    buffer_load_dwordx4 v[64:67], v38, s[32:35], s60 offen offset:0 sc1
    buffer_load_dwordx4 v[68:71], v38, s[32:35], s60 offen offset:64 sc1
    buffer_load_dwordx4 v[72:75], v38, s[32:35], s60 offen offset:128 sc1
    buffer_load_dwordx4 v[76:79], v38, s[32:35], s60 offen offset:192 sc1
    s_waitcnt vmcnt(0)
    s_nop 7
    s_nop 1
RJ_13:
    s_nop 7
    s_nop 1
    s_nop 7
    s_nop 1
    s_branch XO_24
REC_K:
    s_nop 7
    s_add_u32 s92, s92, 4
    s_addc_u32 s93, s93, 0
    v_mov_b32 v20, 0x38ff38ff
    v_and_b32 v22, 0x7fff7fff, v48
    v_pk_sub_u16 v22, v22, 1 op_sel_hi:[1,0]
    v_pk_sub_u16 v22, v20, v22 clamp
    v_pk_min_u16 v22, v22, 1 op_sel_hi:[1,0]
    v_and_b32 v33, 0x7fff7fff, v49
    v_pk_sub_u16 v33, v33, 1 op_sel_hi:[1,0]
    v_pk_sub_u16 v33, v20, v33 clamp
    v_pk_min_u16 v33, v33, 1 op_sel_hi:[1,0]
    v_lshl_or_b32 v22, v33, 1, v22
    v_and_b32 v23, 0x7fff7fff, v50
    v_pk_sub_u16 v23, v23, 1 op_sel_hi:[1,0]
    v_pk_sub_u16 v23, v20, v23 clamp
    v_pk_min_u16 v23, v23, 1 op_sel_hi:[1,0]
    v_lshl_or_b32 v22, v23, 2, v22
    v_and_b32 v33, 0x7fff7fff, v51
    v_pk_sub_u16 v33, v33, 1 op_sel_hi:[1,0]
    v_pk_sub_u16 v33, v20, v33 clamp
    v_pk_min_u16 v33, v33, 1 op_sel_hi:[1,0]
    v_lshl_or_b32 v22, v33, 3, v22
    v_and_b32 v23, 0x7fff7fff, v52
    v_pk_sub_u16 v23, v23, 1 op_sel_hi:[1,0]
    v_pk_sub_u16 v23, v20, v23 clamp
    v_pk_min_u16 v23, v23, 1 op_sel_hi:[1,0]
    v_lshl_or_b32 v22, v23, 4, v22
    v_and_b32 v33, 0x7fff7fff, v53
    v_pk_sub_u16 v33, v33, 1 op_sel_hi:[1,0]
    v_pk_sub_u16 v33, v20, v33 clamp
    v_pk_min_u16 v33, v33, 1 op_sel_hi:[1,0]
    v_lshl_or_b32 v22, v33, 5, v22
    v_and_b32 v23, 0x7fff7fff, v54
    v_pk_sub_u16 v23, v23, 1 op_sel_hi:[1,0]
    v_pk_sub_u16 v23, v20, v23 clamp
    v_pk_min_u16 v23, v23, 1 op_sel_hi:[1,0]
    v_lshl_or_b32 v22, v23, 6, v22
    v_and_b32 v33, 0x7fff7fff, v55
    v_pk_sub_u16 v33, v33, 1 op_sel_hi:[1,0]
    v_pk_sub_u16 v33, v20, v33 clamp
    v_pk_min_u16 v33, v33, 1 op_sel_hi:[1,0]
    v_lshl_or_b32 v22, v33, 7, v22
    v_and_b32 v23, 0x7fff7fff, v56
    v_pk_sub_u16 v23, v23, 1 op_sel_hi:[1,0]
    v_pk_sub_u16 v23, v20, v23 clamp
    v_pk_min_u16 v23, v23, 1 op_sel_hi:[1,0]
    v_lshl_or_b32 v22, v23, 8, v22
    v_and_b32 v33, 0x7fff7fff, v57
    v_pk_sub_u16 v33, v33, 1 op_sel_hi:[1,0]
    v_pk_sub_u16 v33, v20, v33 clamp
    v_pk_min_u16 v33, v33, 1 op_sel_hi:[1,0]
    v_lshl_or_b32 v22, v33, 9, v22
    v_and_b32 v23, 0x7fff7fff, v58
    v_pk_sub_u16 v23, v23, 1 op_sel_hi:[1,0]
    v_pk_sub_u16 v23, v20, v23 clamp
    v_pk_min_u16 v23, v23, 1 op_sel_hi:[1,0]
    v_lshl_or_b32 v22, v23, 10, v22
    v_and_b32 v33, 0x7fff7fff, v59
    v_pk_sub_u16 v33, v33, 1 op_sel_hi:[1,0]
    v_pk_sub_u16 v33, v20, v33 clamp
    v_pk_min_u16 v33, v33, 1 op_sel_hi:[1,0]
    v_lshl_or_b32 v22, v33, 11, v22
    v_and_b32 v23, 0x7fff7fff, v60
    v_pk_sub_u16 v23, v23, 1 op_sel_hi:[1,0]
    v_pk_sub_u16 v23, v20, v23 clamp
    v_pk_min_u16 v23, v23, 1 op_sel_hi:[1,0]
    v_lshl_or_b32 v22, v23, 12, v22
    v_and_b32 v33, 0x7fff7fff, v61
    v_pk_sub_u16 v33, v33, 1 op_sel_hi:[1,0]
    v_pk_sub_u16 v33, v20, v33 clamp
    v_pk_min_u16 v33, v33, 1 op_sel_hi:[1,0]
    v_lshl_or_b32 v22, v33, 13, v22
    v_and_b32 v23, 0x7fff7fff, v62
    v_pk_sub_u16 v23, v23, 1 op_sel_hi:[1,0]
    v_pk_sub_u16 v23, v20, v23 clamp
    v_pk_min_u16 v23, v23, 1 op_sel_hi:[1,0]
    v_lshl_or_b32 v22, v23, 14, v22
    v_and_b32 v33, 0x7fff7fff, v63
    v_pk_sub_u16 v33, v33, 1 op_sel_hi:[1,0]
    v_pk_sub_u16 v33, v20, v33 clamp
    v_pk_min_u16 v33, v33, 1 op_sel_hi:[1,0]
    v_lshl_or_b32 v22, v33, 15, v22
    v_cmp_ne_u32 vcc, 0, v22
    s_nop 4
RCL_25:
    s_cmp_eq_u64 vcc, 0
    s_cbranch_scc1 RCE_27
    s_ff1_i32_b64 s64, vcc
    s_bitset0_b64 vcc, s64
    s_nop 3
    v_readlane_b32 s65, v22, s64
    s_nop 3
RCB_26:
    s_ff1_i32_b32 s61, s65
    s_bitset0_b32 s65, s61
    s_and_b32 s60, s61, 15
    s_set_gpr_idx_on s60, 0x1
    s_nop 1
    v_mov_b32 v21, v48
    s_set_gpr_idx_off
    s_nop 1
    v_readlane_b32 s54, v21, s64
    s_nop 3
    s_lshl_b32 s60, s60, 6
    s_and_b32 s62, s62, 63
    s_or_b32 s62, s62, s60
    s_and_b32 s60, s61, 16
    s_xor_b32 s60, s60, 16
    s_lshl_b32 s54, s54, s60
    s_and_b32 s54, s54, 0xffff0000
    s_lshl_b32 s60, s64, 10
    s_or_b32 s54, s54, s60
    s_and_b32 s60, s62, 0x3c0
    s_or_b32 s54, s54, s60
    s_and_b32 s62, s62, 63
    s_lshr_b32 s60, s61, 4
    s_lshl_b32 s60, s60, 5
    s_or_b32 s54, s54, s60
    s_lshr_b32 s60, s99, 24
    s_cmp_ge_u32 s60, 63
    s_cbranch_scc1 RCF_28
    s_lshl_b32 s60, s60, 3
    s_add_u32 s60, s60, s59
    v_mov_b32 v32, s60
    v_mov_b32 v34, s62
    v_mov_b32 v35, s54
    s_mov_b64 exec, 1
    ds_write_b64 v32, v[34:35] offset:8192
    s_mov_b64 exec, -1
    s_add_u32 s99, s99, 16777216
    s_and_b32 s60, s62, 31
    s_bitset1_b32 s96, s60
    s_branch RCN_29
RCF_28:
    s_and_b32 s60, s62, 31
    s_bitset1_b32 s99, s60
RCN_29:
    s_cmp_lg_u32 s65, 0
    s_cbranch_scc1 RCB_26
    s_branch RCL_25
RCE_27:
    s_waitcnt lgkmcnt(0)
    s_nop 7
    s_nop 1
    s_setpc_b64 s[92:93]
REC_V:
    s_nop 7
    s_add_u32 s92, s92, 4
    s_addc_u32 s93, s93, 0
    v_mov_b32 v20, 0x397f397f
    v_and_b32 v22, 0x7fff7fff, v64
    v_pk_sub_u16 v22, v22, 1 op_sel_hi:[1,0]
    v_pk_sub_u16 v22, v20, v22 clamp
    v_pk_min_u16 v22, v22, 1 op_sel_hi:[1,0]
    v_and_b32 v33, 0x7fff7fff, v65
    v_pk_sub_u16 v33, v33, 1 op_sel_hi:[1,0]
    v_pk_sub_u16 v33, v20, v33 clamp
    v_pk_min_u16 v33, v33, 1 op_sel_hi:[1,0]
    v_lshl_or_b32 v22, v33, 1, v22
    v_and_b32 v23, 0x7fff7fff, v66
    v_pk_sub_u16 v23, v23, 1 op_sel_hi:[1,0]
    v_pk_sub_u16 v23, v20, v23 clamp
    v_pk_min_u16 v23, v23, 1 op_sel_hi:[1,0]
    v_lshl_or_b32 v22, v23, 2, v22
    v_and_b32 v33, 0x7fff7fff, v67
    v_pk_sub_u16 v33, v33, 1 op_sel_hi:[1,0]
    v_pk_sub_u16 v33, v20, v33 clamp
    v_pk_min_u16 v33, v33, 1 op_sel_hi:[1,0]
    v_lshl_or_b32 v22, v33, 3, v22
    v_and_b32 v23, 0x7fff7fff, v68
    v_pk_sub_u16 v23, v23, 1 op_sel_hi:[1,0]
    v_pk_sub_u16 v23, v20, v23 clamp
    v_pk_min_u16 v23, v23, 1 op_sel_hi:[1,0]
    v_lshl_or_b32 v22, v23, 4, v22
    v_and_b32 v33, 0x7fff7fff, v69
    v_pk_sub_u16 v33, v33, 1 op_sel_hi:[1,0]
    v_pk_sub_u16 v33, v20, v33 clamp
    v_pk_min_u16 v33, v33, 1 op_sel_hi:[1,0]
    v_lshl_or_b32 v22, v33, 5, v22
    v_and_b32 v23, 0x7fff7fff, v70
    v_pk_sub_u16 v23, v23, 1 op_sel_hi:[1,0]
    v_pk_sub_u16 v23, v20, v23 clamp
    v_pk_min_u16 v23, v23, 1 op_sel_hi:[1,0]
    v_lshl_or_b32 v22, v23, 6, v22
    v_and_b32 v33, 0x7fff7fff, v71
    v_pk_sub_u16 v33, v33, 1 op_sel_hi:[1,0]
    v_pk_sub_u16 v33, v20, v33 clamp
    v_pk_min_u16 v33, v33, 1 op_sel_hi:[1,0]
    v_lshl_or_b32 v22, v33, 7, v22
    v_and_b32 v23, 0x7fff7fff, v72
    v_pk_sub_u16 v23, v23, 1 op_sel_hi:[1,0]
    v_pk_sub_u16 v23, v20, v23 clamp
    v_pk_min_u16 v23, v23, 1 op_sel_hi:[1,0]
    v_lshl_or_b32 v22, v23, 8, v22
    v_and_b32 v33, 0x7fff7fff, v73
    v_pk_sub_u16 v33, v33, 1 op_sel_hi:[1,0]
    v_pk_sub_u16 v33, v20, v33 clamp
    v_pk_min_u16 v33, v33, 1 op_sel_hi:[1,0]
    v_lshl_or_b32 v22, v33, 9, v22
    v_and_b32 v23, 0x7fff7fff, v74
    v_pk_sub_u16 v23, v23, 1 op_sel_hi:[1,0]
    v_pk_sub_u16 v23, v20, v23 clamp
    v_pk_min_u16 v23, v23, 1 op_sel_hi:[1,0]
    v_lshl_or_b32 v22, v23, 10, v22
    v_and_b32 v33, 0x7fff7fff, v75
    v_pk_sub_u16 v33, v33, 1 op_sel_hi:[1,0]
    v_pk_sub_u16 v33, v20, v33 clamp
    v_pk_min_u16 v33, v33, 1 op_sel_hi:[1,0]
    v_lshl_or_b32 v22, v33, 11, v22
    v_and_b32 v23, 0x7fff7fff, v76
    v_pk_sub_u16 v23, v23, 1 op_sel_hi:[1,0]
    v_pk_sub_u16 v23, v20, v23 clamp
    v_pk_min_u16 v23, v23, 1 op_sel_hi:[1,0]
    v_lshl_or_b32 v22, v23, 12, v22
    v_and_b32 v33, 0x7fff7fff, v77
    v_pk_sub_u16 v33, v33, 1 op_sel_hi:[1,0]
    v_pk_sub_u16 v33, v20, v33 clamp
    v_pk_min_u16 v33, v33, 1 op_sel_hi:[1,0]
    v_lshl_or_b32 v22, v33, 13, v22
    v_and_b32 v23, 0x7fff7fff, v78
    v_pk_sub_u16 v23, v23, 1 op_sel_hi:[1,0]
    v_pk_sub_u16 v23, v20, v23 clamp
    v_pk_min_u16 v23, v23, 1 op_sel_hi:[1,0]
    v_lshl_or_b32 v22, v23, 14, v22
    v_and_b32 v33, 0x7fff7fff, v79
    v_pk_sub_u16 v33, v33, 1 op_sel_hi:[1,0]
    v_pk_sub_u16 v33, v20, v33 clamp
    v_pk_min_u16 v33, v33, 1 op_sel_hi:[1,0]
    v_lshl_or_b32 v22, v33, 15, v22
    v_cmp_ne_u32 vcc, 0, v22
    s_nop 4
RCL_30:
    s_cmp_eq_u64 vcc, 0
    s_cbranch_scc1 RCE_32
    s_ff1_i32_b64 s64, vcc
    s_bitset0_b64 vcc, s64
    s_nop 3
    v_readlane_b32 s65, v22, s64
    s_nop 3
RCB_31:
    s_ff1_i32_b32 s61, s65
    s_bitset0_b32 s65, s61
    s_and_b32 s60, s61, 15
    s_set_gpr_idx_on s60, 0x1
    s_nop 1
    v_mov_b32 v21, v64
    s_set_gpr_idx_off
    s_nop 1
    v_readlane_b32 s54, v21, s64
    s_nop 3
    s_lshl_b32 s60, s60, 6
    s_and_b32 s62, s62, 63
    s_or_b32 s62, s62, s60
    s_and_b32 s60, s61, 16
    s_xor_b32 s60, s60, 16
    s_lshl_b32 s54, s54, s60
    s_and_b32 s54, s54, 0xffff0000
    s_lshl_b32 s60, s64, 10
    s_or_b32 s54, s54, s60
    s_and_b32 s60, s62, 0x3c0
    s_or_b32 s54, s54, s60
    s_and_b32 s62, s62, 63
    s_lshr_b32 s60, s61, 4
    s_lshl_b32 s60, s60, 5
    s_or_b32 s54, s54, s60
    s_lshr_b32 s60, s99, 24
    s_cmp_ge_u32 s60, 63
    s_cbranch_scc1 RCF_33
    s_lshl_b32 s60, s60, 3
    s_add_u32 s60, s60, s59
    v_mov_b32 v32, s60
    v_mov_b32 v34, s62
    v_mov_b32 v35, s54
    s_mov_b64 exec, 1
    ds_write_b64 v32, v[34:35] offset:8192
    s_mov_b64 exec, -1
    s_add_u32 s99, s99, 16777216
    s_and_b32 s60, s62, 31
    s_bitset1_b32 s97, s60
    s_branch RCN_34
RCF_33:
    s_and_b32 s60, s62, 31
    s_bitset1_b32 s99, s60
RCN_34:
    s_cmp_lg_u32 s65, 0
    s_cbranch_scc1 RCB_31
    s_branch RCL_30
RCE_32:
    s_waitcnt lgkmcnt(0)
    s_nop 7
    s_nop 1
    s_setpc_b64 s[92:93]
    s_nop 7
    s_nop 1
PATCH_K:
    s_nop 7
    s_add_u32 s92, s92, 4
    s_addc_u32 s93, s93, 0
    v_lshlrev_b32 v30, 3, v0
    v_add_u32 v30, s59, v30
    ds_read_b64 v[28:29], v30 offset:8192
    s_lshr_b32 s60, s99, 24
    s_waitcnt lgkmcnt(0)
    v_cmp_gt_u32 vcc, s60, v0
    s_nop 1
    v_cndmask_b32 v28, -1, v28, vcc
    v_cmp_eq_u32 vcc, s62, v28
    s_nop 4
PTB_35:
    s_cmp_eq_u64 vcc, 0
    s_cbranch_scc1 PTE_36
    s_ff1_i32_b64 s61, vcc
    s_bitset0_b64 vcc, s61
    s_nop 3
    v_readlane_b32 s60, v29, s61
    s_nop 3
    s_bfe_u32 s61, s60, 0x6000a
    s_bfe_u32 s54, s60, 0x40006
    s_bfe_u32 s64, s60, 0x10005
    s_and_b32 s94, s61, 48
    v_and_b32 v30, 15, v0
    v_add_u32 v30, s94, v30
    v_lshlrev_b32 v30, 2, v30
    s_set_gpr_idx_on s54, 0x1
    s_nop 1
    v_mov_b32 v31, v64
    s_set_gpr_idx_off
    s_nop 1
    ds_bpermute_b32 v31, v30, v31
    s_and_b32 s60, s60, 0xffff0000
    s_waitcnt lgkmcnt(0)
    s_lshl_b32 s94, s64, 4
    s_sub_u32 s94, 16, s94
    v_lshlrev_b32 v31, s94, v31
    v_and_b32 v31, 0xffff0000, v31
    v_mul_f32 v31, s60, v31
    v_mul_f32 v31, 0x07000000, v31
    s_and_b32 s61, s61, 15
    s_lshr_b32 s94, s61, 2
    s_lshl_b32 s94, s94, 4
    s_mov_b32 exec_lo, 0xffff
    s_mov_b32 exec_hi, 0
    s_lshl_b64 exec, exec, s94
    s_and_b32 s61, s61, 3
    s_set_gpr_idx_on s61, 0x9
    s_nop 1
    v_add_f32 v24, v24, v31
    s_set_gpr_idx_off
    s_mov_b64 exec, -1
    s_nop 1
    s_branch PTB_35
PTE_36:
    s_nop 7
    s_nop 1
    s_setpc_b64 s[92:93]
PATCH_V:
    s_nop 7
    s_add_u32 s92, s92, 4
    s_addc_u32 s93, s93, 0
    v_lshlrev_b32 v30, 3, v0
    v_add_u32 v30, s59, v30
    ds_read_b64 v[28:29], v30 offset:8192
    s_lshr_b32 s60, s99, 24
    s_waitcnt lgkmcnt(0)
    v_cmp_gt_u32 vcc, s60, v0
    s_nop 1
    v_cndmask_b32 v28, -1, v28, vcc
    v_cmp_eq_u32 vcc, s62, v28
    s_nop 4
PTB_37:
    s_cmp_eq_u64 vcc, 0
    s_cbranch_scc1 PTE_38
    s_ff1_i32_b64 s61, vcc
    s_bitset0_b64 vcc, s61
    s_nop 3
    v_readlane_b32 s60, v29, s61
    s_nop 3
    s_bfe_u32 s61, s60, 0x6000a
    s_bfe_u32 s54, s60, 0x40006
    s_bfe_u32 s64, s60, 0x10005
    s_and_b32 s94, s61, 48
    v_and_b32 v30, 15, v0
    v_add_u32 v30, s94, v30
    v_lshlrev_b32 v30, 2, v30
    s_lshr_b32 s94, s54, 2
    s_set_gpr_idx_on s94, 0x1
    s_nop 1
    v_mov_b32 v31, v32
    s_set_gpr_idx_off
    s_nop 1
    ds_bpermute_b32 v31, v30, v31
    s_and_b32 s60, s60, 0xffff0000
    s_waitcnt lgkmcnt(0)
    v_and_b32 v31, 0xffff0000, v31
    v_mul_f32 v31, s60, v31
    v_mul_f32 v31, 0x06800000, v31
    s_and_b32 s61, s61, 15
    s_lshr_b32 s94, s61, 2
    s_lshl_b32 s94, s94, 4
    s_and_b32 s54, s54, 3
    s_lshl_b32 s54, s54, 1
    s_add_u32 s54, s54, s64
    s_add_u32 s94, s94, s54
    s_mov_b32 exec_lo, 0x101
    s_mov_b32 exec_hi, 0
    s_lshl_b64 exec, exec, s94
    s_and_b32 s61, s61, 3
    s_set_gpr_idx_on s61, 0x9
    s_nop 1
    v_add_f32 v20, v20, v31
    s_set_gpr_idx_off
    s_mov_b64 exec, -1
    s_nop 1
    s_branch PTB_37
PTE_38:
    s_nop 7
    s_nop 1
    s_setpc_b64 s[92:93]
    s_nop 7
    s_nop 1
XO_24:
L_pass:
    v_mov_b32 v17, 0x7f61b1e6
    v_mov_b32 v18, 0
    v_mov_b32 v19, 0
    v_mov_b32 v20, 0
    v_mov_b32 v21, 0
    v_mov_b32 v22, 0
    v_mov_b32 v23, 0
    v_cmp_eq_u32 vcc, 0, v0
    v_mov_b32 v43, 0x40000000
    s_nop 0
    v_cndmask_b32 v43, v43, 0, vcc
    s_lshl_b32 s65, s83, 4
    s_add_u32 s65, s65, s57
    s_lshl_b32 s65, s65, 2
    s_add_u32 s65, s65, s3
    s_lshl_b32 s65, s65, 8
    s_add_u32 s65, s65, 3211264
    s_waitcnt vmcnt(12)
    ds_read_b128 v[48:51], v9 offset:0
    ds_read_b128 v[52:55], v10 offset:0
    ds_read_b128 v[56:59], v11 offset:0
    ds_read_b128 v[60:63], v12 offset:0
    s_waitcnt lgkmcnt(3)
    v_mfma_f32_16x16x32_bf16 v[24:27], v[48:51], v[64:67], 0
    s_waitcnt lgkmcnt(2)
    v_mfma_f32_16x16x32_bf16 v[24:27], v[52:55], v[68:71], v[24:27]
    s_waitcnt lgkmcnt(1)
    v_mfma_f32_16x16x32_bf16 v[24:27], v[56:59], v[72:75], v[24:27]
    s_waitcnt lgkmcnt(0)
    v_mfma_f32_16x16x32_bf16 v[24:27], v[60:63], v[76:79], v[24:27]
    s_nop 7
    v_fma_f32 v28, v24, s55, v17
    v_fma_f32 v29, v25, s55, v17
    v_fma_f32 v30, v26, s55, v17
    v_fma_f32 v31, v27, s55, v17
    v_max3_f32 v36, v28, v29, v30
    v_max_f32 v36, v36, v31
    v_cmp_lt_f32 vcc, s56, v36
    s_cbranch_vccnz RS_39
RB_40:
    v_exp_f32 v28, v28
    v_exp_f32 v29, v29
    v_exp_f32 v30, v30
    v_exp_f32 v31, v31
    v_cvt_pk_bf16_f32 v32, v28, v28
    v_add_f32 v18, v18, v28
    v_cvt_pk_bf16_f32 v33, v29, v29
    v_add_f32 v19, v19, v29
    v_cvt_pk_bf16_f32 v34, v30, v30
    v_add_f32 v18, v18, v30
    v_cvt_pk_bf16_f32 v35, v31, v31
    v_add_f32 v19, v19, v31
    s_waitcnt vmcnt(8)
    v_and_b32 v48, v32, v13
    v_and_b32 v49, v32, v14
    v_and_b32 v50, v32, v15
    v_and_b32 v51, v32, v16
    v_and_b32 v52, v33, v13
    v_and_b32 v53, v33, v14
    v_and_b32 v54, v33, v15
    v_and_b32 v55, v33, v16
    v_mfma_f32_16x16x32_bf16 v[20:23], a[0:3], v[48:51], v[20:23]
    v_and_b32 v56, v34, v13
    v_and_b32 v57, v34, v14
    v_and_b32 v58, v34, v15
    v_and_b32 v59, v34, v16
    v_mfma_f32_16x16x32_bf16 v[20:23], a[4:7], v[52:55], v[20:23]
    v_and_b32 v60, v35, v13
    v_and_b32 v61, v35, v14
    v_and_b32 v62, v35, v15
    v_and_b32 v63, v35, v16
    v_mfma_f32_16x16x32_bf16 v[20:23], a[8:11], v[56:59], v[20:23]
    s_nop 0
    v_mfma_f32_16x16x32_bf16 v[20:23], a[12:15], v[60:63], v[20:23]
    s_cmp_eq_u32 s83, 0
    s_cbranch_scc0 ML_41
    s_add_u32 s76, s90, 560
    s_mul_i32 s54, s76, s85
    s_add_u32 s54, s54, s53
    s_add_u32 m0, s59, 0
    s_nop 0
    buffer_load_dwordx4 v4, s[4:7], s54 offen offset:0 nt lds
    buffer_load_dwordx4 v5, s[4:7], s54 offen offset:1024 nt lds
    buffer_load_dwordx4 v6, s[4:7], s54 offen offset:2048 nt lds
    buffer_load_dwordx4 v7, s[4:7], s54 offen offset:3072 nt lds
    buffer_load_dwordx4 a[0:3], v8, s[8:11], s54 offen offset:0 nt
    buffer_load_dwordx4 a[4:7], v8, s[8:11], s54 offen offset:256 nt
    buffer_load_dwordx4 a[8:11], v8, s[8:11], s54 offen offset:512 nt
    buffer_load_dwordx4 a[12:15], v8, s[8:11], s54 offen offset:768 nt
    s_branch MJ_42
ML_41:
    s_add_u32 s76, s90, 32
    s_mul_i32 s54, s76, s85
    s_add_u32 s54, s54, s53
    s_add_u32 m0, s59, 0
    s_nop 0
    buffer_load_dwordx4 v4, s[4:7], s54 offen offset:0 lds
    buffer_load_dwordx4 v5, s[4:7], s54 offen offset:1024 lds
    buffer_load_dwordx4 v6, s[4:7], s54 offen offset:2048 lds
    buffer_load_dwordx4 v7, s[4:7], s54 offen offset:3072 lds
    buffer_load_dwordx4 a[0:3], v8, s[8:11], s54 offen offset:0
    buffer_load_dwordx4 a[4:7], v8, s[8:11], s54 offen offset:256
    buffer_load_dwordx4 a[8:11], v8, s[8:11], s54 offen offset:512
    buffer_load_dwordx4 a[12:15], v8, s[8:11], s54 offen offset:768
MJ_42:
    s_waitcnt vmcnt(12)
    ds_read_b128 v[48:51], v9 offset:4096
    ds_read_b128 v[52:55], v10 offset:4096
    ds_read_b128 v[56:59], v11 offset:4096
    ds_read_b128 v[60:63], v12 offset:4096
    s_waitcnt lgkmcnt(3)
    v_mfma_f32_16x16x32_bf16 v[24:27], v[48:51], v[64:67], 0
    s_waitcnt lgkmcnt(2)
    v_mfma_f32_16x16x32_bf16 v[24:27], v[52:55], v[68:71], v[24:27]
    s_waitcnt lgkmcnt(1)
    v_mfma_f32_16x16x32_bf16 v[24:27], v[56:59], v[72:75], v[24:27]
    s_waitcnt lgkmcnt(0)
    v_mfma_f32_16x16x32_bf16 v[24:27], v[60:63], v[76:79], v[24:27]
    s_nop 7
    v_fma_f32 v28, v24, s55, v17
    v_fma_f32 v29, v25, s55, v17
    v_fma_f32 v30, v26, s55, v17
    v_fma_f32 v31, v27, s55, v17
    v_max3_f32 v36, v28, v29, v30
    v_max_f32 v36, v36, v31
    v_cmp_lt_f32 vcc, s56, v36
    s_cbranch_vccnz RS_43
RB_44:
    v_exp_f32 v28, v28
    v_exp_f32 v29, v29
    v_exp_f32 v30, v30
    v_exp_f32 v31, v31
    v_cvt_pk_bf16_f32 v32, v28, v28
    v_add_f32 v18, v18, v28
    v_cvt_pk_bf16_f32 v33, v29, v29
    v_add_f32 v19, v19, v29
    v_cvt_pk_bf16_f32 v34, v30, v30
    v_add_f32 v18, v18, v30
    v_cvt_pk_bf16_f32 v35, v31, v31
    v_add_f32 v19, v19, v31
    s_waitcnt vmcnt(8)
    v_and_b32 v48, v32, v13
    v_and_b32 v49, v32, v14
    v_and_b32 v50, v32, v15
    v_and_b32 v51, v32, v16
    v_and_b32 v52, v33, v13
    v_and_b32 v53, v33, v14
    v_and_b32 v54, v33, v15
    v_and_b32 v55, v33, v16
    v_mfma_f32_16x16x32_bf16 v[20:23], a[16:19], v[48:51], v[20:23]
    v_and_b32 v56, v34, v13
    v_and_b32 v57, v34, v14
    v_and_b32 v58, v34, v15
    v_and_b32 v59, v34, v16
    v_mfma_f32_16x16x32_bf16 v[20:23], a[20:23], v[52:55], v[20:23]
    v_and_b32 v60, v35, v13
    v_and_b32 v61, v35, v14
    v_and_b32 v62, v35, v15
    v_and_b32 v63, v35, v16
    v_mfma_f32_16x16x32_bf16 v[20:23], a[24:27], v[56:59], v[20:23]
    s_nop 0
    v_mfma_f32_16x16x32_bf16 v[20:23], a[28:31], v[60:63], v[20:23]
    s_cmp_eq_u32 s83, 0
    s_cbranch_scc0 ML_45
    s_add_u32 s77, s90, 576
    s_mul_i32 s54, s77, s85
    s_add_u32 s54, s54, s53
    s_add_u32 m0, s59, 4096
    s_nop 0
    buffer_load_dwordx4 v4, s[4:7], s54 offen offset:0 nt lds
    buffer_load_dwordx4 v5, s[4:7], s54 offen offset:1024 nt lds
    buffer_load_dwordx4 v6, s[4:7], s54 offen offset:2048 nt lds
    buffer_load_dwordx4 v7, s[4:7], s54 offen offset:3072 nt lds
    buffer_load_dwordx4 a[16:19], v8, s[8:11], s54 offen offset:0 nt
    buffer_load_dwordx4 a[20:23], v8, s[8:11], s54 offen offset:256 nt
    buffer_load_dwordx4 a[24:27], v8, s[8:11], s54 offen offset:512 nt
    buffer_load_dwordx4 a[28:31], v8, s[8:11], s54 offen offset:768 nt
    s_branch MJ_46
ML_45:
    s_add_u32 s77, s90, 48
    s_mul_i32 s54, s77, s85
    s_add_u32 s54, s54, s53
    s_add_u32 m0, s59, 4096
    s_nop 0
    buffer_load_dwordx4 v4, s[4:7], s54 offen offset:0 lds
    buffer_load_dwordx4 v5, s[4:7], s54 offen offset:1024 lds
    buffer_load_dwordx4 v6, s[4:7], s54 offen offset:2048 lds
    buffer_load_dwordx4 v7, s[4:7], s54 offen offset:3072 lds
    buffer_load_dwordx4 a[16:19], v8, s[8:11], s54 offen offset:0
    buffer_load_dwordx4 a[20:23], v8, s[8:11], s54 offen offset:256
    buffer_load_dwordx4 a[24:27], v8, s[8:11], s54 offen offset:512
    buffer_load_dwordx4 a[28:31], v8, s[8:11], s54 offen offset:768
MJ_46:
    s_waitcnt vmcnt(12)
    ds_read_b128 v[48:51], v9 offset:0
    ds_read_b128 v[52:55], v10 offset:0
    ds_read_b128 v[56:59], v11 offset:0
    ds_read_b128 v[60:63], v12 offset:0
    s_waitcnt lgkmcnt(3)
    v_mfma_f32_16x16x32_bf16 v[24:27], v[48:51], v[64:67], 0
    s_waitcnt lgkmcnt(2)
    v_mfma_f32_16x16x32_bf16 v[24:27], v[52:55], v[68:71], v[24:27]
    s_waitcnt lgkmcnt(1)
    v_mfma_f32_16x16x32_bf16 v[24:27], v[56:59], v[72:75], v[24:27]
    s_waitcnt lgkmcnt(0)
    v_mfma_f32_16x16x32_bf16 v[24:27], v[60:63], v[76:79], v[24:27]
    s_nop 7
    v_fma_f32 v28, v24, s55, v17
    v_fma_f32 v29, v25, s55, v17
    v_fma_f32 v30, v26, s55, v17
    v_fma_f32 v31, v27, s55, v17
    v_max3_f32 v36, v28, v29, v30
    v_max_f32 v36, v36, v31
    v_cmp_lt_f32 vcc, s56, v36
    s_cbranch_vccnz RS_47
RB_48:
    v_exp_f32 v28, v28
    v_exp_f32 v29, v29
    v_exp_f32 v30, v30
    v_exp_f32 v31, v31
    v_cvt_pk_bf16_f32 v32, v28, v28
    v_add_f32 v18, v18, v28
    v_cvt_pk_bf16_f32 v33, v29, v29
    v_add_f32 v19, v19, v29
    v_cvt_pk_bf16_f32 v34, v30, v30
    v_add_f32 v18, v18, v30
    v_cvt_pk_bf16_f32 v35, v31, v31
    v_add_f32 v19, v19, v31
    s_waitcnt vmcnt(8)
    v_and_b32 v48, v32, v13
    v_and_b32 v49, v32, v14
    v_and_b32 v50, v32, v15
    v_and_b32 v51, v32, v16
    v_and_b32 v52, v33, v13
    v_and_b32 v53, v33, v14
    v_and_b32 v54, v33, v15
    v_and_b32 v55, v33, v16
    v_mfma_f32_16x16x32_bf16 v[20:23], a[0:3], v[48:51], v[20:23]
    v_and_b32 v56, v34, v13
    v_and_b32 v57, v34, v14
    v_and_b32 v58, v34, v15
    v_and_b32 v59, v34, v16
    v_mfma_f32_16x16x32_bf16 v[20:23], a[4:7], v[52:55], v[20:23]
    v_and_b32 v60, v35, v13
    v_and_b32 v61, v35, v14
    v_and_b32 v62, v35, v15
    v_and_b32 v63, v35, v16
    v_mfma_f32_16x16x32_bf16 v[20:23], a[8:11], v[56:59], v[20:23]
    s_nop 0
    v_mfma_f32_16x16x32_bf16 v[20:23], a[12:15], v[60:63], v[20:23]
    s_cmp_eq_u32 s83, 0
    s_cbranch_scc0 ML_49
    s_add_u32 s76, s90, 592
    s_mul_i32 s54, s76, s85
    s_add_u32 s54, s54, s53
    s_add_u32 m0, s59, 0
    s_nop 0
    buffer_load_dwordx4 v4, s[4:7], s54 offen offset:0 sc1 lds
    buffer_load_dwordx4 v5, s[4:7], s54 offen offset:1024 sc1 lds
    buffer_load_dwordx4 v6, s[4:7], s54 offen offset:2048 sc1 lds
    buffer_load_dwordx4 v7, s[4:7], s54 offen offset:3072 sc1 lds
    buffer_load_dwordx4 a[0:3], v8, s[8:11], s54 offen offset:0 sc1
    buffer_load_dwordx4 a[4:7], v8, s[8:11], s54 offen offset:256 sc1
    buffer_load_dwordx4 a[8:11], v8, s[8:11], s54 offen offset:512 sc1
    buffer_load_dwordx4 a[12:15], v8, s[8:11], s54 offen offset:768 sc1
    s_branch MJ_50
ML_49:
    s_add_u32 s76, s90, 64
    s_mul_i32 s54, s76, s85
    s_add_u32 s54, s54, s53
    s_add_u32 m0, s59, 0
    s_nop 0
    buffer_load_dwordx4 v4, s[4:7], s54 offen offset:0 lds
    buffer_load_dwordx4 v5, s[4:7], s54 offen offset:1024 lds
    buffer_load_dwordx4 v6, s[4:7], s54 offen offset:2048 lds
    buffer_load_dwordx4 v7, s[4:7], s54 offen offset:3072 lds
    buffer_load_dwordx4 a[0:3], v8, s[8:11], s54 offen offset:0
    buffer_load_dwordx4 a[4:7], v8, s[8:11], s54 offen offset:256
    buffer_load_dwordx4 a[8:11], v8, s[8:11], s54 offen offset:512
    buffer_load_dwordx4 a[12:15], v8, s[8:11], s54 offen offset:768
MJ_50:
    s_waitcnt vmcnt(12)
    ds_read_b128 v[48:51], v9 offset:4096
    ds_read_b128 v[52:55], v10 offset:4096
    ds_read_b128 v[56:59], v11 offset:4096
    ds_read_b128 v[60:63], v12 offset:4096
    s_waitcnt lgkmcnt(3)
    v_mfma_f32_16x16x32_bf16 v[24:27], v[48:51], v[64:67], 0
    s_waitcnt lgkmcnt(2)
    v_mfma_f32_16x16x32_bf16 v[24:27], v[52:55], v[68:71], v[24:27]
    s_waitcnt lgkmcnt(1)
    v_mfma_f32_16x16x32_bf16 v[24:27], v[56:59], v[72:75], v[24:27]
    s_waitcnt lgkmcnt(0)
    v_mfma_f32_16x16x32_bf16 v[24:27], v[60:63], v[76:79], v[24:27]
    s_nop 7
    v_fma_f32 v28, v24, s55, v17
    v_fma_f32 v29, v25, s55, v17
    v_fma_f32 v30, v26, s55, v17
    v_fma_f32 v31, v27, s55, v17
    v_max3_f32 v36, v28, v29, v30
    v_max_f32 v36, v36, v31
    v_cmp_lt_f32 vcc, s56, v36
    s_cbranch_vccnz RS_51
RB_52:
    v_exp_f32 v28, v28
    v_exp_f32 v29, v29
    v_exp_f32 v30, v30
    v_exp_f32 v31, v31
    v_cvt_pk_bf16_f32 v32, v28, v28
    v_add_f32 v18, v18, v28
    v_cvt_pk_bf16_f32 v33, v29, v29
    v_add_f32 v19, v19, v29
    v_cvt_pk_bf16_f32 v34, v30, v30
    v_add_f32 v18, v18, v30
    v_cvt_pk_bf16_f32 v35, v31, v31
    v_add_f32 v19, v19, v31
    s_waitcnt vmcnt(8)
    v_and_b32 v48, v32, v13
    v_and_b32 v49, v32, v14
    v_and_b32 v50, v32, v15
    v_and_b32 v51, v32, v16
    v_and_b32 v52, v33, v13
    v_and_b32 v53, v33, v14
    v_and_b32 v54, v33, v15
    v_and_b32 v55, v33, v16
    v_mfma_f32_16x16x32_bf16 v[20:23], a[16:19], v[48:51], v[20:23]
    v_and_b32 v56, v34, v13
    v_and_b32 v57, v34, v14
    v_and_b32 v58, v34, v15
    v_and_b32 v59, v34, v16
    v_mfma_f32_16x16x32_bf16 v[20:23], a[20:23], v[52:55], v[20:23]
    v_and_b32 v60, v35, v13
    v_and_b32 v61, v35, v14
    v_and_b32 v62, v35, v15
    v_and_b32 v63, v35, v16
    v_mfma_f32_16x16x32_bf16 v[20:23], a[24:27], v[56:59], v[20:23]
    s_nop 0
    v_mfma_f32_16x16x32_bf16 v[20:23], a[28:31], v[60:63], v[20:23]
    s_add_u32 s77, s90, 80
    s_mul_i32 s54, s77, s85
    s_add_u32 s54, s54, s53
    s_add_u32 m0, s59, 4096
    s_nop 0
    buffer_load_dwordx4 v4, s[4:7], s54 offen offset:0 nt lds
    buffer_load_dwordx4 v5, s[4:7], s54 offen offset:1024 nt lds
    buffer_load_dwordx4 v6, s[4:7], s54 offen offset:2048 nt lds
    buffer_load_dwordx4 v7, s[4:7], s54 offen offset:3072 nt lds
    buffer_load_dwordx4 a[16:19], v8, s[8:11], s54 offen offset:0 nt
    buffer_load_dwordx4 a[20:23], v8, s[8:11], s54 offen offset:256 nt
    buffer_load_dwordx4 a[24:27], v8, s[8:11], s54 offen offset:512 nt
    buffer_load_dwordx4 a[28:31], v8, s[8:11], s54 offen offset:768 nt
    s_waitcnt vmcnt(12)
    ds_read_b128 v[48:51], v9 offset:0
    ds_read_b128 v[52:55], v10 offset:0
    ds_read_b128 v[56:59], v11 offset:0
    ds_read_b128 v[60:63], v12 offset:0
    s_waitcnt lgkmcnt(3)
    v_mfma_f32_16x16x32_bf16 v[24:27], v[48:51], v[64:67], 0
    s_waitcnt lgkmcnt(2)
    v_mfma_f32_16x16x32_bf16 v[24:27], v[52:55], v[68:71], v[24:27]
    s_waitcnt lgkmcnt(1)
    v_mfma_f32_16x16x32_bf16 v[24:27], v[56:59], v[72:75], v[24:27]
    s_waitcnt lgkmcnt(0)
    v_mfma_f32_16x16x32_bf16 v[24:27], v[60:63], v[76:79], v[24:27]
    s_nop 7
    v_fma_f32 v28, v24, s55, v17
    v_fma_f32 v29, v25, s55, v17
    v_fma_f32 v30, v26, s55, v17
    v_fma_f32 v31, v27, s55, v17
    v_max3_f32 v36, v28, v29, v30
    v_max_f32 v36, v36, v31
    v_cmp_lt_f32 vcc, s56, v36
    s_cbranch_vccnz RS_53
RB_54:
    v_exp_f32 v28, v28
    v_exp_f32 v29, v29
    v_exp_f32 v30, v30
    v_exp_f32 v31, v31
    v_cvt_pk_bf16_f32 v32, v28, v28
    v_add_f32 v18, v18, v28
    v_cvt_pk_bf16_f32 v33, v29, v29
    v_add_f32 v19, v19, v29
    v_cvt_pk_bf16_f32 v34, v30, v30
    v_add_f32 v18, v18, v30
    v_cvt_pk_bf16_f32 v35, v31, v31
    v_add_f32 v19, v19, v31
    s_waitcnt vmcnt(8)
    v_and_b32 v48, v32, v13
    v_and_b32 v49, v32, v14
    v_and_b32 v50, v32, v15
    v_and_b32 v51, v32, v16
    v_and_b32 v52, v33, v13
    v_and_b32 v53, v33, v14
    v_and_b32 v54, v33, v15
    v_and_b32 v55, v33, v16
    v_mfma_f32_16x16x32_bf16 v[20:23], a[0:3], v[48:51], v[20:23]
    v_and_b32 v56, v34, v13
    v_and_b32 v57, v34, v14
    v_and_b32 v58, v34, v15
    v_and_b32 v59, v34, v16
    v_mfma_f32_16x16x32_bf16 v[20:23], a[4:7], v[52:55], v[20:23]
    v_and_b32 v60, v35, v13
    v_and_b32 v61, v35, v14
    v_and_b32 v62, v35, v15
    v_and_b32 v63, v35, v16
    v_mfma_f32_16x16x32_bf16 v[20:23], a[8:11], v[56:59], v[20:23]
    s_nop 0
    v_mfma_f32_16x16x32_bf16 v[20:23], a[12:15], v[60:63], v[20:23]
    s_add_u32 s76, s90, 96
    s_mul_i32 s54, s76, s85
    s_add_u32 s54, s54, s53
    s_add_u32 m0, s59, 0
    s_nop 0
    buffer_load_dwordx4 v4, s[4:7], s54 offen offset:0 nt lds
    buffer_load_dwordx4 v5, s[4:7], s54 offen offset:1024 nt lds
    buffer_load_dwordx4 v6, s[4:7], s54 offen offset:2048 nt lds
    buffer_load_dwordx4 v7, s[4:7], s54 offen offset:3072 nt lds
    buffer_load_dwordx4 a[0:3], v8, s[8:11], s54 offen offset:0 nt
    buffer_load_dwordx4 a[4:7], v8, s[8:11], s54 offen offset:256 nt
    buffer_load_dwordx4 a[8:11], v8, s[8:11], s54 offen offset:512 nt
    buffer_load_dwordx4 a[12:15], v8, s[8:11], s54 offen offset:768 nt
    s_waitcnt vmcnt(12)
    ds_read_b128 v[48:51], v9 offset:4096
    ds_read_b128 v[52:55], v10 offset:4096
    ds_read_b128 v[56:59], v11 offset:4096
    ds_read_b128 v[60:63], v12 offset:4096
    s_waitcnt lgkmcnt(3)
    v_mfma_f32_16x16x32_bf16 v[24:27], v[48:51], v[64:67], 0
    s_waitcnt lgkmcnt(2)
    v_mfma_f32_16x16x32_bf16 v[24:27], v[52:55], v[68:71], v[24:27]
    s_waitcnt lgkmcnt(1)
    v_mfma_f32_16x16x32_bf16 v[24:27], v[56:59], v[72:75], v[24:27]
    s_waitcnt lgkmcnt(0)
    v_mfma_f32_16x16x32_bf16 v[24:27], v[60:63], v[76:79], v[24:27]
    s_nop 7
    v_fma_f32 v28, v24, s55, v17
    v_fma_f32 v29, v25, s55, v17
    v_fma_f32 v30, v26, s55, v17
    v_fma_f32 v31, v27, s55, v17
    v_max3_f32 v36, v28, v29, v30
    v_max_f32 v36, v36, v31
    v_cmp_lt_f32 vcc, s56, v36
    s_cbranch_vccnz RS_55
RB_56:
    v_exp_f32 v28, v28
    v_exp_f32 v29, v29
    v_exp_f32 v30, v30
    v_exp_f32 v31, v31
    v_cvt_pk_bf16_f32 v32, v28, v28
    v_add_f32 v18, v18, v28
    v_cvt_pk_bf16_f32 v33, v29, v29
    v_add_f32 v19, v19, v29
    v_cvt_pk_bf16_f32 v34, v30, v30
    v_add_f32 v18, v18, v30
    v_cvt_pk_bf16_f32 v35, v31, v31
    v_add_f32 v19, v19, v31
    s_waitcnt vmcnt(8)
    v_and_b32 v48, v32, v13
    v_and_b32 v49, v32, v14
    v_and_b32 v50, v32, v15
    v_and_b32 v51, v32, v16
    v_and_b32 v52, v33, v13
    v_and_b32 v53, v33, v14
    v_and_b32 v54, v33, v15
    v_and_b32 v55, v33, v16
    v_mfma_f32_16x16x32_bf16 v[20:23], a[16:19], v[48:51], v[20:23]
    v_and_b32 v56, v34, v13
    v_and_b32 v57, v34, v14
    v_and_b32 v58, v34, v15
    v_and_b32 v59, v34, v16
    v_mfma_f32_16x16x32_bf16 v[20:23], a[20:23], v[52:55], v[20:23]
    v_and_b32 v60, v35, v13
    v_and_b32 v61, v35, v14
    v_and_b32 v62, v35, v15
    v_and_b32 v63, v35, v16
    v_mfma_f32_16x16x32_bf16 v[20:23], a[24:27], v[56:59], v[20:23]
    s_nop 0
    v_mfma_f32_16x16x32_bf16 v[20:23], a[28:31], v[60:63], v[20:23]
    s_cmp_eq_u32 s83, 0
    s_cbranch_scc0 ML_57
    s_add_u32 s77, s90, 112
    s_mul_i32 s54, s77, s85
    s_add_u32 s54, s54, s53
    s_add_u32 m0, s59, 4096
    s_nop 0
    buffer_load_dwordx4 v4, s[4:7], s54 offen offset:0 sc1 lds
    buffer_load_dwordx4 v5, s[4:7], s54 offen offset:1024 sc1 lds
    buffer_load_dwordx4 v6, s[4:7], s54 offen offset:2048 sc1 lds
    buffer_load_dwordx4 v7, s[4:7], s54 offen offset:3072 sc1 lds
    buffer_load_dwordx4 a[16:19], v8, s[8:11], s54 offen offset:0 sc1
    buffer_load_dwordx4 a[20:23], v8, s[8:11], s54 offen offset:256 sc1
    buffer_load_dwordx4 a[24:27], v8, s[8:11], s54 offen offset:512 sc1
    buffer_load_dwordx4 a[28:31], v8, s[8:11], s54 offen offset:768 sc1
    s_branch MJ_58
ML_57:
    s_add_u32 s77, s90, 112
    s_mul_i32 s54, s77, s85
    s_add_u32 s54, s54, s53
    s_add_u32 m0, s59, 4096
    s_nop 0
    buffer_load_dwordx4 v4, s[4:7], s54 offen offset:0 nt lds
    buffer_load_dwordx4 v5, s[4:7], s54 offen offset:1024 nt lds
    buffer_load_dwordx4 v6, s[4:7], s54 offen offset:2048 nt lds
    buffer_load_dwordx4 v7, s[4:7], s54 offen offset:3072 nt lds
    buffer_load_dwordx4 a[16:19], v8, s[8:11], s54 offen offset:0 nt
    buffer_load_dwordx4 a[20:23], v8, s[8:11], s54 offen offset:256 nt
    buffer_load_dwordx4 a[24:27], v8, s[8:11], s54 offen offset:512 nt
    buffer_load_dwordx4 a[28:31], v8, s[8:11], s54 offen offset:768 nt
MJ_58:
    s_waitcnt vmcnt(12)
    ds_read_b128 v[48:51], v9 offset:0
    ds_read_b128 v[52:55], v10 offset:0
    ds_read_b128 v[56:59], v11 offset:0
    ds_read_b128 v[60:63], v12 offset:0
    s_waitcnt lgkmcnt(3)
    v_mfma_f32_16x16x32_bf16 v[24:27], v[48:51], v[64:67], 0
    s_waitcnt lgkmcnt(2)
    v_mfma_f32_16x16x32_bf16 v[24:27], v[52:55], v[68:71], v[24:27]
    s_waitcnt lgkmcnt(1)
    v_mfma_f32_16x16x32_bf16 v[24:27], v[56:59], v[72:75], v[24:27]
    s_waitcnt lgkmcnt(0)
    v_mfma_f32_16x16x32_bf16 v[24:27], v[60:63], v[76:79], v[24:27]
    s_nop 7
    v_fma_f32 v28, v24, s55, v17
    v_fma_f32 v29, v25, s55, v17
    v_fma_f32 v30, v26, s55, v17
    v_fma_f32 v31, v27, s55, v17
    v_max3_f32 v36, v28, v29, v30
    v_max_f32 v36, v36, v31
    v_cmp_lt_f32 vcc, s56, v36
    s_cbranch_vccnz RS_59
RB_60:
    v_exp_f32 v28, v28
    v_exp_f32 v29, v29
    v_exp_f32 v30, v30
    v_exp_f32 v31, v31
    v_cvt_pk_bf16_f32 v32, v28, v28
    v_add_f32 v18, v18, v28
    v_cvt_pk_bf16_f32 v33, v29, v29
    v_add_f32 v19, v19, v29
    v_cvt_pk_bf16_f32 v34, v30, v30
    v_add_f32 v18, v18, v30
    v_cvt_pk_bf16_f32 v35, v31, v31
    v_add_f32 v19, v19, v31
    s_waitcnt vmcnt(8)
    v_and_b32 v48, v32, v13
    v_and_b32 v49, v32, v14
    v_and_b32 v50, v32, v15
    v_and_b32 v51, v32, v16
    v_and_b32 v52, v33, v13
    v_and_b32 v53, v33, v14
    v_and_b32 v54, v33, v15
    v_and_b32 v55, v33, v16
    v_mfma_f32_16x16x32_bf16 v[20:23], a[0:3], v[48:51], v[20:23]
    v_and_b32 v56, v34, v13
    v_and_b32 v57, v34, v14
    v_and_b32 v58, v34, v15
    v_and_b32 v59, v34, v16
    v_mfma_f32_16x16x32_bf16 v[20:23], a[4:7], v[52:55], v[20:23]
    v_and_b32 v60, v35, v13
    v_and_b32 v61, v35, v14
    v_and_b32 v62, v35, v15
    v_and_b32 v63, v35, v16
    v_mfma_f32_16x16x32_bf16 v[20:23], a[8:11], v[56:59], v[20:23]
    s_nop 0
    v_mfma_f32_16x16x32_bf16 v[20:23], a[12:15], v[60:63], v[20:23]
    s_add_u32 s76, s90, 128
    s_mul_i32 s54, s76, s85
    s_add_u32 s54, s54, s53
    s_add_u32 m0, s59, 0
    s_nop 0
    buffer_load_dwordx4 v4, s[4:7], s54 offen offset:0 nt lds
    buffer_load_dwordx4 v5, s[4:7], s54 offen offset:1024 nt lds
    buffer_load_dwordx4 v6, s[4:7], s54 offen offset:2048 nt lds
    buffer_load_dwordx4 v7, s[4:7], s54 offen offset:3072 nt lds
    buffer_load_dwordx4 a[0:3], v8, s[8:11], s54 offen offset:0 nt
    buffer_load_dwordx4 a[4:7], v8, s[8:11], s54 offen offset:256 nt
    buffer_load_dwordx4 a[8:11], v8, s[8:11], s54 offen offset:512 nt
    buffer_load_dwordx4 a[12:15], v8, s[8:11], s54 offen offset:768 nt
    s_waitcnt vmcnt(12)
    ds_read_b128 v[48:51], v9 offset:4096
    ds_read_b128 v[52:55], v10 offset:4096
    ds_read_b128 v[56:59], v11 offset:4096
    ds_read_b128 v[60:63], v12 offset:4096
    s_waitcnt lgkmcnt(3)
    v_mfma_f32_16x16x32_bf16 v[24:27], v[48:51], v[64:67], 0
    s_waitcnt lgkmcnt(2)
    v_mfma_f32_16x16x32_bf16 v[24:27], v[52:55], v[68:71], v[24:27]
    s_waitcnt lgkmcnt(1)
    v_mfma_f32_16x16x32_bf16 v[24:27], v[56:59], v[72:75], v[24:27]
    s_waitcnt lgkmcnt(0)
    v_mfma_f32_16x16x32_bf16 v[24:27], v[60:63], v[76:79], v[24:27]
    s_nop 7
    v_fma_f32 v28, v24, s55, v17
    v_fma_f32 v29, v25, s55, v17
    v_fma_f32 v30, v26, s55, v17
    v_fma_f32 v31, v27, s55, v17
    v_max3_f32 v36, v28, v29, v30
    v_max_f32 v36, v36, v31
    v_cmp_lt_f32 vcc, s56, v36
    s_cbranch_vccnz RS_61
RB_62:
    v_exp_f32 v28, v28
    v_exp_f32 v29, v29
    v_exp_f32 v30, v30
    v_exp_f32 v31, v31
    v_cvt_pk_bf16_f32 v32, v28, v28
    v_add_f32 v18, v18, v28
    v_cvt_pk_bf16_f32 v33, v29, v29
    v_add_f32 v19, v19, v29
    v_cvt_pk_bf16_f32 v34, v30, v30
    v_add_f32 v18, v18, v30
    v_cvt_pk_bf16_f32 v35, v31, v31
    v_add_f32 v19, v19, v31
    s_waitcnt vmcnt(8)
    v_and_b32 v48, v32, v13
    v_and_b32 v49, v32, v14
    v_and_b32 v50, v32, v15
    v_and_b32 v51, v32, v16
    v_and_b32 v52, v33, v13
    v_and_b32 v53, v33, v14
    v_and_b32 v54, v33, v15
    v_and_b32 v55, v33, v16
    v_mfma_f32_16x16x32_bf16 v[20:23], a[16:19], v[48:51], v[20:23]
    v_and_b32 v56, v34, v13
    v_and_b32 v57, v34, v14
    v_and_b32 v58, v34, v15
    v_and_b32 v59, v34, v16
    v_mfma_f32_16x16x32_bf16 v[20:23], a[20:23], v[52:55], v[20:23]
    v_and_b32 v60, v35, v13
    v_and_b32 v61, v35, v14
    v_and_b32 v62, v35, v15
    v_and_b32 v63, v35, v16
    v_mfma_f32_16x16x32_bf16 v[20:23], a[24:27], v[56:59], v[20:23]
    s_nop 0
    v_mfma_f32_16x16x32_bf16 v[20:23], a[28:31], v[60:63], v[20:23]
    s_add_u32 s77, s90, 144
    s_mul_i32 s54, s77, s85
    s_add_u32 s54, s54, s53
    s_add_u32 m0, s59, 4096
    s_nop 0
    buffer_load_dwordx4 v4, s[4:7], s54 offen offset:0 nt lds
    buffer_load_dwordx4 v5, s[4:7], s54 offen offset:1024 nt lds
    buffer_load_dwordx4 v6, s[4:7], s54 offen offset:2048 nt lds
    buffer_load_dwordx4 v7, s[4:7], s54 offen offset:3072 nt lds
    buffer_load_dwordx4 a[16:19], v8, s[8:11], s54 offen offset:0 nt
    buffer_load_dwordx4 a[20:23], v8, s[8:11], s54 offen offset:256 nt
    buffer_load_dwordx4 a[24:27], v8, s[8:11], s54 offen offset:512 nt
    buffer_load_dwordx4 a[28:31], v8, s[8:11], s54 offen offset:768 nt
    s_waitcnt vmcnt(12)
    ds_read_b128 v[48:51], v9 offset:0
    ds_read_b128 v[52:55], v10 offset:0
    ds_read_b128 v[56:59], v11 offset:0
    ds_read_b128 v[60:63], v12 offset:0
    s_waitcnt lgkmcnt(3)
    v_mfma_f32_16x16x32_bf16 v[24:27], v[48:51], v[64:67], 0
    s_waitcnt lgkmcnt(2)
    v_mfma_f32_16x16x32_bf16 v[24:27], v[52:55], v[68:71], v[24:27]
    s_waitcnt lgkmcnt(1)
    v_mfma_f32_16x16x32_bf16 v[24:27], v[56:59], v[72:75], v[24:27]
    s_waitcnt lgkmcnt(0)
    v_mfma_f32_16x16x32_bf16 v[24:27], v[60:63], v[76:79], v[24:27]
    s_nop 7
    v_fma_f32 v28, v24, s55, v17
    v_fma_f32 v29, v25, s55, v17
    v_fma_f32 v30, v26, s55, v17
    v_fma_f32 v31, v27, s55, v17
    v_max3_f32 v36, v28, v29, v30
    v_max_f32 v36, v36, v31
    v_cmp_lt_f32 vcc, s56, v36
    s_cbranch_vccnz RS_63
RB_64:
    v_exp_f32 v28, v28
    v_exp_f32 v29, v29
    v_exp_f32 v30, v30
    v_exp_f32 v31, v31
    v_cvt_pk_bf16_f32 v32, v28, v28
    v_add_f32 v18, v18, v28
    v_cvt_pk_bf16_f32 v33, v29, v29
    v_add_f32 v19, v19, v29
    v_cvt_pk_bf16_f32 v34, v30, v30
    v_add_f32 v18, v18, v30
    v_cvt_pk_bf16_f32 v35, v31, v31
    v_add_f32 v19, v19, v31
    s_waitcnt vmcnt(8)
    v_and_b32 v48, v32, v13
    v_and_b32 v49, v32, v14
    v_and_b32 v50, v32, v15
    v_and_b32 v51, v32, v16
    v_and_b32 v52, v33, v13
    v_and_b32 v53, v33, v14
    v_and_b32 v54, v33, v15
    v_and_b32 v55, v33, v16
    v_mfma_f32_16x16x32_bf16 v[20:23], a[0:3], v[48:51], v[20:23]
    v_and_b32 v56, v34, v13
    v_and_b32 v57, v34, v14
    v_and_b32 v58, v34, v15
    v_and_b32 v59, v34, v16
    v_mfma_f32_16x16x32_bf16 v[20:23], a[4:7], v[52:55], v[20:23]
    v_and_b32 v60, v35, v13
    v_and_b32 v61, v35, v14
    v_and_b32 v62, v35, v15
    v_and_b32 v63, v35, v16
    v_mfma_f32_16x16x32_bf16 v[20:23], a[8:11], v[56:59], v[20:23]
    s_nop 0
    v_mfma_f32_16x16x32_bf16 v[20:23], a[12:15], v[60:63], v[20:23]
    s_cmp_eq_u32 s83, 0
    s_cbranch_scc0 ML_65
    s_add_u32 s76, s90, 160
    s_mul_i32 s54, s76, s85
    s_add_u32 s54, s54, s53
    s_add_u32 m0, s59, 0
    s_nop 0
    buffer_load_dwordx4 v4, s[4:7], s54 offen offset:0 sc1 lds
    buffer_load_dwordx4 v5, s[4:7], s54 offen offset:1024 sc1 lds
    buffer_load_dwordx4 v6, s[4:7], s54 offen offset:2048 sc1 lds
    buffer_load_dwordx4 v7, s[4:7], s54 offen offset:3072 sc1 lds
    buffer_load_dwordx4 a[0:3], v8, s[8:11], s54 offen offset:0 sc1
    buffer_load_dwordx4 a[4:7], v8, s[8:11], s54 offen offset:256 sc1
    buffer_load_dwordx4 a[8:11], v8, s[8:11], s54 offen offset:512 sc1
    buffer_load_dwordx4 a[12:15], v8, s[8:11], s54 offen offset:768 sc1
    s_branch MJ_66
ML_65:
    s_add_u32 s76, s90, 160
    s_mul_i32 s54, s76, s85
    s_add_u32 s54, s54, s53
    s_add_u32 m0, s59, 0
    s_nop 0
    buffer_load_dwordx4 v4, s[4:7], s54 offen offset:0 nt lds
    buffer_load_dwordx4 v5, s[4:7], s54 offen offset:1024 nt lds
    buffer_load_dwordx4 v6, s[4:7], s54 offen offset:2048 nt lds
    buffer_load_dwordx4 v7, s[4:7], s54 offen offset:3072 nt lds
    buffer_load_dwordx4 a[0:3], v8, s[8:11], s54 offen offset:0 nt
    buffer_load_dwordx4 a[4:7], v8, s[8:11], s54 offen offset:256 nt
    buffer_load_dwordx4 a[8:11], v8, s[8:11], s54 offen offset:512 nt
    buffer_load_dwordx4 a[12:15], v8, s[8:11], s54 offen offset:768 nt
MJ_66:
    s_waitcnt vmcnt(12)
    ds_read_b128 v[48:51], v9 offset:4096
    ds_read_b128 v[52:55], v10 offset:4096
    ds_read_b128 v[56:59], v11 offset:4096
    ds_read_b128 v[60:63], v12 offset:4096
    s_waitcnt lgkmcnt(3)
    v_mfma_f32_16x16x32_bf16 v[24:27], v[48:51], v[64:67], 0
    s_waitcnt lgkmcnt(2)
    v_mfma_f32_16x16x32_bf16 v[24:27], v[52:55], v[68:71], v[24:27]
    s_waitcnt lgkmcnt(1)
    v_mfma_f32_16x16x32_bf16 v[24:27], v[56:59], v[72:75], v[24:27]
    s_waitcnt lgkmcnt(0)
    v_mfma_f32_16x16x32_bf16 v[24:27], v[60:63], v[76:79], v[24:27]
    s_nop 7
    v_fma_f32 v28, v24, s55, v17
    v_fma_f32 v29, v25, s55, v17
    v_fma_f32 v30, v26, s55, v17
    v_fma_f32 v31, v27, s55, v17
    v_max3_f32 v36, v28, v29, v30
    v_max_f32 v36, v36, v31
    v_cmp_lt_f32 vcc, s56, v36
    s_cbranch_vccnz RS_67
RB_68:
    v_exp_f32 v28, v28
    v_exp_f32 v29, v29
    v_exp_f32 v30, v30
    v_exp_f32 v31, v31
    v_cvt_pk_bf16_f32 v32, v28, v28
    v_add_f32 v18, v18, v28
    v_cvt_pk_bf16_f32 v33, v29, v29
    v_add_f32 v19, v19, v29
    v_cvt_pk_bf16_f32 v34, v30, v30
    v_add_f32 v18, v18, v30
    v_cvt_pk_bf16_f32 v35, v31, v31
    v_add_f32 v19, v19, v31
    s_waitcnt vmcnt(8)
    v_and_b32 v48, v32, v13
    v_and_b32 v49, v32, v14
    v_and_b32 v50, v32, v15
    v_and_b32 v51, v32, v16
    v_and_b32 v52, v33, v13
    v_and_b32 v53, v33, v14
    v_and_b32 v54, v33, v15
    v_and_b32 v55, v33, v16
    v_mfma_f32_16x16x32_bf16 v[20:23], a[16:19], v[48:51], v[20:23]
    v_and_b32 v56, v34, v13
    v_and_b32 v57, v34, v14
    v_and_b32 v58, v34, v15
    v_and_b32 v59, v34, v16
    v_mfma_f32_16x16x32_bf16 v[20:23], a[20:23], v[52:55], v[20:23]
    v_and_b32 v60, v35, v13
    v_and_b32 v61, v35, v14
    v_and_b32 v62, v35, v15
    v_and_b32 v63, v35, v16
    v_mfma_f32_16x16x32_bf16 v[20:23], a[24:27], v[56:59], v[20:23]
    s_nop 0
    v_mfma_f32_16x16x32_bf16 v[20:23], a[28:31], v[60:63], v[20:23]
    s_add_u32 s77, s90, 176
    s_mul_i32 s54, s77, s85
    s_add_u32 s54, s54, s53
    s_add_u32 m0, s59, 4096
    s_nop 0
    buffer_load_dwordx4 v4, s[4:7], s54 offen offset:0 nt lds
    buffer_load_dwordx4 v5, s[4:7], s54 offen offset:1024 nt lds
    buffer_load_dwordx4 v6, s[4:7], s54 offen offset:2048 nt lds
    buffer_load_dwordx4 v7, s[4:7], s54 offen offset:3072 nt lds
    buffer_load_dwordx4 a[16:19], v8, s[8:11], s54 offen offset:0 nt
    buffer_load_dwordx4 a[20:23], v8, s[8:11], s54 offen offset:256 nt
    buffer_load_dwordx4 a[24:27], v8, s[8:11], s54 offen offset:512 nt
    buffer_load_dwordx4 a[28:31], v8, s[8:11], s54 offen offset:768 nt
    s_waitcnt vmcnt(12)
    ds_read_b128 v[48:51], v9 offset:0
    ds_read_b128 v[52:55], v10 offset:0
    ds_read_b128 v[56:59], v11 offset:0
    ds_read_b128 v[60:63], v12 offset:0
    s_waitcnt lgkmcnt(3)
    v_mfma_f32_16x16x32_bf16 v[24:27], v[48:51], v[64:67], 0
    s_waitcnt lgkmcnt(2)
    v_mfma_f32_16x16x32_bf16 v[24:27], v[52:55], v[68:71], v[24:27]
    s_waitcnt lgkmcnt(1)
    v_mfma_f32_16x16x32_bf16 v[24:27], v[56:59], v[72:75], v[24:27]
    s_waitcnt lgkmcnt(0)
    v_mfma_f32_16x16x32_bf16 v[24:27], v[60:63], v[76:79], v[24:27]
    s_nop 7
    v_fma_f32 v28, v24, s55, v17
    v_fma_f32 v29, v25, s55, v17
    v_fma_f32 v30, v26, s55, v17
    v_fma_f32 v31, v27, s55, v17
    v_max3_f32 v36, v28, v29, v30
    v_max_f32 v36, v36, v31
    v_cmp_lt_f32 vcc, s56, v36
    s_cbranch_vccnz RS_69
RB_70:
    v_exp_f32 v28, v28
    v_exp_f32 v29, v29
    v_exp_f32 v30, v30
    v_exp_f32 v31, v31
    v_cvt_pk_bf16_f32 v32, v28, v28
    v_add_f32 v18, v18, v28
    v_cvt_pk_bf16_f32 v33, v29, v29
    v_add_f32 v19, v19, v29
    v_cvt_pk_bf16_f32 v34, v30, v30
    v_add_f32 v18, v18, v30
    v_cvt_pk_bf16_f32 v35, v31, v31
    v_add_f32 v19, v19, v31
    s_waitcnt vmcnt(8)
    v_and_b32 v48, v32, v13
    v_and_b32 v49, v32, v14
    v_and_b32 v50, v32, v15
    v_and_b32 v51, v32, v16
    v_and_b32 v52, v33, v13
    v_and_b32 v53, v33, v14
    v_and_b32 v54, v33, v15
    v_and_b32 v55, v33, v16
    v_mfma_f32_16x16x32_bf16 v[20:23], a[0:3], v[48:51], v[20:23]
    v_and_b32 v56, v34, v13
    v_and_b32 v57, v34, v14
    v_and_b32 v58, v34, v15
    v_and_b32 v59, v34, v16
    v_mfma_f32_16x16x32_bf16 v[20:23], a[4:7], v[52:55], v[20:23]
    v_and_b32 v60, v35, v13
    v_and_b32 v61, v35, v14
    v_and_b32 v62, v35, v15
    v_and_b32 v63, v35, v16
    v_mfma_f32_16x16x32_bf16 v[20:23], a[8:11], v[56:59], v[20:23]
    s_nop 0
    v_mfma_f32_16x16x32_bf16 v[20:23], a[12:15], v[60:63], v[20:23]
    s_add_u32 s76, s90, 192
    s_mul_i32 s54, s76, s85
    s_add_u32 s54, s54, s53
    s_add_u32 m0, s59, 0
    s_nop 0
    buffer_load_dwordx4 v4, s[4:7], s54 offen offset:0 nt lds
    buffer_load_dwordx4 v5, s[4:7], s54 offen offset:1024 nt lds
    buffer_load_dwordx4 v6, s[4:7], s54 offen offset:2048 nt lds
    buffer_load_dwordx4 v7, s[4:7], s54 offen offset:3072 nt lds
    buffer_load_dwordx4 a[0:3], v8, s[8:11], s54 offen offset:0 nt
    buffer_load_dwordx4 a[4:7], v8, s[8:11], s54 offen offset:256 nt
    buffer_load_dwordx4 a[8:11], v8, s[8:11], s54 offen offset:512 nt
    buffer_load_dwordx4 a[12:15], v8, s[8:11], s54 offen offset:768 nt
    s_waitcnt vmcnt(12)
    ds_read_b128 v[48:51], v9 offset:4096
    ds_read_b128 v[52:55], v10 offset:4096
    ds_read_b128 v[56:59], v11 offset:4096
    ds_read_b128 v[60:63], v12 offset:4096
    s_waitcnt lgkmcnt(3)
    v_mfma_f32_16x16x32_bf16 v[24:27], v[48:51], v[64:67], 0
    s_waitcnt lgkmcnt(2)
    v_mfma_f32_16x16x32_bf16 v[24:27], v[52:55], v[68:71], v[24:27]
    s_waitcnt lgkmcnt(1)
    v_mfma_f32_16x16x32_bf16 v[24:27], v[56:59], v[72:75], v[24:27]
    s_waitcnt lgkmcnt(0)
    v_mfma_f32_16x16x32_bf16 v[24:27], v[60:63], v[76:79], v[24:27]
    s_nop 7
    v_fma_f32 v28, v24, s55, v17
    v_fma_f32 v29, v25, s55, v17
    v_fma_f32 v30, v26, s55, v17
    v_fma_f32 v31, v27, s55, v17
    v_max3_f32 v36, v28, v29, v30
    v_max_f32 v36, v36, v31
    v_cmp_lt_f32 vcc, s56, v36
    s_cbranch_vccnz RS_71
RB_72:
    v_exp_f32 v28, v28
    v_exp_f32 v29, v29
    v_exp_f32 v30, v30
    v_exp_f32 v31, v31
    v_cvt_pk_bf16_f32 v32, v28, v28
    v_add_f32 v18, v18, v28
    v_cvt_pk_bf16_f32 v33, v29, v29
    v_add_f32 v19, v19, v29
    v_cvt_pk_bf16_f32 v34, v30, v30
    v_add_f32 v18, v18, v30
    v_cvt_pk_bf16_f32 v35, v31, v31
    v_add_f32 v19, v19, v31
    s_waitcnt vmcnt(8)
    v_and_b32 v48, v32, v13
    v_and_b32 v49, v32, v14
    v_and_b32 v50, v32, v15
    v_and_b32 v51, v32, v16
    v_and_b32 v52, v33, v13
    v_and_b32 v53, v33, v14
    v_and_b32 v54, v33, v15
    v_and_b32 v55, v33, v16
    v_mfma_f32_16x16x32_bf16 v[20:23], a[16:19], v[48:51], v[20:23]
    v_and_b32 v56, v34, v13
    v_and_b32 v57, v34, v14
    v_and_b32 v58, v34, v15
    v_and_b32 v59, v34, v16
    v_mfma_f32_16x16x32_bf16 v[20:23], a[20:23], v[52:55], v[20:23]
    v_and_b32 v60, v35, v13
    v_and_b32 v61, v35, v14
    v_and_b32 v62, v35, v15
    v_and_b32 v63, v35, v16
    v_mfma_f32_16x16x32_bf16 v[20:23], a[24:27], v[56:59], v[20:23]
    s_nop 0
    v_mfma_f32_16x16x32_bf16 v[20:23], a[28:31], v[60:63], v[20:23]
    s_cmp_eq_u32 s83, 0
    s_cbranch_scc0 ML_73
    s_add_u32 s77, s90, 208
    s_mul_i32 s54, s77, s85
    s_add_u32 s54, s54, s53
    s_add_u32 m0, s59, 4096
    s_nop 0
    buffer_load_dwordx4 v4, s[4:7], s54 offen offset:0 sc1 lds
    buffer_load_dwordx4 v5, s[4:7], s54 offen offset:1024 sc1 lds
    buffer_load_dwordx4 v6, s[4:7], s54 offen offset:2048 sc1 lds
    buffer_load_dwordx4 v7, s[4:7], s54 offen offset:3072 sc1 lds
    buffer_load_dwordx4 a[16:19], v8, s[8:11], s54 offen offset:0 sc1
    buffer_load_dwordx4 a[20:23], v8, s[8:11], s54 offen offset:256 sc1
    buffer_load_dwordx4 a[24:27], v8, s[8:11], s54 offen offset:512 sc1
    buffer_load_dwordx4 a[28:31], v8, s[8:11], s54 offen offset:768 sc1
    s_branch MJ_74
ML_73:
    s_add_u32 s77, s90, 208
    s_mul_i32 s54, s77, s85
    s_add_u32 s54, s54, s53
    s_add_u32 m0, s59, 4096
    s_nop 0
    buffer_load_dwordx4 v4, s[4:7], s54 offen offset:0 nt lds
    buffer_load_dwordx4 v5, s[4:7], s54 offen offset:1024 nt lds
    buffer_load_dwordx4 v6, s[4:7], s54 offen offset:2048 nt lds
    buffer_load_dwordx4 v7, s[4:7], s54 offen offset:3072 nt lds
    buffer_load_dwordx4 a[16:19], v8, s[8:11], s54 offen offset:0 nt
    buffer_load_dwordx4 a[20:23], v8, s[8:11], s54 offen offset:256 nt
    buffer_load_dwordx4 a[24:27], v8, s[8:11], s54 offen offset:512 nt
    buffer_load_dwordx4 a[28:31], v8, s[8:11], s54 offen offset:768 nt
MJ_74:
    s_waitcnt vmcnt(12)
    ds_read_b128 v[48:51], v9 offset:0
    ds_read_b128 v[52:55], v10 offset:0
    ds_read_b128 v[56:59], v11 offset:0
    ds_read_b128 v[60:63], v12 offset:0
    s_waitcnt lgkmcnt(3)
    v_mfma_f32_16x16x32_bf16 v[24:27], v[48:51], v[64:67], 0
    s_waitcnt lgkmcnt(2)
    v_mfma_f32_16x16x32_bf16 v[24:27], v[52:55], v[68:71], v[24:27]
    s_waitcnt lgkmcnt(1)
    v_mfma_f32_16x16x32_bf16 v[24:27], v[56:59], v[72:75], v[24:27]
    s_waitcnt lgkmcnt(0)
    v_mfma_f32_16x16x32_bf16 v[24:27], v[60:63], v[76:79], v[24:27]
    s_nop 7
    v_fma_f32 v28, v24, s55, v17
    v_fma_f32 v29, v25, s55, v17
    v_fma_f32 v30, v26, s55, v17
    v_fma_f32 v31, v27, s55, v17
    v_max3_f32 v36, v28, v29, v30
    v_max_f32 v36, v36, v31
    v_cmp_lt_f32 vcc, s56, v36
    s_cbranch_vccnz RS_75
RB_76:
    v_exp_f32 v28, v28
    v_exp_f32 v29, v29
    v_exp_f32 v30, v30
    v_exp_f32 v31, v31
    v_cvt_pk_bf16_f32 v32, v28, v28
    v_add_f32 v18, v18, v28
    v_cvt_pk_bf16_f32 v33, v29, v29
    v_add_f32 v19, v19, v29
    v_cvt_pk_bf16_f32 v34, v30, v30
    v_add_f32 v18, v18, v30
    v_cvt_pk_bf16_f32 v35, v31, v31
    v_add_f32 v19, v19, v31
    s_waitcnt vmcnt(8)
    v_and_b32 v48, v32, v13
    v_and_b32 v49, v32, v14
    v_and_b32 v50, v32, v15
    v_and_b32 v51, v32, v16
    v_and_b32 v52, v33, v13
    v_and_b32 v53, v33, v14
    v_and_b32 v54, v33, v15
    v_and_b32 v55, v33, v16
    v_mfma_f32_16x16x32_bf16 v[20:23], a[0:3], v[48:51], v[20:23]
    v_and_b32 v56, v34, v13
    v_and_b32 v57, v34, v14
    v_and_b32 v58, v34, v15
    v_and_b32 v59, v34, v16
    v_mfma_f32_16x16x32_bf16 v[20:23], a[4:7], v[52:55], v[20:23]
    v_and_b32 v60, v35, v13
    v_and_b32 v61, v35, v14
    v_and_b32 v62, v35, v15
    v_and_b32 v63, v35, v16
    v_mfma_f32_16x16x32_bf16 v[20:23], a[8:11], v[56:59], v[20:23]
    s_nop 0
    v_mfma_f32_16x16x32_bf16 v[20:23], a[12:15], v[60:63], v[20:23]
    s_add_u32 s76, s90, 224
    s_mul_i32 s54, s76, s85
    s_add_u32 s54, s54, s53
    s_add_u32 m0, s59, 0
    s_nop 0
    buffer_load_dwordx4 v4, s[4:7], s54 offen offset:0 nt lds
    buffer_load_dwordx4 v5, s[4:7], s54 offen offset:1024 nt lds
    buffer_load_dwordx4 v6, s[4:7], s54 offen offset:2048 nt lds
    buffer_load_dwordx4 v7, s[4:7], s54 offen offset:3072 nt lds
    buffer_load_dwordx4 a[0:3], v8, s[8:11], s54 offen offset:0 nt
    buffer_load_dwordx4 a[4:7], v8, s[8:11], s54 offen offset:256 nt
    buffer_load_dwordx4 a[8:11], v8, s[8:11], s54 offen offset:512 nt
    buffer_load_dwordx4 a[12:15], v8, s[8:11], s54 offen offset:768 nt
    s_waitcnt vmcnt(12)
    ds_read_b128 v[48:51], v9 offset:4096
    ds_read_b128 v[52:55], v10 offset:4096
    ds_read_b128 v[56:59], v11 offset:4096
    ds_read_b128 v[60:63], v12 offset:4096
    s_waitcnt lgkmcnt(3)
    v_mfma_f32_16x16x32_bf16 v[24:27], v[48:51], v[64:67], 0
    s_waitcnt lgkmcnt(2)
    v_mfma_f32_16x16x32_bf16 v[24:27], v[52:55], v[68:71], v[24:27]
    s_waitcnt lgkmcnt(1)
    v_mfma_f32_16x16x32_bf16 v[24:27], v[56:59], v[72:75], v[24:27]
    s_waitcnt lgkmcnt(0)
    v_mfma_f32_16x16x32_bf16 v[24:27], v[60:63], v[76:79], v[24:27]
    s_nop 7
    v_fma_f32 v28, v24, s55, v17
    v_fma_f32 v29, v25, s55, v17
    v_fma_f32 v30, v26, s55, v17
    v_fma_f32 v31, v27, s55, v17
    v_max3_f32 v36, v28, v29, v30
    v_max_f32 v36, v36, v31
    v_cmp_lt_f32 vcc, s56, v36
    s_cbranch_vccnz RS_77
RB_78:
    v_exp_f32 v28, v28
    v_exp_f32 v29, v29
    v_exp_f32 v30, v30
    v_exp_f32 v31, v31
    v_cvt_pk_bf16_f32 v32, v28, v28
    v_add_f32 v18, v18, v28
    v_cvt_pk_bf16_f32 v33, v29, v29
    v_add_f32 v19, v19, v29
    v_cvt_pk_bf16_f32 v34, v30, v30
    v_add_f32 v18, v18, v30
    v_cvt_pk_bf16_f32 v35, v31, v31
    v_add_f32 v19, v19, v31
    s_waitcnt vmcnt(8)
    v_and_b32 v48, v32, v13
    v_and_b32 v49, v32, v14
    v_and_b32 v50, v32, v15
    v_and_b32 v51, v32, v16
    v_and_b32 v52, v33, v13
    v_and_b32 v53, v33, v14
    v_and_b32 v54, v33, v15
    v_and_b32 v55, v33, v16
    v_mfma_f32_16x16x32_bf16 v[20:23], a[16:19], v[48:51], v[20:23]
    v_and_b32 v56, v34, v13
    v_and_b32 v57, v34, v14
    v_and_b32 v58, v34, v15
    v_and_b32 v59, v34, v16
    v_mfma_f32_16x16x32_bf16 v[20:23], a[20:23], v[52:55], v[20:23]
    v_and_b32 v60, v35, v13
    v_and_b32 v61, v35, v14
    v_and_b32 v62, v35, v15
    v_and_b32 v63, v35, v16
    v_mfma_f32_16x16x32_bf16 v[20:23], a[24:27], v[56:59], v[20:23]
    s_nop 0
    v_mfma_f32_16x16x32_bf16 v[20:23], a[28:31], v[60:63], v[20:23]
    s_add_u32 s77, s90, 240
    s_mul_i32 s54, s77, s85
    s_add_u32 s54, s54, s53
    s_add_u32 m0, s59, 4096
    s_nop 0
    buffer_load_dwordx4 v4, s[4:7], s54 offen offset:0 nt lds
    buffer_load_dwordx4 v5, s[4:7], s54 offen offset:1024 nt lds
    buffer_load_dwordx4 v6, s[4:7], s54 offen offset:2048 nt lds
    buffer_load_dwordx4 v7, s[4:7], s54 offen offset:3072 nt lds
    buffer_load_dwordx4 a[16:19], v8, s[8:11], s54 offen offset:0 nt
    buffer_load_dwordx4 a[20:23], v8, s[8:11], s54 offen offset:256 nt
    buffer_load_dwordx4 a[24:27], v8, s[8:11], s54 offen offset:512 nt
    buffer_load_dwordx4 a[28:31], v8, s[8:11], s54 offen offset:768 nt
    s_waitcnt vmcnt(12)
    ds_read_b128 v[48:51], v9 offset:0
    ds_read_b128 v[52:55], v10 offset:0
    ds_read_b128 v[56:59], v11 offset:0
    ds_read_b128 v[60:63], v12 offset:0
    s_waitcnt lgkmcnt(3)
    v_mfma_f32_16x16x32_bf16 v[24:27], v[48:51], v[64:67], 0
    s_waitcnt lgkmcnt(2)
    v_mfma_f32_16x16x32_bf16 v[24:27], v[52:55], v[68:71], v[24:27]
    s_waitcnt lgkmcnt(1)
    v_mfma_f32_16x16x32_bf16 v[24:27], v[56:59], v[72:75], v[24:27]
    s_waitcnt lgkmcnt(0)
    v_mfma_f32_16x16x32_bf16 v[24:27], v[60:63], v[76:79], v[24:27]
    s_nop 7
    v_fma_f32 v28, v24, s55, v17
    v_fma_f32 v29, v25, s55, v17
    v_fma_f32 v30, v26, s55, v17
    v_fma_f32 v31, v27, s55, v17
    v_max3_f32 v36, v28, v29, v30
    v_max_f32 v36, v36, v31
    v_cmp_lt_f32 vcc, s56, v36
    s_cbranch_vccnz RS_79
RB_80:
    v_exp_f32 v28, v28
    v_exp_f32 v29, v29
    v_exp_f32 v30, v30
    v_exp_f32 v31, v31
    v_cvt_pk_bf16_f32 v32, v28, v28
    v_add_f32 v18, v18, v28
    v_cvt_pk_bf16_f32 v33, v29, v29
    v_add_f32 v19, v19, v29
    v_cvt_pk_bf16_f32 v34, v30, v30
    v_add_f32 v18, v18, v30
    v_cvt_pk_bf16_f32 v35, v31, v31
    v_add_f32 v19, v19, v31
    s_waitcnt vmcnt(8)
    v_and_b32 v48, v32, v13
    v_and_b32 v49, v32, v14
    v_and_b32 v50, v32, v15
    v_and_b32 v51, v32, v16
    v_and_b32 v52, v33, v13
    v_and_b32 v53, v33, v14
    v_and_b32 v54, v33, v15
    v_and_b32 v55, v33, v16
    v_mfma_f32_16x16x32_bf16 v[20:23], a[0:3], v[48:51], v[20:23]
    v_and_b32 v56, v34, v13
    v_and_b32 v57, v34, v14
    v_and_b32 v58, v34, v15
    v_and_b32 v59, v34, v16
    v_mfma_f32_16x16x32_bf16 v[20:23], a[4:7], v[52:55], v[20:23]
    v_and_b32 v60, v35, v13
    v_and_b32 v61, v35, v14
    v_and_b32 v62, v35, v15
    v_and_b32 v63, v35, v16
    v_mfma_f32_16x16x32_bf16 v[20:23], a[8:11], v[56:59], v[20:23]
    s_nop 0
    v_mfma_f32_16x16x32_bf16 v[20:23], a[12:15], v[60:63], v[20:23]
    s_cmp_eq_u32 s83, 0
    s_cbranch_scc0 ML_81
    s_add_u32 s76, s90, 256
    s_mul_i32 s54, s76, s85
    s_add_u32 s54, s54, s53
    s_add_u32 m0, s59, 0
    s_nop 0
    buffer_load_dwordx4 v4, s[4:7], s54 offen offset:0 sc1 lds
    buffer_load_dwordx4 v5, s[4:7], s54 offen offset:1024 sc1 lds
    buffer_load_dwordx4 v6, s[4:7], s54 offen offset:2048 sc1 lds
    buffer_load_dwordx4 v7, s[4:7], s54 offen offset:3072 sc1 lds
    buffer_load_dwordx4 a[0:3], v8, s[8:11], s54 offen offset:0 sc1
    buffer_load_dwordx4 a[4:7], v8, s[8:11], s54 offen offset:256 sc1
    buffer_load_dwordx4 a[8:11], v8, s[8:11], s54 offen offset:512 sc1
    buffer_load_dwordx4 a[12:15], v8, s[8:11], s54 offen offset:768 sc1
    s_branch MJ_82
ML_81:
    s_add_u32 s76, s90, 256
    s_mul_i32 s54, s76, s85
    s_add_u32 s54, s54, s53
    s_add_u32 m0, s59, 0
    s_nop 0
    buffer_load_dwordx4 v4, s[4:7], s54 offen offset:0 nt lds
    buffer_load_dwordx4 v5, s[4:7], s54 offen offset:1024 nt lds
    buffer_load_dwordx4 v6, s[4:7], s54 offen offset:2048 nt lds
    buffer_load_dwordx4 v7, s[4:7], s54 offen offset:3072 nt lds
    buffer_load_dwordx4 a[0:3], v8, s[8:11], s54 offen offset:0 nt
    buffer_load_dwordx4 a[4:7], v8, s[8:11], s54 offen offset:256 nt
    buffer_load_dwordx4 a[8:11], v8, s[8:11], s54 offen offset:512 nt
    buffer_load_dwordx4 a[12:15], v8, s[8:11], s54 offen offset:768 nt
MJ_82:
    s_waitcnt vmcnt(12)
    ds_read_b128 v[48:51], v9 offset:4096
    ds_read_b128 v[52:55], v10 offset:4096
    ds_read_b128 v[56:59], v11 offset:4096
    ds_read_b128 v[60:63], v12 offset:4096
    s_waitcnt lgkmcnt(3)
    v_mfma_f32_16x16x32_bf16 v[24:27], v[48:51], v[64:67], 0
    s_waitcnt lgkmcnt(2)
    v_mfma_f32_16x16x32_bf16 v[24:27], v[52:55], v[68:71], v[24:27]
    s_waitcnt lgkmcnt(1)
    v_mfma_f32_16x16x32_bf16 v[24:27], v[56:59], v[72:75], v[24:27]
    s_waitcnt lgkmcnt(0)
    v_mfma_f32_16x16x32_bf16 v[24:27], v[60:63], v[76:79], v[24:27]
    s_nop 7
    v_fma_f32 v28, v24, s55, v17
    v_fma_f32 v29, v25, s55, v17
    v_fma_f32 v30, v26, s55, v17
    v_fma_f32 v31, v27, s55, v17
    v_max3_f32 v36, v28, v29, v30
    v_max_f32 v36, v36, v31
    v_cmp_lt_f32 vcc, s56, v36
    s_cbranch_vccnz RS_83
RB_84:
    v_exp_f32 v28, v28
    v_exp_f32 v29, v29
    v_exp_f32 v30, v30
    v_exp_f32 v31, v31
    v_cvt_pk_bf16_f32 v32, v28, v28
    v_add_f32 v18, v18, v28
    v_cvt_pk_bf16_f32 v33, v29, v29
    v_add_f32 v19, v19, v29
    v_cvt_pk_bf16_f32 v34, v30, v30
    v_add_f32 v18, v18, v30
    v_cvt_pk_bf16_f32 v35, v31, v31
    v_add_f32 v19, v19, v31
    s_waitcnt vmcnt(8)
    v_and_b32 v48, v32, v13
    v_and_b32 v49, v32, v14
    v_and_b32 v50, v32, v15
    v_and_b32 v51, v32, v16
    v_and_b32 v52, v33, v13
    v_and_b32 v53, v33, v14
    v_and_b32 v54, v33, v15
    v_and_b32 v55, v33, v16
    v_mfma_f32_16x16x32_bf16 v[20:23], a[16:19], v[48:51], v[20:23]
    v_and_b32 v56, v34, v13
    v_and_b32 v57, v34, v14
    v_and_b32 v58, v34, v15
    v_and_b32 v59, v34, v16
    v_mfma_f32_16x16x32_bf16 v[20:23], a[20:23], v[52:55], v[20:23]
    v_and_b32 v60, v35, v13
    v_and_b32 v61, v35, v14
    v_and_b32 v62, v35, v15
    v_and_b32 v63, v35, v16
    v_mfma_f32_16x16x32_bf16 v[20:23], a[24:27], v[56:59], v[20:23]
    s_nop 0
    v_mfma_f32_16x16x32_bf16 v[20:23], a[28:31], v[60:63], v[20:23]
    s_add_u32 s77, s90, 272
    s_mul_i32 s54, s77, s85
    s_add_u32 s54, s54, s53
    s_add_u32 m0, s59, 4096
    s_nop 0
    buffer_load_dwordx4 v4, s[4:7], s54 offen offset:0 nt lds
    buffer_load_dwordx4 v5, s[4:7], s54 offen offset:1024 nt lds
    buffer_load_dwordx4 v6, s[4:7], s54 offen offset:2048 nt lds
    buffer_load_dwordx4 v7, s[4:7], s54 offen offset:3072 nt lds
    buffer_load_dwordx4 a[16:19], v8, s[8:11], s54 offen offset:0 nt
    buffer_load_dwordx4 a[20:23], v8, s[8:11], s54 offen offset:256 nt
    buffer_load_dwordx4 a[24:27], v8, s[8:11], s54 offen offset:512 nt
    buffer_load_dwordx4 a[28:31], v8, s[8:11], s54 offen offset:768 nt
    s_bitcmp1_b32 s99, 0
    s_cbranch_scc1 SL_85
    v_accvgpr_read_b32 v48, a48
    v_accvgpr_read_b32 v49, a49
    v_accvgpr_read_b32 v50, a50
    v_accvgpr_read_b32 v51, a51
    v_lshrrev_b32 v36, 11, v48
    v_and_b32 v60, 0x000f000f, v36
    v_and_b32 v48, 0x87ff87ff, v48
    v_lshrrev_b32 v37, 11, v49
    v_and_b32 v61, 0x000f000f, v37
    v_and_b32 v49, 0x87ff87ff, v49
    v_lshrrev_b32 v36, 11, v50
    v_and_b32 v62, 0x000f000f, v36
    v_and_b32 v50, 0x87ff87ff, v50
    v_lshrrev_b32 v37, 11, v51
    v_and_b32 v63, 0x000f000f, v37
    v_and_b32 v51, 0x87ff87ff, v51
    s_nop 1
    v_mfma_f32_16x16x32_bf16 v[24:27], v[48:51], v[64:67], 0
    v_accvgpr_read_b32 v52, a52
    v_accvgpr_read_b32 v53, a53
    v_accvgpr_read_b32 v54, a54
    v_accvgpr_read_b32 v55, a55
    v_lshrrev_b32 v36, 7, v52
    v_and_or_b32 v60, v36, s100, v60
    v_and_b32 v52, 0x87ff87ff, v52
    v_lshrrev_b32 v37, 7, v53
    v_and_or_b32 v61, v37, s100, v61
    v_and_b32 v53, 0x87ff87ff, v53
    v_lshrrev_b32 v36, 7, v54
    v_and_or_b32 v62, v36, s100, v62
    v_and_b32 v54, 0x87ff87ff, v54
    v_lshrrev_b32 v37, 7, v55
    v_and_or_b32 v63, v37, s100, v63
    v_and_b32 v55, 0x87ff87ff, v55
    s_nop 1
    v_mfma_f32_16x16x32_bf16 v[24:27], v[52:55], v[68:71], v[24:27]
    v_accvgpr_read_b32 v56, a56
    v_accvgpr_read_b32 v57, a57
    v_accvgpr_read_b32 v58, a58
    v_accvgpr_read_b32 v59, a59
    v_lshrrev_b32 v36, 3, v56
    v_and_or_b32 v60, v36, s101, v60
    v_lshlrev_b32 v37, 1, v56
    v_and_or_b32 v60, v37, s80, v60
    v_and_b32 v56, 0x87ff87ff, v56
    v_lshrrev_b32 v37, 3, v57
    v_and_or_b32 v61, v37, s101, v61
    v_lshlrev_b32 v36, 1, v57
    v_and_or_b32 v61, v36, s80, v61
    v_and_b32 v57, 0x87ff87ff, v57
    v_lshrrev_b32 v36, 3, v58
    v_and_or_b32 v62, v36, s101, v62
    v_lshlrev_b32 v37, 1, v58
    v_and_or_b32 v62, v37, s80, v62
    v_and_b32 v58, 0x87ff87ff, v58
    v_lshrrev_b32 v37, 3, v59
    v_and_or_b32 v63, v37, s101, v63
    v_lshlrev_b32 v36, 1, v59
    v_and_or_b32 v63, v36, s80, v63
    v_and_b32 v59, 0x87ff87ff, v59
    s_nop 1
    v_mfma_f32_16x16x32_bf16 v[24:27], v[56:59], v[72:75], v[24:27]
    v_mfma_f32_16x16x32_bf16 v[24:27], v[60:63], v[76:79], v[24:27]
    s_or_b32 s62, 0, 0
    s_bitcmp1_b32 s96, 0
    s_getpc_b64 s[92:93]
    s_cbranch_scc1 PATCH_K
    v_lshrrev_b32 v36, 11, v80
    v_and_b32 v56, 0x000f000f, v36
    v_and_b32 v48, 0x87ff87ff, v80
    v_lshrrev_b32 v37, 11, v81
    v_and_b32 v57, 0x000f000f, v37
    v_and_b32 v49, 0x87ff87ff, v81
    v_lshrrev_b32 v36, 11, v82
    v_and_b32 v58, 0x000f000f, v36
    v_and_b32 v50, 0x87ff87ff, v82
    v_lshrrev_b32 v37, 11, v83
    v_and_b32 v59, 0x000f000f, v37
    v_and_b32 v51, 0x87ff87ff, v83
    v_fmamk_f32 v28, v24, 0x568293ee, v17
    v_fmamk_f32 v29, v25, 0x568293ee, v17
    v_fmamk_f32 v30, v26, 0x568293ee, v17
    v_fmamk_f32 v31, v27, 0x568293ee, v17
    v_max3_f32 v36, v28, v29, v30
    v_max_f32 v36, v36, v31
    v_cmp_lt_f32 vcc, s56, v36
    s_cbranch_vccnz RS_87
RB_88:
    v_exp_f32 v28, v28
    v_exp_f32 v29, v29
    v_exp_f32 v30, v30
    v_exp_f32 v31, v31
    v_lshrrev_b32 v36, 7, v84
    v_and_or_b32 v56, v36, s100, v56
    v_and_b32 v52, 0x87ff87ff, v84
    v_lshrrev_b32 v37, 7, v85
    v_and_or_b32 v57, v37, s100, v57
    v_and_b32 v53, 0x87ff87ff, v85
    v_lshrrev_b32 v36, 7, v86
    v_and_or_b32 v58, v36, s100, v58
    v_and_b32 v54, 0x87ff87ff, v86
    v_lshrrev_b32 v37, 7, v87
    v_and_or_b32 v59, v37, s100, v59
    v_and_b32 v55, 0x87ff87ff, v87
    v_add_f32 v18, v18, v28
    v_mul_f32 v28, 0x78800000, v28
    v_add_f32 v19, v19, v29
    v_mul_f32 v29, 0x78800000, v29
    v_add_f32 v18, v18, v30
    v_mul_f32 v30, 0x78800000, v30
    v_add_f32 v19, v19, v31
    v_mul_f32 v31, 0x78800000, v31
    v_cvt_pk_bf16_f32 v32, v28, v28
    v_cvt_pk_bf16_f32 v33, v29, v29
    v_cvt_pk_bf16_f32 v34, v30, v30
    v_cvt_pk_bf16_f32 v35, v31, v31
    v_and_b32 v60, v32, v13
    v_and_b32 v61, v32, v14
    v_and_b32 v62, v32, v15
    v_and_b32 v63, v32, v16
    s_nop 1
    v_mfma_f32_16x16x32_bf16 v[20:23], v[48:51], v[60:63], v[20:23]
    v_and_b32 v24, v33, v13
    v_and_b32 v25, v33, v14
    v_and_b32 v26, v33, v15
    v_and_b32 v27, v33, v16
    s_nop 1
    v_mfma_f32_16x16x32_bf16 v[20:23], v[52:55], v[24:27], v[20:23]
    v_lshrrev_b32 v36, 3, v88
    v_and_or_b32 v56, v36, s101, v56
    v_lshlrev_b32 v37, 1, v88
    v_and_or_b32 v56, v37, s80, v56
    v_and_b32 v48, 0x87ff87ff, v88
    v_lshrrev_b32 v37, 3, v89
    v_and_or_b32 v57, v37, s101, v57
    v_lshlrev_b32 v36, 1, v89
    v_and_or_b32 v57, v36, s80, v57
    v_and_b32 v49, 0x87ff87ff, v89
    v_lshrrev_b32 v36, 3, v90
    v_and_or_b32 v58, v36, s101, v58
    v_lshlrev_b32 v37, 1, v90
    v_and_or_b32 v58, v37, s80, v58
    v_and_b32 v50, 0x87ff87ff, v90
    v_lshrrev_b32 v37, 3, v91
    v_and_or_b32 v59, v37, s101, v59
    v_lshlrev_b32 v36, 1, v91
    v_and_or_b32 v59, v36, s80, v59
    v_and_b32 v51, 0x87ff87ff, v91
    v_and_b32 v60, v34, v13
    v_and_b32 v61, v34, v14
    v_and_b32 v62, v34, v15
    v_and_b32 v63, v34, v16
    s_nop 1
    v_mfma_f32_16x16x32_bf16 v[20:23], v[48:51], v[60:63], v[20:23]
    v_and_b32 v24, v35, v13
    v_and_b32 v25, v35, v14
    v_and_b32 v26, v35, v15
    v_and_b32 v27, v35, v16
    s_nop 1
    v_mfma_f32_16x16x32_bf16 v[20:23], v[56:59], v[24:27], v[20:23]
    s_or_b32 s62, 32, 0
    s_bitcmp1_b32 s97, 0
    s_getpc_b64 s[92:93]
    s_cbranch_scc1 PATCH_V
SD_86:
    s_waitcnt vmcnt(12)
    ds_read_b128 v[48:51], v9 offset:0
    ds_read_b128 v[52:55], v10 offset:0
    ds_read_b128 v[56:59], v11 offset:0
    ds_read_b128 v[60:63], v12 offset:0
    s_waitcnt lgkmcnt(3)
    v_mfma_f32_16x16x32_bf16 v[24:27], v[48:51], v[64:67], 0
    s_waitcnt lgkmcnt(2)
    v_mfma_f32_16x16x32_bf16 v[24:27], v[52:55], v[68:71], v[24:27]
    s_waitcnt lgkmcnt(1)
    v_mfma_f32_16x16x32_bf16 v[24:27], v[56:59], v[72:75], v[24:27]
    s_waitcnt lgkmcnt(0)
    v_mfma_f32_16x16x32_bf16 v[24:27], v[60:63], v[76:79], v[24:27]
    s_nop 7
    v_fma_f32 v28, v24, s55, v17
    v_fma_f32 v29, v25, s55, v17
    v_fma_f32 v30, v26, s55, v17
    v_fma_f32 v31, v27, s55, v17
    v_max3_f32 v36, v28, v29, v30
    v_max_f32 v36, v36, v31
    v_cmp_lt_f32 vcc, s56, v36
    s_cbranch_vccnz RS_89
RB_90:
    v_exp_f32 v28, v28
    v_exp_f32 v29, v29
    v_exp_f32 v30, v30
    v_exp_f32 v31, v31
    v_cvt_pk_bf16_f32 v32, v28, v28
    v_add_f32 v18, v18, v28
    v_cvt_pk_bf16_f32 v33, v29, v29
    v_add_f32 v19, v19, v29
    v_cvt_pk_bf16_f32 v34, v30, v30
    v_add_f32 v18, v18, v30
    v_cvt_pk_bf16_f32 v35, v31, v31
    v_add_f32 v19, v19, v31
    s_waitcnt vmcnt(8)
    v_and_b32 v48, v32, v13
    v_and_b32 v49, v32, v14
    v_and_b32 v50, v32, v15
    v_and_b32 v51, v32, v16
    v_and_b32 v52, v33, v13
    v_and_b32 v53, v33, v14
    v_and_b32 v54, v33, v15
    v_and_b32 v55, v33, v16
    v_mfma_f32_16x16x32_bf16 v[20:23], a[0:3], v[48:51], v[20:23]
    v_and_b32 v56, v34, v13
    v_and_b32 v57, v34, v14
    v_and_b32 v58, v34, v15
    v_and_b32 v59, v34, v16
    v_mfma_f32_16x16x32_bf16 v[20:23], a[4:7], v[52:55], v[20:23]
    v_and_b32 v60, v35, v13
    v_and_b32 v61, v35, v14
    v_and_b32 v62, v35, v15
    v_and_b32 v63, v35, v16
    v_mfma_f32_16x16x32_bf16 v[20:23], a[8:11], v[56:59], v[20:23]
    s_nop 0
    v_mfma_f32_16x16x32_bf16 v[20:23], a[12:15], v[60:63], v[20:23]
    s_add_u32 s76, s90, 288
    s_mul_i32 s54, s76, s85
    s_add_u32 s54, s54, s53
    s_add_u32 m0, s59, 0
    s_nop 0
    buffer_load_dwordx4 v4, s[4:7], s54 offen offset:0 nt lds
    buffer_load_dwordx4 v5, s[4:7], s54 offen offset:1024 nt lds
    buffer_load_dwordx4 v6, s[4:7], s54 offen offset:2048 nt lds
    buffer_load_dwordx4 v7, s[4:7], s54 offen offset:3072 nt lds
    buffer_load_dwordx4 a[0:3], v8, s[8:11], s54 offen offset:0 nt
    buffer_load_dwordx4 a[4:7], v8, s[8:11], s54 offen offset:256 nt
    buffer_load_dwordx4 a[8:11], v8, s[8:11], s54 offen offset:512 nt
    buffer_load_dwordx4 a[12:15], v8, s[8:11], s54 offen offset:768 nt
    s_bitcmp1_b32 s99, 1
    s_cbranch_scc1 SL_91
    v_accvgpr_read_b32 v48, a60
    v_accvgpr_read_b32 v49, a61
    v_accvgpr_read_b32 v50, a62
    v_accvgpr_read_b32 v51, a63
    v_lshrrev_b32 v36, 11, v48
    v_and_b32 v60, 0x000f000f, v36
    v_and_b32 v48, 0x87ff87ff, v48
    v_lshrrev_b32 v37, 11, v49
    v_and_b32 v61, 0x000f000f, v37
    v_and_b32 v49, 0x87ff87ff, v49
    v_lshrrev_b32 v36, 11, v50
    v_and_b32 v62, 0x000f000f, v36
    v_and_b32 v50, 0x87ff87ff, v50
    v_lshrrev_b32 v37, 11, v51
    v_and_b32 v63, 0x000f000f, v37
    v_and_b32 v51, 0x87ff87ff, v51
    s_nop 1
    v_mfma_f32_16x16x32_bf16 v[24:27], v[48:51], v[64:67], 0
    v_accvgpr_read_b32 v52, a64
    v_accvgpr_read_b32 v53, a65
    v_accvgpr_read_b32 v54, a66
    v_accvgpr_read_b32 v55, a67
    v_lshrrev_b32 v36, 7, v52
    v_and_or_b32 v60, v36, s100, v60
    v_and_b32 v52, 0x87ff87ff, v52
    v_lshrrev_b32 v37, 7, v53
    v_and_or_b32 v61, v37, s100, v61
    v_and_b32 v53, 0x87ff87ff, v53
    v_lshrrev_b32 v36, 7, v54
    v_and_or_b32 v62, v36, s100, v62
    v_and_b32 v54, 0x87ff87ff, v54
    v_lshrrev_b32 v37, 7, v55
    v_and_or_b32 v63, v37, s100, v63
    v_and_b32 v55, 0x87ff87ff, v55
    s_nop 1
    v_mfma_f32_16x16x32_bf16 v[24:27], v[52:55], v[68:71], v[24:27]
    v_accvgpr_read_b32 v56, a68
    v_accvgpr_read_b32 v57, a69
    v_accvgpr_read_b32 v58, a70
    v_accvgpr_read_b32 v59, a71
    v_lshrrev_b32 v36, 3, v56
    v_and_or_b32 v60, v36, s101, v60
    v_lshlrev_b32 v37, 1, v56
    v_and_or_b32 v60, v37, s80, v60
    v_and_b32 v56, 0x87ff87ff, v56
    v_lshrrev_b32 v37, 3, v57
    v_and_or_b32 v61, v37, s101, v61
    v_lshlrev_b32 v36, 1, v57
    v_and_or_b32 v61, v36, s80, v61
    v_and_b32 v57, 0x87ff87ff, v57
    v_lshrrev_b32 v36, 3, v58
    v_and_or_b32 v62, v36, s101, v62
    v_lshlrev_b32 v37, 1, v58
    v_and_or_b32 v62, v37, s80, v62
    v_and_b32 v58, 0x87ff87ff, v58
    v_lshrrev_b32 v37, 3, v59
    v_and_or_b32 v63, v37, s101, v63
    v_lshlrev_b32 v36, 1, v59
    v_and_or_b32 v63, v36, s80, v63
    v_and_b32 v59, 0x87ff87ff, v59
    s_nop 1
    v_mfma_f32_16x16x32_bf16 v[24:27], v[56:59], v[72:75], v[24:27]
    v_mfma_f32_16x16x32_bf16 v[24:27], v[60:63], v[76:79], v[24:27]
    s_or_b32 s62, 1, 0
    s_bitcmp1_b32 s96, 1
    s_getpc_b64 s[92:93]
    s_cbranch_scc1 PATCH_K
    v_lshrrev_b32 v36, 11, v92
    v_and_b32 v56, 0x000f000f, v36
    v_and_b32 v48, 0x87ff87ff, v92
    v_lshrrev_b32 v37, 11, v93
    v_and_b32 v57, 0x000f000f, v37
    v_and_b32 v49, 0x87ff87ff, v93
    v_lshrrev_b32 v36, 11, v94
    v_and_b32 v58, 0x000f000f, v36
    v_and_b32 v50, 0x87ff87ff, v94
    v_lshrrev_b32 v37, 11, v95
    v_and_b32 v59, 0x000f000f, v37
    v_and_b32 v51, 0x87ff87ff, v95
    v_fmamk_f32 v28, v24, 0x568293ee, v17
    v_fmamk_f32 v29, v25, 0x568293ee, v17
    v_fmamk_f32 v30, v26, 0x568293ee, v17
    v_fmamk_f32 v31, v27, 0x568293ee, v17
    v_max3_f32 v36, v28, v29, v30
    v_max_f32 v36, v36, v31
    v_cmp_lt_f32 vcc, s56, v36
    s_cbranch_vccnz RS_93
RB_94:
    v_exp_f32 v28, v28
    v_exp_f32 v29, v29
    v_exp_f32 v30, v30
    v_exp_f32 v31, v31
    v_lshrrev_b32 v36, 7, v96
    v_and_or_b32 v56, v36, s100, v56
    v_and_b32 v52, 0x87ff87ff, v96
    v_lshrrev_b32 v37, 7, v97
    v_and_or_b32 v57, v37, s100, v57
    v_and_b32 v53, 0x87ff87ff, v97
    v_lshrrev_b32 v36, 7, v98
    v_and_or_b32 v58, v36, s100, v58
    v_and_b32 v54, 0x87ff87ff, v98
    v_lshrrev_b32 v37, 7, v99
    v_and_or_b32 v59, v37, s100, v59
    v_and_b32 v55, 0x87ff87ff, v99
    v_add_f32 v18, v18, v28
    v_mul_f32 v28, 0x78800000, v28
    v_add_f32 v19, v19, v29
    v_mul_f32 v29, 0x78800000, v29
    v_add_f32 v18, v18, v30
    v_mul_f32 v30, 0x78800000, v30
    v_add_f32 v19, v19, v31
    v_mul_f32 v31, 0x78800000, v31
    v_cvt_pk_bf16_f32 v32, v28, v28
    v_cvt_pk_bf16_f32 v33, v29, v29
    v_cvt_pk_bf16_f32 v34, v30, v30
    v_cvt_pk_bf16_f32 v35, v31, v31
    v_and_b32 v60, v32, v13
    v_and_b32 v61, v32, v14
    v_and_b32 v62, v32, v15
    v_and_b32 v63, v32, v16
    s_nop 1
    v_mfma_f32_16x16x32_bf16 v[20:23], v[48:51], v[60:63], v[20:23]
    v_and_b32 v24, v33, v13
    v_and_b32 v25, v33, v14
    v_and_b32 v26, v33, v15
    v_and_b32 v27, v33, v16
    s_nop 1
    v_mfma_f32_16x16x32_bf16 v[20:23], v[52:55], v[24:27], v[20:23]
    v_lshrrev_b32 v36, 3, v100
    v_and_or_b32 v56, v36, s101, v56
    v_lshlrev_b32 v37, 1, v100
    v_and_or_b32 v56, v37, s80, v56
    v_and_b32 v48, 0x87ff87ff, v100
    v_lshrrev_b32 v37, 3, v101
    v_and_or_b32 v57, v37, s101, v57
    v_lshlrev_b32 v36, 1, v101
    v_and_or_b32 v57, v36, s80, v57
    v_and_b32 v49, 0x87ff87ff, v101
    v_lshrrev_b32 v36, 3, v102
    v_and_or_b32 v58, v36, s101, v58
    v_lshlrev_b32 v37, 1, v102
    v_and_or_b32 v58, v37, s80, v58
    v_and_b32 v50, 0x87ff87ff, v102
    v_lshrrev_b32 v37, 3, v103
    v_and_or_b32 v59, v37, s101, v59
    v_lshlrev_b32 v36, 1, v103
    v_and_or_b32 v59, v36, s80, v59
    v_and_b32 v51, 0x87ff87ff, v103
    v_and_b32 v60, v34, v13
    v_and_b32 v61, v34, v14
    v_and_b32 v62, v34, v15
    v_and_b32 v63, v34, v16
    s_nop 1
    v_mfma_f32_16x16x32_bf16 v[20:23], v[48:51], v[60:63], v[20:23]
    v_and_b32 v24, v35, v13
    v_and_b32 v25, v35, v14
    v_and_b32 v26, v35, v15
    v_and_b32 v27, v35, v16
    s_nop 1
    v_mfma_f32_16x16x32_bf16 v[20:23], v[56:59], v[24:27], v[20:23]
    s_or_b32 s62, 33, 0
    s_bitcmp1_b32 s97, 1
    s_getpc_b64 s[92:93]
    s_cbranch_scc1 PATCH_V
SD_92:
    s_waitcnt vmcnt(12)
    ds_read_b128 v[48:51], v9 offset:4096
    ds_read_b128 v[52:55], v10 offset:4096
    ds_read_b128 v[56:59], v11 offset:4096
    ds_read_b128 v[60:63], v12 offset:4096
    s_waitcnt lgkmcnt(3)
    v_mfma_f32_16x16x32_bf16 v[24:27], v[48:51], v[64:67], 0
    s_waitcnt lgkmcnt(2)
    v_mfma_f32_16x16x32_bf16 v[24:27], v[52:55], v[68:71], v[24:27]
    s_waitcnt lgkmcnt(1)
    v_mfma_f32_16x16x32_bf16 v[24:27], v[56:59], v[72:75], v[24:27]
    s_waitcnt lgkmcnt(0)
    v_mfma_f32_16x16x32_bf16 v[24:27], v[60:63], v[76:79], v[24:27]
    s_nop 7
    v_fma_f32 v28, v24, s55, v17
    v_fma_f32 v29, v25, s55, v17
    v_fma_f32 v30, v26, s55, v17
    v_fma_f32 v31, v27, s55, v17
    v_max3_f32 v36, v28, v29, v30
    v_max_f32 v36, v36, v31
    v_cmp_lt_f32 vcc, s56, v36
    s_cbranch_vccnz RS_95
RB_96:
    v_exp_f32 v28, v28
    v_exp_f32 v29, v29
    v_exp_f32 v30, v30
    v_exp_f32 v31, v31
    v_cvt_pk_bf16_f32 v32, v28, v28
    v_add_f32 v18, v18, v28
    v_cvt_pk_bf16_f32 v33, v29, v29
    v_add_f32 v19, v19, v29
    v_cvt_pk_bf16_f32 v34, v30, v30
    v_add_f32 v18, v18, v30
    v_cvt_pk_bf16_f32 v35, v31, v31
    v_add_f32 v19, v19, v31
    s_waitcnt vmcnt(8)
    v_and_b32 v48, v32, v13
    v_and_b32 v49, v32, v14
    v_and_b32 v50, v32, v15
    v_and_b32 v51, v32, v16
    v_and_b32 v52, v33, v13
    v_and_b32 v53, v33, v14
    v_and_b32 v54, v33, v15
    v_and_b32 v55, v33, v16
    v_mfma_f32_16x16x32_bf16 v[20:23], a[16:19], v[48:51], v[20:23]
    v_and_b32 v56, v34, v13
    v_and_b32 v57, v34, v14
    v_and_b32 v58, v34, v15
    v_and_b32 v59, v34, v16
    v_mfma_f32_16x16x32_bf16 v[20:23], a[20:23], v[52:55], v[20:23]
    v_and_b32 v60, v35, v13
    v_and_b32 v61, v35, v14
    v_and_b32 v62, v35, v15
    v_and_b32 v63, v35, v16
    v_mfma_f32_16x16x32_bf16 v[20:23], a[24:27], v[56:59], v[20:23]
    s_nop 0
    v_mfma_f32_16x16x32_bf16 v[20:23], a[28:31], v[60:63], v[20:23]
    s_cmp_eq_u32 s83, 0
    s_cbranch_scc0 ML_97
    s_add_u32 s77, s90, 304
    s_mul_i32 s54, s77, s85
    s_add_u32 s54, s54, s53
    s_add_u32 m0, s59, 4096
    s_nop 0
    buffer_load_dwordx4 v4, s[4:7], s54 offen offset:0 sc1 lds
    buffer_load_dwordx4 v5, s[4:7], s54 offen offset:1024 sc1 lds
    buffer_load_dwordx4 v6, s[4:7], s54 offen offset:2048 sc1 lds
    buffer_load_dwordx4 v7, s[4:7], s54 offen offset:3072 sc1 lds
    buffer_load_dwordx4 a[16:19], v8, s[8:11], s54 offen offset:0 sc1
    buffer_load_dwordx4 a[20:23], v8, s[8:11], s54 offen offset:256 sc1
    buffer_load_dwordx4 a[24:27], v8, s[8:11], s54 offen offset:512 sc1
    buffer_load_dwordx4 a[28:31], v8, s[8:11], s54 offen offset:768 sc1
    s_branch MJ_98
ML_97:
    s_add_u32 s77, s90, 304
    s_mul_i32 s54, s77, s85
    s_add_u32 s54, s54, s53
    s_add_u32 m0, s59, 4096
    s_nop 0
    buffer_load_dwordx4 v4, s[4:7], s54 offen offset:0 nt lds
    buffer_load_dwordx4 v5, s[4:7], s54 offen offset:1024 nt lds
    buffer_load_dwordx4 v6, s[4:7], s54 offen offset:2048 nt lds
    buffer_load_dwordx4 v7, s[4:7], s54 offen offset:3072 nt lds
    buffer_load_dwordx4 a[16:19], v8, s[8:11], s54 offen offset:0 nt
    buffer_load_dwordx4 a[20:23], v8, s[8:11], s54 offen offset:256 nt
    buffer_load_dwordx4 a[24:27], v8, s[8:11], s54 offen offset:512 nt
    buffer_load_dwordx4 a[28:31], v8, s[8:11], s54 offen offset:768 nt
MJ_98:
    s_bitcmp1_b32 s99, 2
    s_cbranch_scc1 SL_99
    v_accvgpr_read_b32 v48, a72
    v_accvgpr_read_b32 v49, a73
    v_accvgpr_read_b32 v50, a74
    v_accvgpr_read_b32 v51, a75
    v_lshrrev_b32 v36, 11, v48
    v_and_b32 v60, 0x000f000f, v36
    v_and_b32 v48, 0x87ff87ff, v48
    v_lshrrev_b32 v37, 11, v49
    v_and_b32 v61, 0x000f000f, v37
    v_and_b32 v49, 0x87ff87ff, v49
    v_lshrrev_b32 v36, 11, v50
    v_and_b32 v62, 0x000f000f, v36
    v_and_b32 v50, 0x87ff87ff, v50
    v_lshrrev_b32 v37, 11, v51
    v_and_b32 v63, 0x000f000f, v37
    v_and_b32 v51, 0x87ff87ff, v51
    s_nop 1
    v_mfma_f32_16x16x32_bf16 v[24:27], v[48:51], v[64:67], 0
    v_accvgpr_read_b32 v52, a76
    v_accvgpr_read_b32 v53, a77
    v_accvgpr_read_b32 v54, a78
    v_accvgpr_read_b32 v55, a79
    v_lshrrev_b32 v36, 7, v52
    v_and_or_b32 v60, v36, s100, v60
    v_and_b32 v52, 0x87ff87ff, v52
    v_lshrrev_b32 v37, 7, v53
    v_and_or_b32 v61, v37, s100, v61
    v_and_b32 v53, 0x87ff87ff, v53
    v_lshrrev_b32 v36, 7, v54
    v_and_or_b32 v62, v36, s100, v62
    v_and_b32 v54, 0x87ff87ff, v54
    v_lshrrev_b32 v37, 7, v55
    v_and_or_b32 v63, v37, s100, v63
    v_and_b32 v55, 0x87ff87ff, v55
    s_nop 1
    v_mfma_f32_16x16x32_bf16 v[24:27], v[52:55], v[68:71], v[24:27]
    v_accvgpr_read_b32 v56, a80
    v_accvgpr_read_b32 v57, a81
    v_accvgpr_read_b32 v58, a82
    v_accvgpr_read_b32 v59, a83
    v_lshrrev_b32 v36, 3, v56
    v_and_or_b32 v60, v36, s101, v60
    v_lshlrev_b32 v37, 1, v56
    v_and_or_b32 v60, v37, s80, v60
    v_and_b32 v56, 0x87ff87ff, v56
    v_lshrrev_b32 v37, 3, v57
    v_and_or_b32 v61, v37, s101, v61
    v_lshlrev_b32 v36, 1, v57
    v_and_or_b32 v61, v36, s80, v61
    v_and_b32 v57, 0x87ff87ff, v57
    v_lshrrev_b32 v36, 3, v58
    v_and_or_b32 v62, v36, s101, v62
    v_lshlrev_b32 v37, 1, v58
    v_and_or_b32 v62, v37, s80, v62
    v_and_b32 v58, 0x87ff87ff, v58
    v_lshrrev_b32 v37, 3, v59
    v_and_or_b32 v63, v37, s101, v63
    v_lshlrev_b32 v36, 1, v59
    v_and_or_b32 v63, v36, s80, v63
    v_and_b32 v59, 0x87ff87ff, v59
    s_nop 1
    v_mfma_f32_16x16x32_bf16 v[24:27], v[56:59], v[72:75], v[24:27]
    v_mfma_f32_16x16x32_bf16 v[24:27], v[60:63], v[76:79], v[24:27]
    s_or_b32 s62, 2, 0
    s_bitcmp1_b32 s96, 2
    s_getpc_b64 s[92:93]
    s_cbranch_scc1 PATCH_K
    v_lshrrev_b32 v36, 11, v104
    v_and_b32 v56, 0x000f000f, v36
    v_and_b32 v48, 0x87ff87ff, v104
    v_lshrrev_b32 v37, 11, v105
    v_and_b32 v57, 0x000f000f, v37
    v_and_b32 v49, 0x87ff87ff, v105
    v_lshrrev_b32 v36, 11, v106
    v_and_b32 v58, 0x000f000f, v36
    v_and_b32 v50, 0x87ff87ff, v106
    v_lshrrev_b32 v37, 11, v107
    v_and_b32 v59, 0x000f000f, v37
    v_and_b32 v51, 0x87ff87ff, v107
    v_fmamk_f32 v28, v24, 0x568293ee, v17
    v_fmamk_f32 v29, v25, 0x568293ee, v17
    v_fmamk_f32 v30, v26, 0x568293ee, v17
    v_fmamk_f32 v31, v27, 0x568293ee, v17
    v_max3_f32 v36, v28, v29, v30
    v_max_f32 v36, v36, v31
    v_cmp_lt_f32 vcc, s56, v36
    s_cbranch_vccnz RS_101
RB_102:
    v_exp_f32 v28, v28
    v_exp_f32 v29, v29
    v_exp_f32 v30, v30
    v_exp_f32 v31, v31
    v_lshrrev_b32 v36, 7, v108
    v_and_or_b32 v56, v36, s100, v56
    v_and_b32 v52, 0x87ff87ff, v108
    v_lshrrev_b32 v37, 7, v109
    v_and_or_b32 v57, v37, s100, v57
    v_and_b32 v53, 0x87ff87ff, v109
    v_lshrrev_b32 v36, 7, v110
    v_and_or_b32 v58, v36, s100, v58
    v_and_b32 v54, 0x87ff87ff, v110
    v_lshrrev_b32 v37, 7, v111
    v_and_or_b32 v59, v37, s100, v59
    v_and_b32 v55, 0x87ff87ff, v111
    v_add_f32 v18, v18, v28
    v_mul_f32 v28, 0x78800000, v28
    v_add_f32 v19, v19, v29
    v_mul_f32 v29, 0x78800000, v29
    v_add_f32 v18, v18, v30
    v_mul_f32 v30, 0x78800000, v30
    v_add_f32 v19, v19, v31
    v_mul_f32 v31, 0x78800000, v31
    v_cvt_pk_bf16_f32 v32, v28, v28
    v_cvt_pk_bf16_f32 v33, v29, v29
    v_cvt_pk_bf16_f32 v34, v30, v30
    v_cvt_pk_bf16_f32 v35, v31, v31
    v_and_b32 v60, v32, v13
    v_and_b32 v61, v32, v14
    v_and_b32 v62, v32, v15
    v_and_b32 v63, v32, v16
    s_nop 1
    v_mfma_f32_16x16x32_bf16 v[20:23], v[48:51], v[60:63], v[20:23]
    v_and_b32 v24, v33, v13
    v_and_b32 v25, v33, v14
    v_and_b32 v26, v33, v15
    v_and_b32 v27, v33, v16
    s_nop 1
    v_mfma_f32_16x16x32_bf16 v[20:23], v[52:55], v[24:27], v[20:23]
    v_lshrrev_b32 v36, 3, v112
    v_and_or_b32 v56, v36, s101, v56
    v_lshlrev_b32 v37, 1, v112
    v_and_or_b32 v56, v37, s80, v56
    v_and_b32 v48, 0x87ff87ff, v112
    v_lshrrev_b32 v37, 3, v113
    v_and_or_b32 v57, v37, s101, v57
    v_lshlrev_b32 v36, 1, v113
    v_and_or_b32 v57, v36, s80, v57
    v_and_b32 v49, 0x87ff87ff, v113
    v_lshrrev_b32 v36, 3, v114
    v_and_or_b32 v58, v36, s101, v58
    v_lshlrev_b32 v37, 1, v114
    v_and_or_b32 v58, v37, s80, v58
    v_and_b32 v50, 0x87ff87ff, v114
    v_lshrrev_b32 v37, 3, v115
    v_and_or_b32 v59, v37, s101, v59
    v_lshlrev_b32 v36, 1, v115
    v_and_or_b32 v59, v36, s80, v59
    v_and_b32 v51, 0x87ff87ff, v115
    v_and_b32 v60, v34, v13
    v_and_b32 v61, v34, v14
    v_and_b32 v62, v34, v15
    v_and_b32 v63, v34, v16
    s_nop 1
    v_mfma_f32_16x16x32_bf16 v[20:23], v[48:51], v[60:63], v[20:23]
    v_and_b32 v24, v35, v13
    v_and_b32 v25, v35, v14
    v_and_b32 v26, v35, v15
    v_and_b32 v27, v35, v16
    s_nop 1
    v_mfma_f32_16x16x32_bf16 v[20:23], v[56:59], v[24:27], v[20:23]
    s_or_b32 s62, 34, 0
    s_bitcmp1_b32 s97, 2
    s_getpc_b64 s[92:93]
    s_cbranch_scc1 PATCH_V
SD_100:
    s_waitcnt vmcnt(12)
    ds_read_b128 v[48:51], v9 offset:0
    ds_read_b128 v[52:55], v10 offset:0
    ds_read_b128 v[56:59], v11 offset:0
    ds_read_b128 v[60:63], v12 offset:0
    s_waitcnt lgkmcnt(3)
    v_mfma_f32_16x16x32_bf16 v[24:27], v[48:51], v[64:67], 0
    s_waitcnt lgkmcnt(2)
    v_mfma_f32_16x16x32_bf16 v[24:27], v[52:55], v[68:71], v[24:27]
    s_waitcnt lgkmcnt(1)
    v_mfma_f32_16x16x32_bf16 v[24:27], v[56:59], v[72:75], v[24:27]
    s_waitcnt lgkmcnt(0)
    v_mfma_f32_16x16x32_bf16 v[24:27], v[60:63], v[76:79], v[24:27]
    s_nop 7
    v_fma_f32 v28, v24, s55, v17
    v_fma_f32 v29, v25, s55, v17
    v_fma_f32 v30, v26, s55, v17
    v_fma_f32 v31, v27, s55, v17
    v_max3_f32 v36, v28, v29, v30
    v_max_f32 v36, v36, v31
    v_cmp_lt_f32 vcc, s56, v36
    s_cbranch_vccnz RS_103
RB_104:
    v_exp_f32 v28, v28
    v_exp_f32 v29, v29
    v_exp_f32 v30, v30
    v_exp_f32 v31, v31
    v_cvt_pk_bf16_f32 v32, v28, v28
    v_add_f32 v18, v18, v28
    v_cvt_pk_bf16_f32 v33, v29, v29
    v_add_f32 v19, v19, v29
    v_cvt_pk_bf16_f32 v34, v30, v30
    v_add_f32 v18, v18, v30
    v_cvt_pk_bf16_f32 v35, v31, v31
    v_add_f32 v19, v19, v31
    s_waitcnt vmcnt(8)
    v_and_b32 v48, v32, v13
    v_and_b32 v49, v32, v14
    v_and_b32 v50, v32, v15
    v_and_b32 v51, v32, v16
    v_and_b32 v52, v33, v13
    v_and_b32 v53, v33, v14
    v_and_b32 v54, v33, v15
    v_and_b32 v55, v33, v16
    v_mfma_f32_16x16x32_bf16 v[20:23], a[0:3], v[48:51], v[20:23]
    v_and_b32 v56, v34, v13
    v_and_b32 v57, v34, v14
    v_and_b32 v58, v34, v15
    v_and_b32 v59, v34, v16
    v_mfma_f32_16x16x32_bf16 v[20:23], a[4:7], v[52:55], v[20:23]
    v_and_b32 v60, v35, v13
    v_and_b32 v61, v35, v14
    v_and_b32 v62, v35, v15
    v_and_b32 v63, v35, v16
    v_mfma_f32_16x16x32_bf16 v[20:23], a[8:11], v[56:59], v[20:23]
    s_nop 0
    v_mfma_f32_16x16x32_bf16 v[20:23], a[12:15], v[60:63], v[20:23]
    s_add_u32 s76, s90, 320
    s_mul_i32 s54, s76, s85
    s_add_u32 s54, s54, s53
    s_add_u32 m0, s59, 0
    s_nop 0
    buffer_load_dwordx4 v4, s[4:7], s54 offen offset:0 nt lds
    buffer_load_dwordx4 v5, s[4:7], s54 offen offset:1024 nt lds
    buffer_load_dwordx4 v6, s[4:7], s54 offen offset:2048 nt lds
    buffer_load_dwordx4 v7, s[4:7], s54 offen offset:3072 nt lds
    buffer_load_dwordx4 a[0:3], v8, s[8:11], s54 offen offset:0 nt
    buffer_load_dwordx4 a[4:7], v8, s[8:11], s54 offen offset:256 nt
    buffer_load_dwordx4 a[8:11], v8, s[8:11], s54 offen offset:512 nt
    buffer_load_dwordx4 a[12:15], v8, s[8:11], s54 offen offset:768 nt
    s_bitcmp1_b32 s99, 3
    s_cbranch_scc1 SL_105
    v_accvgpr_read_b32 v48, a84
    v_accvgpr_read_b32 v49, a85
    v_accvgpr_read_b32 v50, a86
    v_accvgpr_read_b32 v51, a87
    v_lshrrev_b32 v36, 11, v48
    v_and_b32 v60, 0x000f000f, v36
    v_and_b32 v48, 0x87ff87ff, v48
    v_lshrrev_b32 v37, 11, v49
    v_and_b32 v61, 0x000f000f, v37
    v_and_b32 v49, 0x87ff87ff, v49
    v_lshrrev_b32 v36, 11, v50
    v_and_b32 v62, 0x000f000f, v36
    v_and_b32 v50, 0x87ff87ff, v50
    v_lshrrev_b32 v37, 11, v51
    v_and_b32 v63, 0x000f000f, v37
    v_and_b32 v51, 0x87ff87ff, v51
    s_nop 1
    v_mfma_f32_16x16x32_bf16 v[24:27], v[48:51], v[64:67], 0
    v_accvgpr_read_b32 v52, a88
    v_accvgpr_read_b32 v53, a89
    v_accvgpr_read_b32 v54, a90
    v_accvgpr_read_b32 v55, a91
    v_lshrrev_b32 v36, 7, v52
    v_and_or_b32 v60, v36, s100, v60
    v_and_b32 v52, 0x87ff87ff, v52
    v_lshrrev_b32 v37, 7, v53
    v_and_or_b32 v61, v37, s100, v61
    v_and_b32 v53, 0x87ff87ff, v53
    v_lshrrev_b32 v36, 7, v54
    v_and_or_b32 v62, v36, s100, v62
    v_and_b32 v54, 0x87ff87ff, v54
    v_lshrrev_b32 v37, 7, v55
    v_and_or_b32 v63, v37, s100, v63
    v_and_b32 v55, 0x87ff87ff, v55
    s_nop 1
    v_mfma_f32_16x16x32_bf16 v[24:27], v[52:55], v[68:71], v[24:27]
    v_accvgpr_read_b32 v56, a92
    v_accvgpr_read_b32 v57, a93
    v_accvgpr_read_b32 v58, a94
    v_accvgpr_read_b32 v59, a95
    v_lshrrev_b32 v36, 3, v56
    v_and_or_b32 v60, v36, s101, v60
    v_lshlrev_b32 v37, 1, v56
    v_and_or_b32 v60, v37, s80, v60
    v_and_b32 v56, 0x87ff87ff, v56
    v_lshrrev_b32 v37, 3, v57
    v_and_or_b32 v61, v37, s101, v61
    v_lshlrev_b32 v36, 1, v57
    v_and_or_b32 v61, v36, s80, v61
    v_and_b32 v57, 0x87ff87ff, v57
    v_lshrrev_b32 v36, 3, v58
    v_and_or_b32 v62, v36, s101, v62
    v_lshlrev_b32 v37, 1, v58
    v_and_or_b32 v62, v37, s80, v62
    v_and_b32 v58, 0x87ff87ff, v58
    v_lshrrev_b32 v37, 3, v59
    v_and_or_b32 v63, v37, s101, v63
    v_lshlrev_b32 v36, 1, v59
    v_and_or_b32 v63, v36, s80, v63
    v_and_b32 v59, 0x87ff87ff, v59
    s_nop 1
    v_mfma_f32_16x16x32_bf16 v[24:27], v[56:59], v[72:75], v[24:27]
    v_mfma_f32_16x16x32_bf16 v[24:27], v[60:63], v[76:79], v[24:27]
    s_or_b32 s62, 3, 0
    s_bitcmp1_b32 s96, 3
    s_getpc_b64 s[92:93]
    s_cbranch_scc1 PATCH_K
    v_lshrrev_b32 v36, 11, v116
    v_and_b32 v56, 0x000f000f, v36
    v_and_b32 v48, 0x87ff87ff, v116
    v_lshrrev_b32 v37, 11, v117
    v_and_b32 v57, 0x000f000f, v37
    v_and_b32 v49, 0x87ff87ff, v117
    v_lshrrev_b32 v36, 11, v118
    v_and_b32 v58, 0x000f000f, v36
    v_and_b32 v50, 0x87ff87ff, v118
    v_lshrrev_b32 v37, 11, v119
    v_and_b32 v59, 0x000f000f, v37
    v_and_b32 v51, 0x87ff87ff, v119
    v_fmamk_f32 v28, v24, 0x568293ee, v17
    v_fmamk_f32 v29, v25, 0x568293ee, v17
    v_fmamk_f32 v30, v26, 0x568293ee, v17
    v_fmamk_f32 v31, v27, 0x568293ee, v17
    v_max3_f32 v36, v28, v29, v30
    v_max_f32 v36, v36, v31
    v_cmp_lt_f32 vcc, s56, v36
    s_cbranch_vccnz RS_107
RB_108:
    v_exp_f32 v28, v28
    v_exp_f32 v29, v29
    v_exp_f32 v30, v30
    v_exp_f32 v31, v31
    v_lshrrev_b32 v36, 7, v120
    v_and_or_b32 v56, v36, s100, v56
    v_and_b32 v52, 0x87ff87ff, v120
    v_lshrrev_b32 v37, 7, v121
    v_and_or_b32 v57, v37, s100, v57
    v_and_b32 v53, 0x87ff87ff, v121
    v_lshrrev_b32 v36, 7, v122
    v_and_or_b32 v58, v36, s100, v58
    v_and_b32 v54, 0x87ff87ff, v122
    v_lshrrev_b32 v37, 7, v123
    v_and_or_b32 v59, v37, s100, v59
    v_and_b32 v55, 0x87ff87ff, v123
    v_add_f32 v18, v18, v28
    v_mul_f32 v28, 0x78800000, v28
    v_add_f32 v19, v19, v29
    v_mul_f32 v29, 0x78800000, v29
    v_add_f32 v18, v18, v30
    v_mul_f32 v30, 0x78800000, v30
    v_add_f32 v19, v19, v31
    v_mul_f32 v31, 0x78800000, v31
    v_cvt_pk_bf16_f32 v32, v28, v28
    v_cvt_pk_bf16_f32 v33, v29, v29
    v_cvt_pk_bf16_f32 v34, v30, v30
    v_cvt_pk_bf16_f32 v35, v31, v31
    v_and_b32 v60, v32, v13
    v_and_b32 v61, v32, v14
    v_and_b32 v62, v32, v15
    v_and_b32 v63, v32, v16
    s_nop 1
    v_mfma_f32_16x16x32_bf16 v[20:23], v[48:51], v[60:63], v[20:23]
    v_and_b32 v24, v33, v13
    v_and_b32 v25, v33, v14
    v_and_b32 v26, v33, v15
    v_and_b32 v27, v33, v16
    s_nop 1
    v_mfma_f32_16x16x32_bf16 v[20:23], v[52:55], v[24:27], v[20:23]
    v_lshrrev_b32 v36, 3, v124
    v_and_or_b32 v56, v36, s101, v56
    v_lshlrev_b32 v37, 1, v124
    v_and_or_b32 v56, v37, s80, v56
    v_and_b32 v48, 0x87ff87ff, v124
    v_lshrrev_b32 v37, 3, v125
    v_and_or_b32 v57, v37, s101, v57
    v_lshlrev_b32 v36, 1, v125
    v_and_or_b32 v57, v36, s80, v57
    v_and_b32 v49, 0x87ff87ff, v125
    v_lshrrev_b32 v36, 3, v126
    v_and_or_b32 v58, v36, s101, v58
    v_lshlrev_b32 v37, 1, v126
    v_and_or_b32 v58, v37, s80, v58
    v_and_b32 v50, 0x87ff87ff, v126
    v_lshrrev_b32 v37, 3, v127
    v_and_or_b32 v59, v37, s101, v59
    v_lshlrev_b32 v36, 1, v127
    v_and_or_b32 v59, v36, s80, v59
    v_and_b32 v51, 0x87ff87ff, v127
    v_and_b32 v60, v34, v13
    v_and_b32 v61, v34, v14
    v_and_b32 v62, v34, v15
    v_and_b32 v63, v34, v16
    s_nop 1
    v_mfma_f32_16x16x32_bf16 v[20:23], v[48:51], v[60:63], v[20:23]
    v_and_b32 v24, v35, v13
    v_and_b32 v25, v35, v14
    v_and_b32 v26, v35, v15
    v_and_b32 v27, v35, v16
    s_nop 1
    v_mfma_f32_16x16x32_bf16 v[20:23], v[56:59], v[24:27], v[20:23]
    s_or_b32 s62, 35, 0
    s_bitcmp1_b32 s97, 3
    s_getpc_b64 s[92:93]
    s_cbranch_scc1 PATCH_V
SD_106:
    s_waitcnt vmcnt(12)
    ds_read_b128 v[48:51], v9 offset:4096
    ds_read_b128 v[52:55], v10 offset:4096
    ds_read_b128 v[56:59], v11 offset:4096
    ds_read_b128 v[60:63], v12 offset:4096
    s_waitcnt lgkmcnt(3)
    v_mfma_f32_16x16x32_bf16 v[24:27], v[48:51], v[64:67], 0
    s_waitcnt lgkmcnt(2)
    v_mfma_f32_16x16x32_bf16 v[24:27], v[52:55], v[68:71], v[24:27]
    s_waitcnt lgkmcnt(1)
    v_mfma_f32_16x16x32_bf16 v[24:27], v[56:59], v[72:75], v[24:27]
    s_waitcnt lgkmcnt(0)
    v_mfma_f32_16x16x32_bf16 v[24:27], v[60:63], v[76:79], v[24:27]
    s_nop 7
    v_fma_f32 v28, v24, s55, v17
    v_fma_f32 v29, v25, s55, v17
    v_fma_f32 v30, v26, s55, v17
    v_fma_f32 v31, v27, s55, v17
    v_max3_f32 v36, v28, v29, v30
    v_max_f32 v36, v36, v31
    v_cmp_lt_f32 vcc, s56, v36
    s_cbranch_vccnz RS_109
RB_110:
    v_exp_f32 v28, v28
    v_exp_f32 v29, v29
    v_exp_f32 v30, v30
    v_exp_f32 v31, v31
    v_cvt_pk_bf16_f32 v32, v28, v28
    v_add_f32 v18, v18, v28
    v_cvt_pk_bf16_f32 v33, v29, v29
    v_add_f32 v19, v19, v29
    v_cvt_pk_bf16_f32 v34, v30, v30
    v_add_f32 v18, v18, v30
    v_cvt_pk_bf16_f32 v35, v31, v31
    v_add_f32 v19, v19, v31
    s_waitcnt vmcnt(8)
    v_and_b32 v48, v32, v13
    v_and_b32 v49, v32, v14
    v_and_b32 v50, v32, v15
    v_and_b32 v51, v32, v16
    v_and_b32 v52, v33, v13
    v_and_b32 v53, v33, v14
    v_and_b32 v54, v33, v15
    v_and_b32 v55, v33, v16
    v_mfma_f32_16x16x32_bf16 v[20:23], a[16:19], v[48:51], v[20:23]
    v_and_b32 v56, v34, v13
    v_and_b32 v57, v34, v14
    v_and_b32 v58, v34, v15
    v_and_b32 v59, v34, v16
    v_mfma_f32_16x16x32_bf16 v[20:23], a[20:23], v[52:55], v[20:23]
    v_and_b32 v60, v35, v13
    v_and_b32 v61, v35, v14
    v_and_b32 v62, v35, v15
    v_and_b32 v63, v35, v16
    v_mfma_f32_16x16x32_bf16 v[20:23], a[24:27], v[56:59], v[20:23]
    s_nop 0
    v_mfma_f32_16x16x32_bf16 v[20:23], a[28:31], v[60:63], v[20:23]
    s_add_u32 s77, s90, 336
    s_mul_i32 s54, s77, s85
    s_add_u32 s54, s54, s53
    s_add_u32 m0, s59, 4096
    s_nop 0
    buffer_load_dwordx4 v4, s[4:7], s54 offen offset:0 nt lds
    buffer_load_dwordx4 v5, s[4:7], s54 offen offset:1024 nt lds
    buffer_load_dwordx4 v6, s[4:7], s54 offen offset:2048 nt lds
    buffer_load_dwordx4 v7, s[4:7], s54 offen offset:3072 nt lds
    buffer_load_dwordx4 a[16:19], v8, s[8:11], s54 offen offset:0 nt
    buffer_load_dwordx4 a[20:23], v8, s[8:11], s54 offen offset:256 nt
    buffer_load_dwordx4 a[24:27], v8, s[8:11], s54 offen offset:512 nt
    buffer_load_dwordx4 a[28:31], v8, s[8:11], s54 offen offset:768 nt
    s_bitcmp1_b32 s99, 4
    s_cbranch_scc1 SL_111
    v_accvgpr_read_b32 v48, a96
    v_accvgpr_read_b32 v49, a97
    v_accvgpr_read_b32 v50, a98
    v_accvgpr_read_b32 v51, a99
    v_lshrrev_b32 v36, 11, v48
    v_and_b32 v60, 0x000f000f, v36
    v_and_b32 v48, 0x87ff87ff, v48
    v_lshrrev_b32 v37, 11, v49
    v_and_b32 v61, 0x000f000f, v37
    v_and_b32 v49, 0x87ff87ff, v49
    v_lshrrev_b32 v36, 11, v50
    v_and_b32 v62, 0x000f000f, v36
    v_and_b32 v50, 0x87ff87ff, v50
    v_lshrrev_b32 v37, 11, v51
    v_and_b32 v63, 0x000f000f, v37
    v_and_b32 v51, 0x87ff87ff, v51
    s_nop 1
    v_mfma_f32_16x16x32_bf16 v[24:27], v[48:51], v[64:67], 0
    v_accvgpr_read_b32 v52, a100
    v_accvgpr_read_b32 v53, a101
    v_accvgpr_read_b32 v54, a102
    v_accvgpr_read_b32 v55, a103
    v_lshrrev_b32 v36, 7, v52
    v_and_or_b32 v60, v36, s100, v60
    v_and_b32 v52, 0x87ff87ff, v52
    v_lshrrev_b32 v37, 7, v53
    v_and_or_b32 v61, v37, s100, v61
    v_and_b32 v53, 0x87ff87ff, v53
    v_lshrrev_b32 v36, 7, v54
    v_and_or_b32 v62, v36, s100, v62
    v_and_b32 v54, 0x87ff87ff, v54
    v_lshrrev_b32 v37, 7, v55
    v_and_or_b32 v63, v37, s100, v63
    v_and_b32 v55, 0x87ff87ff, v55
    s_nop 1
    v_mfma_f32_16x16x32_bf16 v[24:27], v[52:55], v[68:71], v[24:27]
    v_accvgpr_read_b32 v56, a104
    v_accvgpr_read_b32 v57, a105
    v_accvgpr_read_b32 v58, a106
    v_accvgpr_read_b32 v59, a107
    v_lshrrev_b32 v36, 3, v56
    v_and_or_b32 v60, v36, s101, v60
    v_lshlrev_b32 v37, 1, v56
    v_and_or_b32 v60, v37, s80, v60
    v_and_b32 v56, 0x87ff87ff, v56
    v_lshrrev_b32 v37, 3, v57
    v_and_or_b32 v61, v37, s101, v61
    v_lshlrev_b32 v36, 1, v57
    v_and_or_b32 v61, v36, s80, v61
    v_and_b32 v57, 0x87ff87ff, v57
    v_lshrrev_b32 v36, 3, v58
    v_and_or_b32 v62, v36, s101, v62
    v_lshlrev_b32 v37, 1, v58
    v_and_or_b32 v62, v37, s80, v62
    v_and_b32 v58, 0x87ff87ff, v58
    v_lshrrev_b32 v37, 3, v59
    v_and_or_b32 v63, v37, s101, v63
    v_lshlrev_b32 v36, 1, v59
    v_and_or_b32 v63, v36, s80, v63
    v_and_b32 v59, 0x87ff87ff, v59
    s_nop 1
    v_mfma_f32_16x16x32_bf16 v[24:27], v[56:59], v[72:75], v[24:27]
    v_mfma_f32_16x16x32_bf16 v[24:27], v[60:63], v[76:79], v[24:27]
    s_or_b32 s62, 4, 0
    s_bitcmp1_b32 s96, 4
    s_getpc_b64 s[92:93]
    s_cbranch_scc1 PATCH_K
    v_lshrrev_b32 v36, 11, v128
    v_and_b32 v56, 0x000f000f, v36
    v_and_b32 v48, 0x87ff87ff, v128
    v_lshrrev_b32 v37, 11, v129
    v_and_b32 v57, 0x000f000f, v37
    v_and_b32 v49, 0x87ff87ff, v129
    v_lshrrev_b32 v36, 11, v130
    v_and_b32 v58, 0x000f000f, v36
    v_and_b32 v50, 0x87ff87ff, v130
    v_lshrrev_b32 v37, 11, v131
    v_and_b32 v59, 0x000f000f, v37
    v_and_b32 v51, 0x87ff87ff, v131
    v_fmamk_f32 v28, v24, 0x568293ee, v17
    v_fmamk_f32 v29, v25, 0x568293ee, v17
    v_fmamk_f32 v30, v26, 0x568293ee, v17
    v_fmamk_f32 v31, v27, 0x568293ee, v17
    v_max3_f32 v36, v28, v29, v30
    v_max_f32 v36, v36, v31
    v_cmp_lt_f32 vcc, s56, v36
    s_cbranch_vccnz RS_113
RB_114:
    v_exp_f32 v28, v28
    v_exp_f32 v29, v29
    v_exp_f32 v30, v30
    v_exp_f32 v31, v31
    v_lshrrev_b32 v36, 7, v132
    v_and_or_b32 v56, v36, s100, v56
    v_and_b32 v52, 0x87ff87ff, v132
    v_lshrrev_b32 v37, 7, v133
    v_and_or_b32 v57, v37, s100, v57
    v_and_b32 v53, 0x87ff87ff, v133
    v_lshrrev_b32 v36, 7, v134
    v_and_or_b32 v58, v36, s100, v58
    v_and_b32 v54, 0x87ff87ff, v134
    v_lshrrev_b32 v37, 7, v135
    v_and_or_b32 v59, v37, s100, v59
    v_and_b32 v55, 0x87ff87ff, v135
    v_add_f32 v18, v18, v28
    v_mul_f32 v28, 0x78800000, v28
    v_add_f32 v19, v19, v29
    v_mul_f32 v29, 0x78800000, v29
    v_add_f32 v18, v18, v30
    v_mul_f32 v30, 0x78800000, v30
    v_add_f32 v19, v19, v31
    v_mul_f32 v31, 0x78800000, v31
    v_cvt_pk_bf16_f32 v32, v28, v28
    v_cvt_pk_bf16_f32 v33, v29, v29
    v_cvt_pk_bf16_f32 v34, v30, v30
    v_cvt_pk_bf16_f32 v35, v31, v31
    v_and_b32 v60, v32, v13
    v_and_b32 v61, v32, v14
    v_and_b32 v62, v32, v15
    v_and_b32 v63, v32, v16
    s_nop 1
    v_mfma_f32_16x16x32_bf16 v[20:23], v[48:51], v[60:63], v[20:23]
    v_and_b32 v24, v33, v13
    v_and_b32 v25, v33, v14
    v_and_b32 v26, v33, v15
    v_and_b32 v27, v33, v16
    s_nop 1
    v_mfma_f32_16x16x32_bf16 v[20:23], v[52:55], v[24:27], v[20:23]
    v_lshrrev_b32 v36, 3, v136
    v_and_or_b32 v56, v36, s101, v56
    v_lshlrev_b32 v37, 1, v136
    v_and_or_b32 v56, v37, s80, v56
    v_and_b32 v48, 0x87ff87ff, v136
    v_lshrrev_b32 v37, 3, v137
    v_and_or_b32 v57, v37, s101, v57
    v_lshlrev_b32 v36, 1, v137
    v_and_or_b32 v57, v36, s80, v57
    v_and_b32 v49, 0x87ff87ff, v137
    v_lshrrev_b32 v36, 3, v138
    v_and_or_b32 v58, v36, s101, v58
    v_lshlrev_b32 v37, 1, v138
    v_and_or_b32 v58, v37, s80, v58
    v_and_b32 v50, 0x87ff87ff, v138
    v_lshrrev_b32 v37, 3, v139
    v_and_or_b32 v59, v37, s101, v59
    v_lshlrev_b32 v36, 1, v139
    v_and_or_b32 v59, v36, s80, v59
    v_and_b32 v51, 0x87ff87ff, v139
    v_and_b32 v60, v34, v13
    v_and_b32 v61, v34, v14
    v_and_b32 v62, v34, v15
    v_and_b32 v63, v34, v16
    s_nop 1
    v_mfma_f32_16x16x32_bf16 v[20:23], v[48:51], v[60:63], v[20:23]
    v_and_b32 v24, v35, v13
    v_and_b32 v25, v35, v14
    v_and_b32 v26, v35, v15
    v_and_b32 v27, v35, v16
    s_nop 1
    v_mfma_f32_16x16x32_bf16 v[20:23], v[56:59], v[24:27], v[20:23]
    s_or_b32 s62, 36, 0
    s_bitcmp1_b32 s97, 4
    s_getpc_b64 s[92:93]
    s_cbranch_scc1 PATCH_V
SD_112:
    s_waitcnt vmcnt(12)
    ds_read_b128 v[48:51], v9 offset:0
    ds_read_b128 v[52:55], v10 offset:0
    ds_read_b128 v[56:59], v11 offset:0
    ds_read_b128 v[60:63], v12 offset:0
    s_waitcnt lgkmcnt(3)
    v_mfma_f32_16x16x32_bf16 v[24:27], v[48:51], v[64:67], 0
    s_waitcnt lgkmcnt(2)
    v_mfma_f32_16x16x32_bf16 v[24:27], v[52:55], v[68:71], v[24:27]
    s_waitcnt lgkmcnt(1)
    v_mfma_f32_16x16x32_bf16 v[24:27], v[56:59], v[72:75], v[24:27]
    s_waitcnt lgkmcnt(0)
    v_mfma_f32_16x16x32_bf16 v[24:27], v[60:63], v[76:79], v[24:27]
    s_nop 7
    v_fma_f32 v28, v24, s55, v17
    v_fma_f32 v29, v25, s55, v17
    v_fma_f32 v30, v26, s55, v17
    v_fma_f32 v31, v27, s55, v17
    v_max3_f32 v36, v28, v29, v30
    v_max_f32 v36, v36, v31
    v_cmp_lt_f32 vcc, s56, v36
    s_cbranch_vccnz RS_115
RB_116:
    v_exp_f32 v28, v28
    v_exp_f32 v29, v29
    v_exp_f32 v30, v30
    v_exp_f32 v31, v31
    v_cvt_pk_bf16_f32 v32, v28, v28
    v_add_f32 v18, v18, v28
    v_cvt_pk_bf16_f32 v33, v29, v29
    v_add_f32 v19, v19, v29
    v_cvt_pk_bf16_f32 v34, v30, v30
    v_add_f32 v18, v18, v30
    v_cvt_pk_bf16_f32 v35, v31, v31
    v_add_f32 v19, v19, v31
    s_waitcnt vmcnt(8)
    v_and_b32 v48, v32, v13
    v_and_b32 v49, v32, v14
    v_and_b32 v50, v32, v15
    v_and_b32 v51, v32, v16
    v_and_b32 v52, v33, v13
    v_and_b32 v53, v33, v14
    v_and_b32 v54, v33, v15
    v_and_b32 v55, v33, v16
    v_mfma_f32_16x16x32_bf16 v[20:23], a[0:3], v[48:51], v[20:23]
    v_and_b32 v56, v34, v13
    v_and_b32 v57, v34, v14
    v_and_b32 v58, v34, v15
    v_and_b32 v59, v34, v16
    v_mfma_f32_16x16x32_bf16 v[20:23], a[4:7], v[52:55], v[20:23]
    v_and_b32 v60, v35, v13
    v_and_b32 v61, v35, v14
    v_and_b32 v62, v35, v15
    v_and_b32 v63, v35, v16
    v_mfma_f32_16x16x32_bf16 v[20:23], a[8:11], v[56:59], v[20:23]
    s_nop 0
    v_mfma_f32_16x16x32_bf16 v[20:23], a[12:15], v[60:63], v[20:23]
    s_cmp_eq_u32 s83, 0
    s_cbranch_scc0 ML_117
    s_add_u32 s76, s90, 352
    s_mul_i32 s54, s76, s85
    s_add_u32 s54, s54, s53
    s_add_u32 m0, s59, 0
    s_nop 0
    buffer_load_dwordx4 v4, s[4:7], s54 offen offset:0 sc1 lds
    buffer_load_dwordx4 v5, s[4:7], s54 offen offset:1024 sc1 lds
    buffer_load_dwordx4 v6, s[4:7], s54 offen offset:2048 sc1 lds
    buffer_load_dwordx4 v7, s[4:7], s54 offen offset:3072 sc1 lds
    buffer_load_dwordx4 a[0:3], v8, s[8:11], s54 offen offset:0 sc1
    buffer_load_dwordx4 a[4:7], v8, s[8:11], s54 offen offset:256 sc1
    buffer_load_dwordx4 a[8:11], v8, s[8:11], s54 offen offset:512 sc1
    buffer_load_dwordx4 a[12:15], v8, s[8:11], s54 offen offset:768 sc1
    s_branch MJ_118
ML_117:
    s_add_u32 s76, s90, 352
    s_mul_i32 s54, s76, s85
    s_add_u32 s54, s54, s53
    s_add_u32 m0, s59, 0
    s_nop 0
    buffer_load_dwordx4 v4, s[4:7], s54 offen offset:0 nt lds
    buffer_load_dwordx4 v5, s[4:7], s54 offen offset:1024 nt lds
    buffer_load_dwordx4 v6, s[4:7], s54 offen offset:2048 nt lds
    buffer_load_dwordx4 v7, s[4:7], s54 offen offset:3072 nt lds
    buffer_load_dwordx4 a[0:3], v8, s[8:11], s54 offen offset:0 nt
    buffer_load_dwordx4 a[4:7], v8, s[8:11], s54 offen offset:256 nt
    buffer_load_dwordx4 a[8:11], v8, s[8:11], s54 offen offset:512 nt
    buffer_load_dwordx4 a[12:15], v8, s[8:11], s54 offen offset:768 nt
MJ_118:
    s_bitcmp1_b32 s99, 5
    s_cbranch_scc1 SL_119
    v_accvgpr_read_b32 v48, a108
    v_accvgpr_read_b32 v49, a109
    v_accvgpr_read_b32 v50, a110
    v_accvgpr_read_b32 v51, a111
    v_lshrrev_b32 v36, 11, v48
    v_and_b32 v60, 0x000f000f, v36
    v_and_b32 v48, 0x87ff87ff, v48
    v_lshrrev_b32 v37, 11, v49
    v_and_b32 v61, 0x000f000f, v37
    v_and_b32 v49, 0x87ff87ff, v49
    v_lshrrev_b32 v36, 11, v50
    v_and_b32 v62, 0x000f000f, v36
    v_and_b32 v50, 0x87ff87ff, v50
    v_lshrrev_b32 v37, 11, v51
    v_and_b32 v63, 0x000f000f, v37
    v_and_b32 v51, 0x87ff87ff, v51
    s_nop 1
    v_mfma_f32_16x16x32_bf16 v[24:27], v[48:51], v[64:67], 0
    v_accvgpr_read_b32 v52, a112
    v_accvgpr_read_b32 v53, a113
    v_accvgpr_read_b32 v54, a114
    v_accvgpr_read_b32 v55, a115
    v_lshrrev_b32 v36, 7, v52
    v_and_or_b32 v60, v36, s100, v60
    v_and_b32 v52, 0x87ff87ff, v52
    v_lshrrev_b32 v37, 7, v53
    v_and_or_b32 v61, v37, s100, v61
    v_and_b32 v53, 0x87ff87ff, v53
    v_lshrrev_b32 v36, 7, v54
    v_and_or_b32 v62, v36, s100, v62
    v_and_b32 v54, 0x87ff87ff, v54
    v_lshrrev_b32 v37, 7, v55
    v_and_or_b32 v63, v37, s100, v63
    v_and_b32 v55, 0x87ff87ff, v55
    s_nop 1
    v_mfma_f32_16x16x32_bf16 v[24:27], v[52:55], v[68:71], v[24:27]
    v_accvgpr_read_b32 v56, a116
    v_accvgpr_read_b32 v57, a117
    v_accvgpr_read_b32 v58, a118
    v_accvgpr_read_b32 v59, a119
    v_lshrrev_b32 v36, 3, v56
    v_and_or_b32 v60, v36, s101, v60
    v_lshlrev_b32 v37, 1, v56
    v_and_or_b32 v60, v37, s80, v60
    v_and_b32 v56, 0x87ff87ff, v56
    v_lshrrev_b32 v37, 3, v57
    v_and_or_b32 v61, v37, s101, v61
    v_lshlrev_b32 v36, 1, v57
    v_and_or_b32 v61, v36, s80, v61
    v_and_b32 v57, 0x87ff87ff, v57
    v_lshrrev_b32 v36, 3, v58
    v_and_or_b32 v62, v36, s101, v62
    v_lshlrev_b32 v37, 1, v58
    v_and_or_b32 v62, v37, s80, v62
    v_and_b32 v58, 0x87ff87ff, v58
    v_lshrrev_b32 v37, 3, v59
    v_and_or_b32 v63, v37, s101, v63
    v_lshlrev_b32 v36, 1, v59
    v_and_or_b32 v63, v36, s80, v63
    v_and_b32 v59, 0x87ff87ff, v59
    s_nop 1
    v_mfma_f32_16x16x32_bf16 v[24:27], v[56:59], v[72:75], v[24:27]
    v_mfma_f32_16x16x32_bf16 v[24:27], v[60:63], v[76:79], v[24:27]
    s_or_b32 s62, 5, 0
    s_bitcmp1_b32 s96, 5
    s_getpc_b64 s[92:93]
    s_cbranch_scc1 PATCH_K
    v_lshrrev_b32 v36, 11, v140
    v_and_b32 v56, 0x000f000f, v36
    v_and_b32 v48, 0x87ff87ff, v140
    v_lshrrev_b32 v37, 11, v141
    v_and_b32 v57, 0x000f000f, v37
    v_and_b32 v49, 0x87ff87ff, v141
    v_lshrrev_b32 v36, 11, v142
    v_and_b32 v58, 0x000f000f, v36
    v_and_b32 v50, 0x87ff87ff, v142
    v_lshrrev_b32 v37, 11, v143
    v_and_b32 v59, 0x000f000f, v37
    v_and_b32 v51, 0x87ff87ff, v143
    v_fmamk_f32 v28, v24, 0x568293ee, v17
    v_fmamk_f32 v29, v25, 0x568293ee, v17
    v_fmamk_f32 v30, v26, 0x568293ee, v17
    v_fmamk_f32 v31, v27, 0x568293ee, v17
    v_max3_f32 v36, v28, v29, v30
    v_max_f32 v36, v36, v31
    v_cmp_lt_f32 vcc, s56, v36
    s_cbranch_vccnz RS_121
RB_122:
    v_exp_f32 v28, v28
    v_exp_f32 v29, v29
    v_exp_f32 v30, v30
    v_exp_f32 v31, v31
    v_lshrrev_b32 v36, 7, v144
    v_and_or_b32 v56, v36, s100, v56
    v_and_b32 v52, 0x87ff87ff, v144
    v_lshrrev_b32 v37, 7, v145
    v_and_or_b32 v57, v37, s100, v57
    v_and_b32 v53, 0x87ff87ff, v145
    v_lshrrev_b32 v36, 7, v146
    v_and_or_b32 v58, v36, s100, v58
    v_and_b32 v54, 0x87ff87ff, v146
    v_lshrrev_b32 v37, 7, v147
    v_and_or_b32 v59, v37, s100, v59
    v_and_b32 v55, 0x87ff87ff, v147
    v_add_f32 v18, v18, v28
    v_mul_f32 v28, 0x78800000, v28
    v_add_f32 v19, v19, v29
    v_mul_f32 v29, 0x78800000, v29
    v_add_f32 v18, v18, v30
    v_mul_f32 v30, 0x78800000, v30
    v_add_f32 v19, v19, v31
    v_mul_f32 v31, 0x78800000, v31
    v_cvt_pk_bf16_f32 v32, v28, v28
    v_cvt_pk_bf16_f32 v33, v29, v29
    v_cvt_pk_bf16_f32 v34, v30, v30
    v_cvt_pk_bf16_f32 v35, v31, v31
    v_and_b32 v60, v32, v13
    v_and_b32 v61, v32, v14
    v_and_b32 v62, v32, v15
    v_and_b32 v63, v32, v16
    s_nop 1
    v_mfma_f32_16x16x32_bf16 v[20:23], v[48:51], v[60:63], v[20:23]
    v_and_b32 v24, v33, v13
    v_and_b32 v25, v33, v14
    v_and_b32 v26, v33, v15
    v_and_b32 v27, v33, v16
    s_nop 1
    v_mfma_f32_16x16x32_bf16 v[20:23], v[52:55], v[24:27], v[20:23]
    v_lshrrev_b32 v36, 3, v148
    v_and_or_b32 v56, v36, s101, v56
    v_lshlrev_b32 v37, 1, v148
    v_and_or_b32 v56, v37, s80, v56
    v_and_b32 v48, 0x87ff87ff, v148
    v_lshrrev_b32 v37, 3, v149
    v_and_or_b32 v57, v37, s101, v57
    v_lshlrev_b32 v36, 1, v149
    v_and_or_b32 v57, v36, s80, v57
    v_and_b32 v49, 0x87ff87ff, v149
    v_lshrrev_b32 v36, 3, v150
    v_and_or_b32 v58, v36, s101, v58
    v_lshlrev_b32 v37, 1, v150
    v_and_or_b32 v58, v37, s80, v58
    v_and_b32 v50, 0x87ff87ff, v150
    v_lshrrev_b32 v37, 3, v151
    v_and_or_b32 v59, v37, s101, v59
    v_lshlrev_b32 v36, 1, v151
    v_and_or_b32 v59, v36, s80, v59
    v_and_b32 v51, 0x87ff87ff, v151
    v_and_b32 v60, v34, v13
    v_and_b32 v61, v34, v14
    v_and_b32 v62, v34, v15
    v_and_b32 v63, v34, v16
    s_nop 1
    v_mfma_f32_16x16x32_bf16 v[20:23], v[48:51], v[60:63], v[20:23]
    v_and_b32 v24, v35, v13
    v_and_b32 v25, v35, v14
    v_and_b32 v26, v35, v15
    v_and_b32 v27, v35, v16
    s_nop 1
    v_mfma_f32_16x16x32_bf16 v[20:23], v[56:59], v[24:27], v[20:23]
    s_or_b32 s62, 37, 0
    s_bitcmp1_b32 s97, 5
    s_getpc_b64 s[92:93]
    s_cbranch_scc1 PATCH_V
SD_120:
    s_waitcnt vmcnt(12)
    ds_read_b128 v[48:51], v9 offset:4096
    ds_read_b128 v[52:55], v10 offset:4096
    ds_read_b128 v[56:59], v11 offset:4096
    ds_read_b128 v[60:63], v12 offset:4096
    s_waitcnt lgkmcnt(3)
    v_mfma_f32_16x16x32_bf16 v[24:27], v[48:51], v[64:67], 0
    s_waitcnt lgkmcnt(2)
    v_mfma_f32_16x16x32_bf16 v[24:27], v[52:55], v[68:71], v[24:27]
    s_waitcnt lgkmcnt(1)
    v_mfma_f32_16x16x32_bf16 v[24:27], v[56:59], v[72:75], v[24:27]
    s_waitcnt lgkmcnt(0)
    v_mfma_f32_16x16x32_bf16 v[24:27], v[60:63], v[76:79], v[24:27]
    s_nop 7
    v_fma_f32 v28, v24, s55, v17
    v_fma_f32 v29, v25, s55, v17
    v_fma_f32 v30, v26, s55, v17
    v_fma_f32 v31, v27, s55, v17
    v_max3_f32 v36, v28, v29, v30
    v_max_f32 v36, v36, v31
    v_cmp_lt_f32 vcc, s56, v36
    s_cbranch_vccnz RS_123
RB_124:
    v_exp_f32 v28, v28
    v_exp_f32 v29, v29
    v_exp_f32 v30, v30
    v_exp_f32 v31, v31
    v_cvt_pk_bf16_f32 v32, v28, v28
    v_add_f32 v18, v18, v28
    v_cvt_pk_bf16_f32 v33, v29, v29
    v_add_f32 v19, v19, v29
    v_cvt_pk_bf16_f32 v34, v30, v30
    v_add_f32 v18, v18, v30
    v_cvt_pk_bf16_f32 v35, v31, v31
    v_add_f32 v19, v19, v31
    s_waitcnt vmcnt(8)
    v_and_b32 v48, v32, v13
    v_and_b32 v49, v32, v14
    v_and_b32 v50, v32, v15
    v_and_b32 v51, v32, v16
    v_and_b32 v52, v33, v13
    v_and_b32 v53, v33, v14
    v_and_b32 v54, v33, v15
    v_and_b32 v55, v33, v16
    v_mfma_f32_16x16x32_bf16 v[20:23], a[16:19], v[48:51], v[20:23]
    v_and_b32 v56, v34, v13
    v_and_b32 v57, v34, v14
    v_and_b32 v58, v34, v15
    v_and_b32 v59, v34, v16
    v_mfma_f32_16x16x32_bf16 v[20:23], a[20:23], v[52:55], v[20:23]
    v_and_b32 v60, v35, v13
    v_and_b32 v61, v35, v14
    v_and_b32 v62, v35, v15
    v_and_b32 v63, v35, v16
    v_mfma_f32_16x16x32_bf16 v[20:23], a[24:27], v[56:59], v[20:23]
    s_nop 0
    v_mfma_f32_16x16x32_bf16 v[20:23], a[28:31], v[60:63], v[20:23]
    s_add_u32 s77, s90, 368
    s_mul_i32 s54, s77, s85
    s_add_u32 s54, s54, s53
    s_add_u32 m0, s59, 4096
    s_nop 0
    buffer_load_dwordx4 v4, s[4:7], s54 offen offset:0 nt lds
    buffer_load_dwordx4 v5, s[4:7], s54 offen offset:1024 nt lds
    buffer_load_dwordx4 v6, s[4:7], s54 offen offset:2048 nt lds
    buffer_load_dwordx4 v7, s[4:7], s54 offen offset:3072 nt lds
    buffer_load_dwordx4 a[16:19], v8, s[8:11], s54 offen offset:0 nt
    buffer_load_dwordx4 a[20:23], v8, s[8:11], s54 offen offset:256 nt
    buffer_load_dwordx4 a[24:27], v8, s[8:11], s54 offen offset:512 nt
    buffer_load_dwordx4 a[28:31], v8, s[8:11], s54 offen offset:768 nt
    s_bitcmp1_b32 s99, 6
    s_cbranch_scc1 SL_125
    v_accvgpr_read_b32 v48, a120
    v_accvgpr_read_b32 v49, a121
    v_accvgpr_read_b32 v50, a122
    v_accvgpr_read_b32 v51, a123
    v_lshrrev_b32 v36, 11, v48
    v_and_b32 v60, 0x000f000f, v36
    v_and_b32 v48, 0x87ff87ff, v48
    v_lshrrev_b32 v37, 11, v49
    v_and_b32 v61, 0x000f000f, v37
    v_and_b32 v49, 0x87ff87ff, v49
    v_lshrrev_b32 v36, 11, v50
    v_and_b32 v62, 0x000f000f, v36
    v_and_b32 v50, 0x87ff87ff, v50
    v_lshrrev_b32 v37, 11, v51
    v_and_b32 v63, 0x000f000f, v37
    v_and_b32 v51, 0x87ff87ff, v51
    s_nop 1
    v_mfma_f32_16x16x32_bf16 v[24:27], v[48:51], v[64:67], 0
    v_accvgpr_read_b32 v52, a124
    v_accvgpr_read_b32 v53, a125
    v_accvgpr_read_b32 v54, a126
    v_accvgpr_read_b32 v55, a127
    v_lshrrev_b32 v36, 7, v52
    v_and_or_b32 v60, v36, s100, v60
    v_and_b32 v52, 0x87ff87ff, v52
    v_lshrrev_b32 v37, 7, v53
    v_and_or_b32 v61, v37, s100, v61
    v_and_b32 v53, 0x87ff87ff, v53
    v_lshrrev_b32 v36, 7, v54
    v_and_or_b32 v62, v36, s100, v62
    v_and_b32 v54, 0x87ff87ff, v54
    v_lshrrev_b32 v37, 7, v55
    v_and_or_b32 v63, v37, s100, v63
    v_and_b32 v55, 0x87ff87ff, v55
    s_nop 1
    v_mfma_f32_16x16x32_bf16 v[24:27], v[52:55], v[68:71], v[24:27]
    v_accvgpr_read_b32 v56, a128
    v_accvgpr_read_b32 v57, a129
    v_accvgpr_read_b32 v58, a130
    v_accvgpr_read_b32 v59, a131
    v_lshrrev_b32 v36, 3, v56
    v_and_or_b32 v60, v36, s101, v60
    v_lshlrev_b32 v37, 1, v56
    v_and_or_b32 v60, v37, s80, v60
    v_and_b32 v56, 0x87ff87ff, v56
    v_lshrrev_b32 v37, 3, v57
    v_and_or_b32 v61, v37, s101, v61
    v_lshlrev_b32 v36, 1, v57
    v_and_or_b32 v61, v36, s80, v61
    v_and_b32 v57, 0x87ff87ff, v57
    v_lshrrev_b32 v36, 3, v58
    v_and_or_b32 v62, v36, s101, v62
    v_lshlrev_b32 v37, 1, v58
    v_and_or_b32 v62, v37, s80, v62
    v_and_b32 v58, 0x87ff87ff, v58
    v_lshrrev_b32 v37, 3, v59
    v_and_or_b32 v63, v37, s101, v63
    v_lshlrev_b32 v36, 1, v59
    v_and_or_b32 v63, v36, s80, v63
    v_and_b32 v59, 0x87ff87ff, v59
    s_nop 1
    v_mfma_f32_16x16x32_bf16 v[24:27], v[56:59], v[72:75], v[24:27]
    v_mfma_f32_16x16x32_bf16 v[24:27], v[60:63], v[76:79], v[24:27]
    s_or_b32 s62, 6, 0
    s_bitcmp1_b32 s96, 6
    s_getpc_b64 s[92:93]
    s_cbranch_scc1 PATCH_K
    v_lshrrev_b32 v36, 11, v152
    v_and_b32 v56, 0x000f000f, v36
    v_and_b32 v48, 0x87ff87ff, v152
    v_lshrrev_b32 v37, 11, v153
    v_and_b32 v57, 0x000f000f, v37
    v_and_b32 v49, 0x87ff87ff, v153
    v_lshrrev_b32 v36, 11, v154
    v_and_b32 v58, 0x000f000f, v36
    v_and_b32 v50, 0x87ff87ff, v154
    v_lshrrev_b32 v37, 11, v155
    v_and_b32 v59, 0x000f000f, v37
    v_and_b32 v51, 0x87ff87ff, v155
    v_fmamk_f32 v28, v24, 0x568293ee, v17
    v_fmamk_f32 v29, v25, 0x568293ee, v17
    v_fmamk_f32 v30, v26, 0x568293ee, v17
    v_fmamk_f32 v31, v27, 0x568293ee, v17
    v_max3_f32 v36, v28, v29, v30
    v_max_f32 v36, v36, v31
    v_cmp_lt_f32 vcc, s56, v36
    s_cbranch_vccnz RS_127
RB_128:
    v_exp_f32 v28, v28
    v_exp_f32 v29, v29
    v_exp_f32 v30, v30
    v_exp_f32 v31, v31
    v_lshrrev_b32 v36, 7, v156
    v_and_or_b32 v56, v36, s100, v56
    v_and_b32 v52, 0x87ff87ff, v156
    v_lshrrev_b32 v37, 7, v157
    v_and_or_b32 v57, v37, s100, v57
    v_and_b32 v53, 0x87ff87ff, v157
    v_lshrrev_b32 v36, 7, v158
    v_and_or_b32 v58, v36, s100, v58
    v_and_b32 v54, 0x87ff87ff, v158
    v_lshrrev_b32 v37, 7, v159
    v_and_or_b32 v59, v37, s100, v59
    v_and_b32 v55, 0x87ff87ff, v159
    v_add_f32 v18, v18, v28
    v_mul_f32 v28, 0x78800000, v28
    v_add_f32 v19, v19, v29
    v_mul_f32 v29, 0x78800000, v29
    v_add_f32 v18, v18, v30
    v_mul_f32 v30, 0x78800000, v30
    v_add_f32 v19, v19, v31
    v_mul_f32 v31, 0x78800000, v31
    v_cvt_pk_bf16_f32 v32, v28, v28
    v_cvt_pk_bf16_f32 v33, v29, v29
    v_cvt_pk_bf16_f32 v34, v30, v30
    v_cvt_pk_bf16_f32 v35, v31, v31
    v_and_b32 v60, v32, v13
    v_and_b32 v61, v32, v14
    v_and_b32 v62, v32, v15
    v_and_b32 v63, v32, v16
    s_nop 1
    v_mfma_f32_16x16x32_bf16 v[20:23], v[48:51], v[60:63], v[20:23]
    v_and_b32 v24, v33, v13
    v_and_b32 v25, v33, v14
    v_and_b32 v26, v33, v15
    v_and_b32 v27, v33, v16
    s_nop 1
    v_mfma_f32_16x16x32_bf16 v[20:23], v[52:55], v[24:27], v[20:23]
    v_lshrrev_b32 v36, 3, v160
    v_and_or_b32 v56, v36, s101, v56
    v_lshlrev_b32 v37, 1, v160
    v_and_or_b32 v56, v37, s80, v56
    v_and_b32 v48, 0x87ff87ff, v160
    v_lshrrev_b32 v37, 3, v161
    v_and_or_b32 v57, v37, s101, v57
    v_lshlrev_b32 v36, 1, v161
    v_and_or_b32 v57, v36, s80, v57
    v_and_b32 v49, 0x87ff87ff, v161
    v_lshrrev_b32 v36, 3, v162
    v_and_or_b32 v58, v36, s101, v58
    v_lshlrev_b32 v37, 1, v162
    v_and_or_b32 v58, v37, s80, v58
    v_and_b32 v50, 0x87ff87ff, v162
    v_lshrrev_b32 v37, 3, v163
    v_and_or_b32 v59, v37, s101, v59
    v_lshlrev_b32 v36, 1, v163
    v_and_or_b32 v59, v36, s80, v59
    v_and_b32 v51, 0x87ff87ff, v163
    v_and_b32 v60, v34, v13
    v_and_b32 v61, v34, v14
    v_and_b32 v62, v34, v15
    v_and_b32 v63, v34, v16
    s_nop 1
    v_mfma_f32_16x16x32_bf16 v[20:23], v[48:51], v[60:63], v[20:23]
    v_and_b32 v24, v35, v13
    v_and_b32 v25, v35, v14
    v_and_b32 v26, v35, v15
    v_and_b32 v27, v35, v16
    s_nop 1
    v_mfma_f32_16x16x32_bf16 v[20:23], v[56:59], v[24:27], v[20:23]
    s_or_b32 s62, 38, 0
    s_bitcmp1_b32 s97, 6
    s_getpc_b64 s[92:93]
    s_cbranch_scc1 PATCH_V
SD_126:
    s_waitcnt vmcnt(12)
    ds_read_b128 v[48:51], v9 offset:0
    ds_read_b128 v[52:55], v10 offset:0
    ds_read_b128 v[56:59], v11 offset:0
    ds_read_b128 v[60:63], v12 offset:0
    s_waitcnt lgkmcnt(3)
    v_mfma_f32_16x16x32_bf16 v[24:27], v[48:51], v[64:67], 0
    s_waitcnt lgkmcnt(2)
    v_mfma_f32_16x16x32_bf16 v[24:27], v[52:55], v[68:71], v[24:27]
    s_waitcnt lgkmcnt(1)
    v_mfma_f32_16x16x32_bf16 v[24:27], v[56:59], v[72:75], v[24:27]
    s_waitcnt lgkmcnt(0)
    v_mfma_f32_16x16x32_bf16 v[24:27], v[60:63], v[76:79], v[24:27]
    s_nop 7
    v_fma_f32 v28, v24, s55, v17
    v_fma_f32 v29, v25, s55, v17
    v_fma_f32 v30, v26, s55, v17
    v_fma_f32 v31, v27, s55, v17
    v_max3_f32 v36, v28, v29, v30
    v_max_f32 v36, v36, v31
    v_cmp_lt_f32 vcc, s56, v36
    s_cbranch_vccnz RS_129
RB_130:
    v_exp_f32 v28, v28
    v_exp_f32 v29, v29
    v_exp_f32 v30, v30
    v_exp_f32 v31, v31
    v_cvt_pk_bf16_f32 v32, v28, v28
    v_add_f32 v18, v18, v28
    v_cvt_pk_bf16_f32 v33, v29, v29
    v_add_f32 v19, v19, v29
    v_cvt_pk_bf16_f32 v34, v30, v30
    v_add_f32 v18, v18, v30
    v_cvt_pk_bf16_f32 v35, v31, v31
    v_add_f32 v19, v19, v31
    s_waitcnt vmcnt(8)
    v_and_b32 v48, v32, v13
    v_and_b32 v49, v32, v14
    v_and_b32 v50, v32, v15
    v_and_b32 v51, v32, v16
    v_and_b32 v52, v33, v13
    v_and_b32 v53, v33, v14
    v_and_b32 v54, v33, v15
    v_and_b32 v55, v33, v16
    v_mfma_f32_16x16x32_bf16 v[20:23], a[0:3], v[48:51], v[20:23]
    v_and_b32 v56, v34, v13
    v_and_b32 v57, v34, v14
    v_and_b32 v58, v34, v15
    v_and_b32 v59, v34, v16
    v_mfma_f32_16x16x32_bf16 v[20:23], a[4:7], v[52:55], v[20:23]
    v_and_b32 v60, v35, v13
    v_and_b32 v61, v35, v14
    v_and_b32 v62, v35, v15
    v_and_b32 v63, v35, v16
    v_mfma_f32_16x16x32_bf16 v[20:23], a[8:11], v[56:59], v[20:23]
    s_nop 0
    v_mfma_f32_16x16x32_bf16 v[20:23], a[12:15], v[60:63], v[20:23]
    s_add_u32 s76, s90, 384
    s_mul_i32 s54, s76, s85
    s_add_u32 s54, s54, s53
    s_add_u32 m0, s59, 0
    s_nop 0
    buffer_load_dwordx4 v4, s[4:7], s54 offen offset:0 nt lds
    buffer_load_dwordx4 v5, s[4:7], s54 offen offset:1024 nt lds
    buffer_load_dwordx4 v6, s[4:7], s54 offen offset:2048 nt lds
    buffer_load_dwordx4 v7, s[4:7], s54 offen offset:3072 nt lds
    buffer_load_dwordx4 a[0:3], v8, s[8:11], s54 offen offset:0 nt
    buffer_load_dwordx4 a[4:7], v8, s[8:11], s54 offen offset:256 nt
    buffer_load_dwordx4 a[8:11], v8, s[8:11], s54 offen offset:512 nt
    buffer_load_dwordx4 a[12:15], v8, s[8:11], s54 offen offset:768 nt
    s_bitcmp1_b32 s99, 7
    s_cbranch_scc1 SL_131
    v_accvgpr_read_b32 v48, a132
    v_accvgpr_read_b32 v49, a133
    v_accvgpr_read_b32 v50, a134
    v_accvgpr_read_b32 v51, a135
    v_lshrrev_b32 v36, 11, v48
    v_and_b32 v60, 0x000f000f, v36
    v_and_b32 v48, 0x87ff87ff, v48
    v_lshrrev_b32 v37, 11, v49
    v_and_b32 v61, 0x000f000f, v37
    v_and_b32 v49, 0x87ff87ff, v49
    v_lshrrev_b32 v36, 11, v50
    v_and_b32 v62, 0x000f000f, v36
    v_and_b32 v50, 0x87ff87ff, v50
    v_lshrrev_b32 v37, 11, v51
    v_and_b32 v63, 0x000f000f, v37
    v_and_b32 v51, 0x87ff87ff, v51
    s_nop 1
    v_mfma_f32_16x16x32_bf16 v[24:27], v[48:51], v[64:67], 0
    v_accvgpr_read_b32 v52, a136
    v_accvgpr_read_b32 v53, a137
    v_accvgpr_read_b32 v54, a138
    v_accvgpr_read_b32 v55, a139
    v_lshrrev_b32 v36, 7, v52
    v_and_or_b32 v60, v36, s100, v60
    v_and_b32 v52, 0x87ff87ff, v52
    v_lshrrev_b32 v37, 7, v53
    v_and_or_b32 v61, v37, s100, v61
    v_and_b32 v53, 0x87ff87ff, v53
    v_lshrrev_b32 v36, 7, v54
    v_and_or_b32 v62, v36, s100, v62
    v_and_b32 v54, 0x87ff87ff, v54
    v_lshrrev_b32 v37, 7, v55
    v_and_or_b32 v63, v37, s100, v63
    v_and_b32 v55, 0x87ff87ff, v55
    s_nop 1
    v_mfma_f32_16x16x32_bf16 v[24:27], v[52:55], v[68:71], v[24:27]
    v_accvgpr_read_b32 v56, a140
    v_accvgpr_read_b32 v57, a141
    v_accvgpr_read_b32 v58, a142
    v_accvgpr_read_b32 v59, a143
    v_lshrrev_b32 v36, 3, v56
    v_and_or_b32 v60, v36, s101, v60
    v_lshlrev_b32 v37, 1, v56
    v_and_or_b32 v60, v37, s80, v60
    v_and_b32 v56, 0x87ff87ff, v56
    v_lshrrev_b32 v37, 3, v57
    v_and_or_b32 v61, v37, s101, v61
    v_lshlrev_b32 v36, 1, v57
    v_and_or_b32 v61, v36, s80, v61
    v_and_b32 v57, 0x87ff87ff, v57
    v_lshrrev_b32 v36, 3, v58
    v_and_or_b32 v62, v36, s101, v62
    v_lshlrev_b32 v37, 1, v58
    v_and_or_b32 v62, v37, s80, v62
    v_and_b32 v58, 0x87ff87ff, v58
    v_lshrrev_b32 v37, 3, v59
    v_and_or_b32 v63, v37, s101, v63
    v_lshlrev_b32 v36, 1, v59
    v_and_or_b32 v63, v36, s80, v63
    v_and_b32 v59, 0x87ff87ff, v59
    s_nop 1
    v_mfma_f32_16x16x32_bf16 v[24:27], v[56:59], v[72:75], v[24:27]
    v_mfma_f32_16x16x32_bf16 v[24:27], v[60:63], v[76:79], v[24:27]
    s_or_b32 s62, 7, 0
    s_bitcmp1_b32 s96, 7
    s_getpc_b64 s[92:93]
    s_cbranch_scc1 PATCH_K
    v_lshrrev_b32 v36, 11, v164
    v_and_b32 v56, 0x000f000f, v36
    v_and_b32 v48, 0x87ff87ff, v164
    v_lshrrev_b32 v37, 11, v165
    v_and_b32 v57, 0x000f000f, v37
    v_and_b32 v49, 0x87ff87ff, v165
    v_lshrrev_b32 v36, 11, v166
    v_and_b32 v58, 0x000f000f, v36
    v_and_b32 v50, 0x87ff87ff, v166
    v_lshrrev_b32 v37, 11, v167
    v_and_b32 v59, 0x000f000f, v37
    v_and_b32 v51, 0x87ff87ff, v167
    v_fmamk_f32 v28, v24, 0x568293ee, v17
    v_fmamk_f32 v29, v25, 0x568293ee, v17
    v_fmamk_f32 v30, v26, 0x568293ee, v17
    v_fmamk_f32 v31, v27, 0x568293ee, v17
    v_max3_f32 v36, v28, v29, v30
    v_max_f32 v36, v36, v31
    v_cmp_lt_f32 vcc, s56, v36
    s_cbranch_vccnz RS_133
RB_134:
    v_exp_f32 v28, v28
    v_exp_f32 v29, v29
    v_exp_f32 v30, v30
    v_exp_f32 v31, v31
    v_lshrrev_b32 v36, 7, v168
    v_and_or_b32 v56, v36, s100, v56
    v_and_b32 v52, 0x87ff87ff, v168
    v_lshrrev_b32 v37, 7, v169
    v_and_or_b32 v57, v37, s100, v57
    v_and_b32 v53, 0x87ff87ff, v169
    v_lshrrev_b32 v36, 7, v170
    v_and_or_b32 v58, v36, s100, v58
    v_and_b32 v54, 0x87ff87ff, v170
    v_lshrrev_b32 v37, 7, v171
    v_and_or_b32 v59, v37, s100, v59
    v_and_b32 v55, 0x87ff87ff, v171
    v_add_f32 v18, v18, v28
    v_mul_f32 v28, 0x78800000, v28
    v_add_f32 v19, v19, v29
    v_mul_f32 v29, 0x78800000, v29
    v_add_f32 v18, v18, v30
    v_mul_f32 v30, 0x78800000, v30
    v_add_f32 v19, v19, v31
    v_mul_f32 v31, 0x78800000, v31
    v_cvt_pk_bf16_f32 v32, v28, v28
    v_cvt_pk_bf16_f32 v33, v29, v29
    v_cvt_pk_bf16_f32 v34, v30, v30
    v_cvt_pk_bf16_f32 v35, v31, v31
    v_and_b32 v60, v32, v13
    v_and_b32 v61, v32, v14
    v_and_b32 v62, v32, v15
    v_and_b32 v63, v32, v16
    s_nop 1
    v_mfma_f32_16x16x32_bf16 v[20:23], v[48:51], v[60:63], v[20:23]
    v_and_b32 v24, v33, v13
    v_and_b32 v25, v33, v14
    v_and_b32 v26, v33, v15
    v_and_b32 v27, v33, v16
    s_nop 1
    v_mfma_f32_16x16x32_bf16 v[20:23], v[52:55], v[24:27], v[20:23]
    v_lshrrev_b32 v36, 3, v172
    v_and_or_b32 v56, v36, s101, v56
    v_lshlrev_b32 v37, 1, v172
    v_and_or_b32 v56, v37, s80, v56
    v_and_b32 v48, 0x87ff87ff, v172
    v_lshrrev_b32 v37, 3, v173
    v_and_or_b32 v57, v37, s101, v57
    v_lshlrev_b32 v36, 1, v173
    v_and_or_b32 v57, v36, s80, v57
    v_and_b32 v49, 0x87ff87ff, v173
    v_lshrrev_b32 v36, 3, v174
    v_and_or_b32 v58, v36, s101, v58
    v_lshlrev_b32 v37, 1, v174
    v_and_or_b32 v58, v37, s80, v58
    v_and_b32 v50, 0x87ff87ff, v174
    v_lshrrev_b32 v37, 3, v175
    v_and_or_b32 v59, v37, s101, v59
    v_lshlrev_b32 v36, 1, v175
    v_and_or_b32 v59, v36, s80, v59
    v_and_b32 v51, 0x87ff87ff, v175
    v_and_b32 v60, v34, v13
    v_and_b32 v61, v34, v14
    v_and_b32 v62, v34, v15
    v_and_b32 v63, v34, v16
    s_nop 1
    v_mfma_f32_16x16x32_bf16 v[20:23], v[48:51], v[60:63], v[20:23]
    v_and_b32 v24, v35, v13
    v_and_b32 v25, v35, v14
    v_and_b32 v26, v35, v15
    v_and_b32 v27, v35, v16
    s_nop 1
    v_mfma_f32_16x16x32_bf16 v[20:23], v[56:59], v[24:27], v[20:23]
    s_or_b32 s62, 39, 0
    s_bitcmp1_b32 s97, 7
    s_getpc_b64 s[92:93]
    s_cbranch_scc1 PATCH_V
SD_132:
    s_waitcnt vmcnt(12)
    ds_read_b128 v[48:51], v9 offset:4096
    ds_read_b128 v[52:55], v10 offset:4096
    ds_read_b128 v[56:59], v11 offset:4096
    ds_read_b128 v[60:63], v12 offset:4096
    s_waitcnt lgkmcnt(3)
    v_mfma_f32_16x16x32_bf16 v[24:27], v[48:51], v[64:67], 0
    s_waitcnt lgkmcnt(2)
    v_mfma_f32_16x16x32_bf16 v[24:27], v[52:55], v[68:71], v[24:27]
    s_waitcnt lgkmcnt(1)
    v_mfma_f32_16x16x32_bf16 v[24:27], v[56:59], v[72:75], v[24:27]
    s_waitcnt lgkmcnt(0)
    v_mfma_f32_16x16x32_bf16 v[24:27], v[60:63], v[76:79], v[24:27]
    s_nop 7
    v_fma_f32 v28, v24, s55, v17
    v_fma_f32 v29, v25, s55, v17
    v_fma_f32 v30, v26, s55, v17
    v_fma_f32 v31, v27, s55, v17
    v_max3_f32 v36, v28, v29, v30
    v_max_f32 v36, v36, v31
    v_cmp_lt_f32 vcc, s56, v36
    s_cbranch_vccnz RS_135
RB_136:
    v_exp_f32 v28, v28
    v_exp_f32 v29, v29
    v_exp_f32 v30, v30
    v_exp_f32 v31, v31
    v_cvt_pk_bf16_f32 v32, v28, v28
    v_add_f32 v18, v18, v28
    v_cvt_pk_bf16_f32 v33, v29, v29
    v_add_f32 v19, v19, v29
    v_cvt_pk_bf16_f32 v34, v30, v30
    v_add_f32 v18, v18, v30
    v_cvt_pk_bf16_f32 v35, v31, v31
    v_add_f32 v19, v19, v31
    s_waitcnt vmcnt(8)
    v_and_b32 v48, v32, v13
    v_and_b32 v49, v32, v14
    v_and_b32 v50, v32, v15
    v_and_b32 v51, v32, v16
    v_and_b32 v52, v33, v13
    v_and_b32 v53, v33, v14
    v_and_b32 v54, v33, v15
    v_and_b32 v55, v33, v16
    v_mfma_f32_16x16x32_bf16 v[20:23], a[16:19], v[48:51], v[20:23]
    v_and_b32 v56, v34, v13
    v_and_b32 v57, v34, v14
    v_and_b32 v58, v34, v15
    v_and_b32 v59, v34, v16
    v_mfma_f32_16x16x32_bf16 v[20:23], a[20:23], v[52:55], v[20:23]
    v_and_b32 v60, v35, v13
    v_and_b32 v61, v35, v14
    v_and_b32 v62, v35, v15
    v_and_b32 v63, v35, v16
    v_mfma_f32_16x16x32_bf16 v[20:23], a[24:27], v[56:59], v[20:23]
    s_nop 0
    v_mfma_f32_16x16x32_bf16 v[20:23], a[28:31], v[60:63], v[20:23]
    s_cmp_eq_u32 s83, 0
    s_cbranch_scc0 ML_137
    s_add_u32 s77, s90, 400
    s_mul_i32 s54, s77, s85
    s_add_u32 s54, s54, s53
    s_add_u32 m0, s59, 4096
    s_nop 0
    buffer_load_dwordx4 v4, s[4:7], s54 offen offset:0 sc1 lds
    buffer_load_dwordx4 v5, s[4:7], s54 offen offset:1024 sc1 lds
    buffer_load_dwordx4 v6, s[4:7], s54 offen offset:2048 sc1 lds
    buffer_load_dwordx4 v7, s[4:7], s54 offen offset:3072 sc1 lds
    buffer_load_dwordx4 a[16:19], v8, s[8:11], s54 offen offset:0 sc1
    buffer_load_dwordx4 a[20:23], v8, s[8:11], s54 offen offset:256 sc1
    buffer_load_dwordx4 a[24:27], v8, s[8:11], s54 offen offset:512 sc1
    buffer_load_dwordx4 a[28:31], v8, s[8:11], s54 offen offset:768 sc1
    s_branch MJ_138
ML_137:
    s_add_u32 s77, s90, 400
    s_mul_i32 s54, s77, s85
    s_add_u32 s54, s54, s53
    s_add_u32 m0, s59, 4096
    s_nop 0
    buffer_load_dwordx4 v4, s[4:7], s54 offen offset:0 nt lds
    buffer_load_dwordx4 v5, s[4:7], s54 offen offset:1024 nt lds
    buffer_load_dwordx4 v6, s[4:7], s54 offen offset:2048 nt lds
    buffer_load_dwordx4 v7, s[4:7], s54 offen offset:3072 nt lds
    buffer_load_dwordx4 a[16:19], v8, s[8:11], s54 offen offset:0 nt
    buffer_load_dwordx4 a[20:23], v8, s[8:11], s54 offen offset:256 nt
    buffer_load_dwordx4 a[24:27], v8, s[8:11], s54 offen offset:512 nt
    buffer_load_dwordx4 a[28:31], v8, s[8:11], s54 offen offset:768 nt
MJ_138:
    s_bitcmp1_b32 s99, 8
    s_cbranch_scc1 SL_139
    v_accvgpr_read_b32 v48, a144
    v_accvgpr_read_b32 v49, a145
    v_accvgpr_read_b32 v50, a146
    v_accvgpr_read_b32 v51, a147
    v_lshrrev_b32 v36, 11, v48
    v_and_b32 v60, 0x000f000f, v36
    v_and_b32 v48, 0x87ff87ff, v48
    v_lshrrev_b32 v37, 11, v49
    v_and_b32 v61, 0x000f000f, v37
    v_and_b32 v49, 0x87ff87ff, v49
    v_lshrrev_b32 v36, 11, v50
    v_and_b32 v62, 0x000f000f, v36
    v_and_b32 v50, 0x87ff87ff, v50
    v_lshrrev_b32 v37, 11, v51
    v_and_b32 v63, 0x000f000f, v37
    v_and_b32 v51, 0x87ff87ff, v51
    s_nop 1
    v_mfma_f32_16x16x32_bf16 v[24:27], v[48:51], v[64:67], 0
    v_accvgpr_read_b32 v52, a148
    v_accvgpr_read_b32 v53, a149
    v_accvgpr_read_b32 v54, a150
    v_accvgpr_read_b32 v55, a151
    v_lshrrev_b32 v36, 7, v52
    v_and_or_b32 v60, v36, s100, v60
    v_and_b32 v52, 0x87ff87ff, v52
    v_lshrrev_b32 v37, 7, v53
    v_and_or_b32 v61, v37, s100, v61
    v_and_b32 v53, 0x87ff87ff, v53
    v_lshrrev_b32 v36, 7, v54
    v_and_or_b32 v62, v36, s100, v62
    v_and_b32 v54, 0x87ff87ff, v54
    v_lshrrev_b32 v37, 7, v55
    v_and_or_b32 v63, v37, s100, v63
    v_and_b32 v55, 0x87ff87ff, v55
    s_nop 1
    v_mfma_f32_16x16x32_bf16 v[24:27], v[52:55], v[68:71], v[24:27]
    v_accvgpr_read_b32 v56, a152
    v_accvgpr_read_b32 v57, a153
    v_accvgpr_read_b32 v58, a154
    v_accvgpr_read_b32 v59, a155
    v_lshrrev_b32 v36, 3, v56
    v_and_or_b32 v60, v36, s101, v60
    v_lshlrev_b32 v37, 1, v56
    v_and_or_b32 v60, v37, s80, v60
    v_and_b32 v56, 0x87ff87ff, v56
    v_lshrrev_b32 v37, 3, v57
    v_and_or_b32 v61, v37, s101, v61
    v_lshlrev_b32 v36, 1, v57
    v_and_or_b32 v61, v36, s80, v61
    v_and_b32 v57, 0x87ff87ff, v57
    v_lshrrev_b32 v36, 3, v58
    v_and_or_b32 v62, v36, s101, v62
    v_lshlrev_b32 v37, 1, v58
    v_and_or_b32 v62, v37, s80, v62
    v_and_b32 v58, 0x87ff87ff, v58
    v_lshrrev_b32 v37, 3, v59
    v_and_or_b32 v63, v37, s101, v63
    v_lshlrev_b32 v36, 1, v59
    v_and_or_b32 v63, v36, s80, v63
    v_and_b32 v59, 0x87ff87ff, v59
    s_nop 1
    v_mfma_f32_16x16x32_bf16 v[24:27], v[56:59], v[72:75], v[24:27]
    v_mfma_f32_16x16x32_bf16 v[24:27], v[60:63], v[76:79], v[24:27]
    s_or_b32 s62, 8, 0
    s_bitcmp1_b32 s96, 8
    s_getpc_b64 s[92:93]
    s_cbranch_scc1 PATCH_K
    v_lshrrev_b32 v36, 11, v176
    v_and_b32 v56, 0x000f000f, v36
    v_and_b32 v48, 0x87ff87ff, v176
    v_lshrrev_b32 v37, 11, v177
    v_and_b32 v57, 0x000f000f, v37
    v_and_b32 v49, 0x87ff87ff, v177
    v_lshrrev_b32 v36, 11, v178
    v_and_b32 v58, 0x000f000f, v36
    v_and_b32 v50, 0x87ff87ff, v178
    v_lshrrev_b32 v37, 11, v179
    v_and_b32 v59, 0x000f000f, v37
    v_and_b32 v51, 0x87ff87ff, v179
    v_fmamk_f32 v28, v24, 0x568293ee, v17
    v_fmamk_f32 v29, v25, 0x568293ee, v17
    v_fmamk_f32 v30, v26, 0x568293ee, v17
    v_fmamk_f32 v31, v27, 0x568293ee, v17
    v_max3_f32 v36, v28, v29, v30
    v_max_f32 v36, v36, v31
    v_cmp_lt_f32 vcc, s56, v36
    s_cbranch_vccnz RS_141
RB_142:
    v_exp_f32 v28, v28
    v_exp_f32 v29, v29
    v_exp_f32 v30, v30
    v_exp_f32 v31, v31
    v_lshrrev_b32 v36, 7, v180
    v_and_or_b32 v56, v36, s100, v56
    v_and_b32 v52, 0x87ff87ff, v180
    v_lshrrev_b32 v37, 7, v181
    v_and_or_b32 v57, v37, s100, v57
    v_and_b32 v53, 0x87ff87ff, v181
    v_lshrrev_b32 v36, 7, v182
    v_and_or_b32 v58, v36, s100, v58
    v_and_b32 v54, 0x87ff87ff, v182
    v_lshrrev_b32 v37, 7, v183
    v_and_or_b32 v59, v37, s100, v59
    v_and_b32 v55, 0x87ff87ff, v183
    v_add_f32 v18, v18, v28
    v_mul_f32 v28, 0x78800000, v28
    v_add_f32 v19, v19, v29
    v_mul_f32 v29, 0x78800000, v29
    v_add_f32 v18, v18, v30
    v_mul_f32 v30, 0x78800000, v30
    v_add_f32 v19, v19, v31
    v_mul_f32 v31, 0x78800000, v31
    v_cvt_pk_bf16_f32 v32, v28, v28
    v_cvt_pk_bf16_f32 v33, v29, v29
    v_cvt_pk_bf16_f32 v34, v30, v30
    v_cvt_pk_bf16_f32 v35, v31, v31
    v_and_b32 v60, v32, v13
    v_and_b32 v61, v32, v14
    v_and_b32 v62, v32, v15
    v_and_b32 v63, v32, v16
    s_nop 1
    v_mfma_f32_16x16x32_bf16 v[20:23], v[48:51], v[60:63], v[20:23]
    v_and_b32 v24, v33, v13
    v_and_b32 v25, v33, v14
    v_and_b32 v26, v33, v15
    v_and_b32 v27, v33, v16
    s_nop 1
    v_mfma_f32_16x16x32_bf16 v[20:23], v[52:55], v[24:27], v[20:23]
    v_lshrrev_b32 v36, 3, v184
    v_and_or_b32 v56, v36, s101, v56
    v_lshlrev_b32 v37, 1, v184
    v_and_or_b32 v56, v37, s80, v56
    v_and_b32 v48, 0x87ff87ff, v184
    v_lshrrev_b32 v37, 3, v185
    v_and_or_b32 v57, v37, s101, v57
    v_lshlrev_b32 v36, 1, v185
    v_and_or_b32 v57, v36, s80, v57
    v_and_b32 v49, 0x87ff87ff, v185
    v_lshrrev_b32 v36, 3, v186
    v_and_or_b32 v58, v36, s101, v58
    v_lshlrev_b32 v37, 1, v186
    v_and_or_b32 v58, v37, s80, v58
    v_and_b32 v50, 0x87ff87ff, v186
    v_lshrrev_b32 v37, 3, v187
    v_and_or_b32 v59, v37, s101, v59
    v_lshlrev_b32 v36, 1, v187
    v_and_or_b32 v59, v36, s80, v59
    v_and_b32 v51, 0x87ff87ff, v187
    v_and_b32 v60, v34, v13
    v_and_b32 v61, v34, v14
    v_and_b32 v62, v34, v15
    v_and_b32 v63, v34, v16
    s_nop 1
    v_mfma_f32_16x16x32_bf16 v[20:23], v[48:51], v[60:63], v[20:23]
    v_and_b32 v24, v35, v13
    v_and_b32 v25, v35, v14
    v_and_b32 v26, v35, v15
    v_and_b32 v27, v35, v16
    s_nop 1
    v_mfma_f32_16x16x32_bf16 v[20:23], v[56:59], v[24:27], v[20:23]
    s_or_b32 s62, 40, 0
    s_bitcmp1_b32 s97, 8
    s_getpc_b64 s[92:93]
    s_cbranch_scc1 PATCH_V
SD_140:
    s_waitcnt vmcnt(12)
    ds_read_b128 v[48:51], v9 offset:0
    ds_read_b128 v[52:55], v10 offset:0
    ds_read_b128 v[56:59], v11 offset:0
    ds_read_b128 v[60:63], v12 offset:0
    s_waitcnt lgkmcnt(3)
    v_mfma_f32_16x16x32_bf16 v[24:27], v[48:51], v[64:67], 0
    s_waitcnt lgkmcnt(2)
    v_mfma_f32_16x16x32_bf16 v[24:27], v[52:55], v[68:71], v[24:27]
    s_waitcnt lgkmcnt(1)
    v_mfma_f32_16x16x32_bf16 v[24:27], v[56:59], v[72:75], v[24:27]
    s_waitcnt lgkmcnt(0)
    v_mfma_f32_16x16x32_bf16 v[24:27], v[60:63], v[76:79], v[24:27]
    s_nop 7
    v_fma_f32 v28, v24, s55, v17
    v_fma_f32 v29, v25, s55, v17
    v_fma_f32 v30, v26, s55, v17
    v_fma_f32 v31, v27, s55, v17
    v_max3_f32 v36, v28, v29, v30
    v_max_f32 v36, v36, v31
    v_cmp_lt_f32 vcc, s56, v36
    s_cbranch_vccnz RS_143
RB_144:
    v_exp_f32 v28, v28
    v_exp_f32 v29, v29
    v_exp_f32 v30, v30
    v_exp_f32 v31, v31
    v_cvt_pk_bf16_f32 v32, v28, v28
    v_add_f32 v18, v18, v28
    v_cvt_pk_bf16_f32 v33, v29, v29
    v_add_f32 v19, v19, v29
    v_cvt_pk_bf16_f32 v34, v30, v30
    v_add_f32 v18, v18, v30
    v_cvt_pk_bf16_f32 v35, v31, v31
    v_add_f32 v19, v19, v31
    s_waitcnt vmcnt(8)
    v_and_b32 v48, v32, v13
    v_and_b32 v49, v32, v14
    v_and_b32 v50, v32, v15
    v_and_b32 v51, v32, v16
    v_and_b32 v52, v33, v13
    v_and_b32 v53, v33, v14
    v_and_b32 v54, v33, v15
    v_and_b32 v55, v33, v16
    v_mfma_f32_16x16x32_bf16 v[20:23], a[0:3], v[48:51], v[20:23]
    v_and_b32 v56, v34, v13
    v_and_b32 v57, v34, v14
    v_and_b32 v58, v34, v15
    v_and_b32 v59, v34, v16
    v_mfma_f32_16x16x32_bf16 v[20:23], a[4:7], v[52:55], v[20:23]
    v_and_b32 v60, v35, v13
    v_and_b32 v61, v35, v14
    v_and_b32 v62, v35, v15
    v_and_b32 v63, v35, v16
    v_mfma_f32_16x16x32_bf16 v[20:23], a[8:11], v[56:59], v[20:23]
    s_nop 0
    v_mfma_f32_16x16x32_bf16 v[20:23], a[12:15], v[60:63], v[20:23]
    s_add_u32 s76, s90, 416
    s_mul_i32 s54, s76, s85
    s_add_u32 s54, s54, s53
    s_add_u32 m0, s59, 0
    s_nop 0
    buffer_load_dwordx4 v4, s[4:7], s54 offen offset:0 nt lds
    buffer_load_dwordx4 v5, s[4:7], s54 offen offset:1024 nt lds
    buffer_load_dwordx4 v6, s[4:7], s54 offen offset:2048 nt lds
    buffer_load_dwordx4 v7, s[4:7], s54 offen offset:3072 nt lds
    buffer_load_dwordx4 a[0:3], v8, s[8:11], s54 offen offset:0 nt
    buffer_load_dwordx4 a[4:7], v8, s[8:11], s54 offen offset:256 nt
    buffer_load_dwordx4 a[8:11], v8, s[8:11], s54 offen offset:512 nt
    buffer_load_dwordx4 a[12:15], v8, s[8:11], s54 offen offset:768 nt
    s_bitcmp1_b32 s99, 9
    s_cbranch_scc1 SL_145
    v_accvgpr_read_b32 v48, a156
    v_accvgpr_read_b32 v49, a157
    v_accvgpr_read_b32 v50, a158
    v_accvgpr_read_b32 v51, a159
    v_lshrrev_b32 v36, 11, v48
    v_and_b32 v60, 0x000f000f, v36
    v_and_b32 v48, 0x87ff87ff, v48
    v_lshrrev_b32 v37, 11, v49
    v_and_b32 v61, 0x000f000f, v37
    v_and_b32 v49, 0x87ff87ff, v49
    v_lshrrev_b32 v36, 11, v50
    v_and_b32 v62, 0x000f000f, v36
    v_and_b32 v50, 0x87ff87ff, v50
    v_lshrrev_b32 v37, 11, v51
    v_and_b32 v63, 0x000f000f, v37
    v_and_b32 v51, 0x87ff87ff, v51
    s_nop 1
    v_mfma_f32_16x16x32_bf16 v[24:27], v[48:51], v[64:67], 0
    v_accvgpr_read_b32 v52, a248
    v_accvgpr_read_b32 v53, a249
    v_accvgpr_read_b32 v54, a250
    v_accvgpr_read_b32 v55, a251
    v_lshrrev_b32 v36, 7, v52
    v_and_or_b32 v60, v36, s100, v60
    v_and_b32 v52, 0x87ff87ff, v52
    v_lshrrev_b32 v37, 7, v53
    v_and_or_b32 v61, v37, s100, v61
    v_and_b32 v53, 0x87ff87ff, v53
    v_lshrrev_b32 v36, 7, v54
    v_and_or_b32 v62, v36, s100, v62
    v_and_b32 v54, 0x87ff87ff, v54
    v_lshrrev_b32 v37, 7, v55
    v_and_or_b32 v63, v37, s100, v63
    v_and_b32 v55, 0x87ff87ff, v55
    s_nop 1
    v_mfma_f32_16x16x32_bf16 v[24:27], v[52:55], v[68:71], v[24:27]
    v_accvgpr_read_b32 v56, a252
    v_accvgpr_read_b32 v57, a253
    v_accvgpr_read_b32 v58, a254
    v_accvgpr_read_b32 v59, a255
    v_lshrrev_b32 v36, 3, v56
    v_and_or_b32 v60, v36, s101, v60
    v_lshlrev_b32 v37, 1, v56
    v_and_or_b32 v60, v37, s80, v60
    v_and_b32 v56, 0x87ff87ff, v56
    v_lshrrev_b32 v37, 3, v57
    v_and_or_b32 v61, v37, s101, v61
    v_lshlrev_b32 v36, 1, v57
    v_and_or_b32 v61, v36, s80, v61
    v_and_b32 v57, 0x87ff87ff, v57
    v_lshrrev_b32 v36, 3, v58
    v_and_or_b32 v62, v36, s101, v62
    v_lshlrev_b32 v37, 1, v58
    v_and_or_b32 v62, v37, s80, v62
    v_and_b32 v58, 0x87ff87ff, v58
    v_lshrrev_b32 v37, 3, v59
    v_and_or_b32 v63, v37, s101, v63
    v_lshlrev_b32 v36, 1, v59
    v_and_or_b32 v63, v36, s80, v63
    v_and_b32 v59, 0x87ff87ff, v59
    s_nop 1
    v_mfma_f32_16x16x32_bf16 v[24:27], v[56:59], v[72:75], v[24:27]
    v_mfma_f32_16x16x32_bf16 v[24:27], v[60:63], v[76:79], v[24:27]
    s_or_b32 s62, 9, 0
    s_bitcmp1_b32 s96, 9
    s_getpc_b64 s[92:93]
    s_cbranch_scc1 PATCH_K
    v_lshrrev_b32 v36, 11, v188
    v_and_b32 v56, 0x000f000f, v36
    v_and_b32 v48, 0x87ff87ff, v188
    v_lshrrev_b32 v37, 11, v189
    v_and_b32 v57, 0x000f000f, v37
    v_and_b32 v49, 0x87ff87ff, v189
    v_lshrrev_b32 v36, 11, v190
    v_and_b32 v58, 0x000f000f, v36
    v_and_b32 v50, 0x87ff87ff, v190
    v_lshrrev_b32 v37, 11, v191
    v_and_b32 v59, 0x000f000f, v37
    v_and_b32 v51, 0x87ff87ff, v191
    v_fmamk_f32 v28, v24, 0x568293ee, v17
    v_fmamk_f32 v29, v25, 0x568293ee, v17
    v_fmamk_f32 v30, v26, 0x568293ee, v17
    v_fmamk_f32 v31, v27, 0x568293ee, v17
    v_max3_f32 v36, v28, v29, v30
    v_max_f32 v36, v36, v31
    v_cmp_lt_f32 vcc, s56, v36
    s_cbranch_vccnz RS_147
RB_148:
    v_exp_f32 v28, v28
    v_exp_f32 v29, v29
    v_exp_f32 v30, v30
    v_exp_f32 v31, v31
    v_lshrrev_b32 v36, 7, v192
    v_and_or_b32 v56, v36, s100, v56
    v_and_b32 v52, 0x87ff87ff, v192
    v_lshrrev_b32 v37, 7, v193
    v_and_or_b32 v57, v37, s100, v57
    v_and_b32 v53, 0x87ff87ff, v193
    v_lshrrev_b32 v36, 7, v194
    v_and_or_b32 v58, v36, s100, v58
    v_and_b32 v54, 0x87ff87ff, v194
    v_lshrrev_b32 v37, 7, v195
    v_and_or_b32 v59, v37, s100, v59
    v_and_b32 v55, 0x87ff87ff, v195
    v_add_f32 v18, v18, v28
    v_mul_f32 v28, 0x78800000, v28
    v_add_f32 v19, v19, v29
    v_mul_f32 v29, 0x78800000, v29
    v_add_f32 v18, v18, v30
    v_mul_f32 v30, 0x78800000, v30
    v_add_f32 v19, v19, v31
    v_mul_f32 v31, 0x78800000, v31
    v_cvt_pk_bf16_f32 v32, v28, v28
    v_cvt_pk_bf16_f32 v33, v29, v29
    v_cvt_pk_bf16_f32 v34, v30, v30
    v_cvt_pk_bf16_f32 v35, v31, v31
    v_and_b32 v60, v32, v13
    v_and_b32 v61, v32, v14
    v_and_b32 v62, v32, v15
    v_and_b32 v63, v32, v16
    s_nop 1
    v_mfma_f32_16x16x32_bf16 v[20:23], v[48:51], v[60:63], v[20:23]
    v_and_b32 v24, v33, v13
    v_and_b32 v25, v33, v14
    v_and_b32 v26, v33, v15
    v_and_b32 v27, v33, v16
    s_nop 1
    v_mfma_f32_16x16x32_bf16 v[20:23], v[52:55], v[24:27], v[20:23]
    v_lshrrev_b32 v36, 3, v196
    v_and_or_b32 v56, v36, s101, v56
    v_lshlrev_b32 v37, 1, v196
    v_and_or_b32 v56, v37, s80, v56
    v_and_b32 v48, 0x87ff87ff, v196
    v_lshrrev_b32 v37, 3, v197
    v_and_or_b32 v57, v37, s101, v57
    v_lshlrev_b32 v36, 1, v197
    v_and_or_b32 v57, v36, s80, v57
    v_and_b32 v49, 0x87ff87ff, v197
    v_lshrrev_b32 v36, 3, v198
    v_and_or_b32 v58, v36, s101, v58
    v_lshlrev_b32 v37, 1, v198
    v_and_or_b32 v58, v37, s80, v58
    v_and_b32 v50, 0x87ff87ff, v198
    v_lshrrev_b32 v37, 3, v199
    v_and_or_b32 v59, v37, s101, v59
    v_lshlrev_b32 v36, 1, v199
    v_and_or_b32 v59, v36, s80, v59
    v_and_b32 v51, 0x87ff87ff, v199
    v_and_b32 v60, v34, v13
    v_and_b32 v61, v34, v14
    v_and_b32 v62, v34, v15
    v_and_b32 v63, v34, v16
    s_nop 1
    v_mfma_f32_16x16x32_bf16 v[20:23], v[48:51], v[60:63], v[20:23]
    v_and_b32 v24, v35, v13
    v_and_b32 v25, v35, v14
    v_and_b32 v26, v35, v15
    v_and_b32 v27, v35, v16
    s_nop 1
    v_mfma_f32_16x16x32_bf16 v[20:23], v[56:59], v[24:27], v[20:23]
    s_or_b32 s62, 41, 0
    s_bitcmp1_b32 s97, 9
    s_getpc_b64 s[92:93]
    s_cbranch_scc1 PATCH_V
SD_146:
    s_waitcnt vmcnt(12)
    ds_read_b128 v[48:51], v9 offset:4096
    ds_read_b128 v[52:55], v10 offset:4096
    ds_read_b128 v[56:59], v11 offset:4096
    ds_read_b128 v[60:63], v12 offset:4096
    s_waitcnt lgkmcnt(3)
    v_mfma_f32_16x16x32_bf16 v[24:27], v[48:51], v[64:67], 0
    s_waitcnt lgkmcnt(2)
    v_mfma_f32_16x16x32_bf16 v[24:27], v[52:55], v[68:71], v[24:27]
    s_waitcnt lgkmcnt(1)
    v_mfma_f32_16x16x32_bf16 v[24:27], v[56:59], v[72:75], v[24:27]
    s_waitcnt lgkmcnt(0)
    v_mfma_f32_16x16x32_bf16 v[24:27], v[60:63], v[76:79], v[24:27]
    s_nop 7
    v_fma_f32 v28, v24, s55, v17
    v_fma_f32 v29, v25, s55, v17
    v_fma_f32 v30, v26, s55, v17
    v_fma_f32 v31, v27, s55, v17
    v_max3_f32 v36, v28, v29, v30
    v_max_f32 v36, v36, v31
    v_cmp_lt_f32 vcc, s56, v36
    s_cbranch_vccnz RS_149
RB_150:
    v_exp_f32 v28, v28
    v_exp_f32 v29, v29
    v_exp_f32 v30, v30
    v_exp_f32 v31, v31
    v_cvt_pk_bf16_f32 v32, v28, v28
    v_add_f32 v18, v18, v28
    v_cvt_pk_bf16_f32 v33, v29, v29
    v_add_f32 v19, v19, v29
    v_cvt_pk_bf16_f32 v34, v30, v30
    v_add_f32 v18, v18, v30
    v_cvt_pk_bf16_f32 v35, v31, v31
    v_add_f32 v19, v19, v31
    s_waitcnt vmcnt(8)
    v_and_b32 v48, v32, v13
    v_and_b32 v49, v32, v14
    v_and_b32 v50, v32, v15
    v_and_b32 v51, v32, v16
    v_and_b32 v52, v33, v13
    v_and_b32 v53, v33, v14
    v_and_b32 v54, v33, v15
    v_and_b32 v55, v33, v16
    v_mfma_f32_16x16x32_bf16 v[20:23], a[16:19], v[48:51], v[20:23]
    v_and_b32 v56, v34, v13
    v_and_b32 v57, v34, v14
    v_and_b32 v58, v34, v15
    v_and_b32 v59, v34, v16
    v_mfma_f32_16x16x32_bf16 v[20:23], a[20:23], v[52:55], v[20:23]
    v_and_b32 v60, v35, v13
    v_and_b32 v61, v35, v14
    v_and_b32 v62, v35, v15
    v_and_b32 v63, v35, v16
    v_mfma_f32_16x16x32_bf16 v[20:23], a[24:27], v[56:59], v[20:23]
    s_nop 0
    v_mfma_f32_16x16x32_bf16 v[20:23], a[28:31], v[60:63], v[20:23]
    s_add_u32 s77, s90, 432
    s_mul_i32 s54, s77, s85
    s_add_u32 s54, s54, s53
    s_add_u32 m0, s59, 4096
    s_nop 0
    buffer_load_dwordx4 v4, s[4:7], s54 offen offset:0 nt lds
    buffer_load_dwordx4 v5, s[4:7], s54 offen offset:1024 nt lds
    buffer_load_dwordx4 v6, s[4:7], s54 offen offset:2048 nt lds
    buffer_load_dwordx4 v7, s[4:7], s54 offen offset:3072 nt lds
    buffer_load_dwordx4 a[16:19], v8, s[8:11], s54 offen offset:0 nt
    buffer_load_dwordx4 a[20:23], v8, s[8:11], s54 offen offset:256 nt
    buffer_load_dwordx4 a[24:27], v8, s[8:11], s54 offen offset:512 nt
    buffer_load_dwordx4 a[28:31], v8, s[8:11], s54 offen offset:768 nt
    s_bitcmp1_b32 s99, 10
    s_cbranch_scc1 SL_151
    v_lshlrev_b32 v36, 4, v0
    v_add_u32 v36, s59, v36
    ds_read_b128 v[48:51], v36 offset:8704
    ds_read_b128 v[52:55], v36 offset:9728
    ds_read_b128 v[56:59], v36 offset:10752
    s_waitcnt lgkmcnt(2)
    v_lshrrev_b32 v36, 11, v48
    v_and_b32 v60, 0x000f000f, v36
    v_and_b32 v48, 0x87ff87ff, v48
    v_lshrrev_b32 v37, 11, v49
    v_and_b32 v61, 0x000f000f, v37
    v_and_b32 v49, 0x87ff87ff, v49
    v_lshrrev_b32 v36, 11, v50
    v_and_b32 v62, 0x000f000f, v36
    v_and_b32 v50, 0x87ff87ff, v50
    v_lshrrev_b32 v37, 11, v51
    v_and_b32 v63, 0x000f000f, v37
    v_and_b32 v51, 0x87ff87ff, v51
    s_nop 1
    v_mfma_f32_16x16x32_bf16 v[24:27], v[48:51], v[64:67], 0
    s_waitcnt lgkmcnt(1)
    v_lshrrev_b32 v36, 7, v52
    v_and_or_b32 v60, v36, s100, v60
    v_and_b32 v52, 0x87ff87ff, v52
    v_lshrrev_b32 v37, 7, v53
    v_and_or_b32 v61, v37, s100, v61
    v_and_b32 v53, 0x87ff87ff, v53
    v_lshrrev_b32 v36, 7, v54
    v_and_or_b32 v62, v36, s100, v62
    v_and_b32 v54, 0x87ff87ff, v54
    v_lshrrev_b32 v37, 7, v55
    v_and_or_b32 v63, v37, s100, v63
    v_and_b32 v55, 0x87ff87ff, v55
    s_nop 1
    v_mfma_f32_16x16x32_bf16 v[24:27], v[52:55], v[68:71], v[24:27]
    s_waitcnt lgkmcnt(0)
    v_lshrrev_b32 v36, 3, v56
    v_and_or_b32 v60, v36, s101, v60
    v_lshlrev_b32 v37, 1, v56
    v_and_or_b32 v60, v37, s80, v60
    v_and_b32 v56, 0x87ff87ff, v56
    v_lshrrev_b32 v37, 3, v57
    v_and_or_b32 v61, v37, s101, v61
    v_lshlrev_b32 v36, 1, v57
    v_and_or_b32 v61, v36, s80, v61
    v_and_b32 v57, 0x87ff87ff, v57
    v_lshrrev_b32 v36, 3, v58
    v_and_or_b32 v62, v36, s101, v62
    v_lshlrev_b32 v37, 1, v58
    v_and_or_b32 v62, v37, s80, v62
    v_and_b32 v58, 0x87ff87ff, v58
    v_lshrrev_b32 v37, 3, v59
    v_and_or_b32 v63, v37, s101, v63
    v_lshlrev_b32 v36, 1, v59
    v_and_or_b32 v63, v36, s80, v63
    v_and_b32 v59, 0x87ff87ff, v59
    s_nop 1
    v_mfma_f32_16x16x32_bf16 v[24:27], v[56:59], v[72:75], v[24:27]
    v_mfma_f32_16x16x32_bf16 v[24:27], v[60:63], v[76:79], v[24:27]
    s_or_b32 s62, 10, 0
    s_bitcmp1_b32 s96, 10
    s_getpc_b64 s[92:93]
    s_cbranch_scc1 PATCH_K
    v_lshrrev_b32 v36, 11, v200
    v_and_b32 v56, 0x000f000f, v36
    v_and_b32 v48, 0x87ff87ff, v200
    v_lshrrev_b32 v37, 11, v201
    v_and_b32 v57, 0x000f000f, v37
    v_and_b32 v49, 0x87ff87ff, v201
    v_lshrrev_b32 v36, 11, v202
    v_and_b32 v58, 0x000f000f, v36
    v_and_b32 v50, 0x87ff87ff, v202
    v_lshrrev_b32 v37, 11, v203
    v_and_b32 v59, 0x000f000f, v37
    v_and_b32 v51, 0x87ff87ff, v203
    v_fmamk_f32 v28, v24, 0x568293ee, v17
    v_fmamk_f32 v29, v25, 0x568293ee, v17
    v_fmamk_f32 v30, v26, 0x568293ee, v17
    v_fmamk_f32 v31, v27, 0x568293ee, v17
    v_max3_f32 v36, v28, v29, v30
    v_max_f32 v36, v36, v31
    v_cmp_lt_f32 vcc, s56, v36
    s_cbranch_vccnz RS_153
RB_154:
    v_exp_f32 v28, v28
    v_exp_f32 v29, v29
    v_exp_f32 v30, v30
    v_exp_f32 v31, v31
    v_lshrrev_b32 v36, 7, v204
    v_and_or_b32 v56, v36, s100, v56
    v_and_b32 v52, 0x87ff87ff, v204
    v_lshrrev_b32 v37, 7, v205
    v_and_or_b32 v57, v37, s100, v57
    v_and_b32 v53, 0x87ff87ff, v205
    v_lshrrev_b32 v36, 7, v206
    v_and_or_b32 v58, v36, s100, v58
    v_and_b32 v54, 0x87ff87ff, v206
    v_lshrrev_b32 v37, 7, v207
    v_and_or_b32 v59, v37, s100, v59
    v_and_b32 v55, 0x87ff87ff, v207
    v_add_f32 v18, v18, v28
    v_mul_f32 v28, 0x78800000, v28
    v_add_f32 v19, v19, v29
    v_mul_f32 v29, 0x78800000, v29
    v_add_f32 v18, v18, v30
    v_mul_f32 v30, 0x78800000, v30
    v_add_f32 v19, v19, v31
    v_mul_f32 v31, 0x78800000, v31
    v_cvt_pk_bf16_f32 v32, v28, v28
    v_cvt_pk_bf16_f32 v33, v29, v29
    v_cvt_pk_bf16_f32 v34, v30, v30
    v_cvt_pk_bf16_f32 v35, v31, v31
    v_and_b32 v60, v32, v13
    v_and_b32 v61, v32, v14
    v_and_b32 v62, v32, v15
    v_and_b32 v63, v32, v16
    s_nop 1
    v_mfma_f32_16x16x32_bf16 v[20:23], v[48:51], v[60:63], v[20:23]
    v_and_b32 v24, v33, v13
    v_and_b32 v25, v33, v14
    v_and_b32 v26, v33, v15
    v_and_b32 v27, v33, v16
    s_nop 1
    v_mfma_f32_16x16x32_bf16 v[20:23], v[52:55], v[24:27], v[20:23]
    v_lshrrev_b32 v36, 3, v208
    v_and_or_b32 v56, v36, s101, v56
    v_lshlrev_b32 v37, 1, v208
    v_and_or_b32 v56, v37, s80, v56
    v_and_b32 v48, 0x87ff87ff, v208
    v_lshrrev_b32 v37, 3, v209
    v_and_or_b32 v57, v37, s101, v57
    v_lshlrev_b32 v36, 1, v209
    v_and_or_b32 v57, v36, s80, v57
    v_and_b32 v49, 0x87ff87ff, v209
    v_lshrrev_b32 v36, 3, v210
    v_and_or_b32 v58, v36, s101, v58
    v_lshlrev_b32 v37, 1, v210
    v_and_or_b32 v58, v37, s80, v58
    v_and_b32 v50, 0x87ff87ff, v210
    v_lshrrev_b32 v37, 3, v211
    v_and_or_b32 v59, v37, s101, v59
    v_lshlrev_b32 v36, 1, v211
    v_and_or_b32 v59, v36, s80, v59
    v_and_b32 v51, 0x87ff87ff, v211
    v_and_b32 v60, v34, v13
    v_and_b32 v61, v34, v14
    v_and_b32 v62, v34, v15
    v_and_b32 v63, v34, v16
    s_nop 1
    v_mfma_f32_16x16x32_bf16 v[20:23], v[48:51], v[60:63], v[20:23]
    v_and_b32 v24, v35, v13
    v_and_b32 v25, v35, v14
    v_and_b32 v26, v35, v15
    v_and_b32 v27, v35, v16
    s_nop 1
    v_mfma_f32_16x16x32_bf16 v[20:23], v[56:59], v[24:27], v[20:23]
    s_or_b32 s62, 42, 0
    s_bitcmp1_b32 s97, 10
    s_getpc_b64 s[92:93]
    s_cbranch_scc1 PATCH_V
SD_152:
    s_waitcnt vmcnt(12)
    ds_read_b128 v[48:51], v9 offset:0
    ds_read_b128 v[52:55], v10 offset:0
    ds_read_b128 v[56:59], v11 offset:0
    ds_read_b128 v[60:63], v12 offset:0
    s_waitcnt lgkmcnt(3)
    v_mfma_f32_16x16x32_bf16 v[24:27], v[48:51], v[64:67], 0
    s_waitcnt lgkmcnt(2)
    v_mfma_f32_16x16x32_bf16 v[24:27], v[52:55], v[68:71], v[24:27]
    s_waitcnt lgkmcnt(1)
    v_mfma_f32_16x16x32_bf16 v[24:27], v[56:59], v[72:75], v[24:27]
    s_waitcnt lgkmcnt(0)
    v_mfma_f32_16x16x32_bf16 v[24:27], v[60:63], v[76:79], v[24:27]
    s_nop 7
    v_fma_f32 v28, v24, s55, v17
    v_fma_f32 v29, v25, s55, v17
    v_fma_f32 v30, v26, s55, v17
    v_fma_f32 v31, v27, s55, v17
    v_max3_f32 v36, v28, v29, v30
    v_max_f32 v36, v36, v31
    v_cmp_lt_f32 vcc, s56, v36
    s_cbranch_vccnz RS_155
RB_156:
    v_exp_f32 v28, v28
    v_exp_f32 v29, v29
    v_exp_f32 v30, v30
    v_exp_f32 v31, v31
    v_cvt_pk_bf16_f32 v32, v28, v28
    v_add_f32 v18, v18, v28
    v_cvt_pk_bf16_f32 v33, v29, v29
    v_add_f32 v19, v19, v29
    v_cvt_pk_bf16_f32 v34, v30, v30
    v_add_f32 v18, v18, v30
    v_cvt_pk_bf16_f32 v35, v31, v31
    v_add_f32 v19, v19, v31
    s_waitcnt vmcnt(8)
    v_and_b32 v48, v32, v13
    v_and_b32 v49, v32, v14
    v_and_b32 v50, v32, v15
    v_and_b32 v51, v32, v16
    v_and_b32 v52, v33, v13
    v_and_b32 v53, v33, v14
    v_and_b32 v54, v33, v15
    v_and_b32 v55, v33, v16
    v_mfma_f32_16x16x32_bf16 v[20:23], a[0:3], v[48:51], v[20:23]
    v_and_b32 v56, v34, v13
    v_and_b32 v57, v34, v14
    v_and_b32 v58, v34, v15
    v_and_b32 v59, v34, v16
    v_mfma_f32_16x16x32_bf16 v[20:23], a[4:7], v[52:55], v[20:23]
    v_and_b32 v60, v35, v13
    v_and_b32 v61, v35, v14
    v_and_b32 v62, v35, v15
    v_and_b32 v63, v35, v16
    v_mfma_f32_16x16x32_bf16 v[20:23], a[8:11], v[56:59], v[20:23]
    s_nop 0
    v_mfma_f32_16x16x32_bf16 v[20:23], a[12:15], v[60:63], v[20:23]
    s_cmp_eq_u32 s83, 0
    s_cbranch_scc0 ML_157
    s_add_u32 s76, s90, 448
    s_mul_i32 s54, s76, s85
    s_add_u32 s54, s54, s53
    s_add_u32 m0, s59, 0
    s_nop 0
    buffer_load_dwordx4 v4, s[4:7], s54 offen offset:0 sc1 lds
    buffer_load_dwordx4 v5, s[4:7], s54 offen offset:1024 sc1 lds
    buffer_load_dwordx4 v6, s[4:7], s54 offen offset:2048 sc1 lds
    buffer_load_dwordx4 v7, s[4:7], s54 offen offset:3072 sc1 lds
    buffer_load_dwordx4 a[0:3], v8, s[8:11], s54 offen offset:0 sc1
    buffer_load_dwordx4 a[4:7], v8, s[8:11], s54 offen offset:256 sc1
    buffer_load_dwordx4 a[8:11], v8, s[8:11], s54 offen offset:512 sc1
    buffer_load_dwordx4 a[12:15], v8, s[8:11], s54 offen offset:768 sc1
    s_branch MJ_158
ML_157:
    s_add_u32 s76, s90, 448
    s_mul_i32 s54, s76, s85
    s_add_u32 s54, s54, s53
    s_add_u32 m0, s59, 0
    s_nop 0
    buffer_load_dwordx4 v4, s[4:7], s54 offen offset:0 nt lds
    buffer_load_dwordx4 v5, s[4:7], s54 offen offset:1024 nt lds
    buffer_load_dwordx4 v6, s[4:7], s54 offen offset:2048 nt lds
    buffer_load_dwordx4 v7, s[4:7], s54 offen offset:3072 nt lds
    buffer_load_dwordx4 a[0:3], v8, s[8:11], s54 offen offset:0 nt
    buffer_load_dwordx4 a[4:7], v8, s[8:11], s54 offen offset:256 nt
    buffer_load_dwordx4 a[8:11], v8, s[8:11], s54 offen offset:512 nt
    buffer_load_dwordx4 a[12:15], v8, s[8:11], s54 offen offset:768 nt
MJ_158:
    s_bitcmp1_b32 s99, 11
    s_cbranch_scc1 SL_159
    v_lshlrev_b32 v36, 4, v0
    v_add_u32 v36, s59, v36
    ds_read_b128 v[48:51], v36 offset:11776
    ds_read_b128 v[52:55], v36 offset:12800
    ds_read_b128 v[56:59], v36 offset:13824
    s_waitcnt lgkmcnt(2)
    v_lshrrev_b32 v36, 11, v48
    v_and_b32 v60, 0x000f000f, v36
    v_and_b32 v48, 0x87ff87ff, v48
    v_lshrrev_b32 v37, 11, v49
    v_and_b32 v61, 0x000f000f, v37
    v_and_b32 v49, 0x87ff87ff, v49
    v_lshrrev_b32 v36, 11, v50
    v_and_b32 v62, 0x000f000f, v36
    v_and_b32 v50, 0x87ff87ff, v50
    v_lshrrev_b32 v37, 11, v51
    v_and_b32 v63, 0x000f000f, v37
    v_and_b32 v51, 0x87ff87ff, v51
    s_nop 1
    v_mfma_f32_16x16x32_bf16 v[24:27], v[48:51], v[64:67], 0
    s_waitcnt lgkmcnt(1)
    v_lshrrev_b32 v36, 7, v52
    v_and_or_b32 v60, v36, s100, v60
    v_and_b32 v52, 0x87ff87ff, v52
    v_lshrrev_b32 v37, 7, v53
    v_and_or_b32 v61, v37, s100, v61
    v_and_b32 v53, 0x87ff87ff, v53
    v_lshrrev_b32 v36, 7, v54
    v_and_or_b32 v62, v36, s100, v62
    v_and_b32 v54, 0x87ff87ff, v54
    v_lshrrev_b32 v37, 7, v55
    v_and_or_b32 v63, v37, s100, v63
    v_and_b32 v55, 0x87ff87ff, v55
    s_nop 1
    v_mfma_f32_16x16x32_bf16 v[24:27], v[52:55], v[68:71], v[24:27]
    s_waitcnt lgkmcnt(0)
    v_lshrrev_b32 v36, 3, v56
    v_and_or_b32 v60, v36, s101, v60
    v_lshlrev_b32 v37, 1, v56
    v_and_or_b32 v60, v37, s80, v60
    v_and_b32 v56, 0x87ff87ff, v56
    v_lshrrev_b32 v37, 3, v57
    v_and_or_b32 v61, v37, s101, v61
    v_lshlrev_b32 v36, 1, v57
    v_and_or_b32 v61, v36, s80, v61
    v_and_b32 v57, 0x87ff87ff, v57
    v_lshrrev_b32 v36, 3, v58
    v_and_or_b32 v62, v36, s101, v62
    v_lshlrev_b32 v37, 1, v58
    v_and_or_b32 v62, v37, s80, v62
    v_and_b32 v58, 0x87ff87ff, v58
    v_lshrrev_b32 v37, 3, v59
    v_and_or_b32 v63, v37, s101, v63
    v_lshlrev_b32 v36, 1, v59
    v_and_or_b32 v63, v36, s80, v63
    v_and_b32 v59, 0x87ff87ff, v59
    s_nop 1
    v_mfma_f32_16x16x32_bf16 v[24:27], v[56:59], v[72:75], v[24:27]
    v_mfma_f32_16x16x32_bf16 v[24:27], v[60:63], v[76:79], v[24:27]
    s_or_b32 s62, 11, 0
    s_bitcmp1_b32 s96, 11
    s_getpc_b64 s[92:93]
    s_cbranch_scc1 PATCH_K
    v_lshrrev_b32 v36, 11, v212
    v_and_b32 v56, 0x000f000f, v36
    v_and_b32 v48, 0x87ff87ff, v212
    v_lshrrev_b32 v37, 11, v213
    v_and_b32 v57, 0x000f000f, v37
    v_and_b32 v49, 0x87ff87ff, v213
    v_lshrrev_b32 v36, 11, v214
    v_and_b32 v58, 0x000f000f, v36
    v_and_b32 v50, 0x87ff87ff, v214
    v_lshrrev_b32 v37, 11, v215
    v_and_b32 v59, 0x000f000f, v37
    v_and_b32 v51, 0x87ff87ff, v215
    v_fmamk_f32 v28, v24, 0x568293ee, v17
    v_fmamk_f32 v29, v25, 0x568293ee, v17
    v_fmamk_f32 v30, v26, 0x568293ee, v17
    v_fmamk_f32 v31, v27, 0x568293ee, v17
    v_max3_f32 v36, v28, v29, v30
    v_max_f32 v36, v36, v31
    v_cmp_lt_f32 vcc, s56, v36
    s_cbranch_vccnz RS_161
RB_162:
    v_exp_f32 v28, v28
    v_exp_f32 v29, v29
    v_exp_f32 v30, v30
    v_exp_f32 v31, v31
    v_lshrrev_b32 v36, 7, v216
    v_and_or_b32 v56, v36, s100, v56
    v_and_b32 v52, 0x87ff87ff, v216
    v_lshrrev_b32 v37, 7, v217
    v_and_or_b32 v57, v37, s100, v57
    v_and_b32 v53, 0x87ff87ff, v217
    v_lshrrev_b32 v36, 7, v218
    v_and_or_b32 v58, v36, s100, v58
    v_and_b32 v54, 0x87ff87ff, v218
    v_lshrrev_b32 v37, 7, v219
    v_and_or_b32 v59, v37, s100, v59
    v_and_b32 v55, 0x87ff87ff, v219
    v_add_f32 v18, v18, v28
    v_mul_f32 v28, 0x78800000, v28
    v_add_f32 v19, v19, v29
    v_mul_f32 v29, 0x78800000, v29
    v_add_f32 v18, v18, v30
    v_mul_f32 v30, 0x78800000, v30
    v_add_f32 v19, v19, v31
    v_mul_f32 v31, 0x78800000, v31
    v_cvt_pk_bf16_f32 v32, v28, v28
    v_cvt_pk_bf16_f32 v33, v29, v29
    v_cvt_pk_bf16_f32 v34, v30, v30
    v_cvt_pk_bf16_f32 v35, v31, v31
    v_and_b32 v60, v32, v13
    v_and_b32 v61, v32, v14
    v_and_b32 v62, v32, v15
    v_and_b32 v63, v32, v16
    s_nop 1
    v_mfma_f32_16x16x32_bf16 v[20:23], v[48:51], v[60:63], v[20:23]
    v_and_b32 v24, v33, v13
    v_and_b32 v25, v33, v14
    v_and_b32 v26, v33, v15
    v_and_b32 v27, v33, v16
    s_nop 1
    v_mfma_f32_16x16x32_bf16 v[20:23], v[52:55], v[24:27], v[20:23]
    v_lshrrev_b32 v36, 3, v220
    v_and_or_b32 v56, v36, s101, v56
    v_lshlrev_b32 v37, 1, v220
    v_and_or_b32 v56, v37, s80, v56
    v_and_b32 v48, 0x87ff87ff, v220
    v_lshrrev_b32 v37, 3, v221
    v_and_or_b32 v57, v37, s101, v57
    v_lshlrev_b32 v36, 1, v221
    v_and_or_b32 v57, v36, s80, v57
    v_and_b32 v49, 0x87ff87ff, v221
    v_lshrrev_b32 v36, 3, v222
    v_and_or_b32 v58, v36, s101, v58
    v_lshlrev_b32 v37, 1, v222
    v_and_or_b32 v58, v37, s80, v58
    v_and_b32 v50, 0x87ff87ff, v222
    v_lshrrev_b32 v37, 3, v223
    v_and_or_b32 v59, v37, s101, v59
    v_lshlrev_b32 v36, 1, v223
    v_and_or_b32 v59, v36, s80, v59
    v_and_b32 v51, 0x87ff87ff, v223
    v_and_b32 v60, v34, v13
    v_and_b32 v61, v34, v14
    v_and_b32 v62, v34, v15
    v_and_b32 v63, v34, v16
    s_nop 1
    v_mfma_f32_16x16x32_bf16 v[20:23], v[48:51], v[60:63], v[20:23]
    v_and_b32 v24, v35, v13
    v_and_b32 v25, v35, v14
    v_and_b32 v26, v35, v15
    v_and_b32 v27, v35, v16
    s_nop 1
    v_mfma_f32_16x16x32_bf16 v[20:23], v[56:59], v[24:27], v[20:23]
    s_or_b32 s62, 43, 0
    s_bitcmp1_b32 s97, 11
    s_getpc_b64 s[92:93]
    s_cbranch_scc1 PATCH_V
SD_160:
    s_waitcnt vmcnt(12)
    ds_read_b128 v[48:51], v9 offset:4096
    ds_read_b128 v[52:55], v10 offset:4096
    ds_read_b128 v[56:59], v11 offset:4096
    ds_read_b128 v[60:63], v12 offset:4096
    s_waitcnt lgkmcnt(3)
    v_mfma_f32_16x16x32_bf16 v[24:27], v[48:51], v[64:67], 0
    s_waitcnt lgkmcnt(2)
    v_mfma_f32_16x16x32_bf16 v[24:27], v[52:55], v[68:71], v[24:27]
    s_waitcnt lgkmcnt(1)
    v_mfma_f32_16x16x32_bf16 v[24:27], v[56:59], v[72:75], v[24:27]
    s_waitcnt lgkmcnt(0)
    v_mfma_f32_16x16x32_bf16 v[24:27], v[60:63], v[76:79], v[24:27]
    s_nop 7
    v_fma_f32 v28, v24, s55, v17
    v_fma_f32 v29, v25, s55, v17
    v_fma_f32 v30, v26, s55, v17
    v_fma_f32 v31, v27, s55, v17
    v_max3_f32 v36, v28, v29, v30
    v_max_f32 v36, v36, v31
    v_cmp_lt_f32 vcc, s56, v36
    s_cbranch_vccnz RS_163
RB_164:
    v_exp_f32 v28, v28
    v_exp_f32 v29, v29
    v_exp_f32 v30, v30
    v_exp_f32 v31, v31
    v_cvt_pk_bf16_f32 v32, v28, v28
    v_add_f32 v18, v18, v28
    v_cvt_pk_bf16_f32 v33, v29, v29
    v_add_f32 v19, v19, v29
    v_cvt_pk_bf16_f32 v34, v30, v30
    v_add_f32 v18, v18, v30
    v_cvt_pk_bf16_f32 v35, v31, v31
    v_add_f32 v19, v19, v31
    s_waitcnt vmcnt(8)
    v_and_b32 v48, v32, v13
    v_and_b32 v49, v32, v14
    v_and_b32 v50, v32, v15
    v_and_b32 v51, v32, v16
    v_and_b32 v52, v33, v13
    v_and_b32 v53, v33, v14
    v_and_b32 v54, v33, v15
    v_and_b32 v55, v33, v16
    v_mfma_f32_16x16x32_bf16 v[20:23], a[16:19], v[48:51], v[20:23]
    v_and_b32 v56, v34, v13
    v_and_b32 v57, v34, v14
    v_and_b32 v58, v34, v15
    v_and_b32 v59, v34, v16
    v_mfma_f32_16x16x32_bf16 v[20:23], a[20:23], v[52:55], v[20:23]
    v_and_b32 v60, v35, v13
    v_and_b32 v61, v35, v14
    v_and_b32 v62, v35, v15
    v_and_b32 v63, v35, v16
    v_mfma_f32_16x16x32_bf16 v[20:23], a[24:27], v[56:59], v[20:23]
    s_nop 0
    v_mfma_f32_16x16x32_bf16 v[20:23], a[28:31], v[60:63], v[20:23]
    s_add_u32 s77, s90, 464
    s_mul_i32 s54, s77, s85
    s_add_u32 s54, s54, s53
    s_add_u32 m0, s59, 4096
    s_nop 0
    buffer_load_dwordx4 v4, s[4:7], s54 offen offset:0 nt lds
    buffer_load_dwordx4 v5, s[4:7], s54 offen offset:1024 nt lds
    buffer_load_dwordx4 v6, s[4:7], s54 offen offset:2048 nt lds
    buffer_load_dwordx4 v7, s[4:7], s54 offen offset:3072 nt lds
    buffer_load_dwordx4 a[16:19], v8, s[8:11], s54 offen offset:0 nt
    buffer_load_dwordx4 a[20:23], v8, s[8:11], s54 offen offset:256 nt
    buffer_load_dwordx4 a[24:27], v8, s[8:11], s54 offen offset:512 nt
    buffer_load_dwordx4 a[28:31], v8, s[8:11], s54 offen offset:768 nt
    s_bitcmp1_b32 s99, 12
    s_cbranch_scc1 SL_165
    v_lshlrev_b32 v36, 4, v0
    v_add_u32 v36, s59, v36
    ds_read_b128 v[48:51], v36 offset:14848
    ds_read_b128 v[52:55], v36 offset:15872
    ds_read_b128 v[56:59], v36 offset:16896
    s_waitcnt lgkmcnt(2)
    v_lshrrev_b32 v36, 11, v48
    v_and_b32 v60, 0x000f000f, v36
    v_and_b32 v48, 0x87ff87ff, v48
    v_lshrrev_b32 v37, 11, v49
    v_and_b32 v61, 0x000f000f, v37
    v_and_b32 v49, 0x87ff87ff, v49
    v_lshrrev_b32 v36, 11, v50
    v_and_b32 v62, 0x000f000f, v36
    v_and_b32 v50, 0x87ff87ff, v50
    v_lshrrev_b32 v37, 11, v51
    v_and_b32 v63, 0x000f000f, v37
    v_and_b32 v51, 0x87ff87ff, v51
    s_nop 1
    v_mfma_f32_16x16x32_bf16 v[24:27], v[48:51], v[64:67], 0
    s_waitcnt lgkmcnt(1)
    v_lshrrev_b32 v36, 7, v52
    v_and_or_b32 v60, v36, s100, v60
    v_and_b32 v52, 0x87ff87ff, v52
    v_lshrrev_b32 v37, 7, v53
    v_and_or_b32 v61, v37, s100, v61
    v_and_b32 v53, 0x87ff87ff, v53
    v_lshrrev_b32 v36, 7, v54
    v_and_or_b32 v62, v36, s100, v62
    v_and_b32 v54, 0x87ff87ff, v54
    v_lshrrev_b32 v37, 7, v55
    v_and_or_b32 v63, v37, s100, v63
    v_and_b32 v55, 0x87ff87ff, v55
    s_nop 1
    v_mfma_f32_16x16x32_bf16 v[24:27], v[52:55], v[68:71], v[24:27]
    s_waitcnt lgkmcnt(0)
    v_lshrrev_b32 v36, 3, v56
    v_and_or_b32 v60, v36, s101, v60
    v_lshlrev_b32 v37, 1, v56
    v_and_or_b32 v60, v37, s80, v60
    v_and_b32 v56, 0x87ff87ff, v56
    v_lshrrev_b32 v37, 3, v57
    v_and_or_b32 v61, v37, s101, v61
    v_lshlrev_b32 v36, 1, v57
    v_and_or_b32 v61, v36, s80, v61
    v_and_b32 v57, 0x87ff87ff, v57
    v_lshrrev_b32 v36, 3, v58
    v_and_or_b32 v62, v36, s101, v62
    v_lshlrev_b32 v37, 1, v58
    v_and_or_b32 v62, v37, s80, v62
    v_and_b32 v58, 0x87ff87ff, v58
    v_lshrrev_b32 v37, 3, v59
    v_and_or_b32 v63, v37, s101, v63
    v_lshlrev_b32 v36, 1, v59
    v_and_or_b32 v63, v36, s80, v63
    v_and_b32 v59, 0x87ff87ff, v59
    s_nop 1
    v_mfma_f32_16x16x32_bf16 v[24:27], v[56:59], v[72:75], v[24:27]
    v_mfma_f32_16x16x32_bf16 v[24:27], v[60:63], v[76:79], v[24:27]
    s_or_b32 s62, 12, 0
    s_bitcmp1_b32 s96, 12
    s_getpc_b64 s[92:93]
    s_cbranch_scc1 PATCH_K
    v_lshrrev_b32 v36, 11, v224
    v_and_b32 v56, 0x000f000f, v36
    v_and_b32 v48, 0x87ff87ff, v224
    v_lshrrev_b32 v37, 11, v225
    v_and_b32 v57, 0x000f000f, v37
    v_and_b32 v49, 0x87ff87ff, v225
    v_lshrrev_b32 v36, 11, v226
    v_and_b32 v58, 0x000f000f, v36
    v_and_b32 v50, 0x87ff87ff, v226
    v_lshrrev_b32 v37, 11, v227
    v_and_b32 v59, 0x000f000f, v37
    v_and_b32 v51, 0x87ff87ff, v227
    v_fmamk_f32 v28, v24, 0x568293ee, v17
    v_fmamk_f32 v29, v25, 0x568293ee, v17
    v_fmamk_f32 v30, v26, 0x568293ee, v17
    v_fmamk_f32 v31, v27, 0x568293ee, v17
    v_max3_f32 v36, v28, v29, v30
    v_max_f32 v36, v36, v31
    v_cmp_lt_f32 vcc, s56, v36
    s_cbranch_vccnz RS_167
RB_168:
    v_exp_f32 v28, v28
    v_exp_f32 v29, v29
    v_exp_f32 v30, v30
    v_exp_f32 v31, v31
    v_lshrrev_b32 v36, 7, v228
    v_and_or_b32 v56, v36, s100, v56
    v_and_b32 v52, 0x87ff87ff, v228
    v_lshrrev_b32 v37, 7, v229
    v_and_or_b32 v57, v37, s100, v57
    v_and_b32 v53, 0x87ff87ff, v229
    v_lshrrev_b32 v36, 7, v230
    v_and_or_b32 v58, v36, s100, v58
    v_and_b32 v54, 0x87ff87ff, v230
    v_lshrrev_b32 v37, 7, v231
    v_and_or_b32 v59, v37, s100, v59
    v_and_b32 v55, 0x87ff87ff, v231
    v_add_f32 v18, v18, v28
    v_mul_f32 v28, 0x78800000, v28
    v_add_f32 v19, v19, v29
    v_mul_f32 v29, 0x78800000, v29
    v_add_f32 v18, v18, v30
    v_mul_f32 v30, 0x78800000, v30
    v_add_f32 v19, v19, v31
    v_mul_f32 v31, 0x78800000, v31
    v_cvt_pk_bf16_f32 v32, v28, v28
    v_cvt_pk_bf16_f32 v33, v29, v29
    v_cvt_pk_bf16_f32 v34, v30, v30
    v_cvt_pk_bf16_f32 v35, v31, v31
    v_and_b32 v60, v32, v13
    v_and_b32 v61, v32, v14
    v_and_b32 v62, v32, v15
    v_and_b32 v63, v32, v16
    s_nop 1
    v_mfma_f32_16x16x32_bf16 v[20:23], v[48:51], v[60:63], v[20:23]
    v_and_b32 v24, v33, v13
    v_and_b32 v25, v33, v14
    v_and_b32 v26, v33, v15
    v_and_b32 v27, v33, v16
    s_nop 1
    v_mfma_f32_16x16x32_bf16 v[20:23], v[52:55], v[24:27], v[20:23]
    v_lshrrev_b32 v36, 3, v232
    v_and_or_b32 v56, v36, s101, v56
    v_lshlrev_b32 v37, 1, v232
    v_and_or_b32 v56, v37, s80, v56
    v_and_b32 v48, 0x87ff87ff, v232
    v_lshrrev_b32 v37, 3, v233
    v_and_or_b32 v57, v37, s101, v57
    v_lshlrev_b32 v36, 1, v233
    v_and_or_b32 v57, v36, s80, v57
    v_and_b32 v49, 0x87ff87ff, v233
    v_lshrrev_b32 v36, 3, v234
    v_and_or_b32 v58, v36, s101, v58
    v_lshlrev_b32 v37, 1, v234
    v_and_or_b32 v58, v37, s80, v58
    v_and_b32 v50, 0x87ff87ff, v234
    v_lshrrev_b32 v37, 3, v235
    v_and_or_b32 v59, v37, s101, v59
    v_lshlrev_b32 v36, 1, v235
    v_and_or_b32 v59, v36, s80, v59
    v_and_b32 v51, 0x87ff87ff, v235
    v_and_b32 v60, v34, v13
    v_and_b32 v61, v34, v14
    v_and_b32 v62, v34, v15
    v_and_b32 v63, v34, v16
    s_nop 1
    v_mfma_f32_16x16x32_bf16 v[20:23], v[48:51], v[60:63], v[20:23]
    v_and_b32 v24, v35, v13
    v_and_b32 v25, v35, v14
    v_and_b32 v26, v35, v15
    v_and_b32 v27, v35, v16
    s_nop 1
    v_mfma_f32_16x16x32_bf16 v[20:23], v[56:59], v[24:27], v[20:23]
    s_or_b32 s62, 44, 0
    s_bitcmp1_b32 s97, 12
    s_getpc_b64 s[92:93]
    s_cbranch_scc1 PATCH_V
SD_166:
    s_waitcnt vmcnt(12)
    ds_read_b128 v[48:51], v9 offset:0
    ds_read_b128 v[52:55], v10 offset:0
    ds_read_b128 v[56:59], v11 offset:0
    ds_read_b128 v[60:63], v12 offset:0
    s_waitcnt lgkmcnt(3)
    v_mfma_f32_16x16x32_bf16 v[24:27], v[48:51], v[64:67], 0
    s_waitcnt lgkmcnt(2)
    v_mfma_f32_16x16x32_bf16 v[24:27], v[52:55], v[68:71], v[24:27]
    s_waitcnt lgkmcnt(1)
    v_mfma_f32_16x16x32_bf16 v[24:27], v[56:59], v[72:75], v[24:27]
    s_waitcnt lgkmcnt(0)
    v_mfma_f32_16x16x32_bf16 v[24:27], v[60:63], v[76:79], v[24:27]
    s_nop 7
    v_fma_f32 v28, v24, s55, v17
    v_fma_f32 v29, v25, s55, v17
    v_fma_f32 v30, v26, s55, v17
    v_fma_f32 v31, v27, s55, v17
    v_max3_f32 v36, v28, v29, v30
    v_max_f32 v36, v36, v31
    v_cmp_lt_f32 vcc, s56, v36
    s_cbranch_vccnz RS_169
RB_170:
    v_exp_f32 v28, v28
    v_exp_f32 v29, v29
    v_exp_f32 v30, v30
    v_exp_f32 v31, v31
    v_cvt_pk_bf16_f32 v32, v28, v28
    v_add_f32 v18, v18, v28
    v_cvt_pk_bf16_f32 v33, v29, v29
    v_add_f32 v19, v19, v29
    v_cvt_pk_bf16_f32 v34, v30, v30
    v_add_f32 v18, v18, v30
    v_cvt_pk_bf16_f32 v35, v31, v31
    v_add_f32 v19, v19, v31
    s_waitcnt vmcnt(8)
    v_and_b32 v48, v32, v13
    v_and_b32 v49, v32, v14
    v_and_b32 v50, v32, v15
    v_and_b32 v51, v32, v16
    v_and_b32 v52, v33, v13
    v_and_b32 v53, v33, v14
    v_and_b32 v54, v33, v15
    v_and_b32 v55, v33, v16
    v_mfma_f32_16x16x32_bf16 v[20:23], a[0:3], v[48:51], v[20:23]
    v_and_b32 v56, v34, v13
    v_and_b32 v57, v34, v14
    v_and_b32 v58, v34, v15
    v_and_b32 v59, v34, v16
    v_mfma_f32_16x16x32_bf16 v[20:23], a[4:7], v[52:55], v[20:23]
    v_and_b32 v60, v35, v13
    v_and_b32 v61, v35, v14
    v_and_b32 v62, v35, v15
    v_and_b32 v63, v35, v16
    v_mfma_f32_16x16x32_bf16 v[20:23], a[8:11], v[56:59], v[20:23]
    s_nop 0
    v_mfma_f32_16x16x32_bf16 v[20:23], a[12:15], v[60:63], v[20:23]
    s_add_u32 s76, s90, 480
    s_mul_i32 s54, s76, s85
    s_add_u32 s54, s54, s53
    s_add_u32 m0, s59, 0
    s_nop 0
    buffer_load_dwordx4 v4, s[4:7], s54 offen offset:0 nt lds
    buffer_load_dwordx4 v5, s[4:7], s54 offen offset:1024 nt lds
    buffer_load_dwordx4 v6, s[4:7], s54 offen offset:2048 nt lds
    buffer_load_dwordx4 v7, s[4:7], s54 offen offset:3072 nt lds
    buffer_load_dwordx4 a[0:3], v8, s[8:11], s54 offen offset:0 nt
    buffer_load_dwordx4 a[4:7], v8, s[8:11], s54 offen offset:256 nt
    buffer_load_dwordx4 a[8:11], v8, s[8:11], s54 offen offset:512 nt
    buffer_load_dwordx4 a[12:15], v8, s[8:11], s54 offen offset:768 nt
    s_bitcmp1_b32 s99, 13
    s_cbranch_scc1 SL_171
    v_lshlrev_b32 v36, 4, v0
    v_add_u32 v36, s59, v36
    ds_read_b128 v[48:51], v36 offset:17920
    ds_read_b128 v[52:55], v36 offset:18944
    ds_read_b128 v[56:59], v36 offset:19968
    s_waitcnt lgkmcnt(2)
    v_lshrrev_b32 v36, 11, v48
    v_and_b32 v60, 0x000f000f, v36
    v_and_b32 v48, 0x87ff87ff, v48
    v_lshrrev_b32 v37, 11, v49
    v_and_b32 v61, 0x000f000f, v37
    v_and_b32 v49, 0x87ff87ff, v49
    v_lshrrev_b32 v36, 11, v50
    v_and_b32 v62, 0x000f000f, v36
    v_and_b32 v50, 0x87ff87ff, v50
    v_lshrrev_b32 v37, 11, v51
    v_and_b32 v63, 0x000f000f, v37
    v_and_b32 v51, 0x87ff87ff, v51
    s_nop 1
    v_mfma_f32_16x16x32_bf16 v[24:27], v[48:51], v[64:67], 0
    s_waitcnt lgkmcnt(1)
    v_lshrrev_b32 v36, 7, v52
    v_and_or_b32 v60, v36, s100, v60
    v_and_b32 v52, 0x87ff87ff, v52
    v_lshrrev_b32 v37, 7, v53
    v_and_or_b32 v61, v37, s100, v61
    v_and_b32 v53, 0x87ff87ff, v53
    v_lshrrev_b32 v36, 7, v54
    v_and_or_b32 v62, v36, s100, v62
    v_and_b32 v54, 0x87ff87ff, v54
    v_lshrrev_b32 v37, 7, v55
    v_and_or_b32 v63, v37, s100, v63
    v_and_b32 v55, 0x87ff87ff, v55
    s_nop 1
    v_mfma_f32_16x16x32_bf16 v[24:27], v[52:55], v[68:71], v[24:27]
    s_waitcnt lgkmcnt(0)
    v_lshrrev_b32 v36, 3, v56
    v_and_or_b32 v60, v36, s101, v60
    v_lshlrev_b32 v37, 1, v56
    v_and_or_b32 v60, v37, s80, v60
    v_and_b32 v56, 0x87ff87ff, v56
    v_lshrrev_b32 v37, 3, v57
    v_and_or_b32 v61, v37, s101, v61
    v_lshlrev_b32 v36, 1, v57
    v_and_or_b32 v61, v36, s80, v61
    v_and_b32 v57, 0x87ff87ff, v57
    v_lshrrev_b32 v36, 3, v58
    v_and_or_b32 v62, v36, s101, v62
    v_lshlrev_b32 v37, 1, v58
    v_and_or_b32 v62, v37, s80, v62
    v_and_b32 v58, 0x87ff87ff, v58
    v_lshrrev_b32 v37, 3, v59
    v_and_or_b32 v63, v37, s101, v63
    v_lshlrev_b32 v36, 1, v59
    v_and_or_b32 v63, v36, s80, v63
    v_and_b32 v59, 0x87ff87ff, v59
    s_nop 1
    v_mfma_f32_16x16x32_bf16 v[24:27], v[56:59], v[72:75], v[24:27]
    v_mfma_f32_16x16x32_bf16 v[24:27], v[60:63], v[76:79], v[24:27]
    s_or_b32 s62, 13, 0
    s_bitcmp1_b32 s96, 13
    s_getpc_b64 s[92:93]
    s_cbranch_scc1 PATCH_K
    v_lshrrev_b32 v36, 11, v236
    v_and_b32 v56, 0x000f000f, v36
    v_and_b32 v48, 0x87ff87ff, v236
    v_lshrrev_b32 v37, 11, v237
    v_and_b32 v57, 0x000f000f, v37
    v_and_b32 v49, 0x87ff87ff, v237
    v_lshrrev_b32 v36, 11, v238
    v_and_b32 v58, 0x000f000f, v36
    v_and_b32 v50, 0x87ff87ff, v238
    v_lshrrev_b32 v37, 11, v239
    v_and_b32 v59, 0x000f000f, v37
    v_and_b32 v51, 0x87ff87ff, v239
    v_fmamk_f32 v28, v24, 0x568293ee, v17
    v_fmamk_f32 v29, v25, 0x568293ee, v17
    v_fmamk_f32 v30, v26, 0x568293ee, v17
    v_fmamk_f32 v31, v27, 0x568293ee, v17
    v_max3_f32 v36, v28, v29, v30
    v_max_f32 v36, v36, v31
    v_cmp_lt_f32 vcc, s56, v36
    s_cbranch_vccnz RS_173
RB_174:
    v_exp_f32 v28, v28
    v_exp_f32 v29, v29
    v_exp_f32 v30, v30
    v_exp_f32 v31, v31
    v_lshrrev_b32 v36, 7, v240
    v_and_or_b32 v56, v36, s100, v56
    v_and_b32 v52, 0x87ff87ff, v240
    v_lshrrev_b32 v37, 7, v241
    v_and_or_b32 v57, v37, s100, v57
    v_and_b32 v53, 0x87ff87ff, v241
    v_lshrrev_b32 v36, 7, v242
    v_and_or_b32 v58, v36, s100, v58
    v_and_b32 v54, 0x87ff87ff, v242
    v_lshrrev_b32 v37, 7, v243
    v_and_or_b32 v59, v37, s100, v59
    v_and_b32 v55, 0x87ff87ff, v243
    v_add_f32 v18, v18, v28
    v_mul_f32 v28, 0x78800000, v28
    v_add_f32 v19, v19, v29
    v_mul_f32 v29, 0x78800000, v29
    v_add_f32 v18, v18, v30
    v_mul_f32 v30, 0x78800000, v30
    v_add_f32 v19, v19, v31
    v_mul_f32 v31, 0x78800000, v31
    v_cvt_pk_bf16_f32 v32, v28, v28
    v_cvt_pk_bf16_f32 v33, v29, v29
    v_cvt_pk_bf16_f32 v34, v30, v30
    v_cvt_pk_bf16_f32 v35, v31, v31
    v_and_b32 v60, v32, v13
    v_and_b32 v61, v32, v14
    v_and_b32 v62, v32, v15
    v_and_b32 v63, v32, v16
    s_nop 1
    v_mfma_f32_16x16x32_bf16 v[20:23], v[48:51], v[60:63], v[20:23]
    v_and_b32 v24, v33, v13
    v_and_b32 v25, v33, v14
    v_and_b32 v26, v33, v15
    v_and_b32 v27, v33, v16
    s_nop 1
    v_mfma_f32_16x16x32_bf16 v[20:23], v[52:55], v[24:27], v[20:23]
    v_lshrrev_b32 v36, 3, v244
    v_and_or_b32 v56, v36, s101, v56
    v_lshlrev_b32 v37, 1, v244
    v_and_or_b32 v56, v37, s80, v56
    v_and_b32 v48, 0x87ff87ff, v244
    v_lshrrev_b32 v37, 3, v245
    v_and_or_b32 v57, v37, s101, v57
    v_lshlrev_b32 v36, 1, v245
    v_and_or_b32 v57, v36, s80, v57
    v_and_b32 v49, 0x87ff87ff, v245
    v_lshrrev_b32 v36, 3, v246
    v_and_or_b32 v58, v36, s101, v58
    v_lshlrev_b32 v37, 1, v246
    v_and_or_b32 v58, v37, s80, v58
    v_and_b32 v50, 0x87ff87ff, v246
    v_lshrrev_b32 v37, 3, v247
    v_and_or_b32 v59, v37, s101, v59
    v_lshlrev_b32 v36, 1, v247
    v_and_or_b32 v59, v36, s80, v59
    v_and_b32 v51, 0x87ff87ff, v247
    v_and_b32 v60, v34, v13
    v_and_b32 v61, v34, v14
    v_and_b32 v62, v34, v15
    v_and_b32 v63, v34, v16
    s_nop 1
    v_mfma_f32_16x16x32_bf16 v[20:23], v[48:51], v[60:63], v[20:23]
    v_and_b32 v24, v35, v13
    v_and_b32 v25, v35, v14
    v_and_b32 v26, v35, v15
    v_and_b32 v27, v35, v16
    s_nop 1
    v_mfma_f32_16x16x32_bf16 v[20:23], v[56:59], v[24:27], v[20:23]
    s_or_b32 s62, 45, 0
    s_bitcmp1_b32 s97, 13
    s_getpc_b64 s[92:93]
    s_cbranch_scc1 PATCH_V
SD_172:
    s_waitcnt vmcnt(12)
    ds_read_b128 v[48:51], v9 offset:4096
    ds_read_b128 v[52:55], v10 offset:4096
    ds_read_b128 v[56:59], v11 offset:4096
    ds_read_b128 v[60:63], v12 offset:4096
    s_waitcnt lgkmcnt(3)
    v_mfma_f32_16x16x32_bf16 v[24:27], v[48:51], v[64:67], 0
    s_waitcnt lgkmcnt(2)
    v_mfma_f32_16x16x32_bf16 v[24:27], v[52:55], v[68:71], v[24:27]
    s_waitcnt lgkmcnt(1)
    v_mfma_f32_16x16x32_bf16 v[24:27], v[56:59], v[72:75], v[24:27]
    s_waitcnt lgkmcnt(0)
    v_mfma_f32_16x16x32_bf16 v[24:27], v[60:63], v[76:79], v[24:27]
    s_nop 7
    v_fma_f32 v28, v24, s55, v17
    v_fma_f32 v29, v25, s55, v17
    v_fma_f32 v30, v26, s55, v17
    v_fma_f32 v31, v27, s55, v17
    v_max3_f32 v36, v28, v29, v30
    v_max_f32 v36, v36, v31
    v_cmp_lt_f32 vcc, s56, v36
    s_cbranch_vccnz RS_175
RB_176:
    v_exp_f32 v28, v28
    v_exp_f32 v29, v29
    v_exp_f32 v30, v30
    v_exp_f32 v31, v31
    v_cvt_pk_bf16_f32 v32, v28, v28
    v_add_f32 v18, v18, v28
    v_cvt_pk_bf16_f32 v33, v29, v29
    v_add_f32 v19, v19, v29
    v_cvt_pk_bf16_f32 v34, v30, v30
    v_add_f32 v18, v18, v30
    v_cvt_pk_bf16_f32 v35, v31, v31
    v_add_f32 v19, v19, v31
    s_waitcnt vmcnt(8)
    v_and_b32 v48, v32, v13
    v_and_b32 v49, v32, v14
    v_and_b32 v50, v32, v15
    v_and_b32 v51, v32, v16
    v_and_b32 v52, v33, v13
    v_and_b32 v53, v33, v14
    v_and_b32 v54, v33, v15
    v_and_b32 v55, v33, v16
    v_mfma_f32_16x16x32_bf16 v[20:23], a[16:19], v[48:51], v[20:23]
    v_and_b32 v56, v34, v13
    v_and_b32 v57, v34, v14
    v_and_b32 v58, v34, v15
    v_and_b32 v59, v34, v16
    v_mfma_f32_16x16x32_bf16 v[20:23], a[20:23], v[52:55], v[20:23]
    v_and_b32 v60, v35, v13
    v_and_b32 v61, v35, v14
    v_and_b32 v62, v35, v15
    v_and_b32 v63, v35, v16
    v_mfma_f32_16x16x32_bf16 v[20:23], a[24:27], v[56:59], v[20:23]
    s_nop 0
    v_mfma_f32_16x16x32_bf16 v[20:23], a[28:31], v[60:63], v[20:23]
    s_cmp_eq_u32 s83, 0
    s_cbranch_scc0 ML_177
    s_add_u32 s77, s90, 496
    s_mul_i32 s54, s77, s85
    s_add_u32 s54, s54, s53
    s_add_u32 m0, s59, 4096
    s_nop 0
    buffer_load_dwordx4 v4, s[4:7], s54 offen offset:0 sc1 lds
    buffer_load_dwordx4 v5, s[4:7], s54 offen offset:1024 sc1 lds
    buffer_load_dwordx4 v6, s[4:7], s54 offen offset:2048 sc1 lds
    buffer_load_dwordx4 v7, s[4:7], s54 offen offset:3072 sc1 lds
    buffer_load_dwordx4 a[16:19], v8, s[8:11], s54 offen offset:0 sc1
    buffer_load_dwordx4 a[20:23], v8, s[8:11], s54 offen offset:256 sc1
    buffer_load_dwordx4 a[24:27], v8, s[8:11], s54 offen offset:512 sc1
    buffer_load_dwordx4 a[28:31], v8, s[8:11], s54 offen offset:768 sc1
    s_branch MJ_178
ML_177:
    s_add_u32 s77, s90, 496
    s_mul_i32 s54, s77, s85
    s_add_u32 s54, s54, s53
    s_add_u32 m0, s59, 4096
    s_nop 0
    buffer_load_dwordx4 v4, s[4:7], s54 offen offset:0 nt lds
    buffer_load_dwordx4 v5, s[4:7], s54 offen offset:1024 nt lds
    buffer_load_dwordx4 v6, s[4:7], s54 offen offset:2048 nt lds
    buffer_load_dwordx4 v7, s[4:7], s54 offen offset:3072 nt lds
    buffer_load_dwordx4 a[16:19], v8, s[8:11], s54 offen offset:0 nt
    buffer_load_dwordx4 a[20:23], v8, s[8:11], s54 offen offset:256 nt
    buffer_load_dwordx4 a[24:27], v8, s[8:11], s54 offen offset:512 nt
    buffer_load_dwordx4 a[28:31], v8, s[8:11], s54 offen offset:768 nt
MJ_178:
    s_bitcmp1_b32 s99, 14
    s_cbranch_scc1 SL_179
    v_lshlrev_b32 v36, 4, v0
    v_add_u32 v36, s59, v36
    ds_read_b128 v[48:51], v36 offset:20992
    ds_read_b128 v[52:55], v36 offset:22016
    ds_read_b128 v[56:59], v36 offset:23040
    s_waitcnt lgkmcnt(2)
    v_lshrrev_b32 v36, 11, v48
    v_and_b32 v60, 0x000f000f, v36
    v_and_b32 v48, 0x87ff87ff, v48
    v_lshrrev_b32 v37, 11, v49
    v_and_b32 v61, 0x000f000f, v37
    v_and_b32 v49, 0x87ff87ff, v49
    v_lshrrev_b32 v36, 11, v50
    v_and_b32 v62, 0x000f000f, v36
    v_and_b32 v50, 0x87ff87ff, v50
    v_lshrrev_b32 v37, 11, v51
    v_and_b32 v63, 0x000f000f, v37
    v_and_b32 v51, 0x87ff87ff, v51
    s_nop 1
    v_mfma_f32_16x16x32_bf16 v[24:27], v[48:51], v[64:67], 0
    s_waitcnt lgkmcnt(1)
    v_lshrrev_b32 v36, 7, v52
    v_and_or_b32 v60, v36, s100, v60
    v_and_b32 v52, 0x87ff87ff, v52
    v_lshrrev_b32 v37, 7, v53
    v_and_or_b32 v61, v37, s100, v61
    v_and_b32 v53, 0x87ff87ff, v53
    v_lshrrev_b32 v36, 7, v54
    v_and_or_b32 v62, v36, s100, v62
    v_and_b32 v54, 0x87ff87ff, v54
    v_lshrrev_b32 v37, 7, v55
    v_and_or_b32 v63, v37, s100, v63
    v_and_b32 v55, 0x87ff87ff, v55
    s_nop 1
    v_mfma_f32_16x16x32_bf16 v[24:27], v[52:55], v[68:71], v[24:27]
    s_waitcnt lgkmcnt(0)
    v_lshrrev_b32 v36, 3, v56
    v_and_or_b32 v60, v36, s101, v60
    v_lshlrev_b32 v37, 1, v56
    v_and_or_b32 v60, v37, s80, v60
    v_and_b32 v56, 0x87ff87ff, v56
    v_lshrrev_b32 v37, 3, v57
    v_and_or_b32 v61, v37, s101, v61
    v_lshlrev_b32 v36, 1, v57
    v_and_or_b32 v61, v36, s80, v61
    v_and_b32 v57, 0x87ff87ff, v57
    v_lshrrev_b32 v36, 3, v58
    v_and_or_b32 v62, v36, s101, v62
    v_lshlrev_b32 v37, 1, v58
    v_and_or_b32 v62, v37, s80, v62
    v_and_b32 v58, 0x87ff87ff, v58
    v_lshrrev_b32 v37, 3, v59
    v_and_or_b32 v63, v37, s101, v63
    v_lshlrev_b32 v36, 1, v59
    v_and_or_b32 v63, v36, s80, v63
    v_and_b32 v59, 0x87ff87ff, v59
    s_nop 1
    v_mfma_f32_16x16x32_bf16 v[24:27], v[56:59], v[72:75], v[24:27]
    v_mfma_f32_16x16x32_bf16 v[24:27], v[60:63], v[76:79], v[24:27]
    s_or_b32 s62, 14, 0
    s_bitcmp1_b32 s96, 14
    s_getpc_b64 s[92:93]
    s_cbranch_scc1 PATCH_K
    v_lshrrev_b32 v36, 11, v248
    v_and_b32 v56, 0x000f000f, v36
    v_and_b32 v48, 0x87ff87ff, v248
    v_lshrrev_b32 v37, 11, v249
    v_and_b32 v57, 0x000f000f, v37
    v_and_b32 v49, 0x87ff87ff, v249
    v_lshrrev_b32 v36, 11, v250
    v_and_b32 v58, 0x000f000f, v36
    v_and_b32 v50, 0x87ff87ff, v250
    v_lshrrev_b32 v37, 11, v251
    v_and_b32 v59, 0x000f000f, v37
    v_and_b32 v51, 0x87ff87ff, v251
    v_fmamk_f32 v28, v24, 0x568293ee, v17
    v_fmamk_f32 v29, v25, 0x568293ee, v17
    v_fmamk_f32 v30, v26, 0x568293ee, v17
    v_fmamk_f32 v31, v27, 0x568293ee, v17
    v_max3_f32 v36, v28, v29, v30
    v_max_f32 v36, v36, v31
    v_cmp_lt_f32 vcc, s56, v36
    s_cbranch_vccnz RS_181
RB_182:
    v_exp_f32 v28, v28
    v_exp_f32 v29, v29
    v_exp_f32 v30, v30
    v_exp_f32 v31, v31
    v_lshrrev_b32 v36, 7, v252
    v_and_or_b32 v56, v36, s100, v56
    v_and_b32 v52, 0x87ff87ff, v252
    v_lshrrev_b32 v37, 7, v253
    v_and_or_b32 v57, v37, s100, v57
    v_and_b32 v53, 0x87ff87ff, v253
    v_lshrrev_b32 v36, 7, v254
    v_and_or_b32 v58, v36, s100, v58
    v_and_b32 v54, 0x87ff87ff, v254
    v_lshrrev_b32 v37, 7, v255
    v_and_or_b32 v59, v37, s100, v59
    v_and_b32 v55, 0x87ff87ff, v255
    v_add_f32 v18, v18, v28
    v_mul_f32 v28, 0x78800000, v28
    v_add_f32 v19, v19, v29
    v_mul_f32 v29, 0x78800000, v29
    v_add_f32 v18, v18, v30
    v_mul_f32 v30, 0x78800000, v30
    v_add_f32 v19, v19, v31
    v_mul_f32 v31, 0x78800000, v31
    v_cvt_pk_bf16_f32 v32, v28, v28
    v_cvt_pk_bf16_f32 v33, v29, v29
    v_cvt_pk_bf16_f32 v34, v30, v30
    v_cvt_pk_bf16_f32 v35, v31, v31
    v_and_b32 v60, v32, v13
    v_and_b32 v61, v32, v14
    v_and_b32 v62, v32, v15
    v_and_b32 v63, v32, v16
    s_nop 1
    v_mfma_f32_16x16x32_bf16 v[20:23], v[48:51], v[60:63], v[20:23]
    v_and_b32 v24, v33, v13
    v_and_b32 v25, v33, v14
    v_and_b32 v26, v33, v15
    v_and_b32 v27, v33, v16
    s_nop 1
    v_mfma_f32_16x16x32_bf16 v[20:23], v[52:55], v[24:27], v[20:23]
    v_accvgpr_read_b32 v48, a32
    v_accvgpr_read_b32 v49, a33
    v_accvgpr_read_b32 v50, a34
    v_accvgpr_read_b32 v51, a35
    v_lshrrev_b32 v36, 3, v48
    v_and_or_b32 v56, v36, s101, v56
    v_lshlrev_b32 v37, 1, v48
    v_and_or_b32 v56, v37, s80, v56
    v_and_b32 v48, 0x87ff87ff, v48
    v_lshrrev_b32 v37, 3, v49
    v_and_or_b32 v57, v37, s101, v57
    v_lshlrev_b32 v36, 1, v49
    v_and_or_b32 v57, v36, s80, v57
    v_and_b32 v49, 0x87ff87ff, v49
    v_lshrrev_b32 v36, 3, v50
    v_and_or_b32 v58, v36, s101, v58
    v_lshlrev_b32 v37, 1, v50
    v_and_or_b32 v58, v37, s80, v58
    v_and_b32 v50, 0x87ff87ff, v50
    v_lshrrev_b32 v37, 3, v51
    v_and_or_b32 v59, v37, s101, v59
    v_lshlrev_b32 v36, 1, v51
    v_and_or_b32 v59, v36, s80, v59
    v_and_b32 v51, 0x87ff87ff, v51
    v_and_b32 v60, v34, v13
    v_and_b32 v61, v34, v14
    v_and_b32 v62, v34, v15
    v_and_b32 v63, v34, v16
    s_nop 1
    v_mfma_f32_16x16x32_bf16 v[20:23], v[48:51], v[60:63], v[20:23]
    v_and_b32 v24, v35, v13
    v_and_b32 v25, v35, v14
    v_and_b32 v26, v35, v15
    v_and_b32 v27, v35, v16
    s_nop 1
    v_mfma_f32_16x16x32_bf16 v[20:23], v[56:59], v[24:27], v[20:23]
    s_or_b32 s62, 46, 0
    s_bitcmp1_b32 s97, 14
    s_getpc_b64 s[92:93]
    s_cbranch_scc1 PATCH_V
SD_180:
    s_waitcnt vmcnt(12)
    ds_read_b128 v[48:51], v9 offset:0
    ds_read_b128 v[52:55], v10 offset:0
    ds_read_b128 v[56:59], v11 offset:0
    ds_read_b128 v[60:63], v12 offset:0
    s_waitcnt lgkmcnt(3)
    v_mfma_f32_16x16x32_bf16 v[24:27], v[48:51], v[64:67], 0
    s_waitcnt lgkmcnt(2)
    v_mfma_f32_16x16x32_bf16 v[24:27], v[52:55], v[68:71], v[24:27]
    s_waitcnt lgkmcnt(1)
    v_mfma_f32_16x16x32_bf16 v[24:27], v[56:59], v[72:75], v[24:27]
    s_waitcnt lgkmcnt(0)
    v_mfma_f32_16x16x32_bf16 v[24:27], v[60:63], v[76:79], v[24:27]
    s_nop 7
    v_fma_f32 v28, v24, s55, v17
    v_fma_f32 v29, v25, s55, v17
    v_fma_f32 v30, v26, s55, v17
    v_fma_f32 v31, v27, s55, v17
    v_max3_f32 v36, v28, v29, v30
    v_max_f32 v36, v36, v31
    v_cmp_lt_f32 vcc, s56, v36
    s_cbranch_vccnz RS_183
RB_184:
    v_exp_f32 v28, v28
    v_exp_f32 v29, v29
    v_exp_f32 v30, v30
    v_exp_f32 v31, v31
    v_cvt_pk_bf16_f32 v32, v28, v28
    v_add_f32 v18, v18, v28
    v_cvt_pk_bf16_f32 v33, v29, v29
    v_add_f32 v19, v19, v29
    v_cvt_pk_bf16_f32 v34, v30, v30
    v_add_f32 v18, v18, v30
    v_cvt_pk_bf16_f32 v35, v31, v31
    v_add_f32 v19, v19, v31
    s_waitcnt vmcnt(8)
    v_and_b32 v48, v32, v13
    v_and_b32 v49, v32, v14
    v_and_b32 v50, v32, v15
    v_and_b32 v51, v32, v16
    v_and_b32 v52, v33, v13
    v_and_b32 v53, v33, v14
    v_and_b32 v54, v33, v15
    v_and_b32 v55, v33, v16
    v_mfma_f32_16x16x32_bf16 v[20:23], a[0:3], v[48:51], v[20:23]
    v_and_b32 v56, v34, v13
    v_and_b32 v57, v34, v14
    v_and_b32 v58, v34, v15
    v_and_b32 v59, v34, v16
    v_mfma_f32_16x16x32_bf16 v[20:23], a[4:7], v[52:55], v[20:23]
    v_and_b32 v60, v35, v13
    v_and_b32 v61, v35, v14
    v_and_b32 v62, v35, v15
    v_and_b32 v63, v35, v16
    v_mfma_f32_16x16x32_bf16 v[20:23], a[8:11], v[56:59], v[20:23]
    s_nop 0
    v_mfma_f32_16x16x32_bf16 v[20:23], a[12:15], v[60:63], v[20:23]
    s_add_u32 s76, s90, 512
    s_mul_i32 s54, s76, s85
    s_add_u32 s54, s54, s53
    s_add_u32 m0, s59, 0
    s_nop 0
    buffer_load_dwordx4 v4, s[4:7], s54 offen offset:0 nt lds
    buffer_load_dwordx4 v5, s[4:7], s54 offen offset:1024 nt lds
    buffer_load_dwordx4 v6, s[4:7], s54 offen offset:2048 nt lds
    buffer_load_dwordx4 v7, s[4:7], s54 offen offset:3072 nt lds
    buffer_load_dwordx4 a[0:3], v8, s[8:11], s54 offen offset:0 nt
    buffer_load_dwordx4 a[4:7], v8, s[8:11], s54 offen offset:256 nt
    buffer_load_dwordx4 a[8:11], v8, s[8:11], s54 offen offset:512 nt
    buffer_load_dwordx4 a[12:15], v8, s[8:11], s54 offen offset:768 nt
    s_bitcmp1_b32 s99, 15
    s_cbranch_scc1 SL_185
    v_lshlrev_b32 v36, 4, v0
    v_add_u32 v36, s59, v36
    ds_read_b128 v[48:51], v36 offset:24064
    ds_read_b128 v[52:55], v36 offset:25088
    ds_read_b128 v[56:59], v36 offset:26112
    s_waitcnt lgkmcnt(2)
    v_lshrrev_b32 v36, 11, v48
    v_and_b32 v60, 0x000f000f, v36
    v_and_b32 v48, 0x87ff87ff, v48
    v_lshrrev_b32 v37, 11, v49
    v_and_b32 v61, 0x000f000f, v37
    v_and_b32 v49, 0x87ff87ff, v49
    v_lshrrev_b32 v36, 11, v50
    v_and_b32 v62, 0x000f000f, v36
    v_and_b32 v50, 0x87ff87ff, v50
    v_lshrrev_b32 v37, 11, v51
    v_and_b32 v63, 0x000f000f, v37
    v_and_b32 v51, 0x87ff87ff, v51
    s_nop 1
    v_mfma_f32_16x16x32_bf16 v[24:27], v[48:51], v[64:67], 0
    s_waitcnt lgkmcnt(1)
    v_lshrrev_b32 v36, 7, v52
    v_and_or_b32 v60, v36, s100, v60
    v_and_b32 v52, 0x87ff87ff, v52
    v_lshrrev_b32 v37, 7, v53
    v_and_or_b32 v61, v37, s100, v61
    v_and_b32 v53, 0x87ff87ff, v53
    v_lshrrev_b32 v36, 7, v54
    v_and_or_b32 v62, v36, s100, v62
    v_and_b32 v54, 0x87ff87ff, v54
    v_lshrrev_b32 v37, 7, v55
    v_and_or_b32 v63, v37, s100, v63
    v_and_b32 v55, 0x87ff87ff, v55
    s_nop 1
    v_mfma_f32_16x16x32_bf16 v[24:27], v[52:55], v[68:71], v[24:27]
    s_waitcnt lgkmcnt(0)
    v_lshrrev_b32 v36, 3, v56
    v_and_or_b32 v60, v36, s101, v60
    v_lshlrev_b32 v37, 1, v56
    v_and_or_b32 v60, v37, s80, v60
    v_and_b32 v56, 0x87ff87ff, v56
    v_lshrrev_b32 v37, 3, v57
    v_and_or_b32 v61, v37, s101, v61
    v_lshlrev_b32 v36, 1, v57
    v_and_or_b32 v61, v36, s80, v61
    v_and_b32 v57, 0x87ff87ff, v57
    v_lshrrev_b32 v36, 3, v58
    v_and_or_b32 v62, v36, s101, v62
    v_lshlrev_b32 v37, 1, v58
    v_and_or_b32 v62, v37, s80, v62
    v_and_b32 v58, 0x87ff87ff, v58
    v_lshrrev_b32 v37, 3, v59
    v_and_or_b32 v63, v37, s101, v63
    v_lshlrev_b32 v36, 1, v59
    v_and_or_b32 v63, v36, s80, v63
    v_and_b32 v59, 0x87ff87ff, v59
    s_nop 1
    v_mfma_f32_16x16x32_bf16 v[24:27], v[56:59], v[72:75], v[24:27]
    v_mfma_f32_16x16x32_bf16 v[24:27], v[60:63], v[76:79], v[24:27]
    s_or_b32 s62, 15, 0
    s_bitcmp1_b32 s96, 15
    s_getpc_b64 s[92:93]
    s_cbranch_scc1 PATCH_K
    v_accvgpr_read_b32 v48, a36
    v_accvgpr_read_b32 v49, a37
    v_accvgpr_read_b32 v50, a38
    v_accvgpr_read_b32 v51, a39
    v_lshrrev_b32 v36, 11, v48
    v_and_b32 v56, 0x000f000f, v36
    v_and_b32 v48, 0x87ff87ff, v48
    v_lshrrev_b32 v37, 11, v49
    v_and_b32 v57, 0x000f000f, v37
    v_and_b32 v49, 0x87ff87ff, v49
    v_lshrrev_b32 v36, 11, v50
    v_and_b32 v58, 0x000f000f, v36
    v_and_b32 v50, 0x87ff87ff, v50
    v_lshrrev_b32 v37, 11, v51
    v_and_b32 v59, 0x000f000f, v37
    v_and_b32 v51, 0x87ff87ff, v51
    v_fmamk_f32 v28, v24, 0x568293ee, v17
    v_fmamk_f32 v29, v25, 0x568293ee, v17
    v_fmamk_f32 v30, v26, 0x568293ee, v17
    v_fmamk_f32 v31, v27, 0x568293ee, v17
    v_max3_f32 v36, v28, v29, v30
    v_max_f32 v36, v36, v31
    v_cmp_lt_f32 vcc, s56, v36
    s_cbranch_vccnz RS_187
RB_188:
    v_exp_f32 v28, v28
    v_exp_f32 v29, v29
    v_exp_f32 v30, v30
    v_exp_f32 v31, v31
    v_accvgpr_read_b32 v52, a40
    v_accvgpr_read_b32 v53, a41
    v_accvgpr_read_b32 v54, a42
    v_accvgpr_read_b32 v55, a43
    v_lshrrev_b32 v36, 7, v52
    v_and_or_b32 v56, v36, s100, v56
    v_and_b32 v52, 0x87ff87ff, v52
    v_lshrrev_b32 v37, 7, v53
    v_and_or_b32 v57, v37, s100, v57
    v_and_b32 v53, 0x87ff87ff, v53
    v_lshrrev_b32 v36, 7, v54
    v_and_or_b32 v58, v36, s100, v58
    v_and_b32 v54, 0x87ff87ff, v54
    v_lshrrev_b32 v37, 7, v55
    v_and_or_b32 v59, v37, s100, v59
    v_and_b32 v55, 0x87ff87ff, v55
    v_add_f32 v18, v18, v28
    v_mul_f32 v28, 0x78800000, v28
    v_add_f32 v19, v19, v29
    v_mul_f32 v29, 0x78800000, v29
    v_add_f32 v18, v18, v30
    v_mul_f32 v30, 0x78800000, v30
    v_add_f32 v19, v19, v31
    v_mul_f32 v31, 0x78800000, v31
    v_cvt_pk_bf16_f32 v32, v28, v28
    v_cvt_pk_bf16_f32 v33, v29, v29
    v_cvt_pk_bf16_f32 v34, v30, v30
    v_cvt_pk_bf16_f32 v35, v31, v31
    v_and_b32 v60, v32, v13
    v_and_b32 v61, v32, v14
    v_and_b32 v62, v32, v15
    v_and_b32 v63, v32, v16
    s_nop 1
    v_mfma_f32_16x16x32_bf16 v[20:23], v[48:51], v[60:63], v[20:23]
    v_and_b32 v24, v33, v13
    v_and_b32 v25, v33, v14
    v_and_b32 v26, v33, v15
    v_and_b32 v27, v33, v16
    s_nop 1
    v_mfma_f32_16x16x32_bf16 v[20:23], v[52:55], v[24:27], v[20:23]
    v_accvgpr_read_b32 v48, a44
    v_accvgpr_read_b32 v49, a45
    v_accvgpr_read_b32 v50, a46
    v_accvgpr_read_b32 v51, a47
    v_lshrrev_b32 v36, 3, v48
    v_and_or_b32 v56, v36, s101, v56
    v_lshlrev_b32 v37, 1, v48
    v_and_or_b32 v56, v37, s80, v56
    v_and_b32 v48, 0x87ff87ff, v48
    v_lshrrev_b32 v37, 3, v49
    v_and_or_b32 v57, v37, s101, v57
    v_lshlrev_b32 v36, 1, v49
    v_and_or_b32 v57, v36, s80, v57
    v_and_b32 v49, 0x87ff87ff, v49
    v_lshrrev_b32 v36, 3, v50
    v_and_or_b32 v58, v36, s101, v58
    v_lshlrev_b32 v37, 1, v50
    v_and_or_b32 v58, v37, s80, v58
    v_and_b32 v50, 0x87ff87ff, v50
    v_lshrrev_b32 v37, 3, v51
    v_and_or_b32 v59, v37, s101, v59
    v_lshlrev_b32 v36, 1, v51
    v_and_or_b32 v59, v36, s80, v59
    v_and_b32 v51, 0x87ff87ff, v51
    v_and_b32 v60, v34, v13
    v_and_b32 v61, v34, v14
    v_and_b32 v62, v34, v15
    v_and_b32 v63, v34, v16
    s_nop 1
    v_mfma_f32_16x16x32_bf16 v[20:23], v[48:51], v[60:63], v[20:23]
    v_and_b32 v24, v35, v13
    v_and_b32 v25, v35, v14
    v_and_b32 v26, v35, v15
    v_and_b32 v27, v35, v16
    s_nop 1
    v_mfma_f32_16x16x32_bf16 v[20:23], v[56:59], v[24:27], v[20:23]
    s_or_b32 s62, 47, 0
    s_bitcmp1_b32 s97, 15
    s_getpc_b64 s[92:93]
    s_cbranch_scc1 PATCH_V
SD_186:
    s_waitcnt vmcnt(12)
    ds_read_b128 v[48:51], v9 offset:4096
    ds_read_b128 v[52:55], v10 offset:4096
    ds_read_b128 v[56:59], v11 offset:4096
    ds_read_b128 v[60:63], v12 offset:4096
    s_waitcnt lgkmcnt(3)
    v_mfma_f32_16x16x32_bf16 v[24:27], v[48:51], v[64:67], 0
    s_waitcnt lgkmcnt(2)
    v_mfma_f32_16x16x32_bf16 v[24:27], v[52:55], v[68:71], v[24:27]
    s_waitcnt lgkmcnt(1)
    v_mfma_f32_16x16x32_bf16 v[24:27], v[56:59], v[72:75], v[24:27]
    s_waitcnt lgkmcnt(0)
    v_mfma_f32_16x16x32_bf16 v[24:27], v[60:63], v[76:79], v[24:27]
    s_nop 7
    v_fma_f32 v28, v24, s55, v17
    v_fma_f32 v29, v25, s55, v17
    v_fma_f32 v30, v26, s55, v17
    v_fma_f32 v31, v27, s55, v17
    v_max3_f32 v36, v28, v29, v30
    v_max_f32 v36, v36, v31
    v_cmp_lt_f32 vcc, s56, v36
    s_cbranch_vccnz RS_189
RB_190:
    v_exp_f32 v28, v28
    v_exp_f32 v29, v29
    v_exp_f32 v30, v30
    v_exp_f32 v31, v31
    v_cvt_pk_bf16_f32 v32, v28, v28
    v_add_f32 v18, v18, v28
    v_cvt_pk_bf16_f32 v33, v29, v29
    v_add_f32 v19, v19, v29
    v_cvt_pk_bf16_f32 v34, v30, v30
    v_add_f32 v18, v18, v30
    v_cvt_pk_bf16_f32 v35, v31, v31
    v_add_f32 v19, v19, v31
    s_waitcnt vmcnt(8)
    v_and_b32 v48, v32, v13
    v_and_b32 v49, v32, v14
    v_and_b32 v50, v32, v15
    v_and_b32 v51, v32, v16
    v_and_b32 v52, v33, v13
    v_and_b32 v53, v33, v14
    v_and_b32 v54, v33, v15
    v_and_b32 v55, v33, v16
    v_mfma_f32_16x16x32_bf16 v[20:23], a[16:19], v[48:51], v[20:23]
    v_and_b32 v56, v34, v13
    v_and_b32 v57, v34, v14
    v_and_b32 v58, v34, v15
    v_and_b32 v59, v34, v16
    v_mfma_f32_16x16x32_bf16 v[20:23], a[20:23], v[52:55], v[20:23]
    v_and_b32 v60, v35, v13
    v_and_b32 v61, v35, v14
    v_and_b32 v62, v35, v15
    v_and_b32 v63, v35, v16
    v_mfma_f32_16x16x32_bf16 v[20:23], a[24:27], v[56:59], v[20:23]
    s_nop 0
    v_mfma_f32_16x16x32_bf16 v[20:23], a[28:31], v[60:63], v[20:23]
    s_add_u32 s77, s90, 528
    s_mul_i32 s54, s77, s85
    s_add_u32 s54, s54, s53
    s_add_u32 m0, s59, 4096
    s_nop 0
    buffer_load_dwordx4 v4, s[4:7], s54 offen offset:0 nt lds
    buffer_load_dwordx4 v5, s[4:7], s54 offen offset:1024 nt lds
    buffer_load_dwordx4 v6, s[4:7], s54 offen offset:2048 nt lds
    buffer_load_dwordx4 v7, s[4:7], s54 offen offset:3072 nt lds
    buffer_load_dwordx4 a[16:19], v8, s[8:11], s54 offen offset:0 nt
    buffer_load_dwordx4 a[20:23], v8, s[8:11], s54 offen offset:256 nt
    buffer_load_dwordx4 a[24:27], v8, s[8:11], s54 offen offset:512 nt
    buffer_load_dwordx4 a[28:31], v8, s[8:11], s54 offen offset:768 nt
    s_cmp_lt_u32 s81, 2
    s_cbranch_scc1 XR_191
    s_bitcmp1_b32 s99, 16
    s_cbranch_scc1 SL_192
    v_lshlrev_b32 v36, 4, v0
    v_add_u32 v36, s59, v36
    ds_read_b128 v[48:51], v36 offset:27136
    ds_read_b128 v[52:55], v36 offset:28160
    ds_read_b128 v[56:59], v36 offset:29184
    s_waitcnt lgkmcnt(2)
    v_lshrrev_b32 v36, 11, v48
    v_and_b32 v60, 0x000f000f, v36
    v_and_b32 v48, 0x87ff87ff, v48
    v_lshrrev_b32 v37, 11, v49
    v_and_b32 v61, 0x000f000f, v37
    v_and_b32 v49, 0x87ff87ff, v49
    v_lshrrev_b32 v36, 11, v50
    v_and_b32 v62, 0x000f000f, v36
    v_and_b32 v50, 0x87ff87ff, v50
    v_lshrrev_b32 v37, 11, v51
    v_and_b32 v63, 0x000f000f, v37
    v_and_b32 v51, 0x87ff87ff, v51
    s_nop 1
    v_mfma_f32_16x16x32_bf16 v[24:27], v[48:51], v[64:67], 0
    s_waitcnt lgkmcnt(1)
    v_lshrrev_b32 v36, 7, v52
    v_and_or_b32 v60, v36, s100, v60
    v_and_b32 v52, 0x87ff87ff, v52
    v_lshrrev_b32 v37, 7, v53
    v_and_or_b32 v61, v37, s100, v61
    v_and_b32 v53, 0x87ff87ff, v53
    v_lshrrev_b32 v36, 7, v54
    v_and_or_b32 v62, v36, s100, v62
    v_and_b32 v54, 0x87ff87ff, v54
    v_lshrrev_b32 v37, 7, v55
    v_and_or_b32 v63, v37, s100, v63
    v_and_b32 v55, 0x87ff87ff, v55
    s_nop 1
    v_mfma_f32_16x16x32_bf16 v[24:27], v[52:55], v[68:71], v[24:27]
    s_waitcnt lgkmcnt(0)
    v_lshrrev_b32 v36, 3, v56
    v_and_or_b32 v60, v36, s101, v60
    v_lshlrev_b32 v37, 1, v56
    v_and_or_b32 v60, v37, s80, v60
    v_and_b32 v56, 0x87ff87ff, v56
    v_lshrrev_b32 v37, 3, v57
    v_and_or_b32 v61, v37, s101, v61
    v_lshlrev_b32 v36, 1, v57
    v_and_or_b32 v61, v36, s80, v61
    v_and_b32 v57, 0x87ff87ff, v57
    v_lshrrev_b32 v36, 3, v58
    v_and_or_b32 v62, v36, s101, v62
    v_lshlrev_b32 v37, 1, v58
    v_and_or_b32 v62, v37, s80, v62
    v_and_b32 v58, 0x87ff87ff, v58
    v_lshrrev_b32 v37, 3, v59
    v_and_or_b32 v63, v37, s101, v63
    v_lshlrev_b32 v36, 1, v59
    v_and_or_b32 v63, v36, s80, v63
    v_and_b32 v59, 0x87ff87ff, v59
    s_nop 1
    v_mfma_f32_16x16x32_bf16 v[24:27], v[56:59], v[72:75], v[24:27]
    v_mfma_f32_16x16x32_bf16 v[24:27], v[60:63], v[76:79], v[24:27]
    s_or_b32 s62, 16, 0
    s_bitcmp1_b32 s96, 16
    s_getpc_b64 s[92:93]
    s_cbranch_scc1 PATCH_K
    v_accvgpr_read_b32 v48, a184
    v_accvgpr_read_b32 v49, a185
    v_accvgpr_read_b32 v50, a186
    v_accvgpr_read_b32 v51, a187
    v_lshrrev_b32 v36, 11, v48
    v_and_b32 v56, 0x000f000f, v36
    v_and_b32 v48, 0x87ff87ff, v48
    v_lshrrev_b32 v37, 11, v49
    v_and_b32 v57, 0x000f000f, v37
    v_and_b32 v49, 0x87ff87ff, v49
    v_lshrrev_b32 v36, 11, v50
    v_and_b32 v58, 0x000f000f, v36
    v_and_b32 v50, 0x87ff87ff, v50
    v_lshrrev_b32 v37, 11, v51
    v_and_b32 v59, 0x000f000f, v37
    v_and_b32 v51, 0x87ff87ff, v51
    v_fmamk_f32 v28, v24, 0x568293ee, v17
    v_fmamk_f32 v29, v25, 0x568293ee, v17
    v_fmamk_f32 v30, v26, 0x568293ee, v17
    v_fmamk_f32 v31, v27, 0x568293ee, v17
    v_max3_f32 v36, v28, v29, v30
    v_max_f32 v36, v36, v31
    v_cmp_lt_f32 vcc, s56, v36
    s_cbranch_vccnz RS_194
RB_195:
    v_exp_f32 v28, v28
    v_exp_f32 v29, v29
    v_exp_f32 v30, v30
    v_exp_f32 v31, v31
    v_accvgpr_read_b32 v52, a188
    v_accvgpr_read_b32 v53, a189
    v_accvgpr_read_b32 v54, a190
    v_accvgpr_read_b32 v55, a191
    v_lshrrev_b32 v36, 7, v52
    v_and_or_b32 v56, v36, s100, v56
    v_and_b32 v52, 0x87ff87ff, v52
    v_lshrrev_b32 v37, 7, v53
    v_and_or_b32 v57, v37, s100, v57
    v_and_b32 v53, 0x87ff87ff, v53
    v_lshrrev_b32 v36, 7, v54
    v_and_or_b32 v58, v36, s100, v58
    v_and_b32 v54, 0x87ff87ff, v54
    v_lshrrev_b32 v37, 7, v55
    v_and_or_b32 v59, v37, s100, v59
    v_and_b32 v55, 0x87ff87ff, v55
    v_add_f32 v18, v18, v28
    v_mul_f32 v28, 0x78800000, v28
    v_add_f32 v19, v19, v29
    v_mul_f32 v29, 0x78800000, v29
    v_add_f32 v18, v18, v30
    v_mul_f32 v30, 0x78800000, v30
    v_add_f32 v19, v19, v31
    v_mul_f32 v31, 0x78800000, v31
    v_cvt_pk_bf16_f32 v32, v28, v28
    v_cvt_pk_bf16_f32 v33, v29, v29
    v_cvt_pk_bf16_f32 v34, v30, v30
    v_cvt_pk_bf16_f32 v35, v31, v31
    v_and_b32 v60, v32, v13
    v_and_b32 v61, v32, v14
    v_and_b32 v62, v32, v15
    v_and_b32 v63, v32, v16
    s_nop 1
    v_mfma_f32_16x16x32_bf16 v[20:23], v[48:51], v[60:63], v[20:23]
    v_and_b32 v24, v33, v13
    v_and_b32 v25, v33, v14
    v_and_b32 v26, v33, v15
    v_and_b32 v27, v33, v16
    s_nop 1
    v_mfma_f32_16x16x32_bf16 v[20:23], v[52:55], v[24:27], v[20:23]
    v_accvgpr_read_b32 v48, a192
    v_accvgpr_read_b32 v49, a193
    v_accvgpr_read_b32 v50, a194
    v_accvgpr_read_b32 v51, a195
    v_lshrrev_b32 v36, 3, v48
    v_and_or_b32 v56, v36, s101, v56
    v_lshlrev_b32 v37, 1, v48
    v_and_or_b32 v56, v37, s80, v56
    v_and_b32 v48, 0x87ff87ff, v48
    v_lshrrev_b32 v37, 3, v49
    v_and_or_b32 v57, v37, s101, v57
    v_lshlrev_b32 v36, 1, v49
    v_and_or_b32 v57, v36, s80, v57
    v_and_b32 v49, 0x87ff87ff, v49
    v_lshrrev_b32 v36, 3, v50
    v_and_or_b32 v58, v36, s101, v58
    v_lshlrev_b32 v37, 1, v50
    v_and_or_b32 v58, v37, s80, v58
    v_and_b32 v50, 0x87ff87ff, v50
    v_lshrrev_b32 v37, 3, v51
    v_and_or_b32 v59, v37, s101, v59
    v_lshlrev_b32 v36, 1, v51
    v_and_or_b32 v59, v36, s80, v59
    v_and_b32 v51, 0x87ff87ff, v51
    v_and_b32 v60, v34, v13
    v_and_b32 v61, v34, v14
    v_and_b32 v62, v34, v15
    v_and_b32 v63, v34, v16
    s_nop 1
    v_mfma_f32_16x16x32_bf16 v[20:23], v[48:51], v[60:63], v[20:23]
    v_and_b32 v24, v35, v13
    v_and_b32 v25, v35, v14
    v_and_b32 v26, v35, v15
    v_and_b32 v27, v35, v16
    s_nop 1
    v_mfma_f32_16x16x32_bf16 v[20:23], v[56:59], v[24:27], v[20:23]
    s_or_b32 s62, 48, 0
    s_bitcmp1_b32 s97, 16
    s_getpc_b64 s[92:93]
    s_cbranch_scc1 PATCH_V
SD_193:
XR_191:
    s_waitcnt vmcnt(12)
    ds_read_b128 v[48:51], v9 offset:0
    ds_read_b128 v[52:55], v10 offset:0
    ds_read_b128 v[56:59], v11 offset:0
    ds_read_b128 v[60:63], v12 offset:0
    s_waitcnt lgkmcnt(3)
    v_mfma_f32_16x16x32_bf16 v[24:27], v[48:51], v[64:67], 0
    s_waitcnt lgkmcnt(2)
    v_mfma_f32_16x16x32_bf16 v[24:27], v[52:55], v[68:71], v[24:27]
    s_waitcnt lgkmcnt(1)
    v_mfma_f32_16x16x32_bf16 v[24:27], v[56:59], v[72:75], v[24:27]
    s_waitcnt lgkmcnt(0)
    v_mfma_f32_16x16x32_bf16 v[24:27], v[60:63], v[76:79], v[24:27]
    s_nop 7
    v_fma_f32 v28, v24, s55, v17
    v_fma_f32 v29, v25, s55, v17
    v_fma_f32 v30, v26, s55, v17
    v_fma_f32 v31, v27, s55, v17
    v_max3_f32 v36, v28, v29, v30
    v_max_f32 v36, v36, v31
    v_cmp_lt_f32 vcc, s56, v36
    s_cbranch_vccnz RS_196
RB_197:
    v_exp_f32 v28, v28
    v_exp_f32 v29, v29
    v_exp_f32 v30, v30
    v_exp_f32 v31, v31
    v_cvt_pk_bf16_f32 v32, v28, v28
    v_add_f32 v18, v18, v28
    v_cvt_pk_bf16_f32 v33, v29, v29
    v_add_f32 v19, v19, v29
    v_cvt_pk_bf16_f32 v34, v30, v30
    v_add_f32 v18, v18, v30
    v_cvt_pk_bf16_f32 v35, v31, v31
    v_add_f32 v19, v19, v31
    s_waitcnt vmcnt(8)
    v_and_b32 v48, v32, v13
    v_and_b32 v49, v32, v14
    v_and_b32 v50, v32, v15
    v_and_b32 v51, v32, v16
    v_and_b32 v52, v33, v13
    v_and_b32 v53, v33, v14
    v_and_b32 v54, v33, v15
    v_and_b32 v55, v33, v16
    v_mfma_f32_16x16x32_bf16 v[20:23], a[0:3], v[48:51], v[20:23]
    v_and_b32 v56, v34, v13
    v_and_b32 v57, v34, v14
    v_and_b32 v58, v34, v15
    v_and_b32 v59, v34, v16
    v_mfma_f32_16x16x32_bf16 v[20:23], a[4:7], v[52:55], v[20:23]
    v_and_b32 v60, v35, v13
    v_and_b32 v61, v35, v14
    v_and_b32 v62, v35, v15
    v_and_b32 v63, v35, v16
    v_mfma_f32_16x16x32_bf16 v[20:23], a[8:11], v[56:59], v[20:23]
    s_nop 0
    v_mfma_f32_16x16x32_bf16 v[20:23], a[12:15], v[60:63], v[20:23]
    s_cmp_eq_u32 s83, 0
    s_cbranch_scc0 ML_198
    s_add_u32 s76, s90, 544
    s_mul_i32 s54, s76, s85
    s_add_u32 s54, s54, s53
    s_add_u32 m0, s59, 0
    s_nop 0
    buffer_load_dwordx4 v4, s[4:7], s54 offen offset:0 sc1 lds
    buffer_load_dwordx4 v5, s[4:7], s54 offen offset:1024 sc1 lds
    buffer_load_dwordx4 v6, s[4:7], s54 offen offset:2048 sc1 lds
    buffer_load_dwordx4 v7, s[4:7], s54 offen offset:3072 sc1 lds
    buffer_load_dwordx4 a[0:3], v8, s[8:11], s54 offen offset:0 sc1
    buffer_load_dwordx4 a[4:7], v8, s[8:11], s54 offen offset:256 sc1
    buffer_load_dwordx4 a[8:11], v8, s[8:11], s54 offen offset:512 sc1
    buffer_load_dwordx4 a[12:15], v8, s[8:11], s54 offen offset:768 sc1
    s_branch MJ_199
ML_198:
    s_add_u32 s76, s90, 544
    s_mul_i32 s54, s76, s85
    s_add_u32 s54, s54, s53
    s_add_u32 m0, s59, 0
    s_nop 0
    buffer_load_dwordx4 v4, s[4:7], s54 offen offset:0 nt lds
    buffer_load_dwordx4 v5, s[4:7], s54 offen offset:1024 nt lds
    buffer_load_dwordx4 v6, s[4:7], s54 offen offset:2048 nt lds
    buffer_load_dwordx4 v7, s[4:7], s54 offen offset:3072 nt lds
    buffer_load_dwordx4 a[0:3], v8, s[8:11], s54 offen offset:0 nt
    buffer_load_dwordx4 a[4:7], v8, s[8:11], s54 offen offset:256 nt
    buffer_load_dwordx4 a[8:11], v8, s[8:11], s54 offen offset:512 nt
    buffer_load_dwordx4 a[12:15], v8, s[8:11], s54 offen offset:768 nt
MJ_199:
    s_cmp_lt_u32 s81, 2
    s_cbranch_scc1 XR_200
    s_bitcmp1_b32 s99, 17
    s_cbranch_scc1 SL_201
    v_accvgpr_read_b32 v48, a160
    v_accvgpr_read_b32 v49, a161
    v_accvgpr_read_b32 v50, a162
    v_accvgpr_read_b32 v51, a163
    v_lshrrev_b32 v36, 11, v48
    v_and_b32 v60, 0x000f000f, v36
    v_and_b32 v48, 0x87ff87ff, v48
    v_lshrrev_b32 v37, 11, v49
    v_and_b32 v61, 0x000f000f, v37
    v_and_b32 v49, 0x87ff87ff, v49
    v_lshrrev_b32 v36, 11, v50
    v_and_b32 v62, 0x000f000f, v36
    v_and_b32 v50, 0x87ff87ff, v50
    v_lshrrev_b32 v37, 11, v51
    v_and_b32 v63, 0x000f000f, v37
    v_and_b32 v51, 0x87ff87ff, v51
    s_nop 1
    v_mfma_f32_16x16x32_bf16 v[24:27], v[48:51], v[64:67], 0
    v_accvgpr_read_b32 v52, a164
    v_accvgpr_read_b32 v53, a165
    v_accvgpr_read_b32 v54, a166
    v_accvgpr_read_b32 v55, a167
    v_lshrrev_b32 v36, 7, v52
    v_and_or_b32 v60, v36, s100, v60
    v_and_b32 v52, 0x87ff87ff, v52
    v_lshrrev_b32 v37, 7, v53
    v_and_or_b32 v61, v37, s100, v61
    v_and_b32 v53, 0x87ff87ff, v53
    v_lshrrev_b32 v36, 7, v54
    v_and_or_b32 v62, v36, s100, v62
    v_and_b32 v54, 0x87ff87ff, v54
    v_lshrrev_b32 v37, 7, v55
    v_and_or_b32 v63, v37, s100, v63
    v_and_b32 v55, 0x87ff87ff, v55
    s_nop 1
    v_mfma_f32_16x16x32_bf16 v[24:27], v[52:55], v[68:71], v[24:27]
    v_accvgpr_read_b32 v56, a168
    v_accvgpr_read_b32 v57, a169
    v_accvgpr_read_b32 v58, a170
    v_accvgpr_read_b32 v59, a171
    v_lshrrev_b32 v36, 3, v56
    v_and_or_b32 v60, v36, s101, v60
    v_lshlrev_b32 v37, 1, v56
    v_and_or_b32 v60, v37, s80, v60
    v_and_b32 v56, 0x87ff87ff, v56
    v_lshrrev_b32 v37, 3, v57
    v_and_or_b32 v61, v37, s101, v61
    v_lshlrev_b32 v36, 1, v57
    v_and_or_b32 v61, v36, s80, v61
    v_and_b32 v57, 0x87ff87ff, v57
    v_lshrrev_b32 v36, 3, v58
    v_and_or_b32 v62, v36, s101, v62
    v_lshlrev_b32 v37, 1, v58
    v_and_or_b32 v62, v37, s80, v62
    v_and_b32 v58, 0x87ff87ff, v58
    v_lshrrev_b32 v37, 3, v59
    v_and_or_b32 v63, v37, s101, v63
    v_lshlrev_b32 v36, 1, v59
    v_and_or_b32 v63, v36, s80, v63
    v_and_b32 v59, 0x87ff87ff, v59
    s_nop 1
    v_mfma_f32_16x16x32_bf16 v[24:27], v[56:59], v[72:75], v[24:27]
    v_mfma_f32_16x16x32_bf16 v[24:27], v[60:63], v[76:79], v[24:27]
    s_or_b32 s62, 17, 0
    s_bitcmp1_b32 s96, 17
    s_getpc_b64 s[92:93]
    s_cbranch_scc1 PATCH_K
    v_accvgpr_read_b32 v48, a196
    v_accvgpr_read_b32 v49, a197
    v_accvgpr_read_b32 v50, a198
    v_accvgpr_read_b32 v51, a199
    v_lshrrev_b32 v36, 11, v48
    v_and_b32 v56, 0x000f000f, v36
    v_and_b32 v48, 0x87ff87ff, v48
    v_lshrrev_b32 v37, 11, v49
    v_and_b32 v57, 0x000f000f, v37
    v_and_b32 v49, 0x87ff87ff, v49
    v_lshrrev_b32 v36, 11, v50
    v_and_b32 v58, 0x000f000f, v36
    v_and_b32 v50, 0x87ff87ff, v50
    v_lshrrev_b32 v37, 11, v51
    v_and_b32 v59, 0x000f000f, v37
    v_and_b32 v51, 0x87ff87ff, v51
    v_fmamk_f32 v28, v24, 0x568293ee, v17
    v_fmamk_f32 v29, v25, 0x568293ee, v17
    v_fmamk_f32 v30, v26, 0x568293ee, v17
    v_fmamk_f32 v31, v27, 0x568293ee, v17
    v_max3_f32 v36, v28, v29, v30
    v_max_f32 v36, v36, v31
    v_cmp_lt_f32 vcc, s56, v36
    s_cbranch_vccnz RS_203
RB_204:
    v_exp_f32 v28, v28
    v_exp_f32 v29, v29
    v_exp_f32 v30, v30
    v_exp_f32 v31, v31
    v_accvgpr_read_b32 v52, a200
    v_accvgpr_read_b32 v53, a201
    v_accvgpr_read_b32 v54, a202
    v_accvgpr_read_b32 v55, a203
    v_lshrrev_b32 v36, 7, v52
    v_and_or_b32 v56, v36, s100, v56
    v_and_b32 v52, 0x87ff87ff, v52
    v_lshrrev_b32 v37, 7, v53
    v_and_or_b32 v57, v37, s100, v57
    v_and_b32 v53, 0x87ff87ff, v53
    v_lshrrev_b32 v36, 7, v54
    v_and_or_b32 v58, v36, s100, v58
    v_and_b32 v54, 0x87ff87ff, v54
    v_lshrrev_b32 v37, 7, v55
    v_and_or_b32 v59, v37, s100, v59
    v_and_b32 v55, 0x87ff87ff, v55
    v_add_f32 v18, v18, v28
    v_mul_f32 v28, 0x78800000, v28
    v_add_f32 v19, v19, v29
    v_mul_f32 v29, 0x78800000, v29
    v_add_f32 v18, v18, v30
    v_mul_f32 v30, 0x78800000, v30
    v_add_f32 v19, v19, v31
    v_mul_f32 v31, 0x78800000, v31
    v_cvt_pk_bf16_f32 v32, v28, v28
    v_cvt_pk_bf16_f32 v33, v29, v29
    v_cvt_pk_bf16_f32 v34, v30, v30
    v_cvt_pk_bf16_f32 v35, v31, v31
    v_and_b32 v60, v32, v13
    v_and_b32 v61, v32, v14
    v_and_b32 v62, v32, v15
    v_and_b32 v63, v32, v16
    s_nop 1
    v_mfma_f32_16x16x32_bf16 v[20:23], v[48:51], v[60:63], v[20:23]
    v_and_b32 v24, v33, v13
    v_and_b32 v25, v33, v14
    v_and_b32 v26, v33, v15
    v_and_b32 v27, v33, v16
    s_nop 1
    v_mfma_f32_16x16x32_bf16 v[20:23], v[52:55], v[24:27], v[20:23]
    v_accvgpr_read_b32 v48, a204
    v_accvgpr_read_b32 v49, a205
    v_accvgpr_read_b32 v50, a206
    v_accvgpr_read_b32 v51, a207
    v_lshrrev_b32 v36, 3, v48
    v_and_or_b32 v56, v36, s101, v56
    v_lshlrev_b32 v37, 1, v48
    v_and_or_b32 v56, v37, s80, v56
    v_and_b32 v48, 0x87ff87ff, v48
    v_lshrrev_b32 v37, 3, v49
    v_and_or_b32 v57, v37, s101, v57
    v_lshlrev_b32 v36, 1, v49
    v_and_or_b32 v57, v36, s80, v57
    v_and_b32 v49, 0x87ff87ff, v49
    v_lshrrev_b32 v36, 3, v50
    v_and_or_b32 v58, v36, s101, v58
    v_lshlrev_b32 v37, 1, v50
    v_and_or_b32 v58, v37, s80, v58
    v_and_b32 v50, 0x87ff87ff, v50
    v_lshrrev_b32 v37, 3, v51
    v_and_or_b32 v59, v37, s101, v59
    v_lshlrev_b32 v36, 1, v51
    v_and_or_b32 v59, v36, s80, v59
    v_and_b32 v51, 0x87ff87ff, v51
    v_and_b32 v60, v34, v13
    v_and_b32 v61, v34, v14
    v_and_b32 v62, v34, v15
    v_and_b32 v63, v34, v16
    s_nop 1
    v_mfma_f32_16x16x32_bf16 v[20:23], v[48:51], v[60:63], v[20:23]
    v_and_b32 v24, v35, v13
    v_and_b32 v25, v35, v14
    v_and_b32 v26, v35, v15
    v_and_b32 v27, v35, v16
    s_nop 1
    v_mfma_f32_16x16x32_bf16 v[20:23], v[56:59], v[24:27], v[20:23]
    s_or_b32 s62, 49, 0
    s_bitcmp1_b32 s97, 17
    s_getpc_b64 s[92:93]
    s_cbranch_scc1 PATCH_V
SD_202:
XR_200:
    s_waitcnt vmcnt(12)
    ds_read_b128 v[48:51], v9 offset:4096
    ds_read_b128 v[52:55], v10 offset:4096
    ds_read_b128 v[56:59], v11 offset:4096
    ds_read_b128 v[60:63], v12 offset:4096
    s_waitcnt lgkmcnt(3)
    v_mfma_f32_16x16x32_bf16 v[24:27], v[48:51], v[64:67], 0
    s_waitcnt lgkmcnt(2)
    v_mfma_f32_16x16x32_bf16 v[24:27], v[52:55], v[68:71], v[24:27]
    s_waitcnt lgkmcnt(1)
    v_mfma_f32_16x16x32_bf16 v[24:27], v[56:59], v[72:75], v[24:27]
    s_waitcnt lgkmcnt(0)
    v_mfma_f32_16x16x32_bf16 v[24:27], v[60:63], v[76:79], v[24:27]
    s_nop 7
    v_fma_f32 v28, v24, s55, v17
    v_fma_f32 v29, v25, s55, v17
    v_fma_f32 v30, v26, s55, v17
    v_fma_f32 v31, v27, s55, v17
    v_max3_f32 v36, v28, v29, v30
    v_max_f32 v36, v36, v31
    v_cmp_lt_f32 vcc, s56, v36
    s_cbranch_vccnz RS_205
RB_206:
    v_exp_f32 v28, v28
    v_exp_f32 v29, v29
    v_exp_f32 v30, v30
    v_exp_f32 v31, v31
    v_cvt_pk_bf16_f32 v32, v28, v28
    v_add_f32 v18, v18, v28
    v_cvt_pk_bf16_f32 v33, v29, v29
    v_add_f32 v19, v19, v29
    v_cvt_pk_bf16_f32 v34, v30, v30
    v_add_f32 v18, v18, v30
    v_cvt_pk_bf16_f32 v35, v31, v31
    v_add_f32 v19, v19, v31
    s_waitcnt vmcnt(8)
    v_and_b32 v48, v32, v13
    v_and_b32 v49, v32, v14
    v_and_b32 v50, v32, v15
    v_and_b32 v51, v32, v16
    v_and_b32 v52, v33, v13
    v_and_b32 v53, v33, v14
    v_and_b32 v54, v33, v15
    v_and_b32 v55, v33, v16
    v_mfma_f32_16x16x32_bf16 v[20:23], a[16:19], v[48:51], v[20:23]
    v_and_b32 v56, v34, v13
    v_and_b32 v57, v34, v14
    v_and_b32 v58, v34, v15
    v_and_b32 v59, v34, v16
    v_mfma_f32_16x16x32_bf16 v[20:23], a[20:23], v[52:55], v[20:23]
    v_and_b32 v60, v35, v13
    v_and_b32 v61, v35, v14
    v_and_b32 v62, v35, v15
    v_and_b32 v63, v35, v16
    v_mfma_f32_16x16x32_bf16 v[20:23], a[24:27], v[56:59], v[20:23]
    s_nop 0
    v_mfma_f32_16x16x32_bf16 v[20:23], a[28:31], v[60:63], v[20:23]
    s_cmp_eq_u32 s83, 0
    s_cbranch_scc0 ML_207
    s_add_u32 s77, s90, 32
    s_mul_i32 s54, s77, s85
    s_add_u32 s54, s54, s53
    s_add_u32 m0, s59, 4096
    s_nop 0
    buffer_load_dwordx4 v4, s[4:7], s54 offen offset:0 lds
    buffer_load_dwordx4 v5, s[4:7], s54 offen offset:1024 lds
    buffer_load_dwordx4 v6, s[4:7], s54 offen offset:2048 lds
    buffer_load_dwordx4 v7, s[4:7], s54 offen offset:3072 lds
    buffer_load_dwordx4 a[16:19], v8, s[8:11], s54 offen offset:0
    buffer_load_dwordx4 a[20:23], v8, s[8:11], s54 offen offset:256
    buffer_load_dwordx4 a[24:27], v8, s[8:11], s54 offen offset:512
    buffer_load_dwordx4 a[28:31], v8, s[8:11], s54 offen offset:768
    s_branch MJ_208
ML_207:
    s_add_u32 s77, s90, 560
    s_mul_i32 s54, s77, s85
    s_add_u32 s54, s54, s53
    s_add_u32 m0, s59, 4096
    s_nop 0
    buffer_load_dwordx4 v4, s[4:7], s54 offen offset:0 nt lds
    buffer_load_dwordx4 v5, s[4:7], s54 offen offset:1024 nt lds
    buffer_load_dwordx4 v6, s[4:7], s54 offen offset:2048 nt lds
    buffer_load_dwordx4 v7, s[4:7], s54 offen offset:3072 nt lds
    buffer_load_dwordx4 a[16:19], v8, s[8:11], s54 offen offset:0 nt
    buffer_load_dwordx4 a[20:23], v8, s[8:11], s54 offen offset:256 nt
    buffer_load_dwordx4 a[24:27], v8, s[8:11], s54 offen offset:512 nt
    buffer_load_dwordx4 a[28:31], v8, s[8:11], s54 offen offset:768 nt
MJ_208:
    buffer_load_dword v39, off, s[36:39], 0 offset:64 sc1
    s_cmp_lt_u32 s81, 2
    s_cbranch_scc1 XR_209
    s_bitcmp1_b32 s99, 18
    s_cbranch_scc1 SL_210
    v_lshlrev_b32 v36, 4, v0
    v_add_u32 v36, s59, v36
    ds_read_b128 v[48:51], v36 offset:30208
    ds_read_b128 v[52:55], v36 offset:31232
    ds_read_b128 v[56:59], v36 offset:32256
    s_waitcnt lgkmcnt(2)
    v_lshrrev_b32 v36, 11, v48
    v_and_b32 v60, 0x000f000f, v36
    v_and_b32 v48, 0x87ff87ff, v48
    v_lshrrev_b32 v37, 11, v49
    v_and_b32 v61, 0x000f000f, v37
    v_and_b32 v49, 0x87ff87ff, v49
    v_lshrrev_b32 v36, 11, v50
    v_and_b32 v62, 0x000f000f, v36
    v_and_b32 v50, 0x87ff87ff, v50
    v_lshrrev_b32 v37, 11, v51
    v_and_b32 v63, 0x000f000f, v37
    v_and_b32 v51, 0x87ff87ff, v51
    s_nop 1
    v_mfma_f32_16x16x32_bf16 v[24:27], v[48:51], v[64:67], 0
    s_waitcnt lgkmcnt(1)
    v_lshrrev_b32 v36, 7, v52
    v_and_or_b32 v60, v36, s100, v60
    v_and_b32 v52, 0x87ff87ff, v52
    v_lshrrev_b32 v37, 7, v53
    v_and_or_b32 v61, v37, s100, v61
    v_and_b32 v53, 0x87ff87ff, v53
    v_lshrrev_b32 v36, 7, v54
    v_and_or_b32 v62, v36, s100, v62
    v_and_b32 v54, 0x87ff87ff, v54
    v_lshrrev_b32 v37, 7, v55
    v_and_or_b32 v63, v37, s100, v63
    v_and_b32 v55, 0x87ff87ff, v55
    s_nop 1
    v_mfma_f32_16x16x32_bf16 v[24:27], v[52:55], v[68:71], v[24:27]
    s_waitcnt lgkmcnt(0)
    v_lshrrev_b32 v36, 3, v56
    v_and_or_b32 v60, v36, s101, v60
    v_lshlrev_b32 v37, 1, v56
    v_and_or_b32 v60, v37, s80, v60
    v_and_b32 v56, 0x87ff87ff, v56
    v_lshrrev_b32 v37, 3, v57
    v_and_or_b32 v61, v37, s101, v61
    v_lshlrev_b32 v36, 1, v57
    v_and_or_b32 v61, v36, s80, v61
    v_and_b32 v57, 0x87ff87ff, v57
    v_lshrrev_b32 v36, 3, v58
    v_and_or_b32 v62, v36, s101, v62
    v_lshlrev_b32 v37, 1, v58
    v_and_or_b32 v62, v37, s80, v62
    v_and_b32 v58, 0x87ff87ff, v58
    v_lshrrev_b32 v37, 3, v59
    v_and_or_b32 v63, v37, s101, v63
    v_lshlrev_b32 v36, 1, v59
    v_and_or_b32 v63, v36, s80, v63
    v_and_b32 v59, 0x87ff87ff, v59
    s_nop 1
    v_mfma_f32_16x16x32_bf16 v[24:27], v[56:59], v[72:75], v[24:27]
    v_mfma_f32_16x16x32_bf16 v[24:27], v[60:63], v[76:79], v[24:27]
    s_or_b32 s62, 18, 0
    s_bitcmp1_b32 s96, 18
    s_getpc_b64 s[92:93]
    s_cbranch_scc1 PATCH_K
    v_accvgpr_read_b32 v48, a208
    v_accvgpr_read_b32 v49, a209
    v_accvgpr_read_b32 v50, a210
    v_accvgpr_read_b32 v51, a211
    v_lshrrev_b32 v36, 11, v48
    v_and_b32 v56, 0x000f000f, v36
    v_and_b32 v48, 0x87ff87ff, v48
    v_lshrrev_b32 v37, 11, v49
    v_and_b32 v57, 0x000f000f, v37
    v_and_b32 v49, 0x87ff87ff, v49
    v_lshrrev_b32 v36, 11, v50
    v_and_b32 v58, 0x000f000f, v36
    v_and_b32 v50, 0x87ff87ff, v50
    v_lshrrev_b32 v37, 11, v51
    v_and_b32 v59, 0x000f000f, v37
    v_and_b32 v51, 0x87ff87ff, v51
    v_fmamk_f32 v28, v24, 0x568293ee, v17
    v_fmamk_f32 v29, v25, 0x568293ee, v17
    v_fmamk_f32 v30, v26, 0x568293ee, v17
    v_fmamk_f32 v31, v27, 0x568293ee, v17
    v_max3_f32 v36, v28, v29, v30
    v_max_f32 v36, v36, v31
    v_cmp_lt_f32 vcc, s56, v36
    s_cbranch_vccnz RS_212
RB_213:
    v_exp_f32 v28, v28
    v_exp_f32 v29, v29
    v_exp_f32 v30, v30
    v_exp_f32 v31, v31
    v_accvgpr_read_b32 v52, a212
    v_accvgpr_read_b32 v53, a213
    v_accvgpr_read_b32 v54, a214
    v_accvgpr_read_b32 v55, a215
    v_lshrrev_b32 v36, 7, v52
    v_and_or_b32 v56, v36, s100, v56
    v_and_b32 v52, 0x87ff87ff, v52
    v_lshrrev_b32 v37, 7, v53
    v_and_or_b32 v57, v37, s100, v57
    v_and_b32 v53, 0x87ff87ff, v53
    v_lshrrev_b32 v36, 7, v54
    v_and_or_b32 v58, v36, s100, v58
    v_and_b32 v54, 0x87ff87ff, v54
    v_lshrrev_b32 v37, 7, v55
    v_and_or_b32 v59, v37, s100, v59
    v_and_b32 v55, 0x87ff87ff, v55
    v_add_f32 v18, v18, v28
    v_mul_f32 v28, 0x78800000, v28
    v_add_f32 v19, v19, v29
    v_mul_f32 v29, 0x78800000, v29
    v_add_f32 v18, v18, v30
    v_mul_f32 v30, 0x78800000, v30
    v_add_f32 v19, v19, v31
    v_mul_f32 v31, 0x78800000, v31
    v_cvt_pk_bf16_f32 v32, v28, v28
    v_cvt_pk_bf16_f32 v33, v29, v29
    v_cvt_pk_bf16_f32 v34, v30, v30
    v_cvt_pk_bf16_f32 v35, v31, v31
    v_and_b32 v60, v32, v13
    v_and_b32 v61, v32, v14
    v_and_b32 v62, v32, v15
    v_and_b32 v63, v32, v16
    s_nop 1
    v_mfma_f32_16x16x32_bf16 v[20:23], v[48:51], v[60:63], v[20:23]
    v_and_b32 v24, v33, v13
    v_and_b32 v25, v33, v14
    v_and_b32 v26, v33, v15
    v_and_b32 v27, v33, v16
    s_nop 1
    v_mfma_f32_16x16x32_bf16 v[20:23], v[52:55], v[24:27], v[20:23]
    v_accvgpr_read_b32 v48, a216
    v_accvgpr_read_b32 v49, a217
    v_accvgpr_read_b32 v50, a218
    v_accvgpr_read_b32 v51, a219
    v_lshrrev_b32 v36, 3, v48
    v_and_or_b32 v56, v36, s101, v56
    v_lshlrev_b32 v37, 1, v48
    v_and_or_b32 v56, v37, s80, v56
    v_and_b32 v48, 0x87ff87ff, v48
    v_lshrrev_b32 v37, 3, v49
    v_and_or_b32 v57, v37, s101, v57
    v_lshlrev_b32 v36, 1, v49
    v_and_or_b32 v57, v36, s80, v57
    v_and_b32 v49, 0x87ff87ff, v49
    v_lshrrev_b32 v36, 3, v50
    v_and_or_b32 v58, v36, s101, v58
    v_lshlrev_b32 v37, 1, v50
    v_and_or_b32 v58, v37, s80, v58
    v_and_b32 v50, 0x87ff87ff, v50
    v_lshrrev_b32 v37, 3, v51
    v_and_or_b32 v59, v37, s101, v59
    v_lshlrev_b32 v36, 1, v51
    v_and_or_b32 v59, v36, s80, v59
    v_and_b32 v51, 0x87ff87ff, v51
    v_and_b32 v60, v34, v13
    v_and_b32 v61, v34, v14
    v_and_b32 v62, v34, v15
    v_and_b32 v63, v34, v16
    s_nop 1
    v_mfma_f32_16x16x32_bf16 v[20:23], v[48:51], v[60:63], v[20:23]
    v_and_b32 v24, v35, v13
    v_and_b32 v25, v35, v14
    v_and_b32 v26, v35, v15
    v_and_b32 v27, v35, v16
    s_nop 1
    v_mfma_f32_16x16x32_bf16 v[20:23], v[56:59], v[24:27], v[20:23]
    s_or_b32 s62, 50, 0
    s_bitcmp1_b32 s97, 18
    s_getpc_b64 s[92:93]
    s_cbranch_scc1 PATCH_V
SD_211:
XR_209:
    s_waitcnt vmcnt(13)
    ds_read_b128 v[48:51], v9 offset:0
    ds_read_b128 v[52:55], v10 offset:0
    ds_read_b128 v[56:59], v11 offset:0
    ds_read_b128 v[60:63], v12 offset:0
    s_waitcnt lgkmcnt(3)
    v_mfma_f32_16x16x32_bf16 v[24:27], v[48:51], v[64:67], 0
    s_waitcnt lgkmcnt(2)
    v_mfma_f32_16x16x32_bf16 v[24:27], v[52:55], v[68:71], v[24:27]
    s_waitcnt lgkmcnt(1)
    v_mfma_f32_16x16x32_bf16 v[24:27], v[56:59], v[72:75], v[24:27]
    s_waitcnt lgkmcnt(0)
    v_mfma_f32_16x16x32_bf16 v[24:27], v[60:63], v[76:79], v[24:27]
    s_nop 7
    v_fma_f32 v28, v24, s55, v17
    v_fma_f32 v29, v25, s55, v17
    v_fma_f32 v30, v26, s55, v17
    v_fma_f32 v31, v27, s55, v17
    v_max3_f32 v36, v28, v29, v30
    v_max_f32 v36, v36, v31
    v_cmp_lt_f32 vcc, s56, v36
    s_cbranch_vccnz RS_214
RB_215:
    v_exp_f32 v28, v28
    v_exp_f32 v29, v29
    v_exp_f32 v30, v30
    v_exp_f32 v31, v31
    v_cvt_pk_bf16_f32 v32, v28, v28
    v_add_f32 v18, v18, v28
    v_cvt_pk_bf16_f32 v33, v29, v29
    v_add_f32 v19, v19, v29
    v_cvt_pk_bf16_f32 v34, v30, v30
    v_add_f32 v18, v18, v30
    v_cvt_pk_bf16_f32 v35, v31, v31
    v_add_f32 v19, v19, v31
    s_waitcnt vmcnt(9)
    v_and_b32 v48, v32, v13
    v_and_b32 v49, v32, v14
    v_and_b32 v50, v32, v15
    v_and_b32 v51, v32, v16
    v_and_b32 v52, v33, v13
    v_and_b32 v53, v33, v14
    v_and_b32 v54, v33, v15
    v_and_b32 v55, v33, v16
    v_mfma_f32_16x16x32_bf16 v[20:23], a[0:3], v[48:51], v[20:23]
    v_and_b32 v56, v34, v13
    v_and_b32 v57, v34, v14
    v_and_b32 v58, v34, v15
    v_and_b32 v59, v34, v16
    v_mfma_f32_16x16x32_bf16 v[20:23], a[4:7], v[52:55], v[20:23]
    v_and_b32 v60, v35, v13
    v_and_b32 v61, v35, v14
    v_and_b32 v62, v35, v15
    v_and_b32 v63, v35, v16
    v_mfma_f32_16x16x32_bf16 v[20:23], a[8:11], v[56:59], v[20:23]
    s_nop 0
    v_mfma_f32_16x16x32_bf16 v[20:23], a[12:15], v[60:63], v[20:23]
    s_cmp_eq_u32 s83, 0
    s_cbranch_scc0 ML_216
    s_add_u32 s76, s90, 48
    s_mul_i32 s54, s76, s85
    s_add_u32 s54, s54, s53
    s_add_u32 m0, s59, 0
    s_nop 0
    buffer_load_dwordx4 v4, s[4:7], s54 offen offset:0 lds
    buffer_load_dwordx4 v5, s[4:7], s54 offen offset:1024 lds
    buffer_load_dwordx4 v6, s[4:7], s54 offen offset:2048 lds
    buffer_load_dwordx4 v7, s[4:7], s54 offen offset:3072 lds
    buffer_load_dwordx4 a[0:3], v8, s[8:11], s54 offen offset:0
    buffer_load_dwordx4 a[4:7], v8, s[8:11], s54 offen offset:256
    buffer_load_dwordx4 a[8:11], v8, s[8:11], s54 offen offset:512
    buffer_load_dwordx4 a[12:15], v8, s[8:11], s54 offen offset:768
    s_branch MJ_217
ML_216:
    s_add_u32 s76, s90, 576
    s_mul_i32 s54, s76, s85
    s_add_u32 s54, s54, s53
    s_add_u32 m0, s59, 0
    s_nop 0
    buffer_load_dwordx4 v4, s[4:7], s54 offen offset:0 nt lds
    buffer_load_dwordx4 v5, s[4:7], s54 offen offset:1024 nt lds
    buffer_load_dwordx4 v6, s[4:7], s54 offen offset:2048 nt lds
    buffer_load_dwordx4 v7, s[4:7], s54 offen offset:3072 nt lds
    buffer_load_dwordx4 a[0:3], v8, s[8:11], s54 offen offset:0 nt
    buffer_load_dwordx4 a[4:7], v8, s[8:11], s54 offen offset:256 nt
    buffer_load_dwordx4 a[8:11], v8, s[8:11], s54 offen offset:512 nt
    buffer_load_dwordx4 a[12:15], v8, s[8:11], s54 offen offset:768 nt
MJ_217:
    s_cmp_lt_u32 s81, 2
    s_cbranch_scc1 XR_218
    s_bitcmp1_b32 s99, 19
    s_cbranch_scc1 SL_219
    v_lshlrev_b32 v36, 4, v0
    v_add_u32 v36, s59, v36
    ds_read_b128 v[48:51], v36 offset:33280
    ds_read_b128 v[52:55], v36 offset:34304
    ds_read_b128 v[56:59], v36 offset:35328
    s_waitcnt lgkmcnt(2)
    v_lshrrev_b32 v36, 11, v48
    v_and_b32 v60, 0x000f000f, v36
    v_and_b32 v48, 0x87ff87ff, v48
    v_lshrrev_b32 v37, 11, v49
    v_and_b32 v61, 0x000f000f, v37
    v_and_b32 v49, 0x87ff87ff, v49
    v_lshrrev_b32 v36, 11, v50
    v_and_b32 v62, 0x000f000f, v36
    v_and_b32 v50, 0x87ff87ff, v50
    v_lshrrev_b32 v37, 11, v51
    v_and_b32 v63, 0x000f000f, v37
    v_and_b32 v51, 0x87ff87ff, v51
    s_nop 1
    v_mfma_f32_16x16x32_bf16 v[24:27], v[48:51], v[64:67], 0
    s_waitcnt lgkmcnt(1)
    v_lshrrev_b32 v36, 7, v52
    v_and_or_b32 v60, v36, s100, v60
    v_and_b32 v52, 0x87ff87ff, v52
    v_lshrrev_b32 v37, 7, v53
    v_and_or_b32 v61, v37, s100, v61
    v_and_b32 v53, 0x87ff87ff, v53
    v_lshrrev_b32 v36, 7, v54
    v_and_or_b32 v62, v36, s100, v62
    v_and_b32 v54, 0x87ff87ff, v54
    v_lshrrev_b32 v37, 7, v55
    v_and_or_b32 v63, v37, s100, v63
    v_and_b32 v55, 0x87ff87ff, v55
    s_nop 1
    v_mfma_f32_16x16x32_bf16 v[24:27], v[52:55], v[68:71], v[24:27]
    s_waitcnt lgkmcnt(0)
    v_lshrrev_b32 v36, 3, v56
    v_and_or_b32 v60, v36, s101, v60
    v_lshlrev_b32 v37, 1, v56
    v_and_or_b32 v60, v37, s80, v60
    v_and_b32 v56, 0x87ff87ff, v56
    v_lshrrev_b32 v37, 3, v57
    v_and_or_b32 v61, v37, s101, v61
    v_lshlrev_b32 v36, 1, v57
    v_and_or_b32 v61, v36, s80, v61
    v_and_b32 v57, 0x87ff87ff, v57
    v_lshrrev_b32 v36, 3, v58
    v_and_or_b32 v62, v36, s101, v62
    v_lshlrev_b32 v37, 1, v58
    v_and_or_b32 v62, v37, s80, v62
    v_and_b32 v58, 0x87ff87ff, v58
    v_lshrrev_b32 v37, 3, v59
    v_and_or_b32 v63, v37, s101, v63
    v_lshlrev_b32 v36, 1, v59
    v_and_or_b32 v63, v36, s80, v63
    v_and_b32 v59, 0x87ff87ff, v59
    s_nop 1
    v_mfma_f32_16x16x32_bf16 v[24:27], v[56:59], v[72:75], v[24:27]
    v_mfma_f32_16x16x32_bf16 v[24:27], v[60:63], v[76:79], v[24:27]
    s_or_b32 s62, 19, 0
    s_bitcmp1_b32 s96, 19
    s_getpc_b64 s[92:93]
    s_cbranch_scc1 PATCH_K
    v_accvgpr_read_b32 v48, a220
    v_accvgpr_read_b32 v49, a221
    v_accvgpr_read_b32 v50, a222
    v_accvgpr_read_b32 v51, a223
    v_lshrrev_b32 v36, 11, v48
    v_and_b32 v56, 0x000f000f, v36
    v_and_b32 v48, 0x87ff87ff, v48
    v_lshrrev_b32 v37, 11, v49
    v_and_b32 v57, 0x000f000f, v37
    v_and_b32 v49, 0x87ff87ff, v49
    v_lshrrev_b32 v36, 11, v50
    v_and_b32 v58, 0x000f000f, v36
    v_and_b32 v50, 0x87ff87ff, v50
    v_lshrrev_b32 v37, 11, v51
    v_and_b32 v59, 0x000f000f, v37
    v_and_b32 v51, 0x87ff87ff, v51
    v_fmamk_f32 v28, v24, 0x568293ee, v17
    v_fmamk_f32 v29, v25, 0x568293ee, v17
    v_fmamk_f32 v30, v26, 0x568293ee, v17
    v_fmamk_f32 v31, v27, 0x568293ee, v17
    v_max3_f32 v36, v28, v29, v30
    v_max_f32 v36, v36, v31
    v_cmp_lt_f32 vcc, s56, v36
    s_cbranch_vccnz RS_221
RB_222:
    v_exp_f32 v28, v28
    v_exp_f32 v29, v29
    v_exp_f32 v30, v30
    v_exp_f32 v31, v31
    v_accvgpr_read_b32 v52, a224
    v_accvgpr_read_b32 v53, a225
    v_accvgpr_read_b32 v54, a226
    v_accvgpr_read_b32 v55, a227
    v_lshrrev_b32 v36, 7, v52
    v_and_or_b32 v56, v36, s100, v56
    v_and_b32 v52, 0x87ff87ff, v52
    v_lshrrev_b32 v37, 7, v53
    v_and_or_b32 v57, v37, s100, v57
    v_and_b32 v53, 0x87ff87ff, v53
    v_lshrrev_b32 v36, 7, v54
    v_and_or_b32 v58, v36, s100, v58
    v_and_b32 v54, 0x87ff87ff, v54
    v_lshrrev_b32 v37, 7, v55
    v_and_or_b32 v59, v37, s100, v59
    v_and_b32 v55, 0x87ff87ff, v55
    v_add_f32 v18, v18, v28
    v_mul_f32 v28, 0x78800000, v28
    v_add_f32 v19, v19, v29
    v_mul_f32 v29, 0x78800000, v29
    v_add_f32 v18, v18, v30
    v_mul_f32 v30, 0x78800000, v30
    v_add_f32 v19, v19, v31
    v_mul_f32 v31, 0x78800000, v31
    v_cvt_pk_bf16_f32 v32, v28, v28
    v_cvt_pk_bf16_f32 v33, v29, v29
    v_cvt_pk_bf16_f32 v34, v30, v30
    v_cvt_pk_bf16_f32 v35, v31, v31
    v_and_b32 v60, v32, v13
    v_and_b32 v61, v32, v14
    v_and_b32 v62, v32, v15
    v_and_b32 v63, v32, v16
    s_nop 1
    v_mfma_f32_16x16x32_bf16 v[20:23], v[48:51], v[60:63], v[20:23]
    v_and_b32 v24, v33, v13
    v_and_b32 v25, v33, v14
    v_and_b32 v26, v33, v15
    v_and_b32 v27, v33, v16
    s_nop 1
    v_mfma_f32_16x16x32_bf16 v[20:23], v[52:55], v[24:27], v[20:23]
    v_accvgpr_read_b32 v48, a228
    v_accvgpr_read_b32 v49, a229
    v_accvgpr_read_b32 v50, a230
    v_accvgpr_read_b32 v51, a231
    v_lshrrev_b32 v36, 3, v48
    v_and_or_b32 v56, v36, s101, v56
    v_lshlrev_b32 v37, 1, v48
    v_and_or_b32 v56, v37, s80, v56
    v_and_b32 v48, 0x87ff87ff, v48
    v_lshrrev_b32 v37, 3, v49
    v_and_or_b32 v57, v37, s101, v57
    v_lshlrev_b32 v36, 1, v49
    v_and_or_b32 v57, v36, s80, v57
    v_and_b32 v49, 0x87ff87ff, v49
    v_lshrrev_b32 v36, 3, v50
    v_and_or_b32 v58, v36, s101, v58
    v_lshlrev_b32 v37, 1, v50
    v_and_or_b32 v58, v37, s80, v58
    v_and_b32 v50, 0x87ff87ff, v50
    v_lshrrev_b32 v37, 3, v51
    v_and_or_b32 v59, v37, s101, v59
    v_lshlrev_b32 v36, 1, v51
    v_and_or_b32 v59, v36, s80, v59
    v_and_b32 v51, 0x87ff87ff, v51
    v_and_b32 v60, v34, v13
    v_and_b32 v61, v34, v14
    v_and_b32 v62, v34, v15
    v_and_b32 v63, v34, v16
    s_nop 1
    v_mfma_f32_16x16x32_bf16 v[20:23], v[48:51], v[60:63], v[20:23]
    v_and_b32 v24, v35, v13
    v_and_b32 v25, v35, v14
    v_and_b32 v26, v35, v15
    v_and_b32 v27, v35, v16
    s_nop 1
    v_mfma_f32_16x16x32_bf16 v[20:23], v[56:59], v[24:27], v[20:23]
    s_or_b32 s62, 51, 0
    s_bitcmp1_b32 s97, 19
    s_getpc_b64 s[92:93]
    s_cbranch_scc1 PATCH_V
SD_220:
XR_218:
    s_waitcnt vmcnt(13)
    ds_read_b128 v[48:51], v9 offset:4096
    ds_read_b128 v[52:55], v10 offset:4096
    ds_read_b128 v[56:59], v11 offset:4096
    ds_read_b128 v[60:63], v12 offset:4096
    s_waitcnt lgkmcnt(3)
    v_mfma_f32_16x16x32_bf16 v[24:27], v[48:51], v[64:67], 0
    s_waitcnt lgkmcnt(2)
    v_mfma_f32_16x16x32_bf16 v[24:27], v[52:55], v[68:71], v[24:27]
    s_waitcnt lgkmcnt(1)
    v_mfma_f32_16x16x32_bf16 v[24:27], v[56:59], v[72:75], v[24:27]
    s_waitcnt lgkmcnt(0)
    v_mfma_f32_16x16x32_bf16 v[24:27], v[60:63], v[76:79], v[24:27]
    s_nop 7
    v_fma_f32 v28, v24, s55, v17
    v_fma_f32 v29, v25, s55, v17
    v_fma_f32 v30, v26, s55, v17
    v_fma_f32 v31, v27, s55, v17
    v_max3_f32 v36, v28, v29, v30
    v_max_f32 v36, v36, v31
    v_cmp_lt_f32 vcc, s56, v36
    s_cbranch_vccnz RS_223
RB_224:
    v_exp_f32 v28, v28
    v_exp_f32 v29, v29
    v_exp_f32 v30, v30
    v_exp_f32 v31, v31
    v_cvt_pk_bf16_f32 v32, v28, v28
    v_add_f32 v18, v18, v28
    v_cvt_pk_bf16_f32 v33, v29, v29
    v_add_f32 v19, v19, v29
    v_cvt_pk_bf16_f32 v34, v30, v30
    v_add_f32 v18, v18, v30
    v_cvt_pk_bf16_f32 v35, v31, v31
    v_add_f32 v19, v19, v31
    s_waitcnt vmcnt(9)
    v_and_b32 v48, v32, v13
    v_and_b32 v49, v32, v14
    v_and_b32 v50, v32, v15
    v_and_b32 v51, v32, v16
    v_and_b32 v52, v33, v13
    v_and_b32 v53, v33, v14
    v_and_b32 v54, v33, v15
    v_and_b32 v55, v33, v16
    v_mfma_f32_16x16x32_bf16 v[20:23], a[16:19], v[48:51], v[20:23]
    v_and_b32 v56, v34, v13
    v_and_b32 v57, v34, v14
    v_and_b32 v58, v34, v15
    v_and_b32 v59, v34, v16
    v_mfma_f32_16x16x32_bf16 v[20:23], a[20:23], v[52:55], v[20:23]
    v_and_b32 v60, v35, v13
    v_and_b32 v61, v35, v14
    v_and_b32 v62, v35, v15
    v_and_b32 v63, v35, v16
    v_mfma_f32_16x16x32_bf16 v[20:23], a[24:27], v[56:59], v[20:23]
    s_nop 0
    v_mfma_f32_16x16x32_bf16 v[20:23], a[28:31], v[60:63], v[20:23]
    s_waitcnt vmcnt(8)
    s_mov_b32 s64, 200000
CL_225:
    v_readfirstlane_b32 s60, v39
    s_cmp_eq_u32 s60, 256
    s_cbranch_scc1 CD_226
    buffer_load_dword v39, off, s[36:39], 0 offset:64 sc1
    s_waitcnt vmcnt(0)
    s_sub_u32 s64, s64, 1
    s_cmp_lg_u32 s64, 0
    s_cbranch_scc1 CL_225
CD_226:
    s_lshl_b32 s60, s88, 2
    buffer_load_dword v1, off, s[36:39], s60 offset:96 sc1
    v_mov_b32 v39, 1
    buffer_atomic_add v39, v43, s[48:51], s65 offen sc0
    s_cmp_eq_u32 s83, 0
    s_cbranch_scc0 ML_227
    s_add_u32 s77, s90, 64
    s_mul_i32 s54, s77, s85
    s_add_u32 s54, s54, s53
    s_add_u32 m0, s59, 4096
    s_nop 0
    buffer_load_dwordx4 v4, s[4:7], s54 offen offset:0 lds
    buffer_load_dwordx4 v5, s[4:7], s54 offen offset:1024 lds
    buffer_load_dwordx4 v6, s[4:7], s54 offen offset:2048 lds
    buffer_load_dwordx4 v7, s[4:7], s54 offen offset:3072 lds
    buffer_load_dwordx4 a[16:19], v8, s[8:11], s54 offen offset:0
    buffer_load_dwordx4 a[20:23], v8, s[8:11], s54 offen offset:256
    buffer_load_dwordx4 a[24:27], v8, s[8:11], s54 offen offset:512
    buffer_load_dwordx4 a[28:31], v8, s[8:11], s54 offen offset:768
    s_branch MJ_228
ML_227:
    s_add_u32 s77, s90, 592
    s_mul_i32 s54, s77, s85
    s_add_u32 s54, s54, s53
    s_add_u32 m0, s59, 4096
    s_nop 0
    buffer_load_dwordx4 v4, s[4:7], s54 offen offset:0 nt lds
    buffer_load_dwordx4 v5, s[4:7], s54 offen offset:1024 nt lds
    buffer_load_dwordx4 v6, s[4:7], s54 offen offset:2048 nt lds
    buffer_load_dwordx4 v7, s[4:7], s54 offen offset:3072 nt lds
    buffer_load_dwordx4 a[16:19], v8, s[8:11], s54 offen offset:0 nt
    buffer_load_dwordx4 a[20:23], v8, s[8:11], s54 offen offset:256 nt
    buffer_load_dwordx4 a[24:27], v8, s[8:11], s54 offen offset:512 nt
    buffer_load_dwordx4 a[28:31], v8, s[8:11], s54 offen offset:768 nt
MJ_228:
    s_nop 7
    s_nop 1
LOOP_229:
    s_waitcnt vmcnt(13)
    ds_read_b128 v[48:51], v9 offset:0
    ds_read_b128 v[52:55], v10 offset:0
    ds_read_b128 v[56:59], v11 offset:0
    ds_read_b128 v[60:63], v12 offset:0
    s_waitcnt lgkmcnt(3)
    v_mfma_f32_16x16x32_bf16 v[24:27], v[48:51], v[64:67], 0
    s_waitcnt lgkmcnt(2)
    v_mfma_f32_16x16x32_bf16 v[24:27], v[52:55], v[68:71], v[24:27]
    s_waitcnt lgkmcnt(1)
    v_mfma_f32_16x16x32_bf16 v[24:27], v[56:59], v[72:75], v[24:27]
    s_waitcnt lgkmcnt(0)
    v_mfma_f32_16x16x32_bf16 v[24:27], v[60:63], v[76:79], v[24:27]
    s_nop 7
    v_fma_f32 v28, v24, s55, v17
    v_fma_f32 v29, v25, s55, v17
    v_fma_f32 v30, v26, s55, v17
    v_fma_f32 v31, v27, s55, v17
    v_max3_f32 v36, v28, v29, v30
    v_max_f32 v36, v36, v31
    v_cmp_lt_f32 vcc, s56, v36
    s_cbranch_vccnz RS_231
RB_232:
    v_exp_f32 v28, v28
    v_exp_f32 v29, v29
    v_exp_f32 v30, v30
    v_exp_f32 v31, v31
    v_cvt_pk_bf16_f32 v32, v28, v28
    v_add_f32 v18, v18, v28
    v_cvt_pk_bf16_f32 v33, v29, v29
    v_add_f32 v19, v19, v29
    v_cvt_pk_bf16_f32 v34, v30, v30
    v_add_f32 v18, v18, v30
    v_cvt_pk_bf16_f32 v35, v31, v31
    v_add_f32 v19, v19, v31
    s_waitcnt vmcnt(9)
    v_and_b32 v48, v32, v13
    v_and_b32 v49, v32, v14
    v_and_b32 v50, v32, v15
    v_and_b32 v51, v32, v16
    v_and_b32 v52, v33, v13
    v_and_b32 v53, v33, v14
    v_and_b32 v54, v33, v15
    v_and_b32 v55, v33, v16
    v_mfma_f32_16x16x32_bf16 v[20:23], a[0:3], v[48:51], v[20:23]
    v_and_b32 v56, v34, v13
    v_and_b32 v57, v34, v14
    v_and_b32 v58, v34, v15
    v_and_b32 v59, v34, v16
    v_mfma_f32_16x16x32_bf16 v[20:23], a[4:7], v[52:55], v[20:23]
    v_and_b32 v60, v35, v13
    v_and_b32 v61, v35, v14
    v_and_b32 v62, v35, v15
    v_and_b32 v63, v35, v16
    v_mfma_f32_16x16x32_bf16 v[20:23], a[8:11], v[56:59], v[20:23]
    s_nop 0
    v_mfma_f32_16x16x32_bf16 v[20:23], a[12:15], v[60:63], v[20:23]
    s_waitcnt vmcnt(8)
    v_readfirstlane_b32 s76, v39
    s_add_u32 s76, s76, 608
    s_cmp_lt_u32 s76, 756
    s_cbranch_scc0 XS_233
    s_mul_i32 s54, s76, s85
    s_add_u32 s54, s54, s53
    v_mov_b32 v38, 1
    buffer_atomic_add v38, v43, s[48:51], s65 offen sc0
    s_add_u32 m0, s59, 0
    s_nop 0
    buffer_load_dwordx4 v4, s[4:7], s54 offen offset:0 nt lds
    buffer_load_dwordx4 v5, s[4:7], s54 offen offset:1024 nt lds
    buffer_load_dwordx4 v6, s[4:7], s54 offen offset:2048 nt lds
    buffer_load_dwordx4 v7, s[4:7], s54 offen offset:3072 nt lds
    buffer_load_dwordx4 a[0:3], v8, s[8:11], s54 offen offset:0 nt
    buffer_load_dwordx4 a[4:7], v8, s[8:11], s54 offen offset:256 nt
    buffer_load_dwordx4 a[8:11], v8, s[8:11], s54 offen offset:512 nt
    buffer_load_dwordx4 a[12:15], v8, s[8:11], s54 offen offset:768 nt
    s_waitcnt vmcnt(13)
    ds_read_b128 v[48:51], v9 offset:4096
    ds_read_b128 v[52:55], v10 offset:4096
    ds_read_b128 v[56:59], v11 offset:4096
    ds_read_b128 v[60:63], v12 offset:4096
    s_waitcnt lgkmcnt(3)
    v_mfma_f32_16x16x32_bf16 v[24:27], v[48:51], v[64:67], 0
    s_waitcnt lgkmcnt(2)
    v_mfma_f32_16x16x32_bf16 v[24:27], v[52:55], v[68:71], v[24:27]
    s_waitcnt lgkmcnt(1)
    v_mfma_f32_16x16x32_bf16 v[24:27], v[56:59], v[72:75], v[24:27]
    s_waitcnt lgkmcnt(0)
    v_mfma_f32_16x16x32_bf16 v[24:27], v[60:63], v[76:79], v[24:27]
    s_nop 7
    v_fma_f32 v28, v24, s55, v17
    v_fma_f32 v29, v25, s55, v17
    v_fma_f32 v30, v26, s55, v17
    v_fma_f32 v31, v27, s55, v17
    v_max3_f32 v36, v28, v29, v30
    v_max_f32 v36, v36, v31
    v_cmp_lt_f32 vcc, s56, v36
    s_cbranch_vccnz RS_235
RB_236:
    v_exp_f32 v28, v28
    v_exp_f32 v29, v29
    v_exp_f32 v30, v30
    v_exp_f32 v31, v31
    v_cvt_pk_bf16_f32 v32, v28, v28
    v_add_f32 v18, v18, v28
    v_cvt_pk_bf16_f32 v33, v29, v29
    v_add_f32 v19, v19, v29
    v_cvt_pk_bf16_f32 v34, v30, v30
    v_add_f32 v18, v18, v30
    v_cvt_pk_bf16_f32 v35, v31, v31
    v_add_f32 v19, v19, v31
    s_waitcnt vmcnt(9)
    v_and_b32 v48, v32, v13
    v_and_b32 v49, v32, v14
    v_and_b32 v50, v32, v15
    v_and_b32 v51, v32, v16
    v_and_b32 v52, v33, v13
    v_and_b32 v53, v33, v14
    v_and_b32 v54, v33, v15
    v_and_b32 v55, v33, v16
    v_mfma_f32_16x16x32_bf16 v[20:23], a[16:19], v[48:51], v[20:23]
    v_and_b32 v56, v34, v13
    v_and_b32 v57, v34, v14
    v_and_b32 v58, v34, v15
    v_and_b32 v59, v34, v16
    v_mfma_f32_16x16x32_bf16 v[20:23], a[20:23], v[52:55], v[20:23]
    v_and_b32 v60, v35, v13
    v_and_b32 v61, v35, v14
    v_and_b32 v62, v35, v15
    v_and_b32 v63, v35, v16
    v_mfma_f32_16x16x32_bf16 v[20:23], a[24:27], v[56:59], v[20:23]
    s_nop 0
    v_mfma_f32_16x16x32_bf16 v[20:23], a[28:31], v[60:63], v[20:23]
    s_waitcnt vmcnt(8)
    v_readfirstlane_b32 s77, v38
    s_add_u32 s77, s77, 608
    s_cmp_lt_u32 s77, 756
    s_cbranch_scc0 XS_237
    s_mul_i32 s54, s77, s85
    s_add_u32 s54, s54, s53
    v_mov_b32 v39, 1
    buffer_atomic_add v39, v43, s[48:51], s65 offen sc0
    s_add_u32 m0, s59, 4096
    s_nop 0
    buffer_load_dwordx4 v4, s[4:7], s54 offen offset:0 nt lds
    buffer_load_dwordx4 v5, s[4:7], s54 offen offset:1024 nt lds
    buffer_load_dwordx4 v6, s[4:7], s54 offen offset:2048 nt lds
    buffer_load_dwordx4 v7, s[4:7], s54 offen offset:3072 nt lds
    buffer_load_dwordx4 a[16:19], v8, s[8:11], s54 offen offset:0 nt
    buffer_load_dwordx4 a[20:23], v8, s[8:11], s54 offen offset:256 nt
    buffer_load_dwordx4 a[24:27], v8, s[8:11], s54 offen offset:512 nt
    buffer_load_dwordx4 a[28:31], v8, s[8:11], s54 offen offset:768 nt
    s_nop 7
    s_nop 1
    s_branch LOOP_229
XS_233:
    s_mov_b32 s95, 0
    s_waitcnt vmcnt(4)
    ds_read_b128 v[48:51], v9 offset:4096
    ds_read_b128 v[52:55], v10 offset:4096
    ds_read_b128 v[56:59], v11 offset:4096
    ds_read_b128 v[60:63], v12 offset:4096
    s_waitcnt lgkmcnt(3)
    v_mfma_f32_16x16x32_bf16 v[24:27], v[48:51], v[64:67], 0
    s_waitcnt lgkmcnt(2)
    v_mfma_f32_16x16x32_bf16 v[24:27], v[52:55], v[68:71], v[24:27]
    s_waitcnt lgkmcnt(1)
    v_mfma_f32_16x16x32_bf16 v[24:27], v[56:59], v[72:75], v[24:27]
    s_waitcnt lgkmcnt(0)
    v_mfma_f32_16x16x32_bf16 v[24:27], v[60:63], v[76:79], v[24:27]
    s_nop 7
    v_fma_f32 v28, v24, s55, v17
    v_fma_f32 v29, v25, s55, v17
    v_fma_f32 v30, v26, s55, v17
    v_fma_f32 v31, v27, s55, v17
    v_max3_f32 v36, v28, v29, v30
    v_max_f32 v36, v36, v31
    v_cmp_lt_f32 vcc, s56, v36
    s_cbranch_vccnz RS_239
RB_240:
    v_exp_f32 v28, v28
    v_exp_f32 v29, v29
    v_exp_f32 v30, v30
    v_exp_f32 v31, v31
    v_cvt_pk_bf16_f32 v32, v28, v28
    v_add_f32 v18, v18, v28
    v_cvt_pk_bf16_f32 v33, v29, v29
    v_add_f32 v19, v19, v29
    v_cvt_pk_bf16_f32 v34, v30, v30
    v_add_f32 v18, v18, v30
    v_cvt_pk_bf16_f32 v35, v31, v31
    v_add_f32 v19, v19, v31
    s_waitcnt vmcnt(0)
    v_and_b32 v48, v32, v13
    v_and_b32 v49, v32, v14
    v_and_b32 v50, v32, v15
    v_and_b32 v51, v32, v16
    v_and_b32 v52, v33, v13
    v_and_b32 v53, v33, v14
    v_and_b32 v54, v33, v15
    v_and_b32 v55, v33, v16
    v_mfma_f32_16x16x32_bf16 v[20:23], a[16:19], v[48:51], v[20:23]
    v_and_b32 v56, v34, v13
    v_and_b32 v57, v34, v14
    v_and_b32 v58, v34, v15
    v_and_b32 v59, v34, v16
    v_mfma_f32_16x16x32_bf16 v[20:23], a[20:23], v[52:55], v[20:23]
    v_and_b32 v60, v35, v13
    v_and_b32 v61, v35, v14
    v_and_b32 v62, v35, v15
    v_and_b32 v63, v35, v16
    v_mfma_f32_16x16x32_bf16 v[20:23], a[24:27], v[56:59], v[20:23]
    s_nop 0
    v_mfma_f32_16x16x32_bf16 v[20:23], a[28:31], v[60:63], v[20:23]
    s_nop 7
    s_nop 1
    s_branch PEND_230
XS_237:
    s_mov_b32 s95, 0
    s_waitcnt vmcnt(4)
    ds_read_b128 v[48:51], v9 offset:0
    ds_read_b128 v[52:55], v10 offset:0
    ds_read_b128 v[56:59], v11 offset:0
    ds_read_b128 v[60:63], v12 offset:0
    s_waitcnt lgkmcnt(3)
    v_mfma_f32_16x16x32_bf16 v[24:27], v[48:51], v[64:67], 0
    s_waitcnt lgkmcnt(2)
    v_mfma_f32_16x16x32_bf16 v[24:27], v[52:55], v[68:71], v[24:27]
    s_waitcnt lgkmcnt(1)
    v_mfma_f32_16x16x32_bf16 v[24:27], v[56:59], v[72:75], v[24:27]
    s_waitcnt lgkmcnt(0)
    v_mfma_f32_16x16x32_bf16 v[24:27], v[60:63], v[76:79], v[24:27]
    s_nop 7
    v_fma_f32 v28, v24, s55, v17
    v_fma_f32 v29, v25, s55, v17
    v_fma_f32 v30, v26, s55, v17
    v_fma_f32 v31, v27, s55, v17
    v_max3_f32 v36, v28, v29, v30
    v_max_f32 v36, v36, v31
    v_cmp_lt_f32 vcc, s56, v36
    s_cbranch_vccnz RS_241
RB_242:
    v_exp_f32 v28, v28
    v_exp_f32 v29, v29
    v_exp_f32 v30, v30
    v_exp_f32 v31, v31
    v_cvt_pk_bf16_f32 v32, v28, v28
    v_add_f32 v18, v18, v28
    v_cvt_pk_bf16_f32 v33, v29, v29
    v_add_f32 v19, v19, v29
    v_cvt_pk_bf16_f32 v34, v30, v30
    v_add_f32 v18, v18, v30
    v_cvt_pk_bf16_f32 v35, v31, v31
    v_add_f32 v19, v19, v31
    s_waitcnt vmcnt(0)
    v_and_b32 v48, v32, v13
    v_and_b32 v49, v32, v14
    v_and_b32 v50, v32, v15
    v_and_b32 v51, v32, v16
    v_and_b32 v52, v33, v13
    v_and_b32 v53, v33, v14
    v_and_b32 v54, v33, v15
    v_and_b32 v55, v33, v16
    v_mfma_f32_16x16x32_bf16 v[20:23], a[0:3], v[48:51], v[20:23]
    v_and_b32 v56, v34, v13
    v_and_b32 v57, v34, v14
    v_and_b32 v58, v34, v15
    v_and_b32 v59, v34, v16
    v_mfma_f32_16x16x32_bf16 v[20:23], a[4:7], v[52:55], v[20:23]
    v_and_b32 v60, v35, v13
    v_and_b32 v61, v35, v14
    v_and_b32 v62, v35, v15
    v_and_b32 v63, v35, v16
    v_mfma_f32_16x16x32_bf16 v[20:23], a[8:11], v[56:59], v[20:23]
    s_nop 0
    v_mfma_f32_16x16x32_bf16 v[20:23], a[12:15], v[60:63], v[20:23]
    s_nop 7
    s_nop 1
    s_branch PEND_230
PEND_230:
    s_nop 7
    s_nop 1
    v_readfirstlane_b32 s60, v1
    s_bcnt1_i32_b32 s60, s60
    s_cmp_eq_u32 s60, 1
    s_cselect_b32 s86, 1, 0
    v_lshrrev_b32 v1, 4, v0
    v_mul_u32_u24 v1, 36864, v1
    v_and_b32 v2, 15, v0
    v_lshl_add_u32 v1, v2, 4, v1
    s_lshl_b32 s60, s57, 8
    s_lshr_b32 s61, s58, 3
    s_lshl_b32 s61, s61, 7
    s_add_u32 s60, s60, s61
    s_and_b32 s61, s58, 7
    s_add_u32 s60, s60, s61
    s_mul_i32 s60, s60, 1152
    s_lshl_b32 s61, s3, 8
    s_add_u32 s61, s61, s60
    s_add_u32 s62, s61, 0
    buffer_load_dwordx4 v[64:67], v1, s[16:19], s62 offen nt
    s_add_u32 s62, s61, 9216
    buffer_load_dwordx4 v[68:71], v1, s[16:19], s62 offen nt
    s_add_u32 s62, s61, 18432
    buffer_load_dwordx4 v[72:75], v1, s[16:19], s62 offen nt
    s_add_u32 s62, s61, 27648
    buffer_load_dwordx4 v[76:79], v1, s[16:19], s62 offen nt
    s_cmp_eq_u32 s3, 3
    s_cbranch_scc0 WO_243
    s_add_u32 s62, s60, 1024
    buffer_load_dwordx4 v[48:51], v1, s[16:19], s62 offen nt
    s_add_u32 s62, s60, 10240
    buffer_load_dwordx4 v[52:55], v1, s[16:19], s62 offen nt
    s_add_u32 s62, s60, 19456
    buffer_load_dwordx4 v[56:59], v1, s[16:19], s62 offen nt
    s_add_u32 s62, s60, 28672
    buffer_load_dwordx4 v[60:63], v1, s[16:19], s62 offen nt
WO_243:
    v_add_f32 v18, v18, v19
    v_mov_b32 v36, v18
    s_nop 1
    v_permlane16_swap_b32 v18, v36
    v_add_f32 v18, v18, v36
    v_mov_b32 v36, v18
    s_nop 1
    v_permlane32_swap_b32 v18, v36
    v_add_f32 v18, v18, v36
    v_mov_b32 v19, v18
    v_mov_b32 v18, v17
    v_lshlrev_b32 v38, 4, v0
    v_add_u32 v38, 147456, v38
    v_lshlrev_b32 v39, 3, v0
    v_add_u32 v39, 151552, v39
    s_lshl_b32 s60, s3, 10
    v_add_u32 v36, s60, v38
    s_lshl_b32 s60, s3, 9
    v_add_u32 v37, s60, v39
    ds_write_b128 v36, v[20:23]
    ds_write_b64 v37, v[18:19]
    s_waitcnt lgkmcnt(0)
    s_barrier
    s_cmp_eq_u32 s3, 0
    s_cbranch_scc0 CA_244
    ds_read_b64 v[48:49], v39 offset:0
    ds_read_b64 v[50:51], v39 offset:512
    ds_read_b64 v[52:53], v39 offset:1024
    ds_read_b64 v[54:55], v39 offset:1536
    ds_read_b128 v[24:27], v38 offset:1024
    ds_read_b128 v[28:31], v38 offset:2048
    ds_read_b128 v[32:35], v38 offset:3072
    s_waitcnt lgkmcnt(3)
    v_min_f32 v18, v48, v50
    v_min3_f32 v18, v18, v52, v54
    v_sub_f32 v48, v18, v48
    v_sub_f32 v50, v18, v50
    v_sub_f32 v52, v18, v52
    v_sub_f32 v54, v18, v54
    v_exp_f32 v48, v48
    v_exp_f32 v50, v50
    v_exp_f32 v52, v52
    v_exp_f32 v54, v54
    v_mul_f32 v19, v48, v49
    v_fma_f32 v19, v50, v51, v19
    v_fma_f32 v19, v52, v53, v19
    v_fma_f32 v19, v54, v55, v19
    v_mul_f32 v20, v20, v48
    v_mul_f32 v21, v21, v48
    v_mul_f32 v22, v22, v48
    v_mul_f32 v23, v23, v48
    s_waitcnt lgkmcnt(0)
    v_fma_f32 v20, v24, v50, v20
    v_fma_f32 v21, v25, v50, v21
    v_fma_f32 v22, v26, v50, v22
    v_fma_f32 v23, v27, v50, v23
    v_fma_f32 v20, v28, v52, v20
    v_fma_f32 v21, v29, v52, v21
    v_fma_f32 v22, v30, v52, v22
    v_fma_f32 v23, v31, v52, v23
    v_fma_f32 v20, v32, v54, v20
    v_fma_f32 v21, v33, v54, v21
    v_fma_f32 v22, v34, v54, v22
    v_fma_f32 v23, v35, v54, v23
    v_and_b32 v38, 15, v0
    v_lshlrev_b32 v39, 7, v38
    v_lshlrev_b32 v38, 10, v38
    v_lshrrev_b32 v36, 4, v0
    v_lshl_add_u32 v38, v36, 4, v38
    s_lshl_b32 s60, s57, 14
    s_lshl_b32 s61, s58, 6
    s_add_u32 s60, s60, s61
    s_add_u32 s60, s60, 933888
    s_add_u32 s60, s60, s82
    buffer_store_dwordx4 v[20:23], v38, s[32:35], s60 offen sc1
    s_lshl_b32 s60, s57, 11
    s_lshl_b32 s61, s58, 3
    s_add_u32 s60, s60, s61
    s_add_u32 s60, s60, 1196032
    s_add_u32 s60, s60, s82
    s_mov_b64 exec, 0xffff
    buffer_store_dwordx2 v[18:19], v39, s[32:35], s60 offen sc1
    s_mov_b64 exec, -1
    s_nop 7
    s_nop 1
CA_244:
    v_bfe_u32 v1, v0, 2, 2
    v_mul_u32_u24 v1, 4096, v1
    v_and_b32 v2, 3, v0
    v_lshl_add_u32 v1, v2, 5, v1
    v_bfe_u32 v2, v0, 4, 1
    v_lshl_add_u32 v1, v2, 4, v1
    s_mul_i32 s92, s88, 18
    s_lshl_b32 s93, s3, 2
    s_add_u32 s92, s92, s93
    s_mul_i32 s92, s92, 4096
    s_lshl_b32 s93, s91, 7
    s_add_u32 s92, s92, s93
    s_add_u32 s92, s92, 0
    s_add_u32 s92, s92, s82
    s_add_u32 s93, s92, 16384
    v_and_b32 v39, 15, v0
    v_lshlrev_b32 v38, 6, v39
    v_lshlrev_b32 v39, 3, v39
    v_lshrrev_b32 v36, 4, v0
    v_lshl_add_u32 v38, v36, 4, v38
    s_lshl_b32 s61, s87, 7
    s_add_u32 s61, s61, 1196032
    s_add_u32 s61, s61, s82
    s_lshl_b32 s60, s87, 10
    s_add_u32 s60, s60, 933888
    s_add_u32 s60, s60, s82
    s_cmp_eq_u32 s3, 1
    s_cbranch_scc0 BP_245
    s_nop 7
    s_nop 1
    s_mov_b32 s64, 200000
    buffer_load_dwordx4 v[48:51], v38, s[32:35], s60 offen sc1
    buffer_load_dwordx2 v[52:53], v39, s[32:35], s61 offen sc1
    buffer_load_dwordx4 v[48:51], v38, s[32:35], s60 offen sc1
    buffer_load_dwordx2 v[52:53], v39, s[32:35], s61 offen sc1
    buffer_load_dwordx4 v[48:51], v38, s[32:35], s60 offen sc1
    buffer_load_dwordx2 v[52:53], v39, s[32:35], s61 offen sc1
PL_246:
    buffer_load_dwordx4 v[48:51], v38, s[32:35], s60 offen sc1
    buffer_load_dwordx2 v[52:53], v39, s[32:35], s61 offen sc1
    s_waitcnt vmcnt(6)
    v_max3_u32 v36, v48, v49, v50
    v_max3_u32 v36, v36, v51, v52
    v_max_u32 v36, v36, v53
    v_cmp_eq_u32 vcc, -1, v36
    s_cbranch_vccz PD_247
    s_sub_u32 s64, s64, 1
    s_cmp_lg_u32 s64, 0
    s_cbranch_scc1 PL_246
PD_247:
    v_mov_b32 v36, v52
    s_nop 1
    v_min_f32_dpp v36, v36, v36 row_ror:8 row_mask:0xf bank_mask:0xf
    s_nop 1
    v_min_f32_dpp v36, v36, v36 row_ror:4 row_mask:0xf bank_mask:0xf
    s_nop 1
    v_min_f32_dpp v36, v36, v36 row_ror:2 row_mask:0xf bank_mask:0xf
    s_nop 1
    v_min_f32_dpp v36, v36, v36 row_ror:1 row_mask:0xf bank_mask:0xf
    v_sub_f32 v36, v36, v52
    v_exp_f32 v36, v36
    s_nop 0
    v_mul_f32 v19, v53, v36
    v_mul_f32 v20, v48, v36
    v_mul_f32 v21, v49, v36
    v_mul_f32 v22, v50, v36
    v_mul_f32 v23, v51, v36
    v_add_f32_dpp v19, v19, v19 row_ror:8 row_mask:0xf bank_mask:0xf
    v_add_f32_dpp v20, v20, v20 row_ror:8 row_mask:0xf bank_mask:0xf
    v_add_f32_dpp v21, v21, v21 row_ror:8 row_mask:0xf bank_mask:0xf
    v_add_f32_dpp v22, v22, v22 row_ror:8 row_mask:0xf bank_mask:0xf
    v_add_f32_dpp v23, v23, v23 row_ror:8 row_mask:0xf bank_mask:0xf
    v_add_f32_dpp v19, v19, v19 row_ror:4 row_mask:0xf bank_mask:0xf
    v_add_f32_dpp v20, v20, v20 row_ror:4 row_mask:0xf bank_mask:0xf
    v_add_f32_dpp v21, v21, v21 row_ror:4 row_mask:0xf bank_mask:0xf
    v_add_f32_dpp v22, v22, v22 row_ror:4 row_mask:0xf bank_mask:0xf
    v_add_f32_dpp v23, v23, v23 row_ror:4 row_mask:0xf bank_mask:0xf
    v_add_f32_dpp v19, v19, v19 row_ror:2 row_mask:0xf bank_mask:0xf
    v_add_f32_dpp v20, v20, v20 row_ror:2 row_mask:0xf bank_mask:0xf
    v_add_f32_dpp v21, v21, v21 row_ror:2 row_mask:0xf bank_mask:0xf
    v_add_f32_dpp v22, v22, v22 row_ror:2 row_mask:0xf bank_mask:0xf
    v_add_f32_dpp v23, v23, v23 row_ror:2 row_mask:0xf bank_mask:0xf
    v_add_f32_dpp v19, v19, v19 row_ror:1 row_mask:0xf bank_mask:0xf
    v_add_f32_dpp v20, v20, v20 row_ror:1 row_mask:0xf bank_mask:0xf
    v_add_f32_dpp v21, v21, v21 row_ror:1 row_mask:0xf bank_mask:0xf
    v_add_f32_dpp v22, v22, v22 row_ror:1 row_mask:0xf bank_mask:0xf
    v_add_f32_dpp v23, v23, v23 row_ror:1 row_mask:0xf bank_mask:0xf
    v_rcp_f32 v19, v19
    s_nop 0
    v_mul_f32 v20, v20, v19
    v_mul_f32 v21, v21, v19
    v_mul_f32 v22, v22, v19
    v_mul_f32 v23, v23, v19
    v_cvt_pk_bf16_f32 v32, v20, v20
    v_cvt_pk_bf16_f32 v33, v21, v21
    v_cvt_pk_bf16_f32 v34, v22, v22
    v_cvt_pk_bf16_f32 v35, v23, v23
    v_lshrrev_b32 v36, 4, v0
    v_lshlrev_b32 v36, 4, v36
    v_add_u32 v36, 151552, v36
    ds_write_b128 v36, v[32:35]
    s_waitcnt lgkmcnt(0)
BP_245:
    s_barrier
    v_lshrrev_b32 v36, 4, v0
    v_lshlrev_b32 v36, 4, v36
    v_add_u32 v36, 151552, v36
    ds_read_b128 v[32:35], v36
    s_waitcnt vmcnt(6) lgkmcnt(0)
    v_and_b32 v24, v32, v13
    v_and_b32 v25, v32, v14
    v_and_b32 v26, v32, v15
    v_and_b32 v27, v32, v16
    s_nop 1
    v_mfma_f32_16x16x32_bf16 v[20:23], v[24:27], v[64:67], 0
    v_and_b32 v28, v33, v13
    v_and_b32 v29, v33, v14
    v_and_b32 v30, v33, v15
    v_and_b32 v31, v33, v16
    s_nop 1
    v_mfma_f32_16x16x32_bf16 v[20:23], v[28:31], v[68:71], v[20:23]
    v_and_b32 v24, v34, v13
    v_and_b32 v25, v34, v14
    v_and_b32 v26, v34, v15
    v_and_b32 v27, v34, v16
    s_nop 1
    v_mfma_f32_16x16x32_bf16 v[20:23], v[24:27], v[72:75], v[20:23]
    v_and_b32 v28, v35, v13
    v_and_b32 v29, v35, v14
    v_and_b32 v30, v35, v15
    v_and_b32 v31, v35, v16
    s_nop 1
    v_mfma_f32_16x16x32_bf16 v[20:23], v[28:31], v[76:79], v[20:23]
    s_cmp_eq_u32 s3, 3
    s_cbranch_scc0 WB_248
    v_and_b32 v24, v32, v13
    v_and_b32 v25, v32, v14
    v_and_b32 v26, v32, v15
    v_and_b32 v27, v32, v16
    s_nop 1
    v_mfma_f32_16x16x32_bf16 v[40:43], v[24:27], v[48:51], 0
    v_and_b32 v28, v33, v13
    v_and_b32 v29, v33, v14
    v_and_b32 v30, v33, v15
    v_and_b32 v31, v33, v16
    s_nop 1
    v_mfma_f32_16x16x32_bf16 v[40:43], v[28:31], v[52:55], v[40:43]
    v_and_b32 v24, v34, v13
    v_and_b32 v25, v34, v14
    v_and_b32 v26, v34, v15
    v_and_b32 v27, v34, v16
    s_nop 1
    v_mfma_f32_16x16x32_bf16 v[40:43], v[24:27], v[56:59], v[40:43]
    v_and_b32 v28, v35, v13
    v_and_b32 v29, v35, v14
    v_and_b32 v30, v35, v15
    v_and_b32 v31, v35, v16
    s_nop 1
    v_mfma_f32_16x16x32_bf16 v[40:43], v[28:31], v[60:63], v[40:43]
    s_nop 7
    s_nop 1
WB_248:
    s_cmp_eq_u32 s86, 1
    s_cbranch_scc0 NS_249
    s_mov_b64 exec, 0xffffffff
    buffer_store_dwordx4 v[20:23], v1, s[32:35], s92 offen
    s_cmp_eq_u32 s3, 3
    s_cbranch_scc0 N3_251
    s_mov_b64 exec, 0x00ff00ff
    buffer_store_dwordx4 v[40:43], v1, s[32:35], s93 offen
N3_251:
    s_branch ND_250
NS_249:
    s_mov_b64 exec, 0xffffffff
    buffer_store_dwordx4 v[20:23], v1, s[32:35], s92 offen sc1
    s_cmp_eq_u32 s3, 3
    s_cbranch_scc0 N3_252
    s_mov_b64 exec, 0x00ff00ff
    buffer_store_dwordx4 v[40:43], v1, s[32:35], s93 offen sc1
N3_252:
ND_250:
    s_mov_b64 exec, -1
    s_cmp_eq_u32 s81, 0
    s_cbranch_scc1 FFN_253
    s_cmp_eq_u32 s81, 2
    s_cbranch_scc1 RED_254
    s_cmp_lg_u32 s83, 0
    s_cbranch_scc1 L_exit
    s_branch QP_255
FFN_253:
    s_nop 7
    s_nop 1
    s_cmp_lg_u32 s83, 0
    s_cbranch_scc1 F1_257
    v_lshrrev_b32 v40, 5, v0
    v_lshlrev_b32 v40, 8, v40
    v_bfe_u32 v39, v0, 4, 1
    v_lshl_add_u32 v40, v39, 7, v40
    v_and_b32 v39, 7, v0
    v_lshl_add_u32 v40, v39, 2, v40
    s_lshl_b32 s60, s3, 9
    s_add_u32 s60, s60, 147456
    v_add_u32 v40, s60, v40
    v_and_b32 v24, 0x3f803f80, v13
    v_and_b32 v25, 0x3f803f80, v14
    v_and_b32 v26, 0x3f803f80, v15
    v_and_b32 v27, 0x3f803f80, v16
    s_nop 1
    v_mfma_f32_16x16x32_bf16 v[20:23], a[160:163], v[24:27], 0
    v_mfma_f32_16x16x32_bf16 v[32:35], a[164:167], v[24:27], 0
    v_mfma_f32_16x16x32_bf16 v[20:23], a[168:171], v[24:27], v[20:23]
    v_mfma_f32_16x16x32_bf16 v[32:35], a[172:175], v[24:27], v[32:35]
    v_mfma_f32_16x16x32_bf16 v[20:23], a[176:179], v[24:27], v[20:23]
    v_mfma_f32_16x16x32_bf16 v[32:35], a[180:183], v[24:27], v[32:35]
    v_mfma_f32_16x16x32_bf16 v[20:23], a[184:187], v[24:27], v[20:23]
    v_mfma_f32_16x16x32_bf16 v[32:35], a[188:191], v[24:27], v[32:35]
    v_mfma_f32_16x16x32_bf16 v[20:23], a[192:195], v[24:27], v[20:23]
    v_mfma_f32_16x16x32_bf16 v[32:35], a[196:199], v[24:27], v[32:35]
    v_mfma_f32_16x16x32_bf16 v[20:23], a[200:203], v[24:27], v[20:23]
    v_mfma_f32_16x16x32_bf16 v[32:35], a[204:207], v[24:27], v[32:35]
    v_mfma_f32_16x16x32_bf16 v[20:23], a[208:211], v[24:27], v[20:23]
    v_mfma_f32_16x16x32_bf16 v[32:35], a[212:215], v[24:27], v[32:35]
    v_mfma_f32_16x16x32_bf16 v[20:23], a[216:219], v[24:27], v[20:23]
    v_mfma_f32_16x16x32_bf16 v[32:35], a[220:223], v[24:27], v[32:35]
    v_mfma_f32_16x16x32_bf16 v[20:23], a[224:227], v[24:27], v[20:23]
    v_mfma_f32_16x16x32_bf16 v[32:35], a[228:231], v[24:27], v[32:35]
    s_nop 7
    v_add_f32 v20, v20, v32
    v_add_f32 v21, v21, v33
    v_add_f32 v22, v22, v34
    v_add_f32 v23, v23, v35
    s_mov_b64 exec, s[68:69]
    ds_write_b32 v40, v20 offset:0
    ds_write_b32 v40, v21 offset:32
    ds_write_b32 v40, v22 offset:64
    ds_write_b32 v40, v23 offset:96
    s_mov_b64 exec, -1
    s_waitcnt lgkmcnt(0)
    s_barrier
    s_cmp_eq_u32 s3, 0
    s_cbranch_scc0 CS_259
    v_lshlrev_b32 v38, 2, v0
    v_add_u32 v38, 147456, v38
    ds_read2st64_b32 v[48:49], v38 offset0:0 offset1:1
    ds_read2st64_b32 v[50:51], v38 offset0:2 offset1:3
    ds_read2st64_b32 v[52:53], v38 offset0:4 offset1:5
    ds_read2st64_b32 v[54:55], v38 offset0:6 offset1:7
    s_waitcnt lgkmcnt(0)
    v_add_f32 v48, v48, v49
    v_add_f32 v50, v50, v51
    v_add_f32 v52, v52, v53
    v_add_f32 v54, v54, v55
    v_add_f32 v48, v48, v50
    v_add_f32 v52, v52, v54
    v_add_f32 v36, v48, v52
    ds_write_b32 v38, v36 offset:14848
    s_nop 7
    s_nop 1
CS_259:
    s_nop 7
    s_nop 1
    s_branch F2_258
F1_257:
    s_nop 7
    s_nop 1
F2_258:
    s_nop 7
    s_nop 1
    s_mul_i32 s60, s88, 18
    s_sub_u32 s94, s63, s60
    v_bfe_u32 v1, v0, 2, 2
    v_mul_u32_u24 v1, 2304, v1
    v_and_b32 v2, 3, v0
    v_lshl_add_u32 v1, v2, 5, v1
    v_bfe_u32 v2, v0, 4, 1
    v_lshl_add_u32 v1, v2, 4, v1
    s_mul_i32 s92, s88, 18
    s_lshl_b32 s93, s3, 2
    s_add_u32 s92, s92, s93
    s_mul_i32 s92, s92, 2304
    s_lshl_b32 s93, s94, 7
    s_add_u32 s92, s92, s93
    s_add_u32 s92, s92, 589824
    s_add_u32 s92, s92, s82
    s_add_u32 s93, s92, 9216
    v_lshlrev_b32 v38, 4, v0
    s_mul_i32 s60, s3, 576
    s_mul_i32 s61, s88, 2304
    s_add_u32 s60, s60, s61
    s_add_u32 s60, s60, 1331200
    s_add_u32 s60, s60, s82
    s_mov_b32 exec_lo, -1
    s_mov_b32 exec_hi, 0xf
    s_nop 7
    s_nop 1
    s_mov_b32 s64, 200000
PL_260:
    buffer_load_dwordx4 v[44:47], v38, s[32:35], s60 offen sc1
    s_waitcnt vmcnt(0)
    v_max3_u32 v36, v44, v45, v46
    v_max_u32 v36, v36, v47
    v_cmp_eq_u32 vcc, -1, v36
    s_cbranch_vccz PD_261
    s_sub_u32 s64, s64, 1
    s_cmp_lg_u32 s64, 0
    s_cbranch_scc1 PL_260
PD_261:
    s_mov_b64 exec, -1
    v_cvt_pk_bf16_f32 v28, v44, v44
    v_cvt_pk_bf16_f32 v29, v45, v45
    v_cvt_pk_bf16_f32 v30, v46, v46
    v_cvt_pk_bf16_f32 v31, v47, v47
    v_lshlrev_b32 v38, 4, v0
    s_mul_i32 s60, s3, 576
    s_add_u32 s60, s60, 153600
    v_add_u32 v38, s60, v38
    s_mov_b32 exec_lo, -1
    s_mov_b32 exec_hi, 0xf
    ds_write_b128 v38, v[28:31]
    s_mov_b64 exec, -1
    v_lshrrev_b32 v38, 4, v0
    v_lshlrev_b32 v38, 1, v38
    v_bfe_u32 v39, v0, 3, 1
    v_add_u32 v38, v38, v39
    v_lshlrev_b32 v38, 2, v38
    v_add_u32 v38, s60, v38
    ds_read2_b32 v[48:49], v38 offset0:0 offset1:8
    ds_read2_b32 v[50:51], v38 offset0:16 offset1:24
    ds_read2_b32 v[52:53], v38 offset0:32 offset1:40
    ds_read2_b32 v[54:55], v38 offset0:48 offset1:56
    ds_read2_b32 v[56:57], v38 offset0:64 offset1:72
    ds_read2_b32 v[58:59], v38 offset0:80 offset1:88
    ds_read2_b32 v[60:61], v38 offset0:96 offset1:104
    ds_read2_b32 v[62:63], v38 offset0:112 offset1:120
    ds_read2_b32 v[64:65], v38 offset0:128 offset1:136
    v_add_f32 v42, v44, v45
    v_add_f32 v39, v46, v47
    v_mul_f32 v43, v44, v44
    v_add_f32 v42, v42, v39
    v_fma_f32 v43, v45, v45, v43
    v_fma_f32 v43, v46, v46, v43
    v_fma_f32 v43, v47, v47, v43
    v_add_f32_dpp v42, v42, v42 row_ror:8 row_mask:0xf bank_mask:0xf
    s_nop 0
    v_add_f32_dpp v43, v43, v43 row_ror:8 row_mask:0xf bank_mask:0xf
    v_add_f32_dpp v42, v42, v42 row_ror:4 row_mask:0xf bank_mask:0xf
    s_nop 0
    v_add_f32_dpp v43, v43, v43 row_ror:4 row_mask:0xf bank_mask:0xf
    v_add_f32_dpp v42, v42, v42 row_ror:2 row_mask:0xf bank_mask:0xf
    s_nop 0
    v_add_f32_dpp v43, v43, v43 row_ror:2 row_mask:0xf bank_mask:0xf
    v_add_f32_dpp v42, v42, v42 row_ror:1 row_mask:0xf bank_mask:0xf
    s_nop 0
    v_add_f32_dpp v43, v43, v43 row_ror:1 row_mask:0xf bank_mask:0xf
    v_mov_b32 v36, v42
    v_mov_b32 v37, v43
    s_nop 0
    v_permlane16_swap_b32 v42, v36
    v_permlane16_swap_b32 v43, v37
    v_add_f32 v42, v42, v36
    v_add_f32 v43, v43, v37
    v_mov_b32 v36, v42
    v_mov_b32 v37, v43
    s_nop 0
    v_permlane32_swap_b32 v42, v36
    v_permlane32_swap_b32 v43, v37
    v_add_f32 v42, v42, v36
    v_add_f32 v43, v43, v37
    s_lshl_b32 s60, s3, 3
    s_add_u32 s60, s60, 162560
    v_mov_b32 v39, s60
    s_mov_b64 exec, 1
    ds_write_b64 v39, v[42:43]
    s_mov_b64 exec, -1
    v_lshrrev_b32 v40, 5, v0
    v_lshlrev_b32 v40, 8, v40
    v_bfe_u32 v39, v0, 4, 1
    v_lshl_add_u32 v40, v39, 7, v40
    v_and_b32 v39, 7, v0
    v_lshl_add_u32 v40, v39, 2, v40
    s_lshl_b32 s60, s3, 9
    s_add_u32 s60, s60, 156160
    v_add_u32 v40, s60, v40
    s_waitcnt lgkmcnt(9)
    v_and_b32 v24, v48, v13
    v_and_b32 v25, v48, v14
    v_and_b32 v26, v48, v15
    v_and_b32 v27, v48, v16
    s_nop 1
    v_mfma_f32_16x16x32_bf16 v[20:23], a[160:163], v[24:27], 0
    v_and_b32 v28, v49, v13
    v_and_b32 v29, v49, v14
    v_and_b32 v30, v49, v15
    v_and_b32 v31, v49, v16
    s_nop 1
    v_mfma_f32_16x16x32_bf16 v[32:35], a[164:167], v[28:31], 0
    s_waitcnt lgkmcnt(8)
    v_and_b32 v24, v50, v13
    v_and_b32 v25, v50, v14
    v_and_b32 v26, v50, v15
    v_and_b32 v27, v50, v16
    s_nop 1
    v_mfma_f32_16x16x32_bf16 v[20:23], a[168:171], v[24:27], v[20:23]
    v_and_b32 v28, v51, v13
    v_and_b32 v29, v51, v14
    v_and_b32 v30, v51, v15
    v_and_b32 v31, v51, v16
    s_nop 1
    v_mfma_f32_16x16x32_bf16 v[32:35], a[172:175], v[28:31], v[32:35]
    s_waitcnt lgkmcnt(7)
    v_and_b32 v24, v52, v13
    v_and_b32 v25, v52, v14
    v_and_b32 v26, v52, v15
    v_and_b32 v27, v52, v16
    s_nop 1
    v_mfma_f32_16x16x32_bf16 v[20:23], a[176:179], v[24:27], v[20:23]
    v_and_b32 v28, v53, v13
    v_and_b32 v29, v53, v14
    v_and_b32 v30, v53, v15
    v_and_b32 v31, v53, v16
    s_nop 1
    v_mfma_f32_16x16x32_bf16 v[32:35], a[180:183], v[28:31], v[32:35]
    s_waitcnt lgkmcnt(6)
    v_and_b32 v24, v54, v13
    v_and_b32 v25, v54, v14
    v_and_b32 v26, v54, v15
    v_and_b32 v27, v54, v16
    s_nop 1
    v_mfma_f32_16x16x32_bf16 v[20:23], a[184:187], v[24:27], v[20:23]
    v_and_b32 v28, v55, v13
    v_and_b32 v29, v55, v14
    v_and_b32 v30, v55, v15
    v_and_b32 v31, v55, v16
    s_nop 1
    v_mfma_f32_16x16x32_bf16 v[32:35], a[188:191], v[28:31], v[32:35]
    s_waitcnt lgkmcnt(0)
    s_barrier
    v_mov_b32 v39, 162560
    ds_read_b128 v[68:71], v39
    ds_read_b128 v[72:75], v39 offset:16
    v_and_b32 v24, v56, v13
    v_and_b32 v25, v56, v14
    v_and_b32 v26, v56, v15
    v_and_b32 v27, v56, v16
    s_nop 1
    v_mfma_f32_16x16x32_bf16 v[20:23], a[192:195], v[24:27], v[20:23]
    v_and_b32 v28, v57, v13
    v_and_b32 v29, v57, v14
    v_and_b32 v30, v57, v15
    v_and_b32 v31, v57, v16
    s_nop 1
    v_mfma_f32_16x16x32_bf16 v[32:35], a[196:199], v[28:31], v[32:35]
    v_and_b32 v24, v58, v13
    v_and_b32 v25, v58, v14
    v_and_b32 v26, v58, v15
    v_and_b32 v27, v58, v16
    s_nop 1
    v_mfma_f32_16x16x32_bf16 v[20:23], a[200:203], v[24:27], v[20:23]
    s_waitcnt lgkmcnt(0)
    v_and_b32 v28, v59, v13
    v_and_b32 v29, v59, v14
    v_and_b32 v30, v59, v15
    v_and_b32 v31, v59, v16
    s_nop 1
    v_mfma_f32_16x16x32_bf16 v[32:35], a[204:207], v[28:31], v[32:35]
    v_add_f32 v68, v68, v70
    v_add_f32 v69, v69, v71
    v_add_f32 v72, v72, v74
    v_and_b32 v24, v60, v13
    v_and_b32 v25, v60, v14
    v_and_b32 v26, v60, v15
    v_and_b32 v27, v60, v16
    s_nop 1
    v_mfma_f32_16x16x32_bf16 v[20:23], a[208:211], v[24:27], v[20:23]
    v_add_f32 v73, v73, v75
    v_add_f32 v42, v68, v72
    v_add_f32 v43, v69, v73
    v_and_b32 v28, v61, v13
    v_and_b32 v29, v61, v14
    v_and_b32 v30, v61, v15
    v_and_b32 v31, v61, v16
    s_nop 1
    v_mfma_f32_16x16x32_bf16 v[32:35], a[212:215], v[28:31], v[32:35]
    v_mul_f32 v42, 0x3ae38e39, v42
    v_mul_f32 v43, 0x3ae38e39, v43
    v_fma_f32 v43, -v42, v42, v43
    v_and_b32 v24, v62, v13
    v_and_b32 v25, v62, v14
    v_and_b32 v26, v62, v15
    v_and_b32 v27, v62, v16
    s_nop 1
    v_mfma_f32_16x16x32_bf16 v[20:23], a[216:219], v[24:27], v[20:23]
    v_max_f32 v43, 0, v43
    v_cvt_pk_bf16_f32 v39, v42, v43
    v_lshlrev_b32 v42, 16, v39
    v_and_b32 v28, v63, v13
    v_and_b32 v29, v63, v14
    v_and_b32 v30, v63, v15
    v_and_b32 v31, v63, v16
    s_nop 1
    v_mfma_f32_16x16x32_bf16 v[32:35], a[220:223], v[28:31], v[32:35]
    v_and_b32 v43, 0xffff0000, v39
    v_add_f32 v43, 0x3727c5ac, v43
    v_cvt_pk_bf16_f32 v43, v43, v43
    v_and_b32 v24, v64, v13
    v_and_b32 v25, v64, v14
    v_and_b32 v26, v64, v15
    v_and_b32 v27, v64, v16
    s_nop 1
    v_mfma_f32_16x16x32_bf16 v[20:23], a[224:227], v[24:27], v[20:23]
    v_and_b32 v43, 0xffff0000, v43
    v_sqrt_f32 v43, v43
    s_nop 0
    v_cvt_pk_bf16_f32 v43, v43, v43
    v_and_b32 v28, v65, v13
    v_and_b32 v29, v65, v14
    v_and_b32 v30, v65, v15
    v_and_b32 v31, v65, v16
    s_nop 1
    v_mfma_f32_16x16x32_bf16 v[32:35], a[228:231], v[28:31], v[32:35]
    v_and_b32 v43, 0xffff0000, v43
    v_rcp_f32 v43, v43
    s_nop 5
    v_add_f32 v20, v20, v32
    v_add_f32 v21, v21, v33
    v_add_f32 v22, v22, v34
    v_add_f32 v23, v23, v35
    s_mov_b64 exec, s[68:69]
    ds_write_b32 v40, v20 offset:0
    ds_write_b32 v40, v21 offset:32
    ds_write_b32 v40, v22 offset:64
    ds_write_b32 v40, v23 offset:96
    s_mov_b64 exec, -1
    s_waitcnt lgkmcnt(0)
    s_barrier
    v_lshlrev_b32 v41, 4, v0
    v_add_u32 v41, s59, v41
    v_bfe_u32 v38, v0, 3, 1
    v_lshlrev_b32 v38, 5, v38
    v_lshrrev_b32 v39, 4, v0
    v_lshl_add_u32 v38, v39, 3, v38
    v_and_b32 v39, 7, v0
    v_add_u32 v38, v38, v39
    v_lshlrev_b32 v38, 2, v38
    v_add_u32 v38, 156160, v38
    ds_read2st64_b32 v[48:49], v38 offset0:0 offset1:1
    ds_read2st64_b32 v[50:51], v38 offset0:2 offset1:3
    ds_read2st64_b32 v[52:53], v38 offset0:4 offset1:5
    ds_read2st64_b32 v[54:55], v38 offset0:6 offset1:7
    ds_read_b32 v40, v38 offset:6144
    ds_read_b128 v[64:67], v41 offset:28672
    ds_read_b128 v[68:71], v41 offset:29696
    ds_read_b128 v[72:75], v41 offset:30720
    ds_read_b128 v[76:79], v41 offset:31744
    s_waitcnt lgkmcnt(4)
    v_add_f32 v48, v48, v49
    v_add_f32 v50, v50, v51
    v_add_f32 v52, v52, v53
    v_add_f32 v54, v54, v55
    v_add_f32 v48, v48, v50
    v_add_f32 v52, v52, v54
    v_add_f32 v36, v48, v52
    v_fma_f32 v36, -v42, v40, v36
    v_mul_f32 v36, v43, v36
    v_cvt_pk_bf16_f32 v36, v36, v36
    v_and_b32 v36, 0xffff0000, v36
    s_nop 1
    v_mov_b32_dpp v37, v36 row_ror:8 row_mask:0xf bank_mask:0xf
    v_cndmask_b32 v24, v37, v36, s[66:67]
    v_cndmask_b32 v25, v36, v37, s[66:67]
    v_mul_f32 v26, v24, v24
    v_mov_b32 v27, 0x3f4c422a
    v_mul_f32 v26, 0x3d122279, v26
    v_add_f32 v26, v26, v27
    v_mul_f32 v26, v26, v24
    v_mul_f32 v26, 0xc038aa3b, v26
    v_exp_f32 v26, v26
    s_nop 0
    v_add_f32 v26, 1.0, v26
    v_rcp_f32 v26, v26
    s_nop 0
    v_mul_f32 v26, v26, v24
    v_cvt_pk_bf16_f32 v26, v26, v26
    v_and_b32 v26, 0xffff0000, v26
    v_mul_f32 v26, v26, v25
    v_cvt_pk_bf16_f32 v32, v26, v26
    s_nop 1
    v_and_b32_dpp v48, v32, v13 row_newbcast:0 row_mask:0xf bank_mask:0xf
    v_and_b32_dpp v49, v32, v14 row_newbcast:0 row_mask:0xf bank_mask:0xf
    v_and_b32_dpp v50, v32, v15 row_newbcast:0 row_mask:0xf bank_mask:0xf
    v_and_b32_dpp v51, v32, v16 row_newbcast:0 row_mask:0xf bank_mask:0xf
    s_waitcnt lgkmcnt(3)
    s_nop 0
    v_mfma_f32_16x16x32_bf16 v[20:23], v[48:51], v[64:67], 0
    s_nop 3
    ds_read_b128 v[64:67], v41 offset:32768
    v_and_b32_dpp v52, v32, v13 row_newbcast:1 row_mask:0xf bank_mask:0xf
    v_and_b32_dpp v53, v32, v14 row_newbcast:1 row_mask:0xf bank_mask:0xf
    v_and_b32_dpp v54, v32, v15 row_newbcast:1 row_mask:0xf bank_mask:0xf
    v_and_b32_dpp v55, v32, v16 row_newbcast:1 row_mask:0xf bank_mask:0xf
    s_waitcnt lgkmcnt(3)
    s_nop 0
    v_mfma_f32_16x16x32_bf16 v[20:23], v[52:55], v[68:71], v[20:23]
    s_nop 3
    ds_read_b128 v[68:71], v41 offset:33792
    v_and_b32_dpp v56, v32, v13 row_newbcast:2 row_mask:0xf bank_mask:0xf
    v_and_b32_dpp v57, v32, v14 row_newbcast:2 row_mask:0xf bank_mask:0xf
    v_and_b32_dpp v58, v32, v15 row_newbcast:2 row_mask:0xf bank_mask:0xf
    v_and_b32_dpp v59, v32, v16 row_newbcast:2 row_mask:0xf bank_mask:0xf
    s_waitcnt lgkmcnt(3)
    s_nop 0
    v_mfma_f32_16x16x32_bf16 v[20:23], v[56:59], v[72:75], v[20:23]
    s_nop 3
    ds_read_b128 v[72:75], v41 offset:34816
    v_and_b32_dpp v60, v32, v13 row_newbcast:3 row_mask:0xf bank_mask:0xf
    v_and_b32_dpp v61, v32, v14 row_newbcast:3 row_mask:0xf bank_mask:0xf
    v_and_b32_dpp v62, v32, v15 row_newbcast:3 row_mask:0xf bank_mask:0xf
    v_and_b32_dpp v63, v32, v16 row_newbcast:3 row_mask:0xf bank_mask:0xf
    s_waitcnt lgkmcnt(3)
    s_nop 0
    v_mfma_f32_16x16x32_bf16 v[20:23], v[60:63], v[76:79], v[20:23]
    s_nop 3
    ds_read_b128 v[76:79], v41 offset:35840
    v_and_b32_dpp v48, v32, v13 row_newbcast:4 row_mask:0xf bank_mask:0xf
    v_and_b32_dpp v49, v32, v14 row_newbcast:4 row_mask:0xf bank_mask:0xf
    v_and_b32_dpp v50, v32, v15 row_newbcast:4 row_mask:0xf bank_mask:0xf
    v_and_b32_dpp v51, v32, v16 row_newbcast:4 row_mask:0xf bank_mask:0xf
    s_waitcnt lgkmcnt(3)
    s_nop 0
    v_mfma_f32_16x16x32_bf16 v[20:23], v[48:51], v[64:67], v[20:23]
    v_and_b32_dpp v52, v32, v13 row_newbcast:5 row_mask:0xf bank_mask:0xf
    v_and_b32_dpp v53, v32, v14 row_newbcast:5 row_mask:0xf bank_mask:0xf
    v_and_b32_dpp v54, v32, v15 row_newbcast:5 row_mask:0xf bank_mask:0xf
    v_and_b32_dpp v55, v32, v16 row_newbcast:5 row_mask:0xf bank_mask:0xf
    s_waitcnt lgkmcnt(2)
    s_nop 0
    v_mfma_f32_16x16x32_bf16 v[20:23], v[52:55], v[68:71], v[20:23]
    v_and_b32_dpp v56, v32, v13 row_newbcast:6 row_mask:0xf bank_mask:0xf
    v_and_b32_dpp v57, v32, v14 row_newbcast:6 row_mask:0xf bank_mask:0xf
    v_and_b32_dpp v58, v32, v15 row_newbcast:6 row_mask:0xf bank_mask:0xf
    v_and_b32_dpp v59, v32, v16 row_newbcast:6 row_mask:0xf bank_mask:0xf
    s_waitcnt lgkmcnt(1)
    s_nop 0
    v_mfma_f32_16x16x32_bf16 v[20:23], v[56:59], v[72:75], v[20:23]
    v_and_b32_dpp v60, v32, v13 row_newbcast:7 row_mask:0xf bank_mask:0xf
    v_and_b32_dpp v61, v32, v14 row_newbcast:7 row_mask:0xf bank_mask:0xf
    v_and_b32_dpp v62, v32, v15 row_newbcast:7 row_mask:0xf bank_mask:0xf
    v_and_b32_dpp v63, v32, v16 row_newbcast:7 row_mask:0xf bank_mask:0xf
    s_waitcnt lgkmcnt(0)
    s_nop 0
    v_mfma_f32_16x16x32_bf16 v[20:23], v[60:63], v[76:79], v[20:23]
    s_cmp_eq_u32 s3, 3
    s_cbranch_scc0 DB_262
    v_mov_b32_dpp v24, v32 row_newbcast:0 row_mask:0xf bank_mask:0x3
    s_nop 1
    v_mov_b32_dpp v24, v32 row_newbcast:1 row_mask:0xf bank_mask:0xc
    v_and_b32 v48, v24, v13
    v_and_b32 v49, v24, v14
    v_and_b32 v50, v24, v15
    v_and_b32 v51, v24, v16
    s_nop 1
    v_mfma_f32_16x16x32_bf16 v[38:41], v[48:51], a[232:235], 0
    v_mov_b32_dpp v24, v32 row_newbcast:2 row_mask:0xf bank_mask:0x3
    s_nop 1
    v_mov_b32_dpp v24, v32 row_newbcast:3 row_mask:0xf bank_mask:0xc
    v_and_b32 v52, v24, v13
    v_and_b32 v53, v24, v14
    v_and_b32 v54, v24, v15
    v_and_b32 v55, v24, v16
    s_nop 1
    v_mfma_f32_16x16x32_bf16 v[38:41], v[52:55], a[236:239], v[38:41]
    v_mov_b32_dpp v24, v32 row_newbcast:4 row_mask:0xf bank_mask:0x3
    s_nop 1
    v_mov_b32_dpp v24, v32 row_newbcast:5 row_mask:0xf bank_mask:0xc
    v_and_b32 v56, v24, v13
    v_and_b32 v57, v24, v14
    v_and_b32 v58, v24, v15
    v_and_b32 v59, v24, v16
    s_nop 1
    v_mfma_f32_16x16x32_bf16 v[38:41], v[56:59], a[240:243], v[38:41]
    v_mov_b32_dpp v24, v32 row_newbcast:6 row_mask:0xf bank_mask:0x3
    s_nop 1
    v_mov_b32_dpp v24, v32 row_newbcast:7 row_mask:0xf bank_mask:0xc
    v_and_b32 v60, v24, v13
    v_and_b32 v61, v24, v14
    v_and_b32 v62, v24, v15
    v_and_b32 v63, v24, v16
    s_nop 1
    v_mfma_f32_16x16x32_bf16 v[38:41], v[60:63], a[244:247], v[38:41]
    s_nop 7
    v_mov_b32_dpp v28, v38 row_ror:8 row_mask:0xf bank_mask:0xf
    v_mov_b32_dpp v29, v39 row_ror:8 row_mask:0xf bank_mask:0xf
    v_mov_b32_dpp v30, v40 row_ror:8 row_mask:0xf bank_mask:0xf
    v_mov_b32_dpp v31, v41 row_ror:8 row_mask:0xf bank_mask:0xf
    v_mov_b32 v48, v28
    v_mov_b32 v49, v29
    v_mov_b32 v50, v30
    v_mov_b32 v51, v31
    v_permlane32_swap_b32 v48, v28
    v_permlane32_swap_b32 v49, v29
    v_permlane32_swap_b32 v50, v30
    v_permlane32_swap_b32 v51, v31
    v_add_f32 v38, v38, v28
    v_add_f32 v39, v39, v29
    v_add_f32 v40, v40, v30
    v_add_f32 v41, v41, v31
    s_nop 7
    s_nop 1
DB_262:
    s_cmp_eq_u32 s86, 1
    s_cbranch_scc0 NS_263
    s_mov_b64 exec, 0xffffffff
    buffer_store_dwordx4 v[20:23], v1, s[32:35], s92 offen
    s_cmp_eq_u32 s3, 3
    s_cbranch_scc0 N3_265
    s_mov_b64 exec, 0x00ff00ff
    buffer_store_dwordx4 v[38:41], v1, s[32:35], s93 offen
N3_265:
    s_branch ND_264
NS_263:
    s_mov_b64 exec, 0xffffffff
    buffer_store_dwordx4 v[20:23], v1, s[32:35], s92 offen sc1
    s_cmp_eq_u32 s3, 3
    s_cbranch_scc0 N3_266
    s_mov_b64 exec, 0x00ff00ff
    buffer_store_dwordx4 v[38:41], v1, s[32:35], s93 offen sc1
N3_266:
ND_264:
    s_mov_b64 exec, -1
    s_cmp_lg_u32 s83, 0
    s_cbranch_scc1 FL_267
    s_barrier
    s_nop 7
    s_nop 1
    s_bitcmp1_b32 s95, 0
    s_cbranch_scc1 PFS_268
    s_add_u32 s76, s90, 0
    s_mul_i32 s54, s76, s85
    s_add_u32 s54, s54, s53
    s_add_u32 m0, s59, 0
    s_nop 0
    buffer_load_dwordx4 v4, s[4:7], s54 offen offset:0 nt lds
    buffer_load_dwordx4 v5, s[4:7], s54 offen offset:1024 nt lds
    buffer_load_dwordx4 v6, s[4:7], s54 offen offset:2048 nt lds
    buffer_load_dwordx4 v7, s[4:7], s54 offen offset:3072 nt lds
    buffer_load_dwordx4 a[0:3], v8, s[8:11], s54 offen offset:0 nt
    buffer_load_dwordx4 a[4:7], v8, s[8:11], s54 offen offset:256 nt
    buffer_load_dwordx4 a[8:11], v8, s[8:11], s54 offen offset:512 nt
    buffer_load_dwordx4 a[12:15], v8, s[8:11], s54 offen offset:768 nt
    s_bitset1_b32 s95, 0
    s_nop 7
    s_nop 1
PFS_268:
    s_bitcmp1_b32 s95, 1
    s_cbranch_scc1 PFS_269
    s_add_u32 s77, s90, 16
    s_mul_i32 s54, s77, s85
    s_add_u32 s54, s54, s53
    s_add_u32 m0, s59, 4096
    s_nop 0
    buffer_load_dwordx4 v4, s[4:7], s54 offen offset:0 nt lds
    buffer_load_dwordx4 v5, s[4:7], s54 offen offset:1024 nt lds
    buffer_load_dwordx4 v6, s[4:7], s54 offen offset:2048 nt lds
    buffer_load_dwordx4 v7, s[4:7], s54 offen offset:3072 nt lds
    buffer_load_dwordx4 a[16:19], v8, s[8:11], s54 offen offset:0 nt
    buffer_load_dwordx4 a[20:23], v8, s[8:11], s54 offen offset:256 nt
    buffer_load_dwordx4 a[24:27], v8, s[8:11], s54 offen offset:512 nt
    buffer_load_dwordx4 a[28:31], v8, s[8:11], s54 offen offset:768 nt
    s_bitset1_b32 s95, 1
    s_nop 7
    s_nop 1
PFS_269:
    v_lshlrev_b32 v2, 7, v0
    s_mov_b64 exec, 0xffffffff
    s_add_u32 s60, s90, 32
    s_mul_i32 s60, s60, s85
    s_add_u32 s60, s60, s53
    buffer_load_dword v1, v2, s[4:7], s60 offen offset:0
    buffer_load_dword v1, v2, s[8:11], s60 offen offset:0
    s_add_u32 s60, s90, 48
    s_mul_i32 s60, s60, s85
    s_add_u32 s60, s60, s53
    buffer_load_dword v1, v2, s[4:7], s60 offen offset:0
    buffer_load_dword v1, v2, s[8:11], s60 offen offset:0
    s_add_u32 s60, s90, 64
    s_mul_i32 s60, s60, s85
    s_add_u32 s60, s60, s53
    buffer_load_dword v1, v2, s[4:7], s60 offen offset:0
    buffer_load_dword v1, v2, s[8:11], s60 offen offset:0
    s_mov_b64 exec, -1
    s_branch GG_256
FL_267:
    s_nop 7
    s_nop 1
    s_branch L_exit
    s_cmp_lg_u32 s63, 0
    s_cbranch_scc1 L_exit
    v_lshlrev_b32 v38, 4, v0
    s_mul_i32 s60, s3, 576
    s_add_u32 s60, s60, 1310720
    s_add_u32 s60, s60, s82
    s_add_u32 s61, s60, 4608
    s_add_u32 s62, s60, 9216
    s_add_u32 s54, s60, 13824
    s_mov_b32 exec_lo, -1
    s_mov_b32 exec_hi, 0xf
    s_nop 7
    s_nop 1
    s_mov_b32 s64, 200000
PL_270:
    buffer_load_dwordx4 v[48:51], v38, s[32:35], s60 offen offset:0 sc1
    buffer_load_dwordx4 v[52:55], v38, s[32:35], s60 offen offset:2304 sc1
    buffer_load_dwordx4 v[56:59], v38, s[32:35], s61 offen offset:0 sc1
    buffer_load_dwordx4 v[60:63], v38, s[32:35], s61 offen offset:2304 sc1
    buffer_load_dwordx4 v[64:67], v38, s[32:35], s62 offen offset:0 sc1
    buffer_load_dwordx4 v[68:71], v38, s[32:35], s62 offen offset:2304 sc1
    buffer_load_dwordx4 v[72:75], v38, s[32:35], s54 offen offset:0 sc1
    buffer_load_dwordx4 v[76:79], v38, s[32:35], s54 offen offset:2304 sc1
    s_waitcnt vmcnt(0)
    v_max3_u32 v36, v48, v49, v50
    v_max3_u32 v36, v36, v51, v52
    v_max3_u32 v36, v36, v53, v54
    v_max3_u32 v36, v36, v55, v56
    v_max3_u32 v36, v36, v57, v58
    v_max3_u32 v36, v36, v59, v60
    v_max3_u32 v36, v36, v61, v62
    v_max3_u32 v36, v36, v63, v64
    v_max3_u32 v36, v36, v65, v66
    v_max3_u32 v36, v36, v67, v68
    v_max3_u32 v36, v36, v69, v70
    v_max3_u32 v36, v36, v71, v72
    v_max3_u32 v36, v36, v73, v74
    v_max3_u32 v36, v36, v75, v76
    v_max3_u32 v36, v36, v77, v78
    v_max_u32 v36, v36, v79
    v_cmp_eq_u32 vcc, -1, v36
    s_cbranch_vccz PD_271
    s_sub_u32 s64, s64, 1
    s_cmp_lg_u32 s64, 0
    s_cbranch_scc1 PL_270
PD_271:
    v_add_f32 v48, v48, v52
    v_add_f32 v49, v49, v53
    v_add_f32 v50, v50, v54
    v_add_f32 v51, v51, v55
    v_add_f32 v56, v56, v60
    v_add_f32 v57, v57, v61
    v_add_f32 v58, v58, v62
    v_add_f32 v59, v59, v63
    v_add_f32 v64, v64, v68
    v_add_f32 v65, v65, v69
    v_add_f32 v66, v66, v70
    v_add_f32 v67, v67, v71
    v_add_f32 v72, v72, v76
    v_add_f32 v73, v73, v77
    v_add_f32 v74, v74, v78
    v_add_f32 v75, v75, v79
    v_add_f32 v48, v48, v56
    v_add_f32 v49, v49, v57
    v_add_f32 v50, v50, v58
    v_add_f32 v51, v51, v59
    v_add_f32 v64, v64, v72
    v_add_f32 v65, v65, v73
    v_add_f32 v66, v66, v74
    v_add_f32 v67, v67, v75
    v_add_f32 v48, v48, v64
    v_add_f32 v49, v49, v65
    v_add_f32 v50, v50, v66
    v_add_f32 v51, v51, v67
    v_cvt_pk_bf16_f32 v24, v48, v49
    v_cvt_pk_bf16_f32 v25, v50, v51
    v_lshlrev_b32 v28, 16, v24
    v_and_b32 v29, 0xffff0000, v24
    v_lshlrev_b32 v30, 16, v25
    v_and_b32 v31, 0xffff0000, v25
    v_add_f32 v28, v28, v44
    v_add_f32 v29, v29, v45
    v_add_f32 v30, v30, v46
    v_add_f32 v31, v31, v47
    v_cvt_pk_bf16_f32 v24, v28, v29
    v_cvt_pk_bf16_f32 v25, v30, v31
    v_lshlrev_b32 v44, 16, v24
    v_and_b32 v45, 0xffff0000, v24
    v_lshlrev_b32 v46, 16, v25
    v_and_b32 v47, 0xffff0000, v25
    s_mov_b64 exec, -1
    v_lshlrev_b32 v38, 3, v0
    s_mul_i32 s60, s3, 288
    s_mov_b32 exec_lo, -1
    s_mov_b32 exec_hi, 0xf
    buffer_store_dwordx2 v[24:25], v38, s[44:47], s60 offen
    s_mov_b64 exec, -1
    s_branch L_exit
RED_254:
    s_nop 7
    s_nop 1
    s_cmp_eq_u32 s3, 3
    s_cbranch_scc1 R3_272
    v_lshlrev_b32 v38, 4, v0
    s_mul_i32 s62, s3, 6
    s_add_u32 s62, s62, s63
    s_mul_i32 s60, s88, 18
    s_add_u32 s60, s60, s62
    s_mul_i32 s60, s60, 4096
    s_add_u32 s60, s60, 0
    s_add_u32 s60, s60, s82
    s_mul_i32 s61, s88, 2304
    s_lshl_b32 s62, s62, 7
    s_add_u32 s61, s61, s62
    s_add_u32 s61, s61, 1245184
    s_add_u32 s61, s61, s82
    s_nop 7
    s_nop 1
    s_mov_b32 s64, 200000
PL_273:
    buffer_load_dwordx4 v[48:51], v38, s[32:35], s60 offen offset:0 sc1
    buffer_load_dwordx4 v[52:55], v38, s[32:35], s60 offen offset:1024 sc1
    buffer_load_dwordx4 v[56:59], v38, s[32:35], s60 offen offset:2048 sc1
    buffer_load_dwordx4 v[60:63], v38, s[32:35], s60 offen offset:3072 sc1
    s_waitcnt vmcnt(0)
    v_max3_u32 v36, v48, v49, v50
    v_max3_u32 v36, v36, v51, v52
    v_max3_u32 v36, v36, v53, v54
    v_max3_u32 v36, v36, v55, v56
    v_max3_u32 v36, v36, v57, v58
    v_max3_u32 v36, v36, v59, v60
    v_max3_u32 v36, v36, v61, v62
    v_max_u32 v36, v36, v63
    v_cmp_eq_u32 vcc, -1, v36
    s_cbranch_vccz PD_274
    s_sub_u32 s64, s64, 1
    s_cmp_lg_u32 s64, 0
    s_cbranch_scc1 PL_273
PD_274:
    v_add_f32 v48, v48, v52
    v_add_f32 v49, v49, v53
    v_add_f32 v50, v50, v54
    v_add_f32 v51, v51, v55
    v_add_f32 v56, v56, v60
    v_add_f32 v57, v57, v61
    v_add_f32 v58, v58, v62
    v_add_f32 v59, v59, v63
    v_add_f32 v48, v48, v56
    v_add_f32 v49, v49, v57
    v_add_f32 v50, v50, v58
    v_add_f32 v51, v51, v59
    v_add_f32_dpp v48, v48, v48 row_ror:8 row_mask:0xf bank_mask:0xf
    v_add_f32_dpp v49, v49, v49 row_ror:8 row_mask:0xf bank_mask:0xf
    v_add_f32_dpp v50, v50, v50 row_ror:8 row_mask:0xf bank_mask:0xf
    v_add_f32_dpp v51, v51, v51 row_ror:8 row_mask:0xf bank_mask:0xf
    v_mov_b32 v64, v48
    v_mov_b32 v65, v49
    v_mov_b32 v66, v50
    v_mov_b32 v67, v51
    v_permlane16_swap_b32 v48, v64
    v_permlane16_swap_b32 v49, v65
    v_permlane16_swap_b32 v50, v66
    v_permlane16_swap_b32 v51, v67
    v_add_f32 v48, v48, v64
    v_add_f32 v49, v49, v65
    v_add_f32 v50, v50, v66
    v_add_f32 v51, v51, v67
    v_mov_b32 v64, v48
    v_mov_b32 v65, v49
    v_mov_b32 v66, v50
    v_mov_b32 v67, v51
    v_permlane32_swap_b32 v48, v64
    v_permlane32_swap_b32 v49, v65
    v_permlane32_swap_b32 v50, v66
    v_permlane32_swap_b32 v51, v67
    v_add_f32 v48, v48, v64
    v_add_f32 v49, v49, v65
    v_add_f32 v50, v50, v66
    v_add_f32 v51, v51, v67
    s_nop 7
    s_nop 1
R3_272:
    s_barrier
    s_cmp_eq_u32 s3, 3
    s_cbranch_scc1 R3_275
    s_mov_b64 exec, 0xff
    buffer_store_dwordx4 v[48:51], v38, s[32:35], s61 offen sc1
    s_mov_b64 exec, -1
    v_lshrrev_b32 v39, 3, v0
    v_mul_u32_u24 v39, 2304, v39
    v_and_b32 v36, 7, v0
    v_lshl_add_u32 v39, v36, 4, v39
    s_mul_i32 s62, s3, 6
    s_add_u32 s62, s62, s63
    s_lshl_b32 s62, s62, 7
    s_add_u32 s60, s62, 1245184
    s_add_u32 s60, s60, s82
    s_mul_i32 s61, s88, 2304
    s_add_u32 s61, s61, s62
    s_add_u32 s61, s61, 1331200
    s_add_u32 s61, s61, s82
    s_lshl_b32 s62, s88, 3
    s_lshl_b64 s[0:1], 0xff, s62
    s_not_b64 exec, s[0:1]
    s_nop 7
    s_nop 1
    s_mov_b32 s64, 200000
    buffer_load_dwordx4 v[48:51], v39, s[32:35], s60 offen sc1
    buffer_load_dwordx4 v[48:51], v39, s[32:35], s60 offen sc1
    buffer_load_dwordx4 v[48:51], v39, s[32:35], s60 offen sc1
PL_276:
    buffer_load_dwordx4 v[48:51], v39, s[32:35], s60 offen sc1
    s_waitcnt vmcnt(3)
    v_max3_u32 v36, v48, v49, v50
    v_max_u32 v36, v36, v51
    v_cmp_eq_u32 vcc, -1, v36
    s_cbranch_vccz PD_277
    s_sub_u32 s64, s64, 1
    s_cmp_lg_u32 s64, 0
    s_cbranch_scc1 PL_276
PD_277:
    s_mov_b64 exec, -1
    v_add_f32_dpp v20, v48, v48 row_ror:8 row_mask:0xf bank_mask:0xf
    v_add_f32_dpp v21, v49, v49 row_ror:8 row_mask:0xf bank_mask:0xf
    v_add_f32_dpp v22, v50, v50 row_ror:8 row_mask:0xf bank_mask:0xf
    v_add_f32_dpp v23, v51, v51 row_ror:8 row_mask:0xf bank_mask:0xf
    v_mov_b32 v64, v20
    v_mov_b32 v65, v21
    v_mov_b32 v66, v22
    v_mov_b32 v67, v23
    v_permlane16_swap_b32 v20, v64
    v_permlane16_swap_b32 v21, v65
    v_permlane16_swap_b32 v22, v66
    v_permlane16_swap_b32 v23, v67
    v_add_f32 v20, v20, v64
    v_add_f32 v21, v21, v65
    v_add_f32 v22, v22, v66
    v_add_f32 v23, v23, v67
    v_mov_b32 v64, v20
    v_mov_b32 v65, v21
    v_mov_b32 v66, v22
    v_mov_b32 v67, v23
    v_permlane32_swap_b32 v20, v64
    v_permlane32_swap_b32 v21, v65
    v_permlane32_swap_b32 v22, v66
    v_permlane32_swap_b32 v23, v67
    v_add_f32 v20, v20, v64
    v_add_f32 v21, v21, v65
    v_add_f32 v22, v22, v66
    v_add_f32 v23, v23, v67
    v_cvt_pk_bf16_f32 v24, v20, v21
    v_cvt_pk_bf16_f32 v25, v22, v23
    v_lshlrev_b32 v28, 16, v24
    v_and_b32 v29, 0xffff0000, v24
    v_lshlrev_b32 v30, 16, v25
    v_and_b32 v31, 0xffff0000, v25
    v_add_f32 v28, v28, v44
    v_add_f32 v29, v29, v45
    v_add_f32 v30, v30, v46
    v_add_f32 v31, v31, v47
    v_cvt_pk_bf16_f32 v24, v28, v29
    v_cvt_pk_bf16_f32 v25, v30, v31
    v_lshlrev_b32 v44, 16, v24
    v_and_b32 v45, 0xffff0000, v24
    v_lshlrev_b32 v46, 16, v25
    v_and_b32 v47, 0xffff0000, v25
    s_mul_i32 s62, s3, 6
    s_add_u32 s62, s62, s63
    s_lshl_b32 s62, s62, 7
    s_mov_b64 exec, 0xff
    s_cmp_eq_u32 s86, 1
    s_cbranch_scc0 RS_279
    buffer_store_dwordx4 v[44:47], v39, s[32:35], s61 offen
    s_branch RD_278
RS_279:
    buffer_store_dwordx4 v[44:47], v39, s[32:35], s61 offen sc1
RD_278:
    s_mov_b64 exec, -1
R3_275:
    s_nop 7
    s_nop 1
    s_cmp_lg_u32 s83, 0
    s_cbranch_scc1 R4_280
    s_barrier
    s_nop 7
    s_nop 1
    s_bitcmp1_b32 s95, 0
    s_cbranch_scc1 PFS_281
    s_add_u32 s76, s90, 0
    s_mul_i32 s54, s76, s85
    s_add_u32 s54, s54, s53
    s_add_u32 m0, s59, 0
    s_nop 0
    buffer_load_dwordx4 v4, s[4:7], s54 offen offset:0 nt lds
    buffer_load_dwordx4 v5, s[4:7], s54 offen offset:1024 nt lds
    buffer_load_dwordx4 v6, s[4:7], s54 offen offset:2048 nt lds
    buffer_load_dwordx4 v7, s[4:7], s54 offen offset:3072 nt lds
    buffer_load_dwordx4 a[0:3], v8, s[8:11], s54 offen offset:0 nt
    buffer_load_dwordx4 a[4:7], v8, s[8:11], s54 offen offset:256 nt
    buffer_load_dwordx4 a[8:11], v8, s[8:11], s54 offen offset:512 nt
    buffer_load_dwordx4 a[12:15], v8, s[8:11], s54 offen offset:768 nt
    s_bitset1_b32 s95, 0
    s_nop 7
    s_nop 1
PFS_281:
    s_bitcmp1_b32 s95, 1
    s_cbranch_scc1 PFS_282
    s_add_u32 s77, s90, 16
    s_mul_i32 s54, s77, s85
    s_add_u32 s54, s54, s53
    s_add_u32 m0, s59, 4096
    s_nop 0
    buffer_load_dwordx4 v4, s[4:7], s54 offen offset:0 nt lds
    buffer_load_dwordx4 v5, s[4:7], s54 offen offset:1024 nt lds
    buffer_load_dwordx4 v6, s[4:7], s54 offen offset:2048 nt lds
    buffer_load_dwordx4 v7, s[4:7], s54 offen offset:3072 nt lds
    buffer_load_dwordx4 a[16:19], v8, s[8:11], s54 offen offset:0 nt
    buffer_load_dwordx4 a[20:23], v8, s[8:11], s54 offen offset:256 nt
    buffer_load_dwordx4 a[24:27], v8, s[8:11], s54 offen offset:512 nt
    buffer_load_dwordx4 a[28:31], v8, s[8:11], s54 offen offset:768 nt
    s_bitset1_b32 s95, 1
    s_nop 7
    s_nop 1
PFS_282:
R4_280:
    s_nop 7
    s_nop 1
    s_cmp_eq_u32 s3, 3
    s_cbranch_scc1 R5_283
    v_lshlrev_b32 v38, 4, v0
    s_mul_i32 s62, s3, 6
    s_add_u32 s62, s62, s63
    s_mul_i32 s60, s88, 18
    s_add_u32 s60, s60, s62
    s_mul_i32 s60, s60, 2304
    s_add_u32 s60, s60, 589824
    s_add_u32 s60, s60, s82
    s_mul_i32 s61, s88, 2304
    s_lshl_b32 s62, s62, 7
    s_add_u32 s61, s61, s62
    s_add_u32 s61, s61, 1310720
    s_add_u32 s61, s61, s82
    v_mov_b32 v56, 0
    v_mov_b32 v57, 0
    v_mov_b32 v58, 0
    v_mov_b32 v59, 0
    s_nop 7
    s_nop 1
    s_mov_b32 s64, 200000
PL_284:
    buffer_load_dwordx4 v[48:51], v38, s[32:35], s60 offen offset:0 sc1
    buffer_load_dwordx4 v[52:55], v38, s[32:35], s60 offen offset:1024 sc1
    s_mov_b64 exec, 0xffff
    buffer_load_dwordx4 v[56:59], v38, s[32:35], s60 offen offset:2048 sc1
    s_mov_b64 exec, -1
    s_waitcnt vmcnt(0)
    v_max3_u32 v36, v48, v49, v50
    v_max3_u32 v36, v36, v51, v52
    v_max3_u32 v36, v36, v53, v54
    v_max3_u32 v36, v36, v55, v56
    v_max3_u32 v36, v36, v57, v58
    v_max_u32 v36, v36, v59
    v_cmp_eq_u32 vcc, -1, v36
    s_cbranch_vccz PD_285
    s_sub_u32 s64, s64, 1
    s_cmp_lg_u32 s64, 0
    s_cbranch_scc1 PL_284
PD_285:
    v_add_f32 v48, v48, v52
    v_add_f32 v49, v49, v53
    v_add_f32 v50, v50, v54
    v_add_f32 v51, v51, v55
    v_add_f32 v48, v48, v56
    v_add_f32 v49, v49, v57
    v_add_f32 v50, v50, v58
    v_add_f32 v51, v51, v59
    v_add_f32_dpp v48, v48, v48 row_ror:8 row_mask:0xf bank_mask:0xf
    v_add_f32_dpp v49, v49, v49 row_ror:8 row_mask:0xf bank_mask:0xf
    v_add_f32_dpp v50, v50, v50 row_ror:8 row_mask:0xf bank_mask:0xf
    v_add_f32_dpp v51, v51, v51 row_ror:8 row_mask:0xf bank_mask:0xf
    v_mov_b32 v64, v48
    v_mov_b32 v65, v49
    v_mov_b32 v66, v50
    v_mov_b32 v67, v51
    v_permlane16_swap_b32 v48, v64
    v_permlane16_swap_b32 v49, v65
    v_permlane16_swap_b32 v50, v66
    v_permlane16_swap_b32 v51, v67
    v_add_f32 v48, v48, v64
    v_add_f32 v49, v49, v65
    v_add_f32 v50, v50, v66
    v_add_f32 v51, v51, v67
    v_mov_b32 v64, v48
    v_mov_b32 v65, v49
    v_mov_b32 v66, v50
    v_mov_b32 v67, v51
    v_permlane32_swap_b32 v48, v64
    v_permlane32_swap_b32 v49, v65
    v_permlane32_swap_b32 v50, v66
    v_permlane32_swap_b32 v51, v67
    v_add_f32 v48, v48, v64
    v_add_f32 v49, v49, v65
    v_add_f32 v50, v50, v66
    v_add_f32 v51, v51, v67
    s_nop 7
    s_nop 1
R5_283:
    s_barrier
    s_cmp_eq_u32 s3, 3
    s_cbranch_scc1 R3_286
    s_mov_b64 exec, 0xff
    buffer_store_dwordx4 v[48:51], v38, s[32:35], s61 offen sc1
    s_mov_b64 exec, -1
    v_lshrrev_b32 v39, 3, v0
    v_mul_u32_u24 v39, 2304, v39
    v_and_b32 v36, 7, v0
    v_lshl_add_u32 v39, v36, 4, v39
    s_mul_i32 s62, s3, 6
    s_add_u32 s62, s62, s63
    s_lshl_b32 s62, s62, 7
    s_add_u32 s60, s62, 1310720
    s_add_u32 s60, s60, s82
    s_mul_i32 s61, s88, 2304
    s_add_u32 s61, s61, s62
    s_add_u32 s61, s61, 1351680
    s_add_u32 s61, s61, s82
    s_lshl_b32 s62, s88, 3
    s_lshl_b64 s[0:1], 0xff, s62
    s_not_b64 exec, s[0:1]
    s_nop 7
    s_nop 1
    s_mov_b32 s64, 200000
    buffer_load_dwordx4 v[48:51], v39, s[32:35], s60 offen sc1
    buffer_load_dwordx4 v[48:51], v39, s[32:35], s60 offen sc1
    buffer_load_dwordx4 v[48:51], v39, s[32:35], s60 offen sc1
PL_287:
    buffer_load_dwordx4 v[48:51], v39, s[32:35], s60 offen sc1
    s_waitcnt vmcnt(3)
    v_max3_u32 v36, v48, v49, v50
    v_max_u32 v36, v36, v51
    v_cmp_eq_u32 vcc, -1, v36
    s_cbranch_vccz PD_288
    s_sub_u32 s64, s64, 1
    s_cmp_lg_u32 s64, 0
    s_cbranch_scc1 PL_287
PD_288:
    s_mov_b64 exec, -1
    v_add_f32_dpp v20, v48, v48 row_ror:8 row_mask:0xf bank_mask:0xf
    v_add_f32_dpp v21, v49, v49 row_ror:8 row_mask:0xf bank_mask:0xf
    v_add_f32_dpp v22, v50, v50 row_ror:8 row_mask:0xf bank_mask:0xf
    v_add_f32_dpp v23, v51, v51 row_ror:8 row_mask:0xf bank_mask:0xf
    v_mov_b32 v64, v20
    v_mov_b32 v65, v21
    v_mov_b32 v66, v22
    v_mov_b32 v67, v23
    v_permlane16_swap_b32 v20, v64
    v_permlane16_swap_b32 v21, v65
    v_permlane16_swap_b32 v22, v66
    v_permlane16_swap_b32 v23, v67
    v_add_f32 v20, v20, v64
    v_add_f32 v21, v21, v65
    v_add_f32 v22, v22, v66
    v_add_f32 v23, v23, v67
    v_mov_b32 v64, v20
    v_mov_b32 v65, v21
    v_mov_b32 v66, v22
    v_mov_b32 v67, v23
    v_permlane32_swap_b32 v20, v64
    v_permlane32_swap_b32 v21, v65
    v_permlane32_swap_b32 v22, v66
    v_permlane32_swap_b32 v23, v67
    v_add_f32 v20, v20, v64
    v_add_f32 v21, v21, v65
    v_add_f32 v22, v22, v66
    v_add_f32 v23, v23, v67
    v_cvt_pk_bf16_f32 v24, v20, v21
    v_cvt_pk_bf16_f32 v25, v22, v23
    v_lshlrev_b32 v28, 16, v24
    v_and_b32 v29, 0xffff0000, v24
    v_lshlrev_b32 v30, 16, v25
    v_and_b32 v31, 0xffff0000, v25
    v_add_f32 v28, v28, v44
    v_add_f32 v29, v29, v45
    v_add_f32 v30, v30, v46
    v_add_f32 v31, v31, v47
    v_cvt_pk_bf16_f32 v24, v28, v29
    v_cvt_pk_bf16_f32 v25, v30, v31
    v_lshlrev_b32 v44, 16, v24
    v_and_b32 v45, 0xffff0000, v24
    v_lshlrev_b32 v46, 16, v25
    v_and_b32 v47, 0xffff0000, v25
    s_mul_i32 s62, s3, 6
    s_add_u32 s62, s62, s63
    s_lshl_b32 s62, s62, 7
    s_cmp_eq_u32 s83, 0
    s_cbranch_scc1 RL_290
    s_cmp_lg_u32 s88, 0
    s_cbranch_scc1 RD_289
    v_lshlrev_b32 v39, 3, v0
    s_lshr_b32 s62, s62, 1
    s_mov_b64 exec, 0xff
    buffer_store_dwordx2 v[24:25], v39, s[44:47], s62 offen
    s_branch RD_289
RL_290:
    s_mov_b64 exec, 0xff
    s_cmp_eq_u32 s86, 1
    s_cbranch_scc0 RS_291
    buffer_store_dwordx4 v[44:47], v39, s[32:35], s61 offen
    s_branch RD_289
RS_291:
    buffer_store_dwordx4 v[44:47], v39, s[32:35], s61 offen sc1
RD_289:
    s_mov_b64 exec, -1
R3_286:
    s_nop 7
    s_nop 1
    s_cmp_lg_u32 s83, 0
    s_cbranch_scc1 L_exit
    s_barrier
    s_nop 7
    s_nop 1
    s_bitcmp1_b32 s95, 0
    s_cbranch_scc1 PFS_292
    s_add_u32 s76, s90, 0
    s_mul_i32 s54, s76, s85
    s_add_u32 s54, s54, s53
    s_add_u32 m0, s59, 0
    s_nop 0
    buffer_load_dwordx4 v4, s[4:7], s54 offen offset:0 nt lds
    buffer_load_dwordx4 v5, s[4:7], s54 offen offset:1024 nt lds
    buffer_load_dwordx4 v6, s[4:7], s54 offen offset:2048 nt lds
    buffer_load_dwordx4 v7, s[4:7], s54 offen offset:3072 nt lds
    buffer_load_dwordx4 a[0:3], v8, s[8:11], s54 offen offset:0 nt
    buffer_load_dwordx4 a[4:7], v8, s[8:11], s54 offen offset:256 nt
    buffer_load_dwordx4 a[8:11], v8, s[8:11], s54 offen offset:512 nt
    buffer_load_dwordx4 a[12:15], v8, s[8:11], s54 offen offset:768 nt
    s_bitset1_b32 s95, 0
    s_nop 7
    s_nop 1
PFS_292:
    s_bitcmp1_b32 s95, 1
    s_cbranch_scc1 PFS_293
    s_add_u32 s77, s90, 16
    s_mul_i32 s54, s77, s85
    s_add_u32 s54, s54, s53
    s_add_u32 m0, s59, 4096
    s_nop 0
    buffer_load_dwordx4 v4, s[4:7], s54 offen offset:0 nt lds
    buffer_load_dwordx4 v5, s[4:7], s54 offen offset:1024 nt lds
    buffer_load_dwordx4 v6, s[4:7], s54 offen offset:2048 nt lds
    buffer_load_dwordx4 v7, s[4:7], s54 offen offset:3072 nt lds
    buffer_load_dwordx4 a[16:19], v8, s[8:11], s54 offen offset:0 nt
    buffer_load_dwordx4 a[20:23], v8, s[8:11], s54 offen offset:256 nt
    buffer_load_dwordx4 a[24:27], v8, s[8:11], s54 offen offset:512 nt
    buffer_load_dwordx4 a[28:31], v8, s[8:11], s54 offen offset:768 nt
    s_bitset1_b32 s95, 1
    s_nop 7
    s_nop 1
PFS_293:
    v_lshlrev_b32 v2, 7, v0
    s_mov_b64 exec, 0xffffffff
    s_add_u32 s60, s90, 32
    s_mul_i32 s60, s60, s85
    s_add_u32 s60, s60, s53
    buffer_load_dword v1, v2, s[4:7], s60 offen offset:0
    buffer_load_dword v1, v2, s[8:11], s60 offen offset:0
    s_add_u32 s60, s90, 48
    s_mul_i32 s60, s60, s85
    s_add_u32 s60, s60, s53
    buffer_load_dword v1, v2, s[4:7], s60 offen offset:0
    buffer_load_dword v1, v2, s[8:11], s60 offen offset:0
    s_add_u32 s60, s90, 64
    s_mul_i32 s60, s60, s85
    s_add_u32 s60, s60, s53
    buffer_load_dword v1, v2, s[4:7], s60 offen offset:0
    buffer_load_dword v1, v2, s[8:11], s60 offen offset:0
    s_mov_b64 exec, -1
    s_branch GG_256
QP_255:
    s_nop 7
    s_nop 1
    s_barrier
    s_nop 7
    s_nop 1
    s_bitcmp1_b32 s95, 0
    s_cbranch_scc1 PFS_294
    s_add_u32 s76, s90, 0
    s_mul_i32 s54, s76, s85
    s_add_u32 s54, s54, s53
    s_add_u32 m0, s59, 0
    s_nop 0
    buffer_load_dwordx4 v4, s[4:7], s54 offen offset:0 nt lds
    buffer_load_dwordx4 v5, s[4:7], s54 offen offset:1024 nt lds
    buffer_load_dwordx4 v6, s[4:7], s54 offen offset:2048 nt lds
    buffer_load_dwordx4 v7, s[4:7], s54 offen offset:3072 nt lds
    buffer_load_dwordx4 a[0:3], v8, s[8:11], s54 offen offset:0 nt
    buffer_load_dwordx4 a[4:7], v8, s[8:11], s54 offen offset:256 nt
    buffer_load_dwordx4 a[8:11], v8, s[8:11], s54 offen offset:512 nt
    buffer_load_dwordx4 a[12:15], v8, s[8:11], s54 offen offset:768 nt
    s_bitset1_b32 s95, 0
    s_nop 7
    s_nop 1
PFS_294:
    s_bitcmp1_b32 s95, 1
    s_cbranch_scc1 PFS_295
    s_add_u32 s77, s90, 16
    s_mul_i32 s54, s77, s85
    s_add_u32 s54, s54, s53
    s_add_u32 m0, s59, 4096
    s_nop 0
    buffer_load_dwordx4 v4, s[4:7], s54 offen offset:0 nt lds
    buffer_load_dwordx4 v5, s[4:7], s54 offen offset:1024 nt lds
    buffer_load_dwordx4 v6, s[4:7], s54 offen offset:2048 nt lds
    buffer_load_dwordx4 v7, s[4:7], s54 offen offset:3072 nt lds
    buffer_load_dwordx4 a[16:19], v8, s[8:11], s54 offen offset:0 nt
    buffer_load_dwordx4 a[20:23], v8, s[8:11], s54 offen offset:256 nt
    buffer_load_dwordx4 a[24:27], v8, s[8:11], s54 offen offset:512 nt
    buffer_load_dwordx4 a[28:31], v8, s[8:11], s54 offen offset:768 nt
    s_bitset1_b32 s95, 1
    s_nop 7
    s_nop 1
PFS_295:
    v_lshlrev_b32 v2, 7, v0
    s_mov_b64 exec, 0xffffffff
    s_add_u32 s60, s90, 32
    s_mul_i32 s60, s60, s85
    s_add_u32 s60, s60, s53
    buffer_load_dword v1, v2, s[4:7], s60 offen offset:0
    buffer_load_dword v1, v2, s[8:11], s60 offen offset:0
    s_add_u32 s60, s90, 48
    s_mul_i32 s60, s60, s85
    s_add_u32 s60, s60, s53
    buffer_load_dword v1, v2, s[4:7], s60 offen offset:0
    buffer_load_dword v1, v2, s[8:11], s60 offen offset:0
    s_add_u32 s60, s90, 64
    s_mul_i32 s60, s60, s85
    s_add_u32 s60, s60, s53
    buffer_load_dword v1, v2, s[4:7], s60 offen offset:0
    buffer_load_dword v1, v2, s[8:11], s60 offen offset:0
    s_mov_b64 exec, -1
    v_lshrrev_b32 v40, 5, v0
    v_lshlrev_b32 v40, 8, v40
    v_bfe_u32 v39, v0, 4, 1
    v_lshl_add_u32 v40, v39, 7, v40
    v_and_b32 v39, 7, v0
    v_lshl_add_u32 v40, v39, 2, v40
    s_lshl_b32 s60, s3, 9
    s_add_u32 s60, s60, 147456
    v_add_u32 v40, s60, v40
    v_and_b32 v24, 0x3f803f80, v13
    v_and_b32 v25, 0x3f803f80, v14
    v_and_b32 v26, 0x3f803f80, v15
    v_and_b32 v27, 0x3f803f80, v16
    s_nop 1
    v_mfma_f32_16x16x32_bf16 v[20:23], a[160:163], v[24:27], 0
    v_mfma_f32_16x16x32_bf16 v[32:35], a[164:167], v[24:27], 0
    v_mfma_f32_16x16x32_bf16 v[20:23], a[168:171], v[24:27], v[20:23]
    v_mfma_f32_16x16x32_bf16 v[32:35], a[172:175], v[24:27], v[32:35]
    v_mfma_f32_16x16x32_bf16 v[20:23], a[176:179], v[24:27], v[20:23]
    v_mfma_f32_16x16x32_bf16 v[32:35], a[180:183], v[24:27], v[32:35]
    v_mfma_f32_16x16x32_bf16 v[20:23], a[184:187], v[24:27], v[20:23]
    v_mfma_f32_16x16x32_bf16 v[32:35], a[188:191], v[24:27], v[32:35]
    v_mfma_f32_16x16x32_bf16 v[20:23], a[192:195], v[24:27], v[20:23]
    v_mfma_f32_16x16x32_bf16 v[32:35], a[196:199], v[24:27], v[32:35]
    v_mfma_f32_16x16x32_bf16 v[20:23], a[200:203], v[24:27], v[20:23]
    v_mfma_f32_16x16x32_bf16 v[32:35], a[204:207], v[24:27], v[32:35]
    v_mfma_f32_16x16x32_bf16 v[20:23], a[208:211], v[24:27], v[20:23]
    v_mfma_f32_16x16x32_bf16 v[32:35], a[212:215], v[24:27], v[32:35]
    v_mfma_f32_16x16x32_bf16 v[20:23], a[216:219], v[24:27], v[20:23]
    v_mfma_f32_16x16x32_bf16 v[32:35], a[220:223], v[24:27], v[32:35]
    v_mfma_f32_16x16x32_bf16 v[20:23], a[224:227], v[24:27], v[20:23]
    v_mfma_f32_16x16x32_bf16 v[32:35], a[228:231], v[24:27], v[32:35]
    s_nop 7
    v_add_f32 v20, v20, v32
    v_add_f32 v21, v21, v33
    v_add_f32 v22, v22, v34
    v_add_f32 v23, v23, v35
    s_mov_b64 exec, s[68:69]
    ds_write_b32 v40, v20 offset:0
    ds_write_b32 v40, v21 offset:32
    ds_write_b32 v40, v22 offset:64
    ds_write_b32 v40, v23 offset:96
    s_mov_b64 exec, -1
    s_waitcnt lgkmcnt(0)
    s_barrier
    s_cmp_eq_u32 s3, 0
    s_cbranch_scc0 CS_296
    v_lshlrev_b32 v38, 2, v0
    v_add_u32 v38, 147456, v38
    ds_read2st64_b32 v[48:49], v38 offset0:0 offset1:1
    ds_read2st64_b32 v[50:51], v38 offset0:2 offset1:3
    ds_read2st64_b32 v[52:53], v38 offset0:4 offset1:5
    ds_read2st64_b32 v[54:55], v38 offset0:6 offset1:7
    s_waitcnt lgkmcnt(0)
    v_add_f32 v48, v48, v49
    v_add_f32 v50, v50, v51
    v_add_f32 v52, v52, v53
    v_add_f32 v54, v54, v55
    v_add_f32 v48, v48, v50
    v_add_f32 v52, v52, v54
    v_add_f32 v36, v48, v52
    ds_write_b32 v38, v36 offset:14848
    s_nop 7
    s_nop 1
CS_296:
    v_lshlrev_b32 v38, 4, v0
    s_mul_i32 s60, s3, 576
    s_mul_i32 s61, s88, 2304
    s_add_u32 s60, s60, s61
    s_add_u32 s60, s60, 1351680
    s_add_u32 s60, s60, s82
    s_mov_b32 exec_lo, -1
    s_mov_b32 exec_hi, 0xf
    s_nop 7
    s_nop 1
    s_mov_b32 s64, 200000
PL_297:
    buffer_load_dwordx4 v[44:47], v38, s[32:35], s60 offen sc1
    s_waitcnt vmcnt(0)
    v_max3_u32 v36, v44, v45, v46
    v_max_u32 v36, v36, v47
    v_cmp_eq_u32 vcc, -1, v36
    s_cbranch_vccz PD_298
    s_sub_u32 s64, s64, 1
    s_cmp_lg_u32 s64, 0
    s_cbranch_scc1 PL_297
PD_298:
    s_mov_b64 exec, -1
    v_cvt_pk_bf16_f32 v28, v44, v44
    v_cvt_pk_bf16_f32 v29, v45, v45
    v_cvt_pk_bf16_f32 v30, v46, v46
    v_cvt_pk_bf16_f32 v31, v47, v47
    v_lshlrev_b32 v38, 4, v0
    s_mul_i32 s60, s3, 576
    s_add_u32 s60, s60, 153600
    v_add_u32 v38, s60, v38
    s_mov_b32 exec_lo, -1
    s_mov_b32 exec_hi, 0xf
    ds_write_b128 v38, v[28:31]
    s_mov_b64 exec, -1
    v_lshrrev_b32 v38, 4, v0
    v_lshlrev_b32 v38, 1, v38
    v_bfe_u32 v39, v0, 3, 1
    v_add_u32 v38, v38, v39
    v_lshlrev_b32 v38, 2, v38
    v_add_u32 v38, s60, v38
    ds_read2_b32 v[48:49], v38 offset0:0 offset1:8
    ds_read2_b32 v[50:51], v38 offset0:16 offset1:24
    ds_read2_b32 v[52:53], v38 offset0:32 offset1:40
    ds_read2_b32 v[54:55], v38 offset0:48 offset1:56
    ds_read2_b32 v[56:57], v38 offset0:64 offset1:72
    ds_read2_b32 v[58:59], v38 offset0:80 offset1:88
    ds_read2_b32 v[60:61], v38 offset0:96 offset1:104
    ds_read2_b32 v[62:63], v38 offset0:112 offset1:120
    ds_read2_b32 v[64:65], v38 offset0:128 offset1:136
    v_add_f32 v42, v44, v45
    v_add_f32 v39, v46, v47
    v_mul_f32 v43, v44, v44
    v_add_f32 v42, v42, v39
    v_fma_f32 v43, v45, v45, v43
    v_fma_f32 v43, v46, v46, v43
    v_fma_f32 v43, v47, v47, v43
    v_add_f32_dpp v42, v42, v42 row_ror:8 row_mask:0xf bank_mask:0xf
    s_nop 0
    v_add_f32_dpp v43, v43, v43 row_ror:8 row_mask:0xf bank_mask:0xf
    v_add_f32_dpp v42, v42, v42 row_ror:4 row_mask:0xf bank_mask:0xf
    s_nop 0
    v_add_f32_dpp v43, v43, v43 row_ror:4 row_mask:0xf bank_mask:0xf
    v_add_f32_dpp v42, v42, v42 row_ror:2 row_mask:0xf bank_mask:0xf
    s_nop 0
    v_add_f32_dpp v43, v43, v43 row_ror:2 row_mask:0xf bank_mask:0xf
    v_add_f32_dpp v42, v42, v42 row_ror:1 row_mask:0xf bank_mask:0xf
    s_nop 0
    v_add_f32_dpp v43, v43, v43 row_ror:1 row_mask:0xf bank_mask:0xf
    v_mov_b32 v36, v42
    v_mov_b32 v37, v43
    s_nop 0
    v_permlane16_swap_b32 v42, v36
    v_permlane16_swap_b32 v43, v37
    v_add_f32 v42, v42, v36
    v_add_f32 v43, v43, v37
    v_mov_b32 v36, v42
    v_mov_b32 v37, v43
    s_nop 0
    v_permlane32_swap_b32 v42, v36
    v_permlane32_swap_b32 v43, v37
    v_add_f32 v42, v42, v36
    v_add_f32 v43, v43, v37
    s_lshl_b32 s60, s3, 3
    s_add_u32 s60, s60, 162560
    v_mov_b32 v39, s60
    s_mov_b64 exec, 1
    ds_write_b64 v39, v[42:43]
    s_mov_b64 exec, -1
    v_lshrrev_b32 v40, 5, v0
    v_lshlrev_b32 v40, 8, v40
    v_bfe_u32 v39, v0, 4, 1
    v_lshl_add_u32 v40, v39, 7, v40
    v_and_b32 v39, 7, v0
    v_lshl_add_u32 v40, v39, 2, v40
    s_lshl_b32 s60, s3, 9
    s_add_u32 s60, s60, 156160
    v_add_u32 v40, s60, v40
    s_waitcnt lgkmcnt(9)
    v_and_b32 v24, v48, v13
    v_and_b32 v25, v48, v14
    v_and_b32 v26, v48, v15
    v_and_b32 v27, v48, v16
    s_nop 1
    v_mfma_f32_16x16x32_bf16 v[20:23], a[160:163], v[24:27], 0
    v_and_b32 v28, v49, v13
    v_and_b32 v29, v49, v14
    v_and_b32 v30, v49, v15
    v_and_b32 v31, v49, v16
    s_nop 1
    v_mfma_f32_16x16x32_bf16 v[32:35], a[164:167], v[28:31], 0
    s_waitcnt lgkmcnt(8)
    v_and_b32 v24, v50, v13
    v_and_b32 v25, v50, v14
    v_and_b32 v26, v50, v15
    v_and_b32 v27, v50, v16
    s_nop 1
    v_mfma_f32_16x16x32_bf16 v[20:23], a[168:171], v[24:27], v[20:23]
    v_and_b32 v28, v51, v13
    v_and_b32 v29, v51, v14
    v_and_b32 v30, v51, v15
    v_and_b32 v31, v51, v16
    s_nop 1
    v_mfma_f32_16x16x32_bf16 v[32:35], a[172:175], v[28:31], v[32:35]
    s_waitcnt lgkmcnt(7)
    v_and_b32 v24, v52, v13
    v_and_b32 v25, v52, v14
    v_and_b32 v26, v52, v15
    v_and_b32 v27, v52, v16
    s_nop 1
    v_mfma_f32_16x16x32_bf16 v[20:23], a[176:179], v[24:27], v[20:23]
    v_and_b32 v28, v53, v13
    v_and_b32 v29, v53, v14
    v_and_b32 v30, v53, v15
    v_and_b32 v31, v53, v16
    s_nop 1
    v_mfma_f32_16x16x32_bf16 v[32:35], a[180:183], v[28:31], v[32:35]
    s_waitcnt lgkmcnt(6)
    v_and_b32 v24, v54, v13
    v_and_b32 v25, v54, v14
    v_and_b32 v26, v54, v15
    v_and_b32 v27, v54, v16
    s_nop 1
    v_mfma_f32_16x16x32_bf16 v[20:23], a[184:187], v[24:27], v[20:23]
    v_and_b32 v28, v55, v13
    v_and_b32 v29, v55, v14
    v_and_b32 v30, v55, v15
    v_and_b32 v31, v55, v16
    s_nop 1
    v_mfma_f32_16x16x32_bf16 v[32:35], a[188:191], v[28:31], v[32:35]
    s_waitcnt lgkmcnt(0)
    s_barrier
    v_mov_b32 v39, 162560
    ds_read_b128 v[68:71], v39
    ds_read_b128 v[72:75], v39 offset:16
    v_and_b32 v24, v56, v13
    v_and_b32 v25, v56, v14
    v_and_b32 v26, v56, v15
    v_and_b32 v27, v56, v16
    s_nop 1
    v_mfma_f32_16x16x32_bf16 v[20:23], a[192:195], v[24:27], v[20:23]
    v_and_b32 v28, v57, v13
    v_and_b32 v29, v57, v14
    v_and_b32 v30, v57, v15
    v_and_b32 v31, v57, v16
    s_nop 1
    v_mfma_f32_16x16x32_bf16 v[32:35], a[196:199], v[28:31], v[32:35]
    v_and_b32 v24, v58, v13
    v_and_b32 v25, v58, v14
    v_and_b32 v26, v58, v15
    v_and_b32 v27, v58, v16
    s_nop 1
    v_mfma_f32_16x16x32_bf16 v[20:23], a[200:203], v[24:27], v[20:23]
    s_waitcnt lgkmcnt(0)
    v_and_b32 v28, v59, v13
    v_and_b32 v29, v59, v14
    v_and_b32 v30, v59, v15
    v_and_b32 v31, v59, v16
    s_nop 1
    v_mfma_f32_16x16x32_bf16 v[32:35], a[204:207], v[28:31], v[32:35]
    v_add_f32 v68, v68, v70
    v_add_f32 v69, v69, v71
    v_add_f32 v72, v72, v74
    v_and_b32 v24, v60, v13
    v_and_b32 v25, v60, v14
    v_and_b32 v26, v60, v15
    v_and_b32 v27, v60, v16
    s_nop 1
    v_mfma_f32_16x16x32_bf16 v[20:23], a[208:211], v[24:27], v[20:23]
    v_add_f32 v73, v73, v75
    v_add_f32 v42, v68, v72
    v_add_f32 v43, v69, v73
    v_and_b32 v28, v61, v13
    v_and_b32 v29, v61, v14
    v_and_b32 v30, v61, v15
    v_and_b32 v31, v61, v16
    s_nop 1
    v_mfma_f32_16x16x32_bf16 v[32:35], a[212:215], v[28:31], v[32:35]
    v_mul_f32 v42, 0x3ae38e39, v42
    v_mul_f32 v43, 0x3ae38e39, v43
    v_fma_f32 v43, -v42, v42, v43
    v_and_b32 v24, v62, v13
    v_and_b32 v25, v62, v14
    v_and_b32 v26, v62, v15
    v_and_b32 v27, v62, v16
    s_nop 1
    v_mfma_f32_16x16x32_bf16 v[20:23], a[216:219], v[24:27], v[20:23]
    v_max_f32 v43, 0, v43
    v_cvt_pk_bf16_f32 v39, v42, v43
    v_lshlrev_b32 v42, 16, v39
    v_and_b32 v28, v63, v13
    v_and_b32 v29, v63, v14
    v_and_b32 v30, v63, v15
    v_and_b32 v31, v63, v16
    s_nop 1
    v_mfma_f32_16x16x32_bf16 v[32:35], a[220:223], v[28:31], v[32:35]
    v_and_b32 v43, 0xffff0000, v39
    v_add_f32 v43, 0x3727c5ac, v43
    v_cvt_pk_bf16_f32 v43, v43, v43
    v_and_b32 v24, v64, v13
    v_and_b32 v25, v64, v14
    v_and_b32 v26, v64, v15
    v_and_b32 v27, v64, v16
    s_nop 1
    v_mfma_f32_16x16x32_bf16 v[20:23], a[224:227], v[24:27], v[20:23]
    v_and_b32 v43, 0xffff0000, v43
    v_sqrt_f32 v43, v43
    s_nop 0
    v_cvt_pk_bf16_f32 v43, v43, v43
    v_and_b32 v28, v65, v13
    v_and_b32 v29, v65, v14
    v_and_b32 v30, v65, v15
    v_and_b32 v31, v65, v16
    s_nop 1
    v_mfma_f32_16x16x32_bf16 v[32:35], a[228:231], v[28:31], v[32:35]
    v_and_b32 v43, 0xffff0000, v43
    v_rcp_f32 v43, v43
    s_nop 5
    v_add_f32 v20, v20, v32
    v_add_f32 v21, v21, v33
    v_add_f32 v22, v22, v34
    v_add_f32 v23, v23, v35
    s_mov_b64 exec, s[68:69]
    ds_write_b32 v40, v20 offset:0
    ds_write_b32 v40, v21 offset:32
    ds_write_b32 v40, v22 offset:64
    ds_write_b32 v40, v23 offset:96
    s_mov_b64 exec, -1
    s_waitcnt lgkmcnt(0)
    s_barrier
    s_cmp_eq_u32 s3, 0
    s_cbranch_scc0 QS_299
    v_lshlrev_b32 v38, 2, v0
    v_add_u32 v38, 156160, v38
    ds_read2st64_b32 v[48:49], v38 offset0:0 offset1:1
    ds_read2st64_b32 v[50:51], v38 offset0:2 offset1:3
    ds_read2st64_b32 v[52:53], v38 offset0:4 offset1:5
    ds_read2st64_b32 v[54:55], v38 offset0:6 offset1:7
    ds_read_b32 v40, v38 offset:6144
    s_waitcnt lgkmcnt(0)
    v_add_f32 v48, v48, v49
    v_add_f32 v50, v50, v51
    v_add_f32 v52, v52, v53
    v_add_f32 v54, v54, v55
    v_add_f32 v48, v48, v50
    v_add_f32 v52, v52, v54
    v_add_f32 v36, v48, v52
    v_fma_f32 v36, -v42, v40, v36
    v_mul_f32 v36, v43, v36
    v_mul_f32 v36, 0x5f800000, v36
    s_nop 1
    v_mov_b32_dpp v37, v36 quad_perm:[1,0,3,2] row_mask:0xf bank_mask:0xf
    v_cvt_pk_bf16_f32 v36, v36, v37
    v_lshlrev_b32 v38, 1, v0
    s_lshl_b32 s60, s57, 9
    s_lshl_b32 s61, s63, 7
    s_add_u32 s60, s60, s61
    s_add_u32 s60, s60, 1228800
    s_mov_b64 exec, s[74:75]
    buffer_store_dword v36, v38, s[32:35], s60 offen sc1
    s_mov_b64 exec, -1
    s_nop 7
    s_nop 1
QS_299:
GG_256:
    s_nop 7
    s_nop 1
    s_cmp_eq_u32 s3, 0
    s_cbranch_scc0 WJ_300
    v_bfe_u32 v38, v0, 3, 1
    v_lshlrev_b32 v38, 8, v38
    v_lshrrev_b32 v39, 4, v0
    v_lshl_add_u32 v38, v39, 4, v38
    s_lshl_b32 s60, s57, 9
    s_add_u32 s60, s60, 1228800
    s_nop 7
    s_nop 1
    s_mov_b32 s64, 200000
    buffer_load_dwordx4 v[64:67], v38, s[32:35], s60 offen offset:0 sc1
    buffer_load_dwordx4 v[68:71], v38, s[32:35], s60 offen offset:64 sc1
    buffer_load_dwordx4 v[72:75], v38, s[32:35], s60 offen offset:128 sc1
    buffer_load_dwordx4 v[76:79], v38, s[32:35], s60 offen offset:192 sc1
    buffer_load_dwordx4 v[64:67], v38, s[32:35], s60 offen offset:0 sc1
    buffer_load_dwordx4 v[68:71], v38, s[32:35], s60 offen offset:64 sc1
    buffer_load_dwordx4 v[72:75], v38, s[32:35], s60 offen offset:128 sc1
    buffer_load_dwordx4 v[76:79], v38, s[32:35], s60 offen offset:192 sc1
    buffer_load_dwordx4 v[64:67], v38, s[32:35], s60 offen offset:0 sc1
    buffer_load_dwordx4 v[68:71], v38, s[32:35], s60 offen offset:64 sc1
    buffer_load_dwordx4 v[72:75], v38, s[32:35], s60 offen offset:128 sc1
    buffer_load_dwordx4 v[76:79], v38, s[32:35], s60 offen offset:192 sc1
PL_301:
    buffer_load_dwordx4 v[64:67], v38, s[32:35], s60 offen offset:0 sc1
    buffer_load_dwordx4 v[68:71], v38, s[32:35], s60 offen offset:64 sc1
    buffer_load_dwordx4 v[72:75], v38, s[32:35], s60 offen offset:128 sc1
    buffer_load_dwordx4 v[76:79], v38, s[32:35], s60 offen offset:192 sc1
    s_waitcnt vmcnt(12)
    v_max3_u32 v36, v64, v65, v66
    v_max3_u32 v36, v36, v67, v68
    v_max3_u32 v36, v36, v69, v70
    v_max3_u32 v36, v36, v71, v72
    v_max3_u32 v36, v36, v73, v74
    v_max3_u32 v36, v36, v75, v76
    v_max3_u32 v36, v36, v77, v78
    v_max_u32 v36, v36, v79
    v_cmp_eq_u32 vcc, -1, v36
    s_cbranch_vccz PD_302
    s_sub_u32 s64, s64, 1
    s_cmp_lg_u32 s64, 0
    s_cbranch_scc1 PL_301
PD_302:
    v_lshlrev_b32 v40, 4, v0
    v_add_u32 v40, 158208, v40
    ds_write_b128 v40, v[64:67] offset:0
    ds_write_b128 v40, v[68:71] offset:1024
    ds_write_b128 v40, v[72:75] offset:2048
    ds_write_b128 v40, v[76:79] offset:3072
    s_waitcnt lgkmcnt(0)
WJ_300:
    s_nop 7
    s_nop 1
    s_barrier
    v_lshlrev_b32 v40, 4, v0
    v_add_u32 v40, 158208, v40
    ds_read_b128 v[64:67], v40 offset:0
    ds_read_b128 v[68:71], v40 offset:1024
    ds_read_b128 v[72:75], v40 offset:2048
    ds_read_b128 v[76:79], v40 offset:3072
    s_mov_b32 s83, 1
    s_mov_b32 s82, 1376256
    s_waitcnt vmcnt(0) lgkmcnt(0)
    s_mov_b32 s84, 27
    s_branch L_pass
L_exit:
L_quit:
    s_endpgm
SL_85:
    s_add_u32 s54, s52, 0
    v_and_b32 v36, 15, v0
    v_lshlrev_b32 v36, 8, v36
    v_lshrrev_b32 v37, 4, v0
    v_lshl_add_u32 v36, v37, 4, v36
    buffer_load_dwordx4 v[48:51], v36, s[4:7], s54 offen offset:0
    buffer_load_dwordx4 v[52:55], v36, s[4:7], s54 offen offset:64
    buffer_load_dwordx4 v[56:59], v36, s[4:7], s54 offen offset:128
    buffer_load_dwordx4 v[60:63], v36, s[4:7], s54 offen offset:192
    s_waitcnt vmcnt(0)
    v_mfma_f32_16x16x32_bf16 v[24:27], v[48:51], v[64:67], 0
    v_mfma_f32_16x16x32_bf16 v[24:27], v[52:55], v[68:71], v[24:27]
    v_mfma_f32_16x16x32_bf16 v[24:27], v[56:59], v[72:75], v[24:27]
    v_mfma_f32_16x16x32_bf16 v[24:27], v[60:63], v[76:79], v[24:27]
    s_nop 7
    v_fma_f32 v28, v24, s55, v17
    v_fma_f32 v29, v25, s55, v17
    v_fma_f32 v30, v26, s55, v17
    v_fma_f32 v31, v27, s55, v17
    v_max3_f32 v36, v28, v29, v30
    v_max_f32 v36, v36, v31
    v_cmp_lt_f32 vcc, s56, v36
    s_cbranch_vccnz RS_303
RB_304:
    buffer_load_dwordx4 v[48:51], v8, s[8:11], s54 offen offset:0
    buffer_load_dwordx4 v[52:55], v8, s[8:11], s54 offen offset:256
    buffer_load_dwordx4 v[56:59], v8, s[8:11], s54 offen offset:512
    buffer_load_dwordx4 v[60:63], v8, s[8:11], s54 offen offset:768
    v_exp_f32 v28, v28
    v_exp_f32 v29, v29
    v_exp_f32 v30, v30
    v_exp_f32 v31, v31
    v_cvt_pk_bf16_f32 v32, v28, v28
    v_add_f32 v18, v18, v28
    v_cvt_pk_bf16_f32 v33, v29, v29
    v_add_f32 v19, v19, v29
    v_cvt_pk_bf16_f32 v34, v30, v30
    v_add_f32 v18, v18, v30
    v_cvt_pk_bf16_f32 v35, v31, v31
    v_add_f32 v19, v19, v31
    s_waitcnt vmcnt(0)
    v_and_b32 v24, v32, v13
    v_and_b32 v25, v32, v14
    v_and_b32 v26, v32, v15
    v_and_b32 v27, v32, v16
    s_nop 1
    v_mfma_f32_16x16x32_bf16 v[20:23], v[48:51], v[24:27], v[20:23]
    v_and_b32 v28, v33, v13
    v_and_b32 v29, v33, v14
    v_and_b32 v30, v33, v15
    v_and_b32 v31, v33, v16
    s_nop 1
    v_mfma_f32_16x16x32_bf16 v[20:23], v[52:55], v[28:31], v[20:23]
    v_and_b32 v24, v34, v13
    v_and_b32 v25, v34, v14
    v_and_b32 v26, v34, v15
    v_and_b32 v27, v34, v16
    s_nop 1
    v_mfma_f32_16x16x32_bf16 v[20:23], v[56:59], v[24:27], v[20:23]
    v_and_b32 v28, v35, v13
    v_and_b32 v29, v35, v14
    v_and_b32 v30, v35, v15
    v_and_b32 v31, v35, v16
    s_nop 1
    v_mfma_f32_16x16x32_bf16 v[20:23], v[60:63], v[28:31], v[20:23]
    s_nop 7
    s_nop 1
    s_branch SD_86
SL_91:
    s_add_u32 s54, s52, 65536
    v_and_b32 v36, 15, v0
    v_lshlrev_b32 v36, 8, v36
    v_lshrrev_b32 v37, 4, v0
    v_lshl_add_u32 v36, v37, 4, v36
    buffer_load_dwordx4 v[48:51], v36, s[4:7], s54 offen offset:0
    buffer_load_dwordx4 v[52:55], v36, s[4:7], s54 offen offset:64
    buffer_load_dwordx4 v[56:59], v36, s[4:7], s54 offen offset:128
    buffer_load_dwordx4 v[60:63], v36, s[4:7], s54 offen offset:192
    s_waitcnt vmcnt(0)
    v_mfma_f32_16x16x32_bf16 v[24:27], v[48:51], v[64:67], 0
    v_mfma_f32_16x16x32_bf16 v[24:27], v[52:55], v[68:71], v[24:27]
    v_mfma_f32_16x16x32_bf16 v[24:27], v[56:59], v[72:75], v[24:27]
    v_mfma_f32_16x16x32_bf16 v[24:27], v[60:63], v[76:79], v[24:27]
    s_nop 7
    v_fma_f32 v28, v24, s55, v17
    v_fma_f32 v29, v25, s55, v17
    v_fma_f32 v30, v26, s55, v17
    v_fma_f32 v31, v27, s55, v17
    v_max3_f32 v36, v28, v29, v30
    v_max_f32 v36, v36, v31
    v_cmp_lt_f32 vcc, s56, v36
    s_cbranch_vccnz RS_305
RB_306:
    buffer_load_dwordx4 v[48:51], v8, s[8:11], s54 offen offset:0
    buffer_load_dwordx4 v[52:55], v8, s[8:11], s54 offen offset:256
    buffer_load_dwordx4 v[56:59], v8, s[8:11], s54 offen offset:512
    buffer_load_dwordx4 v[60:63], v8, s[8:11], s54 offen offset:768
    v_exp_f32 v28, v28
    v_exp_f32 v29, v29
    v_exp_f32 v30, v30
    v_exp_f32 v31, v31
    v_cvt_pk_bf16_f32 v32, v28, v28
    v_add_f32 v18, v18, v28
    v_cvt_pk_bf16_f32 v33, v29, v29
    v_add_f32 v19, v19, v29
    v_cvt_pk_bf16_f32 v34, v30, v30
    v_add_f32 v18, v18, v30
    v_cvt_pk_bf16_f32 v35, v31, v31
    v_add_f32 v19, v19, v31
    s_waitcnt vmcnt(0)
    v_and_b32 v24, v32, v13
    v_and_b32 v25, v32, v14
    v_and_b32 v26, v32, v15
    v_and_b32 v27, v32, v16
    s_nop 1
    v_mfma_f32_16x16x32_bf16 v[20:23], v[48:51], v[24:27], v[20:23]
    v_and_b32 v28, v33, v13
    v_and_b32 v29, v33, v14
    v_and_b32 v30, v33, v15
    v_and_b32 v31, v33, v16
    s_nop 1
    v_mfma_f32_16x16x32_bf16 v[20:23], v[52:55], v[28:31], v[20:23]
    v_and_b32 v24, v34, v13
    v_and_b32 v25, v34, v14
    v_and_b32 v26, v34, v15
    v_and_b32 v27, v34, v16
    s_nop 1
    v_mfma_f32_16x16x32_bf16 v[20:23], v[56:59], v[24:27], v[20:23]
    v_and_b32 v28, v35, v13
    v_and_b32 v29, v35, v14
    v_and_b32 v30, v35, v15
    v_and_b32 v31, v35, v16
    s_nop 1
    v_mfma_f32_16x16x32_bf16 v[20:23], v[60:63], v[28:31], v[20:23]
    s_nop 7
    s_nop 1
    s_branch SD_92
SL_99:
    s_add_u32 s54, s52, 131072
    v_and_b32 v36, 15, v0
    v_lshlrev_b32 v36, 8, v36
    v_lshrrev_b32 v37, 4, v0
    v_lshl_add_u32 v36, v37, 4, v36
    buffer_load_dwordx4 v[48:51], v36, s[4:7], s54 offen offset:0
    buffer_load_dwordx4 v[52:55], v36, s[4:7], s54 offen offset:64
    buffer_load_dwordx4 v[56:59], v36, s[4:7], s54 offen offset:128
    buffer_load_dwordx4 v[60:63], v36, s[4:7], s54 offen offset:192
    s_waitcnt vmcnt(0)
    v_mfma_f32_16x16x32_bf16 v[24:27], v[48:51], v[64:67], 0
    v_mfma_f32_16x16x32_bf16 v[24:27], v[52:55], v[68:71], v[24:27]
    v_mfma_f32_16x16x32_bf16 v[24:27], v[56:59], v[72:75], v[24:27]
    v_mfma_f32_16x16x32_bf16 v[24:27], v[60:63], v[76:79], v[24:27]
    s_nop 7
    v_fma_f32 v28, v24, s55, v17
    v_fma_f32 v29, v25, s55, v17
    v_fma_f32 v30, v26, s55, v17
    v_fma_f32 v31, v27, s55, v17
    v_max3_f32 v36, v28, v29, v30
    v_max_f32 v36, v36, v31
    v_cmp_lt_f32 vcc, s56, v36
    s_cbranch_vccnz RS_307
RB_308:
    buffer_load_dwordx4 v[48:51], v8, s[8:11], s54 offen offset:0
    buffer_load_dwordx4 v[52:55], v8, s[8:11], s54 offen offset:256
    buffer_load_dwordx4 v[56:59], v8, s[8:11], s54 offen offset:512
    buffer_load_dwordx4 v[60:63], v8, s[8:11], s54 offen offset:768
    v_exp_f32 v28, v28
    v_exp_f32 v29, v29
    v_exp_f32 v30, v30
    v_exp_f32 v31, v31
    v_cvt_pk_bf16_f32 v32, v28, v28
    v_add_f32 v18, v18, v28
    v_cvt_pk_bf16_f32 v33, v29, v29
    v_add_f32 v19, v19, v29
    v_cvt_pk_bf16_f32 v34, v30, v30
    v_add_f32 v18, v18, v30
    v_cvt_pk_bf16_f32 v35, v31, v31
    v_add_f32 v19, v19, v31
    s_waitcnt vmcnt(0)
    v_and_b32 v24, v32, v13
    v_and_b32 v25, v32, v14
    v_and_b32 v26, v32, v15
    v_and_b32 v27, v32, v16
    s_nop 1
    v_mfma_f32_16x16x32_bf16 v[20:23], v[48:51], v[24:27], v[20:23]
    v_and_b32 v28, v33, v13
    v_and_b32 v29, v33, v14
    v_and_b32 v30, v33, v15
    v_and_b32 v31, v33, v16
    s_nop 1
    v_mfma_f32_16x16x32_bf16 v[20:23], v[52:55], v[28:31], v[20:23]
    v_and_b32 v24, v34, v13
    v_and_b32 v25, v34, v14
    v_and_b32 v26, v34, v15
    v_and_b32 v27, v34, v16
    s_nop 1
    v_mfma_f32_16x16x32_bf16 v[20:23], v[56:59], v[24:27], v[20:23]
    v_and_b32 v28, v35, v13
    v_and_b32 v29, v35, v14
    v_and_b32 v30, v35, v15
    v_and_b32 v31, v35, v16
    s_nop 1
    v_mfma_f32_16x16x32_bf16 v[20:23], v[60:63], v[28:31], v[20:23]
    s_nop 7
    s_nop 1
    s_branch SD_100
SL_105:
    s_add_u32 s54, s52, 196608
    v_and_b32 v36, 15, v0
    v_lshlrev_b32 v36, 8, v36
    v_lshrrev_b32 v37, 4, v0
    v_lshl_add_u32 v36, v37, 4, v36
    buffer_load_dwordx4 v[48:51], v36, s[4:7], s54 offen offset:0
    buffer_load_dwordx4 v[52:55], v36, s[4:7], s54 offen offset:64
    buffer_load_dwordx4 v[56:59], v36, s[4:7], s54 offen offset:128
    buffer_load_dwordx4 v[60:63], v36, s[4:7], s54 offen offset:192
    s_waitcnt vmcnt(0)
    v_mfma_f32_16x16x32_bf16 v[24:27], v[48:51], v[64:67], 0
    v_mfma_f32_16x16x32_bf16 v[24:27], v[52:55], v[68:71], v[24:27]
    v_mfma_f32_16x16x32_bf16 v[24:27], v[56:59], v[72:75], v[24:27]
    v_mfma_f32_16x16x32_bf16 v[24:27], v[60:63], v[76:79], v[24:27]
    s_nop 7
    v_fma_f32 v28, v24, s55, v17
    v_fma_f32 v29, v25, s55, v17
    v_fma_f32 v30, v26, s55, v17
    v_fma_f32 v31, v27, s55, v17
    v_max3_f32 v36, v28, v29, v30
    v_max_f32 v36, v36, v31
    v_cmp_lt_f32 vcc, s56, v36
    s_cbranch_vccnz RS_309
RB_310:
    buffer_load_dwordx4 v[48:51], v8, s[8:11], s54 offen offset:0
    buffer_load_dwordx4 v[52:55], v8, s[8:11], s54 offen offset:256
    buffer_load_dwordx4 v[56:59], v8, s[8:11], s54 offen offset:512
    buffer_load_dwordx4 v[60:63], v8, s[8:11], s54 offen offset:768
    v_exp_f32 v28, v28
    v_exp_f32 v29, v29
    v_exp_f32 v30, v30
    v_exp_f32 v31, v31
    v_cvt_pk_bf16_f32 v32, v28, v28
    v_add_f32 v18, v18, v28
    v_cvt_pk_bf16_f32 v33, v29, v29
    v_add_f32 v19, v19, v29
    v_cvt_pk_bf16_f32 v34, v30, v30
    v_add_f32 v18, v18, v30
    v_cvt_pk_bf16_f32 v35, v31, v31
    v_add_f32 v19, v19, v31
    s_waitcnt vmcnt(0)
    v_and_b32 v24, v32, v13
    v_and_b32 v25, v32, v14
    v_and_b32 v26, v32, v15
    v_and_b32 v27, v32, v16
    s_nop 1
    v_mfma_f32_16x16x32_bf16 v[20:23], v[48:51], v[24:27], v[20:23]
    v_and_b32 v28, v33, v13
    v_and_b32 v29, v33, v14
    v_and_b32 v30, v33, v15
    v_and_b32 v31, v33, v16
    s_nop 1
    v_mfma_f32_16x16x32_bf16 v[20:23], v[52:55], v[28:31], v[20:23]
    v_and_b32 v24, v34, v13
    v_and_b32 v25, v34, v14
    v_and_b32 v26, v34, v15
    v_and_b32 v27, v34, v16
    s_nop 1
    v_mfma_f32_16x16x32_bf16 v[20:23], v[56:59], v[24:27], v[20:23]
    v_and_b32 v28, v35, v13
    v_and_b32 v29, v35, v14
    v_and_b32 v30, v35, v15
    v_and_b32 v31, v35, v16
    s_nop 1
    v_mfma_f32_16x16x32_bf16 v[20:23], v[60:63], v[28:31], v[20:23]
    s_nop 7
    s_nop 1
    s_branch SD_106
SL_111:
    s_add_u32 s54, s52, 262144
    v_and_b32 v36, 15, v0
    v_lshlrev_b32 v36, 8, v36
    v_lshrrev_b32 v37, 4, v0
    v_lshl_add_u32 v36, v37, 4, v36
    buffer_load_dwordx4 v[48:51], v36, s[4:7], s54 offen offset:0
    buffer_load_dwordx4 v[52:55], v36, s[4:7], s54 offen offset:64
    buffer_load_dwordx4 v[56:59], v36, s[4:7], s54 offen offset:128
    buffer_load_dwordx4 v[60:63], v36, s[4:7], s54 offen offset:192
    s_waitcnt vmcnt(0)
    v_mfma_f32_16x16x32_bf16 v[24:27], v[48:51], v[64:67], 0
    v_mfma_f32_16x16x32_bf16 v[24:27], v[52:55], v[68:71], v[24:27]
    v_mfma_f32_16x16x32_bf16 v[24:27], v[56:59], v[72:75], v[24:27]
    v_mfma_f32_16x16x32_bf16 v[24:27], v[60:63], v[76:79], v[24:27]
    s_nop 7
    v_fma_f32 v28, v24, s55, v17
    v_fma_f32 v29, v25, s55, v17
    v_fma_f32 v30, v26, s55, v17
    v_fma_f32 v31, v27, s55, v17
    v_max3_f32 v36, v28, v29, v30
    v_max_f32 v36, v36, v31
    v_cmp_lt_f32 vcc, s56, v36
    s_cbranch_vccnz RS_311
RB_312:
    buffer_load_dwordx4 v[48:51], v8, s[8:11], s54 offen offset:0
    buffer_load_dwordx4 v[52:55], v8, s[8:11], s54 offen offset:256
    buffer_load_dwordx4 v[56:59], v8, s[8:11], s54 offen offset:512
    buffer_load_dwordx4 v[60:63], v8, s[8:11], s54 offen offset:768
    v_exp_f32 v28, v28
    v_exp_f32 v29, v29
    v_exp_f32 v30, v30
    v_exp_f32 v31, v31
    v_cvt_pk_bf16_f32 v32, v28, v28
    v_add_f32 v18, v18, v28
    v_cvt_pk_bf16_f32 v33, v29, v29
    v_add_f32 v19, v19, v29
    v_cvt_pk_bf16_f32 v34, v30, v30
    v_add_f32 v18, v18, v30
    v_cvt_pk_bf16_f32 v35, v31, v31
    v_add_f32 v19, v19, v31
    s_waitcnt vmcnt(0)
    v_and_b32 v24, v32, v13
    v_and_b32 v25, v32, v14
    v_and_b32 v26, v32, v15
    v_and_b32 v27, v32, v16
    s_nop 1
    v_mfma_f32_16x16x32_bf16 v[20:23], v[48:51], v[24:27], v[20:23]
    v_and_b32 v28, v33, v13
    v_and_b32 v29, v33, v14
    v_and_b32 v30, v33, v15
    v_and_b32 v31, v33, v16
    s_nop 1
    v_mfma_f32_16x16x32_bf16 v[20:23], v[52:55], v[28:31], v[20:23]
    v_and_b32 v24, v34, v13
    v_and_b32 v25, v34, v14
    v_and_b32 v26, v34, v15
    v_and_b32 v27, v34, v16
    s_nop 1
    v_mfma_f32_16x16x32_bf16 v[20:23], v[56:59], v[24:27], v[20:23]
    v_and_b32 v28, v35, v13
    v_and_b32 v29, v35, v14
    v_and_b32 v30, v35, v15
    v_and_b32 v31, v35, v16
    s_nop 1
    v_mfma_f32_16x16x32_bf16 v[20:23], v[60:63], v[28:31], v[20:23]
    s_nop 7
    s_nop 1
    s_branch SD_112
SL_119:
    s_add_u32 s54, s52, 327680
    v_and_b32 v36, 15, v0
    v_lshlrev_b32 v36, 8, v36
    v_lshrrev_b32 v37, 4, v0
    v_lshl_add_u32 v36, v37, 4, v36
    buffer_load_dwordx4 v[48:51], v36, s[4:7], s54 offen offset:0
    buffer_load_dwordx4 v[52:55], v36, s[4:7], s54 offen offset:64
    buffer_load_dwordx4 v[56:59], v36, s[4:7], s54 offen offset:128
    buffer_load_dwordx4 v[60:63], v36, s[4:7], s54 offen offset:192
    s_waitcnt vmcnt(0)
    v_mfma_f32_16x16x32_bf16 v[24:27], v[48:51], v[64:67], 0
    v_mfma_f32_16x16x32_bf16 v[24:27], v[52:55], v[68:71], v[24:27]
    v_mfma_f32_16x16x32_bf16 v[24:27], v[56:59], v[72:75], v[24:27]
    v_mfma_f32_16x16x32_bf16 v[24:27], v[60:63], v[76:79], v[24:27]
    s_nop 7
    v_fma_f32 v28, v24, s55, v17
    v_fma_f32 v29, v25, s55, v17
    v_fma_f32 v30, v26, s55, v17
    v_fma_f32 v31, v27, s55, v17
    v_max3_f32 v36, v28, v29, v30
    v_max_f32 v36, v36, v31
    v_cmp_lt_f32 vcc, s56, v36
    s_cbranch_vccnz RS_313
RB_314:
    buffer_load_dwordx4 v[48:51], v8, s[8:11], s54 offen offset:0
    buffer_load_dwordx4 v[52:55], v8, s[8:11], s54 offen offset:256
    buffer_load_dwordx4 v[56:59], v8, s[8:11], s54 offen offset:512
    buffer_load_dwordx4 v[60:63], v8, s[8:11], s54 offen offset:768
    v_exp_f32 v28, v28
    v_exp_f32 v29, v29
    v_exp_f32 v30, v30
    v_exp_f32 v31, v31
    v_cvt_pk_bf16_f32 v32, v28, v28
    v_add_f32 v18, v18, v28
    v_cvt_pk_bf16_f32 v33, v29, v29
    v_add_f32 v19, v19, v29
    v_cvt_pk_bf16_f32 v34, v30, v30
    v_add_f32 v18, v18, v30
    v_cvt_pk_bf16_f32 v35, v31, v31
    v_add_f32 v19, v19, v31
    s_waitcnt vmcnt(0)
    v_and_b32 v24, v32, v13
    v_and_b32 v25, v32, v14
    v_and_b32 v26, v32, v15
    v_and_b32 v27, v32, v16
    s_nop 1
    v_mfma_f32_16x16x32_bf16 v[20:23], v[48:51], v[24:27], v[20:23]
    v_and_b32 v28, v33, v13
    v_and_b32 v29, v33, v14
    v_and_b32 v30, v33, v15
    v_and_b32 v31, v33, v16
    s_nop 1
    v_mfma_f32_16x16x32_bf16 v[20:23], v[52:55], v[28:31], v[20:23]
    v_and_b32 v24, v34, v13
    v_and_b32 v25, v34, v14
    v_and_b32 v26, v34, v15
    v_and_b32 v27, v34, v16
    s_nop 1
    v_mfma_f32_16x16x32_bf16 v[20:23], v[56:59], v[24:27], v[20:23]
    v_and_b32 v28, v35, v13
    v_and_b32 v29, v35, v14
    v_and_b32 v30, v35, v15
    v_and_b32 v31, v35, v16
    s_nop 1
    v_mfma_f32_16x16x32_bf16 v[20:23], v[60:63], v[28:31], v[20:23]
    s_nop 7
    s_nop 1
    s_branch SD_120
SL_125:
    s_add_u32 s54, s52, 393216
    v_and_b32 v36, 15, v0
    v_lshlrev_b32 v36, 8, v36
    v_lshrrev_b32 v37, 4, v0
    v_lshl_add_u32 v36, v37, 4, v36
    buffer_load_dwordx4 v[48:51], v36, s[4:7], s54 offen offset:0
    buffer_load_dwordx4 v[52:55], v36, s[4:7], s54 offen offset:64
    buffer_load_dwordx4 v[56:59], v36, s[4:7], s54 offen offset:128
    buffer_load_dwordx4 v[60:63], v36, s[4:7], s54 offen offset:192
    s_waitcnt vmcnt(0)
    v_mfma_f32_16x16x32_bf16 v[24:27], v[48:51], v[64:67], 0
    v_mfma_f32_16x16x32_bf16 v[24:27], v[52:55], v[68:71], v[24:27]
    v_mfma_f32_16x16x32_bf16 v[24:27], v[56:59], v[72:75], v[24:27]
    v_mfma_f32_16x16x32_bf16 v[24:27], v[60:63], v[76:79], v[24:27]
    s_nop 7
    v_fma_f32 v28, v24, s55, v17
    v_fma_f32 v29, v25, s55, v17
    v_fma_f32 v30, v26, s55, v17
    v_fma_f32 v31, v27, s55, v17
    v_max3_f32 v36, v28, v29, v30
    v_max_f32 v36, v36, v31
    v_cmp_lt_f32 vcc, s56, v36
    s_cbranch_vccnz RS_315
RB_316:
    buffer_load_dwordx4 v[48:51], v8, s[8:11], s54 offen offset:0
    buffer_load_dwordx4 v[52:55], v8, s[8:11], s54 offen offset:256
    buffer_load_dwordx4 v[56:59], v8, s[8:11], s54 offen offset:512
    buffer_load_dwordx4 v[60:63], v8, s[8:11], s54 offen offset:768
    v_exp_f32 v28, v28
    v_exp_f32 v29, v29
    v_exp_f32 v30, v30
    v_exp_f32 v31, v31
    v_cvt_pk_bf16_f32 v32, v28, v28
    v_add_f32 v18, v18, v28
    v_cvt_pk_bf16_f32 v33, v29, v29
    v_add_f32 v19, v19, v29
    v_cvt_pk_bf16_f32 v34, v30, v30
    v_add_f32 v18, v18, v30
    v_cvt_pk_bf16_f32 v35, v31, v31
    v_add_f32 v19, v19, v31
    s_waitcnt vmcnt(0)
    v_and_b32 v24, v32, v13
    v_and_b32 v25, v32, v14
    v_and_b32 v26, v32, v15
    v_and_b32 v27, v32, v16
    s_nop 1
    v_mfma_f32_16x16x32_bf16 v[20:23], v[48:51], v[24:27], v[20:23]
    v_and_b32 v28, v33, v13
    v_and_b32 v29, v33, v14
    v_and_b32 v30, v33, v15
    v_and_b32 v31, v33, v16
    s_nop 1
    v_mfma_f32_16x16x32_bf16 v[20:23], v[52:55], v[28:31], v[20:23]
    v_and_b32 v24, v34, v13
    v_and_b32 v25, v34, v14
    v_and_b32 v26, v34, v15
    v_and_b32 v27, v34, v16
    s_nop 1
    v_mfma_f32_16x16x32_bf16 v[20:23], v[56:59], v[24:27], v[20:23]
    v_and_b32 v28, v35, v13
    v_and_b32 v29, v35, v14
    v_and_b32 v30, v35, v15
    v_and_b32 v31, v35, v16
    s_nop 1
    v_mfma_f32_16x16x32_bf16 v[20:23], v[60:63], v[28:31], v[20:23]
    s_nop 7
    s_nop 1
    s_branch SD_126
SL_131:
    s_add_u32 s54, s52, 458752
    v_and_b32 v36, 15, v0
    v_lshlrev_b32 v36, 8, v36
    v_lshrrev_b32 v37, 4, v0
    v_lshl_add_u32 v36, v37, 4, v36
    buffer_load_dwordx4 v[48:51], v36, s[4:7], s54 offen offset:0
    buffer_load_dwordx4 v[52:55], v36, s[4:7], s54 offen offset:64
    buffer_load_dwordx4 v[56:59], v36, s[4:7], s54 offen offset:128
    buffer_load_dwordx4 v[60:63], v36, s[4:7], s54 offen offset:192
    s_waitcnt vmcnt(0)
    v_mfma_f32_16x16x32_bf16 v[24:27], v[48:51], v[64:67], 0
    v_mfma_f32_16x16x32_bf16 v[24:27], v[52:55], v[68:71], v[24:27]
    v_mfma_f32_16x16x32_bf16 v[24:27], v[56:59], v[72:75], v[24:27]
    v_mfma_f32_16x16x32_bf16 v[24:27], v[60:63], v[76:79], v[24:27]
    s_nop 7
    v_fma_f32 v28, v24, s55, v17
    v_fma_f32 v29, v25, s55, v17
    v_fma_f32 v30, v26, s55, v17
    v_fma_f32 v31, v27, s55, v17
    v_max3_f32 v36, v28, v29, v30
    v_max_f32 v36, v36, v31
    v_cmp_lt_f32 vcc, s56, v36
    s_cbranch_vccnz RS_317
RB_318:
    buffer_load_dwordx4 v[48:51], v8, s[8:11], s54 offen offset:0
    buffer_load_dwordx4 v[52:55], v8, s[8:11], s54 offen offset:256
    buffer_load_dwordx4 v[56:59], v8, s[8:11], s54 offen offset:512
    buffer_load_dwordx4 v[60:63], v8, s[8:11], s54 offen offset:768
    v_exp_f32 v28, v28
    v_exp_f32 v29, v29
    v_exp_f32 v30, v30
    v_exp_f32 v31, v31
    v_cvt_pk_bf16_f32 v32, v28, v28
    v_add_f32 v18, v18, v28
    v_cvt_pk_bf16_f32 v33, v29, v29
    v_add_f32 v19, v19, v29
    v_cvt_pk_bf16_f32 v34, v30, v30
    v_add_f32 v18, v18, v30
    v_cvt_pk_bf16_f32 v35, v31, v31
    v_add_f32 v19, v19, v31
    s_waitcnt vmcnt(0)
    v_and_b32 v24, v32, v13
    v_and_b32 v25, v32, v14
    v_and_b32 v26, v32, v15
    v_and_b32 v27, v32, v16
    s_nop 1
    v_mfma_f32_16x16x32_bf16 v[20:23], v[48:51], v[24:27], v[20:23]
    v_and_b32 v28, v33, v13
    v_and_b32 v29, v33, v14
    v_and_b32 v30, v33, v15
    v_and_b32 v31, v33, v16
    s_nop 1
    v_mfma_f32_16x16x32_bf16 v[20:23], v[52:55], v[28:31], v[20:23]
    v_and_b32 v24, v34, v13
    v_and_b32 v25, v34, v14
    v_and_b32 v26, v34, v15
    v_and_b32 v27, v34, v16
    s_nop 1
    v_mfma_f32_16x16x32_bf16 v[20:23], v[56:59], v[24:27], v[20:23]
    v_and_b32 v28, v35, v13
    v_and_b32 v29, v35, v14
    v_and_b32 v30, v35, v15
    v_and_b32 v31, v35, v16
    s_nop 1
    v_mfma_f32_16x16x32_bf16 v[20:23], v[60:63], v[28:31], v[20:23]
    s_nop 7
    s_nop 1
    s_branch SD_132
SL_139:
    s_add_u32 s54, s52, 524288
    v_and_b32 v36, 15, v0
    v_lshlrev_b32 v36, 8, v36
    v_lshrrev_b32 v37, 4, v0
    v_lshl_add_u32 v36, v37, 4, v36
    buffer_load_dwordx4 v[48:51], v36, s[4:7], s54 offen offset:0
    buffer_load_dwordx4 v[52:55], v36, s[4:7], s54 offen offset:64
    buffer_load_dwordx4 v[56:59], v36, s[4:7], s54 offen offset:128
    buffer_load_dwordx4 v[60:63], v36, s[4:7], s54 offen offset:192
    s_waitcnt vmcnt(0)
    v_mfma_f32_16x16x32_bf16 v[24:27], v[48:51], v[64:67], 0
    v_mfma_f32_16x16x32_bf16 v[24:27], v[52:55], v[68:71], v[24:27]
    v_mfma_f32_16x16x32_bf16 v[24:27], v[56:59], v[72:75], v[24:27]
    v_mfma_f32_16x16x32_bf16 v[24:27], v[60:63], v[76:79], v[24:27]
    s_nop 7
    v_fma_f32 v28, v24, s55, v17
    v_fma_f32 v29, v25, s55, v17
    v_fma_f32 v30, v26, s55, v17
    v_fma_f32 v31, v27, s55, v17
    v_max3_f32 v36, v28, v29, v30
    v_max_f32 v36, v36, v31
    v_cmp_lt_f32 vcc, s56, v36
    s_cbranch_vccnz RS_319
RB_320:
    buffer_load_dwordx4 v[48:51], v8, s[8:11], s54 offen offset:0
    buffer_load_dwordx4 v[52:55], v8, s[8:11], s54 offen offset:256
    buffer_load_dwordx4 v[56:59], v8, s[8:11], s54 offen offset:512
    buffer_load_dwordx4 v[60:63], v8, s[8:11], s54 offen offset:768
    v_exp_f32 v28, v28
    v_exp_f32 v29, v29
    v_exp_f32 v30, v30
    v_exp_f32 v31, v31
    v_cvt_pk_bf16_f32 v32, v28, v28
    v_add_f32 v18, v18, v28
    v_cvt_pk_bf16_f32 v33, v29, v29
    v_add_f32 v19, v19, v29
    v_cvt_pk_bf16_f32 v34, v30, v30
    v_add_f32 v18, v18, v30
    v_cvt_pk_bf16_f32 v35, v31, v31
    v_add_f32 v19, v19, v31
    s_waitcnt vmcnt(0)
    v_and_b32 v24, v32, v13
    v_and_b32 v25, v32, v14
    v_and_b32 v26, v32, v15
    v_and_b32 v27, v32, v16
    s_nop 1
    v_mfma_f32_16x16x32_bf16 v[20:23], v[48:51], v[24:27], v[20:23]
    v_and_b32 v28, v33, v13
    v_and_b32 v29, v33, v14
    v_and_b32 v30, v33, v15
    v_and_b32 v31, v33, v16
    s_nop 1
    v_mfma_f32_16x16x32_bf16 v[20:23], v[52:55], v[28:31], v[20:23]
    v_and_b32 v24, v34, v13
    v_and_b32 v25, v34, v14
    v_and_b32 v26, v34, v15
    v_and_b32 v27, v34, v16
    s_nop 1
    v_mfma_f32_16x16x32_bf16 v[20:23], v[56:59], v[24:27], v[20:23]
    v_and_b32 v28, v35, v13
    v_and_b32 v29, v35, v14
    v_and_b32 v30, v35, v15
    v_and_b32 v31, v35, v16
    s_nop 1
    v_mfma_f32_16x16x32_bf16 v[20:23], v[60:63], v[28:31], v[20:23]
    s_nop 7
    s_nop 1
    s_branch SD_140
SL_145:
    s_add_u32 s54, s52, 589824
    v_and_b32 v36, 15, v0
    v_lshlrev_b32 v36, 8, v36
    v_lshrrev_b32 v37, 4, v0
    v_lshl_add_u32 v36, v37, 4, v36
    buffer_load_dwordx4 v[48:51], v36, s[4:7], s54 offen offset:0
    buffer_load_dwordx4 v[52:55], v36, s[4:7], s54 offen offset:64
    buffer_load_dwordx4 v[56:59], v36, s[4:7], s54 offen offset:128
    buffer_load_dwordx4 v[60:63], v36, s[4:7], s54 offen offset:192
    s_waitcnt vmcnt(0)
    v_mfma_f32_16x16x32_bf16 v[24:27], v[48:51], v[64:67], 0
    v_mfma_f32_16x16x32_bf16 v[24:27], v[52:55], v[68:71], v[24:27]
    v_mfma_f32_16x16x32_bf16 v[24:27], v[56:59], v[72:75], v[24:27]
    v_mfma_f32_16x16x32_bf16 v[24:27], v[60:63], v[76:79], v[24:27]
    s_nop 7
    v_fma_f32 v28, v24, s55, v17
    v_fma_f32 v29, v25, s55, v17
    v_fma_f32 v30, v26, s55, v17
    v_fma_f32 v31, v27, s55, v17
    v_max3_f32 v36, v28, v29, v30
    v_max_f32 v36, v36, v31
    v_cmp_lt_f32 vcc, s56, v36
    s_cbranch_vccnz RS_321
RB_322:
    buffer_load_dwordx4 v[48:51], v8, s[8:11], s54 offen offset:0
    buffer_load_dwordx4 v[52:55], v8, s[8:11], s54 offen offset:256
    buffer_load_dwordx4 v[56:59], v8, s[8:11], s54 offen offset:512
    buffer_load_dwordx4 v[60:63], v8, s[8:11], s54 offen offset:768
    v_exp_f32 v28, v28
    v_exp_f32 v29, v29
    v_exp_f32 v30, v30
    v_exp_f32 v31, v31
    v_cvt_pk_bf16_f32 v32, v28, v28
    v_add_f32 v18, v18, v28
    v_cvt_pk_bf16_f32 v33, v29, v29
    v_add_f32 v19, v19, v29
    v_cvt_pk_bf16_f32 v34, v30, v30
    v_add_f32 v18, v18, v30
    v_cvt_pk_bf16_f32 v35, v31, v31
    v_add_f32 v19, v19, v31
    s_waitcnt vmcnt(0)
    v_and_b32 v24, v32, v13
    v_and_b32 v25, v32, v14
    v_and_b32 v26, v32, v15
    v_and_b32 v27, v32, v16
    s_nop 1
    v_mfma_f32_16x16x32_bf16 v[20:23], v[48:51], v[24:27], v[20:23]
    v_and_b32 v28, v33, v13
    v_and_b32 v29, v33, v14
    v_and_b32 v30, v33, v15
    v_and_b32 v31, v33, v16
    s_nop 1
    v_mfma_f32_16x16x32_bf16 v[20:23], v[52:55], v[28:31], v[20:23]
    v_and_b32 v24, v34, v13
    v_and_b32 v25, v34, v14
    v_and_b32 v26, v34, v15
    v_and_b32 v27, v34, v16
    s_nop 1
    v_mfma_f32_16x16x32_bf16 v[20:23], v[56:59], v[24:27], v[20:23]
    v_and_b32 v28, v35, v13
    v_and_b32 v29, v35, v14
    v_and_b32 v30, v35, v15
    v_and_b32 v31, v35, v16
    s_nop 1
    v_mfma_f32_16x16x32_bf16 v[20:23], v[60:63], v[28:31], v[20:23]
    s_nop 7
    s_nop 1
    s_branch SD_146
SL_151:
    s_add_u32 s54, s52, 655360
    v_and_b32 v36, 15, v0
    v_lshlrev_b32 v36, 8, v36
    v_lshrrev_b32 v37, 4, v0
    v_lshl_add_u32 v36, v37, 4, v36
    buffer_load_dwordx4 v[48:51], v36, s[4:7], s54 offen offset:0
    buffer_load_dwordx4 v[52:55], v36, s[4:7], s54 offen offset:64
    buffer_load_dwordx4 v[56:59], v36, s[4:7], s54 offen offset:128
    buffer_load_dwordx4 v[60:63], v36, s[4:7], s54 offen offset:192
    s_waitcnt vmcnt(0)
    v_mfma_f32_16x16x32_bf16 v[24:27], v[48:51], v[64:67], 0
    v_mfma_f32_16x16x32_bf16 v[24:27], v[52:55], v[68:71], v[24:27]
    v_mfma_f32_16x16x32_bf16 v[24:27], v[56:59], v[72:75], v[24:27]
    v_mfma_f32_16x16x32_bf16 v[24:27], v[60:63], v[76:79], v[24:27]
    s_nop 7
    v_fma_f32 v28, v24, s55, v17
    v_fma_f32 v29, v25, s55, v17
    v_fma_f32 v30, v26, s55, v17
    v_fma_f32 v31, v27, s55, v17
    v_max3_f32 v36, v28, v29, v30
    v_max_f32 v36, v36, v31
    v_cmp_lt_f32 vcc, s56, v36
    s_cbranch_vccnz RS_323
RB_324:
    buffer_load_dwordx4 v[48:51], v8, s[8:11], s54 offen offset:0
    buffer_load_dwordx4 v[52:55], v8, s[8:11], s54 offen offset:256
    buffer_load_dwordx4 v[56:59], v8, s[8:11], s54 offen offset:512
    buffer_load_dwordx4 v[60:63], v8, s[8:11], s54 offen offset:768
    v_exp_f32 v28, v28
    v_exp_f32 v29, v29
    v_exp_f32 v30, v30
    v_exp_f32 v31, v31
    v_cvt_pk_bf16_f32 v32, v28, v28
    v_add_f32 v18, v18, v28
    v_cvt_pk_bf16_f32 v33, v29, v29
    v_add_f32 v19, v19, v29
    v_cvt_pk_bf16_f32 v34, v30, v30
    v_add_f32 v18, v18, v30
    v_cvt_pk_bf16_f32 v35, v31, v31
    v_add_f32 v19, v19, v31
    s_waitcnt vmcnt(0)
    v_and_b32 v24, v32, v13
    v_and_b32 v25, v32, v14
    v_and_b32 v26, v32, v15
    v_and_b32 v27, v32, v16
    s_nop 1
    v_mfma_f32_16x16x32_bf16 v[20:23], v[48:51], v[24:27], v[20:23]
    v_and_b32 v28, v33, v13
    v_and_b32 v29, v33, v14
    v_and_b32 v30, v33, v15
    v_and_b32 v31, v33, v16
    s_nop 1
    v_mfma_f32_16x16x32_bf16 v[20:23], v[52:55], v[28:31], v[20:23]
    v_and_b32 v24, v34, v13
    v_and_b32 v25, v34, v14
    v_and_b32 v26, v34, v15
    v_and_b32 v27, v34, v16
    s_nop 1
    v_mfma_f32_16x16x32_bf16 v[20:23], v[56:59], v[24:27], v[20:23]
    v_and_b32 v28, v35, v13
    v_and_b32 v29, v35, v14
    v_and_b32 v30, v35, v15
    v_and_b32 v31, v35, v16
    s_nop 1
    v_mfma_f32_16x16x32_bf16 v[20:23], v[60:63], v[28:31], v[20:23]
    s_nop 7
    s_nop 1
    s_branch SD_152
SL_159:
    s_add_u32 s54, s52, 720896
    v_and_b32 v36, 15, v0
    v_lshlrev_b32 v36, 8, v36
    v_lshrrev_b32 v37, 4, v0
    v_lshl_add_u32 v36, v37, 4, v36
    buffer_load_dwordx4 v[48:51], v36, s[4:7], s54 offen offset:0
    buffer_load_dwordx4 v[52:55], v36, s[4:7], s54 offen offset:64
    buffer_load_dwordx4 v[56:59], v36, s[4:7], s54 offen offset:128
    buffer_load_dwordx4 v[60:63], v36, s[4:7], s54 offen offset:192
    s_waitcnt vmcnt(0)
    v_mfma_f32_16x16x32_bf16 v[24:27], v[48:51], v[64:67], 0
    v_mfma_f32_16x16x32_bf16 v[24:27], v[52:55], v[68:71], v[24:27]
    v_mfma_f32_16x16x32_bf16 v[24:27], v[56:59], v[72:75], v[24:27]
    v_mfma_f32_16x16x32_bf16 v[24:27], v[60:63], v[76:79], v[24:27]
    s_nop 7
    v_fma_f32 v28, v24, s55, v17
    v_fma_f32 v29, v25, s55, v17
    v_fma_f32 v30, v26, s55, v17
    v_fma_f32 v31, v27, s55, v17
    v_max3_f32 v36, v28, v29, v30
    v_max_f32 v36, v36, v31
    v_cmp_lt_f32 vcc, s56, v36
    s_cbranch_vccnz RS_325
RB_326:
    buffer_load_dwordx4 v[48:51], v8, s[8:11], s54 offen offset:0
    buffer_load_dwordx4 v[52:55], v8, s[8:11], s54 offen offset:256
    buffer_load_dwordx4 v[56:59], v8, s[8:11], s54 offen offset:512
    buffer_load_dwordx4 v[60:63], v8, s[8:11], s54 offen offset:768
    v_exp_f32 v28, v28
    v_exp_f32 v29, v29
    v_exp_f32 v30, v30
    v_exp_f32 v31, v31
    v_cvt_pk_bf16_f32 v32, v28, v28
    v_add_f32 v18, v18, v28
    v_cvt_pk_bf16_f32 v33, v29, v29
    v_add_f32 v19, v19, v29
    v_cvt_pk_bf16_f32 v34, v30, v30
    v_add_f32 v18, v18, v30
    v_cvt_pk_bf16_f32 v35, v31, v31
    v_add_f32 v19, v19, v31
    s_waitcnt vmcnt(0)
    v_and_b32 v24, v32, v13
    v_and_b32 v25, v32, v14
    v_and_b32 v26, v32, v15
    v_and_b32 v27, v32, v16
    s_nop 1
    v_mfma_f32_16x16x32_bf16 v[20:23], v[48:51], v[24:27], v[20:23]
    v_and_b32 v28, v33, v13
    v_and_b32 v29, v33, v14
    v_and_b32 v30, v33, v15
    v_and_b32 v31, v33, v16
    s_nop 1
    v_mfma_f32_16x16x32_bf16 v[20:23], v[52:55], v[28:31], v[20:23]
    v_and_b32 v24, v34, v13
    v_and_b32 v25, v34, v14
    v_and_b32 v26, v34, v15
    v_and_b32 v27, v34, v16
    s_nop 1
    v_mfma_f32_16x16x32_bf16 v[20:23], v[56:59], v[24:27], v[20:23]
    v_and_b32 v28, v35, v13
    v_and_b32 v29, v35, v14
    v_and_b32 v30, v35, v15
    v_and_b32 v31, v35, v16
    s_nop 1
    v_mfma_f32_16x16x32_bf16 v[20:23], v[60:63], v[28:31], v[20:23]
    s_nop 7
    s_nop 1
    s_branch SD_160
SL_165:
    s_add_u32 s54, s52, 786432
    v_and_b32 v36, 15, v0
    v_lshlrev_b32 v36, 8, v36
    v_lshrrev_b32 v37, 4, v0
    v_lshl_add_u32 v36, v37, 4, v36
    buffer_load_dwordx4 v[48:51], v36, s[4:7], s54 offen offset:0
    buffer_load_dwordx4 v[52:55], v36, s[4:7], s54 offen offset:64
    buffer_load_dwordx4 v[56:59], v36, s[4:7], s54 offen offset:128
    buffer_load_dwordx4 v[60:63], v36, s[4:7], s54 offen offset:192
    s_waitcnt vmcnt(0)
    v_mfma_f32_16x16x32_bf16 v[24:27], v[48:51], v[64:67], 0
    v_mfma_f32_16x16x32_bf16 v[24:27], v[52:55], v[68:71], v[24:27]
    v_mfma_f32_16x16x32_bf16 v[24:27], v[56:59], v[72:75], v[24:27]
    v_mfma_f32_16x16x32_bf16 v[24:27], v[60:63], v[76:79], v[24:27]
    s_nop 7
    v_fma_f32 v28, v24, s55, v17
    v_fma_f32 v29, v25, s55, v17
    v_fma_f32 v30, v26, s55, v17
    v_fma_f32 v31, v27, s55, v17
    v_max3_f32 v36, v28, v29, v30
    v_max_f32 v36, v36, v31
    v_cmp_lt_f32 vcc, s56, v36
    s_cbranch_vccnz RS_327
RB_328:
    buffer_load_dwordx4 v[48:51], v8, s[8:11], s54 offen offset:0
    buffer_load_dwordx4 v[52:55], v8, s[8:11], s54 offen offset:256
    buffer_load_dwordx4 v[56:59], v8, s[8:11], s54 offen offset:512
    buffer_load_dwordx4 v[60:63], v8, s[8:11], s54 offen offset:768
    v_exp_f32 v28, v28
    v_exp_f32 v29, v29
    v_exp_f32 v30, v30
    v_exp_f32 v31, v31
    v_cvt_pk_bf16_f32 v32, v28, v28
    v_add_f32 v18, v18, v28
    v_cvt_pk_bf16_f32 v33, v29, v29
    v_add_f32 v19, v19, v29
    v_cvt_pk_bf16_f32 v34, v30, v30
    v_add_f32 v18, v18, v30
    v_cvt_pk_bf16_f32 v35, v31, v31
    v_add_f32 v19, v19, v31
    s_waitcnt vmcnt(0)
    v_and_b32 v24, v32, v13
    v_and_b32 v25, v32, v14
    v_and_b32 v26, v32, v15
    v_and_b32 v27, v32, v16
    s_nop 1
    v_mfma_f32_16x16x32_bf16 v[20:23], v[48:51], v[24:27], v[20:23]
    v_and_b32 v28, v33, v13
    v_and_b32 v29, v33, v14
    v_and_b32 v30, v33, v15
    v_and_b32 v31, v33, v16
    s_nop 1
    v_mfma_f32_16x16x32_bf16 v[20:23], v[52:55], v[28:31], v[20:23]
    v_and_b32 v24, v34, v13
    v_and_b32 v25, v34, v14
    v_and_b32 v26, v34, v15
    v_and_b32 v27, v34, v16
    s_nop 1
    v_mfma_f32_16x16x32_bf16 v[20:23], v[56:59], v[24:27], v[20:23]
    v_and_b32 v28, v35, v13
    v_and_b32 v29, v35, v14
    v_and_b32 v30, v35, v15
    v_and_b32 v31, v35, v16
    s_nop 1
    v_mfma_f32_16x16x32_bf16 v[20:23], v[60:63], v[28:31], v[20:23]
    s_nop 7
    s_nop 1
    s_branch SD_166
SL_171:
    s_add_u32 s54, s52, 851968
    v_and_b32 v36, 15, v0
    v_lshlrev_b32 v36, 8, v36
    v_lshrrev_b32 v37, 4, v0
    v_lshl_add_u32 v36, v37, 4, v36
    buffer_load_dwordx4 v[48:51], v36, s[4:7], s54 offen offset:0
    buffer_load_dwordx4 v[52:55], v36, s[4:7], s54 offen offset:64
    buffer_load_dwordx4 v[56:59], v36, s[4:7], s54 offen offset:128
    buffer_load_dwordx4 v[60:63], v36, s[4:7], s54 offen offset:192
    s_waitcnt vmcnt(0)
    v_mfma_f32_16x16x32_bf16 v[24:27], v[48:51], v[64:67], 0
    v_mfma_f32_16x16x32_bf16 v[24:27], v[52:55], v[68:71], v[24:27]
    v_mfma_f32_16x16x32_bf16 v[24:27], v[56:59], v[72:75], v[24:27]
    v_mfma_f32_16x16x32_bf16 v[24:27], v[60:63], v[76:79], v[24:27]
    s_nop 7
    v_fma_f32 v28, v24, s55, v17
    v_fma_f32 v29, v25, s55, v17
    v_fma_f32 v30, v26, s55, v17
    v_fma_f32 v31, v27, s55, v17
    v_max3_f32 v36, v28, v29, v30
    v_max_f32 v36, v36, v31
    v_cmp_lt_f32 vcc, s56, v36
    s_cbranch_vccnz RS_329
RB_330:
    buffer_load_dwordx4 v[48:51], v8, s[8:11], s54 offen offset:0
    buffer_load_dwordx4 v[52:55], v8, s[8:11], s54 offen offset:256
    buffer_load_dwordx4 v[56:59], v8, s[8:11], s54 offen offset:512
    buffer_load_dwordx4 v[60:63], v8, s[8:11], s54 offen offset:768
    v_exp_f32 v28, v28
    v_exp_f32 v29, v29
    v_exp_f32 v30, v30
    v_exp_f32 v31, v31
    v_cvt_pk_bf16_f32 v32, v28, v28
    v_add_f32 v18, v18, v28
    v_cvt_pk_bf16_f32 v33, v29, v29
    v_add_f32 v19, v19, v29
    v_cvt_pk_bf16_f32 v34, v30, v30
    v_add_f32 v18, v18, v30
    v_cvt_pk_bf16_f32 v35, v31, v31
    v_add_f32 v19, v19, v31
    s_waitcnt vmcnt(0)
    v_and_b32 v24, v32, v13
    v_and_b32 v25, v32, v14
    v_and_b32 v26, v32, v15
    v_and_b32 v27, v32, v16
    s_nop 1
    v_mfma_f32_16x16x32_bf16 v[20:23], v[48:51], v[24:27], v[20:23]
    v_and_b32 v28, v33, v13
    v_and_b32 v29, v33, v14
    v_and_b32 v30, v33, v15
    v_and_b32 v31, v33, v16
    s_nop 1
    v_mfma_f32_16x16x32_bf16 v[20:23], v[52:55], v[28:31], v[20:23]
    v_and_b32 v24, v34, v13
    v_and_b32 v25, v34, v14
    v_and_b32 v26, v34, v15
    v_and_b32 v27, v34, v16
    s_nop 1
    v_mfma_f32_16x16x32_bf16 v[20:23], v[56:59], v[24:27], v[20:23]
    v_and_b32 v28, v35, v13
    v_and_b32 v29, v35, v14
    v_and_b32 v30, v35, v15
    v_and_b32 v31, v35, v16
    s_nop 1
    v_mfma_f32_16x16x32_bf16 v[20:23], v[60:63], v[28:31], v[20:23]
    s_nop 7
    s_nop 1
    s_branch SD_172
SL_179:
    s_add_u32 s54, s52, 917504
    v_and_b32 v36, 15, v0
    v_lshlrev_b32 v36, 8, v36
    v_lshrrev_b32 v37, 4, v0
    v_lshl_add_u32 v36, v37, 4, v36
    buffer_load_dwordx4 v[48:51], v36, s[4:7], s54 offen offset:0
    buffer_load_dwordx4 v[52:55], v36, s[4:7], s54 offen offset:64
    buffer_load_dwordx4 v[56:59], v36, s[4:7], s54 offen offset:128
    buffer_load_dwordx4 v[60:63], v36, s[4:7], s54 offen offset:192
    s_waitcnt vmcnt(0)
    v_mfma_f32_16x16x32_bf16 v[24:27], v[48:51], v[64:67], 0
    v_mfma_f32_16x16x32_bf16 v[24:27], v[52:55], v[68:71], v[24:27]
    v_mfma_f32_16x16x32_bf16 v[24:27], v[56:59], v[72:75], v[24:27]
    v_mfma_f32_16x16x32_bf16 v[24:27], v[60:63], v[76:79], v[24:27]
    s_nop 7
    v_fma_f32 v28, v24, s55, v17
    v_fma_f32 v29, v25, s55, v17
    v_fma_f32 v30, v26, s55, v17
    v_fma_f32 v31, v27, s55, v17
    v_max3_f32 v36, v28, v29, v30
    v_max_f32 v36, v36, v31
    v_cmp_lt_f32 vcc, s56, v36
    s_cbranch_vccnz RS_331
RB_332:
    buffer_load_dwordx4 v[48:51], v8, s[8:11], s54 offen offset:0
    buffer_load_dwordx4 v[52:55], v8, s[8:11], s54 offen offset:256
    buffer_load_dwordx4 v[56:59], v8, s[8:11], s54 offen offset:512
    buffer_load_dwordx4 v[60:63], v8, s[8:11], s54 offen offset:768
    v_exp_f32 v28, v28
    v_exp_f32 v29, v29
    v_exp_f32 v30, v30
    v_exp_f32 v31, v31
    v_cvt_pk_bf16_f32 v32, v28, v28
    v_add_f32 v18, v18, v28
    v_cvt_pk_bf16_f32 v33, v29, v29
    v_add_f32 v19, v19, v29
    v_cvt_pk_bf16_f32 v34, v30, v30
    v_add_f32 v18, v18, v30
    v_cvt_pk_bf16_f32 v35, v31, v31
    v_add_f32 v19, v19, v31
    s_waitcnt vmcnt(0)
    v_and_b32 v24, v32, v13
    v_and_b32 v25, v32, v14
    v_and_b32 v26, v32, v15
    v_and_b32 v27, v32, v16
    s_nop 1
    v_mfma_f32_16x16x32_bf16 v[20:23], v[48:51], v[24:27], v[20:23]
    v_and_b32 v28, v33, v13
    v_and_b32 v29, v33, v14
    v_and_b32 v30, v33, v15
    v_and_b32 v31, v33, v16
    s_nop 1
    v_mfma_f32_16x16x32_bf16 v[20:23], v[52:55], v[28:31], v[20:23]
    v_and_b32 v24, v34, v13
    v_and_b32 v25, v34, v14
    v_and_b32 v26, v34, v15
    v_and_b32 v27, v34, v16
    s_nop 1
    v_mfma_f32_16x16x32_bf16 v[20:23], v[56:59], v[24:27], v[20:23]
    v_and_b32 v28, v35, v13
    v_and_b32 v29, v35, v14
    v_and_b32 v30, v35, v15
    v_and_b32 v31, v35, v16
    s_nop 1
    v_mfma_f32_16x16x32_bf16 v[20:23], v[60:63], v[28:31], v[20:23]
    s_nop 7
    s_nop 1
    s_branch SD_180
SL_185:
    s_add_u32 s54, s52, 983040
    v_and_b32 v36, 15, v0
    v_lshlrev_b32 v36, 8, v36
    v_lshrrev_b32 v37, 4, v0
    v_lshl_add_u32 v36, v37, 4, v36
    buffer_load_dwordx4 v[48:51], v36, s[4:7], s54 offen offset:0
    buffer_load_dwordx4 v[52:55], v36, s[4:7], s54 offen offset:64
    buffer_load_dwordx4 v[56:59], v36, s[4:7], s54 offen offset:128
    buffer_load_dwordx4 v[60:63], v36, s[4:7], s54 offen offset:192
    s_waitcnt vmcnt(0)
    v_mfma_f32_16x16x32_bf16 v[24:27], v[48:51], v[64:67], 0
    v_mfma_f32_16x16x32_bf16 v[24:27], v[52:55], v[68:71], v[24:27]
    v_mfma_f32_16x16x32_bf16 v[24:27], v[56:59], v[72:75], v[24:27]
    v_mfma_f32_16x16x32_bf16 v[24:27], v[60:63], v[76:79], v[24:27]
    s_nop 7
    v_fma_f32 v28, v24, s55, v17
    v_fma_f32 v29, v25, s55, v17
    v_fma_f32 v30, v26, s55, v17
    v_fma_f32 v31, v27, s55, v17
    v_max3_f32 v36, v28, v29, v30
    v_max_f32 v36, v36, v31
    v_cmp_lt_f32 vcc, s56, v36
    s_cbranch_vccnz RS_333
RB_334:
    buffer_load_dwordx4 v[48:51], v8, s[8:11], s54 offen offset:0
    buffer_load_dwordx4 v[52:55], v8, s[8:11], s54 offen offset:256
    buffer_load_dwordx4 v[56:59], v8, s[8:11], s54 offen offset:512
    buffer_load_dwordx4 v[60:63], v8, s[8:11], s54 offen offset:768
    v_exp_f32 v28, v28
    v_exp_f32 v29, v29
    v_exp_f32 v30, v30
    v_exp_f32 v31, v31
    v_cvt_pk_bf16_f32 v32, v28, v28
    v_add_f32 v18, v18, v28
    v_cvt_pk_bf16_f32 v33, v29, v29
    v_add_f32 v19, v19, v29
    v_cvt_pk_bf16_f32 v34, v30, v30
    v_add_f32 v18, v18, v30
    v_cvt_pk_bf16_f32 v35, v31, v31
    v_add_f32 v19, v19, v31
    s_waitcnt vmcnt(0)
    v_and_b32 v24, v32, v13
    v_and_b32 v25, v32, v14
    v_and_b32 v26, v32, v15
    v_and_b32 v27, v32, v16
    s_nop 1
    v_mfma_f32_16x16x32_bf16 v[20:23], v[48:51], v[24:27], v[20:23]
    v_and_b32 v28, v33, v13
    v_and_b32 v29, v33, v14
    v_and_b32 v30, v33, v15
    v_and_b32 v31, v33, v16
    s_nop 1
    v_mfma_f32_16x16x32_bf16 v[20:23], v[52:55], v[28:31], v[20:23]
    v_and_b32 v24, v34, v13
    v_and_b32 v25, v34, v14
    v_and_b32 v26, v34, v15
    v_and_b32 v27, v34, v16
    s_nop 1
    v_mfma_f32_16x16x32_bf16 v[20:23], v[56:59], v[24:27], v[20:23]
    v_and_b32 v28, v35, v13
    v_and_b32 v29, v35, v14
    v_and_b32 v30, v35, v15
    v_and_b32 v31, v35, v16
    s_nop 1
    v_mfma_f32_16x16x32_bf16 v[20:23], v[60:63], v[28:31], v[20:23]
    s_nop 7
    s_nop 1
    s_branch SD_186
SL_192:
    s_add_u32 s54, s89, 0
    v_and_b32 v36, 15, v0
    v_lshlrev_b32 v36, 8, v36
    v_lshrrev_b32 v37, 4, v0
    v_lshl_add_u32 v36, v37, 4, v36
    buffer_load_dwordx4 v[48:51], v36, s[4:7], s54 offen offset:0
    buffer_load_dwordx4 v[52:55], v36, s[4:7], s54 offen offset:64
    buffer_load_dwordx4 v[56:59], v36, s[4:7], s54 offen offset:128
    buffer_load_dwordx4 v[60:63], v36, s[4:7], s54 offen offset:192
    s_waitcnt vmcnt(0)
    v_mfma_f32_16x16x32_bf16 v[24:27], v[48:51], v[64:67], 0
    v_mfma_f32_16x16x32_bf16 v[24:27], v[52:55], v[68:71], v[24:27]
    v_mfma_f32_16x16x32_bf16 v[24:27], v[56:59], v[72:75], v[24:27]
    v_mfma_f32_16x16x32_bf16 v[24:27], v[60:63], v[76:79], v[24:27]
    s_nop 7
    v_fma_f32 v28, v24, s55, v17
    v_fma_f32 v29, v25, s55, v17
    v_fma_f32 v30, v26, s55, v17
    v_fma_f32 v31, v27, s55, v17
    v_max3_f32 v36, v28, v29, v30
    v_max_f32 v36, v36, v31
    v_cmp_lt_f32 vcc, s56, v36
    s_cbranch_vccnz RS_335
RB_336:
    buffer_load_dwordx4 v[48:51], v8, s[8:11], s54 offen offset:0
    buffer_load_dwordx4 v[52:55], v8, s[8:11], s54 offen offset:256
    buffer_load_dwordx4 v[56:59], v8, s[8:11], s54 offen offset:512
    buffer_load_dwordx4 v[60:63], v8, s[8:11], s54 offen offset:768
    v_exp_f32 v28, v28
    v_exp_f32 v29, v29
    v_exp_f32 v30, v30
    v_exp_f32 v31, v31
    v_cvt_pk_bf16_f32 v32, v28, v28
    v_add_f32 v18, v18, v28
    v_cvt_pk_bf16_f32 v33, v29, v29
    v_add_f32 v19, v19, v29
    v_cvt_pk_bf16_f32 v34, v30, v30
    v_add_f32 v18, v18, v30
    v_cvt_pk_bf16_f32 v35, v31, v31
    v_add_f32 v19, v19, v31
    s_waitcnt vmcnt(0)
    v_and_b32 v24, v32, v13
    v_and_b32 v25, v32, v14
    v_and_b32 v26, v32, v15
    v_and_b32 v27, v32, v16
    s_nop 1
    v_mfma_f32_16x16x32_bf16 v[20:23], v[48:51], v[24:27], v[20:23]
    v_and_b32 v28, v33, v13
    v_and_b32 v29, v33, v14
    v_and_b32 v30, v33, v15
    v_and_b32 v31, v33, v16
    s_nop 1
    v_mfma_f32_16x16x32_bf16 v[20:23], v[52:55], v[28:31], v[20:23]
    v_and_b32 v24, v34, v13
    v_and_b32 v25, v34, v14
    v_and_b32 v26, v34, v15
    v_and_b32 v27, v34, v16
    s_nop 1
    v_mfma_f32_16x16x32_bf16 v[20:23], v[56:59], v[24:27], v[20:23]
    v_and_b32 v28, v35, v13
    v_and_b32 v29, v35, v14
    v_and_b32 v30, v35, v15
    v_and_b32 v31, v35, v16
    s_nop 1
    v_mfma_f32_16x16x32_bf16 v[20:23], v[60:63], v[28:31], v[20:23]
    s_nop 7
    s_nop 1
    s_branch SD_193
SL_201:
    s_add_u32 s54, s89, 4096
    v_and_b32 v36, 15, v0
    v_lshlrev_b32 v36, 8, v36
    v_lshrrev_b32 v37, 4, v0
    v_lshl_add_u32 v36, v37, 4, v36
    buffer_load_dwordx4 v[48:51], v36, s[4:7], s54 offen offset:0
    buffer_load_dwordx4 v[52:55], v36, s[4:7], s54 offen offset:64
    buffer_load_dwordx4 v[56:59], v36, s[4:7], s54 offen offset:128
    buffer_load_dwordx4 v[60:63], v36, s[4:7], s54 offen offset:192
    s_waitcnt vmcnt(0)
    v_mfma_f32_16x16x32_bf16 v[24:27], v[48:51], v[64:67], 0
    v_mfma_f32_16x16x32_bf16 v[24:27], v[52:55], v[68:71], v[24:27]
    v_mfma_f32_16x16x32_bf16 v[24:27], v[56:59], v[72:75], v[24:27]
    v_mfma_f32_16x16x32_bf16 v[24:27], v[60:63], v[76:79], v[24:27]
    s_nop 7
    v_fma_f32 v28, v24, s55, v17
    v_fma_f32 v29, v25, s55, v17
    v_fma_f32 v30, v26, s55, v17
    v_fma_f32 v31, v27, s55, v17
    v_max3_f32 v36, v28, v29, v30
    v_max_f32 v36, v36, v31
    v_cmp_lt_f32 vcc, s56, v36
    s_cbranch_vccnz RS_337
RB_338:
    buffer_load_dwordx4 v[48:51], v8, s[8:11], s54 offen offset:0
    buffer_load_dwordx4 v[52:55], v8, s[8:11], s54 offen offset:256
    buffer_load_dwordx4 v[56:59], v8, s[8:11], s54 offen offset:512
    buffer_load_dwordx4 v[60:63], v8, s[8:11], s54 offen offset:768
    v_exp_f32 v28, v28
    v_exp_f32 v29, v29
    v_exp_f32 v30, v30
    v_exp_f32 v31, v31
    v_cvt_pk_bf16_f32 v32, v28, v28
    v_add_f32 v18, v18, v28
    v_cvt_pk_bf16_f32 v33, v29, v29
    v_add_f32 v19, v19, v29
    v_cvt_pk_bf16_f32 v34, v30, v30
    v_add_f32 v18, v18, v30
    v_cvt_pk_bf16_f32 v35, v31, v31
    v_add_f32 v19, v19, v31
    s_waitcnt vmcnt(0)
    v_and_b32 v24, v32, v13
    v_and_b32 v25, v32, v14
    v_and_b32 v26, v32, v15
    v_and_b32 v27, v32, v16
    s_nop 1
    v_mfma_f32_16x16x32_bf16 v[20:23], v[48:51], v[24:27], v[20:23]
    v_and_b32 v28, v33, v13
    v_and_b32 v29, v33, v14
    v_and_b32 v30, v33, v15
    v_and_b32 v31, v33, v16
    s_nop 1
    v_mfma_f32_16x16x32_bf16 v[20:23], v[52:55], v[28:31], v[20:23]
    v_and_b32 v24, v34, v13
    v_and_b32 v25, v34, v14
    v_and_b32 v26, v34, v15
    v_and_b32 v27, v34, v16
    s_nop 1
    v_mfma_f32_16x16x32_bf16 v[20:23], v[56:59], v[24:27], v[20:23]
    v_and_b32 v28, v35, v13
    v_and_b32 v29, v35, v14
    v_and_b32 v30, v35, v15
    v_and_b32 v31, v35, v16
    s_nop 1
    v_mfma_f32_16x16x32_bf16 v[20:23], v[60:63], v[28:31], v[20:23]
    s_nop 7
    s_nop 1
    s_branch SD_202
SL_210:
    s_add_u32 s54, s89, 8192
    v_and_b32 v36, 15, v0
    v_lshlrev_b32 v36, 8, v36
    v_lshrrev_b32 v37, 4, v0
    v_lshl_add_u32 v36, v37, 4, v36
    buffer_load_dwordx4 v[48:51], v36, s[4:7], s54 offen offset:0
    buffer_load_dwordx4 v[52:55], v36, s[4:7], s54 offen offset:64
    buffer_load_dwordx4 v[56:59], v36, s[4:7], s54 offen offset:128
    buffer_load_dwordx4 v[60:63], v36, s[4:7], s54 offen offset:192
    s_waitcnt vmcnt(0)
    v_mfma_f32_16x16x32_bf16 v[24:27], v[48:51], v[64:67], 0
    v_mfma_f32_16x16x32_bf16 v[24:27], v[52:55], v[68:71], v[24:27]
    v_mfma_f32_16x16x32_bf16 v[24:27], v[56:59], v[72:75], v[24:27]
    v_mfma_f32_16x16x32_bf16 v[24:27], v[60:63], v[76:79], v[24:27]
    s_nop 7
    v_fma_f32 v28, v24, s55, v17
    v_fma_f32 v29, v25, s55, v17
    v_fma_f32 v30, v26, s55, v17
    v_fma_f32 v31, v27, s55, v17
    v_max3_f32 v36, v28, v29, v30
    v_max_f32 v36, v36, v31
    v_cmp_lt_f32 vcc, s56, v36
    s_cbranch_vccnz RS_339
RB_340:
    buffer_load_dwordx4 v[48:51], v8, s[8:11], s54 offen offset:0
    buffer_load_dwordx4 v[52:55], v8, s[8:11], s54 offen offset:256
    buffer_load_dwordx4 v[56:59], v8, s[8:11], s54 offen offset:512
    buffer_load_dwordx4 v[60:63], v8, s[8:11], s54 offen offset:768
    v_exp_f32 v28, v28
    v_exp_f32 v29, v29
    v_exp_f32 v30, v30
    v_exp_f32 v31, v31
    v_cvt_pk_bf16_f32 v32, v28, v28
    v_add_f32 v18, v18, v28
    v_cvt_pk_bf16_f32 v33, v29, v29
    v_add_f32 v19, v19, v29
    v_cvt_pk_bf16_f32 v34, v30, v30
    v_add_f32 v18, v18, v30
    v_cvt_pk_bf16_f32 v35, v31, v31
    v_add_f32 v19, v19, v31
    s_waitcnt vmcnt(0)
    v_and_b32 v24, v32, v13
    v_and_b32 v25, v32, v14
    v_and_b32 v26, v32, v15
    v_and_b32 v27, v32, v16
    s_nop 1
    v_mfma_f32_16x16x32_bf16 v[20:23], v[48:51], v[24:27], v[20:23]
    v_and_b32 v28, v33, v13
    v_and_b32 v29, v33, v14
    v_and_b32 v30, v33, v15
    v_and_b32 v31, v33, v16
    s_nop 1
    v_mfma_f32_16x16x32_bf16 v[20:23], v[52:55], v[28:31], v[20:23]
    v_and_b32 v24, v34, v13
    v_and_b32 v25, v34, v14
    v_and_b32 v26, v34, v15
    v_and_b32 v27, v34, v16
    s_nop 1
    v_mfma_f32_16x16x32_bf16 v[20:23], v[56:59], v[24:27], v[20:23]
    v_and_b32 v28, v35, v13
    v_and_b32 v29, v35, v14
    v_and_b32 v30, v35, v15
    v_and_b32 v31, v35, v16
    s_nop 1
    v_mfma_f32_16x16x32_bf16 v[20:23], v[60:63], v[28:31], v[20:23]
    s_nop 7
    s_nop 1
    s_branch SD_211
SL_219:
    s_add_u32 s54, s89, 12288
    v_and_b32 v36, 15, v0
    v_lshlrev_b32 v36, 8, v36
    v_lshrrev_b32 v37, 4, v0
    v_lshl_add_u32 v36, v37, 4, v36
    buffer_load_dwordx4 v[48:51], v36, s[4:7], s54 offen offset:0
    buffer_load_dwordx4 v[52:55], v36, s[4:7], s54 offen offset:64
    buffer_load_dwordx4 v[56:59], v36, s[4:7], s54 offen offset:128
    buffer_load_dwordx4 v[60:63], v36, s[4:7], s54 offen offset:192
    s_waitcnt vmcnt(0)
    v_mfma_f32_16x16x32_bf16 v[24:27], v[48:51], v[64:67], 0
    v_mfma_f32_16x16x32_bf16 v[24:27], v[52:55], v[68:71], v[24:27]
    v_mfma_f32_16x16x32_bf16 v[24:27], v[56:59], v[72:75], v[24:27]
    v_mfma_f32_16x16x32_bf16 v[24:27], v[60:63], v[76:79], v[24:27]
    s_nop 7
    v_fma_f32 v28, v24, s55, v17
    v_fma_f32 v29, v25, s55, v17
    v_fma_f32 v30, v26, s55, v17
    v_fma_f32 v31, v27, s55, v17
    v_max3_f32 v36, v28, v29, v30
    v_max_f32 v36, v36, v31
    v_cmp_lt_f32 vcc, s56, v36
    s_cbranch_vccnz RS_341
RB_342:
    buffer_load_dwordx4 v[48:51], v8, s[8:11], s54 offen offset:0
    buffer_load_dwordx4 v[52:55], v8, s[8:11], s54 offen offset:256
    buffer_load_dwordx4 v[56:59], v8, s[8:11], s54 offen offset:512
    buffer_load_dwordx4 v[60:63], v8, s[8:11], s54 offen offset:768
    v_exp_f32 v28, v28
    v_exp_f32 v29, v29
    v_exp_f32 v30, v30
    v_exp_f32 v31, v31
    v_cvt_pk_bf16_f32 v32, v28, v28
    v_add_f32 v18, v18, v28
    v_cvt_pk_bf16_f32 v33, v29, v29
    v_add_f32 v19, v19, v29
    v_cvt_pk_bf16_f32 v34, v30, v30
    v_add_f32 v18, v18, v30
    v_cvt_pk_bf16_f32 v35, v31, v31
    v_add_f32 v19, v19, v31
    s_waitcnt vmcnt(0)
    v_and_b32 v24, v32, v13
    v_and_b32 v25, v32, v14
    v_and_b32 v26, v32, v15
    v_and_b32 v27, v32, v16
    s_nop 1
    v_mfma_f32_16x16x32_bf16 v[20:23], v[48:51], v[24:27], v[20:23]
    v_and_b32 v28, v33, v13
    v_and_b32 v29, v33, v14
    v_and_b32 v30, v33, v15
    v_and_b32 v31, v33, v16
    s_nop 1
    v_mfma_f32_16x16x32_bf16 v[20:23], v[52:55], v[28:31], v[20:23]
    v_and_b32 v24, v34, v13
    v_and_b32 v25, v34, v14
    v_and_b32 v26, v34, v15
    v_and_b32 v27, v34, v16
    s_nop 1
    v_mfma_f32_16x16x32_bf16 v[20:23], v[56:59], v[24:27], v[20:23]
    v_and_b32 v28, v35, v13
    v_and_b32 v29, v35, v14
    v_and_b32 v30, v35, v15
    v_and_b32 v31, v35, v16
    s_nop 1
    v_mfma_f32_16x16x32_bf16 v[20:23], v[60:63], v[28:31], v[20:23]
    s_nop 7
    s_nop 1
    s_branch SD_220
RS_39:
    v_max3_f32 v36, v24, v25, v26
    v_max_f32 v36, v36, v27
    v_mul_f32 v36, s55, v36
    v_mov_b32 v37, v36
    s_nop 1
    v_permlane16_swap_b32 v36, v37
    v_max_f32 v36, v36, v37
    v_mov_b32 v37, v36
    s_nop 1
    v_permlane32_swap_b32 v36, v37
    v_max_f32 v36, v36, v37
    v_ceil_f32 v36, v36
    v_max_f32 v36, v36, -v17
    v_add_f32 v37, v17, v36
    v_exp_f32 v37, -v37
    v_sub_f32 v17, 0, v36
    v_mul_f32 v20, v20, v37
    v_mul_f32 v21, v21, v37
    v_mul_f32 v22, v22, v37
    v_mul_f32 v23, v23, v37
    v_mul_f32 v18, v18, v37
    v_mul_f32 v19, v19, v37
    v_fma_f32 v28, v24, s55, v17
    v_fma_f32 v29, v25, s55, v17
    v_fma_f32 v30, v26, s55, v17
    v_fma_f32 v31, v27, s55, v17
    s_nop 1
    s_branch RB_40
RS_43:
    v_max3_f32 v36, v24, v25, v26
    v_max_f32 v36, v36, v27
    v_mul_f32 v36, s55, v36
    v_mov_b32 v37, v36
    s_nop 1
    v_permlane16_swap_b32 v36, v37
    v_max_f32 v36, v36, v37
    v_mov_b32 v37, v36
    s_nop 1
    v_permlane32_swap_b32 v36, v37
    v_max_f32 v36, v36, v37
    v_ceil_f32 v36, v36
    v_max_f32 v36, v36, -v17
    v_add_f32 v37, v17, v36
    v_exp_f32 v37, -v37
    v_sub_f32 v17, 0, v36
    v_mul_f32 v20, v20, v37
    v_mul_f32 v21, v21, v37
    v_mul_f32 v22, v22, v37
    v_mul_f32 v23, v23, v37
    v_mul_f32 v18, v18, v37
    v_mul_f32 v19, v19, v37
    v_fma_f32 v28, v24, s55, v17
    v_fma_f32 v29, v25, s55, v17
    v_fma_f32 v30, v26, s55, v17
    v_fma_f32 v31, v27, s55, v17
    s_nop 1
    s_branch RB_44
RS_47:
    v_max3_f32 v36, v24, v25, v26
    v_max_f32 v36, v36, v27
    v_mul_f32 v36, s55, v36
    v_mov_b32 v37, v36
    s_nop 1
    v_permlane16_swap_b32 v36, v37
    v_max_f32 v36, v36, v37
    v_mov_b32 v37, v36
    s_nop 1
    v_permlane32_swap_b32 v36, v37
    v_max_f32 v36, v36, v37
    v_ceil_f32 v36, v36
    v_max_f32 v36, v36, -v17
    v_add_f32 v37, v17, v36
    v_exp_f32 v37, -v37
    v_sub_f32 v17, 0, v36
    v_mul_f32 v20, v20, v37
    v_mul_f32 v21, v21, v37
    v_mul_f32 v22, v22, v37
    v_mul_f32 v23, v23, v37
    v_mul_f32 v18, v18, v37
    v_mul_f32 v19, v19, v37
    v_fma_f32 v28, v24, s55, v17
    v_fma_f32 v29, v25, s55, v17
    v_fma_f32 v30, v26, s55, v17
    v_fma_f32 v31, v27, s55, v17
    s_nop 1
    s_branch RB_48
RS_51:
    v_max3_f32 v36, v24, v25, v26
    v_max_f32 v36, v36, v27
    v_mul_f32 v36, s55, v36
    v_mov_b32 v37, v36
    s_nop 1
    v_permlane16_swap_b32 v36, v37
    v_max_f32 v36, v36, v37
    v_mov_b32 v37, v36
    s_nop 1
    v_permlane32_swap_b32 v36, v37
    v_max_f32 v36, v36, v37
    v_ceil_f32 v36, v36
    v_max_f32 v36, v36, -v17
    v_add_f32 v37, v17, v36
    v_exp_f32 v37, -v37
    v_sub_f32 v17, 0, v36
    v_mul_f32 v20, v20, v37
    v_mul_f32 v21, v21, v37
    v_mul_f32 v22, v22, v37
    v_mul_f32 v23, v23, v37
    v_mul_f32 v18, v18, v37
    v_mul_f32 v19, v19, v37
    v_fma_f32 v28, v24, s55, v17
    v_fma_f32 v29, v25, s55, v17
    v_fma_f32 v30, v26, s55, v17
    v_fma_f32 v31, v27, s55, v17
    s_nop 1
    s_branch RB_52
RS_53:
    v_max3_f32 v36, v24, v25, v26
    v_max_f32 v36, v36, v27
    v_mul_f32 v36, s55, v36
    v_mov_b32 v37, v36
    s_nop 1
    v_permlane16_swap_b32 v36, v37
    v_max_f32 v36, v36, v37
    v_mov_b32 v37, v36
    s_nop 1
    v_permlane32_swap_b32 v36, v37
    v_max_f32 v36, v36, v37
    v_ceil_f32 v36, v36
    v_max_f32 v36, v36, -v17
    v_add_f32 v37, v17, v36
    v_exp_f32 v37, -v37
    v_sub_f32 v17, 0, v36
    v_mul_f32 v20, v20, v37
    v_mul_f32 v21, v21, v37
    v_mul_f32 v22, v22, v37
    v_mul_f32 v23, v23, v37
    v_mul_f32 v18, v18, v37
    v_mul_f32 v19, v19, v37
    v_fma_f32 v28, v24, s55, v17
    v_fma_f32 v29, v25, s55, v17
    v_fma_f32 v30, v26, s55, v17
    v_fma_f32 v31, v27, s55, v17
    s_nop 1
    s_branch RB_54
RS_55:
    v_max3_f32 v36, v24, v25, v26
    v_max_f32 v36, v36, v27
    v_mul_f32 v36, s55, v36
    v_mov_b32 v37, v36
    s_nop 1
    v_permlane16_swap_b32 v36, v37
    v_max_f32 v36, v36, v37
    v_mov_b32 v37, v36
    s_nop 1
    v_permlane32_swap_b32 v36, v37
    v_max_f32 v36, v36, v37
    v_ceil_f32 v36, v36
    v_max_f32 v36, v36, -v17
    v_add_f32 v37, v17, v36
    v_exp_f32 v37, -v37
    v_sub_f32 v17, 0, v36
    v_mul_f32 v20, v20, v37
    v_mul_f32 v21, v21, v37
    v_mul_f32 v22, v22, v37
    v_mul_f32 v23, v23, v37
    v_mul_f32 v18, v18, v37
    v_mul_f32 v19, v19, v37
    v_fma_f32 v28, v24, s55, v17
    v_fma_f32 v29, v25, s55, v17
    v_fma_f32 v30, v26, s55, v17
    v_fma_f32 v31, v27, s55, v17
    s_nop 1
    s_branch RB_56
RS_59:
    v_max3_f32 v36, v24, v25, v26
    v_max_f32 v36, v36, v27
    v_mul_f32 v36, s55, v36
    v_mov_b32 v37, v36
    s_nop 1
    v_permlane16_swap_b32 v36, v37
    v_max_f32 v36, v36, v37
    v_mov_b32 v37, v36
    s_nop 1
    v_permlane32_swap_b32 v36, v37
    v_max_f32 v36, v36, v37
    v_ceil_f32 v36, v36
    v_max_f32 v36, v36, -v17
    v_add_f32 v37, v17, v36
    v_exp_f32 v37, -v37
    v_sub_f32 v17, 0, v36
    v_mul_f32 v20, v20, v37
    v_mul_f32 v21, v21, v37
    v_mul_f32 v22, v22, v37
    v_mul_f32 v23, v23, v37
    v_mul_f32 v18, v18, v37
    v_mul_f32 v19, v19, v37
    v_fma_f32 v28, v24, s55, v17
    v_fma_f32 v29, v25, s55, v17
    v_fma_f32 v30, v26, s55, v17
    v_fma_f32 v31, v27, s55, v17
    s_nop 1
    s_branch RB_60
RS_61:
    v_max3_f32 v36, v24, v25, v26
    v_max_f32 v36, v36, v27
    v_mul_f32 v36, s55, v36
    v_mov_b32 v37, v36
    s_nop 1
    v_permlane16_swap_b32 v36, v37
    v_max_f32 v36, v36, v37
    v_mov_b32 v37, v36
    s_nop 1
    v_permlane32_swap_b32 v36, v37
    v_max_f32 v36, v36, v37
    v_ceil_f32 v36, v36
    v_max_f32 v36, v36, -v17
    v_add_f32 v37, v17, v36
    v_exp_f32 v37, -v37
    v_sub_f32 v17, 0, v36
    v_mul_f32 v20, v20, v37
    v_mul_f32 v21, v21, v37
    v_mul_f32 v22, v22, v37
    v_mul_f32 v23, v23, v37
    v_mul_f32 v18, v18, v37
    v_mul_f32 v19, v19, v37
    v_fma_f32 v28, v24, s55, v17
    v_fma_f32 v29, v25, s55, v17
    v_fma_f32 v30, v26, s55, v17
    v_fma_f32 v31, v27, s55, v17
    s_nop 1
    s_branch RB_62
RS_63:
    v_max3_f32 v36, v24, v25, v26
    v_max_f32 v36, v36, v27
    v_mul_f32 v36, s55, v36
    v_mov_b32 v37, v36
    s_nop 1
    v_permlane16_swap_b32 v36, v37
    v_max_f32 v36, v36, v37
    v_mov_b32 v37, v36
    s_nop 1
    v_permlane32_swap_b32 v36, v37
    v_max_f32 v36, v36, v37
    v_ceil_f32 v36, v36
    v_max_f32 v36, v36, -v17
    v_add_f32 v37, v17, v36
    v_exp_f32 v37, -v37
    v_sub_f32 v17, 0, v36
    v_mul_f32 v20, v20, v37
    v_mul_f32 v21, v21, v37
    v_mul_f32 v22, v22, v37
    v_mul_f32 v23, v23, v37
    v_mul_f32 v18, v18, v37
    v_mul_f32 v19, v19, v37
    v_fma_f32 v28, v24, s55, v17
    v_fma_f32 v29, v25, s55, v17
    v_fma_f32 v30, v26, s55, v17
    v_fma_f32 v31, v27, s55, v17
    s_nop 1
    s_branch RB_64
RS_67:
    v_max3_f32 v36, v24, v25, v26
    v_max_f32 v36, v36, v27
    v_mul_f32 v36, s55, v36
    v_mov_b32 v37, v36
    s_nop 1
    v_permlane16_swap_b32 v36, v37
    v_max_f32 v36, v36, v37
    v_mov_b32 v37, v36
    s_nop 1
    v_permlane32_swap_b32 v36, v37
    v_max_f32 v36, v36, v37
    v_ceil_f32 v36, v36
    v_max_f32 v36, v36, -v17
    v_add_f32 v37, v17, v36
    v_exp_f32 v37, -v37
    v_sub_f32 v17, 0, v36
    v_mul_f32 v20, v20, v37
    v_mul_f32 v21, v21, v37
    v_mul_f32 v22, v22, v37
    v_mul_f32 v23, v23, v37
    v_mul_f32 v18, v18, v37
    v_mul_f32 v19, v19, v37
    v_fma_f32 v28, v24, s55, v17
    v_fma_f32 v29, v25, s55, v17
    v_fma_f32 v30, v26, s55, v17
    v_fma_f32 v31, v27, s55, v17
    s_nop 1
    s_branch RB_68
RS_69:
    v_max3_f32 v36, v24, v25, v26
    v_max_f32 v36, v36, v27
    v_mul_f32 v36, s55, v36
    v_mov_b32 v37, v36
    s_nop 1
    v_permlane16_swap_b32 v36, v37
    v_max_f32 v36, v36, v37
    v_mov_b32 v37, v36
    s_nop 1
    v_permlane32_swap_b32 v36, v37
    v_max_f32 v36, v36, v37
    v_ceil_f32 v36, v36
    v_max_f32 v36, v36, -v17
    v_add_f32 v37, v17, v36
    v_exp_f32 v37, -v37
    v_sub_f32 v17, 0, v36
    v_mul_f32 v20, v20, v37
    v_mul_f32 v21, v21, v37
    v_mul_f32 v22, v22, v37
    v_mul_f32 v23, v23, v37
    v_mul_f32 v18, v18, v37
    v_mul_f32 v19, v19, v37
    v_fma_f32 v28, v24, s55, v17
    v_fma_f32 v29, v25, s55, v17
    v_fma_f32 v30, v26, s55, v17
    v_fma_f32 v31, v27, s55, v17
    s_nop 1
    s_branch RB_70
RS_71:
    v_max3_f32 v36, v24, v25, v26
    v_max_f32 v36, v36, v27
    v_mul_f32 v36, s55, v36
    v_mov_b32 v37, v36
    s_nop 1
    v_permlane16_swap_b32 v36, v37
    v_max_f32 v36, v36, v37
    v_mov_b32 v37, v36
    s_nop 1
    v_permlane32_swap_b32 v36, v37
    v_max_f32 v36, v36, v37
    v_ceil_f32 v36, v36
    v_max_f32 v36, v36, -v17
    v_add_f32 v37, v17, v36
    v_exp_f32 v37, -v37
    v_sub_f32 v17, 0, v36
    v_mul_f32 v20, v20, v37
    v_mul_f32 v21, v21, v37
    v_mul_f32 v22, v22, v37
    v_mul_f32 v23, v23, v37
    v_mul_f32 v18, v18, v37
    v_mul_f32 v19, v19, v37
    v_fma_f32 v28, v24, s55, v17
    v_fma_f32 v29, v25, s55, v17
    v_fma_f32 v30, v26, s55, v17
    v_fma_f32 v31, v27, s55, v17
    s_nop 1
    s_branch RB_72
RS_75:
    v_max3_f32 v36, v24, v25, v26
    v_max_f32 v36, v36, v27
    v_mul_f32 v36, s55, v36
    v_mov_b32 v37, v36
    s_nop 1
    v_permlane16_swap_b32 v36, v37
    v_max_f32 v36, v36, v37
    v_mov_b32 v37, v36
    s_nop 1
    v_permlane32_swap_b32 v36, v37
    v_max_f32 v36, v36, v37
    v_ceil_f32 v36, v36
    v_max_f32 v36, v36, -v17
    v_add_f32 v37, v17, v36
    v_exp_f32 v37, -v37
    v_sub_f32 v17, 0, v36
    v_mul_f32 v20, v20, v37
    v_mul_f32 v21, v21, v37
    v_mul_f32 v22, v22, v37
    v_mul_f32 v23, v23, v37
    v_mul_f32 v18, v18, v37
    v_mul_f32 v19, v19, v37
    v_fma_f32 v28, v24, s55, v17
    v_fma_f32 v29, v25, s55, v17
    v_fma_f32 v30, v26, s55, v17
    v_fma_f32 v31, v27, s55, v17
    s_nop 1
    s_branch RB_76
RS_77:
    v_max3_f32 v36, v24, v25, v26
    v_max_f32 v36, v36, v27
    v_mul_f32 v36, s55, v36
    v_mov_b32 v37, v36
    s_nop 1
    v_permlane16_swap_b32 v36, v37
    v_max_f32 v36, v36, v37
    v_mov_b32 v37, v36
    s_nop 1
    v_permlane32_swap_b32 v36, v37
    v_max_f32 v36, v36, v37
    v_ceil_f32 v36, v36
    v_max_f32 v36, v36, -v17
    v_add_f32 v37, v17, v36
    v_exp_f32 v37, -v37
    v_sub_f32 v17, 0, v36
    v_mul_f32 v20, v20, v37
    v_mul_f32 v21, v21, v37
    v_mul_f32 v22, v22, v37
    v_mul_f32 v23, v23, v37
    v_mul_f32 v18, v18, v37
    v_mul_f32 v19, v19, v37
    v_fma_f32 v28, v24, s55, v17
    v_fma_f32 v29, v25, s55, v17
    v_fma_f32 v30, v26, s55, v17
    v_fma_f32 v31, v27, s55, v17
    s_nop 1
    s_branch RB_78
RS_79:
    v_max3_f32 v36, v24, v25, v26
    v_max_f32 v36, v36, v27
    v_mul_f32 v36, s55, v36
    v_mov_b32 v37, v36
    s_nop 1
    v_permlane16_swap_b32 v36, v37
    v_max_f32 v36, v36, v37
    v_mov_b32 v37, v36
    s_nop 1
    v_permlane32_swap_b32 v36, v37
    v_max_f32 v36, v36, v37
    v_ceil_f32 v36, v36
    v_max_f32 v36, v36, -v17
    v_add_f32 v37, v17, v36
    v_exp_f32 v37, -v37
    v_sub_f32 v17, 0, v36
    v_mul_f32 v20, v20, v37
    v_mul_f32 v21, v21, v37
    v_mul_f32 v22, v22, v37
    v_mul_f32 v23, v23, v37
    v_mul_f32 v18, v18, v37
    v_mul_f32 v19, v19, v37
    v_fma_f32 v28, v24, s55, v17
    v_fma_f32 v29, v25, s55, v17
    v_fma_f32 v30, v26, s55, v17
    v_fma_f32 v31, v27, s55, v17
    s_nop 1
    s_branch RB_80
RS_83:
    v_max3_f32 v36, v24, v25, v26
    v_max_f32 v36, v36, v27
    v_mul_f32 v36, s55, v36
    v_mov_b32 v37, v36
    s_nop 1
    v_permlane16_swap_b32 v36, v37
    v_max_f32 v36, v36, v37
    v_mov_b32 v37, v36
    s_nop 1
    v_permlane32_swap_b32 v36, v37
    v_max_f32 v36, v36, v37
    v_ceil_f32 v36, v36
    v_max_f32 v36, v36, -v17
    v_add_f32 v37, v17, v36
    v_exp_f32 v37, -v37
    v_sub_f32 v17, 0, v36
    v_mul_f32 v20, v20, v37
    v_mul_f32 v21, v21, v37
    v_mul_f32 v22, v22, v37
    v_mul_f32 v23, v23, v37
    v_mul_f32 v18, v18, v37
    v_mul_f32 v19, v19, v37
    v_fma_f32 v28, v24, s55, v17
    v_fma_f32 v29, v25, s55, v17
    v_fma_f32 v30, v26, s55, v17
    v_fma_f32 v31, v27, s55, v17
    s_nop 1
    s_branch RB_84
RS_87:
    v_max3_f32 v36, v24, v25, v26
    v_max_f32 v36, v36, v27
    v_mul_f32 v36, 0x568293ee, v36
    v_mov_b32 v37, v36
    s_nop 1
    v_permlane16_swap_b32 v36, v37
    v_max_f32 v36, v36, v37
    v_mov_b32 v37, v36
    s_nop 1
    v_permlane32_swap_b32 v36, v37
    v_max_f32 v36, v36, v37
    v_ceil_f32 v36, v36
    v_max_f32 v36, v36, -v17
    v_add_f32 v37, v17, v36
    v_exp_f32 v37, -v37
    v_sub_f32 v17, 0, v36
    v_mul_f32 v20, v20, v37
    v_mul_f32 v21, v21, v37
    v_mul_f32 v22, v22, v37
    v_mul_f32 v23, v23, v37
    v_mul_f32 v18, v18, v37
    v_mul_f32 v19, v19, v37
    v_fmamk_f32 v28, v24, 0x568293ee, v17
    v_fmamk_f32 v29, v25, 0x568293ee, v17
    v_fmamk_f32 v30, v26, 0x568293ee, v17
    v_fmamk_f32 v31, v27, 0x568293ee, v17
    s_nop 1
    s_branch RB_88
RS_89:
    v_max3_f32 v36, v24, v25, v26
    v_max_f32 v36, v36, v27
    v_mul_f32 v36, s55, v36
    v_mov_b32 v37, v36
    s_nop 1
    v_permlane16_swap_b32 v36, v37
    v_max_f32 v36, v36, v37
    v_mov_b32 v37, v36
    s_nop 1
    v_permlane32_swap_b32 v36, v37
    v_max_f32 v36, v36, v37
    v_ceil_f32 v36, v36
    v_max_f32 v36, v36, -v17
    v_add_f32 v37, v17, v36
    v_exp_f32 v37, -v37
    v_sub_f32 v17, 0, v36
    v_mul_f32 v20, v20, v37
    v_mul_f32 v21, v21, v37
    v_mul_f32 v22, v22, v37
    v_mul_f32 v23, v23, v37
    v_mul_f32 v18, v18, v37
    v_mul_f32 v19, v19, v37
    v_fma_f32 v28, v24, s55, v17
    v_fma_f32 v29, v25, s55, v17
    v_fma_f32 v30, v26, s55, v17
    v_fma_f32 v31, v27, s55, v17
    s_nop 1
    s_branch RB_90
RS_93:
    v_max3_f32 v36, v24, v25, v26
    v_max_f32 v36, v36, v27
    v_mul_f32 v36, 0x568293ee, v36
    v_mov_b32 v37, v36
    s_nop 1
    v_permlane16_swap_b32 v36, v37
    v_max_f32 v36, v36, v37
    v_mov_b32 v37, v36
    s_nop 1
    v_permlane32_swap_b32 v36, v37
    v_max_f32 v36, v36, v37
    v_ceil_f32 v36, v36
    v_max_f32 v36, v36, -v17
    v_add_f32 v37, v17, v36
    v_exp_f32 v37, -v37
    v_sub_f32 v17, 0, v36
    v_mul_f32 v20, v20, v37
    v_mul_f32 v21, v21, v37
    v_mul_f32 v22, v22, v37
    v_mul_f32 v23, v23, v37
    v_mul_f32 v18, v18, v37
    v_mul_f32 v19, v19, v37
    v_fmamk_f32 v28, v24, 0x568293ee, v17
    v_fmamk_f32 v29, v25, 0x568293ee, v17
    v_fmamk_f32 v30, v26, 0x568293ee, v17
    v_fmamk_f32 v31, v27, 0x568293ee, v17
    s_nop 1
    s_branch RB_94
RS_95:
    v_max3_f32 v36, v24, v25, v26
    v_max_f32 v36, v36, v27
    v_mul_f32 v36, s55, v36
    v_mov_b32 v37, v36
    s_nop 1
    v_permlane16_swap_b32 v36, v37
    v_max_f32 v36, v36, v37
    v_mov_b32 v37, v36
    s_nop 1
    v_permlane32_swap_b32 v36, v37
    v_max_f32 v36, v36, v37
    v_ceil_f32 v36, v36
    v_max_f32 v36, v36, -v17
    v_add_f32 v37, v17, v36
    v_exp_f32 v37, -v37
    v_sub_f32 v17, 0, v36
    v_mul_f32 v20, v20, v37
    v_mul_f32 v21, v21, v37
    v_mul_f32 v22, v22, v37
    v_mul_f32 v23, v23, v37
    v_mul_f32 v18, v18, v37
    v_mul_f32 v19, v19, v37
    v_fma_f32 v28, v24, s55, v17
    v_fma_f32 v29, v25, s55, v17
    v_fma_f32 v30, v26, s55, v17
    v_fma_f32 v31, v27, s55, v17
    s_nop 1
    s_branch RB_96
RS_101:
    v_max3_f32 v36, v24, v25, v26
    v_max_f32 v36, v36, v27
    v_mul_f32 v36, 0x568293ee, v36
    v_mov_b32 v37, v36
    s_nop 1
    v_permlane16_swap_b32 v36, v37
    v_max_f32 v36, v36, v37
    v_mov_b32 v37, v36
    s_nop 1
    v_permlane32_swap_b32 v36, v37
    v_max_f32 v36, v36, v37
    v_ceil_f32 v36, v36
    v_max_f32 v36, v36, -v17
    v_add_f32 v37, v17, v36
    v_exp_f32 v37, -v37
    v_sub_f32 v17, 0, v36
    v_mul_f32 v20, v20, v37
    v_mul_f32 v21, v21, v37
    v_mul_f32 v22, v22, v37
    v_mul_f32 v23, v23, v37
    v_mul_f32 v18, v18, v37
    v_mul_f32 v19, v19, v37
    v_fmamk_f32 v28, v24, 0x568293ee, v17
    v_fmamk_f32 v29, v25, 0x568293ee, v17
    v_fmamk_f32 v30, v26, 0x568293ee, v17
    v_fmamk_f32 v31, v27, 0x568293ee, v17
    s_nop 1
    s_branch RB_102
RS_103:
    v_max3_f32 v36, v24, v25, v26
    v_max_f32 v36, v36, v27
    v_mul_f32 v36, s55, v36
    v_mov_b32 v37, v36
    s_nop 1
    v_permlane16_swap_b32 v36, v37
    v_max_f32 v36, v36, v37
    v_mov_b32 v37, v36
    s_nop 1
    v_permlane32_swap_b32 v36, v37
    v_max_f32 v36, v36, v37
    v_ceil_f32 v36, v36
    v_max_f32 v36, v36, -v17
    v_add_f32 v37, v17, v36
    v_exp_f32 v37, -v37
    v_sub_f32 v17, 0, v36
    v_mul_f32 v20, v20, v37
    v_mul_f32 v21, v21, v37
    v_mul_f32 v22, v22, v37
    v_mul_f32 v23, v23, v37
    v_mul_f32 v18, v18, v37
    v_mul_f32 v19, v19, v37
    v_fma_f32 v28, v24, s55, v17
    v_fma_f32 v29, v25, s55, v17
    v_fma_f32 v30, v26, s55, v17
    v_fma_f32 v31, v27, s55, v17
    s_nop 1
    s_branch RB_104
RS_107:
    v_max3_f32 v36, v24, v25, v26
    v_max_f32 v36, v36, v27
    v_mul_f32 v36, 0x568293ee, v36
    v_mov_b32 v37, v36
    s_nop 1
    v_permlane16_swap_b32 v36, v37
    v_max_f32 v36, v36, v37
    v_mov_b32 v37, v36
    s_nop 1
    v_permlane32_swap_b32 v36, v37
    v_max_f32 v36, v36, v37
    v_ceil_f32 v36, v36
    v_max_f32 v36, v36, -v17
    v_add_f32 v37, v17, v36
    v_exp_f32 v37, -v37
    v_sub_f32 v17, 0, v36
    v_mul_f32 v20, v20, v37
    v_mul_f32 v21, v21, v37
    v_mul_f32 v22, v22, v37
    v_mul_f32 v23, v23, v37
    v_mul_f32 v18, v18, v37
    v_mul_f32 v19, v19, v37
    v_fmamk_f32 v28, v24, 0x568293ee, v17
    v_fmamk_f32 v29, v25, 0x568293ee, v17
    v_fmamk_f32 v30, v26, 0x568293ee, v17
    v_fmamk_f32 v31, v27, 0x568293ee, v17
    s_nop 1
    s_branch RB_108
RS_109:
    v_max3_f32 v36, v24, v25, v26
    v_max_f32 v36, v36, v27
    v_mul_f32 v36, s55, v36
    v_mov_b32 v37, v36
    s_nop 1
    v_permlane16_swap_b32 v36, v37
    v_max_f32 v36, v36, v37
    v_mov_b32 v37, v36
    s_nop 1
    v_permlane32_swap_b32 v36, v37
    v_max_f32 v36, v36, v37
    v_ceil_f32 v36, v36
    v_max_f32 v36, v36, -v17
    v_add_f32 v37, v17, v36
    v_exp_f32 v37, -v37
    v_sub_f32 v17, 0, v36
    v_mul_f32 v20, v20, v37
    v_mul_f32 v21, v21, v37
    v_mul_f32 v22, v22, v37
    v_mul_f32 v23, v23, v37
    v_mul_f32 v18, v18, v37
    v_mul_f32 v19, v19, v37
    v_fma_f32 v28, v24, s55, v17
    v_fma_f32 v29, v25, s55, v17
    v_fma_f32 v30, v26, s55, v17
    v_fma_f32 v31, v27, s55, v17
    s_nop 1
    s_branch RB_110
RS_113:
    v_max3_f32 v36, v24, v25, v26
    v_max_f32 v36, v36, v27
    v_mul_f32 v36, 0x568293ee, v36
    v_mov_b32 v37, v36
    s_nop 1
    v_permlane16_swap_b32 v36, v37
    v_max_f32 v36, v36, v37
    v_mov_b32 v37, v36
    s_nop 1
    v_permlane32_swap_b32 v36, v37
    v_max_f32 v36, v36, v37
    v_ceil_f32 v36, v36
    v_max_f32 v36, v36, -v17
    v_add_f32 v37, v17, v36
    v_exp_f32 v37, -v37
    v_sub_f32 v17, 0, v36
    v_mul_f32 v20, v20, v37
    v_mul_f32 v21, v21, v37
    v_mul_f32 v22, v22, v37
    v_mul_f32 v23, v23, v37
    v_mul_f32 v18, v18, v37
    v_mul_f32 v19, v19, v37
    v_fmamk_f32 v28, v24, 0x568293ee, v17
    v_fmamk_f32 v29, v25, 0x568293ee, v17
    v_fmamk_f32 v30, v26, 0x568293ee, v17
    v_fmamk_f32 v31, v27, 0x568293ee, v17
    s_nop 1
    s_branch RB_114
RS_115:
    v_max3_f32 v36, v24, v25, v26
    v_max_f32 v36, v36, v27
    v_mul_f32 v36, s55, v36
    v_mov_b32 v37, v36
    s_nop 1
    v_permlane16_swap_b32 v36, v37
    v_max_f32 v36, v36, v37
    v_mov_b32 v37, v36
    s_nop 1
    v_permlane32_swap_b32 v36, v37
    v_max_f32 v36, v36, v37
    v_ceil_f32 v36, v36
    v_max_f32 v36, v36, -v17
    v_add_f32 v37, v17, v36
    v_exp_f32 v37, -v37
    v_sub_f32 v17, 0, v36
    v_mul_f32 v20, v20, v37
    v_mul_f32 v21, v21, v37
    v_mul_f32 v22, v22, v37
    v_mul_f32 v23, v23, v37
    v_mul_f32 v18, v18, v37
    v_mul_f32 v19, v19, v37
    v_fma_f32 v28, v24, s55, v17
    v_fma_f32 v29, v25, s55, v17
    v_fma_f32 v30, v26, s55, v17
    v_fma_f32 v31, v27, s55, v17
    s_nop 1
    s_branch RB_116
RS_121:
    v_max3_f32 v36, v24, v25, v26
    v_max_f32 v36, v36, v27
    v_mul_f32 v36, 0x568293ee, v36
    v_mov_b32 v37, v36
    s_nop 1
    v_permlane16_swap_b32 v36, v37
    v_max_f32 v36, v36, v37
    v_mov_b32 v37, v36
    s_nop 1
    v_permlane32_swap_b32 v36, v37
    v_max_f32 v36, v36, v37
    v_ceil_f32 v36, v36
    v_max_f32 v36, v36, -v17
    v_add_f32 v37, v17, v36
    v_exp_f32 v37, -v37
    v_sub_f32 v17, 0, v36
    v_mul_f32 v20, v20, v37
    v_mul_f32 v21, v21, v37
    v_mul_f32 v22, v22, v37
    v_mul_f32 v23, v23, v37
    v_mul_f32 v18, v18, v37
    v_mul_f32 v19, v19, v37
    v_fmamk_f32 v28, v24, 0x568293ee, v17
    v_fmamk_f32 v29, v25, 0x568293ee, v17
    v_fmamk_f32 v30, v26, 0x568293ee, v17
    v_fmamk_f32 v31, v27, 0x568293ee, v17
    s_nop 1
    s_branch RB_122
RS_123:
    v_max3_f32 v36, v24, v25, v26
    v_max_f32 v36, v36, v27
    v_mul_f32 v36, s55, v36
    v_mov_b32 v37, v36
    s_nop 1
    v_permlane16_swap_b32 v36, v37
    v_max_f32 v36, v36, v37
    v_mov_b32 v37, v36
    s_nop 1
    v_permlane32_swap_b32 v36, v37
    v_max_f32 v36, v36, v37
    v_ceil_f32 v36, v36
    v_max_f32 v36, v36, -v17
    v_add_f32 v37, v17, v36
    v_exp_f32 v37, -v37
    v_sub_f32 v17, 0, v36
    v_mul_f32 v20, v20, v37
    v_mul_f32 v21, v21, v37
    v_mul_f32 v22, v22, v37
    v_mul_f32 v23, v23, v37
    v_mul_f32 v18, v18, v37
    v_mul_f32 v19, v19, v37
    v_fma_f32 v28, v24, s55, v17
    v_fma_f32 v29, v25, s55, v17
    v_fma_f32 v30, v26, s55, v17
    v_fma_f32 v31, v27, s55, v17
    s_nop 1
    s_branch RB_124
RS_127:
    v_max3_f32 v36, v24, v25, v26
    v_max_f32 v36, v36, v27
    v_mul_f32 v36, 0x568293ee, v36
    v_mov_b32 v37, v36
    s_nop 1
    v_permlane16_swap_b32 v36, v37
    v_max_f32 v36, v36, v37
    v_mov_b32 v37, v36
    s_nop 1
    v_permlane32_swap_b32 v36, v37
    v_max_f32 v36, v36, v37
    v_ceil_f32 v36, v36
    v_max_f32 v36, v36, -v17
    v_add_f32 v37, v17, v36
    v_exp_f32 v37, -v37
    v_sub_f32 v17, 0, v36
    v_mul_f32 v20, v20, v37
    v_mul_f32 v21, v21, v37
    v_mul_f32 v22, v22, v37
    v_mul_f32 v23, v23, v37
    v_mul_f32 v18, v18, v37
    v_mul_f32 v19, v19, v37
    v_fmamk_f32 v28, v24, 0x568293ee, v17
    v_fmamk_f32 v29, v25, 0x568293ee, v17
    v_fmamk_f32 v30, v26, 0x568293ee, v17
    v_fmamk_f32 v31, v27, 0x568293ee, v17
    s_nop 1
    s_branch RB_128
RS_129:
    v_max3_f32 v36, v24, v25, v26
    v_max_f32 v36, v36, v27
    v_mul_f32 v36, s55, v36
    v_mov_b32 v37, v36
    s_nop 1
    v_permlane16_swap_b32 v36, v37
    v_max_f32 v36, v36, v37
    v_mov_b32 v37, v36
    s_nop 1
    v_permlane32_swap_b32 v36, v37
    v_max_f32 v36, v36, v37
    v_ceil_f32 v36, v36
    v_max_f32 v36, v36, -v17
    v_add_f32 v37, v17, v36
    v_exp_f32 v37, -v37
    v_sub_f32 v17, 0, v36
    v_mul_f32 v20, v20, v37
    v_mul_f32 v21, v21, v37
    v_mul_f32 v22, v22, v37
    v_mul_f32 v23, v23, v37
    v_mul_f32 v18, v18, v37
    v_mul_f32 v19, v19, v37
    v_fma_f32 v28, v24, s55, v17
    v_fma_f32 v29, v25, s55, v17
    v_fma_f32 v30, v26, s55, v17
    v_fma_f32 v31, v27, s55, v17
    s_nop 1
    s_branch RB_130
RS_133:
    v_max3_f32 v36, v24, v25, v26
    v_max_f32 v36, v36, v27
    v_mul_f32 v36, 0x568293ee, v36
    v_mov_b32 v37, v36
    s_nop 1
    v_permlane16_swap_b32 v36, v37
    v_max_f32 v36, v36, v37
    v_mov_b32 v37, v36
    s_nop 1
    v_permlane32_swap_b32 v36, v37
    v_max_f32 v36, v36, v37
    v_ceil_f32 v36, v36
    v_max_f32 v36, v36, -v17
    v_add_f32 v37, v17, v36
    v_exp_f32 v37, -v37
    v_sub_f32 v17, 0, v36
    v_mul_f32 v20, v20, v37
    v_mul_f32 v21, v21, v37
    v_mul_f32 v22, v22, v37
    v_mul_f32 v23, v23, v37
    v_mul_f32 v18, v18, v37
    v_mul_f32 v19, v19, v37
    v_fmamk_f32 v28, v24, 0x568293ee, v17
    v_fmamk_f32 v29, v25, 0x568293ee, v17
    v_fmamk_f32 v30, v26, 0x568293ee, v17
    v_fmamk_f32 v31, v27, 0x568293ee, v17
    s_nop 1
    s_branch RB_134
RS_135:
    v_max3_f32 v36, v24, v25, v26
    v_max_f32 v36, v36, v27
    v_mul_f32 v36, s55, v36
    v_mov_b32 v37, v36
    s_nop 1
    v_permlane16_swap_b32 v36, v37
    v_max_f32 v36, v36, v37
    v_mov_b32 v37, v36
    s_nop 1
    v_permlane32_swap_b32 v36, v37
    v_max_f32 v36, v36, v37
    v_ceil_f32 v36, v36
    v_max_f32 v36, v36, -v17
    v_add_f32 v37, v17, v36
    v_exp_f32 v37, -v37
    v_sub_f32 v17, 0, v36
    v_mul_f32 v20, v20, v37
    v_mul_f32 v21, v21, v37
    v_mul_f32 v22, v22, v37
    v_mul_f32 v23, v23, v37
    v_mul_f32 v18, v18, v37
    v_mul_f32 v19, v19, v37
    v_fma_f32 v28, v24, s55, v17
    v_fma_f32 v29, v25, s55, v17
    v_fma_f32 v30, v26, s55, v17
    v_fma_f32 v31, v27, s55, v17
    s_nop 1
    s_branch RB_136
RS_141:
    v_max3_f32 v36, v24, v25, v26
    v_max_f32 v36, v36, v27
    v_mul_f32 v36, 0x568293ee, v36
    v_mov_b32 v37, v36
    s_nop 1
    v_permlane16_swap_b32 v36, v37
    v_max_f32 v36, v36, v37
    v_mov_b32 v37, v36
    s_nop 1
    v_permlane32_swap_b32 v36, v37
    v_max_f32 v36, v36, v37
    v_ceil_f32 v36, v36
    v_max_f32 v36, v36, -v17
    v_add_f32 v37, v17, v36
    v_exp_f32 v37, -v37
    v_sub_f32 v17, 0, v36
    v_mul_f32 v20, v20, v37
    v_mul_f32 v21, v21, v37
    v_mul_f32 v22, v22, v37
    v_mul_f32 v23, v23, v37
    v_mul_f32 v18, v18, v37
    v_mul_f32 v19, v19, v37
    v_fmamk_f32 v28, v24, 0x568293ee, v17
    v_fmamk_f32 v29, v25, 0x568293ee, v17
    v_fmamk_f32 v30, v26, 0x568293ee, v17
    v_fmamk_f32 v31, v27, 0x568293ee, v17
    s_nop 1
    s_branch RB_142
RS_143:
    v_max3_f32 v36, v24, v25, v26
    v_max_f32 v36, v36, v27
    v_mul_f32 v36, s55, v36
    v_mov_b32 v37, v36
    s_nop 1
    v_permlane16_swap_b32 v36, v37
    v_max_f32 v36, v36, v37
    v_mov_b32 v37, v36
    s_nop 1
    v_permlane32_swap_b32 v36, v37
    v_max_f32 v36, v36, v37
    v_ceil_f32 v36, v36
    v_max_f32 v36, v36, -v17
    v_add_f32 v37, v17, v36
    v_exp_f32 v37, -v37
    v_sub_f32 v17, 0, v36
    v_mul_f32 v20, v20, v37
    v_mul_f32 v21, v21, v37
    v_mul_f32 v22, v22, v37
    v_mul_f32 v23, v23, v37
    v_mul_f32 v18, v18, v37
    v_mul_f32 v19, v19, v37
    v_fma_f32 v28, v24, s55, v17
    v_fma_f32 v29, v25, s55, v17
    v_fma_f32 v30, v26, s55, v17
    v_fma_f32 v31, v27, s55, v17
    s_nop 1
    s_branch RB_144
RS_147:
    v_max3_f32 v36, v24, v25, v26
    v_max_f32 v36, v36, v27
    v_mul_f32 v36, 0x568293ee, v36
    v_mov_b32 v37, v36
    s_nop 1
    v_permlane16_swap_b32 v36, v37
    v_max_f32 v36, v36, v37
    v_mov_b32 v37, v36
    s_nop 1
    v_permlane32_swap_b32 v36, v37
    v_max_f32 v36, v36, v37
    v_ceil_f32 v36, v36
    v_max_f32 v36, v36, -v17
    v_add_f32 v37, v17, v36
    v_exp_f32 v37, -v37
    v_sub_f32 v17, 0, v36
    v_mul_f32 v20, v20, v37
    v_mul_f32 v21, v21, v37
    v_mul_f32 v22, v22, v37
    v_mul_f32 v23, v23, v37
    v_mul_f32 v18, v18, v37
    v_mul_f32 v19, v19, v37
    v_fmamk_f32 v28, v24, 0x568293ee, v17
    v_fmamk_f32 v29, v25, 0x568293ee, v17
    v_fmamk_f32 v30, v26, 0x568293ee, v17
    v_fmamk_f32 v31, v27, 0x568293ee, v17
    s_nop 1
    s_branch RB_148
RS_149:
    v_max3_f32 v36, v24, v25, v26
    v_max_f32 v36, v36, v27
    v_mul_f32 v36, s55, v36
    v_mov_b32 v37, v36
    s_nop 1
    v_permlane16_swap_b32 v36, v37
    v_max_f32 v36, v36, v37
    v_mov_b32 v37, v36
    s_nop 1
    v_permlane32_swap_b32 v36, v37
    v_max_f32 v36, v36, v37
    v_ceil_f32 v36, v36
    v_max_f32 v36, v36, -v17
    v_add_f32 v37, v17, v36
    v_exp_f32 v37, -v37
    v_sub_f32 v17, 0, v36
    v_mul_f32 v20, v20, v37
    v_mul_f32 v21, v21, v37
    v_mul_f32 v22, v22, v37
    v_mul_f32 v23, v23, v37
    v_mul_f32 v18, v18, v37
    v_mul_f32 v19, v19, v37
    v_fma_f32 v28, v24, s55, v17
    v_fma_f32 v29, v25, s55, v17
    v_fma_f32 v30, v26, s55, v17
    v_fma_f32 v31, v27, s55, v17
    s_nop 1
    s_branch RB_150
RS_153:
    v_max3_f32 v36, v24, v25, v26
    v_max_f32 v36, v36, v27
    v_mul_f32 v36, 0x568293ee, v36
    v_mov_b32 v37, v36
    s_nop 1
    v_permlane16_swap_b32 v36, v37
    v_max_f32 v36, v36, v37
    v_mov_b32 v37, v36
    s_nop 1
    v_permlane32_swap_b32 v36, v37
    v_max_f32 v36, v36, v37
    v_ceil_f32 v36, v36
    v_max_f32 v36, v36, -v17
    v_add_f32 v37, v17, v36
    v_exp_f32 v37, -v37
    v_sub_f32 v17, 0, v36
    v_mul_f32 v20, v20, v37
    v_mul_f32 v21, v21, v37
    v_mul_f32 v22, v22, v37
    v_mul_f32 v23, v23, v37
    v_mul_f32 v18, v18, v37
    v_mul_f32 v19, v19, v37
    v_fmamk_f32 v28, v24, 0x568293ee, v17
    v_fmamk_f32 v29, v25, 0x568293ee, v17
    v_fmamk_f32 v30, v26, 0x568293ee, v17
    v_fmamk_f32 v31, v27, 0x568293ee, v17
    s_nop 1
    s_branch RB_154
RS_155:
    v_max3_f32 v36, v24, v25, v26
    v_max_f32 v36, v36, v27
    v_mul_f32 v36, s55, v36
    v_mov_b32 v37, v36
    s_nop 1
    v_permlane16_swap_b32 v36, v37
    v_max_f32 v36, v36, v37
    v_mov_b32 v37, v36
    s_nop 1
    v_permlane32_swap_b32 v36, v37
    v_max_f32 v36, v36, v37
    v_ceil_f32 v36, v36
    v_max_f32 v36, v36, -v17
    v_add_f32 v37, v17, v36
    v_exp_f32 v37, -v37
    v_sub_f32 v17, 0, v36
    v_mul_f32 v20, v20, v37
    v_mul_f32 v21, v21, v37
    v_mul_f32 v22, v22, v37
    v_mul_f32 v23, v23, v37
    v_mul_f32 v18, v18, v37
    v_mul_f32 v19, v19, v37
    v_fma_f32 v28, v24, s55, v17
    v_fma_f32 v29, v25, s55, v17
    v_fma_f32 v30, v26, s55, v17
    v_fma_f32 v31, v27, s55, v17
    s_nop 1
    s_branch RB_156
RS_161:
    v_max3_f32 v36, v24, v25, v26
    v_max_f32 v36, v36, v27
    v_mul_f32 v36, 0x568293ee, v36
    v_mov_b32 v37, v36
    s_nop 1
    v_permlane16_swap_b32 v36, v37
    v_max_f32 v36, v36, v37
    v_mov_b32 v37, v36
    s_nop 1
    v_permlane32_swap_b32 v36, v37
    v_max_f32 v36, v36, v37
    v_ceil_f32 v36, v36
    v_max_f32 v36, v36, -v17
    v_add_f32 v37, v17, v36
    v_exp_f32 v37, -v37
    v_sub_f32 v17, 0, v36
    v_mul_f32 v20, v20, v37
    v_mul_f32 v21, v21, v37
    v_mul_f32 v22, v22, v37
    v_mul_f32 v23, v23, v37
    v_mul_f32 v18, v18, v37
    v_mul_f32 v19, v19, v37
    v_fmamk_f32 v28, v24, 0x568293ee, v17
    v_fmamk_f32 v29, v25, 0x568293ee, v17
    v_fmamk_f32 v30, v26, 0x568293ee, v17
    v_fmamk_f32 v31, v27, 0x568293ee, v17
    s_nop 1
    s_branch RB_162
RS_163:
    v_max3_f32 v36, v24, v25, v26
    v_max_f32 v36, v36, v27
    v_mul_f32 v36, s55, v36
    v_mov_b32 v37, v36
    s_nop 1
    v_permlane16_swap_b32 v36, v37
    v_max_f32 v36, v36, v37
    v_mov_b32 v37, v36
    s_nop 1
    v_permlane32_swap_b32 v36, v37
    v_max_f32 v36, v36, v37
    v_ceil_f32 v36, v36
    v_max_f32 v36, v36, -v17
    v_add_f32 v37, v17, v36
    v_exp_f32 v37, -v37
    v_sub_f32 v17, 0, v36
    v_mul_f32 v20, v20, v37
    v_mul_f32 v21, v21, v37
    v_mul_f32 v22, v22, v37
    v_mul_f32 v23, v23, v37
    v_mul_f32 v18, v18, v37
    v_mul_f32 v19, v19, v37
    v_fma_f32 v28, v24, s55, v17
    v_fma_f32 v29, v25, s55, v17
    v_fma_f32 v30, v26, s55, v17
    v_fma_f32 v31, v27, s55, v17
    s_nop 1
    s_branch RB_164
RS_167:
    v_max3_f32 v36, v24, v25, v26
    v_max_f32 v36, v36, v27
    v_mul_f32 v36, 0x568293ee, v36
    v_mov_b32 v37, v36
    s_nop 1
    v_permlane16_swap_b32 v36, v37
    v_max_f32 v36, v36, v37
    v_mov_b32 v37, v36
    s_nop 1
    v_permlane32_swap_b32 v36, v37
    v_max_f32 v36, v36, v37
    v_ceil_f32 v36, v36
    v_max_f32 v36, v36, -v17
    v_add_f32 v37, v17, v36
    v_exp_f32 v37, -v37
    v_sub_f32 v17, 0, v36
    v_mul_f32 v20, v20, v37
    v_mul_f32 v21, v21, v37
    v_mul_f32 v22, v22, v37
    v_mul_f32 v23, v23, v37
    v_mul_f32 v18, v18, v37
    v_mul_f32 v19, v19, v37
    v_fmamk_f32 v28, v24, 0x568293ee, v17
    v_fmamk_f32 v29, v25, 0x568293ee, v17
    v_fmamk_f32 v30, v26, 0x568293ee, v17
    v_fmamk_f32 v31, v27, 0x568293ee, v17
    s_nop 1
    s_branch RB_168
RS_169:
    v_max3_f32 v36, v24, v25, v26
    v_max_f32 v36, v36, v27
    v_mul_f32 v36, s55, v36
    v_mov_b32 v37, v36
    s_nop 1
    v_permlane16_swap_b32 v36, v37
    v_max_f32 v36, v36, v37
    v_mov_b32 v37, v36
    s_nop 1
    v_permlane32_swap_b32 v36, v37
    v_max_f32 v36, v36, v37
    v_ceil_f32 v36, v36
    v_max_f32 v36, v36, -v17
    v_add_f32 v37, v17, v36
    v_exp_f32 v37, -v37
    v_sub_f32 v17, 0, v36
    v_mul_f32 v20, v20, v37
    v_mul_f32 v21, v21, v37
    v_mul_f32 v22, v22, v37
    v_mul_f32 v23, v23, v37
    v_mul_f32 v18, v18, v37
    v_mul_f32 v19, v19, v37
    v_fma_f32 v28, v24, s55, v17
    v_fma_f32 v29, v25, s55, v17
    v_fma_f32 v30, v26, s55, v17
    v_fma_f32 v31, v27, s55, v17
    s_nop 1
    s_branch RB_170
RS_173:
    v_max3_f32 v36, v24, v25, v26
    v_max_f32 v36, v36, v27
    v_mul_f32 v36, 0x568293ee, v36
    v_mov_b32 v37, v36
    s_nop 1
    v_permlane16_swap_b32 v36, v37
    v_max_f32 v36, v36, v37
    v_mov_b32 v37, v36
    s_nop 1
    v_permlane32_swap_b32 v36, v37
    v_max_f32 v36, v36, v37
    v_ceil_f32 v36, v36
    v_max_f32 v36, v36, -v17
    v_add_f32 v37, v17, v36
    v_exp_f32 v37, -v37
    v_sub_f32 v17, 0, v36
    v_mul_f32 v20, v20, v37
    v_mul_f32 v21, v21, v37
    v_mul_f32 v22, v22, v37
    v_mul_f32 v23, v23, v37
    v_mul_f32 v18, v18, v37
    v_mul_f32 v19, v19, v37
    v_fmamk_f32 v28, v24, 0x568293ee, v17
    v_fmamk_f32 v29, v25, 0x568293ee, v17
    v_fmamk_f32 v30, v26, 0x568293ee, v17
    v_fmamk_f32 v31, v27, 0x568293ee, v17
    s_nop 1
    s_branch RB_174
RS_175:
    v_max3_f32 v36, v24, v25, v26
    v_max_f32 v36, v36, v27
    v_mul_f32 v36, s55, v36
    v_mov_b32 v37, v36
    s_nop 1
    v_permlane16_swap_b32 v36, v37
    v_max_f32 v36, v36, v37
    v_mov_b32 v37, v36
    s_nop 1
    v_permlane32_swap_b32 v36, v37
    v_max_f32 v36, v36, v37
    v_ceil_f32 v36, v36
    v_max_f32 v36, v36, -v17
    v_add_f32 v37, v17, v36
    v_exp_f32 v37, -v37
    v_sub_f32 v17, 0, v36
    v_mul_f32 v20, v20, v37
    v_mul_f32 v21, v21, v37
    v_mul_f32 v22, v22, v37
    v_mul_f32 v23, v23, v37
    v_mul_f32 v18, v18, v37
    v_mul_f32 v19, v19, v37
    v_fma_f32 v28, v24, s55, v17
    v_fma_f32 v29, v25, s55, v17
    v_fma_f32 v30, v26, s55, v17
    v_fma_f32 v31, v27, s55, v17
    s_nop 1
    s_branch RB_176
RS_181:
    v_max3_f32 v36, v24, v25, v26
    v_max_f32 v36, v36, v27
    v_mul_f32 v36, 0x568293ee, v36
    v_mov_b32 v37, v36
    s_nop 1
    v_permlane16_swap_b32 v36, v37
    v_max_f32 v36, v36, v37
    v_mov_b32 v37, v36
    s_nop 1
    v_permlane32_swap_b32 v36, v37
    v_max_f32 v36, v36, v37
    v_ceil_f32 v36, v36
    v_max_f32 v36, v36, -v17
    v_add_f32 v37, v17, v36
    v_exp_f32 v37, -v37
    v_sub_f32 v17, 0, v36
    v_mul_f32 v20, v20, v37
    v_mul_f32 v21, v21, v37
    v_mul_f32 v22, v22, v37
    v_mul_f32 v23, v23, v37
    v_mul_f32 v18, v18, v37
    v_mul_f32 v19, v19, v37
    v_fmamk_f32 v28, v24, 0x568293ee, v17
    v_fmamk_f32 v29, v25, 0x568293ee, v17
    v_fmamk_f32 v30, v26, 0x568293ee, v17
    v_fmamk_f32 v31, v27, 0x568293ee, v17
    s_nop 1
    s_branch RB_182
RS_183:
    v_max3_f32 v36, v24, v25, v26
    v_max_f32 v36, v36, v27
    v_mul_f32 v36, s55, v36
    v_mov_b32 v37, v36
    s_nop 1
    v_permlane16_swap_b32 v36, v37
    v_max_f32 v36, v36, v37
    v_mov_b32 v37, v36
    s_nop 1
    v_permlane32_swap_b32 v36, v37
    v_max_f32 v36, v36, v37
    v_ceil_f32 v36, v36
    v_max_f32 v36, v36, -v17
    v_add_f32 v37, v17, v36
    v_exp_f32 v37, -v37
    v_sub_f32 v17, 0, v36
    v_mul_f32 v20, v20, v37
    v_mul_f32 v21, v21, v37
    v_mul_f32 v22, v22, v37
    v_mul_f32 v23, v23, v37
    v_mul_f32 v18, v18, v37
    v_mul_f32 v19, v19, v37
    v_fma_f32 v28, v24, s55, v17
    v_fma_f32 v29, v25, s55, v17
    v_fma_f32 v30, v26, s55, v17
    v_fma_f32 v31, v27, s55, v17
    s_nop 1
    s_branch RB_184
RS_187:
    v_max3_f32 v36, v24, v25, v26
    v_max_f32 v36, v36, v27
    v_mul_f32 v36, 0x568293ee, v36
    v_mov_b32 v37, v36
    s_nop 1
    v_permlane16_swap_b32 v36, v37
    v_max_f32 v36, v36, v37
    v_mov_b32 v37, v36
    s_nop 1
    v_permlane32_swap_b32 v36, v37
    v_max_f32 v36, v36, v37
    v_ceil_f32 v36, v36
    v_max_f32 v36, v36, -v17
    v_add_f32 v37, v17, v36
    v_exp_f32 v37, -v37
    v_sub_f32 v17, 0, v36
    v_mul_f32 v20, v20, v37
    v_mul_f32 v21, v21, v37
    v_mul_f32 v22, v22, v37
    v_mul_f32 v23, v23, v37
    v_mul_f32 v18, v18, v37
    v_mul_f32 v19, v19, v37
    v_fmamk_f32 v28, v24, 0x568293ee, v17
    v_fmamk_f32 v29, v25, 0x568293ee, v17
    v_fmamk_f32 v30, v26, 0x568293ee, v17
    v_fmamk_f32 v31, v27, 0x568293ee, v17
    s_nop 1
    s_branch RB_188
RS_189:
    v_max3_f32 v36, v24, v25, v26
    v_max_f32 v36, v36, v27
    v_mul_f32 v36, s55, v36
    v_mov_b32 v37, v36
    s_nop 1
    v_permlane16_swap_b32 v36, v37
    v_max_f32 v36, v36, v37
    v_mov_b32 v37, v36
    s_nop 1
    v_permlane32_swap_b32 v36, v37
    v_max_f32 v36, v36, v37
    v_ceil_f32 v36, v36
    v_max_f32 v36, v36, -v17
    v_add_f32 v37, v17, v36
    v_exp_f32 v37, -v37
    v_sub_f32 v17, 0, v36
    v_mul_f32 v20, v20, v37
    v_mul_f32 v21, v21, v37
    v_mul_f32 v22, v22, v37
    v_mul_f32 v23, v23, v37
    v_mul_f32 v18, v18, v37
    v_mul_f32 v19, v19, v37
    v_fma_f32 v28, v24, s55, v17
    v_fma_f32 v29, v25, s55, v17
    v_fma_f32 v30, v26, s55, v17
    v_fma_f32 v31, v27, s55, v17
    s_nop 1
    s_branch RB_190
RS_194:
    v_max3_f32 v36, v24, v25, v26
    v_max_f32 v36, v36, v27
    v_mul_f32 v36, 0x568293ee, v36
    v_mov_b32 v37, v36
    s_nop 1
    v_permlane16_swap_b32 v36, v37
    v_max_f32 v36, v36, v37
    v_mov_b32 v37, v36
    s_nop 1
    v_permlane32_swap_b32 v36, v37
    v_max_f32 v36, v36, v37
    v_ceil_f32 v36, v36
    v_max_f32 v36, v36, -v17
    v_add_f32 v37, v17, v36
    v_exp_f32 v37, -v37
    v_sub_f32 v17, 0, v36
    v_mul_f32 v20, v20, v37
    v_mul_f32 v21, v21, v37
    v_mul_f32 v22, v22, v37
    v_mul_f32 v23, v23, v37
    v_mul_f32 v18, v18, v37
    v_mul_f32 v19, v19, v37
    v_fmamk_f32 v28, v24, 0x568293ee, v17
    v_fmamk_f32 v29, v25, 0x568293ee, v17
    v_fmamk_f32 v30, v26, 0x568293ee, v17
    v_fmamk_f32 v31, v27, 0x568293ee, v17
    s_nop 1
    s_branch RB_195
RS_196:
    v_max3_f32 v36, v24, v25, v26
    v_max_f32 v36, v36, v27
    v_mul_f32 v36, s55, v36
    v_mov_b32 v37, v36
    s_nop 1
    v_permlane16_swap_b32 v36, v37
    v_max_f32 v36, v36, v37
    v_mov_b32 v37, v36
    s_nop 1
    v_permlane32_swap_b32 v36, v37
    v_max_f32 v36, v36, v37
    v_ceil_f32 v36, v36
    v_max_f32 v36, v36, -v17
    v_add_f32 v37, v17, v36
    v_exp_f32 v37, -v37
    v_sub_f32 v17, 0, v36
    v_mul_f32 v20, v20, v37
    v_mul_f32 v21, v21, v37
    v_mul_f32 v22, v22, v37
    v_mul_f32 v23, v23, v37
    v_mul_f32 v18, v18, v37
    v_mul_f32 v19, v19, v37
    v_fma_f32 v28, v24, s55, v17
    v_fma_f32 v29, v25, s55, v17
    v_fma_f32 v30, v26, s55, v17
    v_fma_f32 v31, v27, s55, v17
    s_nop 1
    s_branch RB_197
RS_203:
    v_max3_f32 v36, v24, v25, v26
    v_max_f32 v36, v36, v27
    v_mul_f32 v36, 0x568293ee, v36
    v_mov_b32 v37, v36
    s_nop 1
    v_permlane16_swap_b32 v36, v37
    v_max_f32 v36, v36, v37
    v_mov_b32 v37, v36
    s_nop 1
    v_permlane32_swap_b32 v36, v37
    v_max_f32 v36, v36, v37
    v_ceil_f32 v36, v36
    v_max_f32 v36, v36, -v17
    v_add_f32 v37, v17, v36
    v_exp_f32 v37, -v37
    v_sub_f32 v17, 0, v36
    v_mul_f32 v20, v20, v37
    v_mul_f32 v21, v21, v37
    v_mul_f32 v22, v22, v37
    v_mul_f32 v23, v23, v37
    v_mul_f32 v18, v18, v37
    v_mul_f32 v19, v19, v37
    v_fmamk_f32 v28, v24, 0x568293ee, v17
    v_fmamk_f32 v29, v25, 0x568293ee, v17
    v_fmamk_f32 v30, v26, 0x568293ee, v17
    v_fmamk_f32 v31, v27, 0x568293ee, v17
    s_nop 1
    s_branch RB_204
RS_205:
    v_max3_f32 v36, v24, v25, v26
    v_max_f32 v36, v36, v27
    v_mul_f32 v36, s55, v36
    v_mov_b32 v37, v36
    s_nop 1
    v_permlane16_swap_b32 v36, v37
    v_max_f32 v36, v36, v37
    v_mov_b32 v37, v36
    s_nop 1
    v_permlane32_swap_b32 v36, v37
    v_max_f32 v36, v36, v37
    v_ceil_f32 v36, v36
    v_max_f32 v36, v36, -v17
    v_add_f32 v37, v17, v36
    v_exp_f32 v37, -v37
    v_sub_f32 v17, 0, v36
    v_mul_f32 v20, v20, v37
    v_mul_f32 v21, v21, v37
    v_mul_f32 v22, v22, v37
    v_mul_f32 v23, v23, v37
    v_mul_f32 v18, v18, v37
    v_mul_f32 v19, v19, v37
    v_fma_f32 v28, v24, s55, v17
    v_fma_f32 v29, v25, s55, v17
    v_fma_f32 v30, v26, s55, v17
    v_fma_f32 v31, v27, s55, v17
    s_nop 1
    s_branch RB_206
RS_212:
    v_max3_f32 v36, v24, v25, v26
    v_max_f32 v36, v36, v27
    v_mul_f32 v36, 0x568293ee, v36
    v_mov_b32 v37, v36
    s_nop 1
    v_permlane16_swap_b32 v36, v37
    v_max_f32 v36, v36, v37
    v_mov_b32 v37, v36
    s_nop 1
    v_permlane32_swap_b32 v36, v37
    v_max_f32 v36, v36, v37
    v_ceil_f32 v36, v36
    v_max_f32 v36, v36, -v17
    v_add_f32 v37, v17, v36
    v_exp_f32 v37, -v37
    v_sub_f32 v17, 0, v36
    v_mul_f32 v20, v20, v37
    v_mul_f32 v21, v21, v37
    v_mul_f32 v22, v22, v37
    v_mul_f32 v23, v23, v37
    v_mul_f32 v18, v18, v37
    v_mul_f32 v19, v19, v37
    v_fmamk_f32 v28, v24, 0x568293ee, v17
    v_fmamk_f32 v29, v25, 0x568293ee, v17
    v_fmamk_f32 v30, v26, 0x568293ee, v17
    v_fmamk_f32 v31, v27, 0x568293ee, v17
    s_nop 1
    s_branch RB_213
RS_214:
    v_max3_f32 v36, v24, v25, v26
    v_max_f32 v36, v36, v27
    v_mul_f32 v36, s55, v36
    v_mov_b32 v37, v36
    s_nop 1
    v_permlane16_swap_b32 v36, v37
    v_max_f32 v36, v36, v37
    v_mov_b32 v37, v36
    s_nop 1
    v_permlane32_swap_b32 v36, v37
    v_max_f32 v36, v36, v37
    v_ceil_f32 v36, v36
    v_max_f32 v36, v36, -v17
    v_add_f32 v37, v17, v36
    v_exp_f32 v37, -v37
    v_sub_f32 v17, 0, v36
    v_mul_f32 v20, v20, v37
    v_mul_f32 v21, v21, v37
    v_mul_f32 v22, v22, v37
    v_mul_f32 v23, v23, v37
    v_mul_f32 v18, v18, v37
    v_mul_f32 v19, v19, v37
    v_fma_f32 v28, v24, s55, v17
    v_fma_f32 v29, v25, s55, v17
    v_fma_f32 v30, v26, s55, v17
    v_fma_f32 v31, v27, s55, v17
    s_nop 1
    s_branch RB_215
RS_221:
    v_max3_f32 v36, v24, v25, v26
    v_max_f32 v36, v36, v27
    v_mul_f32 v36, 0x568293ee, v36
    v_mov_b32 v37, v36
    s_nop 1
    v_permlane16_swap_b32 v36, v37
    v_max_f32 v36, v36, v37
    v_mov_b32 v37, v36
    s_nop 1
    v_permlane32_swap_b32 v36, v37
    v_max_f32 v36, v36, v37
    v_ceil_f32 v36, v36
    v_max_f32 v36, v36, -v17
    v_add_f32 v37, v17, v36
    v_exp_f32 v37, -v37
    v_sub_f32 v17, 0, v36
    v_mul_f32 v20, v20, v37
    v_mul_f32 v21, v21, v37
    v_mul_f32 v22, v22, v37
    v_mul_f32 v23, v23, v37
    v_mul_f32 v18, v18, v37
    v_mul_f32 v19, v19, v37
    v_fmamk_f32 v28, v24, 0x568293ee, v17
    v_fmamk_f32 v29, v25, 0x568293ee, v17
    v_fmamk_f32 v30, v26, 0x568293ee, v17
    v_fmamk_f32 v31, v27, 0x568293ee, v17
    s_nop 1
    s_branch RB_222
RS_223:
    v_max3_f32 v36, v24, v25, v26
    v_max_f32 v36, v36, v27
    v_mul_f32 v36, s55, v36
    v_mov_b32 v37, v36
    s_nop 1
    v_permlane16_swap_b32 v36, v37
    v_max_f32 v36, v36, v37
    v_mov_b32 v37, v36
    s_nop 1
    v_permlane32_swap_b32 v36, v37
    v_max_f32 v36, v36, v37
    v_ceil_f32 v36, v36
    v_max_f32 v36, v36, -v17
    v_add_f32 v37, v17, v36
    v_exp_f32 v37, -v37
    v_sub_f32 v17, 0, v36
    v_mul_f32 v20, v20, v37
    v_mul_f32 v21, v21, v37
    v_mul_f32 v22, v22, v37
    v_mul_f32 v23, v23, v37
    v_mul_f32 v18, v18, v37
    v_mul_f32 v19, v19, v37
    v_fma_f32 v28, v24, s55, v17
    v_fma_f32 v29, v25, s55, v17
    v_fma_f32 v30, v26, s55, v17
    v_fma_f32 v31, v27, s55, v17
    s_nop 1
    s_branch RB_224
RS_231:
    v_max3_f32 v36, v24, v25, v26
    v_max_f32 v36, v36, v27
    v_mul_f32 v36, s55, v36
    v_mov_b32 v37, v36
    s_nop 1
    v_permlane16_swap_b32 v36, v37
    v_max_f32 v36, v36, v37
    v_mov_b32 v37, v36
    s_nop 1
    v_permlane32_swap_b32 v36, v37
    v_max_f32 v36, v36, v37
    v_ceil_f32 v36, v36
    v_max_f32 v36, v36, -v17
    v_add_f32 v37, v17, v36
    v_exp_f32 v37, -v37
    v_sub_f32 v17, 0, v36
    v_mul_f32 v20, v20, v37
    v_mul_f32 v21, v21, v37
    v_mul_f32 v22, v22, v37
    v_mul_f32 v23, v23, v37
    v_mul_f32 v18, v18, v37
    v_mul_f32 v19, v19, v37
    v_fma_f32 v28, v24, s55, v17
    v_fma_f32 v29, v25, s55, v17
    v_fma_f32 v30, v26, s55, v17
    v_fma_f32 v31, v27, s55, v17
    s_nop 1
    s_branch RB_232
RS_235:
    v_max3_f32 v36, v24, v25, v26
    v_max_f32 v36, v36, v27
    v_mul_f32 v36, s55, v36
    v_mov_b32 v37, v36
    s_nop 1
    v_permlane16_swap_b32 v36, v37
    v_max_f32 v36, v36, v37
    v_mov_b32 v37, v36
    s_nop 1
    v_permlane32_swap_b32 v36, v37
    v_max_f32 v36, v36, v37
    v_ceil_f32 v36, v36
    v_max_f32 v36, v36, -v17
    v_add_f32 v37, v17, v36
    v_exp_f32 v37, -v37
    v_sub_f32 v17, 0, v36
    v_mul_f32 v20, v20, v37
    v_mul_f32 v21, v21, v37
    v_mul_f32 v22, v22, v37
    v_mul_f32 v23, v23, v37
    v_mul_f32 v18, v18, v37
    v_mul_f32 v19, v19, v37
    v_fma_f32 v28, v24, s55, v17
    v_fma_f32 v29, v25, s55, v17
    v_fma_f32 v30, v26, s55, v17
    v_fma_f32 v31, v27, s55, v17
    s_nop 1
    s_branch RB_236
RS_239:
    v_max3_f32 v36, v24, v25, v26
    v_max_f32 v36, v36, v27
    v_mul_f32 v36, s55, v36
    v_mov_b32 v37, v36
    s_nop 1
    v_permlane16_swap_b32 v36, v37
    v_max_f32 v36, v36, v37
    v_mov_b32 v37, v36
    s_nop 1
    v_permlane32_swap_b32 v36, v37
    v_max_f32 v36, v36, v37
    v_ceil_f32 v36, v36
    v_max_f32 v36, v36, -v17
    v_add_f32 v37, v17, v36
    v_exp_f32 v37, -v37
    v_sub_f32 v17, 0, v36
    v_mul_f32 v20, v20, v37
    v_mul_f32 v21, v21, v37
    v_mul_f32 v22, v22, v37
    v_mul_f32 v23, v23, v37
    v_mul_f32 v18, v18, v37
    v_mul_f32 v19, v19, v37
    v_fma_f32 v28, v24, s55, v17
    v_fma_f32 v29, v25, s55, v17
    v_fma_f32 v30, v26, s55, v17
    v_fma_f32 v31, v27, s55, v17
    s_nop 1
    s_branch RB_240
RS_241:
    v_max3_f32 v36, v24, v25, v26
    v_max_f32 v36, v36, v27
    v_mul_f32 v36, s55, v36
    v_mov_b32 v37, v36
    s_nop 1
    v_permlane16_swap_b32 v36, v37
    v_max_f32 v36, v36, v37
    v_mov_b32 v37, v36
    s_nop 1
    v_permlane32_swap_b32 v36, v37
    v_max_f32 v36, v36, v37
    v_ceil_f32 v36, v36
    v_max_f32 v36, v36, -v17
    v_add_f32 v37, v17, v36
    v_exp_f32 v37, -v37
    v_sub_f32 v17, 0, v36
    v_mul_f32 v20, v20, v37
    v_mul_f32 v21, v21, v37
    v_mul_f32 v22, v22, v37
    v_mul_f32 v23, v23, v37
    v_mul_f32 v18, v18, v37
    v_mul_f32 v19, v19, v37
    v_fma_f32 v28, v24, s55, v17
    v_fma_f32 v29, v25, s55, v17
    v_fma_f32 v30, v26, s55, v17
    v_fma_f32 v31, v27, s55, v17
    s_nop 1
    s_branch RB_242
RS_303:
    v_max3_f32 v36, v24, v25, v26
    v_max_f32 v36, v36, v27
    v_mul_f32 v36, s55, v36
    v_mov_b32 v37, v36
    s_nop 1
    v_permlane16_swap_b32 v36, v37
    v_max_f32 v36, v36, v37
    v_mov_b32 v37, v36
    s_nop 1
    v_permlane32_swap_b32 v36, v37
    v_max_f32 v36, v36, v37
    v_ceil_f32 v36, v36
    v_max_f32 v36, v36, -v17
    v_add_f32 v37, v17, v36
    v_exp_f32 v37, -v37
    v_sub_f32 v17, 0, v36
    v_mul_f32 v20, v20, v37
    v_mul_f32 v21, v21, v37
    v_mul_f32 v22, v22, v37
    v_mul_f32 v23, v23, v37
    v_mul_f32 v18, v18, v37
    v_mul_f32 v19, v19, v37
    v_fma_f32 v28, v24, s55, v17
    v_fma_f32 v29, v25, s55, v17
    v_fma_f32 v30, v26, s55, v17
    v_fma_f32 v31, v27, s55, v17
    s_nop 1
    s_branch RB_304
RS_305:
    v_max3_f32 v36, v24, v25, v26
    v_max_f32 v36, v36, v27
    v_mul_f32 v36, s55, v36
    v_mov_b32 v37, v36
    s_nop 1
    v_permlane16_swap_b32 v36, v37
    v_max_f32 v36, v36, v37
    v_mov_b32 v37, v36
    s_nop 1
    v_permlane32_swap_b32 v36, v37
    v_max_f32 v36, v36, v37
    v_ceil_f32 v36, v36
    v_max_f32 v36, v36, -v17
    v_add_f32 v37, v17, v36
    v_exp_f32 v37, -v37
    v_sub_f32 v17, 0, v36
    v_mul_f32 v20, v20, v37
    v_mul_f32 v21, v21, v37
    v_mul_f32 v22, v22, v37
    v_mul_f32 v23, v23, v37
    v_mul_f32 v18, v18, v37
    v_mul_f32 v19, v19, v37
    v_fma_f32 v28, v24, s55, v17
    v_fma_f32 v29, v25, s55, v17
    v_fma_f32 v30, v26, s55, v17
    v_fma_f32 v31, v27, s55, v17
    s_nop 1
    s_branch RB_306
RS_307:
    v_max3_f32 v36, v24, v25, v26
    v_max_f32 v36, v36, v27
    v_mul_f32 v36, s55, v36
    v_mov_b32 v37, v36
    s_nop 1
    v_permlane16_swap_b32 v36, v37
    v_max_f32 v36, v36, v37
    v_mov_b32 v37, v36
    s_nop 1
    v_permlane32_swap_b32 v36, v37
    v_max_f32 v36, v36, v37
    v_ceil_f32 v36, v36
    v_max_f32 v36, v36, -v17
    v_add_f32 v37, v17, v36
    v_exp_f32 v37, -v37
    v_sub_f32 v17, 0, v36
    v_mul_f32 v20, v20, v37
    v_mul_f32 v21, v21, v37
    v_mul_f32 v22, v22, v37
    v_mul_f32 v23, v23, v37
    v_mul_f32 v18, v18, v37
    v_mul_f32 v19, v19, v37
    v_fma_f32 v28, v24, s55, v17
    v_fma_f32 v29, v25, s55, v17
    v_fma_f32 v30, v26, s55, v17
    v_fma_f32 v31, v27, s55, v17
    s_nop 1
    s_branch RB_308
RS_309:
    v_max3_f32 v36, v24, v25, v26
    v_max_f32 v36, v36, v27
    v_mul_f32 v36, s55, v36
    v_mov_b32 v37, v36
    s_nop 1
    v_permlane16_swap_b32 v36, v37
    v_max_f32 v36, v36, v37
    v_mov_b32 v37, v36
    s_nop 1
    v_permlane32_swap_b32 v36, v37
    v_max_f32 v36, v36, v37
    v_ceil_f32 v36, v36
    v_max_f32 v36, v36, -v17
    v_add_f32 v37, v17, v36
    v_exp_f32 v37, -v37
    v_sub_f32 v17, 0, v36
    v_mul_f32 v20, v20, v37
    v_mul_f32 v21, v21, v37
    v_mul_f32 v22, v22, v37
    v_mul_f32 v23, v23, v37
    v_mul_f32 v18, v18, v37
    v_mul_f32 v19, v19, v37
    v_fma_f32 v28, v24, s55, v17
    v_fma_f32 v29, v25, s55, v17
    v_fma_f32 v30, v26, s55, v17
    v_fma_f32 v31, v27, s55, v17
    s_nop 1
    s_branch RB_310
RS_311:
    v_max3_f32 v36, v24, v25, v26
    v_max_f32 v36, v36, v27
    v_mul_f32 v36, s55, v36
    v_mov_b32 v37, v36
    s_nop 1
    v_permlane16_swap_b32 v36, v37
    v_max_f32 v36, v36, v37
    v_mov_b32 v37, v36
    s_nop 1
    v_permlane32_swap_b32 v36, v37
    v_max_f32 v36, v36, v37
    v_ceil_f32 v36, v36
    v_max_f32 v36, v36, -v17
    v_add_f32 v37, v17, v36
    v_exp_f32 v37, -v37
    v_sub_f32 v17, 0, v36
    v_mul_f32 v20, v20, v37
    v_mul_f32 v21, v21, v37
    v_mul_f32 v22, v22, v37
    v_mul_f32 v23, v23, v37
    v_mul_f32 v18, v18, v37
    v_mul_f32 v19, v19, v37
    v_fma_f32 v28, v24, s55, v17
    v_fma_f32 v29, v25, s55, v17
    v_fma_f32 v30, v26, s55, v17
    v_fma_f32 v31, v27, s55, v17
    s_nop 1
    s_branch RB_312
RS_313:
    v_max3_f32 v36, v24, v25, v26
    v_max_f32 v36, v36, v27
    v_mul_f32 v36, s55, v36
    v_mov_b32 v37, v36
    s_nop 1
    v_permlane16_swap_b32 v36, v37
    v_max_f32 v36, v36, v37
    v_mov_b32 v37, v36
    s_nop 1
    v_permlane32_swap_b32 v36, v37
    v_max_f32 v36, v36, v37
    v_ceil_f32 v36, v36
    v_max_f32 v36, v36, -v17
    v_add_f32 v37, v17, v36
    v_exp_f32 v37, -v37
    v_sub_f32 v17, 0, v36
    v_mul_f32 v20, v20, v37
    v_mul_f32 v21, v21, v37
    v_mul_f32 v22, v22, v37
    v_mul_f32 v23, v23, v37
    v_mul_f32 v18, v18, v37
    v_mul_f32 v19, v19, v37
    v_fma_f32 v28, v24, s55, v17
    v_fma_f32 v29, v25, s55, v17
    v_fma_f32 v30, v26, s55, v17
    v_fma_f32 v31, v27, s55, v17
    s_nop 1
    s_branch RB_314
RS_315:
    v_max3_f32 v36, v24, v25, v26
    v_max_f32 v36, v36, v27
    v_mul_f32 v36, s55, v36
    v_mov_b32 v37, v36
    s_nop 1
    v_permlane16_swap_b32 v36, v37
    v_max_f32 v36, v36, v37
    v_mov_b32 v37, v36
    s_nop 1
    v_permlane32_swap_b32 v36, v37
    v_max_f32 v36, v36, v37
    v_ceil_f32 v36, v36
    v_max_f32 v36, v36, -v17
    v_add_f32 v37, v17, v36
    v_exp_f32 v37, -v37
    v_sub_f32 v17, 0, v36
    v_mul_f32 v20, v20, v37
    v_mul_f32 v21, v21, v37
    v_mul_f32 v22, v22, v37
    v_mul_f32 v23, v23, v37
    v_mul_f32 v18, v18, v37
    v_mul_f32 v19, v19, v37
    v_fma_f32 v28, v24, s55, v17
    v_fma_f32 v29, v25, s55, v17
    v_fma_f32 v30, v26, s55, v17
    v_fma_f32 v31, v27, s55, v17
    s_nop 1
    s_branch RB_316
RS_317:
    v_max3_f32 v36, v24, v25, v26
    v_max_f32 v36, v36, v27
    v_mul_f32 v36, s55, v36
    v_mov_b32 v37, v36
    s_nop 1
    v_permlane16_swap_b32 v36, v37
    v_max_f32 v36, v36, v37
    v_mov_b32 v37, v36
    s_nop 1
    v_permlane32_swap_b32 v36, v37
    v_max_f32 v36, v36, v37
    v_ceil_f32 v36, v36
    v_max_f32 v36, v36, -v17
    v_add_f32 v37, v17, v36
    v_exp_f32 v37, -v37
    v_sub_f32 v17, 0, v36
    v_mul_f32 v20, v20, v37
    v_mul_f32 v21, v21, v37
    v_mul_f32 v22, v22, v37
    v_mul_f32 v23, v23, v37
    v_mul_f32 v18, v18, v37
    v_mul_f32 v19, v19, v37
    v_fma_f32 v28, v24, s55, v17
    v_fma_f32 v29, v25, s55, v17
    v_fma_f32 v30, v26, s55, v17
    v_fma_f32 v31, v27, s55, v17
    s_nop 1
    s_branch RB_318
RS_319:
    v_max3_f32 v36, v24, v25, v26
    v_max_f32 v36, v36, v27
    v_mul_f32 v36, s55, v36
    v_mov_b32 v37, v36
    s_nop 1
    v_permlane16_swap_b32 v36, v37
    v_max_f32 v36, v36, v37
    v_mov_b32 v37, v36
    s_nop 1
    v_permlane32_swap_b32 v36, v37
    v_max_f32 v36, v36, v37
    v_ceil_f32 v36, v36
    v_max_f32 v36, v36, -v17
    v_add_f32 v37, v17, v36
    v_exp_f32 v37, -v37
    v_sub_f32 v17, 0, v36
    v_mul_f32 v20, v20, v37
    v_mul_f32 v21, v21, v37
    v_mul_f32 v22, v22, v37
    v_mul_f32 v23, v23, v37
    v_mul_f32 v18, v18, v37
    v_mul_f32 v19, v19, v37
    v_fma_f32 v28, v24, s55, v17
    v_fma_f32 v29, v25, s55, v17
    v_fma_f32 v30, v26, s55, v17
    v_fma_f32 v31, v27, s55, v17
    s_nop 1
    s_branch RB_320
RS_321:
    v_max3_f32 v36, v24, v25, v26
    v_max_f32 v36, v36, v27
    v_mul_f32 v36, s55, v36
    v_mov_b32 v37, v36
    s_nop 1
    v_permlane16_swap_b32 v36, v37
    v_max_f32 v36, v36, v37
    v_mov_b32 v37, v36
    s_nop 1
    v_permlane32_swap_b32 v36, v37
    v_max_f32 v36, v36, v37
    v_ceil_f32 v36, v36
    v_max_f32 v36, v36, -v17
    v_add_f32 v37, v17, v36
    v_exp_f32 v37, -v37
    v_sub_f32 v17, 0, v36
    v_mul_f32 v20, v20, v37
    v_mul_f32 v21, v21, v37
    v_mul_f32 v22, v22, v37
    v_mul_f32 v23, v23, v37
    v_mul_f32 v18, v18, v37
    v_mul_f32 v19, v19, v37
    v_fma_f32 v28, v24, s55, v17
    v_fma_f32 v29, v25, s55, v17
    v_fma_f32 v30, v26, s55, v17
    v_fma_f32 v31, v27, s55, v17
    s_nop 1
    s_branch RB_322
RS_323:
    v_max3_f32 v36, v24, v25, v26
    v_max_f32 v36, v36, v27
    v_mul_f32 v36, s55, v36
    v_mov_b32 v37, v36
    s_nop 1
    v_permlane16_swap_b32 v36, v37
    v_max_f32 v36, v36, v37
    v_mov_b32 v37, v36
    s_nop 1
    v_permlane32_swap_b32 v36, v37
    v_max_f32 v36, v36, v37
    v_ceil_f32 v36, v36
    v_max_f32 v36, v36, -v17
    v_add_f32 v37, v17, v36
    v_exp_f32 v37, -v37
    v_sub_f32 v17, 0, v36
    v_mul_f32 v20, v20, v37
    v_mul_f32 v21, v21, v37
    v_mul_f32 v22, v22, v37
    v_mul_f32 v23, v23, v37
    v_mul_f32 v18, v18, v37
    v_mul_f32 v19, v19, v37
    v_fma_f32 v28, v24, s55, v17
    v_fma_f32 v29, v25, s55, v17
    v_fma_f32 v30, v26, s55, v17
    v_fma_f32 v31, v27, s55, v17
    s_nop 1
    s_branch RB_324
RS_325:
    v_max3_f32 v36, v24, v25, v26
    v_max_f32 v36, v36, v27
    v_mul_f32 v36, s55, v36
    v_mov_b32 v37, v36
    s_nop 1
    v_permlane16_swap_b32 v36, v37
    v_max_f32 v36, v36, v37
    v_mov_b32 v37, v36
    s_nop 1
    v_permlane32_swap_b32 v36, v37
    v_max_f32 v36, v36, v37
    v_ceil_f32 v36, v36
    v_max_f32 v36, v36, -v17
    v_add_f32 v37, v17, v36
    v_exp_f32 v37, -v37
    v_sub_f32 v17, 0, v36
    v_mul_f32 v20, v20, v37
    v_mul_f32 v21, v21, v37
    v_mul_f32 v22, v22, v37
    v_mul_f32 v23, v23, v37
    v_mul_f32 v18, v18, v37
    v_mul_f32 v19, v19, v37
    v_fma_f32 v28, v24, s55, v17
    v_fma_f32 v29, v25, s55, v17
    v_fma_f32 v30, v26, s55, v17
    v_fma_f32 v31, v27, s55, v17
    s_nop 1
    s_branch RB_326
RS_327:
    v_max3_f32 v36, v24, v25, v26
    v_max_f32 v36, v36, v27
    v_mul_f32 v36, s55, v36
    v_mov_b32 v37, v36
    s_nop 1
    v_permlane16_swap_b32 v36, v37
    v_max_f32 v36, v36, v37
    v_mov_b32 v37, v36
    s_nop 1
    v_permlane32_swap_b32 v36, v37
    v_max_f32 v36, v36, v37
    v_ceil_f32 v36, v36
    v_max_f32 v36, v36, -v17
    v_add_f32 v37, v17, v36
    v_exp_f32 v37, -v37
    v_sub_f32 v17, 0, v36
    v_mul_f32 v20, v20, v37
    v_mul_f32 v21, v21, v37
    v_mul_f32 v22, v22, v37
    v_mul_f32 v23, v23, v37
    v_mul_f32 v18, v18, v37
    v_mul_f32 v19, v19, v37
    v_fma_f32 v28, v24, s55, v17
    v_fma_f32 v29, v25, s55, v17
    v_fma_f32 v30, v26, s55, v17
    v_fma_f32 v31, v27, s55, v17
    s_nop 1
    s_branch RB_328
RS_329:
    v_max3_f32 v36, v24, v25, v26
    v_max_f32 v36, v36, v27
    v_mul_f32 v36, s55, v36
    v_mov_b32 v37, v36
    s_nop 1
    v_permlane16_swap_b32 v36, v37
    v_max_f32 v36, v36, v37
    v_mov_b32 v37, v36
    s_nop 1
    v_permlane32_swap_b32 v36, v37
    v_max_f32 v36, v36, v37
    v_ceil_f32 v36, v36
    v_max_f32 v36, v36, -v17
    v_add_f32 v37, v17, v36
    v_exp_f32 v37, -v37
    v_sub_f32 v17, 0, v36
    v_mul_f32 v20, v20, v37
    v_mul_f32 v21, v21, v37
    v_mul_f32 v22, v22, v37
    v_mul_f32 v23, v23, v37
    v_mul_f32 v18, v18, v37
    v_mul_f32 v19, v19, v37
    v_fma_f32 v28, v24, s55, v17
    v_fma_f32 v29, v25, s55, v17
    v_fma_f32 v30, v26, s55, v17
    v_fma_f32 v31, v27, s55, v17
    s_nop 1
    s_branch RB_330
RS_331:
    v_max3_f32 v36, v24, v25, v26
    v_max_f32 v36, v36, v27
    v_mul_f32 v36, s55, v36
    v_mov_b32 v37, v36
    s_nop 1
    v_permlane16_swap_b32 v36, v37
    v_max_f32 v36, v36, v37
    v_mov_b32 v37, v36
    s_nop 1
    v_permlane32_swap_b32 v36, v37
    v_max_f32 v36, v36, v37
    v_ceil_f32 v36, v36
    v_max_f32 v36, v36, -v17
    v_add_f32 v37, v17, v36
    v_exp_f32 v37, -v37
    v_sub_f32 v17, 0, v36
    v_mul_f32 v20, v20, v37
    v_mul_f32 v21, v21, v37
    v_mul_f32 v22, v22, v37
    v_mul_f32 v23, v23, v37
    v_mul_f32 v18, v18, v37
    v_mul_f32 v19, v19, v37
    v_fma_f32 v28, v24, s55, v17
    v_fma_f32 v29, v25, s55, v17
    v_fma_f32 v30, v26, s55, v17
    v_fma_f32 v31, v27, s55, v17
    s_nop 1
    s_branch RB_332
RS_333:
    v_max3_f32 v36, v24, v25, v26
    v_max_f32 v36, v36, v27
    v_mul_f32 v36, s55, v36
    v_mov_b32 v37, v36
    s_nop 1
    v_permlane16_swap_b32 v36, v37
    v_max_f32 v36, v36, v37
    v_mov_b32 v37, v36
    s_nop 1
    v_permlane32_swap_b32 v36, v37
    v_max_f32 v36, v36, v37
    v_ceil_f32 v36, v36
    v_max_f32 v36, v36, -v17
    v_add_f32 v37, v17, v36
    v_exp_f32 v37, -v37
    v_sub_f32 v17, 0, v36
    v_mul_f32 v20, v20, v37
    v_mul_f32 v21, v21, v37
    v_mul_f32 v22, v22, v37
    v_mul_f32 v23, v23, v37
    v_mul_f32 v18, v18, v37
    v_mul_f32 v19, v19, v37
    v_fma_f32 v28, v24, s55, v17
    v_fma_f32 v29, v25, s55, v17
    v_fma_f32 v30, v26, s55, v17
    v_fma_f32 v31, v27, s55, v17
    s_nop 1
    s_branch RB_334
RS_335:
    v_max3_f32 v36, v24, v25, v26
    v_max_f32 v36, v36, v27
    v_mul_f32 v36, s55, v36
    v_mov_b32 v37, v36
    s_nop 1
    v_permlane16_swap_b32 v36, v37
    v_max_f32 v36, v36, v37
    v_mov_b32 v37, v36
    s_nop 1
    v_permlane32_swap_b32 v36, v37
    v_max_f32 v36, v36, v37
    v_ceil_f32 v36, v36
    v_max_f32 v36, v36, -v17
    v_add_f32 v37, v17, v36
    v_exp_f32 v37, -v37
    v_sub_f32 v17, 0, v36
    v_mul_f32 v20, v20, v37
    v_mul_f32 v21, v21, v37
    v_mul_f32 v22, v22, v37
    v_mul_f32 v23, v23, v37
    v_mul_f32 v18, v18, v37
    v_mul_f32 v19, v19, v37
    v_fma_f32 v28, v24, s55, v17
    v_fma_f32 v29, v25, s55, v17
    v_fma_f32 v30, v26, s55, v17
    v_fma_f32 v31, v27, s55, v17
    s_nop 1
    s_branch RB_336
RS_337:
    v_max3_f32 v36, v24, v25, v26
    v_max_f32 v36, v36, v27
    v_mul_f32 v36, s55, v36
    v_mov_b32 v37, v36
    s_nop 1
    v_permlane16_swap_b32 v36, v37
    v_max_f32 v36, v36, v37
    v_mov_b32 v37, v36
    s_nop 1
    v_permlane32_swap_b32 v36, v37
    v_max_f32 v36, v36, v37
    v_ceil_f32 v36, v36
    v_max_f32 v36, v36, -v17
    v_add_f32 v37, v17, v36
    v_exp_f32 v37, -v37
    v_sub_f32 v17, 0, v36
    v_mul_f32 v20, v20, v37
    v_mul_f32 v21, v21, v37
    v_mul_f32 v22, v22, v37
    v_mul_f32 v23, v23, v37
    v_mul_f32 v18, v18, v37
    v_mul_f32 v19, v19, v37
    v_fma_f32 v28, v24, s55, v17
    v_fma_f32 v29, v25, s55, v17
    v_fma_f32 v30, v26, s55, v17
    v_fma_f32 v31, v27, s55, v17
    s_nop 1
    s_branch RB_338
RS_339:
    v_max3_f32 v36, v24, v25, v26
    v_max_f32 v36, v36, v27
    v_mul_f32 v36, s55, v36
    v_mov_b32 v37, v36
    s_nop 1
    v_permlane16_swap_b32 v36, v37
    v_max_f32 v36, v36, v37
    v_mov_b32 v37, v36
    s_nop 1
    v_permlane32_swap_b32 v36, v37
    v_max_f32 v36, v36, v37
    v_ceil_f32 v36, v36
    v_max_f32 v36, v36, -v17
    v_add_f32 v37, v17, v36
    v_exp_f32 v37, -v37
    v_sub_f32 v17, 0, v36
    v_mul_f32 v20, v20, v37
    v_mul_f32 v21, v21, v37
    v_mul_f32 v22, v22, v37
    v_mul_f32 v23, v23, v37
    v_mul_f32 v18, v18, v37
    v_mul_f32 v19, v19, v37
    v_fma_f32 v28, v24, s55, v17
    v_fma_f32 v29, v25, s55, v17
    v_fma_f32 v30, v26, s55, v17
    v_fma_f32 v31, v27, s55, v17
    s_nop 1
    s_branch RB_340
RS_341:
    v_max3_f32 v36, v24, v25, v26
    v_max_f32 v36, v36, v27
    v_mul_f32 v36, s55, v36
    v_mov_b32 v37, v36
    s_nop 1
    v_permlane16_swap_b32 v36, v37
    v_max_f32 v36, v36, v37
    v_mov_b32 v37, v36
    s_nop 1
    v_permlane32_swap_b32 v36, v37
    v_max_f32 v36, v36, v37
    v_ceil_f32 v36, v36
    v_max_f32 v36, v36, -v17
    v_add_f32 v37, v17, v36
    v_exp_f32 v37, -v37
    v_sub_f32 v17, 0, v36
    v_mul_f32 v20, v20, v37
    v_mul_f32 v21, v21, v37
    v_mul_f32 v22, v22, v37
    v_mul_f32 v23, v23, v37
    v_mul_f32 v18, v18, v37
    v_mul_f32 v19, v19, v37
    v_fma_f32 v28, v24, s55, v17
    v_fma_f32 v29, v25, s55, v17
    v_fma_f32 v30, v26, s55, v17
    v_fma_f32 v31, v27, s55, v17
    s_nop 1
    s_branch RB_342
.section .rodata,"a"
.p2align 6
.amdhsa_kernel interleave_layers__gqa_block_cached__glu_gated_geglu__decode_kernel
  .amdhsa_next_free_vgpr 512
  .amdhsa_next_free_sgpr 102
  .amdhsa_accum_offset 256
  .amdhsa_group_segment_fixed_size 0
  .amdhsa_kernarg_size 96
  .amdhsa_user_sgpr_count 2
  .amdhsa_user_sgpr_kernarg_segment_ptr 1
  .amdhsa_system_sgpr_workgroup_id_x 1
.end_amdhsa_kernel
```
